```python
import torch

def _softmax(x, axis=-1):
    return torch.softmax(x, dim=axis)

def _gelu(x):
    return torch.nn.functional.gelu(x, approximate='tanh')

def _silu(x):
    return torch.nn.functional.silu(x)

def _sigmoid(x):
    return torch.sigmoid(x)

def _layernorm(x, axis=-1, eps=1e-05):
    m = x.mean(dim=axis, keepdim=True)
    v = x.var(dim=axis, keepdim=True, unbiased=False)
    return (x - m) / torch.sqrt(v + eps)

def _scatter_add(tgt, idx, src, axis=0):
    return tgt.clone().index_add_(axis, idx, src)

def _segment_sum(src, seg, n):
    out = torch.zeros((n,) + src.shape[1:], dtype=src.dtype)
    return out.index_add_(0, seg, src)

def _pad(x, pw):
    flat = tuple((v for pair in reversed(pw) for v in pair))
    return torch.nn.functional.pad(x, flat)
kernel_name = 'recurrent_scan__sliding_block_cached__mixer_gmlp__prompt'

def setup_inputs():

    _w = lambda a: (lambda t: t.to(torch.bfloat16) if t.is_floating_point() else t)(torch.as_tensor(a))

    def _A_setup():
        B, Sq, D = (1, 2048, 1024)
        Hq, Hkv, Sk, Dh = (32, 4, 2048, 128)
        assert Hq % Hkv == 0, (Hq, Hkv)
        return {'x': _w((lambda *s: torch.randn(*s, dtype=torch.bfloat16) * 0.05)(B, Sq, D)), 'k_cache': _w((lambda *s: torch.randn(*s, dtype=torch.bfloat16) * 0.8)(B, Hkv, Sk, Dh)), 'v_cache': _w((lambda *s: torch.randn(*s, dtype=torch.bfloat16) * 0.2)(B, Hkv, Sk, Dh)), 'wq': _w((lambda *s: torch.randn(*s, dtype=torch.bfloat16) * 0.8)(D, Hq * Dh) * D ** (-0.5)), 'wo': _w((lambda *s: torch.randn(*s, dtype=torch.bfloat16) * 0.2)(Hq * Dh, D) * (Hq * Dh) ** (-0.5))}
    _A_in = _A_setup()

    def _B_setup():
        B, S, D, F = (1, 2048, 1024, 3584)
        Fh = F // 2
        return {'x': _w((lambda *s: torch.randn(*s, dtype=torch.bfloat16) * 0.05)(B, S, D)), 'w_in': _w((lambda *s: torch.randn(*s, dtype=torch.bfloat16) * 0.4)(D, 2 * Fh)), 'w_sp': _w(0.01 * (lambda *s: torch.randn(*s, dtype=torch.bfloat16) * 0.4)(S, S)), 'b_sp': _w(1.0 + 0.01 * (lambda *s: torch.randn(*s, dtype=torch.bfloat16) * 0.1)(S)), 'w_out': _w((lambda *s: torch.randn(*s, dtype=torch.bfloat16) * 0.1)(Fh, D))}
    _B_in = _B_setup()
    return {'A_x': _A_in['x'], 'A_k_cache': _A_in['k_cache'], 'A_v_cache': _A_in['v_cache'], 'A_wq': _A_in['wq'], 'A_wo': _A_in['wo'], 'B_x': _B_in['x'], 'B_w_in': _B_in['w_in'], 'B_w_sp': _B_in['w_sp'], 'B_b_sp': _B_in['b_sp'], 'B_w_out': _B_in['w_out']}

def reference(A_x, A_k_cache, A_v_cache, A_wq, A_wo, B_x, B_w_in, B_w_sp, B_b_sp, B_w_out):

    def _A_ref(x, k_cache, v_cache, wq, wo):
        B, Sq, D = x.shape
        Hq, Dh = (32, 128)
        Hkv, Sk = (k_cache.shape[1], k_cache.shape[2])
        W = min(4096, max(256, Sk // 4))
        rep = Hq // Hkv
        q = (lambda x, *d: x.permute(*d))((x @ wq).reshape(B, Sq, Hq, Dh), 0, 2, 1, 3)
        k = (lambda x, n, axis: torch.repeat_interleave(x, n, dim=axis))(k_cache[:, :, Sk - W:, :], rep, axis=1)
        v = (lambda x, n, axis: torch.repeat_interleave(x, n, dim=axis))(v_cache[:, :, Sk - W:, :], rep, axis=1)
        scores = torch.einsum('bhqd,bhkd->bhqk', q, k) * Dh ** (-0.5)
        p = _softmax(scores, axis=-1)
        o = torch.einsum('bhqk,bhkd->bhqd', p, v)
        return (lambda x, *d: x.permute(*d))(o, 0, 2, 1, 3).reshape(B, Sq, Hq * Dh) @ wo

    def _B_ref(x, w_in, w_sp, b_sp, w_out):
        B, S, D = x.shape
        F = w_in.shape[-1]
        Fh = F // 2
        z = _gelu(torch.einsum('bsd,df->bsf', x, w_in))
        z1 = z[..., :Fh].clone()
        z2 = _layernorm(z[..., Fh:], axis=-1)
        g = torch.einsum('ts,bsf->btf', w_sp, z2) + b_sp[None, :, None]
        return torch.einsum('bsf,fd->bsd', z1 * g, w_out)
    x = A_x
    xn = _layernorm(x, axis=-1)
    s = _A_ref(xn, A_k_cache, A_v_cache, A_wq, A_wo)
    g = _silu(_B_ref(xn, B_w_in, B_w_sp, B_b_sp, B_w_out))
    return x + s * g
```

```asm
; @launch grid=(256,1,1) block=(256,1,1) lds=163840
.amdgcn_target "amdgcn-amd-amdhsa--gfx950"
.macro mf d,a,b,c
 v_mfma_f32_16x16x32_bf16 \d,\a,\b,\c
.endm
.macro tr d,a,o
 ds_read_b64_tr_b16 \d,\a offset:\o
.endm
.macro rd d,a,o
 ds_read_b128 \d,\a offset:\o
.endm
.macro ar d,a
 v_accvgpr_read_b32 \d,\a
.endm
.text
.globl recurrent_scan__sliding_block_cached__mixer_gmlp__prompt_kernel
.p2align 8
.type recurrent_scan__sliding_block_cached__mixer_gmlp__prompt_kernel,@function
recurrent_scan__sliding_block_cached__mixer_gmlp__prompt_kernel:
 s_cmp_lt_u32 s2, 256
 s_cbranch_scc1 L_start
 s_endpgm
L_start:
 s_load_dwordx16 s[56:71], s[0:1], 0
 s_load_dwordx8 s[72:79], s[0:1], 64
 s_load_dwordx2 s[32:33], s[0:1], 96
 s_memrealtime s[40:41]
 v_lshrrev_b32 v5, 6, v0
 v_and_b32 v1, 63, v0
 v_lshrrev_b32_e64 v2, 4, v1
 v_bfe_u32 v3, v1, 2, 2
 v_and_b32 v4, 3, v1
 v_readfirstlane_b32 s20, v5
 s_lshr_b32 s39, s2, 3
 v_and_b32 v64, 7, v1
 v_lshrrev_b32 v65, 3, v1
 s_lshl_b32 s3, s2, 3
 v_add_u32 v66, s3, v64
 v_lshlrev_b32 v67, 11, v66
 s_lshl_b32 s31, s20, 5
 v_add_u32 v68, s31, v65
 v_lshl_add_u32 v67, v68, 4, v67
 s_and_b32 s21, s20, 1
 s_lshr_b32 s22, s20, 1
 s_lshl_b32 s29, s20, 12
 s_and_b32 s96, s2, 7
 s_mov_b32 s50, 30
 s_lshr_b32 s38, s39, 4
 s_cmp_ge_u32 s39, s50
 s_cselect_b32 s38, 2, s38
 s_cmp_lg_u32 s38, 0
 s_cbranch_scc1 L_dec_gm
 s_and_b32 s23, s39, 3
 s_and_b32 s50, s96, 1
 s_lshl_b32 s50, s50, 2
 s_add_u32 s23, s23, s50
 s_lshr_b32 s24, s39, 2
 s_nop 0
 s_bfe_u32 s51, s96, 0x20001
 s_lshl_b32 s51, s51, 2
 s_add_u32 s24, s24, s51
 s_lshl_b32 s26, s24, 9
 s_nop 0
 s_mov_b32 s53, 8192
 s_mov_b32 s54, 128
 s_mov_b32 s55, 256
 s_waitcnt lgkmcnt(0)
 s_mov_b32 s4, s62
 s_mov_b32 s5, s63
 s_nop 0
 s_mov_b32 s6, 0x800000
 s_mov_b32 s7, 0x20000
 s_branch L_dec_done
L_dec_gm:
 s_nop 0
 s_bfe_u32 s51, s96, 0x20001
 s_mul_i32 s51, s51, 14
 s_add_u32 s51, s51, s39
 s_sub_u32 s51, s51, 16
 s_and_b32 s23, s51, 3
 s_lshr_b32 s24, s51, 2
 s_and_b32 s50, s96, 1
 s_lshl_b32 s50, s50, 2
 s_add_u32 s23, s23, s50
 s_lshl_b32 s26, s24, 8
 s_nop 0
 s_mov_b32 s53, 7168
 s_mov_b32 s54, 3584
 s_mov_b32 s55, 128
 s_waitcnt lgkmcnt(0)
 s_mov_b32 s4, s68
 s_mov_b32 s5, s69
 s_nop 0
 s_mov_b32 s6, 0x700000
 s_mov_b32 s7, 0x20000
L_dec_done:
 s_mov_b32 s12, s56
 s_mov_b32 s13, s57
 s_mov_b32 s14, 0x400000
 s_mov_b32 s15, 0x20000
 buffer_load_dwordx4 v[80:83], v67, s[12:15], 0 offen offset:0
 buffer_load_dwordx4 v[84:87], v67, s[12:15], 0 offen offset:128
 buffer_load_dwordx4 v[88:91], v67, s[12:15], 0 offen offset:256
 buffer_load_dwordx4 v[92:95], v67, s[12:15], 0 offen offset:384
 s_mov_b32 s8, s78
 s_mov_b32 s9, s79
 s_mov_b32 s10, 0x100
 s_mov_b32 s11, 0x20000
 v_mov_b32 v60, 0
 s_or_b32 s31, s2, s20
 s_cmp_lg_u32 s31, 0
 s_cbranch_scc1 L_notag
 s_xor_b32 s41, s41, 0x9e3779b9
 v_mov_b32 v62, s40
 v_mov_b32 v63, s41
 buffer_store_dwordx2 v[62:63], v60, s[8:11], 0 offen sc1
L_notag:
 s_getpc_b64 s[44:45]
L_here:
 s_nop 0
 s_sub_u32 s44, s44, L_here - recurrent_scan__sliding_block_cached__mixer_gmlp__prompt_kernel
 s_subb_u32 s45, s45, 0
 s_nop 0
 s_mov_b32 s46, L_hot_end - recurrent_scan__sliding_block_cached__mixer_gmlp__prompt_kernel
 s_mov_b32 s47, 0x20000
 s_lshl_b32 s31, s39, 13
 v_lshlrev_b32 v61, 5, v0
 buffer_load_dword v61, v61, s[44:47], s31 offen
 s_add_u32 s16, s32, 0x2500000
 s_addc_u32 s17, s33, 0
 s_nop 0
 s_mov_b32 s18, 0x10000
 s_mov_b32 s19, 0x20000
 s_lshl_b32 s28, s53, 5
 v_lshrrev_b32 v5, 5, v1
 s_lshl_b32 s31, s20, 3
 v_add_u32 v5, s31, v5
 v_and_b32 v6, 31, v1
 v_add_u32 v7, 0, v5
 v_and_b32_e64 v13, 3, v7
 v_bfe_u32 v14, v7, 3, 1
 v_lshl_add_u32 v13, v14, 2, v13
 v_lshlrev_b32 v13, 1, v13
 v_xor_b32 v13, v13, v6
 v_mul_lo_u32 v7, v7, s53
 v_and_b32_e64 v14, 7, v13
 v_lshl_add_u32 v7, v14, 4, v7
 v_bfe_u32 v14, v13, 3, 1
 v_mad_u32_u24 v7, v14, s54, v7
 v_lshrrev_b32_e64 v14, 4, v13
 v_mad_u32_u24 v7, v14, s55, v7
 v_subrev_u32 v192, 0, v7
 v_add_u32 v7, 2, v5
 v_and_b32_e64 v13, 3, v7
 v_bfe_u32 v14, v7, 3, 1
 v_lshl_add_u32 v13, v14, 2, v13
 v_lshlrev_b32 v13, 1, v13
 v_xor_b32 v13, v13, v6
 v_mul_lo_u32 v7, v7, s53
 v_and_b32_e64 v14, 7, v13
 v_lshl_add_u32 v7, v14, 4, v7
 v_bfe_u32 v14, v13, 3, 1
 v_mad_u32_u24 v7, v14, s54, v7
 v_lshrrev_b32_e64 v14, 4, v13
 v_mad_u32_u24 v7, v14, s55, v7
 v_subrev_u32 v193, 1024, v7
 v_add_u32 v7, 4, v5
 v_and_b32 v13, 3, v7
 v_bfe_u32 v14, v7, 3, 1
 v_lshl_add_u32 v13, v14, 2, v13
 v_lshlrev_b32 v13, 1, v13
 v_xor_b32 v13, v13, v6
 v_mul_lo_u32 v7, v7, s53
 v_and_b32_e64 v14, 7, v13
 v_lshl_add_u32 v7, v14, 4, v7
 v_bfe_u32 v14, v13, 3, 1
 v_mad_u32_u24 v7, v14, s54, v7
 v_lshrrev_b32_e64 v14, 4, v13
 v_mad_u32_u24 v7, v14, s55, v7
 v_subrev_u32 v194, 2048, v7
 v_add_u32 v7, 6, v5
 v_and_b32 v13, 3, v7
 v_bfe_u32 v14, v7, 3, 1
 v_lshl_add_u32 v13, v14, 2, v13
 v_lshlrev_b32 v13, 1, v13
 v_xor_b32 v13, v13, v6
 v_mul_lo_u32 v7, v7, s53
 v_and_b32_e64 v14, 7, v13
 v_lshl_add_u32 v7, v14, 4, v7
 v_bfe_u32 v14, v13, 3, 1
 v_mad_u32_u24 v7, v14, s54, v7
 v_lshrrev_b32_e64 v14, 4, v13
 v_mad_u32_u24 v7, v14, s55, v7
 v_subrev_u32 v195, 3072, v7
 v_lshlrev_b32_e64 v196, 4, v1
 v_add_u32 v197, 31744, v196
 v_add_u32 v198, 63488, v196
 v_add_u32 v199, 95232, v196
 s_cmp_eq_u32 s38, 2
 s_cbranch_scc1 L_ln_helper
 s_add_u32 m0, s29, 0
 s_nop 0
 buffer_load_dwordx4 v192, s[4:7], s26 offen offset:0 lds
 buffer_load_dwordx4 v193, s[4:7], s26 offen offset:1024 lds
 buffer_load_dwordx4 v194, s[4:7], s26 offen offset:2048 lds
 buffer_load_dwordx4 v195, s[4:7], s26 offen offset:3072 lds
 s_add_u32 s26, s26, s28
 s_nop 0
 s_add_u32 m0, s29, 32768
 s_nop 0
 s_nop 0
 buffer_load_dwordx4 v192, s[4:7], s26 offen offset:0 lds
 buffer_load_dwordx4 v193, s[4:7], s26 offen offset:1024 lds
 buffer_load_dwordx4 v194, s[4:7], s26 offen offset:2048 lds
 buffer_load_dwordx4 v195, s[4:7], s26 offen offset:3072 lds
 s_add_u32 s26, s26, s28
 s_branch L_ln
L_ln_helper:
 s_waitcnt vmcnt(0)
L_ln:
 s_nop 0
 buffer_load_dwordx2 v[62:63], v60, s[8:11], 0 offen sc1
 v_lshrrev_b32 v69, 5, v1
 s_lshl_b32 s31, s20, 3
 v_add_u32 v69, s31, v69
 v_lshlrev_b32 v69, 10, v69
 v_lshrrev_b32_e64 v70, 4, v66
 v_lshl_add_u32 v69, v70, 15, v69
 v_and_b32_e64 v70, 3, v65
 v_lshl_add_u32 v69, v70, 8, v69
 v_and_b32_e64 v70, 15, v66
 v_lshl_add_u32 v69, v70, 4, v69
 v_add_u32 v70, s31, v64
 v_lshlrev_b32 v70, 2, v70
 v_add_u32 v70, 161792, v70
 v_lshlrev_b32_e64 v71, 2, v64
 v_add_u32 v71, 161792, v71
 s_waitcnt vmcnt(13)
 v_lshlrev_b32 v96, 16, v80
 v_and_b32 v97, 0xffff0000, v80
 v_lshlrev_b32_e64 v98, 16, v81
 v_and_b32 v99, 0xffff0000, v81
 v_lshlrev_b32_e64 v100, 16, v82
 v_and_b32 v101, 0xffff0000, v82
 v_lshlrev_b32_e64 v102, 16, v83
 v_and_b32 v103, 0xffff0000, v83
 s_waitcnt vmcnt(12)
 v_lshlrev_b32 v104, 16, v84
 v_and_b32 v105, 0xffff0000, v84
 v_lshlrev_b32_e64 v106, 16, v85
 v_and_b32 v107, 0xffff0000, v85
 v_lshlrev_b32_e64 v108, 16, v86
 v_and_b32 v109, 0xffff0000, v86
 v_lshlrev_b32_e64 v110, 16, v87
 v_and_b32 v111, 0xffff0000, v87
 s_waitcnt vmcnt(11)
 v_lshlrev_b32 v112, 16, v88
 v_and_b32 v113, 0xffff0000, v88
 v_lshlrev_b32_e64 v114, 16, v89
 v_and_b32 v115, 0xffff0000, v89
 v_lshlrev_b32_e64 v116, 16, v90
 v_and_b32 v117, 0xffff0000, v90
 v_lshlrev_b32_e64 v118, 16, v91
 v_and_b32 v119, 0xffff0000, v91
 s_waitcnt vmcnt(10)
 v_lshlrev_b32 v120, 16, v92
 v_and_b32 v121, 0xffff0000, v92
 v_lshlrev_b32_e64 v122, 16, v93
 v_and_b32 v123, 0xffff0000, v93
 v_lshlrev_b32_e64 v124, 16, v94
 v_and_b32 v125, 0xffff0000, v94
 v_lshlrev_b32_e64 v126, 16, v95
 v_and_b32 v127, 0xffff0000, v95
 v_pk_add_f32 v[72:73], v[96:97], v[98:99]
 v_pk_mul_f32 v[74:75], v[96:97], v[96:97]
 v_pk_fma_f32 v[74:75], v[98:99], v[98:99], v[74:75]
 v_pk_add_f32 v[72:73], v[72:73], v[100:101]
 v_pk_fma_f32 v[74:75], v[100:101], v[100:101], v[74:75]
 v_pk_add_f32 v[72:73], v[72:73], v[102:103]
 v_pk_fma_f32 v[74:75], v[102:103], v[102:103], v[74:75]
 v_pk_add_f32 v[72:73], v[72:73], v[104:105]
 v_pk_fma_f32 v[74:75], v[104:105], v[104:105], v[74:75]
 v_pk_add_f32 v[72:73], v[72:73], v[106:107]
 v_pk_fma_f32 v[74:75], v[106:107], v[106:107], v[74:75]
 v_pk_add_f32 v[72:73], v[72:73], v[108:109]
 v_pk_fma_f32 v[74:75], v[108:109], v[108:109], v[74:75]
 v_pk_add_f32 v[72:73], v[72:73], v[110:111]
 v_pk_fma_f32 v[74:75], v[110:111], v[110:111], v[74:75]
 v_pk_add_f32 v[72:73], v[72:73], v[112:113]
 v_pk_fma_f32 v[74:75], v[112:113], v[112:113], v[74:75]
 v_pk_add_f32 v[72:73], v[72:73], v[114:115]
 v_pk_fma_f32 v[74:75], v[114:115], v[114:115], v[74:75]
 v_pk_add_f32 v[72:73], v[72:73], v[116:117]
 v_pk_fma_f32 v[74:75], v[116:117], v[116:117], v[74:75]
 v_pk_add_f32 v[72:73], v[72:73], v[118:119]
 v_pk_fma_f32 v[74:75], v[118:119], v[118:119], v[74:75]
 v_pk_add_f32 v[72:73], v[72:73], v[120:121]
 v_pk_fma_f32 v[74:75], v[120:121], v[120:121], v[74:75]
 v_pk_add_f32 v[72:73], v[72:73], v[122:123]
 v_pk_fma_f32 v[74:75], v[122:123], v[122:123], v[74:75]
 v_pk_add_f32 v[72:73], v[72:73], v[124:125]
 v_pk_fma_f32 v[74:75], v[124:125], v[124:125], v[74:75]
 v_pk_add_f32 v[72:73], v[72:73], v[126:127]
 v_pk_fma_f32 v[74:75], v[126:127], v[126:127], v[74:75]
 v_add_f32 v72, v72, v73
 v_add_f32 v73, v74, v75
 v_lshlrev_b32 v70, 1, v70
 v_lshlrev_b32 v71, 1, v71
 v_add_f32_dpp v72, v72, v72 row_ror:8 row_mask:0xf bank_mask:0xf
 v_add_f32_dpp v73, v73, v73 row_ror:8 row_mask:0xf bank_mask:0xf
 v_subrev_u32 v70, 161792, v70
 v_subrev_u32 v71, 161792, v71
 v_mov_b32 v74, v72
 v_mov_b32 v75, v73
 s_nop 0
 v_permlane16_swap_b32 v72, v74
 v_permlane16_swap_b32_e64 v73, v75
 v_pk_add_f32 v[72:73], v[72:73], v[74:75]
 v_mov_b32 v74, v72
 v_mov_b32 v75, v73
 s_nop 0
 v_permlane32_swap_b32 v72, v74
 v_permlane32_swap_b32_e64 v73, v75
 v_pk_add_f32 v[72:73], v[72:73], v[74:75]
 ds_write_b64 v70, v[72:73]
 s_waitcnt lgkmcnt(0)
 s_barrier
 ds_read2_b64 v[128:131], v71 offset0:0 offset1:8
 ds_read2_b64 v[132:135], v71 offset0:16 offset1:24
 s_waitcnt lgkmcnt(0)
 s_nop 0
 v_pk_add_f32 v[128:129], v[128:129], v[130:131]
 v_pk_add_f32 v[132:133], v[132:133], v[134:135]
 v_pk_add_f32 v[72:73], v[128:129], v[132:133]
 v_mul_f32 v76, 0xba800000, v72
 v_mul_f32 v72, 0x3a800000, v73
 v_fma_f32 v72, -v76, v76, v72
 v_max_f32_e64 v72, 0, v72
 v_cvt_pk_bf16_f32 v76, v76, v76
 v_and_b32 v76, 0xffff0000, v76
 v_cvt_pk_bf16_f32 v72, v72, v72
 v_and_b32 v72, 0xffff0000, v72
 v_add_f32 v72, 0x3727c5ac, v72
 v_cvt_pk_bf16_f32 v72, v72, v72
 v_and_b32 v72, 0xffff0000, v72
 v_sqrt_f32 v72, v72
 s_nop 0
 v_cvt_pk_bf16_f32 v72, v72, v72
 v_and_b32 v72, 0xffff0000, v72
 v_rcp_f32_e64 v72, v72
 s_mov_b32 s12, s32
 s_mov_b32 s13, s33
 s_mov_b32 s14, 0x400000
 s_mov_b32 s15, 0x20000
 v_pk_add_f32 v[96:97], v[96:97], v[76:77] op_sel_hi:[1,0]
 v_cvt_pk_bf16_f32 v74, v96, v97
 v_lshlrev_b32_e64 v96, 16, v74
 v_and_b32 v97, 0xffff0000, v74
 v_pk_mul_f32 v[96:97], v[96:97], v[72:73] op_sel_hi:[1,0]
 v_cvt_pk_bf16_f32 v128, v96, v97
 v_pk_add_f32 v[98:99], v[98:99], v[76:77] op_sel_hi:[1,0]
 v_cvt_pk_bf16_f32 v74, v98, v99
 v_lshlrev_b32_e64 v98, 16, v74
 v_and_b32 v99, 0xffff0000, v74
 v_pk_mul_f32 v[98:99], v[98:99], v[72:73] op_sel_hi:[1,0]
 v_cvt_pk_bf16_f32 v129, v98, v99
 v_pk_add_f32 v[100:101], v[100:101], v[76:77] op_sel_hi:[1,0]
 v_cvt_pk_bf16_f32 v74, v100, v101
 v_lshlrev_b32_e64 v100, 16, v74
 v_and_b32 v101, 0xffff0000, v74
 v_pk_mul_f32 v[100:101], v[100:101], v[72:73] op_sel_hi:[1,0]
 v_cvt_pk_bf16_f32 v130, v100, v101
 v_pk_add_f32 v[102:103], v[102:103], v[76:77] op_sel_hi:[1,0]
 v_cvt_pk_bf16_f32 v74, v102, v103
 v_lshlrev_b32_e64 v102, 16, v74
 v_and_b32 v103, 0xffff0000, v74
 v_pk_mul_f32 v[102:103], v[102:103], v[72:73] op_sel_hi:[1,0]
 v_cvt_pk_bf16_f32 v131, v102, v103
 s_mov_b32 s31, 0
 s_nop 0
 buffer_store_dwordx4 v[128:131], v69, s[12:15], s31 offen sc1
 v_pk_add_f32 v[104:105], v[104:105], v[76:77] op_sel_hi:[1,0]
 v_cvt_pk_bf16_f32 v74, v104, v105
 v_lshlrev_b32_e64 v104, 16, v74
 v_and_b32 v105, 0xffff0000, v74
 v_pk_mul_f32 v[104:105], v[104:105], v[72:73] op_sel_hi:[1,0]
 v_cvt_pk_bf16_f32 v132, v104, v105
 v_pk_add_f32 v[106:107], v[106:107], v[76:77] op_sel_hi:[1,0]
 v_cvt_pk_bf16_f32 v74, v106, v107
 v_lshlrev_b32_e64 v106, 16, v74
 v_and_b32 v107, 0xffff0000, v74
 v_pk_mul_f32 v[106:107], v[106:107], v[72:73] op_sel_hi:[1,0]
 v_cvt_pk_bf16_f32 v133, v106, v107
 v_pk_add_f32 v[108:109], v[108:109], v[76:77] op_sel_hi:[1,0]
 v_cvt_pk_bf16_f32 v74, v108, v109
 v_lshlrev_b32_e64 v108, 16, v74
 v_and_b32 v109, 0xffff0000, v74
 v_pk_mul_f32 v[108:109], v[108:109], v[72:73] op_sel_hi:[1,0]
 v_cvt_pk_bf16_f32 v134, v108, v109
 v_pk_add_f32 v[110:111], v[110:111], v[76:77] op_sel_hi:[1,0]
 v_cvt_pk_bf16_f32 v74, v110, v111
 v_lshlrev_b32_e64 v110, 16, v74
 v_and_b32 v111, 0xffff0000, v74
 v_pk_mul_f32 v[110:111], v[110:111], v[72:73] op_sel_hi:[1,0]
 v_cvt_pk_bf16_f32 v135, v110, v111
 s_mov_b32 s31, 2048
 buffer_store_dwordx4 v[132:135], v69, s[12:15], s31 offen sc1
 v_pk_add_f32 v[112:113], v[112:113], v[76:77] op_sel_hi:[1,0]
 v_cvt_pk_bf16_f32 v74, v112, v113
 v_lshlrev_b32_e64 v112, 16, v74
 v_and_b32 v113, 0xffff0000, v74
 v_pk_mul_f32 v[112:113], v[112:113], v[72:73] op_sel_hi:[1,0]
 v_cvt_pk_bf16_f32 v136, v112, v113
 v_pk_add_f32 v[114:115], v[114:115], v[76:77] op_sel_hi:[1,0]
 v_cvt_pk_bf16_f32 v74, v114, v115
 v_lshlrev_b32_e64 v114, 16, v74
 v_and_b32 v115, 0xffff0000, v74
 v_pk_mul_f32 v[114:115], v[114:115], v[72:73] op_sel_hi:[1,0]
 v_cvt_pk_bf16_f32 v137, v114, v115
 v_pk_add_f32 v[116:117], v[116:117], v[76:77] op_sel_hi:[1,0]
 v_cvt_pk_bf16_f32 v74, v116, v117
 v_lshlrev_b32_e64 v116, 16, v74
 v_and_b32 v117, 0xffff0000, v74
 v_pk_mul_f32 v[116:117], v[116:117], v[72:73] op_sel_hi:[1,0]
 v_cvt_pk_bf16_f32 v138, v116, v117
 v_pk_add_f32 v[118:119], v[118:119], v[76:77] op_sel_hi:[1,0]
 v_cvt_pk_bf16_f32 v74, v118, v119
 v_lshlrev_b32_e64 v118, 16, v74
 v_and_b32 v119, 0xffff0000, v74
 v_pk_mul_f32 v[118:119], v[118:119], v[72:73] op_sel_hi:[1,0]
 v_cvt_pk_bf16_f32 v139, v118, v119
 s_mov_b32 s31, 4096
 buffer_store_dwordx4 v[136:139], v69, s[12:15], s31 offen sc1
 v_pk_add_f32 v[120:121], v[120:121], v[76:77] op_sel_hi:[1,0]
 v_cvt_pk_bf16_f32 v74, v120, v121
 v_lshlrev_b32_e64 v120, 16, v74
 v_and_b32 v121, 0xffff0000, v74
 v_pk_mul_f32 v[120:121], v[120:121], v[72:73] op_sel_hi:[1,0]
 v_cvt_pk_bf16_f32 v140, v120, v121
 v_pk_add_f32 v[122:123], v[122:123], v[76:77] op_sel_hi:[1,0]
 v_cvt_pk_bf16_f32 v74, v122, v123
 v_lshlrev_b32_e64 v122, 16, v74
 v_and_b32 v123, 0xffff0000, v74
 v_pk_mul_f32 v[122:123], v[122:123], v[72:73] op_sel_hi:[1,0]
 v_cvt_pk_bf16_f32 v141, v122, v123
 v_pk_add_f32 v[124:125], v[124:125], v[76:77] op_sel_hi:[1,0]
 v_cvt_pk_bf16_f32 v74, v124, v125
 v_lshlrev_b32_e64 v124, 16, v74
 v_and_b32 v125, 0xffff0000, v74
 v_pk_mul_f32 v[124:125], v[124:125], v[72:73] op_sel_hi:[1,0]
 v_cvt_pk_bf16_f32 v142, v124, v125
 v_pk_add_f32 v[126:127], v[126:127], v[76:77] op_sel_hi:[1,0]
 v_cvt_pk_bf16_f32 v74, v126, v127
 v_lshlrev_b32_e64 v126, 16, v74
 v_and_b32 v127, 0xffff0000, v74
 v_pk_mul_f32 v[126:127], v[126:127], v[72:73] op_sel_hi:[1,0]
 v_cvt_pk_bf16_f32 v143, v126, v127
 s_mov_b32 s31, 6144
 buffer_store_dwordx4 v[140:143], v69, s[12:15], s31 offen sc1
 s_mul_i32 s31, s2, 3
 s_add_u32 s31, s31, s20
 s_lshl_b32 s31, s31, 7
 s_nop 0
 v_mul_u32_u24 v59, 98304, v1
 v_add_u32_e64 v59, s31, v59
 s_mov_b32 s44, s62
 s_mov_b32 s45, s63
 s_mov_b32 s46, 0x280000
 s_mov_b32 s47, 0x20000
 s_mov_b32 s48, s68
 s_mov_b32 s49, s69
 s_mov_b32 s50, 0x230000
 s_mov_b32 s51, 0x20000
 s_cmp_eq_u32 s20, 0
 s_cselect_b32 s46, 0, s46
 s_cselect_b32 s50, 0, s50
 s_nop 0
 s_mov_b32 s31, 524160
 s_mov_b32 s25, 458624
 buffer_load_dword v254, v59, s[44:47], s31 offen
 buffer_load_dword v255, v59, s[48:51], s25 offen
 s_lshl_b32 s40, s2, 3
 s_nop 0
 s_mov_b32 s80, 0x20000
 s_waitcnt vmcnt(2)
L_tag:
 v_readfirstlane_b32 s36, v62
 v_readfirstlane_b32 s37, v63
 s_cmp_lg_u32 s37, 0
 s_cbranch_scc1 L_tag_done
 s_sub_u32 s80, s80, 1
 s_cbranch_scc1 L_tag_done
 s_nop 0
 buffer_load_dwordx2 v[62:63], v60, s[8:11], 0 offen sc1
 s_waitcnt vmcnt(0)
 s_branch L_tag
L_tag_done:
 s_barrier
 s_cmp_lg_u32 s20, 0
 s_cbranch_scc1 L_sig_1
 s_mov_b64 exec, 1
 v_mov_b32 v5, 0
 v_mov_b32 v6, s36
 v_mov_b32_e64 v7, s37
 buffer_store_dwordx2 v[6:7], v5, s[16:19], s40 offen sc1
 s_mov_b64 exec, -1
L_sig_1:
 s_cmp_lg_u32 s38, 2
 s_cbranch_scc1 L_not_helper
 s_and_b32 s50, s2, 7
 s_lshl_b32 s50, s50, 1
 s_add_u32 s50, s50, s39
 s_sub_u32 s50, s50, 30
 s_lshl_b32 s31, s50, 2
 s_add_u32 s31, s31, s20
 s_lshl_b32 s31, s31, 13
 v_lshlrev_b32 v8, 7, v1
 v_mov_b32 v11, v8
 s_mov_b32 s51, s31
 v_add_u32 v8, s31, v8
 s_mov_b32 s4, s62
 s_mov_b32 s5, s63
 s_mov_b32 s6, 0x800000
 s_mov_b32 s7, 0x20000
 s_mov_b32 s40, 2621440
 s_mov_b32 s8, s68
 s_mov_b32 s9, s69
 s_mov_b32 s10, 0x700000
 s_mov_b32 s11, 0x20000
 s_mov_b32 s41, 2293760
 s_add_u32 s51, s51, 139264
 s_and_b32 s51, s51, 524287
 s_add_u32 s52, s51, s40
 s_nop 0
 buffer_load_dword v16, v11, s[4:7], s52 offen
 s_add_u32 s40, s40, 524288
 s_add_u32 s51, s51, 139264
 s_and_b32 s51, s51, 524287
 s_add_u32 s52, s51, s40
 s_nop 0
 buffer_load_dword v17, v11, s[4:7], s52 offen
 s_add_u32 s40, s40, 524288
 s_add_u32 s51, s51, 139264
 s_and_b32 s51, s51, 524287
 s_add_u32 s52, s51, s41
 s_nop 0
 buffer_load_dword v18, v11, s[8:11], s52 offen
 s_add_u32 s41, s41, 524288
 s_add_u32 s51, s51, 139264
 s_and_b32 s51, s51, 524287
 s_add_u32 s52, s51, s40
 s_nop 0
 buffer_load_dword v19, v11, s[4:7], s52 offen
 s_add_u32 s40, s40, 524288
 s_add_u32 s51, s51, 139264
 s_and_b32 s51, s51, 524287
 s_add_u32 s52, s51, s41
 s_nop 0
 buffer_load_dword v20, v11, s[8:11], s52 offen
 s_add_u32 s41, s41, 524288
 s_add_u32 s51, s51, 139264
 s_and_b32 s51, s51, 524287
 s_add_u32 s52, s51, s40
 s_nop 0
 buffer_load_dword v21, v11, s[4:7], s52 offen
 s_add_u32 s40, s40, 524288
 s_add_u32 s51, s51, 139264
 s_and_b32 s51, s51, 524287
 s_add_u32 s52, s51, s41
 s_nop 0
 buffer_load_dword v22, v11, s[8:11], s52 offen
 s_add_u32 s41, s41, 524288
 s_add_u32 s51, s51, 139264
 s_and_b32 s51, s51, 524287
 s_add_u32 s52, s51, s40
 s_nop 0
 buffer_load_dword v23, v11, s[4:7], s52 offen
 s_add_u32 s40, s40, 524288
 s_waitcnt vmcnt(40)
 s_nop 0
 s_add_u32 s51, s51, 139264
 s_and_b32 s51, s51, 524287
 s_add_u32 s52, s51, s41
 s_nop 0
 buffer_load_dword v24, v11, s[8:11], s52 offen
 s_add_u32 s41, s41, 524288
 s_add_u32 s51, s51, 139264
 s_and_b32 s51, s51, 524287
 s_add_u32 s52, s51, s40
 s_nop 0
 buffer_load_dword v25, v11, s[4:7], s52 offen
 s_add_u32 s40, s40, 524288
 s_add_u32 s51, s51, 139264
 s_and_b32 s51, s51, 524287
 s_add_u32 s52, s51, s41
 s_nop 0
 buffer_load_dword v26, v11, s[8:11], s52 offen
 s_add_u32 s41, s41, 524288
 s_add_u32 s51, s51, 139264
 s_and_b32 s51, s51, 524287
 s_add_u32 s52, s51, s40
 s_nop 0
 buffer_load_dword v27, v11, s[4:7], s52 offen
 s_add_u32 s40, s40, 524288
 s_add_u32 s51, s51, 139264
 s_and_b32 s51, s51, 524287
 s_add_u32 s52, s51, s41
 s_nop 0
 buffer_load_dword v28, v11, s[8:11], s52 offen
 s_add_u32 s41, s41, 524288
 s_add_u32 s51, s51, 139264
 s_and_b32 s51, s51, 524287
 s_add_u32 s52, s51, s40
 s_nop 0
 buffer_load_dword v29, v11, s[4:7], s52 offen
 s_add_u32 s40, s40, 524288
 s_add_u32 s51, s51, 139264
 s_and_b32 s51, s51, 524287
 s_add_u32 s52, s51, s41
 s_nop 0
 buffer_load_dword v30, v11, s[8:11], s52 offen
 s_add_u32 s41, s41, 524288
 s_add_u32 s51, s51, 139264
 s_and_b32 s51, s51, 524287
 s_add_u32 s52, s51, s40
 s_nop 0
 buffer_load_dword v31, v11, s[4:7], s52 offen
 s_add_u32 s40, s40, 524288
 s_waitcnt vmcnt(40)
 s_nop 0
 s_add_u32 s51, s51, 139264
 s_and_b32 s51, s51, 524287
 s_add_u32 s52, s51, s41
 s_nop 0
 buffer_load_dword v32, v11, s[8:11], s52 offen
 s_add_u32 s41, s41, 524288
 s_add_u32 s51, s51, 139264
 s_and_b32 s51, s51, 524287
 s_add_u32 s52, s51, s40
 s_nop 0
 buffer_load_dword v33, v11, s[4:7], s52 offen
 s_add_u32 s40, s40, 524288
 s_add_u32 s51, s51, 139264
 s_and_b32 s51, s51, 524287
 s_add_u32 s52, s51, s41
 s_nop 0
 buffer_load_dword v34, v11, s[8:11], s52 offen
 s_add_u32 s41, s41, 524288
 s_add_u32 s51, s51, 139264
 s_and_b32 s51, s51, 524287
 s_add_u32 s52, s51, s40
 s_nop 0
 buffer_load_dword v35, v11, s[4:7], s52 offen
 s_add_u32 s40, s40, 524288
 s_add_u32 s51, s51, 139264
 s_and_b32 s51, s51, 524287
 s_add_u32 s52, s51, s41
 s_nop 0
 buffer_load_dword v36, v11, s[8:11], s52 offen
 s_add_u32 s41, s41, 524288
 s_mov_b32 s4, s58
 s_mov_b32 s5, s59
 s_mov_b32 s6, 0x80000
 s_mov_b32 s7, 0x20000
 s_mov_b32 s40, 393216
 s_mov_b32 s8, s60
 s_mov_b32 s9, s61
 s_mov_b32 s10, 0x80000
 s_mov_b32 s11, 0x20000
 s_mov_b32 s41, 393216
 s_add_u32 s51, s51, 139264
 s_and_b32 s51, s51, 524287
 s_add_u32 s52, s51, s40
 s_nop 0
 buffer_load_dword v37, v11, s[4:7], s52 offen
 s_add_u32 s40, s40, 524288
 s_add_u32 s51, s51, 139264
 s_and_b32 s51, s51, 524287
 s_add_u32 s52, s51, s41
 s_nop 0
 buffer_load_dword v38, v11, s[8:11], s52 offen
 s_add_u32 s41, s41, 524288
 s_mov_b32 s4, s58
 s_mov_b32 s5, s59
 s_mov_b32 s6, 0x100000
 s_mov_b32 s7, 0x20000
 s_mov_b32 s40, 917504
 s_mov_b32 s8, s60
 s_mov_b32 s9, s61
 s_mov_b32 s10, 0x100000
 s_mov_b32 s11, 0x20000
 s_mov_b32 s41, 917504
 s_add_u32 s51, s51, 139264
 s_and_b32 s51, s51, 524287
 s_add_u32 s52, s51, s40
 s_nop 0
 buffer_load_dword v39, v11, s[4:7], s52 offen
 s_add_u32 s40, s40, 524288
 s_add_u32 s51, s51, 139264
 s_and_b32 s51, s51, 524287
 s_add_u32 s52, s51, s41
 s_nop 0
 buffer_load_dword v40, v11, s[8:11], s52 offen
 s_add_u32 s41, s41, 524288
 s_mov_b32 s4, s58
 s_mov_b32 s5, s59
 s_mov_b32 s6, 0x180000
 s_mov_b32 s7, 0x20000
 s_mov_b32 s40, 1441792
 s_mov_b32 s8, s60
 s_mov_b32 s9, s61
 s_mov_b32 s10, 0x180000
 s_mov_b32 s11, 0x20000
 s_mov_b32 s41, 1441792
 s_add_u32 s51, s51, 139264
 s_and_b32 s51, s51, 524287
 s_add_u32 s52, s51, s40
 s_nop 0
 buffer_load_dword v41, v11, s[4:7], s52 offen
 s_add_u32 s40, s40, 524288
 s_add_u32 s51, s51, 139264
 s_and_b32 s51, s51, 524287
 s_add_u32 s52, s51, s41
 s_nop 0
 buffer_load_dword v42, v11, s[8:11], s52 offen
 s_add_u32 s41, s41, 524288
 s_mov_b32 s4, s58
 s_mov_b32 s5, s59
 s_mov_b32 s6, 0x200000
 s_mov_b32 s7, 0x20000
 s_mov_b32 s40, 1966080
 s_mov_b32 s8, s60
 s_mov_b32 s9, s61
 s_mov_b32 s10, 0x200000
 s_mov_b32 s11, 0x20000
 s_mov_b32 s41, 1966080
 s_add_u32 s51, s51, 139264
 s_and_b32 s51, s51, 524287
 s_add_u32 s52, s51, s40
 s_nop 0
 buffer_load_dword v43, v11, s[4:7], s52 offen
 s_add_u32 s40, s40, 524288
 s_add_u32 s51, s51, 139264
 s_and_b32 s51, s51, 524287
 s_add_u32 s52, s51, s41
 s_nop 0
 buffer_load_dword v44, v11, s[8:11], s52 offen
 s_add_u32 s41, s41, 524288
 s_mov_b32 s4, s70
 s_mov_b32 s5, s71
 s_mov_b32 s6, 0x800000
 s_mov_b32 s7, 0x20000
 v_lshrrev_b32 v9, 10, v8
 v_lshlrev_b32 v9, 12, v9
 v_and_b32 v10, 1023, v8
 v_add_u32 v9, v9, v10
 s_mov_b32 s40, 0
 v_add_u32 v9, 557056, v9
 v_and_b32 v9, 2097151, v9
 buffer_load_dword v45, v9, s[4:7], s40 offen
 s_mov_b32 s40, 2097152
 v_add_u32 v9, 557056, v9
 v_and_b32 v9, 2097151, v9
 buffer_load_dword v46, v9, s[4:7], s40 offen
 s_mov_b32 s40, 4196352
 v_add_u32 v9, 557056, v9
 v_and_b32 v9, 2097151, v9
 buffer_load_dword v47, v9, s[4:7], s40 offen
 s_mov_b32 s40, 6293504
 v_add_u32 v9, 557056, v9
 v_and_b32 v9, 2097151, v9
 buffer_load_dword v48, v9, s[4:7], s40 offen
 s_mov_b32 s40, 1024
 v_add_u32 v9, 557056, v9
 v_and_b32 v9, 2097151, v9
 buffer_load_dword v49, v9, s[4:7], s40 offen
 s_mov_b32 s40, 2098176
 v_add_u32 v9, 557056, v9
 v_and_b32 v9, 2097151, v9
 buffer_load_dword v50, v9, s[4:7], s40 offen
 s_mov_b32 s40, 4197376
 v_add_u32 v9, 557056, v9
 v_and_b32 v9, 2097151, v9
 buffer_load_dword v51, v9, s[4:7], s40 offen
 s_mov_b32 s40, 6294528
 v_add_u32 v9, 557056, v9
 v_and_b32 v9, 2097151, v9
 buffer_load_dword v52, v9, s[4:7], s40 offen
 s_mov_b32 s40, 2048
 v_add_u32 v9, 557056, v9
 v_and_b32 v9, 2097151, v9
 buffer_load_dword v53, v9, s[4:7], s40 offen
 s_mov_b32 s40, 2099200
 v_add_u32 v9, 557056, v9
 v_and_b32 v9, 2097151, v9
 buffer_load_dword v54, v9, s[4:7], s40 offen
 s_mov_b32 s40, 4194304
 v_add_u32 v9, 557056, v9
 v_and_b32 v9, 2097151, v9
 buffer_load_dword v55, v9, s[4:7], s40 offen
 s_mov_b32 s40, 6291456
 v_add_u32 v9, 557056, v9
 v_and_b32 v9, 2097151, v9
 buffer_load_dword v56, v9, s[4:7], s40 offen
 s_mov_b32 s40, 3072
 v_add_u32 v9, 557056, v9
 v_and_b32 v9, 2097151, v9
 buffer_load_dword v57, v9, s[4:7], s40 offen
 s_mov_b32 s40, 2100224
 v_add_u32 v9, 557056, v9
 v_and_b32 v9, 2097151, v9
 buffer_load_dword v58, v9, s[4:7], s40 offen
 s_mov_b32 s40, 4195328
 v_add_u32 v9, 557056, v9
 v_and_b32 v9, 2097151, v9
 buffer_load_dword v59, v9, s[4:7], s40 offen
 s_mov_b32 s40, 6292480
 v_add_u32 v9, 557056, v9
 v_and_b32 v9, 2097151, v9
 buffer_load_dword v60, v9, s[4:7], s40 offen
 s_waitcnt vmcnt(0)
 s_and_b32 s40, s39, 3
 s_and_b32 s41, s2, 3
 s_lshl_b32 s41, s41, 2
 s_add_u32 s40, s40, s41
 s_nop 0
 s_bfe_u32 s41, s39, 0x20002
 s_and_b32 s42, s2, 4
 s_add_u32 s41, s41, s42
 s_lshl_b32 s83, s41, 8
 s_nop 0
 s_mul_i32 s81, s41, 655360
 s_add_u32 s81, s81, s29
 s_lshl_b32 s84, s22, 17
 s_lshl_b32 s31, s40, 13
 s_add_u32 s84, s84, s31
 s_lshl_b32 s31, s21, 12
 s_add_u32 s84, s84, s31
 s_add_u32 s82, s84, 3407872
 s_lshr_b32 s42, s40, 1
 s_lshl_b32 s31, s42, 8
 s_add_u32 s88, s31, 8216
 s_add_u32 s89, s31, 10240
 s_lshl_b32 s86, s42, 3
 s_add_u32 s86, s86, s41
 s_lshl_b32 s86, s86, 6
 s_nop 0
 s_add_u32 s86, s86, 12288
 s_lshl_b32 s87, s40, 3
 s_add_u32 s87, s87, s41
 s_lshl_b32 s87, s87, 15
 s_lshl_b32 s31, s20, 13
 s_add_u32 s87, s87, s31
 s_lshl_b32 s85, s40, 18
 s_lshl_b32 s31, s22, 17
 s_add_u32 s85, s85, s31
 s_add_u32 s85, s85, s83
 s_lshl_b32 s31, s21, 7
 s_add_u32 s85, s85, s31
 s_lshl_b32 s31, s20, 4
 v_add_u32 v5, s31, v2
 v_lshlrev_b32 v5, 11, v5
 v_and_b32 v6, 15, v1
 v_or_b32 v7, 0, v2
 v_lshlrev_b32 v7, 1, v7
 v_xor_b32 v7, v7, v6
 v_lshl_add_u32 v7, v7, 4, v5
 v_add_u32 v36, 0, v7
 v_or_b32 v7, 4, v2
 v_lshlrev_b32 v7, 1, v7
 v_xor_b32 v7, v7, v6
 v_lshl_add_u32 v7, v7, 4, v5
 v_add_u32 v37, 7168, v7
 v_or_b32 v7, 0, v2
 v_lshlrev_b32 v7, 1, v7
 v_xor_b32_e64 v7, v7, v6
 v_lshl_add_u32 v7, v7, 4, v5
 v_add_u32 v38, 14336, v7
 v_or_b32 v7, 4, v2
 v_lshlrev_b32 v7, 1, v7
 v_xor_b32_e64 v7, v7, v6
 v_lshl_add_u32 v7, v7, 4, v5
 v_add_u32 v39, 21504, v7
 v_lshlrev_b32_e64 v40, 4, v1
 v_lshl_add_u32 v6, v2, 2, v3
 v_lshlrev_b32 v5, 8, v6
 v_and_b32 v7, 1, v4
 v_lshl_add_u32 v5, v7, 3, v5
 v_lshrrev_b32_e64 v7, 1, v4
 v_lshl_add_u32 v5, v7, 4, v5
 v_and_b32 v6, 7, v6
 s_lshl_b32 s31, s21, 2
 s_add_u32 s25, s31, 0
 v_xor_b32 v7, s25, v6
 v_lshl_add_u32 v44, v7, 5, v5
 v_add_u32 v48, 65536, v44
 s_add_u32 s25, s31, 1
 v_xor_b32 v7, s25, v6
 v_lshl_add_u32 v45, v7, 5, v5
 v_add_u32 v49, 65536, v45
 s_add_u32 s25, s31, 2
 v_xor_b32 v7, s25, v6
 v_lshl_add_u32 v46, v7, 5, v5
 v_add_u32 v50, 65536, v46
 s_add_u32 s25, s31, 3
 v_xor_b32 v7, s25, v6
 v_lshl_add_u32 v47, v7, 5, v5
 v_add_u32 v51, 65536, v47
 s_lshl_b32 s31, s22, 12
 s_nop 0
 s_add_u32 s31, s31, 16384
 v_add_u32_e64 v56, s31, v40
 v_add_u32 v57, 65536, v56
 v_min_u32 v41, 13, v1
 v_lshlrev_b32 v41, 3, v41
 v_and_b32 v5, 1, v2
 v_lshlrev_b32 v5, 1, v5
 v_lshrrev_b32 v7, 1, v2
 v_or_b32 v7, v7, v5
 v_and_b32 v6, 15, v1
 v_lshlrev_b32 v59, 11, v6
 v_lshl_add_u32 v59, v7, 4, v59
 s_and_b32 s40, s50, 7
 s_lshr_b32 s41, s50, 3
 s_add_u32 s12, s32, 0x3000000
 s_addc_u32 s13, s33, 0
 s_nop 0
 s_mov_b32 s14, 0x500000
 s_mov_b32 s15, 0x20000
 s_mul_i32 s42, s40, 655360
 s_add_u32 s42, s42, s29
 s_lshl_b32 s43, s41, 14
 s_add_u32 s42, s42, s43
 s_lshl_b32 s43, s40, 8
 s_mov_b32 s4, s64
 s_mov_b32 s5, s65
 s_mov_b32 s6, 0x800000
 s_mov_b32 s7, 0x20000
 s_mov_b32 s8, s74
 s_mov_b32 s9, s75
 s_mov_b32 s10, 0x380000
 s_mov_b32 s11, 0x20000
 s_mul_i32 s31, s41, 131072
 s_add_u32 s31, s31, s43
 s_nop 0
 s_add_u32 s31, s31, 1703936
 buffer_load_dwordx4 v[64:67], v36, s[4:7], s31 offen offset:0
 buffer_load_dwordx4 v[68:71], v37, s[4:7], s31 offen offset:1024
 buffer_load_dwordx4 v[72:75], v38, s[4:7], s31 offen offset:2048
 buffer_load_dwordx4 v[76:79], v39, s[4:7], s31 offen offset:3072
 s_mul_i32 s31, s41, 1835008
 s_add_u32 s31, s31, s43
 s_nop 0
 s_add_u32 s31, s31, 1966080
 buffer_load_dwordx4 v[80:83], v36, s[4:7], s31 offen offset:0
 buffer_load_dwordx4 v[84:87], v37, s[4:7], s31 offen offset:1024
 buffer_load_dwordx4 v[88:91], v38, s[4:7], s31 offen offset:2048
 buffer_load_dwordx4 v[92:95], v39, s[4:7], s31 offen offset:3072
 s_mul_i32 s31, s41, 131072
 s_add_u32 s31, s31, s43
 s_nop 0
 s_add_u32 s31, s31, 3932160
 buffer_load_dwordx4 v[96:99], v36, s[4:7], s31 offen offset:0
 buffer_load_dwordx4 v[100:103], v37, s[4:7], s31 offen offset:1024
 buffer_load_dwordx4 v[104:107], v38, s[4:7], s31 offen offset:2048
 buffer_load_dwordx4 v[108:111], v39, s[4:7], s31 offen offset:3072
 s_mul_i32 s31, s41, 131072
 s_add_u32 s31, s31, s43
 s_nop 0
 s_add_u32 s31, s31, 5898240
 buffer_load_dwordx4 v[112:115], v36, s[4:7], s31 offen offset:0
 buffer_load_dwordx4 v[116:119], v37, s[4:7], s31 offen offset:1024
 buffer_load_dwordx4 v[120:123], v38, s[4:7], s31 offen offset:2048
 buffer_load_dwordx4 v[124:127], v39, s[4:7], s31 offen offset:3072
 s_mul_i32 s31, s41, 1835008
 s_add_u32 s31, s31, s43
 s_nop 0
 s_add_u32 s31, s31, 6160384
 buffer_load_dwordx4 v[128:131], v36, s[4:7], s31 offen offset:0
 buffer_load_dwordx4 v[132:135], v37, s[4:7], s31 offen offset:1024
 buffer_load_dwordx4 v[136:139], v38, s[4:7], s31 offen offset:2048
 buffer_load_dwordx4 v[140:143], v39, s[4:7], s31 offen offset:3072
 s_waitcnt vmcnt(16)
 s_add_u32 s31, s42, 0
 buffer_store_dwordx4 v[64:67], v40, s[12:15], s31 offen offset:0 sc1
 buffer_store_dwordx4 v[68:71], v40, s[12:15], s31 offen offset:1024 sc1
 buffer_store_dwordx4 v[72:75], v40, s[12:15], s31 offen offset:2048 sc1
 buffer_store_dwordx4 v[76:79], v40, s[12:15], s31 offen offset:3072 sc1
 s_waitcnt vmcnt(16)
 s_nop 0
 s_add_u32 s31, s42, 32768
 buffer_store_dwordx4 v[80:83], v40, s[12:15], s31 offen offset:0 sc1
 buffer_store_dwordx4 v[84:87], v40, s[12:15], s31 offen offset:1024 sc1
 buffer_store_dwordx4 v[88:91], v40, s[12:15], s31 offen offset:2048 sc1
 buffer_store_dwordx4 v[92:95], v40, s[12:15], s31 offen offset:3072 sc1
 s_waitcnt vmcnt(16)
 s_nop 0
 s_add_u32 s31, s42, 65536
 buffer_store_dwordx4 v[96:99], v40, s[12:15], s31 offen offset:0 sc1
 buffer_store_dwordx4 v[100:103], v40, s[12:15], s31 offen offset:1024 sc1
 buffer_store_dwordx4 v[104:107], v40, s[12:15], s31 offen offset:2048 sc1
 buffer_store_dwordx4 v[108:111], v40, s[12:15], s31 offen offset:3072 sc1
 s_waitcnt vmcnt(16)
 s_nop 0
 s_add_u32 s31, s42, 98304
 buffer_store_dwordx4 v[112:115], v40, s[12:15], s31 offen offset:0 sc1
 buffer_store_dwordx4 v[116:119], v40, s[12:15], s31 offen offset:1024 sc1
 buffer_store_dwordx4 v[120:123], v40, s[12:15], s31 offen offset:2048 sc1
 buffer_store_dwordx4 v[124:127], v40, s[12:15], s31 offen offset:3072 sc1
 s_waitcnt vmcnt(16)
 s_nop 0
 s_add_u32 s31, s42, 131072
 buffer_store_dwordx4 v[128:131], v40, s[12:15], s31 offen offset:0 sc1
 buffer_store_dwordx4 v[132:135], v40, s[12:15], s31 offen offset:1024 sc1
 buffer_store_dwordx4 v[136:139], v40, s[12:15], s31 offen offset:2048 sc1
 buffer_store_dwordx4 v[140:143], v40, s[12:15], s31 offen offset:3072 sc1
 s_waitcnt vmcnt(0)
 s_nop 0
 s_mul_i32 s31, s41, 131072
 s_add_u32 s31, s31, s43
 s_nop 0
 s_add_u32 s31, s31, 8126464
 buffer_load_dwordx4 v[64:67], v36, s[4:7], s31 offen offset:0
 buffer_load_dwordx4 v[68:71], v37, s[4:7], s31 offen offset:1024
 buffer_load_dwordx4 v[72:75], v38, s[4:7], s31 offen offset:2048
 buffer_load_dwordx4 v[76:79], v39, s[4:7], s31 offen offset:3072
 s_mul_i32 s31, s41, 131072
 s_add_u32 s31, s31, s43
 s_add_u32 s31, s31, 0
 buffer_load_dwordx4 v[80:83], v36, s[8:11], s31 offen offset:0
 buffer_load_dwordx4 v[84:87], v37, s[8:11], s31 offen offset:1024
 buffer_load_dwordx4 v[88:91], v38, s[8:11], s31 offen offset:2048
 buffer_load_dwordx4 v[92:95], v39, s[8:11], s31 offen offset:3072
 s_mul_i32 s31, s41, 131072
 s_add_u32 s31, s31, s43
 s_nop 0
 s_add_u32 s31, s31, 262144
 buffer_load_dwordx4 v[96:99], v36, s[8:11], s31 offen offset:0
 buffer_load_dwordx4 v[100:103], v37, s[8:11], s31 offen offset:1024
 buffer_load_dwordx4 v[104:107], v38, s[8:11], s31 offen offset:2048
 buffer_load_dwordx4 v[108:111], v39, s[8:11], s31 offen offset:3072
 s_mul_i32 s31, s41, 131072
 s_add_u32 s31, s31, s43
 s_nop 0
 s_add_u32 s31, s31, 524288
 buffer_load_dwordx4 v[112:115], v36, s[8:11], s31 offen offset:0
 buffer_load_dwordx4 v[116:119], v37, s[8:11], s31 offen offset:1024
 buffer_load_dwordx4 v[120:123], v38, s[8:11], s31 offen offset:2048
 buffer_load_dwordx4 v[124:127], v39, s[8:11], s31 offen offset:3072
 s_mul_i32 s31, s41, 131072
 s_add_u32 s31, s31, s43
 s_nop 0
 s_add_u32 s31, s31, 786432
 buffer_load_dwordx4 v[128:131], v36, s[8:11], s31 offen offset:0
 buffer_load_dwordx4 v[132:135], v37, s[8:11], s31 offen offset:1024
 buffer_load_dwordx4 v[136:139], v38, s[8:11], s31 offen offset:2048
 buffer_load_dwordx4 v[140:143], v39, s[8:11], s31 offen offset:3072
 s_waitcnt vmcnt(16)
 s_nop 0
 s_add_u32 s31, s42, 163840
 buffer_store_dwordx4 v[64:67], v40, s[12:15], s31 offen offset:0 sc1
 buffer_store_dwordx4 v[68:71], v40, s[12:15], s31 offen offset:1024 sc1
 buffer_store_dwordx4 v[72:75], v40, s[12:15], s31 offen offset:2048 sc1
 buffer_store_dwordx4 v[76:79], v40, s[12:15], s31 offen offset:3072 sc1
 s_waitcnt vmcnt(16)
 s_nop 0
 s_add_u32 s31, s42, 196608
 buffer_store_dwordx4 v[80:83], v40, s[12:15], s31 offen offset:0 sc1
 buffer_store_dwordx4 v[84:87], v40, s[12:15], s31 offen offset:1024 sc1
 buffer_store_dwordx4 v[88:91], v40, s[12:15], s31 offen offset:2048 sc1
 buffer_store_dwordx4 v[92:95], v40, s[12:15], s31 offen offset:3072 sc1
 s_waitcnt vmcnt(16)
 s_nop 0
 s_add_u32 s31, s42, 229376
 buffer_store_dwordx4 v[96:99], v40, s[12:15], s31 offen offset:0 sc1
 buffer_store_dwordx4 v[100:103], v40, s[12:15], s31 offen offset:1024 sc1
 buffer_store_dwordx4 v[104:107], v40, s[12:15], s31 offen offset:2048 sc1
 buffer_store_dwordx4 v[108:111], v40, s[12:15], s31 offen offset:3072 sc1
 s_waitcnt vmcnt(16)
 s_nop 0
 s_add_u32 s31, s42, 262144
 buffer_store_dwordx4 v[112:115], v40, s[12:15], s31 offen offset:0 sc1
 buffer_store_dwordx4 v[116:119], v40, s[12:15], s31 offen offset:1024 sc1
 buffer_store_dwordx4 v[120:123], v40, s[12:15], s31 offen offset:2048 sc1
 buffer_store_dwordx4 v[124:127], v40, s[12:15], s31 offen offset:3072 sc1
 s_waitcnt vmcnt(16)
 s_nop 0
 s_add_u32 s31, s42, 294912
 buffer_store_dwordx4 v[128:131], v40, s[12:15], s31 offen offset:0 sc1
 buffer_store_dwordx4 v[132:135], v40, s[12:15], s31 offen offset:1024 sc1
 buffer_store_dwordx4 v[136:139], v40, s[12:15], s31 offen offset:2048 sc1
 buffer_store_dwordx4 v[140:143], v40, s[12:15], s31 offen offset:3072 sc1
 s_waitcnt vmcnt(0)
 s_nop 0
 s_mul_i32 s31, s41, 131072
 s_add_u32 s31, s31, s43
 s_nop 0
 s_add_u32 s31, s31, 1048576
 buffer_load_dwordx4 v[64:67], v36, s[8:11], s31 offen offset:0
 buffer_load_dwordx4 v[68:71], v37, s[8:11], s31 offen offset:1024
 buffer_load_dwordx4 v[72:75], v38, s[8:11], s31 offen offset:2048
 buffer_load_dwordx4 v[76:79], v39, s[8:11], s31 offen offset:3072
 s_mul_i32 s31, s41, 131072
 s_add_u32 s31, s31, s43
 s_nop 0
 s_add_u32 s31, s31, 1310720
 buffer_load_dwordx4 v[80:83], v36, s[8:11], s31 offen offset:0
 buffer_load_dwordx4 v[84:87], v37, s[8:11], s31 offen offset:1024
 buffer_load_dwordx4 v[88:91], v38, s[8:11], s31 offen offset:2048
 buffer_load_dwordx4 v[92:95], v39, s[8:11], s31 offen offset:3072
 s_mul_i32 s31, s41, 131072
 s_add_u32 s31, s31, s43
 s_nop 0
 s_add_u32 s31, s31, 1572864
 buffer_load_dwordx4 v[96:99], v36, s[8:11], s31 offen offset:0
 buffer_load_dwordx4 v[100:103], v37, s[8:11], s31 offen offset:1024
 buffer_load_dwordx4 v[104:107], v38, s[8:11], s31 offen offset:2048
 buffer_load_dwordx4 v[108:111], v39, s[8:11], s31 offen offset:3072
 s_mul_i32 s31, s41, 131072
 s_add_u32 s31, s31, s43
 s_nop 0
 s_add_u32 s31, s31, 1835008
 buffer_load_dwordx4 v[112:115], v36, s[8:11], s31 offen offset:0
 buffer_load_dwordx4 v[116:119], v37, s[8:11], s31 offen offset:1024
 buffer_load_dwordx4 v[120:123], v38, s[8:11], s31 offen offset:2048
 buffer_load_dwordx4 v[124:127], v39, s[8:11], s31 offen offset:3072
 s_mul_i32 s31, s41, 131072
 s_add_u32 s31, s31, s43
 s_nop 0
 s_add_u32 s31, s31, 2097152
 buffer_load_dwordx4 v[128:131], v36, s[8:11], s31 offen offset:0
 buffer_load_dwordx4 v[132:135], v37, s[8:11], s31 offen offset:1024
 buffer_load_dwordx4 v[136:139], v38, s[8:11], s31 offen offset:2048
 buffer_load_dwordx4 v[140:143], v39, s[8:11], s31 offen offset:3072
 s_waitcnt vmcnt(16)
 s_nop 0
 s_add_u32 s31, s42, 327680
 buffer_store_dwordx4 v[64:67], v40, s[12:15], s31 offen offset:0 sc1
 buffer_store_dwordx4 v[68:71], v40, s[12:15], s31 offen offset:1024 sc1
 buffer_store_dwordx4 v[72:75], v40, s[12:15], s31 offen offset:2048 sc1
 buffer_store_dwordx4 v[76:79], v40, s[12:15], s31 offen offset:3072 sc1
 s_waitcnt vmcnt(16)
 s_nop 0
 s_add_u32 s31, s42, 360448
 buffer_store_dwordx4 v[80:83], v40, s[12:15], s31 offen offset:0 sc1
 buffer_store_dwordx4 v[84:87], v40, s[12:15], s31 offen offset:1024 sc1
 buffer_store_dwordx4 v[88:91], v40, s[12:15], s31 offen offset:2048 sc1
 buffer_store_dwordx4 v[92:95], v40, s[12:15], s31 offen offset:3072 sc1
 s_waitcnt vmcnt(16)
 s_nop 0
 s_add_u32 s31, s42, 393216
 buffer_store_dwordx4 v[96:99], v40, s[12:15], s31 offen offset:0 sc1
 buffer_store_dwordx4 v[100:103], v40, s[12:15], s31 offen offset:1024 sc1
 buffer_store_dwordx4 v[104:107], v40, s[12:15], s31 offen offset:2048 sc1
 buffer_store_dwordx4 v[108:111], v40, s[12:15], s31 offen offset:3072 sc1
 s_waitcnt vmcnt(16)
 s_nop 0
 s_add_u32 s31, s42, 425984
 buffer_store_dwordx4 v[112:115], v40, s[12:15], s31 offen offset:0 sc1
 buffer_store_dwordx4 v[116:119], v40, s[12:15], s31 offen offset:1024 sc1
 buffer_store_dwordx4 v[120:123], v40, s[12:15], s31 offen offset:2048 sc1
 buffer_store_dwordx4 v[124:127], v40, s[12:15], s31 offen offset:3072 sc1
 s_waitcnt vmcnt(16)
 s_nop 0
 s_add_u32 s31, s42, 458752
 buffer_store_dwordx4 v[128:131], v40, s[12:15], s31 offen offset:0 sc1
 buffer_store_dwordx4 v[132:135], v40, s[12:15], s31 offen offset:1024 sc1
 buffer_store_dwordx4 v[136:139], v40, s[12:15], s31 offen offset:2048 sc1
 buffer_store_dwordx4 v[140:143], v40, s[12:15], s31 offen offset:3072 sc1
 s_waitcnt vmcnt(0)
 s_nop 0
 s_mul_i32 s31, s41, 131072
 s_add_u32 s31, s31, s43
 s_nop 0
 s_add_u32 s31, s31, 2359296
 buffer_load_dwordx4 v[64:67], v36, s[8:11], s31 offen offset:0
 buffer_load_dwordx4 v[68:71], v37, s[8:11], s31 offen offset:1024
 buffer_load_dwordx4 v[72:75], v38, s[8:11], s31 offen offset:2048
 buffer_load_dwordx4 v[76:79], v39, s[8:11], s31 offen offset:3072
 s_mul_i32 s31, s41, 131072
 s_add_u32 s31, s31, s43
 s_nop 0
 s_add_u32 s31, s31, 2621440
 buffer_load_dwordx4 v[80:83], v36, s[8:11], s31 offen offset:0
 buffer_load_dwordx4 v[84:87], v37, s[8:11], s31 offen offset:1024
 buffer_load_dwordx4 v[88:91], v38, s[8:11], s31 offen offset:2048
 buffer_load_dwordx4 v[92:95], v39, s[8:11], s31 offen offset:3072
 s_mul_i32 s31, s41, 131072
 s_add_u32 s31, s31, s43
 s_nop 0
 s_add_u32 s31, s31, 2883584
 buffer_load_dwordx4 v[96:99], v36, s[8:11], s31 offen offset:0
 buffer_load_dwordx4 v[100:103], v37, s[8:11], s31 offen offset:1024
 buffer_load_dwordx4 v[104:107], v38, s[8:11], s31 offen offset:2048
 buffer_load_dwordx4 v[108:111], v39, s[8:11], s31 offen offset:3072
 s_mul_i32 s31, s41, 131072
 s_add_u32 s31, s31, s43
 s_nop 0
 s_add_u32 s31, s31, 3145728
 buffer_load_dwordx4 v[112:115], v36, s[8:11], s31 offen offset:0
 buffer_load_dwordx4 v[116:119], v37, s[8:11], s31 offen offset:1024
 buffer_load_dwordx4 v[120:123], v38, s[8:11], s31 offen offset:2048
 buffer_load_dwordx4 v[124:127], v39, s[8:11], s31 offen offset:3072
 s_mul_i32 s31, s41, 131072
 s_add_u32 s31, s31, s43
 s_nop 0
 s_add_u32 s31, s31, 3407872
 buffer_load_dwordx4 v[128:131], v36, s[8:11], s31 offen offset:0
 buffer_load_dwordx4 v[132:135], v37, s[8:11], s31 offen offset:1024
 buffer_load_dwordx4 v[136:139], v38, s[8:11], s31 offen offset:2048
 buffer_load_dwordx4 v[140:143], v39, s[8:11], s31 offen offset:3072
 s_waitcnt vmcnt(16)
 s_nop 0
 s_add_u32 s31, s42, 491520
 buffer_store_dwordx4 v[64:67], v40, s[12:15], s31 offen offset:0 sc1
 buffer_store_dwordx4 v[68:71], v40, s[12:15], s31 offen offset:1024 sc1
 buffer_store_dwordx4 v[72:75], v40, s[12:15], s31 offen offset:2048 sc1
 buffer_store_dwordx4 v[76:79], v40, s[12:15], s31 offen offset:3072 sc1
 s_waitcnt vmcnt(16)
 s_nop 0
 s_add_u32 s31, s42, 524288
 buffer_store_dwordx4 v[80:83], v40, s[12:15], s31 offen offset:0 sc1
 buffer_store_dwordx4 v[84:87], v40, s[12:15], s31 offen offset:1024 sc1
 buffer_store_dwordx4 v[88:91], v40, s[12:15], s31 offen offset:2048 sc1
 buffer_store_dwordx4 v[92:95], v40, s[12:15], s31 offen offset:3072 sc1
 s_waitcnt vmcnt(16)
 s_nop 0
 s_add_u32 s31, s42, 557056
 buffer_store_dwordx4 v[96:99], v40, s[12:15], s31 offen offset:0 sc1
 buffer_store_dwordx4 v[100:103], v40, s[12:15], s31 offen offset:1024 sc1
 buffer_store_dwordx4 v[104:107], v40, s[12:15], s31 offen offset:2048 sc1
 buffer_store_dwordx4 v[108:111], v40, s[12:15], s31 offen offset:3072 sc1
 s_waitcnt vmcnt(16)
 s_nop 0
 s_add_u32 s31, s42, 589824
 buffer_store_dwordx4 v[112:115], v40, s[12:15], s31 offen offset:0 sc1
 buffer_store_dwordx4 v[116:119], v40, s[12:15], s31 offen offset:1024 sc1
 buffer_store_dwordx4 v[120:123], v40, s[12:15], s31 offen offset:2048 sc1
 buffer_store_dwordx4 v[124:127], v40, s[12:15], s31 offen offset:3072 sc1
 s_waitcnt vmcnt(16)
 s_nop 0
 s_add_u32 s31, s42, 622592
 buffer_store_dwordx4 v[128:131], v40, s[12:15], s31 offen offset:0 sc1
 buffer_store_dwordx4 v[132:135], v40, s[12:15], s31 offen offset:1024 sc1
 buffer_store_dwordx4 v[136:139], v40, s[12:15], s31 offen offset:2048 sc1
 buffer_store_dwordx4 v[140:143], v40, s[12:15], s31 offen offset:3072 sc1
 s_waitcnt vmcnt(0)
 s_lshl_b32 s40, s40, 4
 s_lshl_b32 s41, s41, 3
 s_add_u32 s40, s40, s41
 s_add_u32 s40, s40, 20480
 s_waitcnt vmcnt(0)
 s_barrier
 s_cmp_lg_u32 s20, 0
 s_cbranch_scc1 L_sig_2
 s_mov_b64 exec, 1
 v_mov_b32 v5, 0
 v_mov_b32 v6, s36
 v_mov_b32 v7, s37
 buffer_store_dwordx2 v[6:7], v5, s[16:19], s40 offen sc1
 s_mov_b64 exec, -1
L_sig_2:
 s_mov_b32 s90, 0
 s_cmp_lg_u32 s20, 0
 s_cbranch_scc1 L_wt_3
 v_min_u32 v5, 0, v1
 v_lshlrev_b32 v5, 3, v5
 s_mov_b32 s80, 0x20000
 s_branch L_poll_4
L_again_5:
 s_sub_u32 s80, s80, 1
 s_cbranch_scc1 L_wt_3
 s_sleep 40
L_poll_4:
 buffer_load_dwordx2 v[6:7], v5, s[16:19], s88 offen sc1
 s_waitcnt vmcnt(0)
 v_cmp_ne_u64 vcc, s[36:37], v[6:7]
 s_cmp_lg_u64 vcc, 0
 s_cbranch_scc1 L_again_5
L_wt_3:
 s_barrier
 v_and_b32 v5, 1, v1
 s_lshr_b32 s31, s83, 4
 s_nop 0
 s_add_u32 s31, s31, 20480
 v_lshlrev_b32 v5, 3, v5
 v_add_u32 v5, s31, v5
 v_lshlrev_b32 v60, 5, v1
 v_cmp_gt_u32 vcc, 4, v1
 v_add_u32 v60, s88, v60
 s_nop 0
 v_cndmask_b32 v60, v5, v60, vcc
 s_cmp_lg_u32 s20, 0
 s_cbranch_scc1 L_wt_6
 v_mov_b32 v5, v60
 s_mov_b32 s80, 0x20000
 s_branch L_poll_7
L_again_8:
 s_sub_u32 s80, s80, 1
 s_cbranch_scc1 L_wt_6
 s_sleep 2
L_poll_7:
 buffer_load_dwordx2 v[6:7], v5, s[16:19], 0 offen sc1
 s_waitcnt vmcnt(0)
 v_cmp_ne_u64 vcc, s[36:37], v[6:7]
 s_cmp_lg_u64 vcc, 0
 s_cbranch_scc1 L_again_8
L_wt_6:
 s_barrier
 s_nop 0
 s_add_u32 s4, s32, 50331648
 s_addc_u32 s5, s33, 0
 s_nop 0
 s_mov_b32 s6, 5242880
 s_add_u32 s8, s32, 4194304
 s_addc_u32 s9, s33, 0
 s_nop 0
 s_mov_b32 s10, 16777216
 s_mov_b32 s26, s81
 s_mov_b32 s27, s82
 s_add_u32 m0, s29, 0
 s_nop 0
 buffer_load_dwordx4 v40, s[4:7], s26 offen offset:0 lds
 buffer_load_dwordx4 v40, s[4:7], s26 offen offset:1024 lds
 buffer_load_dwordx4 v40, s[4:7], s26 offen offset:2048 lds
 buffer_load_dwordx4 v40, s[4:7], s26 offen offset:3072 lds
 s_add_u32 s26, s26, 16384
 s_add_u32 m0, s29, 16384
 s_nop 0
 s_nop 0
 buffer_load_dwordx4 v40, s[8:11], s27 offen offset:0 lds
 buffer_load_dwordx4 v40, s[8:11], s27 offen offset:1024 lds
 buffer_load_dwordx4 v40, s[8:11], s27 offen offset:2048 lds
 buffer_load_dwordx4 v40, s[8:11], s27 offen offset:3072 lds
 s_add_u32 s27, s27, 262144
 s_add_u32 m0, s29, 32768
 s_nop 0
 s_nop 0
 buffer_load_dwordx4 v40, s[4:7], s26 offen offset:0 lds
 buffer_load_dwordx4 v40, s[4:7], s26 offen offset:1024 lds
 buffer_load_dwordx4 v40, s[4:7], s26 offen offset:2048 lds
 buffer_load_dwordx4 v40, s[4:7], s26 offen offset:3072 lds
 s_add_u32 s26, s26, 16384
 s_add_u32 m0, s29, 49152
 s_nop 0
 s_nop 0
 buffer_load_dwordx4 v40, s[8:11], s27 offen offset:0 lds
 buffer_load_dwordx4 v40, s[8:11], s27 offen offset:1024 lds
 buffer_load_dwordx4 v40, s[8:11], s27 offen offset:2048 lds
 buffer_load_dwordx4 v40, s[8:11], s27 offen offset:3072 lds
 s_add_u32 s27, s27, 262144
 s_add_u32 m0, s29, 65536
 s_nop 0
 s_nop 0
 buffer_load_dwordx4 v40, s[4:7], s26 offen offset:0 lds
 buffer_load_dwordx4 v40, s[4:7], s26 offen offset:1024 lds
 buffer_load_dwordx4 v40, s[4:7], s26 offen offset:2048 lds
 buffer_load_dwordx4 v40, s[4:7], s26 offen offset:3072 lds
 s_add_u32 s26, s26, 16384
 s_add_u32 m0, s29, 81920
 s_nop 0
 s_nop 0
 buffer_load_dwordx4 v40, s[8:11], s27 offen offset:0 lds
 buffer_load_dwordx4 v40, s[8:11], s27 offen offset:1024 lds
 buffer_load_dwordx4 v40, s[8:11], s27 offen offset:2048 lds
 buffer_load_dwordx4 v40, s[8:11], s27 offen offset:3072 lds
 s_add_u32 s27, s27, 3670016
 s_mov_b32 s12, s32
 s_mov_b32 s13, s33
 s_mov_b32 s14, 0x0
 s_nop 0
 s_mov_b32 s15, 0x20000
 v_mov_b32_e64 v19, 0
 s_waitcnt vmcnt(0)
 s_getpc_b64 s[42:43]
L_far_9:
 s_add_u32 s42, s42, L_z_go - L_far_9
 s_addc_u32 s43, s43, (L_z_go - L_far_9) >> 32
 s_setpc_b64 s[42:43]
L_not_helper:
 s_nop 0
 v_lshl_add_u32 v5, v2, 3, v3
 v_lshlrev_b32 v5, 9, v5
 v_lshrrev_b32 v6, 1, v4
 s_lshl_b32 s31, s21, 4
 v_add_u32 v6, s31, v6
 v_lshl_add_u32 v5, v6, 4, v5
 v_and_b32_e64 v6, 1, v4
 v_lshl_add_u32 v5, v6, 3, v5
 v_and_b32_e64 v6, 1, v2
 v_lshl_add_u32 v6, v6, 2, v3
 v_xor_b32_e64 v7, 0, v6
 v_lshl_add_u32 v200, v7, 5, v5
 v_add_u32 v208, 65536, v200
 v_xor_b32_e64 v7, 1, v6
 v_lshl_add_u32 v201, v7, 5, v5
 v_add_u32 v209, 65536, v201
 v_xor_b32_e64 v7, 2, v6
 v_lshl_add_u32 v202, v7, 5, v5
 v_add_u32 v210, 65536, v202
 v_xor_b32_e64 v7, 3, v6
 v_lshl_add_u32 v203, v7, 5, v5
 v_add_u32 v211, 65536, v203
 v_xor_b32_e64 v7, 4, v6
 v_lshl_add_u32 v204, v7, 5, v5
 v_add_u32 v212, 65536, v204
 v_xor_b32_e64 v7, 5, v6
 v_lshl_add_u32 v205, v7, 5, v5
 v_add_u32 v213, 65536, v205
 v_xor_b32_e64 v7, 6, v6
 v_lshl_add_u32 v206, v7, 5, v5
 v_add_u32 v214, 65536, v206
 v_xor_b32_e64 v7, 7, v6
 v_lshl_add_u32 v207, v7, 5, v5
 v_add_u32 v215, 65536, v207
 s_lshl_b32 s31, s22, 13
 s_nop 0
 s_add_u32 s31, s31, 16384
 v_lshlrev_b32 v224, 4, v1
 v_add_u32 v224, s31, v224
 v_add_u32 v225, 65536, v224
 s_mov_b32 s8, s32
 s_mov_b32 s9, s33
 s_mov_b32 s10, 0x400000
 s_mov_b32 s11, 0x20000
 s_lshl_b32 s27, s23, 14
 s_add_u32 s27, s27, s29
 s_lshl_b32 s27, s27, 5
 s_cmp_lg_u32 s38, 0
 s_cbranch_scc1 L_walk_gm
 s_lshr_b32 s34, s24, 2
 s_lshl_b32 s34, s34, 19
 s_nop 0
 s_add_u32 s34, s34, 393216
 s_lshl_b32 s31, s20, 4
 v_add_u32 v5, s31, v2
 v_lshlrev_b32 v5, 8, v5
 v_and_b32 v6, 15, v1
 v_add_u32 v7, 0, v2
 v_xor_b32 v61, v7, v6
 v_lshl_add_u32 v8, v61, 4, v5
 v_and_b32 v7, 7, v7
 v_lshlrev_b32 v7, 1, v7
 v_xor_b32_e64 v61, v7, v6
 v_lshl_add_u32 v12, v61, 4, v5
 v_add_u32 v7, 4, v2
 v_xor_b32 v61, v7, v6
 v_lshl_add_u32 v9, v61, 4, v5
 v_and_b32 v7, 7, v7
 v_lshlrev_b32 v7, 1, v7
 v_xor_b32_e64 v61, v7, v6
 v_lshl_add_u32 v13, v61, 4, v5
 v_add_u32 v7, 8, v2
 v_xor_b32 v61, v7, v6
 v_lshl_add_u32 v10, v61, 4, v5
 v_and_b32 v7, 7, v7
 v_lshlrev_b32 v7, 1, v7
 v_xor_b32_e64 v61, v7, v6
 v_lshl_add_u32 v14, v61, 4, v5
 v_add_u32 v7, 12, v2
 v_xor_b32 v61, v7, v6
 v_lshl_add_u32 v11, v61, 4, v5
 v_and_b32 v7, 7, v7
 v_lshlrev_b32 v7, 1, v7
 v_xor_b32_e64 v61, v7, v6
 v_lshl_add_u32 v15, v61, 4, v5
 v_lshrrev_b32 v62, 1, v2
 v_and_b32 v63, 1, v2
 v_and_b32 v6, 15, v1
 v_lshlrev_b32 v61, 8, v6
 v_lshl_add_u32 v61, v63, 3, v61
 v_add_u32 v7, 0, v62
 v_xor_b32 v7, v7, v6
 v_lshl_add_u32 v16, v7, 4, v61
 v_add_u32 v20, 0x10000, v16
 v_add_u32 v7, 4, v62
 v_xor_b32 v7, v7, v6
 v_lshl_add_u32 v17, v7, 4, v61
 v_add_u32 v21, 0x10000, v17
 v_add_u32 v7, 8, v62
 v_xor_b32 v7, v7, v6
 v_lshl_add_u32 v18, v7, 4, v61
 v_add_u32 v22, 0x10000, v18
 v_add_u32 v7, 12, v62
 v_xor_b32 v7, v7, v6
 v_lshl_add_u32 v19, v7, 4, v61
 v_add_u32 v23, 0x10000, v19
 v_lshl_add_u32 v5, v2, 2, v3
 v_and_b32 v7, 7, v5
 v_lshlrev_b32 v5, 8, v5
 v_lshrrev_b32_e64 v61, 1, v4
 v_lshl_add_u32 v5, v61, 4, v5
 v_and_b32_e64 v61, 1, v4
 v_lshl_add_u32 v5, v61, 3, v5
 v_xor_b32_e64 v61, 0, v7
 v_lshl_add_u32 v24, v61, 5, v5
 v_add_u32 v32, 0x10000, v24
 v_xor_b32_e64 v61, 1, v7
 v_lshl_add_u32 v25, v61, 5, v5
 v_add_u32 v33, 0x10000, v25
 v_xor_b32_e64 v61, 2, v7
 v_lshl_add_u32 v26, v61, 5, v5
 v_add_u32 v34, 0x10000, v26
 v_xor_b32_e64 v61, 3, v7
 v_lshl_add_u32 v27, v61, 5, v5
 v_add_u32 v35, 0x10000, v27
 v_xor_b32_e64 v61, 4, v7
 v_lshl_add_u32 v28, v61, 5, v5
 v_add_u32 v36, 0x10000, v28
 v_xor_b32_e64 v61, 5, v7
 v_lshl_add_u32 v29, v61, 5, v5
 v_add_u32 v37, 0x10000, v29
 v_xor_b32_e64 v61, 6, v7
 v_lshl_add_u32 v30, v61, 5, v5
 v_add_u32 v38, 0x10000, v30
 v_xor_b32_e64 v61, 7, v7
 v_lshl_add_u32 v31, v61, 5, v5
 v_add_u32 v39, 0x10000, v31
 v_mov_b32 v40, 0x3f803f80
 v_mov_b32 v41, 0x3f803f80
 v_mov_b32 v42, 0x3f803f80
 v_mov_b32 v43, 0x3f803f80
 v_lshlrev_b32 v60, 4, v1
 s_lshl_b32 s35, s24, 1
 s_add_u32 s35, s35, s21
 s_lshl_b32 s35, s35, 9
 s_lshl_b32 s31, s23, 4
 s_add_u32 s35, s35, s31
 s_lshl_b32 s31, s22, 3
 s_add_u32 s35, s35, s31
 s_lshl_b32 s35, s35, 10
 s_cmp_eq_u32 s20, 0
 s_cbranch_scc1 L_walk_ret
 s_cmp_eq_u32 s20, 1
 s_cbranch_scc1 L_stub_wa_1600
 s_cmp_eq_u32 s20, 2
 s_cbranch_scc1 L_stub_wa_1865
 s_branch L_stub_wa_2388
 s_nop 0
L_walk_gm:
 v_lshlrev_b32 v8, 4, v1
 s_lshl_b32 s31, s20, 6
 v_lshrrev_b32 v5, 3, v1
 v_add_u32 v5, s31, v5
 v_lshlrev_b32 v5, 12, v5
 v_and_b32 v6, 7, v1
 v_add_u32 v7, 0, v2
 v_xor_b32_e64 v7, v7, v6
 v_lshl_add_u32 v7, v7, 4, v5
 v_add_u32 v9, 0, v7
 v_add_u32 v7, 4, v2
 v_xor_b32_e64 v7, v7, v6
 v_lshl_add_u32 v7, v7, 4, v5
 v_add_u32 v10, 31744, v7
 v_add_u32 v7, 0, v2
 v_xor_b32 v7, v7, v6
 v_lshl_add_u32 v7, v7, 4, v5
 v_add_u32 v11, 63488, v7
 v_add_u32 v7, 4, v2
 v_xor_b32 v7, v7, v6
 v_lshl_add_u32 v7, v7, 4, v5
 v_add_u32 v12, 95232, v7
 v_add_u32 v7, 0, v2
 v_xor_b32 v7, v7, v6
 v_lshl_add_u32 v7, v7, 4, v5
 v_add_u32 v13, 131072, v7
 v_add_u32 v7, 4, v2
 v_xor_b32 v7, v7, v6
 v_lshl_add_u32 v7, v7, 4, v5
 v_add_u32 v14, 162816, v7
 v_add_u32 v7, 0, v2
 v_xor_b32 v7, v7, v6
 v_lshl_add_u32 v7, v7, 4, v5
 v_add_u32 v15, 194560, v7
 v_add_u32 v7, 4, v2
 v_xor_b32 v7, v7, v6
 v_lshl_add_u32 v7, v7, 4, v5
 v_add_u32 v16, 226304, v7
 v_and_b32 v17, 15, v1
 v_lshlrev_b32 v17, 1, v17
 v_mov_b32 v58, 0xc0135761
 v_mov_b32 v59, 0xc0135761
 s_cmp_eq_u32 s20, 0
 s_cbranch_scc1 L_walk_ret
 s_cmp_eq_u32 s20, 1
 s_cbranch_scc1 L_stub_wg_1600
 s_cmp_eq_u32 s20, 2
 s_cbranch_scc1 L_stub_wg_1865
 s_branch L_stub_wg_2388
 s_nop 0
L_walk_ret:
 s_lshl_b32 s40, s23, 8
 s_cmp_lg_u32 s20, 0
 s_cbranch_scc1 L_wt_10
 v_min_u32 v5, 31, v1
 v_lshlrev_b32_e64 v5, 3, v5
 s_mov_b32 s80, 0x20000
 s_branch L_poll_11
L_again_12:
 s_sub_u32 s80, s80, 1
 s_cbranch_scc1 L_wt_10
 s_sleep 2
L_poll_11:
 buffer_load_dwordx2 v[6:7], v5, s[16:19], s40 offen sc1
 s_waitcnt vmcnt(0)
 v_cmp_ne_u64 vcc, s[36:37], v[6:7]
 s_cmp_lg_u64 vcc, 0
 s_cbranch_scc1 L_again_12
L_wt_10:
 s_barrier
 s_nop 0
 s_add_u32 m0, s29, 16384
 s_nop 0
 s_nop 0
 buffer_load_dwordx4 v196, s[8:11], s27 offen offset:0 lds
 buffer_load_dwordx4 v197, s[8:11], s27 offen offset:1024 lds
 buffer_load_dwordx4 v198, s[8:11], s27 offen offset:2048 lds
 buffer_load_dwordx4 v199, s[8:11], s27 offen offset:3072 lds
 s_add_u32 s27, s27, 1024
 s_add_u32 m0, s29, 49152
 s_nop 0
 s_nop 0
 buffer_load_dwordx4 v196, s[8:11], s27 offen offset:0 lds
 buffer_load_dwordx4 v197, s[8:11], s27 offen offset:1024 lds
 buffer_load_dwordx4 v198, s[8:11], s27 offen offset:2048 lds
 buffer_load_dwordx4 v199, s[8:11], s27 offen offset:3072 lds
 s_add_u32 s27, s27, 1024
 s_branch L_skip_1600
.p2align 12
L_stub_wa_1600:
 s_branch L_stub_wa_2922
L_stub_wg_1600:
 s_branch L_stub_wg_11190
 s_nop 0
 s_nop 0
L_skip_1600:
 s_waitcnt vmcnt(4)
 s_barrier
 rd a[32:35],v224,0
 tr a[0:1],v200,0
 tr a[2:3],v200,2048
 rd a[36:39],v224,1024
 tr a[4:5],v201,0
 tr a[6:7],v201,2048
 rd a[40:43],v224,2048
 tr a[8:9],v202,0
 tr a[10:11],v202,2048
 rd a[44:47],v224,3072
 tr a[12:13],v203,0
 tr a[14:15],v203,2048
 rd a[48:51],v224,4096
 tr a[16:17],v204,0
 tr a[18:19],v204,2048
 rd a[52:55],v224,5120
 tr a[20:21],v205,0
 tr a[22:23],v205,2048
 rd a[56:59],v224,6144
 tr a[24:25],v206,0
 tr a[26:27],v206,2048
 rd a[60:63],v224,7168
 tr a[28:29],v207,0
 tr a[30:31],v207,2048
 s_waitcnt vmcnt(0) lgkmcnt(0)
 s_barrier
 mf a[128:131],a[0:3],a[32:35],0
 rd a[96:99],v224,32768
 mf a[160:163],a[4:7],a[32:35],0
 tr a[64:65],v200,32768
 s_add_u32 m0, s29, 65536
 mf a[164:167],a[4:7],a[36:39],0
 buffer_load_dwordx4 v192, s[4:7], s26 offen offset:0 lds
 mf a[132:135],a[0:3],a[36:39],0
 mf a[136:139],a[0:3],a[40:43],0
 tr a[66:67],v200,34816
 mf a[168:171],a[4:7],a[40:43],0
 buffer_load_dwordx4 v193, s[4:7], s26 offen offset:1024 lds
 mf a[172:175],a[4:7],a[44:47],0
 rd a[100:103],v224,33792
 mf a[140:143],a[0:3],a[44:47],0
 mf a[144:147],a[0:3],a[48:51],0
 tr a[68:69],v201,32768
 mf a[176:179],a[4:7],a[48:51],0
 buffer_load_dwordx4 v194, s[4:7], s26 offen offset:2048 lds
 mf a[180:183],a[4:7],a[52:55],0
 tr a[70:71],v201,34816
 mf a[148:151],a[0:3],a[52:55],0
 mf a[152:155],a[0:3],a[56:59],0
 rd a[104:107],v224,34816
 mf a[184:187],a[4:7],a[56:59],0
 buffer_load_dwordx4 v195, s[4:7], s26 offen offset:3072 lds
 mf a[188:191],a[4:7],a[60:63],0
 tr a[72:73],v202,32768
 mf a[156:159],a[0:3],a[60:63],0
 s_add_u32 m0, s29, 81920
 mf a[220:223],a[8:11],a[60:63],0
 tr a[74:75],v202,34816
 s_add_u32 s26, s26, s28
 s_nop 0
 mf a[252:255],a[12:15],a[60:63],0
 buffer_load_dwordx4 v196, s[8:11], s27 offen offset:0 lds
 mf a[248:251],a[12:15],a[56:59],0
 rd a[108:111],v224,35840
 mf a[216:219],a[8:11],a[56:59],0
 mf a[212:215],a[8:11],a[52:55],0
 tr a[76:77],v203,32768
 mf a[244:247],a[12:15],a[52:55],0
 buffer_load_dwordx4 v197, s[8:11], s27 offen offset:1024 lds
 mf a[240:243],a[12:15],a[48:51],0
 tr a[78:79],v203,34816
 mf a[208:211],a[8:11],a[48:51],0
 mf a[204:207],a[8:11],a[44:47],0
 buffer_load_dwordx4 v198, s[8:11], s27 offen offset:2048 lds
 mf a[236:239],a[12:15],a[44:47],0
 rd a[112:115],v224,36864
 mf a[232:235],a[12:15],a[40:43],0
 tr a[80:81],v204,32768
 mf a[200:203],a[8:11],a[40:43],0
 mf a[196:199],a[8:11],a[36:39],0
 buffer_load_dwordx4 v199, s[8:11], s27 offen offset:3072 lds
 mf a[228:231],a[12:15],a[36:39],0
 tr a[82:83],v204,34816
 mf a[224:227],a[12:15],a[32:35],0
 rd a[116:119],v224,37888
 s_add_u32 s27, s27, 1024
 mf a[192:195],a[8:11],a[32:35],0
 s_add_u32 m0, s29, 98304
 mf v[64:67],a[16:19],a[32:35],0
 buffer_load_dwordx4 v192, s[4:7], s26 offen offset:0 lds
 mf v[68:71],a[20:23],a[32:35],0
 tr a[84:85],v205,32768
 mf v[84:87],a[20:23],a[36:39],0
 tr a[86:87],v205,34816
 mf v[80:83],a[16:19],a[36:39],0
 mf v[96:99],a[16:19],a[40:43],0
 buffer_load_dwordx4 v193, s[4:7], s26 offen offset:1024 lds
 mf v[100:103],a[20:23],a[40:43],0
 rd a[120:123],v224,38912
 mf v[116:119],a[20:23],a[44:47],0
 tr a[88:89],v206,32768
 mf v[112:115],a[16:19],a[44:47],0
 mf v[128:131],a[16:19],a[48:51],0
 buffer_load_dwordx4 v194, s[4:7], s26 offen offset:2048 lds
 mf v[132:135],a[20:23],a[48:51],0
 tr a[90:91],v206,34816
 mf v[148:151],a[20:23],a[52:55],0
 rd a[124:127],v224,39936
 mf v[144:147],a[16:19],a[52:55],0
 buffer_load_dwordx4 v195, s[4:7], s26 offen offset:3072 lds
 mf v[160:163],a[16:19],a[56:59],0
 mf v[164:167],a[20:23],a[56:59],0
 tr a[92:93],v207,32768
 s_add_u32 m0, s29, 114688
 mf v[180:183],a[20:23],a[60:63],0
 tr a[94:95],v207,34816
 s_add_u32 s26, s26, s28
 s_nop 0
 mf v[176:179],a[16:19],a[60:63],0
 buffer_load_dwordx4 v196, s[8:11], s27 offen offset:0 lds
 mf v[184:187],a[24:27],a[60:63],0
 mf v[188:191],a[28:31],a[60:63],0
 mf v[172:175],a[28:31],a[56:59],0
 mf v[168:171],a[24:27],a[56:59],0
 buffer_load_dwordx4 v197, s[8:11], s27 offen offset:1024 lds
 mf v[152:155],a[24:27],a[52:55],0
 mf v[156:159],a[28:31],a[52:55],0
 mf v[140:143],a[28:31],a[48:51],0
 mf v[136:139],a[24:27],a[48:51],0
 buffer_load_dwordx4 v198, s[8:11], s27 offen offset:2048 lds
 mf v[120:123],a[24:27],a[44:47],0
 mf v[124:127],a[28:31],a[44:47],0
 mf v[108:111],a[28:31],a[40:43],0
 mf v[104:107],a[24:27],a[40:43],0
 buffer_load_dwordx4 v199, s[8:11], s27 offen offset:3072 lds
 mf v[88:91],a[24:27],a[36:39],0
 s_add_u32 s27, s27, 1024
 mf v[92:95],a[28:31],a[36:39],0
 mf v[76:79],a[28:31],a[32:35],0
 s_waitcnt vmcnt(8) lgkmcnt(0)
 s_nop 0
 mf v[72:75],a[24:27],a[32:35],0
 s_barrier
 s_nop 0
 mf a[128:131],a[64:67],a[96:99],a[128:131]
 rd a[32:35],v225,0
 mf a[160:163],a[68:71],a[96:99],a[160:163]
 tr a[0:1],v208,0
 s_add_u32 m0, s29, 0
 s_nop 0
 mf a[164:167],a[68:71],a[100:103],a[164:167]
 buffer_load_dwordx4 v192, s[4:7], s26 offen offset:0 lds
 mf a[132:135],a[64:67],a[100:103],a[132:135]
 mf a[136:139],a[64:67],a[104:107],a[136:139]
 tr a[2:3],v208,2048
 mf a[168:171],a[68:71],a[104:107],a[168:171]
 buffer_load_dwordx4 v193, s[4:7], s26 offen offset:1024 lds
 mf a[172:175],a[68:71],a[108:111],a[172:175]
 rd a[36:39],v225,1024
 mf a[140:143],a[64:67],a[108:111],a[140:143]
 mf a[144:147],a[64:67],a[112:115],a[144:147]
 tr a[4:5],v209,0
 mf a[176:179],a[68:71],a[112:115],a[176:179]
 buffer_load_dwordx4 v194, s[4:7], s26 offen offset:2048 lds
 mf a[180:183],a[68:71],a[116:119],a[180:183]
 tr a[6:7],v209,2048
 mf a[148:151],a[64:67],a[116:119],a[148:151]
 mf a[152:155],a[64:67],a[120:123],a[152:155]
 rd a[40:43],v225,2048
 mf a[184:187],a[68:71],a[120:123],a[184:187]
 buffer_load_dwordx4 v195, s[4:7], s26 offen offset:3072 lds
 mf a[188:191],a[68:71],a[124:127],a[188:191]
 tr a[8:9],v210,0
 mf a[156:159],a[64:67],a[124:127],a[156:159]
 s_add_u32 m0, s29, 16384
 mf a[220:223],a[72:75],a[124:127],a[220:223]
 tr a[10:11],v210,2048
 s_add_u32 s26, s26, s28
 s_nop 0
 mf a[252:255],a[76:79],a[124:127],a[252:255]
 buffer_load_dwordx4 v196, s[8:11], s27 offen offset:0 lds
 mf a[248:251],a[76:79],a[120:123],a[248:251]
 rd a[44:47],v225,3072
 mf a[216:219],a[72:75],a[120:123],a[216:219]
 mf a[212:215],a[72:75],a[116:119],a[212:215]
 tr a[12:13],v211,0
 mf a[244:247],a[76:79],a[116:119],a[244:247]
 buffer_load_dwordx4 v197, s[8:11], s27 offen offset:1024 lds
 mf a[240:243],a[76:79],a[112:115],a[240:243]
 tr a[14:15],v211,2048
 mf a[208:211],a[72:75],a[112:115],a[208:211]
 mf a[204:207],a[72:75],a[108:111],a[204:207]
 buffer_load_dwordx4 v198, s[8:11], s27 offen offset:2048 lds
 mf a[236:239],a[76:79],a[108:111],a[236:239]
 rd a[48:51],v225,4096
 mf a[232:235],a[76:79],a[104:107],a[232:235]
 tr a[16:17],v212,0
 mf a[200:203],a[72:75],a[104:107],a[200:203]
 mf a[196:199],a[72:75],a[100:103],a[196:199]
 buffer_load_dwordx4 v199, s[8:11], s27 offen offset:3072 lds
 mf a[228:231],a[76:79],a[100:103],a[228:231]
 tr a[18:19],v212,2048
 mf a[224:227],a[76:79],a[96:99],a[224:227]
 rd a[52:55],v225,5120
 s_add_u32 s27, s27, 1024
 mf a[192:195],a[72:75],a[96:99],a[192:195]
 s_add_u32 m0, s29, 32768
 mf v[64:67],a[80:83],a[96:99],v[64:67]
 buffer_load_dwordx4 v192, s[4:7], s26 offen offset:0 lds
 mf v[68:71],a[84:87],a[96:99],v[68:71]
 tr a[20:21],v213,0
 mf v[84:87],a[84:87],a[100:103],v[84:87]
 tr a[22:23],v213,2048
 mf v[80:83],a[80:83],a[100:103],v[80:83]
 mf v[96:99],a[80:83],a[104:107],v[96:99]
 buffer_load_dwordx4 v193, s[4:7], s26 offen offset:1024 lds
 mf v[100:103],a[84:87],a[104:107],v[100:103]
 rd a[56:59],v225,6144
 mf v[116:119],a[84:87],a[108:111],v[116:119]
 tr a[24:25],v214,0
 mf v[112:115],a[80:83],a[108:111],v[112:115]
 mf v[128:131],a[80:83],a[112:115],v[128:131]
 buffer_load_dwordx4 v194, s[4:7], s26 offen offset:2048 lds
 mf v[132:135],a[84:87],a[112:115],v[132:135]
 tr a[26:27],v214,2048
 mf v[148:151],a[84:87],a[116:119],v[148:151]
 rd a[60:63],v225,7168
 mf v[144:147],a[80:83],a[116:119],v[144:147]
 buffer_load_dwordx4 v195, s[4:7], s26 offen offset:3072 lds
 mf v[160:163],a[80:83],a[120:123],v[160:163]
 mf v[164:167],a[84:87],a[120:123],v[164:167]
 tr a[28:29],v215,0
 s_add_u32 m0, s29, 49152
 mf v[180:183],a[84:87],a[124:127],v[180:183]
 tr a[30:31],v215,2048
 s_add_u32 s26, s26, s28
 s_nop 0
 mf v[176:179],a[80:83],a[124:127],v[176:179]
 buffer_load_dwordx4 v196, s[8:11], s27 offen offset:0 lds
 mf v[184:187],a[88:91],a[124:127],v[184:187]
 mf v[188:191],a[92:95],a[124:127],v[188:191]
 mf v[172:175],a[92:95],a[120:123],v[172:175]
 mf v[168:171],a[88:91],a[120:123],v[168:171]
 buffer_load_dwordx4 v197, s[8:11], s27 offen offset:1024 lds
 mf v[152:155],a[88:91],a[116:119],v[152:155]
 mf v[156:159],a[92:95],a[116:119],v[156:159]
 mf v[140:143],a[92:95],a[112:115],v[140:143]
 mf v[136:139],a[88:91],a[112:115],v[136:139]
 buffer_load_dwordx4 v198, s[8:11], s27 offen offset:2048 lds
 mf v[120:123],a[88:91],a[108:111],v[120:123]
 mf v[124:127],a[92:95],a[108:111],v[124:127]
 mf v[108:111],a[92:95],a[104:107],v[108:111]
 mf v[104:107],a[88:91],a[104:107],v[104:107]
 buffer_load_dwordx4 v199, s[8:11], s27 offen offset:3072 lds
 mf v[88:91],a[88:91],a[100:103],v[88:91]
 s_add_u32 s27, s27, 1024
 mf v[92:95],a[92:95],a[100:103],v[92:95]
 mf v[76:79],a[92:95],a[96:99],v[76:79]
 s_waitcnt vmcnt(16) lgkmcnt(0)
 s_nop 0
 mf v[72:75],a[88:91],a[96:99],v[72:75]
 s_mov_b32 s30, 6
 s_branch L_skip_1865
.p2align 12
L_stub_wa_1865:
 s_branch L_stub_wa_3432
L_stub_wg_1865:
 s_branch L_stub_wg_11805
 s_nop 0
 s_nop 0
L_skip_1865:
.p2align 6
L_p1_loop_13:
 s_barrier
 s_nop 0
 mf a[128:131],a[0:3],a[32:35],a[128:131]
 rd a[96:99],v225,32768
 mf a[160:163],a[4:7],a[32:35],a[160:163]
 tr a[64:65],v208,32768
 mf a[164:167],a[4:7],a[36:39],a[164:167]
 mf a[132:135],a[0:3],a[36:39],a[132:135]
 tr a[66:67],v208,34816
 s_add_u32 m0, s29, 65536
 mf a[136:139],a[0:3],a[40:43],a[136:139]
 buffer_load_dwordx4 v192, s[4:7], s26 offen offset:0 lds
 mf a[168:171],a[4:7],a[40:43],a[168:171]
 mf a[172:175],a[4:7],a[44:47],a[172:175]
 rd a[100:103],v225,33792
 mf a[140:143],a[0:3],a[44:47],a[140:143]
 mf a[144:147],a[0:3],a[48:51],a[144:147]
 tr a[68:69],v209,32768
 mf a[176:179],a[4:7],a[48:51],a[176:179]
 tr a[70:71],v209,34816
 mf a[180:183],a[4:7],a[52:55],a[180:183]
 mf a[148:151],a[0:3],a[52:55],a[148:151]
 buffer_load_dwordx4 v193, s[4:7], s26 offen offset:1024 lds
 mf a[152:155],a[0:3],a[56:59],a[152:155]
 rd a[104:107],v225,34816
 mf a[184:187],a[4:7],a[56:59],a[184:187]
 mf a[188:191],a[4:7],a[60:63],a[188:191]
 tr a[72:73],v210,32768
 mf a[156:159],a[0:3],a[60:63],a[156:159]
 mf a[220:223],a[8:11],a[60:63],a[220:223]
 tr a[74:75],v210,34816
 mf a[252:255],a[12:15],a[60:63],a[252:255]
 mf a[248:251],a[12:15],a[56:59],a[248:251]
 rd a[108:111],v225,35840
 mf a[216:219],a[8:11],a[56:59],a[216:219]
 buffer_load_dwordx4 v194, s[4:7], s26 offen offset:2048 lds
 mf a[212:215],a[8:11],a[52:55],a[212:215]
 tr a[76:77],v211,32768
 mf a[244:247],a[12:15],a[52:55],a[244:247]
 mf a[240:243],a[12:15],a[48:51],a[240:243]
 tr a[78:79],v211,34816
 mf a[208:211],a[8:11],a[48:51],a[208:211]
 mf a[204:207],a[8:11],a[44:47],a[204:207]
 rd a[112:115],v225,36864
 mf a[236:239],a[12:15],a[44:47],a[236:239]
 mf a[232:235],a[12:15],a[40:43],a[232:235]
 buffer_load_dwordx4 v195, s[4:7], s26 offen offset:3072 lds
 mf a[200:203],a[8:11],a[40:43],a[200:203]
 tr a[80:81],v212,32768
 mf a[196:199],a[8:11],a[36:39],a[196:199]
 mf a[228:231],a[12:15],a[36:39],a[228:231]
 tr a[82:83],v212,34816
 mf a[224:227],a[12:15],a[32:35],a[224:227]
 rd a[116:119],v225,37888
 mf a[192:195],a[8:11],a[32:35],a[192:195]
 mf v[64:67],a[16:19],a[32:35],v[64:67]
 tr a[84:85],v213,32768
 s_add_u32 m0, s29, 81920
 mf v[68:71],a[20:23],a[32:35],v[68:71]
 s_add_u32 s26, s26, s28
 s_nop 0
 mf v[84:87],a[20:23],a[36:39],v[84:87]
 buffer_load_dwordx4 v196, s[8:11], s27 offen offset:0 lds
 mf v[80:83],a[16:19],a[36:39],v[80:83]
 tr a[86:87],v213,34816
 mf v[96:99],a[16:19],a[40:43],v[96:99]
 mf v[100:103],a[20:23],a[40:43],v[100:103]
 rd a[120:123],v225,38912
 mf v[116:119],a[20:23],a[44:47],v[116:119]
 mf v[112:115],a[16:19],a[44:47],v[112:115]
 tr a[88:89],v214,32768
 mf v[128:131],a[16:19],a[48:51],v[128:131]
 tr a[90:91],v214,34816
 mf v[132:135],a[20:23],a[48:51],v[132:135]
 mf v[148:151],a[20:23],a[52:55],v[148:151]
 buffer_load_dwordx4 v197, s[8:11], s27 offen offset:1024 lds
 mf v[144:147],a[16:19],a[52:55],v[144:147]
 rd a[124:127],v225,39936
 mf v[160:163],a[16:19],a[56:59],v[160:163]
 mf v[164:167],a[20:23],a[56:59],v[164:167]
 tr a[92:93],v215,32768
 mf v[180:183],a[20:23],a[60:63],v[180:183]
 mf v[176:179],a[16:19],a[60:63],v[176:179]
 tr a[94:95],v215,34816
 mf v[184:187],a[24:27],a[60:63],v[184:187]
 mf v[188:191],a[28:31],a[60:63],v[188:191]
 buffer_load_dwordx4 v198, s[8:11], s27 offen offset:2048 lds
 mf v[172:175],a[28:31],a[56:59],v[172:175]
 mf v[168:171],a[24:27],a[56:59],v[168:171]
 mf v[152:155],a[24:27],a[52:55],v[152:155]
 mf v[156:159],a[28:31],a[52:55],v[156:159]
 mf v[140:143],a[28:31],a[48:51],v[140:143]
 mf v[136:139],a[24:27],a[48:51],v[136:139]
 mf v[120:123],a[24:27],a[44:47],v[120:123]
 mf v[124:127],a[28:31],a[44:47],v[124:127]
 buffer_load_dwordx4 v199, s[8:11], s27 offen offset:3072 lds
 mf v[108:111],a[28:31],a[40:43],v[108:111]
 s_add_u32 s27, s27, 1024
 mf v[104:107],a[24:27],a[40:43],v[104:107]
 mf v[88:91],a[24:27],a[36:39],v[88:91]
 mf v[92:95],a[28:31],a[36:39],v[92:95]
 mf v[76:79],a[28:31],a[32:35],v[76:79]
 s_waitcnt vmcnt(16) lgkmcnt(0)
 s_nop 0
 mf v[72:75],a[24:27],a[32:35],v[72:75]
 s_barrier
 s_nop 0
 mf a[128:131],a[64:67],a[96:99],a[128:131]
 rd a[32:35],v224,0
 mf a[160:163],a[68:71],a[96:99],a[160:163]
 tr a[0:1],v200,0
 mf a[164:167],a[68:71],a[100:103],a[164:167]
 mf a[132:135],a[64:67],a[100:103],a[132:135]
 tr a[2:3],v200,2048
 s_add_u32 m0, s29, 98304
 mf a[136:139],a[64:67],a[104:107],a[136:139]
 buffer_load_dwordx4 v192, s[4:7], s26 offen offset:0 lds
 mf a[168:171],a[68:71],a[104:107],a[168:171]
 mf a[172:175],a[68:71],a[108:111],a[172:175]
 rd a[36:39],v224,1024
 mf a[140:143],a[64:67],a[108:111],a[140:143]
 mf a[144:147],a[64:67],a[112:115],a[144:147]
 tr a[4:5],v201,0
 mf a[176:179],a[68:71],a[112:115],a[176:179]
 tr a[6:7],v201,2048
 mf a[180:183],a[68:71],a[116:119],a[180:183]
 mf a[148:151],a[64:67],a[116:119],a[148:151]
 buffer_load_dwordx4 v193, s[4:7], s26 offen offset:1024 lds
 mf a[152:155],a[64:67],a[120:123],a[152:155]
 rd a[40:43],v224,2048
 mf a[184:187],a[68:71],a[120:123],a[184:187]
 mf a[188:191],a[68:71],a[124:127],a[188:191]
 tr a[8:9],v202,0
 mf a[156:159],a[64:67],a[124:127],a[156:159]
 mf a[220:223],a[72:75],a[124:127],a[220:223]
 tr a[10:11],v202,2048
 mf a[252:255],a[76:79],a[124:127],a[252:255]
 mf a[248:251],a[76:79],a[120:123],a[248:251]
 rd a[44:47],v224,3072
 mf a[216:219],a[72:75],a[120:123],a[216:219]
 buffer_load_dwordx4 v194, s[4:7], s26 offen offset:2048 lds
 mf a[212:215],a[72:75],a[116:119],a[212:215]
 tr a[12:13],v203,0
 mf a[244:247],a[76:79],a[116:119],a[244:247]
 mf a[240:243],a[76:79],a[112:115],a[240:243]
 tr a[14:15],v203,2048
 mf a[208:211],a[72:75],a[112:115],a[208:211]
 mf a[204:207],a[72:75],a[108:111],a[204:207]
 rd a[48:51],v224,4096
 mf a[236:239],a[76:79],a[108:111],a[236:239]
 mf a[232:235],a[76:79],a[104:107],a[232:235]
 buffer_load_dwordx4 v195, s[4:7], s26 offen offset:3072 lds
 mf a[200:203],a[72:75],a[104:107],a[200:203]
 tr a[16:17],v204,0
 mf a[196:199],a[72:75],a[100:103],a[196:199]
 mf a[228:231],a[76:79],a[100:103],a[228:231]
 tr a[18:19],v204,2048
 mf a[224:227],a[76:79],a[96:99],a[224:227]
 rd a[52:55],v224,5120
 mf a[192:195],a[72:75],a[96:99],a[192:195]
 mf v[64:67],a[80:83],a[96:99],v[64:67]
 tr a[20:21],v205,0
 s_add_u32 m0, s29, 114688
 mf v[68:71],a[84:87],a[96:99],v[68:71]
 s_add_u32 s26, s26, s28
 s_nop 0
 mf v[84:87],a[84:87],a[100:103],v[84:87]
 buffer_load_dwordx4 v196, s[8:11], s27 offen offset:0 lds
 mf v[80:83],a[80:83],a[100:103],v[80:83]
 tr a[22:23],v205,2048
 mf v[96:99],a[80:83],a[104:107],v[96:99]
 mf v[100:103],a[84:87],a[104:107],v[100:103]
 rd a[56:59],v224,6144
 mf v[116:119],a[84:87],a[108:111],v[116:119]
 mf v[112:115],a[80:83],a[108:111],v[112:115]
 tr a[24:25],v206,0
 mf v[128:131],a[80:83],a[112:115],v[128:131]
 tr a[26:27],v206,2048
 mf v[132:135],a[84:87],a[112:115],v[132:135]
 mf v[148:151],a[84:87],a[116:119],v[148:151]
 buffer_load_dwordx4 v197, s[8:11], s27 offen offset:1024 lds
 mf v[144:147],a[80:83],a[116:119],v[144:147]
 rd a[60:63],v224,7168
 mf v[160:163],a[80:83],a[120:123],v[160:163]
 mf v[164:167],a[84:87],a[120:123],v[164:167]
 tr a[28:29],v207,0
 mf v[180:183],a[84:87],a[124:127],v[180:183]
 mf v[176:179],a[80:83],a[124:127],v[176:179]
 tr a[30:31],v207,2048
 mf v[184:187],a[88:91],a[124:127],v[184:187]
 mf v[188:191],a[92:95],a[124:127],v[188:191]
 buffer_load_dwordx4 v198, s[8:11], s27 offen offset:2048 lds
 mf v[172:175],a[92:95],a[120:123],v[172:175]
 mf v[168:171],a[88:91],a[120:123],v[168:171]
 mf v[152:155],a[88:91],a[116:119],v[152:155]
 mf v[156:159],a[92:95],a[116:119],v[156:159]
 mf v[140:143],a[92:95],a[112:115],v[140:143]
 mf v[136:139],a[88:91],a[112:115],v[136:139]
 mf v[120:123],a[88:91],a[108:111],v[120:123]
 mf v[124:127],a[92:95],a[108:111],v[124:127]
 buffer_load_dwordx4 v199, s[8:11], s27 offen offset:3072 lds
 mf v[108:111],a[92:95],a[104:107],v[108:111]
 s_add_u32 s27, s27, 1024
 mf v[104:107],a[88:91],a[104:107],v[104:107]
 mf v[88:91],a[88:91],a[100:103],v[88:91]
 mf v[92:95],a[92:95],a[100:103],v[92:95]
 mf v[76:79],a[92:95],a[96:99],v[76:79]
 s_waitcnt vmcnt(16) lgkmcnt(0)
 s_nop 0
 mf v[72:75],a[88:91],a[96:99],v[72:75]
 s_barrier
 s_nop 0
 mf a[128:131],a[0:3],a[32:35],a[128:131]
 rd a[96:99],v224,32768
 mf a[160:163],a[4:7],a[32:35],a[160:163]
 tr a[64:65],v200,32768
 mf a[164:167],a[4:7],a[36:39],a[164:167]
 mf a[132:135],a[0:3],a[36:39],a[132:135]
 tr a[66:67],v200,34816
 s_add_u32 m0, s29, 0
 s_nop 0
 mf a[136:139],a[0:3],a[40:43],a[136:139]
 buffer_load_dwordx4 v192, s[4:7], s26 offen offset:0 lds
 mf a[168:171],a[4:7],a[40:43],a[168:171]
 mf a[172:175],a[4:7],a[44:47],a[172:175]
 rd a[100:103],v224,33792
 mf a[140:143],a[0:3],a[44:47],a[140:143]
 mf a[144:147],a[0:3],a[48:51],a[144:147]
 tr a[68:69],v201,32768
 mf a[176:179],a[4:7],a[48:51],a[176:179]
 tr a[70:71],v201,34816
 mf a[180:183],a[4:7],a[52:55],a[180:183]
 mf a[148:151],a[0:3],a[52:55],a[148:151]
 buffer_load_dwordx4 v193, s[4:7], s26 offen offset:1024 lds
 mf a[152:155],a[0:3],a[56:59],a[152:155]
 rd a[104:107],v224,34816
 mf a[184:187],a[4:7],a[56:59],a[184:187]
 mf a[188:191],a[4:7],a[60:63],a[188:191]
 tr a[72:73],v202,32768
 mf a[156:159],a[0:3],a[60:63],a[156:159]
 mf a[220:223],a[8:11],a[60:63],a[220:223]
 tr a[74:75],v202,34816
 mf a[252:255],a[12:15],a[60:63],a[252:255]
 mf a[248:251],a[12:15],a[56:59],a[248:251]
 rd a[108:111],v224,35840
 mf a[216:219],a[8:11],a[56:59],a[216:219]
 buffer_load_dwordx4 v194, s[4:7], s26 offen offset:2048 lds
 mf a[212:215],a[8:11],a[52:55],a[212:215]
 tr a[76:77],v203,32768
 mf a[244:247],a[12:15],a[52:55],a[244:247]
 mf a[240:243],a[12:15],a[48:51],a[240:243]
 tr a[78:79],v203,34816
 mf a[208:211],a[8:11],a[48:51],a[208:211]
 mf a[204:207],a[8:11],a[44:47],a[204:207]
 rd a[112:115],v224,36864
 mf a[236:239],a[12:15],a[44:47],a[236:239]
 mf a[232:235],a[12:15],a[40:43],a[232:235]
 buffer_load_dwordx4 v195, s[4:7], s26 offen offset:3072 lds
 mf a[200:203],a[8:11],a[40:43],a[200:203]
 tr a[80:81],v204,32768
 mf a[196:199],a[8:11],a[36:39],a[196:199]
 mf a[228:231],a[12:15],a[36:39],a[228:231]
 tr a[82:83],v204,34816
 mf a[224:227],a[12:15],a[32:35],a[224:227]
 rd a[116:119],v224,37888
 mf a[192:195],a[8:11],a[32:35],a[192:195]
 mf v[64:67],a[16:19],a[32:35],v[64:67]
 tr a[84:85],v205,32768
 s_add_u32 m0, s29, 16384
 mf v[68:71],a[20:23],a[32:35],v[68:71]
 s_add_u32 s26, s26, s28
 s_nop 0
 mf v[84:87],a[20:23],a[36:39],v[84:87]
 buffer_load_dwordx4 v196, s[8:11], s27 offen offset:0 lds
 mf v[80:83],a[16:19],a[36:39],v[80:83]
 tr a[86:87],v205,34816
 mf v[96:99],a[16:19],a[40:43],v[96:99]
 mf v[100:103],a[20:23],a[40:43],v[100:103]
 rd a[120:123],v224,38912
 mf v[116:119],a[20:23],a[44:47],v[116:119]
 mf v[112:115],a[16:19],a[44:47],v[112:115]
 tr a[88:89],v206,32768
 mf v[128:131],a[16:19],a[48:51],v[128:131]
 tr a[90:91],v206,34816
 mf v[132:135],a[20:23],a[48:51],v[132:135]
 mf v[148:151],a[20:23],a[52:55],v[148:151]
 buffer_load_dwordx4 v197, s[8:11], s27 offen offset:1024 lds
 mf v[144:147],a[16:19],a[52:55],v[144:147]
 rd a[124:127],v224,39936
 mf v[160:163],a[16:19],a[56:59],v[160:163]
 mf v[164:167],a[20:23],a[56:59],v[164:167]
 tr a[92:93],v207,32768
 mf v[180:183],a[20:23],a[60:63],v[180:183]
 mf v[176:179],a[16:19],a[60:63],v[176:179]
 tr a[94:95],v207,34816
 mf v[184:187],a[24:27],a[60:63],v[184:187]
 mf v[188:191],a[28:31],a[60:63],v[188:191]
 buffer_load_dwordx4 v198, s[8:11], s27 offen offset:2048 lds
 mf v[172:175],a[28:31],a[56:59],v[172:175]
 mf v[168:171],a[24:27],a[56:59],v[168:171]
 mf v[152:155],a[24:27],a[52:55],v[152:155]
 mf v[156:159],a[28:31],a[52:55],v[156:159]
 mf v[140:143],a[28:31],a[48:51],v[140:143]
 mf v[136:139],a[24:27],a[48:51],v[136:139]
 mf v[120:123],a[24:27],a[44:47],v[120:123]
 mf v[124:127],a[28:31],a[44:47],v[124:127]
 buffer_load_dwordx4 v199, s[8:11], s27 offen offset:3072 lds
 mf v[108:111],a[28:31],a[40:43],v[108:111]
 s_add_u32 s27, s27, 1024
 mf v[104:107],a[24:27],a[40:43],v[104:107]
 mf v[88:91],a[24:27],a[36:39],v[88:91]
 mf v[92:95],a[28:31],a[36:39],v[92:95]
 mf v[76:79],a[28:31],a[32:35],v[76:79]
 s_waitcnt vmcnt(16) lgkmcnt(0)
 s_nop 0
 mf v[72:75],a[24:27],a[32:35],v[72:75]
 s_barrier
 s_nop 0
 mf a[128:131],a[64:67],a[96:99],a[128:131]
 rd a[32:35],v225,0
 mf a[160:163],a[68:71],a[96:99],a[160:163]
 tr a[0:1],v208,0
 mf a[164:167],a[68:71],a[100:103],a[164:167]
 mf a[132:135],a[64:67],a[100:103],a[132:135]
 tr a[2:3],v208,2048
 s_add_u32 m0, s29, 32768
 mf a[136:139],a[64:67],a[104:107],a[136:139]
 buffer_load_dwordx4 v192, s[4:7], s26 offen offset:0 lds
 mf a[168:171],a[68:71],a[104:107],a[168:171]
 mf a[172:175],a[68:71],a[108:111],a[172:175]
 rd a[36:39],v225,1024
 mf a[140:143],a[64:67],a[108:111],a[140:143]
 mf a[144:147],a[64:67],a[112:115],a[144:147]
 tr a[4:5],v209,0
 mf a[176:179],a[68:71],a[112:115],a[176:179]
 tr a[6:7],v209,2048
 mf a[180:183],a[68:71],a[116:119],a[180:183]
 mf a[148:151],a[64:67],a[116:119],a[148:151]
 buffer_load_dwordx4 v193, s[4:7], s26 offen offset:1024 lds
 mf a[152:155],a[64:67],a[120:123],a[152:155]
 rd a[40:43],v225,2048
 mf a[184:187],a[68:71],a[120:123],a[184:187]
 mf a[188:191],a[68:71],a[124:127],a[188:191]
 tr a[8:9],v210,0
 mf a[156:159],a[64:67],a[124:127],a[156:159]
 mf a[220:223],a[72:75],a[124:127],a[220:223]
 tr a[10:11],v210,2048
 mf a[252:255],a[76:79],a[124:127],a[252:255]
 mf a[248:251],a[76:79],a[120:123],a[248:251]
 rd a[44:47],v225,3072
 mf a[216:219],a[72:75],a[120:123],a[216:219]
 buffer_load_dwordx4 v194, s[4:7], s26 offen offset:2048 lds
 mf a[212:215],a[72:75],a[116:119],a[212:215]
 tr a[12:13],v211,0
 mf a[244:247],a[76:79],a[116:119],a[244:247]
 mf a[240:243],a[76:79],a[112:115],a[240:243]
 tr a[14:15],v211,2048
 mf a[208:211],a[72:75],a[112:115],a[208:211]
 mf a[204:207],a[72:75],a[108:111],a[204:207]
 rd a[48:51],v225,4096
 mf a[236:239],a[76:79],a[108:111],a[236:239]
 mf a[232:235],a[76:79],a[104:107],a[232:235]
 buffer_load_dwordx4 v195, s[4:7], s26 offen offset:3072 lds
 mf a[200:203],a[72:75],a[104:107],a[200:203]
 tr a[16:17],v212,0
 mf a[196:199],a[72:75],a[100:103],a[196:199]
 mf a[228:231],a[76:79],a[100:103],a[228:231]
 tr a[18:19],v212,2048
 mf a[224:227],a[76:79],a[96:99],a[224:227]
 rd a[52:55],v225,5120
 mf a[192:195],a[72:75],a[96:99],a[192:195]
 mf v[64:67],a[80:83],a[96:99],v[64:67]
 tr a[20:21],v213,0
 s_add_u32 m0, s29, 49152
 mf v[68:71],a[84:87],a[96:99],v[68:71]
 s_add_u32 s26, s26, s28
 s_nop 0
 mf v[84:87],a[84:87],a[100:103],v[84:87]
 buffer_load_dwordx4 v196, s[8:11], s27 offen offset:0 lds
 mf v[80:83],a[80:83],a[100:103],v[80:83]
 tr a[22:23],v213,2048
 mf v[96:99],a[80:83],a[104:107],v[96:99]
 mf v[100:103],a[84:87],a[104:107],v[100:103]
 rd a[56:59],v225,6144
 mf v[116:119],a[84:87],a[108:111],v[116:119]
 mf v[112:115],a[80:83],a[108:111],v[112:115]
 tr a[24:25],v214,0
 mf v[128:131],a[80:83],a[112:115],v[128:131]
 tr a[26:27],v214,2048
 mf v[132:135],a[84:87],a[112:115],v[132:135]
 mf v[148:151],a[84:87],a[116:119],v[148:151]
 buffer_load_dwordx4 v197, s[8:11], s27 offen offset:1024 lds
 mf v[144:147],a[80:83],a[116:119],v[144:147]
 rd a[60:63],v225,7168
 mf v[160:163],a[80:83],a[120:123],v[160:163]
 mf v[164:167],a[84:87],a[120:123],v[164:167]
 tr a[28:29],v215,0
 mf v[180:183],a[84:87],a[124:127],v[180:183]
 mf v[176:179],a[80:83],a[124:127],v[176:179]
 tr a[30:31],v215,2048
 mf v[184:187],a[88:91],a[124:127],v[184:187]
 mf v[188:191],a[92:95],a[124:127],v[188:191]
 buffer_load_dwordx4 v198, s[8:11], s27 offen offset:2048 lds
 mf v[172:175],a[92:95],a[120:123],v[172:175]
 mf v[168:171],a[88:91],a[120:123],v[168:171]
 mf v[152:155],a[88:91],a[116:119],v[152:155]
 mf v[156:159],a[92:95],a[116:119],v[156:159]
 mf v[140:143],a[92:95],a[112:115],v[140:143]
 mf v[136:139],a[88:91],a[112:115],v[136:139]
 mf v[120:123],a[88:91],a[108:111],v[120:123]
 mf v[124:127],a[92:95],a[108:111],v[124:127]
 buffer_load_dwordx4 v199, s[8:11], s27 offen offset:3072 lds
 mf v[108:111],a[92:95],a[104:107],v[108:111]
 s_add_u32 s27, s27, 1024
 mf v[104:107],a[88:91],a[104:107],v[104:107]
 mf v[88:91],a[88:91],a[100:103],v[88:91]
 mf v[92:95],a[92:95],a[100:103],v[92:95]
 mf v[76:79],a[92:95],a[96:99],v[76:79]
 s_sub_u32 s30, s30, 1
 s_waitcnt vmcnt(16) lgkmcnt(0)
 s_cmp_lg_u32 s30, 0
 s_nop 0
 mf v[72:75],a[88:91],a[96:99],v[72:75]
 s_cbranch_scc1 L_p1_loop_13
 s_barrier
 mf a[128:131],a[0:3],a[32:35],a[128:131]
 rd a[96:99],v225,32768
 mf a[160:163],a[4:7],a[32:35],a[160:163]
 tr a[64:65],v208,32768
 mf a[164:167],a[4:7],a[36:39],a[164:167]
 mf a[132:135],a[0:3],a[36:39],a[132:135]
 tr a[66:67],v208,34816
 s_add_u32 m0, s29, 65536
 mf a[136:139],a[0:3],a[40:43],a[136:139]
 buffer_load_dwordx4 v192, s[4:7], s26 offen offset:0 lds
 mf a[168:171],a[4:7],a[40:43],a[168:171]
 mf a[172:175],a[4:7],a[44:47],a[172:175]
 rd a[100:103],v225,33792
 mf a[140:143],a[0:3],a[44:47],a[140:143]
 mf a[144:147],a[0:3],a[48:51],a[144:147]
 tr a[68:69],v209,32768
 mf a[176:179],a[4:7],a[48:51],a[176:179]
 tr a[70:71],v209,34816
 mf a[180:183],a[4:7],a[52:55],a[180:183]
 mf a[148:151],a[0:3],a[52:55],a[148:151]
 buffer_load_dwordx4 v193, s[4:7], s26 offen offset:1024 lds
 mf a[152:155],a[0:3],a[56:59],a[152:155]
 rd a[104:107],v225,34816
 mf a[184:187],a[4:7],a[56:59],a[184:187]
 mf a[188:191],a[4:7],a[60:63],a[188:191]
 tr a[72:73],v210,32768
 mf a[156:159],a[0:3],a[60:63],a[156:159]
 mf a[220:223],a[8:11],a[60:63],a[220:223]
 tr a[74:75],v210,34816
 mf a[252:255],a[12:15],a[60:63],a[252:255]
 mf a[248:251],a[12:15],a[56:59],a[248:251]
 rd a[108:111],v225,35840
 mf a[216:219],a[8:11],a[56:59],a[216:219]
 buffer_load_dwordx4 v194, s[4:7], s26 offen offset:2048 lds
 mf a[212:215],a[8:11],a[52:55],a[212:215]
 tr a[76:77],v211,32768
 mf a[244:247],a[12:15],a[52:55],a[244:247]
 mf a[240:243],a[12:15],a[48:51],a[240:243]
 tr a[78:79],v211,34816
 mf a[208:211],a[8:11],a[48:51],a[208:211]
 mf a[204:207],a[8:11],a[44:47],a[204:207]
 rd a[112:115],v225,36864
 mf a[236:239],a[12:15],a[44:47],a[236:239]
 mf a[232:235],a[12:15],a[40:43],a[232:235]
 buffer_load_dwordx4 v195, s[4:7], s26 offen offset:3072 lds
 mf a[200:203],a[8:11],a[40:43],a[200:203]
 tr a[80:81],v212,32768
 mf a[196:199],a[8:11],a[36:39],a[196:199]
 mf a[228:231],a[12:15],a[36:39],a[228:231]
 tr a[82:83],v212,34816
 mf a[224:227],a[12:15],a[32:35],a[224:227]
 rd a[116:119],v225,37888
 mf a[192:195],a[8:11],a[32:35],a[192:195]
 mf v[64:67],a[16:19],a[32:35],v[64:67]
 tr a[84:85],v213,32768
 s_add_u32 m0, s29, 81920
 mf v[68:71],a[20:23],a[32:35],v[68:71]
 s_add_u32 s26, s26, s28
 s_nop 0
 mf v[84:87],a[20:23],a[36:39],v[84:87]
 buffer_load_dwordx4 v196, s[8:11], s27 offen offset:0 lds
 mf v[80:83],a[16:19],a[36:39],v[80:83]
 tr a[86:87],v213,34816
 mf v[96:99],a[16:19],a[40:43],v[96:99]
 mf v[100:103],a[20:23],a[40:43],v[100:103]
 rd a[120:123],v225,38912
 mf v[116:119],a[20:23],a[44:47],v[116:119]
 mf v[112:115],a[16:19],a[44:47],v[112:115]
 tr a[88:89],v214,32768
 mf v[128:131],a[16:19],a[48:51],v[128:131]
 tr a[90:91],v214,34816
 mf v[132:135],a[20:23],a[48:51],v[132:135]
 mf v[148:151],a[20:23],a[52:55],v[148:151]
 buffer_load_dwordx4 v197, s[8:11], s27 offen offset:1024 lds
 mf v[144:147],a[16:19],a[52:55],v[144:147]
 rd a[124:127],v225,39936
 mf v[160:163],a[16:19],a[56:59],v[160:163]
 mf v[164:167],a[20:23],a[56:59],v[164:167]
 tr a[92:93],v215,32768
 mf v[180:183],a[20:23],a[60:63],v[180:183]
 mf v[176:179],a[16:19],a[60:63],v[176:179]
 tr a[94:95],v215,34816
 mf v[184:187],a[24:27],a[60:63],v[184:187]
 mf v[188:191],a[28:31],a[60:63],v[188:191]
 buffer_load_dwordx4 v198, s[8:11], s27 offen offset:2048 lds
 mf v[172:175],a[28:31],a[56:59],v[172:175]
 mf v[168:171],a[24:27],a[56:59],v[168:171]
 mf v[152:155],a[24:27],a[52:55],v[152:155]
 mf v[156:159],a[28:31],a[52:55],v[156:159]
 mf v[140:143],a[28:31],a[48:51],v[140:143]
 mf v[136:139],a[24:27],a[48:51],v[136:139]
 mf v[120:123],a[24:27],a[44:47],v[120:123]
 mf v[124:127],a[28:31],a[44:47],v[124:127]
 buffer_load_dwordx4 v199, s[8:11], s27 offen offset:3072 lds
 s_branch L_skip_2388
.p2align 12
L_stub_wa_2388:
 s_branch L_stub_wa_3966
L_stub_wg_2388:
 s_branch L_stub_wg_12447
 s_nop 0
 s_nop 0
L_skip_2388:
 mf v[108:111],a[28:31],a[40:43],v[108:111]
 s_add_u32 s27, s27, 1024
 mf v[104:107],a[24:27],a[40:43],v[104:107]
 mf v[88:91],a[24:27],a[36:39],v[88:91]
 mf v[92:95],a[28:31],a[36:39],v[92:95]
 mf v[76:79],a[28:31],a[32:35],v[76:79]
 s_waitcnt vmcnt(16) lgkmcnt(0)
 s_nop 0
 mf v[72:75],a[24:27],a[32:35],v[72:75]
 s_barrier
 s_nop 0
 mf a[128:131],a[64:67],a[96:99],a[128:131]
 rd a[32:35],v224,0
 mf a[160:163],a[68:71],a[96:99],a[160:163]
 tr a[0:1],v200,0
 mf a[164:167],a[68:71],a[100:103],a[164:167]
 mf a[132:135],a[64:67],a[100:103],a[132:135]
 tr a[2:3],v200,2048
 s_add_u32 m0, s29, 98304
 mf a[136:139],a[64:67],a[104:107],a[136:139]
 buffer_load_dwordx4 v192, s[4:7], s26 offen offset:0 lds
 mf a[168:171],a[68:71],a[104:107],a[168:171]
 mf a[172:175],a[68:71],a[108:111],a[172:175]
 rd a[36:39],v224,1024
 mf a[140:143],a[64:67],a[108:111],a[140:143]
 mf a[144:147],a[64:67],a[112:115],a[144:147]
 tr a[4:5],v201,0
 mf a[176:179],a[68:71],a[112:115],a[176:179]
 tr a[6:7],v201,2048
 mf a[180:183],a[68:71],a[116:119],a[180:183]
 mf a[148:151],a[64:67],a[116:119],a[148:151]
 buffer_load_dwordx4 v193, s[4:7], s26 offen offset:1024 lds
 mf a[152:155],a[64:67],a[120:123],a[152:155]
 rd a[40:43],v224,2048
 mf a[184:187],a[68:71],a[120:123],a[184:187]
 mf a[188:191],a[68:71],a[124:127],a[188:191]
 tr a[8:9],v202,0
 mf a[156:159],a[64:67],a[124:127],a[156:159]
 mf a[220:223],a[72:75],a[124:127],a[220:223]
 tr a[10:11],v202,2048
 mf a[252:255],a[76:79],a[124:127],a[252:255]
 mf a[248:251],a[76:79],a[120:123],a[248:251]
 rd a[44:47],v224,3072
 mf a[216:219],a[72:75],a[120:123],a[216:219]
 buffer_load_dwordx4 v194, s[4:7], s26 offen offset:2048 lds
 mf a[212:215],a[72:75],a[116:119],a[212:215]
 tr a[12:13],v203,0
 mf a[244:247],a[76:79],a[116:119],a[244:247]
 mf a[240:243],a[76:79],a[112:115],a[240:243]
 tr a[14:15],v203,2048
 mf a[208:211],a[72:75],a[112:115],a[208:211]
 mf a[204:207],a[72:75],a[108:111],a[204:207]
 rd a[48:51],v224,4096
 mf a[236:239],a[76:79],a[108:111],a[236:239]
 mf a[232:235],a[76:79],a[104:107],a[232:235]
 buffer_load_dwordx4 v195, s[4:7], s26 offen offset:3072 lds
 mf a[200:203],a[72:75],a[104:107],a[200:203]
 tr a[16:17],v204,0
 mf a[196:199],a[72:75],a[100:103],a[196:199]
 mf a[228:231],a[76:79],a[100:103],a[228:231]
 tr a[18:19],v204,2048
 mf a[224:227],a[76:79],a[96:99],a[224:227]
 rd a[52:55],v224,5120
 mf a[192:195],a[72:75],a[96:99],a[192:195]
 mf v[64:67],a[80:83],a[96:99],v[64:67]
 tr a[20:21],v205,0
 s_add_u32 m0, s29, 114688
 mf v[68:71],a[84:87],a[96:99],v[68:71]
 s_add_u32 s26, s26, s28
 s_nop 0
 mf v[84:87],a[84:87],a[100:103],v[84:87]
 buffer_load_dwordx4 v196, s[8:11], s27 offen offset:0 lds
 mf v[80:83],a[80:83],a[100:103],v[80:83]
 tr a[22:23],v205,2048
 mf v[96:99],a[80:83],a[104:107],v[96:99]
 mf v[100:103],a[84:87],a[104:107],v[100:103]
 rd a[56:59],v224,6144
 mf v[116:119],a[84:87],a[108:111],v[116:119]
 mf v[112:115],a[80:83],a[108:111],v[112:115]
 tr a[24:25],v206,0
 mf v[128:131],a[80:83],a[112:115],v[128:131]
 tr a[26:27],v206,2048
 mf v[132:135],a[84:87],a[112:115],v[132:135]
 mf v[148:151],a[84:87],a[116:119],v[148:151]
 buffer_load_dwordx4 v197, s[8:11], s27 offen offset:1024 lds
 mf v[144:147],a[80:83],a[116:119],v[144:147]
 rd a[60:63],v224,7168
 mf v[160:163],a[80:83],a[120:123],v[160:163]
 mf v[164:167],a[84:87],a[120:123],v[164:167]
 tr a[28:29],v207,0
 mf v[180:183],a[84:87],a[124:127],v[180:183]
 mf v[176:179],a[80:83],a[124:127],v[176:179]
 tr a[30:31],v207,2048
 mf v[184:187],a[88:91],a[124:127],v[184:187]
 mf v[188:191],a[92:95],a[124:127],v[188:191]
 buffer_load_dwordx4 v198, s[8:11], s27 offen offset:2048 lds
 mf v[172:175],a[92:95],a[120:123],v[172:175]
 mf v[168:171],a[88:91],a[120:123],v[168:171]
 mf v[152:155],a[88:91],a[116:119],v[152:155]
 mf v[156:159],a[92:95],a[116:119],v[156:159]
 mf v[140:143],a[92:95],a[112:115],v[140:143]
 mf v[136:139],a[88:91],a[112:115],v[136:139]
 mf v[120:123],a[88:91],a[108:111],v[120:123]
 mf v[124:127],a[92:95],a[108:111],v[124:127]
 buffer_load_dwordx4 v199, s[8:11], s27 offen offset:3072 lds
 mf v[108:111],a[92:95],a[104:107],v[108:111]
 s_add_u32 s27, s27, 1024
 mf v[104:107],a[88:91],a[104:107],v[104:107]
 mf v[88:91],a[88:91],a[100:103],v[88:91]
 mf v[92:95],a[92:95],a[100:103],v[92:95]
 mf v[76:79],a[92:95],a[96:99],v[76:79]
 s_waitcnt vmcnt(16) lgkmcnt(0)
 s_nop 0
 mf v[72:75],a[88:91],a[96:99],v[72:75]
 s_barrier
 s_nop 0
 mf a[128:131],a[0:3],a[32:35],a[128:131]
 rd a[96:99],v224,32768
 mf a[160:163],a[4:7],a[32:35],a[160:163]
 mf a[164:167],a[4:7],a[36:39],a[164:167]
 tr a[64:65],v200,32768
 mf a[132:135],a[0:3],a[36:39],a[132:135]
 mf a[136:139],a[0:3],a[40:43],a[136:139]
 tr a[66:67],v200,34816
 mf a[168:171],a[4:7],a[40:43],a[168:171]
 mf a[172:175],a[4:7],a[44:47],a[172:175]
 rd a[100:103],v224,33792
 mf a[140:143],a[0:3],a[44:47],a[140:143]
 mf a[144:147],a[0:3],a[48:51],a[144:147]
 tr a[68:69],v201,32768
 mf a[176:179],a[4:7],a[48:51],a[176:179]
 mf a[180:183],a[4:7],a[52:55],a[180:183]
 tr a[70:71],v201,34816
 mf a[148:151],a[0:3],a[52:55],a[148:151]
 mf a[152:155],a[0:3],a[56:59],a[152:155]
 rd a[104:107],v224,34816
 mf a[184:187],a[4:7],a[56:59],a[184:187]
 mf a[188:191],a[4:7],a[60:63],a[188:191]
 tr a[72:73],v202,32768
 mf a[156:159],a[0:3],a[60:63],a[156:159]
 mf a[220:223],a[8:11],a[60:63],a[220:223]
 tr a[74:75],v202,34816
 mf a[252:255],a[12:15],a[60:63],a[252:255]
 mf a[248:251],a[12:15],a[56:59],a[248:251]
 rd a[108:111],v224,35840
 mf a[216:219],a[8:11],a[56:59],a[216:219]
 mf a[212:215],a[8:11],a[52:55],a[212:215]
 tr a[76:77],v203,32768
 mf a[244:247],a[12:15],a[52:55],a[244:247]
 mf a[240:243],a[12:15],a[48:51],a[240:243]
 tr a[78:79],v203,34816
 mf a[208:211],a[8:11],a[48:51],a[208:211]
 mf a[204:207],a[8:11],a[44:47],a[204:207]
 rd a[112:115],v224,36864
 mf a[236:239],a[12:15],a[44:47],a[236:239]
 mf a[232:235],a[12:15],a[40:43],a[232:235]
 tr a[80:81],v204,32768
 mf a[200:203],a[8:11],a[40:43],a[200:203]
 mf a[196:199],a[8:11],a[36:39],a[196:199]
 tr a[82:83],v204,34816
 mf a[228:231],a[12:15],a[36:39],a[228:231]
 mf a[224:227],a[12:15],a[32:35],a[224:227]
 rd a[116:119],v224,37888
 mf a[192:195],a[8:11],a[32:35],a[192:195]
 mf v[64:67],a[16:19],a[32:35],v[64:67]
 tr a[84:85],v205,32768
 mf v[68:71],a[20:23],a[32:35],v[68:71]
 mf v[84:87],a[20:23],a[36:39],v[84:87]
 tr a[86:87],v205,34816
 mf v[80:83],a[16:19],a[36:39],v[80:83]
 mf v[96:99],a[16:19],a[40:43],v[96:99]
 rd a[120:123],v224,38912
 mf v[100:103],a[20:23],a[40:43],v[100:103]
 mf v[116:119],a[20:23],a[44:47],v[116:119]
 tr a[88:89],v206,32768
 mf v[112:115],a[16:19],a[44:47],v[112:115]
 mf v[128:131],a[16:19],a[48:51],v[128:131]
 tr a[90:91],v206,34816
 mf v[132:135],a[20:23],a[48:51],v[132:135]
 mf v[148:151],a[20:23],a[52:55],v[148:151]
 rd a[124:127],v224,39936
 mf v[144:147],a[16:19],a[52:55],v[144:147]
 mf v[160:163],a[16:19],a[56:59],v[160:163]
 tr a[92:93],v207,32768
 mf v[164:167],a[20:23],a[56:59],v[164:167]
 mf v[180:183],a[20:23],a[60:63],v[180:183]
 tr a[94:95],v207,34816
 mf v[176:179],a[16:19],a[60:63],v[176:179]
 mf v[184:187],a[24:27],a[60:63],v[184:187]
 mf v[188:191],a[28:31],a[60:63],v[188:191]
 mf v[172:175],a[28:31],a[56:59],v[172:175]
 mf v[168:171],a[24:27],a[56:59],v[168:171]
 mf v[152:155],a[24:27],a[52:55],v[152:155]
 mf v[156:159],a[28:31],a[52:55],v[156:159]
 mf v[140:143],a[28:31],a[48:51],v[140:143]
 mf v[136:139],a[24:27],a[48:51],v[136:139]
 mf v[120:123],a[24:27],a[44:47],v[120:123]
 mf v[124:127],a[28:31],a[44:47],v[124:127]
 mf v[108:111],a[28:31],a[40:43],v[108:111]
 mf v[104:107],a[24:27],a[40:43],v[104:107]
 mf v[88:91],a[24:27],a[36:39],v[88:91]
 mf v[92:95],a[28:31],a[36:39],v[92:95]
 mf v[76:79],a[28:31],a[32:35],v[76:79]
 s_waitcnt vmcnt(8) lgkmcnt(0)
 s_nop 0
 mf v[72:75],a[24:27],a[32:35],v[72:75]
 s_barrier
 s_nop 0
 mf a[128:131],a[64:67],a[96:99],a[128:131]
 rd a[32:35],v225,0
 mf a[160:163],a[68:71],a[96:99],a[160:163]
 mf a[164:167],a[68:71],a[100:103],a[164:167]
 tr a[0:1],v208,0
 mf a[132:135],a[64:67],a[100:103],a[132:135]
 mf a[136:139],a[64:67],a[104:107],a[136:139]
 tr a[2:3],v208,2048
 mf a[168:171],a[68:71],a[104:107],a[168:171]
 mf a[172:175],a[68:71],a[108:111],a[172:175]
 rd a[36:39],v225,1024
 mf a[140:143],a[64:67],a[108:111],a[140:143]
 mf a[144:147],a[64:67],a[112:115],a[144:147]
 tr a[4:5],v209,0
 mf a[176:179],a[68:71],a[112:115],a[176:179]
 mf a[180:183],a[68:71],a[116:119],a[180:183]
 tr a[6:7],v209,2048
 mf a[148:151],a[64:67],a[116:119],a[148:151]
 mf a[152:155],a[64:67],a[120:123],a[152:155]
 rd a[40:43],v225,2048
 mf a[184:187],a[68:71],a[120:123],a[184:187]
 mf a[188:191],a[68:71],a[124:127],a[188:191]
 tr a[8:9],v210,0
 mf a[156:159],a[64:67],a[124:127],a[156:159]
 mf a[220:223],a[72:75],a[124:127],a[220:223]
 tr a[10:11],v210,2048
 mf a[252:255],a[76:79],a[124:127],a[252:255]
 mf a[248:251],a[76:79],a[120:123],a[248:251]
 rd a[44:47],v225,3072
 mf a[216:219],a[72:75],a[120:123],a[216:219]
 mf a[212:215],a[72:75],a[116:119],a[212:215]
 tr a[12:13],v211,0
 mf a[244:247],a[76:79],a[116:119],a[244:247]
 mf a[240:243],a[76:79],a[112:115],a[240:243]
 tr a[14:15],v211,2048
 mf a[208:211],a[72:75],a[112:115],a[208:211]
 mf a[204:207],a[72:75],a[108:111],a[204:207]
 rd a[48:51],v225,4096
 mf a[236:239],a[76:79],a[108:111],a[236:239]
 mf a[232:235],a[76:79],a[104:107],a[232:235]
 tr a[16:17],v212,0
 mf a[200:203],a[72:75],a[104:107],a[200:203]
 mf a[196:199],a[72:75],a[100:103],a[196:199]
 tr a[18:19],v212,2048
 mf a[228:231],a[76:79],a[100:103],a[228:231]
 mf a[224:227],a[76:79],a[96:99],a[224:227]
 rd a[52:55],v225,5120
 mf a[192:195],a[72:75],a[96:99],a[192:195]
 mf v[64:67],a[80:83],a[96:99],v[64:67]
 tr a[20:21],v213,0
 mf v[68:71],a[84:87],a[96:99],v[68:71]
 mf v[84:87],a[84:87],a[100:103],v[84:87]
 tr a[22:23],v213,2048
 mf v[80:83],a[80:83],a[100:103],v[80:83]
 mf v[96:99],a[80:83],a[104:107],v[96:99]
 rd a[56:59],v225,6144
 mf v[100:103],a[84:87],a[104:107],v[100:103]
 mf v[116:119],a[84:87],a[108:111],v[116:119]
 tr a[24:25],v214,0
 mf v[112:115],a[80:83],a[108:111],v[112:115]
 mf v[128:131],a[80:83],a[112:115],v[128:131]
 tr a[26:27],v214,2048
 mf v[132:135],a[84:87],a[112:115],v[132:135]
 mf v[148:151],a[84:87],a[116:119],v[148:151]
 rd a[60:63],v225,7168
 mf v[144:147],a[80:83],a[116:119],v[144:147]
 mf v[160:163],a[80:83],a[120:123],v[160:163]
 tr a[28:29],v215,0
 mf v[164:167],a[84:87],a[120:123],v[164:167]
 mf v[180:183],a[84:87],a[124:127],v[180:183]
 tr a[30:31],v215,2048
 mf v[176:179],a[80:83],a[124:127],v[176:179]
 mf v[184:187],a[88:91],a[124:127],v[184:187]
 mf v[188:191],a[92:95],a[124:127],v[188:191]
 mf v[172:175],a[92:95],a[120:123],v[172:175]
 mf v[168:171],a[88:91],a[120:123],v[168:171]
 mf v[152:155],a[88:91],a[116:119],v[152:155]
 mf v[156:159],a[92:95],a[116:119],v[156:159]
 mf v[140:143],a[92:95],a[112:115],v[140:143]
 mf v[136:139],a[88:91],a[112:115],v[136:139]
 mf v[120:123],a[88:91],a[108:111],v[120:123]
 mf v[124:127],a[92:95],a[108:111],v[124:127]
 mf v[108:111],a[92:95],a[104:107],v[108:111]
 mf v[104:107],a[88:91],a[104:107],v[104:107]
 mf v[88:91],a[88:91],a[100:103],v[88:91]
 mf v[92:95],a[92:95],a[100:103],v[92:95]
 mf v[76:79],a[92:95],a[96:99],v[76:79]
 s_waitcnt vmcnt(0) lgkmcnt(0)
 s_nop 0
 mf v[72:75],a[88:91],a[96:99],v[72:75]
 s_barrier
 s_nop 0
 mf a[128:131],a[0:3],a[32:35],a[128:131]
 rd a[96:99],v225,32768
 mf a[160:163],a[4:7],a[32:35],a[160:163]
 mf a[164:167],a[4:7],a[36:39],a[164:167]
 tr a[64:65],v208,32768
 mf a[132:135],a[0:3],a[36:39],a[132:135]
 mf a[136:139],a[0:3],a[40:43],a[136:139]
 tr a[66:67],v208,34816
 mf a[168:171],a[4:7],a[40:43],a[168:171]
 mf a[172:175],a[4:7],a[44:47],a[172:175]
 rd a[100:103],v225,33792
 mf a[140:143],a[0:3],a[44:47],a[140:143]
 mf a[144:147],a[0:3],a[48:51],a[144:147]
 tr a[68:69],v209,32768
 mf a[176:179],a[4:7],a[48:51],a[176:179]
 mf a[180:183],a[4:7],a[52:55],a[180:183]
 tr a[70:71],v209,34816
 mf a[148:151],a[0:3],a[52:55],a[148:151]
 mf a[152:155],a[0:3],a[56:59],a[152:155]
 rd a[104:107],v225,34816
 mf a[184:187],a[4:7],a[56:59],a[184:187]
 mf a[188:191],a[4:7],a[60:63],a[188:191]
 tr a[72:73],v210,32768
 mf a[156:159],a[0:3],a[60:63],a[156:159]
 mf a[220:223],a[8:11],a[60:63],a[220:223]
 tr a[74:75],v210,34816
 mf a[252:255],a[12:15],a[60:63],a[252:255]
 mf a[248:251],a[12:15],a[56:59],a[248:251]
 rd a[108:111],v225,35840
 mf a[216:219],a[8:11],a[56:59],a[216:219]
 mf a[212:215],a[8:11],a[52:55],a[212:215]
 tr a[76:77],v211,32768
 mf a[244:247],a[12:15],a[52:55],a[244:247]
 mf a[240:243],a[12:15],a[48:51],a[240:243]
 tr a[78:79],v211,34816
 mf a[208:211],a[8:11],a[48:51],a[208:211]
 mf a[204:207],a[8:11],a[44:47],a[204:207]
 rd a[112:115],v225,36864
 mf a[236:239],a[12:15],a[44:47],a[236:239]
 mf a[232:235],a[12:15],a[40:43],a[232:235]
 tr a[80:81],v212,32768
 mf a[200:203],a[8:11],a[40:43],a[200:203]
 mf a[196:199],a[8:11],a[36:39],a[196:199]
 tr a[82:83],v212,34816
 mf a[228:231],a[12:15],a[36:39],a[228:231]
 mf a[224:227],a[12:15],a[32:35],a[224:227]
 rd a[116:119],v225,37888
 mf a[192:195],a[8:11],a[32:35],a[192:195]
 mf v[64:67],a[16:19],a[32:35],v[64:67]
 tr a[84:85],v213,32768
 mf v[68:71],a[20:23],a[32:35],v[68:71]
 mf v[84:87],a[20:23],a[36:39],v[84:87]
 tr a[86:87],v213,34816
 mf v[80:83],a[16:19],a[36:39],v[80:83]
 mf v[96:99],a[16:19],a[40:43],v[96:99]
 rd a[120:123],v225,38912
 mf v[100:103],a[20:23],a[40:43],v[100:103]
 mf v[116:119],a[20:23],a[44:47],v[116:119]
 tr a[88:89],v214,32768
 mf v[112:115],a[16:19],a[44:47],v[112:115]
 mf v[128:131],a[16:19],a[48:51],v[128:131]
 tr a[90:91],v214,34816
 mf v[132:135],a[20:23],a[48:51],v[132:135]
 mf v[148:151],a[20:23],a[52:55],v[148:151]
 rd a[124:127],v225,39936
 mf v[144:147],a[16:19],a[52:55],v[144:147]
 mf v[160:163],a[16:19],a[56:59],v[160:163]
 tr a[92:93],v215,32768
 mf v[164:167],a[20:23],a[56:59],v[164:167]
 mf v[180:183],a[20:23],a[60:63],v[180:183]
 tr a[94:95],v215,34816
 mf v[176:179],a[16:19],a[60:63],v[176:179]
 mf v[184:187],a[24:27],a[60:63],v[184:187]
 mf v[188:191],a[28:31],a[60:63],v[188:191]
 mf v[172:175],a[28:31],a[56:59],v[172:175]
 mf v[168:171],a[24:27],a[56:59],v[168:171]
 mf v[152:155],a[24:27],a[52:55],v[152:155]
 mf v[156:159],a[28:31],a[52:55],v[156:159]
 mf v[140:143],a[28:31],a[48:51],v[140:143]
 mf v[136:139],a[24:27],a[48:51],v[136:139]
 mf v[120:123],a[24:27],a[44:47],v[120:123]
 mf v[124:127],a[28:31],a[44:47],v[124:127]
 mf v[108:111],a[28:31],a[40:43],v[108:111]
 mf v[104:107],a[24:27],a[40:43],v[104:107]
 mf v[88:91],a[24:27],a[36:39],v[88:91]
 mf v[92:95],a[28:31],a[36:39],v[92:95]
 mf v[76:79],a[28:31],a[32:35],v[76:79]
 s_waitcnt lgkmcnt(0)
 s_nop 0
 mf v[72:75],a[24:27],a[32:35],v[72:75]
 s_cmp_lg_u32 s38, 0
 s_cbranch_scc1 L_gm
 s_barrier
 s_nop 0
 mf a[128:131],a[64:67],a[96:99],a[128:131]
 s_mov_b32 s4, s58
 s_mov_b32 s5, s59
 s_mov_b32 s6, 0x200000
 mf a[160:163],a[68:71],a[96:99],a[160:163]
 s_mov_b32 s7, 0x20000
 s_mov_b32 s8, s60
 s_nop 0
 mf a[164:167],a[68:71],a[100:103],a[164:167]
 s_mov_b32 s9, s61
 s_nop 0
 s_mov_b32 s10, 0x200000
 s_mov_b32 s11, 0x20000
 mf a[132:135],a[64:67],a[100:103],a[132:135]
 s_add_u32 s12, s32, 0x400000
 s_addc_u32 s13, s33, 0
 s_nop 0
 mf a[136:139],a[64:67],a[104:107],a[136:139]
 s_mov_b32 s14, 0x1000000
 s_mov_b32 s15, 0x20000
 s_mov_b64 s[50:51], 0
 s_nop 0
 mf a[168:171],a[68:71],a[104:107],a[168:171]
 s_mov_b32 s54, 0x3e0293ee
 s_mov_b32 s55, s54
 s_nop 0
 mf a[172:175],a[68:71],a[108:111],a[172:175]
 s_add_u32 m0, s29, 0
 s_add_u32 s26, s34, 0
 mf a[140:143],a[64:67],a[108:111],a[140:143]
 buffer_load_dwordx4 v8, s[4:7], s26 offen offset:0 lds
 mf a[144:147],a[64:67],a[112:115],a[144:147]
 buffer_load_dwordx4 v9, s[4:7], s26 offen offset:1024 lds
 mf a[176:179],a[68:71],a[112:115],a[176:179]
 mf a[180:183],a[68:71],a[116:119],a[180:183]
 mf a[148:151],a[64:67],a[116:119],a[148:151]
 mf a[152:155],a[64:67],a[120:123],a[152:155]
 mf a[184:187],a[68:71],a[120:123],a[184:187]
 buffer_load_dwordx4 v10, s[4:7], s26 offen offset:2048 lds
 mf a[188:191],a[68:71],a[124:127],a[188:191]
 mf a[156:159],a[64:67],a[124:127],a[156:159]
 mf a[220:223],a[72:75],a[124:127],a[220:223]
 mf a[252:255],a[76:79],a[124:127],a[252:255]
 mf a[248:251],a[76:79],a[120:123],a[248:251]
 buffer_load_dwordx4 v11, s[4:7], s26 offen offset:3072 lds
 mf a[216:219],a[72:75],a[120:123],a[216:219]
 mf a[212:215],a[72:75],a[116:119],a[212:215]
 mf a[244:247],a[76:79],a[116:119],a[244:247]
 s_add_u32 m0, s29, 32768
 mf a[240:243],a[76:79],a[112:115],a[240:243]
 s_add_u32 s26, s34, 16384
 mf a[208:211],a[72:75],a[112:115],a[208:211]
 buffer_load_dwordx4 v8, s[4:7], s26 offen offset:0 lds
 mf a[204:207],a[72:75],a[108:111],a[204:207]
 mf a[236:239],a[76:79],a[108:111],a[236:239]
 mf a[232:235],a[76:79],a[104:107],a[232:235]
 mf a[200:203],a[72:75],a[104:107],a[200:203]
 mf a[196:199],a[72:75],a[100:103],a[196:199]
 buffer_load_dwordx4 v9, s[4:7], s26 offen offset:1024 lds
 mf a[228:231],a[76:79],a[100:103],a[228:231]
 mf a[224:227],a[76:79],a[96:99],a[224:227]
 mf a[192:195],a[72:75],a[96:99],a[192:195]
 mf v[64:67],a[80:83],a[96:99],v[64:67]
 mf v[68:71],a[84:87],a[96:99],v[68:71]
 buffer_load_dwordx4 v10, s[4:7], s26 offen offset:2048 lds
 mf v[84:87],a[84:87],a[100:103],v[84:87]
 mf v[80:83],a[80:83],a[100:103],v[80:83]
 mf v[96:99],a[80:83],a[104:107],v[96:99]
 mf v[100:103],a[84:87],a[104:107],v[100:103]
 mf v[116:119],a[84:87],a[108:111],v[116:119]
 buffer_load_dwordx4 v11, s[4:7], s26 offen offset:3072 lds
 mf v[112:115],a[80:83],a[108:111],v[112:115]
 mf v[128:131],a[80:83],a[112:115],v[128:131]
 mf v[132:135],a[84:87],a[112:115],v[132:135]
 s_add_u32 m0, s29, 49152
 mf v[148:151],a[84:87],a[116:119],v[148:151]
 s_add_u32 s27, s34, 0
 s_nop 0
 mf v[144:147],a[80:83],a[116:119],v[144:147]
 buffer_load_dwordx4 v12, s[8:11], s27 offen offset:0 lds
 mf v[160:163],a[80:83],a[120:123],v[160:163]
 mf v[164:167],a[84:87],a[120:123],v[164:167]
 mf v[180:183],a[84:87],a[124:127],v[180:183]
 mf v[176:179],a[80:83],a[124:127],v[176:179]
 mf v[184:187],a[88:91],a[124:127],v[184:187]
 buffer_load_dwordx4 v13, s[8:11], s27 offen offset:1024 lds
 mf v[188:191],a[92:95],a[124:127],v[188:191]
 mf v[172:175],a[92:95],a[120:123],v[172:175]
 mf v[168:171],a[88:91],a[120:123],v[168:171]
 mf v[152:155],a[88:91],a[116:119],v[152:155]
 mf v[156:159],a[92:95],a[116:119],v[156:159]
 buffer_load_dwordx4 v14, s[8:11], s27 offen offset:2048 lds
 mf v[140:143],a[92:95],a[112:115],v[140:143]
 mf v[136:139],a[88:91],a[112:115],v[136:139]
 mf v[120:123],a[88:91],a[108:111],v[120:123]
 mf v[124:127],a[92:95],a[108:111],v[124:127]
 mf v[108:111],a[92:95],a[104:107],v[108:111]
 buffer_load_dwordx4 v15, s[8:11], s27 offen offset:3072 lds
 mf v[104:107],a[88:91],a[104:107],v[104:107]
 mf v[88:91],a[88:91],a[100:103],v[88:91]
 mf v[92:95],a[92:95],a[100:103],v[92:95]
 mf v[76:79],a[92:95],a[96:99],v[76:79]
 mf v[72:75],a[88:91],a[96:99],v[72:75]
 v_xor_b32 v224, 32, v16
 v_xor_b32 v225, 32, v17
 v_xor_b32 v226, 32, v18
 v_xor_b32 v227, 32, v19
 v_xor_b32 v228, 32, v20
 v_xor_b32 v229, 32, v21
 v_xor_b32 v230, 32, v22
 v_xor_b32 v231, 32, v23
 v_pk_mul_f32 v[176:177], v[176:177], s[54:55]
 v_pk_mul_f32 v[178:179], v[178:179], s[54:55]
 v_pk_mul_f32 v[180:181], v[180:181], s[54:55]
 v_pk_mul_f32 v[182:183], v[182:183], s[54:55]
 v_cvt_pk_bf16_f32 v240, v176, v177
 v_cvt_pk_bf16_f32 v241, v178, v179
 v_cvt_pk_bf16_f32 v242, v180, v181
 v_cvt_pk_bf16_f32 v243, v182, v183
 s_add_u32 m0, s29, 65536
 v_pk_mul_f32 v[184:185], v[184:185], s[54:55]
 v_pk_mul_f32 v[186:187], v[186:187], s[54:55]
 v_pk_mul_f32 v[188:189], v[188:189], s[54:55]
 v_pk_mul_f32 v[190:191], v[190:191], s[54:55]
 v_accvgpr_write_b32 a120, v240
 v_accvgpr_write_b32 a121, v241
 v_accvgpr_write_b32 a122, v242
 v_accvgpr_write_b32 a123, v243
 v_cvt_pk_bf16_f32 v252, v184, v185
 v_cvt_pk_bf16_f32 v253, v186, v187
 v_cvt_pk_bf16_f32 v254, v188, v189
 v_cvt_pk_bf16_f32 v255, v190, v191
 s_add_u32 s26, s34, 32768
 v_pk_mul_f32 v[160:161], v[160:161], s[54:55]
 v_pk_mul_f32 v[162:163], v[162:163], s[54:55]
 v_pk_mul_f32 v[164:165], v[164:165], s[54:55]
 v_pk_mul_f32 v[166:167], v[166:167], s[54:55]
 v_accvgpr_write_b32 a124, v252
 v_accvgpr_write_b32 a125, v253
 s_branch L_skip_2922
.p2align 12
L_stub_wa_2922:
 s_branch L_stub_wa_4480
 s_nop 0
 s_nop 0
 s_nop 0
L_skip_2922:
 v_accvgpr_write_b32 a126, v254
 v_accvgpr_write_b32 a127, v255
 v_cvt_pk_bf16_f32 v240, v160, v161
 v_cvt_pk_bf16_f32 v241, v162, v163
 v_cvt_pk_bf16_f32 v242, v164, v165
 v_cvt_pk_bf16_f32 v243, v166, v167
 buffer_load_dwordx4 v8, s[4:7], s26 offen offset:0 lds
 v_pk_mul_f32 v[168:169], v[168:169], s[54:55]
 v_pk_mul_f32 v[170:171], v[170:171], s[54:55]
 v_pk_mul_f32 v[172:173], v[172:173], s[54:55]
 v_pk_mul_f32 v[174:175], v[174:175], s[54:55]
 v_accvgpr_write_b32 a104, v240
 v_accvgpr_write_b32 a105, v241
 v_accvgpr_write_b32 a106, v242
 v_accvgpr_write_b32 a107, v243
 v_cvt_pk_bf16_f32 v252, v168, v169
 v_cvt_pk_bf16_f32 v253, v170, v171
 v_cvt_pk_bf16_f32 v254, v172, v173
 v_cvt_pk_bf16_f32 v255, v174, v175
 buffer_load_dwordx4 v9, s[4:7], s26 offen offset:1024 lds
 ar v232,a128
 ar v236,a160
 ar v233,a129
 ar v237,a161
 ar v234,a130
 ar v238,a162
 ar v235,a131
 ar v239,a163
 v_pk_mul_f32 v[232:233], v[232:233], s[54:55]
 v_pk_mul_f32 v[234:235], v[234:235], s[54:55]
 v_pk_mul_f32 v[236:237], v[236:237], s[54:55]
 v_pk_mul_f32 v[238:239], v[238:239], s[54:55]
 v_accvgpr_write_b32 a108, v252
 v_accvgpr_write_b32 a109, v253
 v_accvgpr_write_b32 a110, v254
 v_accvgpr_write_b32 a111, v255
 v_cvt_pk_bf16_f32 v240, v232, v233
 v_cvt_pk_bf16_f32 v241, v234, v235
 v_cvt_pk_bf16_f32 v242, v236, v237
 v_cvt_pk_bf16_f32 v243, v238, v239
 ar v244,a192
 ar v248,a224
 ar v245,a193
 ar v249,a225
 ar v246,a194
 ar v250,a226
 ar v247,a195
 ar v251,a227
 v_pk_mul_f32 v[244:245], v[244:245], s[54:55]
 v_pk_mul_f32 v[246:247], v[246:247], s[54:55]
 v_pk_mul_f32 v[248:249], v[248:249], s[54:55]
 v_pk_mul_f32 v[250:251], v[250:251], s[54:55]
 v_accvgpr_write_b32 a0, v240
 v_accvgpr_write_b32 a1, v241
 v_accvgpr_write_b32 a2, v242
 v_accvgpr_write_b32 a3, v243
 v_cvt_pk_bf16_f32 v252, v244, v245
 v_cvt_pk_bf16_f32 v253, v246, v247
 v_cvt_pk_bf16_f32 v254, v248, v249
 v_cvt_pk_bf16_f32 v255, v250, v251
 buffer_load_dwordx4 v10, s[4:7], s26 offen offset:2048 lds
 v_pk_mul_f32 v[64:65], v[64:65], s[54:55]
 v_pk_mul_f32 v[66:67], v[66:67], s[54:55]
 v_pk_mul_f32 v[68:69], v[68:69], s[54:55]
 v_pk_mul_f32 v[70:71], v[70:71], s[54:55]
 v_accvgpr_write_b32 a4, v252
 v_accvgpr_write_b32 a5, v253
 v_accvgpr_write_b32 a6, v254
 v_accvgpr_write_b32 a7, v255
 v_cvt_pk_bf16_f32 v240, v64, v65
 v_cvt_pk_bf16_f32 v241, v66, v67
 v_cvt_pk_bf16_f32 v242, v68, v69
 v_cvt_pk_bf16_f32 v243, v70, v71
 buffer_load_dwordx4 v11, s[4:7], s26 offen offset:3072 lds
 v_pk_mul_f32 v[72:73], v[72:73], s[54:55]
 v_pk_mul_f32 v[74:75], v[74:75], s[54:55]
 v_pk_mul_f32 v[76:77], v[76:77], s[54:55]
 v_pk_mul_f32 v[78:79], v[78:79], s[54:55]
 v_accvgpr_write_b32 a8, v240
 v_accvgpr_write_b32 a9, v241
 v_accvgpr_write_b32 a10, v242
 v_accvgpr_write_b32 a11, v243
 v_cvt_pk_bf16_f32 v252, v72, v73
 v_cvt_pk_bf16_f32 v253, v74, v75
 v_cvt_pk_bf16_f32 v254, v76, v77
 v_cvt_pk_bf16_f32 v255, v78, v79
 s_add_u32 m0, s29, 81920
 ar v232,a132
 ar v236,a164
 ar v233,a133
 ar v237,a165
 ar v234,a134
 ar v238,a166
 ar v235,a135
 ar v239,a167
 v_pk_mul_f32 v[232:233], v[232:233], s[54:55]
 v_pk_mul_f32 v[234:235], v[234:235], s[54:55]
 v_pk_mul_f32 v[236:237], v[236:237], s[54:55]
 v_pk_mul_f32 v[238:239], v[238:239], s[54:55]
 v_accvgpr_write_b32 a12, v252
 v_accvgpr_write_b32 a13, v253
 v_accvgpr_write_b32 a14, v254
 v_accvgpr_write_b32 a15, v255
 v_cvt_pk_bf16_f32 v240, v232, v233
 v_cvt_pk_bf16_f32 v241, v234, v235
 v_cvt_pk_bf16_f32 v242, v236, v237
 v_cvt_pk_bf16_f32 v243, v238, v239
 s_add_u32 s27, s34, 16384
 ar v244,a196
 ar v248,a228
 ar v245,a197
 ar v249,a229
 ar v246,a198
 ar v250,a230
 ar v247,a199
 ar v251,a231
 v_pk_mul_f32 v[244:245], v[244:245], s[54:55]
 v_pk_mul_f32 v[246:247], v[246:247], s[54:55]
 v_pk_mul_f32 v[248:249], v[248:249], s[54:55]
 v_pk_mul_f32 v[250:251], v[250:251], s[54:55]
 v_accvgpr_write_b32 a16, v240
 v_accvgpr_write_b32 a17, v241
 v_accvgpr_write_b32 a18, v242
 v_accvgpr_write_b32 a19, v243
 v_cvt_pk_bf16_f32 v252, v244, v245
 v_cvt_pk_bf16_f32 v253, v246, v247
 v_cvt_pk_bf16_f32 v254, v248, v249
 v_cvt_pk_bf16_f32 v255, v250, v251
 v_pk_mul_f32 v[80:81], v[80:81], s[54:55]
 v_pk_mul_f32 v[82:83], v[82:83], s[54:55]
 v_pk_mul_f32 v[84:85], v[84:85], s[54:55]
 v_pk_mul_f32 v[86:87], v[86:87], s[54:55]
 v_accvgpr_write_b32 a20, v252
 v_accvgpr_write_b32 a21, v253
 v_accvgpr_write_b32 a22, v254
 v_accvgpr_write_b32 a23, v255
 v_cvt_pk_bf16_f32 v240, v80, v81
 v_cvt_pk_bf16_f32 v241, v82, v83
 v_cvt_pk_bf16_f32 v242, v84, v85
 v_cvt_pk_bf16_f32 v243, v86, v87
 buffer_load_dwordx4 v12, s[8:11], s27 offen offset:0 lds
 v_pk_mul_f32 v[88:89], v[88:89], s[54:55]
 v_pk_mul_f32 v[90:91], v[90:91], s[54:55]
 v_pk_mul_f32 v[92:93], v[92:93], s[54:55]
 v_pk_mul_f32 v[94:95], v[94:95], s[54:55]
 v_accvgpr_write_b32 a24, v240
 v_accvgpr_write_b32 a25, v241
 v_accvgpr_write_b32 a26, v242
 v_accvgpr_write_b32 a27, v243
 v_cvt_pk_bf16_f32 v252, v88, v89
 v_cvt_pk_bf16_f32 v253, v90, v91
 v_cvt_pk_bf16_f32 v254, v92, v93
 v_cvt_pk_bf16_f32 v255, v94, v95
 buffer_load_dwordx4 v13, s[8:11], s27 offen offset:1024 lds
 ar v232,a136
 ar v236,a168
 ar v233,a137
 ar v237,a169
 ar v234,a138
 ar v238,a170
 ar v235,a139
 ar v239,a171
 v_pk_mul_f32 v[232:233], v[232:233], s[54:55]
 v_pk_mul_f32 v[234:235], v[234:235], s[54:55]
 v_pk_mul_f32 v[236:237], v[236:237], s[54:55]
 v_pk_mul_f32 v[238:239], v[238:239], s[54:55]
 v_accvgpr_write_b32 a28, v252
 v_accvgpr_write_b32 a29, v253
 v_accvgpr_write_b32 a30, v254
 v_accvgpr_write_b32 a31, v255
 v_cvt_pk_bf16_f32 v240, v232, v233
 v_cvt_pk_bf16_f32 v241, v234, v235
 v_cvt_pk_bf16_f32 v242, v236, v237
 v_cvt_pk_bf16_f32 v243, v238, v239
 buffer_load_dwordx4 v14, s[8:11], s27 offen offset:2048 lds
 ar v244,a200
 ar v248,a232
 ar v245,a201
 ar v249,a233
 ar v246,a202
 ar v250,a234
 ar v247,a203
 ar v251,a235
 v_pk_mul_f32 v[244:245], v[244:245], s[54:55]
 v_pk_mul_f32 v[246:247], v[246:247], s[54:55]
 v_pk_mul_f32 v[248:249], v[248:249], s[54:55]
 v_pk_mul_f32 v[250:251], v[250:251], s[54:55]
 v_accvgpr_write_b32 a32, v240
 v_accvgpr_write_b32 a33, v241
 v_accvgpr_write_b32 a34, v242
 v_accvgpr_write_b32 a35, v243
 v_cvt_pk_bf16_f32 v252, v244, v245
 v_cvt_pk_bf16_f32 v253, v246, v247
 v_cvt_pk_bf16_f32 v254, v248, v249
 v_cvt_pk_bf16_f32 v255, v250, v251
 buffer_load_dwordx4 v15, s[8:11], s27 offen offset:3072 lds
 s_waitcnt vmcnt(16)
 s_barrier
 ds_read_b64 v[160:161], v16 offset:0
 ds_read_b64 v[162:163], v224 offset:0
 v_pk_mul_f32 v[96:97], v[96:97], s[54:55]
 v_pk_mul_f32 v[98:99], v[98:99], s[54:55]
 v_pk_mul_f32 v[100:101], v[100:101], s[54:55]
 v_pk_mul_f32 v[102:103], v[102:103], s[54:55]
 v_accvgpr_write_b32 a36, v252
 v_accvgpr_write_b32 a37, v253
 v_accvgpr_write_b32 a38, v254
 v_accvgpr_write_b32 a39, v255
 v_cvt_pk_bf16_f32 v240, v96, v97
 v_cvt_pk_bf16_f32 v241, v98, v99
 v_cvt_pk_bf16_f32 v242, v100, v101
 v_cvt_pk_bf16_f32 v243, v102, v103
 ds_read_b64 v[164:165], v17 offset:0
 ds_read_b64 v[166:167], v225 offset:0
 v_pk_mul_f32 v[104:105], v[104:105], s[54:55]
 v_pk_mul_f32 v[106:107], v[106:107], s[54:55]
 v_pk_mul_f32 v[108:109], v[108:109], s[54:55]
 v_pk_mul_f32 v[110:111], v[110:111], s[54:55]
 v_accvgpr_write_b32 a40, v240
 v_accvgpr_write_b32 a41, v241
 v_accvgpr_write_b32 a42, v242
 v_accvgpr_write_b32 a43, v243
 v_cvt_pk_bf16_f32 v252, v104, v105
 v_cvt_pk_bf16_f32 v253, v106, v107
 v_cvt_pk_bf16_f32 v254, v108, v109
 v_cvt_pk_bf16_f32 v255, v110, v111
 s_add_u32 m0, s29, 98304
 ds_read_b64 v[168:169], v18 offset:0
 ds_read_b64 v[170:171], v226 offset:0
 ar v232,a140
 ar v236,a172
 ar v233,a141
 ar v237,a173
 ar v234,a142
 ar v238,a174
 ar v235,a143
 ar v239,a175
 v_pk_mul_f32 v[232:233], v[232:233], s[54:55]
 v_pk_mul_f32 v[234:235], v[234:235], s[54:55]
 v_pk_mul_f32 v[236:237], v[236:237], s[54:55]
 v_pk_mul_f32 v[238:239], v[238:239], s[54:55]
 v_accvgpr_write_b32 a44, v252
 v_accvgpr_write_b32 a45, v253
 v_accvgpr_write_b32 a46, v254
 v_accvgpr_write_b32 a47, v255
 v_cvt_pk_bf16_f32 v240, v232, v233
 v_cvt_pk_bf16_f32 v241, v234, v235
 v_cvt_pk_bf16_f32 v242, v236, v237
 v_cvt_pk_bf16_f32 v243, v238, v239
 s_add_u32 s26, s34, 49152
 ds_read_b64 v[172:173], v19 offset:0
 ds_read_b64 v[174:175], v227 offset:0
 ar v244,a204
 ar v248,a236
 ar v245,a205
 ar v249,a237
 ar v246,a206
 ar v250,a238
 ar v247,a207
 ar v251,a239
 v_pk_mul_f32 v[244:245], v[244:245], s[54:55]
 v_pk_mul_f32 v[246:247], v[246:247], s[54:55]
 v_pk_mul_f32 v[248:249], v[248:249], s[54:55]
 v_pk_mul_f32 v[250:251], v[250:251], s[54:55]
 v_accvgpr_write_b32 a48, v240
 v_accvgpr_write_b32 a49, v241
 v_accvgpr_write_b32 a50, v242
 v_accvgpr_write_b32 a51, v243
 v_cvt_pk_bf16_f32 v252, v244, v245
 v_cvt_pk_bf16_f32 v253, v246, v247
 v_cvt_pk_bf16_f32 v254, v248, v249
 v_cvt_pk_bf16_f32 v255, v250, v251
 buffer_load_dwordx4 v8, s[4:7], s26 offen offset:0 lds
 ds_read_b64 v[176:177], v16 offset:4096
 ds_read_b64 v[178:179], v224 offset:4096
 v_pk_mul_f32 v[112:113], v[112:113], s[54:55]
 v_pk_mul_f32 v[114:115], v[114:115], s[54:55]
 v_pk_mul_f32 v[116:117], v[116:117], s[54:55]
 v_pk_mul_f32 v[118:119], v[118:119], s[54:55]
 v_accvgpr_write_b32 a52, v252
 v_accvgpr_write_b32 a53, v253
 v_accvgpr_write_b32 a54, v254
 v_accvgpr_write_b32 a55, v255
 v_cvt_pk_bf16_f32 v240, v112, v113
 v_cvt_pk_bf16_f32 v241, v114, v115
 v_cvt_pk_bf16_f32 v242, v116, v117
 v_cvt_pk_bf16_f32 v243, v118, v119
 buffer_load_dwordx4 v9, s[4:7], s26 offen offset:1024 lds
 ds_read_b64 v[180:181], v17 offset:4096
 ds_read_b64 v[182:183], v225 offset:4096
 v_pk_mul_f32 v[120:121], v[120:121], s[54:55]
 v_pk_mul_f32 v[122:123], v[122:123], s[54:55]
 v_pk_mul_f32 v[124:125], v[124:125], s[54:55]
 v_pk_mul_f32 v[126:127], v[126:127], s[54:55]
 v_accvgpr_write_b32 a56, v240
 v_accvgpr_write_b32 a57, v241
 v_accvgpr_write_b32 a58, v242
 v_accvgpr_write_b32 a59, v243
 v_cvt_pk_bf16_f32 v252, v120, v121
 v_cvt_pk_bf16_f32 v253, v122, v123
 v_cvt_pk_bf16_f32 v254, v124, v125
 v_cvt_pk_bf16_f32 v255, v126, v127
 ds_read_b64 v[184:185], v18 offset:4096
 ds_read_b64 v[186:187], v226 offset:4096
 ar v232,a144
 ar v236,a176
 ar v233,a145
 ar v237,a177
 ar v234,a146
 ar v238,a178
 ar v235,a147
 ar v239,a179
 v_pk_mul_f32 v[232:233], v[232:233], s[54:55]
 v_pk_mul_f32 v[234:235], v[234:235], s[54:55]
 v_pk_mul_f32 v[236:237], v[236:237], s[54:55]
 v_pk_mul_f32 v[238:239], v[238:239], s[54:55]
 v_accvgpr_write_b32 a60, v252
 v_accvgpr_write_b32 a61, v253
 v_accvgpr_write_b32 a62, v254
 v_accvgpr_write_b32 a63, v255
 v_cvt_pk_bf16_f32 v240, v232, v233
 v_cvt_pk_bf16_f32 v241, v234, v235
 v_cvt_pk_bf16_f32 v242, v236, v237
 v_cvt_pk_bf16_f32 v243, v238, v239
 buffer_load_dwordx4 v10, s[4:7], s26 offen offset:2048 lds
 ds_read_b64 v[188:189], v19 offset:4096
 ds_read_b64 v[190:191], v227 offset:4096
 ar v244,a208
 ar v248,a240
 ar v245,a209
 ar v249,a241
 ar v246,a210
 ar v250,a242
 ar v247,a211
 ar v251,a243
 v_pk_mul_f32 v[244:245], v[244:245], s[54:55]
 v_pk_mul_f32 v[246:247], v[246:247], s[54:55]
 v_pk_mul_f32 v[248:249], v[248:249], s[54:55]
 v_pk_mul_f32 v[250:251], v[250:251], s[54:55]
 v_accvgpr_write_b32 a64, v240
 v_accvgpr_write_b32 a65, v241
 v_accvgpr_write_b32 a66, v242
 v_accvgpr_write_b32 a67, v243
 v_cvt_pk_bf16_f32 v252, v244, v245
 v_cvt_pk_bf16_f32 v253, v246, v247
 v_cvt_pk_bf16_f32 v254, v248, v249
 v_cvt_pk_bf16_f32 v255, v250, v251
 buffer_load_dwordx4 v11, s[4:7], s26 offen offset:3072 lds
 v_pk_mul_f32 v[128:129], v[128:129], s[54:55]
 v_pk_mul_f32 v[130:131], v[130:131], s[54:55]
 v_pk_mul_f32 v[132:133], v[132:133], s[54:55]
 v_pk_mul_f32 v[134:135], v[134:135], s[54:55]
 v_accvgpr_write_b32 a68, v252
 v_accvgpr_write_b32 a69, v253
 v_accvgpr_write_b32 a70, v254
 v_accvgpr_write_b32 a71, v255
 v_cvt_pk_bf16_f32 v240, v128, v129
 v_cvt_pk_bf16_f32 v241, v130, v131
 v_cvt_pk_bf16_f32 v242, v132, v133
 v_cvt_pk_bf16_f32 v243, v134, v135
 s_add_u32 m0, s29, 114688
 v_pk_mul_f32 v[136:137], v[136:137], s[54:55]
 v_pk_mul_f32 v[138:139], v[138:139], s[54:55]
 v_pk_mul_f32 v[140:141], v[140:141], s[54:55]
 v_pk_mul_f32 v[142:143], v[142:143], s[54:55]
 v_accvgpr_write_b32 a72, v240
 v_accvgpr_write_b32 a73, v241
 v_accvgpr_write_b32 a74, v242
 v_accvgpr_write_b32 a75, v243
 v_cvt_pk_bf16_f32 v252, v136, v137
 v_cvt_pk_bf16_f32 v253, v138, v139
 v_cvt_pk_bf16_f32 v254, v140, v141
 v_cvt_pk_bf16_f32 v255, v142, v143
 s_add_u32 s27, s34, 32768
 ar v232,a148
 ar v236,a180
 ar v233,a149
 ar v237,a181
 ar v234,a150
 ar v238,a182
 ar v235,a151
 ar v239,a183
 v_pk_mul_f32 v[232:233], v[232:233], s[54:55]
 v_pk_mul_f32 v[234:235], v[234:235], s[54:55]
 v_pk_mul_f32 v[236:237], v[236:237], s[54:55]
 v_pk_mul_f32 v[238:239], v[238:239], s[54:55]
 v_accvgpr_write_b32 a76, v252
 v_accvgpr_write_b32 a77, v253
 v_accvgpr_write_b32 a78, v254
 v_accvgpr_write_b32 a79, v255
 v_cvt_pk_bf16_f32 v240, v232, v233
 v_cvt_pk_bf16_f32 v241, v234, v235
 v_cvt_pk_bf16_f32 v242, v236, v237
 v_cvt_pk_bf16_f32 v243, v238, v239
 ar v244,a212
 ar v248,a244
 ar v245,a213
 ar v249,a245
 ar v246,a214
 ar v250,a246
 ar v247,a215
 ar v251,a247
 v_pk_mul_f32 v[244:245], v[244:245], s[54:55]
 v_pk_mul_f32 v[246:247], v[246:247], s[54:55]
 v_pk_mul_f32 v[248:249], v[248:249], s[54:55]
 v_pk_mul_f32 v[250:251], v[250:251], s[54:55]
 v_accvgpr_write_b32 a80, v240
 v_accvgpr_write_b32 a81, v241
 v_accvgpr_write_b32 a82, v242
 v_accvgpr_write_b32 a83, v243
 v_cvt_pk_bf16_f32 v252, v244, v245
 v_cvt_pk_bf16_f32 v253, v246, v247
 v_cvt_pk_bf16_f32 v254, v248, v249
 v_cvt_pk_bf16_f32 v255, v250, v251
 buffer_load_dwordx4 v12, s[8:11], s27 offen offset:0 lds
 v_pk_mul_f32 v[144:145], v[144:145], s[54:55]
 v_pk_mul_f32 v[146:147], v[146:147], s[54:55]
 v_pk_mul_f32 v[148:149], v[148:149], s[54:55]
 v_pk_mul_f32 v[150:151], v[150:151], s[54:55]
 v_accvgpr_write_b32 a84, v252
 v_accvgpr_write_b32 a85, v253
 v_accvgpr_write_b32 a86, v254
 v_accvgpr_write_b32 a87, v255
 v_cvt_pk_bf16_f32 v240, v144, v145
 v_cvt_pk_bf16_f32 v241, v146, v147
 v_cvt_pk_bf16_f32 v242, v148, v149
 v_cvt_pk_bf16_f32 v243, v150, v151
 buffer_load_dwordx4 v13, s[8:11], s27 offen offset:1024 lds
 v_pk_mul_f32 v[152:153], v[152:153], s[54:55]
 v_pk_mul_f32 v[154:155], v[154:155], s[54:55]
 v_pk_mul_f32 v[156:157], v[156:157], s[54:55]
 v_pk_mul_f32 v[158:159], v[158:159], s[54:55]
 v_accvgpr_write_b32 a88, v240
 v_accvgpr_write_b32 a89, v241
 v_accvgpr_write_b32 a90, v242
 v_accvgpr_write_b32 a91, v243
 v_cvt_pk_bf16_f32 v252, v152, v153
 v_cvt_pk_bf16_f32 v253, v154, v155
 v_cvt_pk_bf16_f32 v254, v156, v157
 v_cvt_pk_bf16_f32 v255, v158, v159
 buffer_load_dwordx4 v14, s[8:11], s27 offen offset:2048 lds
 ar v232,a152
 ar v236,a184
 ar v233,a153
 ar v237,a185
 ar v234,a154
 ar v238,a186
 ar v235,a155
 ar v239,a187
 v_pk_mul_f32 v[232:233], v[232:233], s[54:55]
 v_pk_mul_f32 v[234:235], v[234:235], s[54:55]
 v_pk_mul_f32 v[236:237], v[236:237], s[54:55]
 v_pk_mul_f32 v[238:239], v[238:239], s[54:55]
 v_accvgpr_write_b32 a92, v252
 v_accvgpr_write_b32 a93, v253
 v_accvgpr_write_b32 a94, v254
 v_accvgpr_write_b32 a95, v255
 v_cvt_pk_bf16_f32 v240, v232, v233
 v_cvt_pk_bf16_f32 v241, v234, v235
 v_cvt_pk_bf16_f32 v242, v236, v237
 v_cvt_pk_bf16_f32 v243, v238, v239
 buffer_load_dwordx4 v15, s[8:11], s27 offen offset:3072 lds
 ar v244,a216
 ar v248,a248
 ar v245,a217
 ar v249,a249
 ar v246,a218
 ar v250,a250
 ar v247,a219
 ar v251,a251
 v_pk_mul_f32 v[244:245], v[244:245], s[54:55]
 v_pk_mul_f32 v[246:247], v[246:247], s[54:55]
 v_pk_mul_f32 v[248:249], v[248:249], s[54:55]
 v_pk_mul_f32 v[250:251], v[250:251], s[54:55]
 v_accvgpr_write_b32 a96, v240
 v_accvgpr_write_b32 a97, v241
 v_accvgpr_write_b32 a98, v242
 v_accvgpr_write_b32 a99, v243
 v_cvt_pk_bf16_f32 v252, v244, v245
 v_cvt_pk_bf16_f32 v253, v246, v247
 v_cvt_pk_bf16_f32 v254, v248, v249
 v_cvt_pk_bf16_f32 v255, v250, v251
 ar v232,a156
 ar v236,a188
 ar v233,a157
 ar v237,a189
 ar v234,a158
 ar v238,a190
 ar v235,a159
 ar v239,a191
 v_pk_mul_f32 v[232:233], v[232:233], s[54:55]
 v_pk_mul_f32 v[234:235], v[234:235], s[54:55]
 v_pk_mul_f32 v[236:237], v[236:237], s[54:55]
 v_pk_mul_f32 v[238:239], v[238:239], s[54:55]
 v_accvgpr_write_b32 a100, v252
 v_accvgpr_write_b32 a101, v253
 v_accvgpr_write_b32 a102, v254
 v_accvgpr_write_b32 a103, v255
 v_cvt_pk_bf16_f32 v240, v232, v233
 v_cvt_pk_bf16_f32 v241, v234, v235
 v_cvt_pk_bf16_f32 v242, v236, v237
 v_cvt_pk_bf16_f32 v243, v238, v239
 ar v244,a220
 ar v248,a252
 ar v245,a221
 ar v249,a253
 ar v246,a222
 ar v250,a254
 ar v247,a223
 ar v251,a255
 s_branch L_skip_3432
.p2align 12
L_stub_wa_3432:
 s_branch L_stub_wa_4997
 s_nop 0
 s_nop 0
 s_nop 0
L_skip_3432:
 v_pk_mul_f32 v[244:245], v[244:245], s[54:55]
 v_pk_mul_f32 v[246:247], v[246:247], s[54:55]
 v_pk_mul_f32 v[248:249], v[248:249], s[54:55]
 v_pk_mul_f32 v[250:251], v[250:251], s[54:55]
 v_accvgpr_write_b32 a112, v240
 v_accvgpr_write_b32 a113, v241
 v_accvgpr_write_b32 a114, v242
 v_accvgpr_write_b32 a115, v243
 v_cvt_pk_bf16_f32 v252, v244, v245
 v_cvt_pk_bf16_f32 v253, v246, v247
 v_cvt_pk_bf16_f32 v254, v248, v249
 v_cvt_pk_bf16_f32 v255, v250, v251
 v_accvgpr_write_b32 a116, v252
 v_accvgpr_write_b32 a117, v253
 v_accvgpr_write_b32 a118, v254
 v_accvgpr_write_b32 a119, v255
 s_waitcnt lgkmcnt(14)
 s_nop 0
 mf v[64:67],v[160:163],a[0:3],0
 s_lshl_b32 s31, s23, 4
 s_add_u32 s31, s31, s24
 mf v[68:71],v[160:163],a[16:19],0
 s_lshl_b32 s31, s31, 2
 s_nop 0
 mf v[72:75],v[160:163],a[32:35],0
 mf v[76:79],v[160:163],a[48:51],0
 s_add_u32 s31, s31, s20
 s_waitcnt lgkmcnt(12)
 mf v[64:67],v[164:167],a[4:7],v[64:67]
 ds_read_b64 v[160:161], v16 offset:8192
 ds_read_b64 v[162:163], v224 offset:8192
 mf v[68:71],v[164:167],a[20:23],v[68:71]
 s_mul_i32 s31, s31, 2048
 mf v[72:75],v[164:167],a[36:39],v[72:75]
 mf v[76:79],v[164:167],a[52:55],v[76:79]
 v_lshlrev_b32 v61, 7, v1
 s_waitcnt lgkmcnt(12)
 mf v[64:67],v[168:171],a[8:11],v[64:67]
 ds_read_b64 v[164:165], v17 offset:8192
 v_add_u32_e64 v61, s31, v61
 mf v[68:71],v[168:171],a[24:27],v[68:71]
 ds_read_b64 v[166:167], v225 offset:8192
 mf v[72:75],v[168:171],a[40:43],v[72:75]
 v_cmp_gt_u32 vcc, 16, v1
 s_nop 0
 mf v[76:79],v[168:171],a[56:59],v[76:79]
 s_waitcnt lgkmcnt(12)
 s_nop 0
 mf v[64:67],v[172:175],a[12:15],v[64:67]
 ds_read_b64 v[168:169], v18 offset:8192
 v_mov_b32 v62, 0x7f000000
 mf v[68:71],v[172:175],a[28:31],v[68:71]
 ds_read_b64 v[170:171], v226 offset:8192
 mf v[72:75],v[172:175],a[44:47],v[72:75]
 s_mov_b32 s40, s64
 s_nop 0
 mf v[76:79],v[172:175],a[60:63],v[76:79]
 s_mov_b32 s41, s65
 s_waitcnt lgkmcnt(12)
 mf v[80:83],v[176:179],a[0:3],0
 ds_read_b64 v[172:173], v19 offset:8192
 ds_read_b64 v[174:175], v227 offset:8192
 mf v[84:87],v[176:179],a[16:19],0
 s_mov_b32 s42, 0x800000
 mf v[88:91],v[176:179],a[32:35],0
 mf v[92:95],v[176:179],a[48:51],0
 s_mov_b32 s43, 0x20000
 s_waitcnt lgkmcnt(12)
 s_nop 0
 mf v[80:83],v[180:183],a[4:7],v[80:83]
 ds_read_b64 v[176:177], v16 offset:12288
 ds_read_b64 v[178:179], v224 offset:12288
 mf v[84:87],v[180:183],a[20:23],v[84:87]
 v_cndmask_b32 v61, v62, v61, vcc
 s_nop 0
 mf v[88:91],v[180:183],a[36:39],v[88:91]
 mf v[92:95],v[180:183],a[52:55],v[92:95]
 s_mov_b32 s44, s74
 s_waitcnt lgkmcnt(12)
 mf v[80:83],v[184:187],a[8:11],v[80:83]
 ds_read_b64 v[180:181], v17 offset:12288
 s_mov_b32 s45, s75
 s_nop 0
 mf v[84:87],v[184:187],a[24:27],v[84:87]
 ds_read_b64 v[182:183], v225 offset:12288
 mf v[88:91],v[184:187],a[40:43],v[88:91]
 s_mov_b32 s46, 0x380000
 mf v[92:95],v[184:187],a[56:59],v[92:95]
 s_waitcnt lgkmcnt(12)
 s_nop 0
 mf v[80:83],v[188:191],a[12:15],v[80:83]
 ds_read_b64 v[184:185], v18 offset:12288
 s_mov_b32 s47, 0x20000
 mf v[84:87],v[188:191],a[28:31],v[84:87]
 ds_read_b64 v[186:187], v226 offset:12288
 mf v[88:91],v[188:191],a[44:47],v[88:91]
 mf v[92:95],v[188:191],a[60:63],v[92:95]
 ds_read_b64 v[188:189], v19 offset:12288
 ds_read_b64 v[190:191], v227 offset:12288
 s_waitcnt lgkmcnt(14)
 s_nop 0
 mf v[96:99],v[160:163],a[0:3],0
 v_exp_f32_e64 v64, v64
 mf v[100:103],v[160:163],a[16:19],0
 v_exp_f32_e64 v65, v65
 mf v[104:107],v[160:163],a[32:35],0
 v_exp_f32_e64 v66, v66
 mf v[108:111],v[160:163],a[48:51],0
 v_exp_f32 v67, v67
 s_waitcnt lgkmcnt(12)
 mf v[96:99],v[164:167],a[4:7],v[96:99]
 v_exp_f32_e64 v68, v68
 mf v[100:103],v[164:167],a[20:23],v[100:103]
 s_mov_b32 s48, 0
 s_nop 0
 v_cvt_pk_bf16_f32 v128, v64, v65
 mf v[104:107],v[164:167],a[36:39],v[104:107]
 v_exp_f32_e64 v69, v69
 mf v[108:111],v[164:167],a[52:55],v[108:111]
 v_cvt_pk_bf16_f32 v129, v66, v67
 v_exp_f32_e64 v70, v70
 s_waitcnt vmcnt(16) lgkmcnt(0)
 s_barrier
 mf v[96:99],v[168:171],a[8:11],v[96:99]
 v_exp_f32_e64 v71, v71
 mf v[100:103],v[168:171],a[24:27],v[100:103]
 v_exp_f32_e64 v72, v72
 mf v[104:107],v[168:171],a[40:43],v[104:107]
 v_cvt_pk_bf16_f32 v132, v68, v69
 v_exp_f32_e64 v73, v73
 mf v[108:111],v[168:171],a[56:59],v[108:111]
 v_cvt_pk_bf16_f32 v133, v70, v71
 v_exp_f32_e64 v74, v74
 mf v[96:99],v[172:175],a[12:15],v[96:99]
 v_exp_f32_e64 v75, v75
 mf v[100:103],v[172:175],a[28:31],v[100:103]
 v_exp_f32_e64 v76, v76
 mf v[104:107],v[172:175],a[44:47],v[104:107]
 v_cvt_pk_bf16_f32 v136, v72, v73
 v_exp_f32_e64 v77, v77
 mf v[108:111],v[172:175],a[60:63],v[108:111]
 v_cvt_pk_bf16_f32 v137, v74, v75
 v_exp_f32_e64 v78, v78
 mf v[112:115],v[176:179],a[0:3],0
 v_exp_f32_e64 v79, v79
 mf v[116:119],v[176:179],a[16:19],0
 v_exp_f32_e64 v80, v80
 mf v[120:123],v[176:179],a[32:35],0
 v_cvt_pk_bf16_f32 v140, v76, v77
 v_exp_f32_e64 v81, v81
 mf v[124:127],v[176:179],a[48:51],0
 v_cvt_pk_bf16_f32 v141, v78, v79
 v_exp_f32_e64 v82, v82
 mf v[112:115],v[180:183],a[4:7],v[112:115]
 v_exp_f32_e64 v83, v83
 mf v[116:119],v[180:183],a[20:23],v[116:119]
 v_exp_f32_e64 v84, v84
 mf v[120:123],v[180:183],a[36:39],v[120:123]
 v_cvt_pk_bf16_f32 v130, v80, v81
 v_exp_f32_e64 v85, v85
 mf v[124:127],v[180:183],a[52:55],v[124:127]
 v_cvt_pk_bf16_f32 v131, v82, v83
 v_exp_f32_e64 v86, v86
 mf v[112:115],v[184:187],a[8:11],v[112:115]
 v_exp_f32_e64 v87, v87
 mf v[116:119],v[184:187],a[24:27],v[116:119]
 v_exp_f32_e64 v88, v88
 mf v[120:123],v[184:187],a[40:43],v[120:123]
 v_cvt_pk_bf16_f32 v134, v84, v85
 v_exp_f32_e64 v89, v89
 mf v[124:127],v[184:187],a[56:59],v[124:127]
 v_cvt_pk_bf16_f32 v135, v86, v87
 v_exp_f32_e64 v90, v90
 mf v[112:115],v[188:191],a[12:15],v[112:115]
 v_exp_f32_e64 v91, v91
 mf v[116:119],v[188:191],a[28:31],v[116:119]
 v_exp_f32_e64 v92, v92
 mf v[120:123],v[188:191],a[44:47],v[120:123]
 v_cvt_pk_bf16_f32 v138, v88, v89
 v_exp_f32_e64 v93, v93
 mf v[124:127],v[188:191],a[60:63],v[124:127]
 v_cvt_pk_bf16_f32 v139, v90, v91
 v_exp_f32 v94, v94
 s_nop 0
 v_exp_f32 v95, v95
 s_nop 0
 v_cvt_pk_bf16_f32 v142, v92, v93
 v_cvt_pk_bf16_f32 v143, v94, v95
 ds_read_b64 v[160:161], v16 offset:32768
 ds_read_b64 v[162:163], v224 offset:32768
 tr v[192:193],v24,49152
 tr v[194:195],v24,53248
 ds_read_b64 v[164:165], v17 offset:32768
 ds_read_b64 v[166:167], v225 offset:32768
 tr v[196:197],v25,49152
 tr v[198:199],v25,53248
 ds_read_b64 v[168:169], v18 offset:32768
 ds_read_b64 v[170:171], v226 offset:32768
 tr v[200:201],v26,49152
 tr v[202:203],v26,53248
 ds_read_b64 v[172:173], v19 offset:32768
 ds_read_b64 v[174:175], v227 offset:32768
 tr v[204:205],v27,49152
 tr v[206:207],v27,53248
 ds_read_b64 v[176:177], v16 offset:36864
 ds_read_b64 v[178:179], v224 offset:36864
 tr v[208:209],v28,49152
 tr v[210:211],v28,53248
 ds_read_b64 v[180:181], v17 offset:36864
 ds_read_b64 v[182:183], v225 offset:36864
 tr v[212:213],v29,49152
 tr v[214:215],v29,53248
 ds_read_b64 v[184:185], v18 offset:36864
 ds_read_b64 v[186:187], v226 offset:36864
 tr v[216:217],v30,49152
 tr v[218:219],v30,53248
 ds_read_b64 v[188:189], v19 offset:36864
 ds_read_b64 v[190:191], v227 offset:36864
 tr v[220:221],v31,49152
 tr v[222:223],v31,53248
 buffer_load_dword v62, v61, s[40:43], s48 offen
 s_add_u32 m0, s29, 0
 s_nop 0
 s_add_u32 s26, s34, 65536
 buffer_load_dwordx4 v8, s[4:7], s26 offen offset:0 lds
 buffer_load_dwordx4 v9, s[4:7], s26 offen offset:1024 lds
 buffer_load_dwordx4 v10, s[4:7], s26 offen offset:2048 lds
 buffer_load_dwordx4 v11, s[4:7], s26 offen offset:3072 lds
 s_waitcnt lgkmcnt(14)
 s_nop 0
 mf v[64:67],v[160:163],a[0:3],0
 v_exp_f32_e64 v96, v96
 mf v[68:71],v[160:163],a[16:19],0
 v_exp_f32_e64 v97, v97
 mf v[72:75],v[160:163],a[32:35],0
 s_add_u32 m0, s29, 16384
 s_add_u32 s27, s34, 49152
 mf v[76:79],v[160:163],a[48:51],0
 buffer_load_dwordx4 v12, s[8:11], s27 offen offset:0 lds
 mf a[128:131],v[192:195],v[128:131],0
 v_exp_f32_e64 v98, v98
 mf a[132:135],v[192:195],v[132:135],0
 v_exp_f32_e64 v99, v99
 mf a[136:139],v[192:195],v[136:139],0
 v_exp_f32_e64 v100, v100
 mf a[140:143],v[192:195],v[140:143],0
 buffer_load_dwordx4 v13, s[8:11], s27 offen offset:1024 lds
 mf v[64:67],v[164:167],a[4:7],v[64:67]
 ds_read_b64 v[160:161], v16 offset:40960
 v_cvt_pk_bf16_f32 v144, v96, v97
 mf v[68:71],v[164:167],a[20:23],v[68:71]
 v_exp_f32_e64 v101, v101
 mf v[72:75],v[164:167],a[36:39],v[72:75]
 ds_read_b64 v[162:163], v224 offset:40960
 v_cvt_pk_bf16_f32 v145, v98, v99
 mf v[76:79],v[164:167],a[52:55],v[76:79]
 buffer_load_dwordx4 v14, s[8:11], s27 offen offset:2048 lds
 mf a[144:147],v[196:199],v[128:131],0
 v_exp_f32_e64 v102, v102
 mf a[148:151],v[196:199],v[132:135],0
 v_exp_f32_e64 v103, v103
 mf a[152:155],v[196:199],v[136:139],0
 tr v[192:193],v24,57344
 tr v[194:195],v24,61440
 mf a[156:159],v[196:199],v[140:143],0
 buffer_load_dwordx4 v15, s[8:11], s27 offen offset:3072 lds
 mf v[64:67],v[168:171],a[8:11],v[64:67]
 v_exp_f32_e64 v104, v104
 mf v[68:71],v[168:171],a[24:27],v[68:71]
 ds_read_b64 v[164:165], v17 offset:40960
 v_cvt_pk_bf16_f32 v148, v100, v101
 mf v[72:75],v[168:171],a[40:43],v[72:75]
 v_exp_f32_e64 v105, v105
 mf v[76:79],v[168:171],a[56:59],v[76:79]
 ds_read_b64 v[166:167], v225 offset:40960
 v_cvt_pk_bf16_f32 v149, v102, v103
 mf a[160:163],v[200:203],v[128:131],0
 v_exp_f32_e64 v106, v106
 mf a[164:167],v[200:203],v[132:135],0
 tr v[196:197],v25,57344
 tr v[198:199],v25,61440
 mf a[168:171],v[200:203],v[136:139],0
 v_exp_f32_e64 v107, v107
 mf a[172:175],v[200:203],v[140:143],0
 v_exp_f32_e64 v108, v108
 mf v[64:67],v[172:175],a[12:15],v[64:67]
 ds_read_b64 v[168:169], v18 offset:40960
 v_cvt_pk_bf16_f32 v152, v104, v105
 mf v[68:71],v[172:175],a[28:31],v[68:71]
 ds_read_b64 v[170:171], v226 offset:40960
 tr v[200:201],v26,57344
 mf v[72:75],v[172:175],a[44:47],v[72:75]
 v_exp_f32_e64 v109, v109
 mf v[76:79],v[172:175],a[60:63],v[76:79]
 tr v[202:203],v26,61440
 v_cvt_pk_bf16_f32 v153, v106, v107
 mf a[176:179],v[204:207],v[128:131],0
 v_exp_f32_e64 v110, v110
 mf a[180:183],v[204:207],v[132:135],0
 ds_read_b64 v[172:173], v19 offset:40960
 ds_read_b64 v[174:175], v227 offset:40960
 mf a[184:187],v[204:207],v[136:139],0
 v_exp_f32_e64 v111, v111
 mf a[188:191],v[204:207],v[140:143],0
 s_mov_b32 s48, 1048576
 mf v[44:47],v[40:43],v[128:131],0
 buffer_load_dword v62, v61, s[40:43], s48 offen
 mf v[48:51],v[40:43],v[132:135],0
 v_exp_f32_e64 v112, v112
 mf v[52:55],v[40:43],v[136:139],0
 tr v[204:205],v27,57344
 v_cvt_pk_bf16_f32 v156, v108, v109
 mf v[56:59],v[40:43],v[140:143],0
 v_exp_f32_e64 v113, v113
 mf v[80:83],v[176:179],a[0:3],0
 tr v[206:207],v27,61440
 v_cvt_pk_bf16_f32 v157, v110, v111
 mf v[84:87],v[176:179],a[16:19],0
 v_exp_f32_e64 v114, v114
 mf v[88:91],v[176:179],a[32:35],0
 mf v[92:95],v[176:179],a[48:51],0
 s_waitcnt lgkmcnt(14)
 s_nop 0
 mf a[192:195],v[208:211],v[128:131],0
 v_exp_f32_e64 v115, v115
 mf a[196:199],v[208:211],v[132:135],0
 v_exp_f32_e64 v116, v116
 mf a[200:203],v[208:211],v[136:139],0
 ds_read_b64 v[176:177], v16 offset:45056
 v_cvt_pk_bf16_f32 v146, v112, v113
 mf a[204:207],v[208:211],v[140:143],0
 v_exp_f32_e64 v117, v117
 mf v[80:83],v[180:183],a[4:7],v[80:83]
 ds_read_b64 v[178:179], v224 offset:45056
 v_cvt_pk_bf16_f32 v147, v114, v115
 mf v[84:87],v[180:183],a[20:23],v[84:87]
 v_exp_f32_e64 v118, v118
 mf v[88:91],v[180:183],a[36:39],v[88:91]
 tr v[208:209],v28,57344
 tr v[210:211],v28,61440
 mf v[92:95],v[180:183],a[52:55],v[92:95]
 v_exp_f32_e64 v119, v119
 mf a[208:211],v[212:215],v[128:131],0
 ds_read_b64 v[180:181], v17 offset:45056
 ds_read_b64 v[182:183], v225 offset:45056
 mf a[212:215],v[212:215],v[132:135],0
 v_exp_f32_e64 v120, v120
 mf a[216:219],v[212:215],v[136:139],0
 v_cvt_pk_bf16_f32 v150, v116, v117
 mf a[220:223],v[212:215],v[140:143],0
 v_exp_f32_e64 v121, v121
 mf v[80:83],v[184:187],a[8:11],v[80:83]
 tr v[212:213],v29,57344
 v_cvt_pk_bf16_f32 v151, v118, v119
 mf v[84:87],v[184:187],a[24:27],v[84:87]
 tr v[214:215],v29,61440
 mf v[88:91],v[184:187],a[40:43],v[88:91]
 v_exp_f32_e64 v122, v122
 mf v[92:95],v[184:187],a[56:59],v[92:95]
 mf a[224:227],v[216:219],v[128:131],0
 v_exp_f32_e64 v123, v123
 mf a[228:231],v[216:219],v[132:135],0
 v_exp_f32_e64 v124, v124
 mf a[232:235],v[216:219],v[136:139],0
 ds_read_b64 v[184:185], v18 offset:45056
 v_cvt_pk_bf16_f32 v154, v120, v121
 mf a[236:239],v[216:219],v[140:143],0
 ds_read_b64 v[186:187], v226 offset:45056
 mf v[80:83],v[188:191],a[12:15],v[80:83]
 v_exp_f32_e64 v125, v125
 mf v[84:87],v[188:191],a[28:31],v[84:87]
 tr v[216:217],v30,57344
 v_cvt_pk_bf16_f32 v155, v122, v123
 mf v[88:91],v[188:191],a[44:47],v[88:91]
 v_exp_f32_e64 v126, v126
 mf v[92:95],v[188:191],a[60:63],v[92:95]
 tr v[218:219],v30,61440
 mf a[240:243],v[220:223],v[128:131],0
 v_exp_f32_e64 v127, v127
 mf a[244:247],v[220:223],v[132:135],0
 ds_read_b64 v[188:189], v19 offset:45056
 v_cvt_pk_bf16_f32 v158, v124, v125
 mf a[248:251],v[220:223],v[136:139],0
 ds_read_b64 v[190:191], v227 offset:45056
 v_cvt_pk_bf16_f32 v159, v126, v127
 mf a[252:255],v[220:223],v[140:143],0
 mf v[96:99],v[160:163],a[0:3],0
 v_exp_f32_e64 v64, v64
 mf v[100:103],v[160:163],a[16:19],0
 v_exp_f32_e64 v65, v65
 mf v[104:107],v[160:163],a[32:35],0
 tr v[220:221],v31,57344
 tr v[222:223],v31,61440
 mf v[108:111],v[160:163],a[48:51],0
 s_waitcnt lgkmcnt(14)
 s_nop 0
 mf a[128:131],v[192:195],v[144:147],a[128:131]
 v_exp_f32_e64 v66, v66
 mf a[132:135],v[192:195],v[148:151],a[132:135]
 v_exp_f32_e64 v67, v67
 mf a[136:139],v[192:195],v[152:155],a[136:139]
 v_exp_f32_e64 v68, v68
 mf a[140:143],v[192:195],v[156:159],a[140:143]
 s_mov_b32 s48, 2097152
 v_cvt_pk_bf16_f32 v128, v64, v65
 mf v[96:99],v[164:167],a[4:7],v[96:99]
 buffer_load_dword v62, v61, s[40:43], s48 offen
 mf v[100:103],v[164:167],a[20:23],v[100:103]
 v_exp_f32_e64 v69, v69
 mf v[104:107],v[164:167],a[36:39],v[104:107]
 v_cvt_pk_bf16_f32 v129, v66, v67
 mf v[108:111],v[164:167],a[52:55],v[108:111]
 s_waitcnt vmcnt(19) lgkmcnt(0)
 s_barrier
 mf a[144:147],v[196:199],v[144:147],a[144:147]
 v_exp_f32_e64 v70, v70
 mf a[148:151],v[196:199],v[148:151],a[148:151]
 v_exp_f32_e64 v71, v71
 mf a[152:155],v[196:199],v[152:155],a[152:155]
 ds_read_b64 v[160:161], v20 offset:0
 ds_read_b64 v[162:163], v228 offset:0
 mf a[156:159],v[196:199],v[156:159],a[156:159]
 v_exp_f32_e64 v72, v72
 mf v[96:99],v[168:171],a[8:11],v[96:99]
 tr v[192:193],v32,16384
 v_cvt_pk_bf16_f32 v132, v68, v69
 mf v[100:103],v[168:171],a[24:27],v[100:103]
 v_exp_f32_e64 v73, v73
 mf v[104:107],v[168:171],a[40:43],v[104:107]
 tr v[194:195],v32,20480
 v_cvt_pk_bf16_f32 v133, v70, v71
 mf v[108:111],v[168:171],a[56:59],v[108:111]
 ds_read_b64 v[164:165], v21 offset:0
 ds_read_b64 v[166:167], v229 offset:0
 mf a[160:163],v[200:203],v[144:147],a[160:163]
 v_exp_f32_e64 v74, v74
 mf a[164:167],v[200:203],v[148:151],a[164:167]
 tr v[196:197],v33,16384
 tr v[198:199],v33,20480
 mf a[168:171],v[200:203],v[152:155],a[168:171]
 v_exp_f32_e64 v75, v75
 mf a[172:175],v[200:203],v[156:159],a[172:175]
 v_exp_f32_e64 v76, v76
 mf v[96:99],v[172:175],a[12:15],v[96:99]
 ds_read_b64 v[168:169], v22 offset:0
 v_cvt_pk_bf16_f32 v136, v72, v73
 mf v[100:103],v[172:175],a[28:31],v[100:103]
 ds_read_b64 v[170:171], v230 offset:0
 tr v[200:201],v34,16384
 mf v[104:107],v[172:175],a[44:47],v[104:107]
 v_exp_f32_e64 v77, v77
 mf v[108:111],v[172:175],a[60:63],v[108:111]
 tr v[202:203],v34,20480
 v_cvt_pk_bf16_f32 v137, v74, v75
 mf a[176:179],v[204:207],v[144:147],a[176:179]
 v_exp_f32_e64 v78, v78
 mf a[180:183],v[204:207],v[148:151],a[180:183]
 ds_read_b64 v[172:173], v23 offset:0
 ds_read_b64 v[174:175], v231 offset:0
 mf a[184:187],v[204:207],v[152:155],a[184:187]
 v_exp_f32_e64 v79, v79
 mf a[188:191],v[204:207],v[156:159],a[188:191]
 s_add_u32 m0, s29, 32768
 s_add_u32 s26, s34, 81920
 mf v[44:47],v[40:43],v[144:147],v[44:47]
 buffer_load_dwordx4 v8, s[4:7], s26 offen offset:0 lds
 mf v[48:51],v[40:43],v[148:151],v[48:51]
 v_exp_f32_e64 v80, v80
 mf v[52:55],v[40:43],v[152:155],v[52:55]
 tr v[204:205],v35,16384
 v_cvt_pk_bf16_f32 v140, v76, v77
 mf v[56:59],v[40:43],v[156:159],v[56:59]
 v_exp_f32_e64 v81, v81
 mf v[112:115],v[176:179],a[0:3],0
 buffer_load_dwordx4 v9, s[4:7], s26 offen offset:1024 lds
 mf v[116:119],v[176:179],a[16:19],0
 tr v[206:207],v35,20480
 v_cvt_pk_bf16_f32 v141, v78, v79
 mf v[120:123],v[176:179],a[32:35],0
 v_exp_f32_e64 v82, v82
 mf v[124:127],v[176:179],a[48:51],0
 v_exp_f32_e64 v83, v83
 mf a[192:195],v[208:211],v[144:147],a[192:195]
 buffer_load_dwordx4 v10, s[4:7], s26 offen offset:2048 lds
 mf a[196:199],v[208:211],v[148:151],a[196:199]
 v_exp_f32_e64 v84, v84
 mf a[200:203],v[208:211],v[152:155],a[200:203]
 ds_read_b64 v[176:177], v20 offset:4096
 v_cvt_pk_bf16_f32 v130, v80, v81
 mf a[204:207],v[208:211],v[156:159],a[204:207]
 v_exp_f32_e64 v85, v85
 mf v[112:115],v[180:183],a[4:7],v[112:115]
 buffer_load_dwordx4 v11, s[4:7], s26 offen offset:3072 lds
 mf v[116:119],v[180:183],a[20:23],v[116:119]
 ds_read_b64 v[178:179], v228 offset:4096
 v_cvt_pk_bf16_f32 v131, v82, v83
 mf v[120:123],v[180:183],a[36:39],v[120:123]
 v_exp_f32_e64 v86, v86
 mf v[124:127],v[180:183],a[52:55],v[124:127]
 v_exp_f32_e64 v87, v87
 mf a[208:211],v[212:215],v[144:147],a[208:211]
 tr v[208:209],v36,16384
 tr v[210:211],v36,20480
 mf a[212:215],v[212:215],v[148:151],a[212:215]
 v_exp_f32_e64 v88, v88
 mf a[216:219],v[212:215],v[152:155],a[216:219]
 ds_read_b64 v[180:181], v21 offset:4096
 v_cvt_pk_bf16_f32 v134, v84, v85
 mf a[220:223],v[212:215],v[156:159],a[220:223]
 v_exp_f32_e64 v89, v89
 mf v[112:115],v[184:187],a[8:11],v[112:115]
 ds_read_b64 v[182:183], v229 offset:4096
 v_cvt_pk_bf16_f32 v135, v86, v87
 mf v[116:119],v[184:187],a[24:27],v[116:119]
 tr v[212:213],v37,16384
 tr v[214:215],v37,20480
 mf v[120:123],v[184:187],a[40:43],v[120:123]
 v_exp_f32_e64 v90, v90
 mf v[124:127],v[184:187],a[56:59],v[124:127]
 mf a[224:227],v[216:219],v[144:147],a[224:227]
 v_exp_f32_e64 v91, v91
 mf a[228:231],v[216:219],v[148:151],a[228:231]
 v_exp_f32_e64 v92, v92
 mf a[232:235],v[216:219],v[152:155],a[232:235]
 ds_read_b64 v[184:185], v22 offset:4096
 v_cvt_pk_bf16_f32 v138, v88, v89
 mf a[236:239],v[216:219],v[156:159],a[236:239]
 ds_read_b64 v[186:187], v230 offset:4096
 mf v[112:115],v[188:191],a[12:15],v[112:115]
 v_exp_f32_e64 v93, v93
 mf v[116:119],v[188:191],a[28:31],v[116:119]
 tr v[216:217],v38,16384
 v_cvt_pk_bf16_f32 v139, v90, v91
 mf v[120:123],v[188:191],a[44:47],v[120:123]
 s_branch L_skip_3966
.p2align 12
L_stub_wa_3966:
 s_branch L_stub_wa_5512
 s_nop 0
 s_nop 0
 s_nop 0
L_skip_3966:
 v_exp_f32_e64 v94, v94
 mf v[124:127],v[188:191],a[60:63],v[124:127]
 tr v[218:219],v38,20480
 mf a[240:243],v[220:223],v[144:147],a[240:243]
 v_exp_f32_e64 v95, v95
 mf a[244:247],v[220:223],v[148:151],a[244:247]
 ds_read_b64 v[188:189], v23 offset:4096
 v_cvt_pk_bf16_f32 v142, v92, v93
 mf a[248:251],v[220:223],v[152:155],a[248:251]
 ds_read_b64 v[190:191], v231 offset:4096
 v_cvt_pk_bf16_f32 v143, v94, v95
 mf a[252:255],v[220:223],v[156:159],a[252:255]
 s_waitcnt lgkmcnt(14)
 s_nop 0
 mf v[64:67],v[160:163],a[0:3],0
 v_exp_f32_e64 v96, v96
 mf v[68:71],v[160:163],a[16:19],0
 v_exp_f32_e64 v97, v97
 mf v[72:75],v[160:163],a[32:35],0
 tr v[220:221],v39,16384
 tr v[222:223],v39,20480
 mf v[76:79],v[160:163],a[48:51],0
 v_exp_f32_e64 v98, v98
 mf a[128:131],v[192:195],v[128:131],a[128:131]
 ds_read_b64 v[160:161], v20 offset:8192
 ds_read_b64 v[162:163], v228 offset:8192
 mf a[132:135],v[192:195],v[132:135],a[132:135]
 v_exp_f32_e64 v99, v99
 mf a[136:139],v[192:195],v[136:139],a[136:139]
 v_exp_f32_e64 v100, v100
 mf a[140:143],v[192:195],v[140:143],a[140:143]
 s_add_u32 m0, s29, 49152
 v_cvt_pk_bf16_f32 v144, v96, v97
 mf v[64:67],v[164:167],a[4:7],v[64:67]
 tr v[192:193],v32,24576
 tr v[194:195],v32,28672
 mf v[68:71],v[164:167],a[20:23],v[68:71]
 v_exp_f32_e64 v101, v101
 mf v[72:75],v[164:167],a[36:39],v[72:75]
 s_add_u32 s27, s34, 65536
 v_cvt_pk_bf16_f32 v145, v98, v99
 mf v[76:79],v[164:167],a[52:55],v[76:79]
 buffer_load_dwordx4 v12, s[8:11], s27 offen offset:0 lds
 mf a[144:147],v[196:199],v[128:131],a[144:147]
 v_exp_f32_e64 v102, v102
 mf a[148:151],v[196:199],v[132:135],a[148:151]
 v_exp_f32_e64 v103, v103
 mf a[152:155],v[196:199],v[136:139],a[152:155]
 ds_read_b64 v[164:165], v21 offset:8192
 ds_read_b64 v[166:167], v229 offset:8192
 mf a[156:159],v[196:199],v[140:143],a[156:159]
 buffer_load_dwordx4 v13, s[8:11], s27 offen offset:1024 lds
 mf v[64:67],v[168:171],a[8:11],v[64:67]
 v_exp_f32_e64 v104, v104
 mf v[68:71],v[168:171],a[24:27],v[68:71]
 tr v[196:197],v33,24576
 v_cvt_pk_bf16_f32 v148, v100, v101
 mf v[72:75],v[168:171],a[40:43],v[72:75]
 v_exp_f32_e64 v105, v105
 mf v[76:79],v[168:171],a[56:59],v[76:79]
 buffer_load_dwordx4 v14, s[8:11], s27 offen offset:2048 lds
 mf a[160:163],v[200:203],v[128:131],a[160:163]
 tr v[198:199],v33,28672
 v_cvt_pk_bf16_f32 v149, v102, v103
 mf a[164:167],v[200:203],v[132:135],a[164:167]
 v_exp_f32_e64 v106, v106
 mf a[168:171],v[200:203],v[136:139],a[168:171]
 v_exp_f32_e64 v107, v107
 mf a[172:175],v[200:203],v[140:143],a[172:175]
 buffer_load_dwordx4 v15, s[8:11], s27 offen offset:3072 lds
 mf v[64:67],v[172:175],a[12:15],v[64:67]
 v_exp_f32_e64 v108, v108
 mf v[68:71],v[172:175],a[28:31],v[68:71]
 ds_read_b64 v[168:169], v22 offset:8192
 v_cvt_pk_bf16_f32 v152, v104, v105
 mf v[72:75],v[172:175],a[44:47],v[72:75]
 v_exp_f32_e64 v109, v109
 mf v[76:79],v[172:175],a[60:63],v[76:79]
 ds_read_b64 v[170:171], v230 offset:8192
 v_cvt_pk_bf16_f32 v153, v106, v107
 mf a[176:179],v[204:207],v[128:131],a[176:179]
 v_exp_f32_e64 v110, v110
 mf a[180:183],v[204:207],v[132:135],a[180:183]
 tr v[200:201],v34,24576
 tr v[202:203],v34,28672
 mf a[184:187],v[204:207],v[136:139],a[184:187]
 v_exp_f32_e64 v111, v111
 mf a[188:191],v[204:207],v[140:143],a[188:191]
 ds_read_b64 v[172:173], v23 offset:8192
 ds_read_b64 v[174:175], v231 offset:8192
 mf v[44:47],v[40:43],v[128:131],v[44:47]
 v_exp_f32_e64 v112, v112
 mf v[48:51],v[40:43],v[132:135],v[48:51]
 tr v[204:205],v35,24576
 v_cvt_pk_bf16_f32 v156, v108, v109
 mf v[52:55],v[40:43],v[136:139],v[52:55]
 v_exp_f32_e64 v113, v113
 mf v[56:59],v[40:43],v[140:143],v[56:59]
 s_waitcnt lgkmcnt(14)
 s_nop 0
 mf v[80:83],v[176:179],a[0:3],0
 tr v[206:207],v35,28672
 v_cvt_pk_bf16_f32 v157, v110, v111
 mf v[84:87],v[176:179],a[16:19],0
 v_exp_f32_e64 v114, v114
 mf v[88:91],v[176:179],a[32:35],0
 s_mov_b32 s48, 3145728
 mf v[92:95],v[176:179],a[48:51],0
 buffer_load_dword v62, v61, s[40:43], s48 offen
 mf a[192:195],v[208:211],v[128:131],a[192:195]
 v_exp_f32_e64 v115, v115
 mf a[196:199],v[208:211],v[132:135],a[196:199]
 v_exp_f32_e64 v116, v116
 mf a[200:203],v[208:211],v[136:139],a[200:203]
 ds_read_b64 v[176:177], v20 offset:12288
 v_cvt_pk_bf16_f32 v146, v112, v113
 mf a[204:207],v[208:211],v[140:143],a[204:207]
 v_exp_f32_e64 v117, v117
 mf v[80:83],v[180:183],a[4:7],v[80:83]
 ds_read_b64 v[178:179], v228 offset:12288
 v_cvt_pk_bf16_f32 v147, v114, v115
 mf v[84:87],v[180:183],a[20:23],v[84:87]
 v_exp_f32_e64 v118, v118
 mf v[88:91],v[180:183],a[36:39],v[88:91]
 tr v[208:209],v36,24576
 tr v[210:211],v36,28672
 mf v[92:95],v[180:183],a[52:55],v[92:95]
 v_exp_f32_e64 v119, v119
 mf a[208:211],v[212:215],v[128:131],a[208:211]
 ds_read_b64 v[180:181], v21 offset:12288
 ds_read_b64 v[182:183], v229 offset:12288
 mf a[212:215],v[212:215],v[132:135],a[212:215]
 v_exp_f32_e64 v120, v120
 mf a[216:219],v[212:215],v[136:139],a[216:219]
 v_cvt_pk_bf16_f32 v150, v116, v117
 mf a[220:223],v[212:215],v[140:143],a[220:223]
 v_exp_f32_e64 v121, v121
 mf v[80:83],v[184:187],a[8:11],v[80:83]
 tr v[212:213],v37,24576
 v_cvt_pk_bf16_f32 v151, v118, v119
 mf v[84:87],v[184:187],a[24:27],v[84:87]
 tr v[214:215],v37,28672
 mf v[88:91],v[184:187],a[40:43],v[88:91]
 v_exp_f32_e64 v122, v122
 mf v[92:95],v[184:187],a[56:59],v[92:95]
 mf a[224:227],v[216:219],v[128:131],a[224:227]
 v_exp_f32_e64 v123, v123
 mf a[228:231],v[216:219],v[132:135],a[228:231]
 v_exp_f32_e64 v124, v124
 mf a[232:235],v[216:219],v[136:139],a[232:235]
 ds_read_b64 v[184:185], v22 offset:12288
 v_cvt_pk_bf16_f32 v154, v120, v121
 mf a[236:239],v[216:219],v[140:143],a[236:239]
 ds_read_b64 v[186:187], v230 offset:12288
 mf v[80:83],v[188:191],a[12:15],v[80:83]
 v_exp_f32_e64 v125, v125
 mf v[84:87],v[188:191],a[28:31],v[84:87]
 tr v[216:217],v38,24576
 v_cvt_pk_bf16_f32 v155, v122, v123
 mf v[88:91],v[188:191],a[44:47],v[88:91]
 v_exp_f32_e64 v126, v126
 mf v[92:95],v[188:191],a[60:63],v[92:95]
 tr v[218:219],v38,28672
 mf a[240:243],v[220:223],v[128:131],a[240:243]
 v_exp_f32_e64 v127, v127
 mf a[244:247],v[220:223],v[132:135],a[244:247]
 ds_read_b64 v[188:189], v23 offset:12288
 v_cvt_pk_bf16_f32 v158, v124, v125
 mf a[248:251],v[220:223],v[136:139],a[248:251]
 ds_read_b64 v[190:191], v231 offset:12288
 v_cvt_pk_bf16_f32 v159, v126, v127
 mf a[252:255],v[220:223],v[140:143],a[252:255]
 s_waitcnt lgkmcnt(14)
 s_nop 0
 mf v[96:99],v[160:163],a[0:3],0
 v_exp_f32_e64 v64, v64
 mf v[100:103],v[160:163],a[16:19],0
 v_exp_f32_e64 v65, v65
 mf v[104:107],v[160:163],a[32:35],0
 tr v[220:221],v39,24576
 tr v[222:223],v39,28672
 mf v[108:111],v[160:163],a[48:51],0
 v_exp_f32_e64 v66, v66
 mf a[128:131],v[192:195],v[144:147],a[128:131]
 s_mov_b32 s48, 4194304
 mf a[132:135],v[192:195],v[148:151],a[132:135]
 buffer_load_dword v62, v61, s[40:43], s48 offen
 mf a[136:139],v[192:195],v[152:155],a[136:139]
 v_exp_f32_e64 v67, v67
 mf a[140:143],v[192:195],v[156:159],a[140:143]
 v_exp_f32_e64 v68, v68
 mf v[96:99],v[164:167],a[4:7],v[96:99]
 v_cvt_pk_bf16_f32 v128, v64, v65
 mf v[100:103],v[164:167],a[20:23],v[100:103]
 v_exp_f32_e64 v69, v69
 mf v[104:107],v[164:167],a[36:39],v[104:107]
 v_cvt_pk_bf16_f32 v129, v66, v67
 mf v[108:111],v[164:167],a[52:55],v[108:111]
 s_cmp_eq_u32 s20, 0
 s_cbranch_scc1 L_stub_wr3_4997
 s_cmp_eq_u32 s20, 1
 s_cbranch_scc1 L_stub_wr3_5512
 s_cmp_eq_u32 s20, 2
 s_cbranch_scc1 L_stub_wr3_6027
 s_branch L_stub_wr3_6554
 s_nop 0
L_rw3:
 s_waitcnt vmcnt(21) lgkmcnt(0)
 s_barrier
 mf a[144:147],v[196:199],v[144:147],a[144:147]
 v_exp_f32_e64 v70, v70
 mf a[148:151],v[196:199],v[148:151],a[148:151]
 v_exp_f32_e64 v71, v71
 mf a[152:155],v[196:199],v[152:155],a[152:155]
 ds_read_b64 v[160:161], v20 offset:32768
 ds_read_b64 v[162:163], v228 offset:32768
 mf a[156:159],v[196:199],v[156:159],a[156:159]
 v_exp_f32_e64 v72, v72
 mf v[96:99],v[168:171],a[8:11],v[96:99]
 tr v[192:193],v32,49152
 v_cvt_pk_bf16_f32 v132, v68, v69
 mf v[100:103],v[168:171],a[24:27],v[100:103]
 v_exp_f32_e64 v73, v73
 mf v[104:107],v[168:171],a[40:43],v[104:107]
 tr v[194:195],v32,53248
 v_cvt_pk_bf16_f32 v133, v70, v71
 mf v[108:111],v[168:171],a[56:59],v[108:111]
 ds_read_b64 v[164:165], v21 offset:32768
 ds_read_b64 v[166:167], v229 offset:32768
 mf a[160:163],v[200:203],v[144:147],a[160:163]
 v_exp_f32_e64 v74, v74
 mf a[164:167],v[200:203],v[148:151],a[164:167]
 tr v[196:197],v33,49152
 tr v[198:199],v33,53248
 mf a[168:171],v[200:203],v[152:155],a[168:171]
 v_exp_f32_e64 v75, v75
 mf a[172:175],v[200:203],v[156:159],a[172:175]
 v_exp_f32_e64 v76, v76
 mf v[96:99],v[172:175],a[12:15],v[96:99]
 ds_read_b64 v[168:169], v22 offset:32768
 v_cvt_pk_bf16_f32 v136, v72, v73
 mf v[100:103],v[172:175],a[28:31],v[100:103]
 ds_read_b64 v[170:171], v230 offset:32768
 tr v[200:201],v34,49152
 mf v[104:107],v[172:175],a[44:47],v[104:107]
 v_exp_f32_e64 v77, v77
 mf v[108:111],v[172:175],a[60:63],v[108:111]
 tr v[202:203],v34,53248
 v_cvt_pk_bf16_f32 v137, v74, v75
 mf a[176:179],v[204:207],v[144:147],a[176:179]
 v_exp_f32_e64 v78, v78
 mf a[180:183],v[204:207],v[148:151],a[180:183]
 ds_read_b64 v[172:173], v23 offset:32768
 ds_read_b64 v[174:175], v231 offset:32768
 mf a[184:187],v[204:207],v[152:155],a[184:187]
 v_exp_f32_e64 v79, v79
 mf a[188:191],v[204:207],v[156:159],a[188:191]
 s_add_u32 m0, s29, 65536
 s_add_u32 s26, s34, 98304
 mf v[44:47],v[40:43],v[144:147],v[44:47]
 buffer_load_dwordx4 v8, s[4:7], s26 offen offset:0 lds
 mf v[48:51],v[40:43],v[148:151],v[48:51]
 v_exp_f32_e64 v80, v80
 mf v[52:55],v[40:43],v[152:155],v[52:55]
 tr v[204:205],v35,49152
 v_cvt_pk_bf16_f32 v140, v76, v77
 mf v[56:59],v[40:43],v[156:159],v[56:59]
 v_exp_f32_e64 v81, v81
 mf v[112:115],v[176:179],a[0:3],0
 buffer_load_dwordx4 v9, s[4:7], s26 offen offset:1024 lds
 mf v[116:119],v[176:179],a[16:19],0
 tr v[206:207],v35,53248
 v_cvt_pk_bf16_f32 v141, v78, v79
 mf v[120:123],v[176:179],a[32:35],0
 v_exp_f32_e64 v82, v82
 mf v[124:127],v[176:179],a[48:51],0
 v_exp_f32_e64 v83, v83
 mf a[192:195],v[208:211],v[144:147],a[192:195]
 buffer_load_dwordx4 v10, s[4:7], s26 offen offset:2048 lds
 mf a[196:199],v[208:211],v[148:151],a[196:199]
 v_exp_f32_e64 v84, v84
 mf a[200:203],v[208:211],v[152:155],a[200:203]
 ds_read_b64 v[176:177], v20 offset:36864
 v_cvt_pk_bf16_f32 v130, v80, v81
 mf a[204:207],v[208:211],v[156:159],a[204:207]
 v_exp_f32_e64 v85, v85
 mf v[112:115],v[180:183],a[4:7],v[112:115]
 buffer_load_dwordx4 v11, s[4:7], s26 offen offset:3072 lds
 mf v[116:119],v[180:183],a[20:23],v[116:119]
 ds_read_b64 v[178:179], v228 offset:36864
 v_cvt_pk_bf16_f32 v131, v82, v83
 mf v[120:123],v[180:183],a[36:39],v[120:123]
 v_exp_f32_e64 v86, v86
 mf v[124:127],v[180:183],a[52:55],v[124:127]
 v_exp_f32_e64 v87, v87
 mf a[208:211],v[212:215],v[144:147],a[208:211]
 tr v[208:209],v36,49152
 tr v[210:211],v36,53248
 mf a[212:215],v[212:215],v[148:151],a[212:215]
 v_exp_f32_e64 v88, v88
 mf a[216:219],v[212:215],v[152:155],a[216:219]
 ds_read_b64 v[180:181], v21 offset:36864
 v_cvt_pk_bf16_f32 v134, v84, v85
 mf a[220:223],v[212:215],v[156:159],a[220:223]
 v_exp_f32_e64 v89, v89
 mf v[112:115],v[184:187],a[8:11],v[112:115]
 ds_read_b64 v[182:183], v229 offset:36864
 v_cvt_pk_bf16_f32 v135, v86, v87
 mf v[116:119],v[184:187],a[24:27],v[116:119]
 tr v[212:213],v37,49152
 tr v[214:215],v37,53248
 mf v[120:123],v[184:187],a[40:43],v[120:123]
 v_exp_f32_e64 v90, v90
 mf v[124:127],v[184:187],a[56:59],v[124:127]
 mf a[224:227],v[216:219],v[144:147],a[224:227]
 v_exp_f32_e64 v91, v91
 mf a[228:231],v[216:219],v[148:151],a[228:231]
 v_exp_f32_e64 v92, v92
 mf a[232:235],v[216:219],v[152:155],a[232:235]
 ds_read_b64 v[184:185], v22 offset:36864
 v_cvt_pk_bf16_f32 v138, v88, v89
 mf a[236:239],v[216:219],v[156:159],a[236:239]
 ds_read_b64 v[186:187], v230 offset:36864
 mf v[112:115],v[188:191],a[12:15],v[112:115]
 v_exp_f32_e64 v93, v93
 mf v[116:119],v[188:191],a[28:31],v[116:119]
 tr v[216:217],v38,49152
 v_cvt_pk_bf16_f32 v139, v90, v91
 mf v[120:123],v[188:191],a[44:47],v[120:123]
 v_exp_f32_e64 v94, v94
 mf v[124:127],v[188:191],a[60:63],v[124:127]
 tr v[218:219],v38,53248
 mf a[240:243],v[220:223],v[144:147],a[240:243]
 v_exp_f32_e64 v95, v95
 mf a[244:247],v[220:223],v[148:151],a[244:247]
 ds_read_b64 v[188:189], v23 offset:36864
 v_cvt_pk_bf16_f32 v142, v92, v93
 mf a[248:251],v[220:223],v[152:155],a[248:251]
 ds_read_b64 v[190:191], v231 offset:36864
 v_cvt_pk_bf16_f32 v143, v94, v95
 mf a[252:255],v[220:223],v[156:159],a[252:255]
 s_waitcnt lgkmcnt(14)
 s_nop 0
 mf v[64:67],v[160:163],a[0:3],0
 v_exp_f32_e64 v96, v96
 mf v[68:71],v[160:163],a[16:19],0
 v_exp_f32_e64 v97, v97
 mf v[72:75],v[160:163],a[32:35],0
 tr v[220:221],v39,49152
 tr v[222:223],v39,53248
 mf v[76:79],v[160:163],a[48:51],0
 v_exp_f32_e64 v98, v98
 mf a[128:131],v[192:195],v[128:131],a[128:131]
 ds_read_b64 v[160:161], v20 offset:40960
 ds_read_b64 v[162:163], v228 offset:40960
 mf a[132:135],v[192:195],v[132:135],a[132:135]
 v_exp_f32_e64 v99, v99
 mf a[136:139],v[192:195],v[136:139],a[136:139]
 v_exp_f32_e64 v100, v100
 mf a[140:143],v[192:195],v[140:143],a[140:143]
 s_add_u32 m0, s29, 81920
 v_cvt_pk_bf16_f32 v144, v96, v97
 mf v[64:67],v[164:167],a[4:7],v[64:67]
 tr v[192:193],v32,57344
 tr v[194:195],v32,61440
 mf v[68:71],v[164:167],a[20:23],v[68:71]
 v_exp_f32_e64 v101, v101
 mf v[72:75],v[164:167],a[36:39],v[72:75]
 s_add_u32 s27, s34, 81920
 v_cvt_pk_bf16_f32 v145, v98, v99
 mf v[76:79],v[164:167],a[52:55],v[76:79]
 buffer_load_dwordx4 v12, s[8:11], s27 offen offset:0 lds
 mf a[144:147],v[196:199],v[128:131],a[144:147]
 v_exp_f32_e64 v102, v102
 mf a[148:151],v[196:199],v[132:135],a[148:151]
 v_exp_f32_e64 v103, v103
 mf a[152:155],v[196:199],v[136:139],a[152:155]
 ds_read_b64 v[164:165], v21 offset:40960
 ds_read_b64 v[166:167], v229 offset:40960
 mf a[156:159],v[196:199],v[140:143],a[156:159]
 buffer_load_dwordx4 v13, s[8:11], s27 offen offset:1024 lds
 mf v[64:67],v[168:171],a[8:11],v[64:67]
 v_exp_f32_e64 v104, v104
 mf v[68:71],v[168:171],a[24:27],v[68:71]
 tr v[196:197],v33,57344
 v_cvt_pk_bf16_f32 v148, v100, v101
 mf v[72:75],v[168:171],a[40:43],v[72:75]
 v_exp_f32_e64 v105, v105
 mf v[76:79],v[168:171],a[56:59],v[76:79]
 buffer_load_dwordx4 v14, s[8:11], s27 offen offset:2048 lds
 mf a[160:163],v[200:203],v[128:131],a[160:163]
 tr v[198:199],v33,61440
 v_cvt_pk_bf16_f32 v149, v102, v103
 mf a[164:167],v[200:203],v[132:135],a[164:167]
 v_exp_f32_e64 v106, v106
 mf a[168:171],v[200:203],v[136:139],a[168:171]
 v_exp_f32_e64 v107, v107
 mf a[172:175],v[200:203],v[140:143],a[172:175]
 buffer_load_dwordx4 v15, s[8:11], s27 offen offset:3072 lds
 mf v[64:67],v[172:175],a[12:15],v[64:67]
 v_exp_f32_e64 v108, v108
 mf v[68:71],v[172:175],a[28:31],v[68:71]
 ds_read_b64 v[168:169], v22 offset:40960
 v_cvt_pk_bf16_f32 v152, v104, v105
 mf v[72:75],v[172:175],a[44:47],v[72:75]
 v_exp_f32_e64 v109, v109
 mf v[76:79],v[172:175],a[60:63],v[76:79]
 ds_read_b64 v[170:171], v230 offset:40960
 v_cvt_pk_bf16_f32 v153, v106, v107
 mf a[176:179],v[204:207],v[128:131],a[176:179]
 v_exp_f32_e64 v110, v110
 mf a[180:183],v[204:207],v[132:135],a[180:183]
 tr v[200:201],v34,57344
 tr v[202:203],v34,61440
 mf a[184:187],v[204:207],v[136:139],a[184:187]
 v_exp_f32_e64 v111, v111
 mf a[188:191],v[204:207],v[140:143],a[188:191]
 ds_read_b64 v[172:173], v23 offset:40960
 ds_read_b64 v[174:175], v231 offset:40960
 mf v[44:47],v[40:43],v[128:131],v[44:47]
 v_exp_f32_e64 v112, v112
 mf v[48:51],v[40:43],v[132:135],v[48:51]
 tr v[204:205],v35,57344
 v_cvt_pk_bf16_f32 v156, v108, v109
 mf v[52:55],v[40:43],v[136:139],v[52:55]
 v_exp_f32_e64 v113, v113
 mf v[56:59],v[40:43],v[140:143],v[56:59]
 s_waitcnt lgkmcnt(14)
 s_nop 0
 mf v[80:83],v[176:179],a[0:3],0
 tr v[206:207],v35,61440
 v_cvt_pk_bf16_f32 v157, v110, v111
 mf v[84:87],v[176:179],a[16:19],0
 v_exp_f32_e64 v114, v114
 mf v[88:91],v[176:179],a[32:35],0
 s_mov_b32 s48, 5242880
 mf v[92:95],v[176:179],a[48:51],0
 buffer_load_dword v62, v61, s[40:43], s48 offen
 mf a[192:195],v[208:211],v[128:131],a[192:195]
 v_exp_f32_e64 v115, v115
 mf a[196:199],v[208:211],v[132:135],a[196:199]
 v_exp_f32_e64 v116, v116
 mf a[200:203],v[208:211],v[136:139],a[200:203]
 ds_read_b64 v[176:177], v20 offset:45056
 v_cvt_pk_bf16_f32 v146, v112, v113
 mf a[204:207],v[208:211],v[140:143],a[204:207]
 v_exp_f32_e64 v117, v117
 mf v[80:83],v[180:183],a[4:7],v[80:83]
 ds_read_b64 v[178:179], v228 offset:45056
 v_cvt_pk_bf16_f32 v147, v114, v115
 mf v[84:87],v[180:183],a[20:23],v[84:87]
 v_exp_f32_e64 v118, v118
 mf v[88:91],v[180:183],a[36:39],v[88:91]
 tr v[208:209],v36,57344
 tr v[210:211],v36,61440
 mf v[92:95],v[180:183],a[52:55],v[92:95]
 v_exp_f32_e64 v119, v119
 mf a[208:211],v[212:215],v[128:131],a[208:211]
 ds_read_b64 v[180:181], v21 offset:45056
 ds_read_b64 v[182:183], v229 offset:45056
 mf a[212:215],v[212:215],v[132:135],a[212:215]
 v_exp_f32_e64 v120, v120
 mf a[216:219],v[212:215],v[136:139],a[216:219]
 v_cvt_pk_bf16_f32 v150, v116, v117
 mf a[220:223],v[212:215],v[140:143],a[220:223]
 v_exp_f32_e64 v121, v121
 mf v[80:83],v[184:187],a[8:11],v[80:83]
 tr v[212:213],v37,57344
 v_cvt_pk_bf16_f32 v151, v118, v119
 mf v[84:87],v[184:187],a[24:27],v[84:87]
 tr v[214:215],v37,61440
 mf v[88:91],v[184:187],a[40:43],v[88:91]
 v_exp_f32_e64 v122, v122
 mf v[92:95],v[184:187],a[56:59],v[92:95]
 mf a[224:227],v[216:219],v[128:131],a[224:227]
 v_exp_f32_e64 v123, v123
 mf a[228:231],v[216:219],v[132:135],a[228:231]
 v_exp_f32_e64 v124, v124
 mf a[232:235],v[216:219],v[136:139],a[232:235]
 ds_read_b64 v[184:185], v22 offset:45056
 v_cvt_pk_bf16_f32 v154, v120, v121
 mf a[236:239],v[216:219],v[140:143],a[236:239]
 ds_read_b64 v[186:187], v230 offset:45056
 mf v[80:83],v[188:191],a[12:15],v[80:83]
 v_exp_f32_e64 v125, v125
 mf v[84:87],v[188:191],a[28:31],v[84:87]
 tr v[216:217],v38,57344
 v_cvt_pk_bf16_f32 v155, v122, v123
 mf v[88:91],v[188:191],a[44:47],v[88:91]
 v_exp_f32_e64 v126, v126
 mf v[92:95],v[188:191],a[60:63],v[92:95]
 tr v[218:219],v38,61440
 mf a[240:243],v[220:223],v[128:131],a[240:243]
 v_exp_f32_e64 v127, v127
 mf a[244:247],v[220:223],v[132:135],a[244:247]
 ds_read_b64 v[188:189], v23 offset:45056
 v_cvt_pk_bf16_f32 v158, v124, v125
 mf a[248:251],v[220:223],v[136:139],a[248:251]
 ds_read_b64 v[190:191], v231 offset:45056
 v_cvt_pk_bf16_f32 v159, v126, v127
 mf a[252:255],v[220:223],v[140:143],a[252:255]
 s_waitcnt lgkmcnt(14)
 s_nop 0
 mf v[96:99],v[160:163],a[0:3],0
 v_exp_f32_e64 v64, v64
 mf v[100:103],v[160:163],a[16:19],0
 v_exp_f32_e64 v65, v65
 mf v[104:107],v[160:163],a[32:35],0
 tr v[220:221],v39,57344
 tr v[222:223],v39,61440
 mf v[108:111],v[160:163],a[48:51],0
 v_exp_f32_e64 v66, v66
 mf a[128:131],v[192:195],v[144:147],a[128:131]
 s_mov_b32 s48, 6291456
 mf a[132:135],v[192:195],v[148:151],a[132:135]
 buffer_load_dword v62, v61, s[40:43], s48 offen
 mf a[136:139],v[192:195],v[152:155],a[136:139]
 v_exp_f32_e64 v67, v67
 mf a[140:143],v[192:195],v[156:159],a[140:143]
 v_exp_f32_e64 v68, v68
 mf v[96:99],v[164:167],a[4:7],v[96:99]
 s_branch L_skip_4480
.p2align 12
L_stub_wa_4480:
 s_branch L_stub_wa_6027
 s_nop 0
 s_nop 0
 s_nop 0
L_skip_4480:
 v_cvt_pk_bf16_f32 v128, v64, v65
 mf v[100:103],v[164:167],a[20:23],v[100:103]
 v_exp_f32_e64 v69, v69
 mf v[104:107],v[164:167],a[36:39],v[104:107]
 v_cvt_pk_bf16_f32 v129, v66, v67
 mf v[108:111],v[164:167],a[52:55],v[108:111]
 s_waitcnt vmcnt(22) lgkmcnt(0)
 s_barrier
 mf a[144:147],v[196:199],v[144:147],a[144:147]
 v_exp_f32_e64 v70, v70
 mf a[148:151],v[196:199],v[148:151],a[148:151]
 v_exp_f32_e64 v71, v71
 mf a[152:155],v[196:199],v[152:155],a[152:155]
 ds_read_b64 v[160:161], v16 offset:0
 ds_read_b64 v[162:163], v224 offset:0
 mf a[156:159],v[196:199],v[156:159],a[156:159]
 v_exp_f32_e64 v72, v72
 mf v[96:99],v[168:171],a[8:11],v[96:99]
 tr v[192:193],v24,16384
 v_cvt_pk_bf16_f32 v132, v68, v69
 mf v[100:103],v[168:171],a[24:27],v[100:103]
 v_exp_f32_e64 v73, v73
 mf v[104:107],v[168:171],a[40:43],v[104:107]
 tr v[194:195],v24,20480
 v_cvt_pk_bf16_f32 v133, v70, v71
 mf v[108:111],v[168:171],a[56:59],v[108:111]
 ds_read_b64 v[164:165], v17 offset:0
 ds_read_b64 v[166:167], v225 offset:0
 mf a[160:163],v[200:203],v[144:147],a[160:163]
 v_exp_f32_e64 v74, v74
 mf a[164:167],v[200:203],v[148:151],a[164:167]
 tr v[196:197],v25,16384
 tr v[198:199],v25,20480
 mf a[168:171],v[200:203],v[152:155],a[168:171]
 v_exp_f32_e64 v75, v75
 mf a[172:175],v[200:203],v[156:159],a[172:175]
 v_exp_f32_e64 v76, v76
 mf v[96:99],v[172:175],a[12:15],v[96:99]
 ds_read_b64 v[168:169], v18 offset:0
 v_cvt_pk_bf16_f32 v136, v72, v73
 mf v[100:103],v[172:175],a[28:31],v[100:103]
 ds_read_b64 v[170:171], v226 offset:0
 tr v[200:201],v26,16384
 mf v[104:107],v[172:175],a[44:47],v[104:107]
 v_exp_f32_e64 v77, v77
 mf v[108:111],v[172:175],a[60:63],v[108:111]
 tr v[202:203],v26,20480
 v_cvt_pk_bf16_f32 v137, v74, v75
 mf a[176:179],v[204:207],v[144:147],a[176:179]
 v_exp_f32_e64 v78, v78
 mf a[180:183],v[204:207],v[148:151],a[180:183]
 ds_read_b64 v[172:173], v19 offset:0
 ds_read_b64 v[174:175], v227 offset:0
 mf a[184:187],v[204:207],v[152:155],a[184:187]
 v_exp_f32_e64 v79, v79
 mf a[188:191],v[204:207],v[156:159],a[188:191]
 s_add_u32 m0, s29, 98304
 s_add_u32 s26, s34, 114688
 mf v[44:47],v[40:43],v[144:147],v[44:47]
 buffer_load_dwordx4 v8, s[4:7], s26 offen offset:0 lds
 mf v[48:51],v[40:43],v[148:151],v[48:51]
 v_exp_f32_e64 v80, v80
 mf v[52:55],v[40:43],v[152:155],v[52:55]
 tr v[204:205],v27,16384
 v_cvt_pk_bf16_f32 v140, v76, v77
 mf v[56:59],v[40:43],v[156:159],v[56:59]
 v_exp_f32_e64 v81, v81
 mf v[112:115],v[176:179],a[0:3],0
 buffer_load_dwordx4 v9, s[4:7], s26 offen offset:1024 lds
 mf v[116:119],v[176:179],a[16:19],0
 tr v[206:207],v27,20480
 v_cvt_pk_bf16_f32 v141, v78, v79
 mf v[120:123],v[176:179],a[32:35],0
 v_exp_f32_e64 v82, v82
 mf v[124:127],v[176:179],a[48:51],0
 v_exp_f32_e64 v83, v83
 mf a[192:195],v[208:211],v[144:147],a[192:195]
 buffer_load_dwordx4 v10, s[4:7], s26 offen offset:2048 lds
 mf a[196:199],v[208:211],v[148:151],a[196:199]
 v_exp_f32_e64 v84, v84
 mf a[200:203],v[208:211],v[152:155],a[200:203]
 ds_read_b64 v[176:177], v16 offset:4096
 v_cvt_pk_bf16_f32 v130, v80, v81
 mf a[204:207],v[208:211],v[156:159],a[204:207]
 v_exp_f32_e64 v85, v85
 mf v[112:115],v[180:183],a[4:7],v[112:115]
 buffer_load_dwordx4 v11, s[4:7], s26 offen offset:3072 lds
 mf v[116:119],v[180:183],a[20:23],v[116:119]
 ds_read_b64 v[178:179], v224 offset:4096
 v_cvt_pk_bf16_f32 v131, v82, v83
 mf v[120:123],v[180:183],a[36:39],v[120:123]
 v_exp_f32_e64 v86, v86
 mf v[124:127],v[180:183],a[52:55],v[124:127]
 v_exp_f32_e64 v87, v87
 mf a[208:211],v[212:215],v[144:147],a[208:211]
 tr v[208:209],v28,16384
 tr v[210:211],v28,20480
 mf a[212:215],v[212:215],v[148:151],a[212:215]
 v_exp_f32_e64 v88, v88
 mf a[216:219],v[212:215],v[152:155],a[216:219]
 ds_read_b64 v[180:181], v17 offset:4096
 v_cvt_pk_bf16_f32 v134, v84, v85
 mf a[220:223],v[212:215],v[156:159],a[220:223]
 v_exp_f32_e64 v89, v89
 mf v[112:115],v[184:187],a[8:11],v[112:115]
 ds_read_b64 v[182:183], v225 offset:4096
 v_cvt_pk_bf16_f32 v135, v86, v87
 mf v[116:119],v[184:187],a[24:27],v[116:119]
 tr v[212:213],v29,16384
 tr v[214:215],v29,20480
 mf v[120:123],v[184:187],a[40:43],v[120:123]
 v_exp_f32_e64 v90, v90
 mf v[124:127],v[184:187],a[56:59],v[124:127]
 mf a[224:227],v[216:219],v[144:147],a[224:227]
 v_exp_f32_e64 v91, v91
 mf a[228:231],v[216:219],v[148:151],a[228:231]
 v_exp_f32_e64 v92, v92
 mf a[232:235],v[216:219],v[152:155],a[232:235]
 ds_read_b64 v[184:185], v18 offset:4096
 v_cvt_pk_bf16_f32 v138, v88, v89
 mf a[236:239],v[216:219],v[156:159],a[236:239]
 ds_read_b64 v[186:187], v226 offset:4096
 mf v[112:115],v[188:191],a[12:15],v[112:115]
 v_exp_f32_e64 v93, v93
 mf v[116:119],v[188:191],a[28:31],v[116:119]
 tr v[216:217],v30,16384
 v_cvt_pk_bf16_f32 v139, v90, v91
 mf v[120:123],v[188:191],a[44:47],v[120:123]
 v_exp_f32_e64 v94, v94
 mf v[124:127],v[188:191],a[60:63],v[124:127]
 tr v[218:219],v30,20480
 mf a[240:243],v[220:223],v[144:147],a[240:243]
 v_exp_f32_e64 v95, v95
 mf a[244:247],v[220:223],v[148:151],a[244:247]
 ds_read_b64 v[188:189], v19 offset:4096
 v_cvt_pk_bf16_f32 v142, v92, v93
 mf a[248:251],v[220:223],v[152:155],a[248:251]
 ds_read_b64 v[190:191], v227 offset:4096
 v_cvt_pk_bf16_f32 v143, v94, v95
 mf a[252:255],v[220:223],v[156:159],a[252:255]
 s_waitcnt lgkmcnt(14)
 s_nop 0
 mf v[64:67],v[160:163],a[0:3],0
 v_exp_f32_e64 v96, v96
 mf v[68:71],v[160:163],a[16:19],0
 v_exp_f32_e64 v97, v97
 mf v[72:75],v[160:163],a[32:35],0
 tr v[220:221],v31,16384
 tr v[222:223],v31,20480
 mf v[76:79],v[160:163],a[48:51],0
 v_exp_f32_e64 v98, v98
 mf a[128:131],v[192:195],v[128:131],a[128:131]
 ds_read_b64 v[160:161], v16 offset:8192
 ds_read_b64 v[162:163], v224 offset:8192
 mf a[132:135],v[192:195],v[132:135],a[132:135]
 v_exp_f32_e64 v99, v99
 mf a[136:139],v[192:195],v[136:139],a[136:139]
 v_exp_f32_e64 v100, v100
 mf a[140:143],v[192:195],v[140:143],a[140:143]
 s_add_u32 m0, s29, 114688
 v_cvt_pk_bf16_f32 v144, v96, v97
 mf v[64:67],v[164:167],a[4:7],v[64:67]
 tr v[192:193],v24,24576
 tr v[194:195],v24,28672
 mf v[68:71],v[164:167],a[20:23],v[68:71]
 v_exp_f32_e64 v101, v101
 mf v[72:75],v[164:167],a[36:39],v[72:75]
 s_add_u32 s27, s34, 98304
 v_cvt_pk_bf16_f32 v145, v98, v99
 mf v[76:79],v[164:167],a[52:55],v[76:79]
 buffer_load_dwordx4 v12, s[8:11], s27 offen offset:0 lds
 mf a[144:147],v[196:199],v[128:131],a[144:147]
 v_exp_f32_e64 v102, v102
 mf a[148:151],v[196:199],v[132:135],a[148:151]
 v_exp_f32_e64 v103, v103
 mf a[152:155],v[196:199],v[136:139],a[152:155]
 ds_read_b64 v[164:165], v17 offset:8192
 ds_read_b64 v[166:167], v225 offset:8192
 mf a[156:159],v[196:199],v[140:143],a[156:159]
 buffer_load_dwordx4 v13, s[8:11], s27 offen offset:1024 lds
 mf v[64:67],v[168:171],a[8:11],v[64:67]
 v_exp_f32_e64 v104, v104
 mf v[68:71],v[168:171],a[24:27],v[68:71]
 tr v[196:197],v25,24576
 v_cvt_pk_bf16_f32 v148, v100, v101
 mf v[72:75],v[168:171],a[40:43],v[72:75]
 v_exp_f32_e64 v105, v105
 mf v[76:79],v[168:171],a[56:59],v[76:79]
 buffer_load_dwordx4 v14, s[8:11], s27 offen offset:2048 lds
 mf a[160:163],v[200:203],v[128:131],a[160:163]
 tr v[198:199],v25,28672
 v_cvt_pk_bf16_f32 v149, v102, v103
 mf a[164:167],v[200:203],v[132:135],a[164:167]
 v_exp_f32_e64 v106, v106
 mf a[168:171],v[200:203],v[136:139],a[168:171]
 v_exp_f32_e64 v107, v107
 mf a[172:175],v[200:203],v[140:143],a[172:175]
 buffer_load_dwordx4 v15, s[8:11], s27 offen offset:3072 lds
 mf v[64:67],v[172:175],a[12:15],v[64:67]
 v_exp_f32_e64 v108, v108
 mf v[68:71],v[172:175],a[28:31],v[68:71]
 ds_read_b64 v[168:169], v18 offset:8192
 v_cvt_pk_bf16_f32 v152, v104, v105
 mf v[72:75],v[172:175],a[44:47],v[72:75]
 v_exp_f32_e64 v109, v109
 mf v[76:79],v[172:175],a[60:63],v[76:79]
 ds_read_b64 v[170:171], v226 offset:8192
 v_cvt_pk_bf16_f32 v153, v106, v107
 mf a[176:179],v[204:207],v[128:131],a[176:179]
 v_exp_f32_e64 v110, v110
 mf a[180:183],v[204:207],v[132:135],a[180:183]
 tr v[200:201],v26,24576
 tr v[202:203],v26,28672
 mf a[184:187],v[204:207],v[136:139],a[184:187]
 v_exp_f32_e64 v111, v111
 mf a[188:191],v[204:207],v[140:143],a[188:191]
 ds_read_b64 v[172:173], v19 offset:8192
 ds_read_b64 v[174:175], v227 offset:8192
 mf v[44:47],v[40:43],v[128:131],v[44:47]
 v_exp_f32_e64 v112, v112
 mf v[48:51],v[40:43],v[132:135],v[48:51]
 tr v[204:205],v27,24576
 v_cvt_pk_bf16_f32 v156, v108, v109
 mf v[52:55],v[40:43],v[136:139],v[52:55]
 v_exp_f32_e64 v113, v113
 mf v[56:59],v[40:43],v[140:143],v[56:59]
 s_waitcnt lgkmcnt(14)
 s_nop 0
 mf v[80:83],v[176:179],a[0:3],0
 tr v[206:207],v27,28672
 v_cvt_pk_bf16_f32 v157, v110, v111
 mf v[84:87],v[176:179],a[16:19],0
 v_exp_f32_e64 v114, v114
 mf v[88:91],v[176:179],a[32:35],0
 s_mov_b32 s48, 7340032
 mf v[92:95],v[176:179],a[48:51],0
 buffer_load_dword v62, v61, s[40:43], s48 offen
 mf a[192:195],v[208:211],v[128:131],a[192:195]
 v_exp_f32_e64 v115, v115
 mf a[196:199],v[208:211],v[132:135],a[196:199]
 v_exp_f32_e64 v116, v116
 mf a[200:203],v[208:211],v[136:139],a[200:203]
 ds_read_b64 v[176:177], v16 offset:12288
 v_cvt_pk_bf16_f32 v146, v112, v113
 mf a[204:207],v[208:211],v[140:143],a[204:207]
 v_exp_f32_e64 v117, v117
 mf v[80:83],v[180:183],a[4:7],v[80:83]
 ds_read_b64 v[178:179], v224 offset:12288
 v_cvt_pk_bf16_f32 v147, v114, v115
 mf v[84:87],v[180:183],a[20:23],v[84:87]
 v_exp_f32_e64 v118, v118
 mf v[88:91],v[180:183],a[36:39],v[88:91]
 tr v[208:209],v28,24576
 tr v[210:211],v28,28672
 mf v[92:95],v[180:183],a[52:55],v[92:95]
 v_exp_f32_e64 v119, v119
 mf a[208:211],v[212:215],v[128:131],a[208:211]
 ds_read_b64 v[180:181], v17 offset:12288
 ds_read_b64 v[182:183], v225 offset:12288
 mf a[212:215],v[212:215],v[132:135],a[212:215]
 v_exp_f32_e64 v120, v120
 mf a[216:219],v[212:215],v[136:139],a[216:219]
 v_cvt_pk_bf16_f32 v150, v116, v117
 mf a[220:223],v[212:215],v[140:143],a[220:223]
 v_exp_f32_e64 v121, v121
 mf v[80:83],v[184:187],a[8:11],v[80:83]
 tr v[212:213],v29,24576
 v_cvt_pk_bf16_f32 v151, v118, v119
 mf v[84:87],v[184:187],a[24:27],v[84:87]
 tr v[214:215],v29,28672
 mf v[88:91],v[184:187],a[40:43],v[88:91]
 v_exp_f32_e64 v122, v122
 mf v[92:95],v[184:187],a[56:59],v[92:95]
 mf a[224:227],v[216:219],v[128:131],a[224:227]
 v_exp_f32_e64 v123, v123
 mf a[228:231],v[216:219],v[132:135],a[228:231]
 v_exp_f32_e64 v124, v124
 mf a[232:235],v[216:219],v[136:139],a[232:235]
 ds_read_b64 v[184:185], v18 offset:12288
 v_cvt_pk_bf16_f32 v154, v120, v121
 mf a[236:239],v[216:219],v[140:143],a[236:239]
 ds_read_b64 v[186:187], v226 offset:12288
 mf v[80:83],v[188:191],a[12:15],v[80:83]
 v_exp_f32_e64 v125, v125
 mf v[84:87],v[188:191],a[28:31],v[84:87]
 tr v[216:217],v30,24576
 v_cvt_pk_bf16_f32 v155, v122, v123
 mf v[88:91],v[188:191],a[44:47],v[88:91]
 v_exp_f32_e64 v126, v126
 mf v[92:95],v[188:191],a[60:63],v[92:95]
 tr v[218:219],v30,28672
 mf a[240:243],v[220:223],v[128:131],a[240:243]
 v_exp_f32_e64 v127, v127
 mf a[244:247],v[220:223],v[132:135],a[244:247]
 ds_read_b64 v[188:189], v19 offset:12288
 v_cvt_pk_bf16_f32 v158, v124, v125
 mf a[248:251],v[220:223],v[136:139],a[248:251]
 ds_read_b64 v[190:191], v227 offset:12288
 v_cvt_pk_bf16_f32 v159, v126, v127
 mf a[252:255],v[220:223],v[140:143],a[252:255]
 s_waitcnt lgkmcnt(14)
 s_nop 0
 mf v[96:99],v[160:163],a[0:3],0
 v_exp_f32_e64 v64, v64
 mf v[100:103],v[160:163],a[16:19],0
 v_exp_f32_e64 v65, v65
 mf v[104:107],v[160:163],a[32:35],0
 tr v[220:221],v31,24576
 tr v[222:223],v31,28672
 mf v[108:111],v[160:163],a[48:51],0
 v_exp_f32_e64 v66, v66
 mf a[128:131],v[192:195],v[144:147],a[128:131]
 s_mov_b32 s48, 0
 s_nop 0
 mf a[132:135],v[192:195],v[148:151],a[132:135]
 buffer_load_dword v62, v61, s[44:47], s48 offen
 mf a[136:139],v[192:195],v[152:155],a[136:139]
 v_exp_f32_e64 v67, v67
 mf a[140:143],v[192:195],v[156:159],a[140:143]
 v_exp_f32_e64 v68, v68
 mf v[96:99],v[164:167],a[4:7],v[96:99]
 v_cvt_pk_bf16_f32 v128, v64, v65
 mf v[100:103],v[164:167],a[20:23],v[100:103]
 v_exp_f32_e64 v69, v69
 mf v[104:107],v[164:167],a[36:39],v[104:107]
 v_cvt_pk_bf16_f32 v129, v66, v67
 mf v[108:111],v[164:167],a[52:55],v[108:111]
 s_waitcnt vmcnt(22) lgkmcnt(0)
 s_barrier
 mf a[144:147],v[196:199],v[144:147],a[144:147]
 v_exp_f32_e64 v70, v70
 mf a[148:151],v[196:199],v[148:151],a[148:151]
 v_exp_f32_e64 v71, v71
 mf a[152:155],v[196:199],v[152:155],a[152:155]
 ds_read_b64 v[160:161], v16 offset:32768
 ds_read_b64 v[162:163], v224 offset:32768
 mf a[156:159],v[196:199],v[156:159],a[156:159]
 v_exp_f32_e64 v72, v72
 mf v[96:99],v[168:171],a[8:11],v[96:99]
 tr v[192:193],v24,49152
 v_cvt_pk_bf16_f32 v132, v68, v69
 mf v[100:103],v[168:171],a[24:27],v[100:103]
 v_exp_f32_e64 v73, v73
 mf v[104:107],v[168:171],a[40:43],v[104:107]
 tr v[194:195],v24,53248
 v_cvt_pk_bf16_f32 v133, v70, v71
 mf v[108:111],v[168:171],a[56:59],v[108:111]
 ds_read_b64 v[164:165], v17 offset:32768
 ds_read_b64 v[166:167], v225 offset:32768
 mf a[160:163],v[200:203],v[144:147],a[160:163]
 v_exp_f32_e64 v74, v74
 mf a[164:167],v[200:203],v[148:151],a[164:167]
 tr v[196:197],v25,49152
 tr v[198:199],v25,53248
 mf a[168:171],v[200:203],v[152:155],a[168:171]
 v_exp_f32_e64 v75, v75
 mf a[172:175],v[200:203],v[156:159],a[172:175]
 v_exp_f32_e64 v76, v76
 mf v[96:99],v[172:175],a[12:15],v[96:99]
 ds_read_b64 v[168:169], v18 offset:32768
 v_cvt_pk_bf16_f32 v136, v72, v73
 mf v[100:103],v[172:175],a[28:31],v[100:103]
 ds_read_b64 v[170:171], v226 offset:32768
 tr v[200:201],v26,49152
 mf v[104:107],v[172:175],a[44:47],v[104:107]
 v_exp_f32_e64 v77, v77
 mf v[108:111],v[172:175],a[60:63],v[108:111]
 tr v[202:203],v26,53248
 v_cvt_pk_bf16_f32 v137, v74, v75
 mf a[176:179],v[204:207],v[144:147],a[176:179]
 v_exp_f32_e64 v78, v78
 mf a[180:183],v[204:207],v[148:151],a[180:183]
 ds_read_b64 v[172:173], v19 offset:32768
 ds_read_b64 v[174:175], v227 offset:32768
 mf a[184:187],v[204:207],v[152:155],a[184:187]
 v_exp_f32_e64 v79, v79
 mf a[188:191],v[204:207],v[156:159],a[188:191]
 s_add_u32 m0, s29, 0
 s_add_u32 s26, s34, 0
 mf v[44:47],v[40:43],v[144:147],v[44:47]
 buffer_load_dwordx4 v8, s[4:7], s26 offen offset:0 lds
 mf v[48:51],v[40:43],v[148:151],v[48:51]
 v_exp_f32_e64 v80, v80
 mf v[52:55],v[40:43],v[152:155],v[52:55]
 tr v[204:205],v27,49152
 v_cvt_pk_bf16_f32 v140, v76, v77
 mf v[56:59],v[40:43],v[156:159],v[56:59]
 v_exp_f32_e64 v81, v81
 mf v[112:115],v[176:179],a[0:3],0
 buffer_load_dwordx4 v9, s[4:7], s26 offen offset:1024 lds
 mf v[116:119],v[176:179],a[16:19],0
 tr v[206:207],v27,53248
 v_cvt_pk_bf16_f32 v141, v78, v79
 mf v[120:123],v[176:179],a[32:35],0
 v_exp_f32_e64 v82, v82
 mf v[124:127],v[176:179],a[48:51],0
 v_exp_f32_e64 v83, v83
 mf a[192:195],v[208:211],v[144:147],a[192:195]
 buffer_load_dwordx4 v10, s[4:7], s26 offen offset:2048 lds
 mf a[196:199],v[208:211],v[148:151],a[196:199]
 v_exp_f32_e64 v84, v84
 mf a[200:203],v[208:211],v[152:155],a[200:203]
 ds_read_b64 v[176:177], v16 offset:36864
 v_cvt_pk_bf16_f32 v130, v80, v81
 mf a[204:207],v[208:211],v[156:159],a[204:207]
 v_exp_f32_e64 v85, v85
 mf v[112:115],v[180:183],a[4:7],v[112:115]
 buffer_load_dwordx4 v11, s[4:7], s26 offen offset:3072 lds
 mf v[116:119],v[180:183],a[20:23],v[116:119]
 ds_read_b64 v[178:179], v224 offset:36864
 v_cvt_pk_bf16_f32 v131, v82, v83
 mf v[120:123],v[180:183],a[36:39],v[120:123]
 v_exp_f32_e64 v86, v86
 mf v[124:127],v[180:183],a[52:55],v[124:127]
 v_exp_f32_e64 v87, v87
 mf a[208:211],v[212:215],v[144:147],a[208:211]
 tr v[208:209],v28,49152
 tr v[210:211],v28,53248
 mf a[212:215],v[212:215],v[148:151],a[212:215]
 v_exp_f32_e64 v88, v88
 mf a[216:219],v[212:215],v[152:155],a[216:219]
 ds_read_b64 v[180:181], v17 offset:36864
 v_cvt_pk_bf16_f32 v134, v84, v85
 mf a[220:223],v[212:215],v[156:159],a[220:223]
 v_exp_f32_e64 v89, v89
 mf v[112:115],v[184:187],a[8:11],v[112:115]
 ds_read_b64 v[182:183], v225 offset:36864
 v_cvt_pk_bf16_f32 v135, v86, v87
 mf v[116:119],v[184:187],a[24:27],v[116:119]
 tr v[212:213],v29,49152
 tr v[214:215],v29,53248
 mf v[120:123],v[184:187],a[40:43],v[120:123]
 v_exp_f32_e64 v90, v90
 mf v[124:127],v[184:187],a[56:59],v[124:127]
 mf a[224:227],v[216:219],v[144:147],a[224:227]
 v_exp_f32_e64 v91, v91
 mf a[228:231],v[216:219],v[148:151],a[228:231]
 v_exp_f32_e64 v92, v92
 mf a[232:235],v[216:219],v[152:155],a[232:235]
 ds_read_b64 v[184:185], v18 offset:36864
 v_cvt_pk_bf16_f32 v138, v88, v89
 mf a[236:239],v[216:219],v[156:159],a[236:239]
 ds_read_b64 v[186:187], v226 offset:36864
 mf v[112:115],v[188:191],a[12:15],v[112:115]
 v_exp_f32_e64 v93, v93
 mf v[116:119],v[188:191],a[28:31],v[116:119]
 tr v[216:217],v30,49152
 v_cvt_pk_bf16_f32 v139, v90, v91
 mf v[120:123],v[188:191],a[44:47],v[120:123]
 v_exp_f32_e64 v94, v94
 mf v[124:127],v[188:191],a[60:63],v[124:127]
 tr v[218:219],v30,53248
 mf a[240:243],v[220:223],v[144:147],a[240:243]
 v_exp_f32_e64 v95, v95
 mf a[244:247],v[220:223],v[148:151],a[244:247]
 ds_read_b64 v[188:189], v19 offset:36864
 v_cvt_pk_bf16_f32 v142, v92, v93
 mf a[248:251],v[220:223],v[152:155],a[248:251]
 ds_read_b64 v[190:191], v227 offset:36864
 v_cvt_pk_bf16_f32 v143, v94, v95
 mf a[252:255],v[220:223],v[156:159],a[252:255]
 s_waitcnt lgkmcnt(14)
 s_nop 0
 mf v[64:67],v[160:163],a[0:3],0
 v_exp_f32_e64 v96, v96
 mf v[68:71],v[160:163],a[16:19],0
 v_exp_f32_e64 v97, v97
 mf v[72:75],v[160:163],a[32:35],0
 tr v[220:221],v31,49152
 tr v[222:223],v31,53248
 mf v[76:79],v[160:163],a[48:51],0
 v_exp_f32_e64 v98, v98
 mf a[128:131],v[192:195],v[128:131],a[128:131]
 ds_read_b64 v[160:161], v16 offset:40960
 ds_read_b64 v[162:163], v224 offset:40960
 mf a[132:135],v[192:195],v[132:135],a[132:135]
 v_exp_f32_e64 v99, v99
 mf a[136:139],v[192:195],v[136:139],a[136:139]
 v_exp_f32_e64 v100, v100
 mf a[140:143],v[192:195],v[140:143],a[140:143]
 s_add_u32 m0, s29, 16384
 v_cvt_pk_bf16_f32 v144, v96, v97
 mf v[64:67],v[164:167],a[4:7],v[64:67]
 tr v[192:193],v24,57344
 tr v[194:195],v24,61440
 mf v[68:71],v[164:167],a[20:23],v[68:71]
 v_exp_f32_e64 v101, v101
 mf v[72:75],v[164:167],a[36:39],v[72:75]
 s_add_u32 s27, s34, 114688
 v_cvt_pk_bf16_f32 v145, v98, v99
 mf v[76:79],v[164:167],a[52:55],v[76:79]
 buffer_load_dwordx4 v12, s[8:11], s27 offen offset:0 lds
 mf a[144:147],v[196:199],v[128:131],a[144:147]
 v_exp_f32_e64 v102, v102
 mf a[148:151],v[196:199],v[132:135],a[148:151]
 v_exp_f32_e64 v103, v103
 mf a[152:155],v[196:199],v[136:139],a[152:155]
 ds_read_b64 v[164:165], v17 offset:40960
 ds_read_b64 v[166:167], v225 offset:40960
 mf a[156:159],v[196:199],v[140:143],a[156:159]
 buffer_load_dwordx4 v13, s[8:11], s27 offen offset:1024 lds
 mf v[64:67],v[168:171],a[8:11],v[64:67]
 v_exp_f32_e64 v104, v104
 mf v[68:71],v[168:171],a[24:27],v[68:71]
 tr v[196:197],v25,57344
 v_cvt_pk_bf16_f32 v148, v100, v101
 mf v[72:75],v[168:171],a[40:43],v[72:75]
 v_exp_f32_e64 v105, v105
 mf v[76:79],v[168:171],a[56:59],v[76:79]
 buffer_load_dwordx4 v14, s[8:11], s27 offen offset:2048 lds
 mf a[160:163],v[200:203],v[128:131],a[160:163]
 tr v[198:199],v25,61440
 v_cvt_pk_bf16_f32 v149, v102, v103
 mf a[164:167],v[200:203],v[132:135],a[164:167]
 v_exp_f32_e64 v106, v106
 mf a[168:171],v[200:203],v[136:139],a[168:171]
 v_exp_f32_e64 v107, v107
 s_branch L_skip_4997
.p2align 12
L_stub_wa_4997:
 s_branch L_stub_wa_6554
L_stub_wr3_4997:
 s_branch L_stub_wr3_7068
 s_nop 0
 s_nop 0
L_skip_4997:
 mf a[172:175],v[200:203],v[140:143],a[172:175]
 buffer_load_dwordx4 v15, s[8:11], s27 offen offset:3072 lds
 mf v[64:67],v[172:175],a[12:15],v[64:67]
 v_exp_f32_e64 v108, v108
 mf v[68:71],v[172:175],a[28:31],v[68:71]
 ds_read_b64 v[168:169], v18 offset:40960
 v_cvt_pk_bf16_f32 v152, v104, v105
 mf v[72:75],v[172:175],a[44:47],v[72:75]
 v_exp_f32_e64 v109, v109
 mf v[76:79],v[172:175],a[60:63],v[76:79]
 ds_read_b64 v[170:171], v226 offset:40960
 v_cvt_pk_bf16_f32 v153, v106, v107
 mf a[176:179],v[204:207],v[128:131],a[176:179]
 v_exp_f32_e64 v110, v110
 mf a[180:183],v[204:207],v[132:135],a[180:183]
 tr v[200:201],v26,57344
 tr v[202:203],v26,61440
 mf a[184:187],v[204:207],v[136:139],a[184:187]
 v_exp_f32_e64 v111, v111
 mf a[188:191],v[204:207],v[140:143],a[188:191]
 ds_read_b64 v[172:173], v19 offset:40960
 ds_read_b64 v[174:175], v227 offset:40960
 mf v[44:47],v[40:43],v[128:131],v[44:47]
 v_exp_f32_e64 v112, v112
 mf v[48:51],v[40:43],v[132:135],v[48:51]
 tr v[204:205],v27,57344
 v_cvt_pk_bf16_f32 v156, v108, v109
 mf v[52:55],v[40:43],v[136:139],v[52:55]
 v_exp_f32_e64 v113, v113
 mf v[56:59],v[40:43],v[140:143],v[56:59]
 s_waitcnt lgkmcnt(14)
 s_nop 0
 mf v[80:83],v[176:179],a[0:3],0
 tr v[206:207],v27,61440
 v_cvt_pk_bf16_f32 v157, v110, v111
 mf v[84:87],v[176:179],a[16:19],0
 v_exp_f32_e64 v114, v114
 mf v[88:91],v[176:179],a[32:35],0
 s_mov_b32 s48, 1048576
 mf v[92:95],v[176:179],a[48:51],0
 buffer_load_dword v62, v61, s[44:47], s48 offen
 mf a[192:195],v[208:211],v[128:131],a[192:195]
 v_exp_f32_e64 v115, v115
 mf a[196:199],v[208:211],v[132:135],a[196:199]
 v_exp_f32_e64 v116, v116
 mf a[200:203],v[208:211],v[136:139],a[200:203]
 ds_read_b64 v[176:177], v16 offset:45056
 v_cvt_pk_bf16_f32 v146, v112, v113
 mf a[204:207],v[208:211],v[140:143],a[204:207]
 v_exp_f32_e64 v117, v117
 mf v[80:83],v[180:183],a[4:7],v[80:83]
 ds_read_b64 v[178:179], v224 offset:45056
 v_cvt_pk_bf16_f32 v147, v114, v115
 mf v[84:87],v[180:183],a[20:23],v[84:87]
 v_exp_f32_e64 v118, v118
 mf v[88:91],v[180:183],a[36:39],v[88:91]
 tr v[208:209],v28,57344
 tr v[210:211],v28,61440
 mf v[92:95],v[180:183],a[52:55],v[92:95]
 v_exp_f32_e64 v119, v119
 mf a[208:211],v[212:215],v[128:131],a[208:211]
 ds_read_b64 v[180:181], v17 offset:45056
 ds_read_b64 v[182:183], v225 offset:45056
 mf a[212:215],v[212:215],v[132:135],a[212:215]
 v_exp_f32_e64 v120, v120
 mf a[216:219],v[212:215],v[136:139],a[216:219]
 v_cvt_pk_bf16_f32 v150, v116, v117
 mf a[220:223],v[212:215],v[140:143],a[220:223]
 v_exp_f32_e64 v121, v121
 mf v[80:83],v[184:187],a[8:11],v[80:83]
 tr v[212:213],v29,57344
 v_cvt_pk_bf16_f32 v151, v118, v119
 mf v[84:87],v[184:187],a[24:27],v[84:87]
 tr v[214:215],v29,61440
 mf v[88:91],v[184:187],a[40:43],v[88:91]
 v_exp_f32_e64 v122, v122
 mf v[92:95],v[184:187],a[56:59],v[92:95]
 mf a[224:227],v[216:219],v[128:131],a[224:227]
 v_exp_f32_e64 v123, v123
 mf a[228:231],v[216:219],v[132:135],a[228:231]
 v_exp_f32_e64 v124, v124
 mf a[232:235],v[216:219],v[136:139],a[232:235]
 ds_read_b64 v[184:185], v18 offset:45056
 v_cvt_pk_bf16_f32 v154, v120, v121
 mf a[236:239],v[216:219],v[140:143],a[236:239]
 ds_read_b64 v[186:187], v226 offset:45056
 mf v[80:83],v[188:191],a[12:15],v[80:83]
 v_exp_f32_e64 v125, v125
 mf v[84:87],v[188:191],a[28:31],v[84:87]
 tr v[216:217],v30,57344
 v_cvt_pk_bf16_f32 v155, v122, v123
 mf v[88:91],v[188:191],a[44:47],v[88:91]
 v_exp_f32_e64 v126, v126
 mf v[92:95],v[188:191],a[60:63],v[92:95]
 tr v[218:219],v30,61440
 mf a[240:243],v[220:223],v[128:131],a[240:243]
 v_exp_f32_e64 v127, v127
 mf a[244:247],v[220:223],v[132:135],a[244:247]
 ds_read_b64 v[188:189], v19 offset:45056
 v_cvt_pk_bf16_f32 v158, v124, v125
 mf a[248:251],v[220:223],v[136:139],a[248:251]
 ds_read_b64 v[190:191], v227 offset:45056
 v_cvt_pk_bf16_f32 v159, v126, v127
 mf a[252:255],v[220:223],v[140:143],a[252:255]
 s_waitcnt lgkmcnt(14)
 s_nop 0
 mf v[96:99],v[160:163],a[0:3],0
 v_exp_f32_e64 v64, v64
 mf v[100:103],v[160:163],a[16:19],0
 v_exp_f32_e64 v65, v65
 mf v[104:107],v[160:163],a[32:35],0
 tr v[220:221],v31,57344
 tr v[222:223],v31,61440
 mf v[108:111],v[160:163],a[48:51],0
 v_exp_f32_e64 v66, v66
 mf a[128:131],v[192:195],v[144:147],a[128:131]
 s_mov_b32 s48, 2097152
 mf a[132:135],v[192:195],v[148:151],a[132:135]
 buffer_load_dword v62, v61, s[44:47], s48 offen
 mf a[136:139],v[192:195],v[152:155],a[136:139]
 v_exp_f32_e64 v67, v67
 mf a[140:143],v[192:195],v[156:159],a[140:143]
 v_exp_f32_e64 v68, v68
 mf v[96:99],v[164:167],a[4:7],v[96:99]
 v_cvt_pk_bf16_f32 v128, v64, v65
 mf v[100:103],v[164:167],a[20:23],v[100:103]
 v_exp_f32_e64 v69, v69
 mf v[104:107],v[164:167],a[36:39],v[104:107]
 v_cvt_pk_bf16_f32 v129, v66, v67
 mf v[108:111],v[164:167],a[52:55],v[108:111]
 s_waitcnt vmcnt(22) lgkmcnt(0)
 s_barrier
 mf a[144:147],v[196:199],v[144:147],a[144:147]
 v_exp_f32_e64 v70, v70
 mf a[148:151],v[196:199],v[148:151],a[148:151]
 v_exp_f32_e64 v71, v71
 mf a[152:155],v[196:199],v[152:155],a[152:155]
 ds_read_b64 v[160:161], v20 offset:0
 ds_read_b64 v[162:163], v228 offset:0
 mf a[156:159],v[196:199],v[156:159],a[156:159]
 v_exp_f32_e64 v72, v72
 mf v[96:99],v[168:171],a[8:11],v[96:99]
 tr v[192:193],v32,16384
 v_cvt_pk_bf16_f32 v132, v68, v69
 mf v[100:103],v[168:171],a[24:27],v[100:103]
 v_exp_f32_e64 v73, v73
 mf v[104:107],v[168:171],a[40:43],v[104:107]
 tr v[194:195],v32,20480
 v_cvt_pk_bf16_f32 v133, v70, v71
 mf v[108:111],v[168:171],a[56:59],v[108:111]
 ds_read_b64 v[164:165], v21 offset:0
 ds_read_b64 v[166:167], v229 offset:0
 mf a[160:163],v[200:203],v[144:147],a[160:163]
 v_exp_f32_e64 v74, v74
 mf a[164:167],v[200:203],v[148:151],a[164:167]
 tr v[196:197],v33,16384
 tr v[198:199],v33,20480
 mf a[168:171],v[200:203],v[152:155],a[168:171]
 v_exp_f32_e64 v75, v75
 mf a[172:175],v[200:203],v[156:159],a[172:175]
 v_exp_f32_e64 v76, v76
 mf v[96:99],v[172:175],a[12:15],v[96:99]
 ds_read_b64 v[168:169], v22 offset:0
 v_cvt_pk_bf16_f32 v136, v72, v73
 mf v[100:103],v[172:175],a[28:31],v[100:103]
 ds_read_b64 v[170:171], v230 offset:0
 tr v[200:201],v34,16384
 mf v[104:107],v[172:175],a[44:47],v[104:107]
 v_exp_f32_e64 v77, v77
 mf v[108:111],v[172:175],a[60:63],v[108:111]
 tr v[202:203],v34,20480
 v_cvt_pk_bf16_f32 v137, v74, v75
 mf a[176:179],v[204:207],v[144:147],a[176:179]
 v_exp_f32_e64 v78, v78
 mf a[180:183],v[204:207],v[148:151],a[180:183]
 ds_read_b64 v[172:173], v23 offset:0
 ds_read_b64 v[174:175], v231 offset:0
 mf a[184:187],v[204:207],v[152:155],a[184:187]
 v_exp_f32_e64 v79, v79
 mf a[188:191],v[204:207],v[156:159],a[188:191]
 s_add_u32 m0, s29, 32768
 s_add_u32 s26, s34, 16384
 mf v[44:47],v[40:43],v[144:147],v[44:47]
 buffer_load_dwordx4 v8, s[4:7], s26 offen offset:0 lds
 mf v[48:51],v[40:43],v[148:151],v[48:51]
 v_exp_f32_e64 v80, v80
 mf v[52:55],v[40:43],v[152:155],v[52:55]
 tr v[204:205],v35,16384
 v_cvt_pk_bf16_f32 v140, v76, v77
 mf v[56:59],v[40:43],v[156:159],v[56:59]
 v_exp_f32_e64 v81, v81
 mf v[112:115],v[176:179],a[0:3],0
 buffer_load_dwordx4 v9, s[4:7], s26 offen offset:1024 lds
 mf v[116:119],v[176:179],a[16:19],0
 tr v[206:207],v35,20480
 v_cvt_pk_bf16_f32 v141, v78, v79
 mf v[120:123],v[176:179],a[32:35],0
 v_exp_f32_e64 v82, v82
 mf v[124:127],v[176:179],a[48:51],0
 v_exp_f32_e64 v83, v83
 mf a[192:195],v[208:211],v[144:147],a[192:195]
 buffer_load_dwordx4 v10, s[4:7], s26 offen offset:2048 lds
 mf a[196:199],v[208:211],v[148:151],a[196:199]
 v_exp_f32_e64 v84, v84
 mf a[200:203],v[208:211],v[152:155],a[200:203]
 ds_read_b64 v[176:177], v20 offset:4096
 v_cvt_pk_bf16_f32 v130, v80, v81
 mf a[204:207],v[208:211],v[156:159],a[204:207]
 v_exp_f32_e64 v85, v85
 mf v[112:115],v[180:183],a[4:7],v[112:115]
 buffer_load_dwordx4 v11, s[4:7], s26 offen offset:3072 lds
 mf v[116:119],v[180:183],a[20:23],v[116:119]
 ds_read_b64 v[178:179], v228 offset:4096
 v_cvt_pk_bf16_f32 v131, v82, v83
 mf v[120:123],v[180:183],a[36:39],v[120:123]
 v_exp_f32_e64 v86, v86
 mf v[124:127],v[180:183],a[52:55],v[124:127]
 v_exp_f32_e64 v87, v87
 mf a[208:211],v[212:215],v[144:147],a[208:211]
 tr v[208:209],v36,16384
 tr v[210:211],v36,20480
 mf a[212:215],v[212:215],v[148:151],a[212:215]
 v_exp_f32_e64 v88, v88
 mf a[216:219],v[212:215],v[152:155],a[216:219]
 ds_read_b64 v[180:181], v21 offset:4096
 v_cvt_pk_bf16_f32 v134, v84, v85
 mf a[220:223],v[212:215],v[156:159],a[220:223]
 v_exp_f32_e64 v89, v89
 mf v[112:115],v[184:187],a[8:11],v[112:115]
 ds_read_b64 v[182:183], v229 offset:4096
 v_cvt_pk_bf16_f32 v135, v86, v87
 mf v[116:119],v[184:187],a[24:27],v[116:119]
 tr v[212:213],v37,16384
 tr v[214:215],v37,20480
 mf v[120:123],v[184:187],a[40:43],v[120:123]
 v_exp_f32_e64 v90, v90
 mf v[124:127],v[184:187],a[56:59],v[124:127]
 mf a[224:227],v[216:219],v[144:147],a[224:227]
 v_exp_f32_e64 v91, v91
 mf a[228:231],v[216:219],v[148:151],a[228:231]
 v_exp_f32_e64 v92, v92
 mf a[232:235],v[216:219],v[152:155],a[232:235]
 ds_read_b64 v[184:185], v22 offset:4096
 v_cvt_pk_bf16_f32 v138, v88, v89
 mf a[236:239],v[216:219],v[156:159],a[236:239]
 ds_read_b64 v[186:187], v230 offset:4096
 mf v[112:115],v[188:191],a[12:15],v[112:115]
 v_exp_f32_e64 v93, v93
 mf v[116:119],v[188:191],a[28:31],v[116:119]
 tr v[216:217],v38,16384
 v_cvt_pk_bf16_f32 v139, v90, v91
 mf v[120:123],v[188:191],a[44:47],v[120:123]
 v_exp_f32_e64 v94, v94
 mf v[124:127],v[188:191],a[60:63],v[124:127]
 tr v[218:219],v38,20480
 mf a[240:243],v[220:223],v[144:147],a[240:243]
 v_exp_f32_e64 v95, v95
 mf a[244:247],v[220:223],v[148:151],a[244:247]
 ds_read_b64 v[188:189], v23 offset:4096
 v_cvt_pk_bf16_f32 v142, v92, v93
 mf a[248:251],v[220:223],v[152:155],a[248:251]
 ds_read_b64 v[190:191], v231 offset:4096
 v_cvt_pk_bf16_f32 v143, v94, v95
 mf a[252:255],v[220:223],v[156:159],a[252:255]
 s_waitcnt lgkmcnt(14)
 s_nop 0
 mf v[64:67],v[160:163],a[0:3],0
 v_exp_f32_e64 v96, v96
 mf v[68:71],v[160:163],a[16:19],0
 v_exp_f32_e64 v97, v97
 mf v[72:75],v[160:163],a[32:35],0
 tr v[220:221],v39,16384
 tr v[222:223],v39,20480
 mf v[76:79],v[160:163],a[48:51],0
 v_exp_f32_e64 v98, v98
 mf a[128:131],v[192:195],v[128:131],a[128:131]
 ds_read_b64 v[160:161], v20 offset:8192
 ds_read_b64 v[162:163], v228 offset:8192
 mf a[132:135],v[192:195],v[132:135],a[132:135]
 v_exp_f32_e64 v99, v99
 mf a[136:139],v[192:195],v[136:139],a[136:139]
 v_exp_f32_e64 v100, v100
 mf a[140:143],v[192:195],v[140:143],a[140:143]
 s_add_u32 m0, s29, 49152
 v_cvt_pk_bf16_f32 v144, v96, v97
 mf v[64:67],v[164:167],a[4:7],v[64:67]
 tr v[192:193],v32,24576
 tr v[194:195],v32,28672
 mf v[68:71],v[164:167],a[20:23],v[68:71]
 v_exp_f32_e64 v101, v101
 mf v[72:75],v[164:167],a[36:39],v[72:75]
 s_add_u32 s27, s34, 0
 s_nop 0
 v_cvt_pk_bf16_f32 v145, v98, v99
 mf v[76:79],v[164:167],a[52:55],v[76:79]
 buffer_load_dwordx4 v12, s[8:11], s27 offen offset:0 lds
 mf a[144:147],v[196:199],v[128:131],a[144:147]
 v_exp_f32_e64 v102, v102
 mf a[148:151],v[196:199],v[132:135],a[148:151]
 v_exp_f32_e64 v103, v103
 mf a[152:155],v[196:199],v[136:139],a[152:155]
 ds_read_b64 v[164:165], v21 offset:8192
 ds_read_b64 v[166:167], v229 offset:8192
 mf a[156:159],v[196:199],v[140:143],a[156:159]
 buffer_load_dwordx4 v13, s[8:11], s27 offen offset:1024 lds
 mf v[64:67],v[168:171],a[8:11],v[64:67]
 v_exp_f32_e64 v104, v104
 mf v[68:71],v[168:171],a[24:27],v[68:71]
 tr v[196:197],v33,24576
 v_cvt_pk_bf16_f32 v148, v100, v101
 mf v[72:75],v[168:171],a[40:43],v[72:75]
 v_exp_f32_e64 v105, v105
 mf v[76:79],v[168:171],a[56:59],v[76:79]
 buffer_load_dwordx4 v14, s[8:11], s27 offen offset:2048 lds
 mf a[160:163],v[200:203],v[128:131],a[160:163]
 tr v[198:199],v33,28672
 v_cvt_pk_bf16_f32 v149, v102, v103
 mf a[164:167],v[200:203],v[132:135],a[164:167]
 v_exp_f32_e64 v106, v106
 mf a[168:171],v[200:203],v[136:139],a[168:171]
 v_exp_f32_e64 v107, v107
 mf a[172:175],v[200:203],v[140:143],a[172:175]
 buffer_load_dwordx4 v15, s[8:11], s27 offen offset:3072 lds
 mf v[64:67],v[172:175],a[12:15],v[64:67]
 v_exp_f32_e64 v108, v108
 mf v[68:71],v[172:175],a[28:31],v[68:71]
 ds_read_b64 v[168:169], v22 offset:8192
 v_cvt_pk_bf16_f32 v152, v104, v105
 mf v[72:75],v[172:175],a[44:47],v[72:75]
 v_exp_f32_e64 v109, v109
 mf v[76:79],v[172:175],a[60:63],v[76:79]
 ds_read_b64 v[170:171], v230 offset:8192
 v_cvt_pk_bf16_f32 v153, v106, v107
 mf a[176:179],v[204:207],v[128:131],a[176:179]
 v_exp_f32_e64 v110, v110
 mf a[180:183],v[204:207],v[132:135],a[180:183]
 tr v[200:201],v34,24576
 tr v[202:203],v34,28672
 mf a[184:187],v[204:207],v[136:139],a[184:187]
 v_exp_f32_e64 v111, v111
 mf a[188:191],v[204:207],v[140:143],a[188:191]
 ds_read_b64 v[172:173], v23 offset:8192
 ds_read_b64 v[174:175], v231 offset:8192
 mf v[44:47],v[40:43],v[128:131],v[44:47]
 v_exp_f32_e64 v112, v112
 mf v[48:51],v[40:43],v[132:135],v[48:51]
 tr v[204:205],v35,24576
 v_cvt_pk_bf16_f32 v156, v108, v109
 mf v[52:55],v[40:43],v[136:139],v[52:55]
 v_exp_f32_e64 v113, v113
 mf v[56:59],v[40:43],v[140:143],v[56:59]
 s_waitcnt lgkmcnt(14)
 s_nop 0
 mf v[80:83],v[176:179],a[0:3],0
 tr v[206:207],v35,28672
 v_cvt_pk_bf16_f32 v157, v110, v111
 mf v[84:87],v[176:179],a[16:19],0
 v_exp_f32_e64 v114, v114
 mf v[88:91],v[176:179],a[32:35],0
 s_mov_b32 s48, 3145728
 mf v[92:95],v[176:179],a[48:51],0
 buffer_load_dword v62, v61, s[44:47], s48 offen
 mf a[192:195],v[208:211],v[128:131],a[192:195]
 v_exp_f32_e64 v115, v115
 mf a[196:199],v[208:211],v[132:135],a[196:199]
 v_exp_f32_e64 v116, v116
 mf a[200:203],v[208:211],v[136:139],a[200:203]
 ds_read_b64 v[176:177], v20 offset:12288
 v_cvt_pk_bf16_f32 v146, v112, v113
 mf a[204:207],v[208:211],v[140:143],a[204:207]
 v_exp_f32_e64 v117, v117
 mf v[80:83],v[180:183],a[4:7],v[80:83]
 ds_read_b64 v[178:179], v228 offset:12288
 v_cvt_pk_bf16_f32 v147, v114, v115
 mf v[84:87],v[180:183],a[20:23],v[84:87]
 v_exp_f32_e64 v118, v118
 mf v[88:91],v[180:183],a[36:39],v[88:91]
 tr v[208:209],v36,24576
 tr v[210:211],v36,28672
 mf v[92:95],v[180:183],a[52:55],v[92:95]
 v_exp_f32_e64 v119, v119
 mf a[208:211],v[212:215],v[128:131],a[208:211]
 ds_read_b64 v[180:181], v21 offset:12288
 ds_read_b64 v[182:183], v229 offset:12288
 mf a[212:215],v[212:215],v[132:135],a[212:215]
 v_exp_f32_e64 v120, v120
 mf a[216:219],v[212:215],v[136:139],a[216:219]
 v_cvt_pk_bf16_f32 v150, v116, v117
 mf a[220:223],v[212:215],v[140:143],a[220:223]
 v_exp_f32_e64 v121, v121
 mf v[80:83],v[184:187],a[8:11],v[80:83]
 tr v[212:213],v37,24576
 v_cvt_pk_bf16_f32 v151, v118, v119
 mf v[84:87],v[184:187],a[24:27],v[84:87]
 tr v[214:215],v37,28672
 mf v[88:91],v[184:187],a[40:43],v[88:91]
 v_exp_f32_e64 v122, v122
 mf v[92:95],v[184:187],a[56:59],v[92:95]
 mf a[224:227],v[216:219],v[128:131],a[224:227]
 v_exp_f32_e64 v123, v123
 mf a[228:231],v[216:219],v[132:135],a[228:231]
 v_exp_f32_e64 v124, v124
 mf a[232:235],v[216:219],v[136:139],a[232:235]
 ds_read_b64 v[184:185], v22 offset:12288
 v_cvt_pk_bf16_f32 v154, v120, v121
 mf a[236:239],v[216:219],v[140:143],a[236:239]
 ds_read_b64 v[186:187], v230 offset:12288
 mf v[80:83],v[188:191],a[12:15],v[80:83]
 v_exp_f32_e64 v125, v125
 mf v[84:87],v[188:191],a[28:31],v[84:87]
 tr v[216:217],v38,24576
 v_cvt_pk_bf16_f32 v155, v122, v123
 mf v[88:91],v[188:191],a[44:47],v[88:91]
 v_exp_f32_e64 v126, v126
 mf v[92:95],v[188:191],a[60:63],v[92:95]
 tr v[218:219],v38,28672
 mf a[240:243],v[220:223],v[128:131],a[240:243]
 v_exp_f32_e64 v127, v127
 mf a[244:247],v[220:223],v[132:135],a[244:247]
 ds_read_b64 v[188:189], v23 offset:12288
 v_cvt_pk_bf16_f32 v158, v124, v125
 mf a[248:251],v[220:223],v[136:139],a[248:251]
 ds_read_b64 v[190:191], v231 offset:12288
 v_cvt_pk_bf16_f32 v159, v126, v127
 mf a[252:255],v[220:223],v[140:143],a[252:255]
 s_waitcnt lgkmcnt(14)
 s_nop 0
 mf v[96:99],v[160:163],a[0:3],0
 v_exp_f32_e64 v64, v64
 mf v[100:103],v[160:163],a[16:19],0
 v_exp_f32_e64 v65, v65
 mf v[104:107],v[160:163],a[32:35],0
 tr v[220:221],v39,24576
 tr v[222:223],v39,28672
 mf v[108:111],v[160:163],a[48:51],0
 v_exp_f32_e64 v66, v66
 mf a[128:131],v[192:195],v[144:147],a[128:131]
 mf a[132:135],v[192:195],v[148:151],a[132:135]
 v_exp_f32_e64 v67, v67
 mf a[136:139],v[192:195],v[152:155],a[136:139]
 v_exp_f32_e64 v68, v68
 mf a[140:143],v[192:195],v[156:159],a[140:143]
 v_cvt_pk_bf16_f32 v128, v64, v65
 mf v[96:99],v[164:167],a[4:7],v[96:99]
 mf v[100:103],v[164:167],a[20:23],v[100:103]
 v_exp_f32_e64 v69, v69
 mf v[104:107],v[164:167],a[36:39],v[104:107]
 v_cvt_pk_bf16_f32 v129, v66, v67
 mf v[108:111],v[164:167],a[52:55],v[108:111]
 s_cmp_eq_u32 s20, 0
 s_cbranch_scc1 L_stub_wr11_6027
 s_cmp_eq_u32 s20, 1
 s_cbranch_scc1 L_stub_wr11_6554
 s_cmp_eq_u32 s20, 2
 s_cbranch_scc1 L_stub_wr11_7068
 s_branch L_stub_wr11_7583
 s_nop 0
L_rw11:
 s_waitcnt vmcnt(21) lgkmcnt(0)
 s_barrier
 mf a[144:147],v[196:199],v[144:147],a[144:147]
 v_exp_f32_e64 v70, v70
 mf a[148:151],v[196:199],v[148:151],a[148:151]
 v_exp_f32_e64 v71, v71
 mf a[152:155],v[196:199],v[152:155],a[152:155]
 ds_read_b64 v[160:161], v20 offset:32768
 ds_read_b64 v[162:163], v228 offset:32768
 mf a[156:159],v[196:199],v[156:159],a[156:159]
 v_exp_f32_e64 v72, v72
 mf v[96:99],v[168:171],a[8:11],v[96:99]
 tr v[192:193],v32,49152
 v_cvt_pk_bf16_f32 v132, v68, v69
 mf v[100:103],v[168:171],a[24:27],v[100:103]
 v_exp_f32_e64 v73, v73
 mf v[104:107],v[168:171],a[40:43],v[104:107]
 tr v[194:195],v32,53248
 v_cvt_pk_bf16_f32 v133, v70, v71
 mf v[108:111],v[168:171],a[56:59],v[108:111]
 ds_read_b64 v[164:165], v21 offset:32768
 ds_read_b64 v[166:167], v229 offset:32768
 mf a[160:163],v[200:203],v[144:147],a[160:163]
 v_exp_f32_e64 v74, v74
 mf a[164:167],v[200:203],v[148:151],a[164:167]
 tr v[196:197],v33,49152
 tr v[198:199],v33,53248
 mf a[168:171],v[200:203],v[152:155],a[168:171]
 v_exp_f32_e64 v75, v75
 mf a[172:175],v[200:203],v[156:159],a[172:175]
 v_exp_f32_e64 v76, v76
 mf v[96:99],v[172:175],a[12:15],v[96:99]
 ds_read_b64 v[168:169], v22 offset:32768
 v_cvt_pk_bf16_f32 v136, v72, v73
 mf v[100:103],v[172:175],a[28:31],v[100:103]
 ds_read_b64 v[170:171], v230 offset:32768
 tr v[200:201],v34,49152
 mf v[104:107],v[172:175],a[44:47],v[104:107]
 v_exp_f32_e64 v77, v77
 mf v[108:111],v[172:175],a[60:63],v[108:111]
 tr v[202:203],v34,53248
 v_cvt_pk_bf16_f32 v137, v74, v75
 mf a[176:179],v[204:207],v[144:147],a[176:179]
 v_exp_f32_e64 v78, v78
 mf a[180:183],v[204:207],v[148:151],a[180:183]
 ds_read_b64 v[172:173], v23 offset:32768
 ds_read_b64 v[174:175], v231 offset:32768
 mf a[184:187],v[204:207],v[152:155],a[184:187]
 v_exp_f32_e64 v79, v79
 mf a[188:191],v[204:207],v[156:159],a[188:191]
 s_add_u32 m0, s29, 65536
 s_add_u32 s26, s34, 32768
 mf v[44:47],v[40:43],v[144:147],v[44:47]
 buffer_load_dwordx4 v8, s[4:7], s26 offen offset:0 lds
 mf v[48:51],v[40:43],v[148:151],v[48:51]
 v_exp_f32_e64 v80, v80
 mf v[52:55],v[40:43],v[152:155],v[52:55]
 tr v[204:205],v35,49152
 v_cvt_pk_bf16_f32 v140, v76, v77
 mf v[56:59],v[40:43],v[156:159],v[56:59]
 v_exp_f32_e64 v81, v81
 mf v[112:115],v[176:179],a[0:3],0
 buffer_load_dwordx4 v9, s[4:7], s26 offen offset:1024 lds
 mf v[116:119],v[176:179],a[16:19],0
 s_branch L_skip_5512
.p2align 12
L_stub_wa_5512:
 s_branch L_stub_wa_7068
L_stub_wr3_5512:
 s_branch L_stub_wr3_7583
 s_nop 0
 s_nop 0
L_skip_5512:
 tr v[206:207],v35,53248
 v_cvt_pk_bf16_f32 v141, v78, v79
 mf v[120:123],v[176:179],a[32:35],0
 v_exp_f32_e64 v82, v82
 mf v[124:127],v[176:179],a[48:51],0
 v_exp_f32_e64 v83, v83
 mf a[192:195],v[208:211],v[144:147],a[192:195]
 buffer_load_dwordx4 v10, s[4:7], s26 offen offset:2048 lds
 mf a[196:199],v[208:211],v[148:151],a[196:199]
 v_exp_f32_e64 v84, v84
 mf a[200:203],v[208:211],v[152:155],a[200:203]
 ds_read_b64 v[176:177], v20 offset:36864
 v_cvt_pk_bf16_f32 v130, v80, v81
 mf a[204:207],v[208:211],v[156:159],a[204:207]
 v_exp_f32_e64 v85, v85
 mf v[112:115],v[180:183],a[4:7],v[112:115]
 buffer_load_dwordx4 v11, s[4:7], s26 offen offset:3072 lds
 mf v[116:119],v[180:183],a[20:23],v[116:119]
 ds_read_b64 v[178:179], v228 offset:36864
 v_cvt_pk_bf16_f32 v131, v82, v83
 mf v[120:123],v[180:183],a[36:39],v[120:123]
 v_exp_f32_e64 v86, v86
 mf v[124:127],v[180:183],a[52:55],v[124:127]
 v_exp_f32_e64 v87, v87
 mf a[208:211],v[212:215],v[144:147],a[208:211]
 tr v[208:209],v36,49152
 tr v[210:211],v36,53248
 mf a[212:215],v[212:215],v[148:151],a[212:215]
 v_exp_f32_e64 v88, v88
 mf a[216:219],v[212:215],v[152:155],a[216:219]
 ds_read_b64 v[180:181], v21 offset:36864
 v_cvt_pk_bf16_f32 v134, v84, v85
 mf a[220:223],v[212:215],v[156:159],a[220:223]
 v_exp_f32_e64 v89, v89
 mf v[112:115],v[184:187],a[8:11],v[112:115]
 ds_read_b64 v[182:183], v229 offset:36864
 v_cvt_pk_bf16_f32 v135, v86, v87
 mf v[116:119],v[184:187],a[24:27],v[116:119]
 tr v[212:213],v37,49152
 tr v[214:215],v37,53248
 mf v[120:123],v[184:187],a[40:43],v[120:123]
 v_exp_f32_e64 v90, v90
 mf v[124:127],v[184:187],a[56:59],v[124:127]
 mf a[224:227],v[216:219],v[144:147],a[224:227]
 v_exp_f32_e64 v91, v91
 mf a[228:231],v[216:219],v[148:151],a[228:231]
 v_exp_f32_e64 v92, v92
 mf a[232:235],v[216:219],v[152:155],a[232:235]
 ds_read_b64 v[184:185], v22 offset:36864
 v_cvt_pk_bf16_f32 v138, v88, v89
 mf a[236:239],v[216:219],v[156:159],a[236:239]
 ds_read_b64 v[186:187], v230 offset:36864
 mf v[112:115],v[188:191],a[12:15],v[112:115]
 v_exp_f32_e64 v93, v93
 mf v[116:119],v[188:191],a[28:31],v[116:119]
 tr v[216:217],v38,49152
 v_cvt_pk_bf16_f32 v139, v90, v91
 mf v[120:123],v[188:191],a[44:47],v[120:123]
 v_exp_f32_e64 v94, v94
 mf v[124:127],v[188:191],a[60:63],v[124:127]
 tr v[218:219],v38,53248
 mf a[240:243],v[220:223],v[144:147],a[240:243]
 v_exp_f32_e64 v95, v95
 mf a[244:247],v[220:223],v[148:151],a[244:247]
 ds_read_b64 v[188:189], v23 offset:36864
 v_cvt_pk_bf16_f32 v142, v92, v93
 mf a[248:251],v[220:223],v[152:155],a[248:251]
 ds_read_b64 v[190:191], v231 offset:36864
 v_cvt_pk_bf16_f32 v143, v94, v95
 mf a[252:255],v[220:223],v[156:159],a[252:255]
 s_waitcnt lgkmcnt(14)
 s_nop 0
 mf v[64:67],v[160:163],a[0:3],0
 v_exp_f32_e64 v96, v96
 mf v[68:71],v[160:163],a[16:19],0
 v_exp_f32_e64 v97, v97
 mf v[72:75],v[160:163],a[32:35],0
 tr v[220:221],v39,49152
 tr v[222:223],v39,53248
 mf v[76:79],v[160:163],a[48:51],0
 v_exp_f32_e64 v98, v98
 mf a[128:131],v[192:195],v[128:131],a[128:131]
 ds_read_b64 v[160:161], v20 offset:40960
 ds_read_b64 v[162:163], v228 offset:40960
 mf a[132:135],v[192:195],v[132:135],a[132:135]
 v_exp_f32_e64 v99, v99
 mf a[136:139],v[192:195],v[136:139],a[136:139]
 v_exp_f32_e64 v100, v100
 mf a[140:143],v[192:195],v[140:143],a[140:143]
 s_add_u32 m0, s29, 81920
 v_cvt_pk_bf16_f32 v144, v96, v97
 mf v[64:67],v[164:167],a[4:7],v[64:67]
 tr v[192:193],v32,57344
 tr v[194:195],v32,61440
 mf v[68:71],v[164:167],a[20:23],v[68:71]
 v_exp_f32_e64 v101, v101
 mf v[72:75],v[164:167],a[36:39],v[72:75]
 s_add_u32 s27, s34, 16384
 v_cvt_pk_bf16_f32 v145, v98, v99
 mf v[76:79],v[164:167],a[52:55],v[76:79]
 buffer_load_dwordx4 v12, s[8:11], s27 offen offset:0 lds
 mf a[144:147],v[196:199],v[128:131],a[144:147]
 v_exp_f32_e64 v102, v102
 mf a[148:151],v[196:199],v[132:135],a[148:151]
 v_exp_f32_e64 v103, v103
 mf a[152:155],v[196:199],v[136:139],a[152:155]
 ds_read_b64 v[164:165], v21 offset:40960
 ds_read_b64 v[166:167], v229 offset:40960
 mf a[156:159],v[196:199],v[140:143],a[156:159]
 buffer_load_dwordx4 v13, s[8:11], s27 offen offset:1024 lds
 mf v[64:67],v[168:171],a[8:11],v[64:67]
 v_exp_f32_e64 v104, v104
 mf v[68:71],v[168:171],a[24:27],v[68:71]
 tr v[196:197],v33,57344
 v_cvt_pk_bf16_f32 v148, v100, v101
 mf v[72:75],v[168:171],a[40:43],v[72:75]
 v_exp_f32_e64 v105, v105
 mf v[76:79],v[168:171],a[56:59],v[76:79]
 buffer_load_dwordx4 v14, s[8:11], s27 offen offset:2048 lds
 mf a[160:163],v[200:203],v[128:131],a[160:163]
 tr v[198:199],v33,61440
 v_cvt_pk_bf16_f32 v149, v102, v103
 mf a[164:167],v[200:203],v[132:135],a[164:167]
 v_exp_f32_e64 v106, v106
 mf a[168:171],v[200:203],v[136:139],a[168:171]
 v_exp_f32_e64 v107, v107
 mf a[172:175],v[200:203],v[140:143],a[172:175]
 buffer_load_dwordx4 v15, s[8:11], s27 offen offset:3072 lds
 mf v[64:67],v[172:175],a[12:15],v[64:67]
 v_exp_f32_e64 v108, v108
 mf v[68:71],v[172:175],a[28:31],v[68:71]
 ds_read_b64 v[168:169], v22 offset:40960
 v_cvt_pk_bf16_f32 v152, v104, v105
 mf v[72:75],v[172:175],a[44:47],v[72:75]
 v_exp_f32_e64 v109, v109
 mf v[76:79],v[172:175],a[60:63],v[76:79]
 ds_read_b64 v[170:171], v230 offset:40960
 v_cvt_pk_bf16_f32 v153, v106, v107
 mf a[176:179],v[204:207],v[128:131],a[176:179]
 v_exp_f32_e64 v110, v110
 mf a[180:183],v[204:207],v[132:135],a[180:183]
 tr v[200:201],v34,57344
 tr v[202:203],v34,61440
 mf a[184:187],v[204:207],v[136:139],a[184:187]
 v_exp_f32_e64 v111, v111
 mf a[188:191],v[204:207],v[140:143],a[188:191]
 ds_read_b64 v[172:173], v23 offset:40960
 ds_read_b64 v[174:175], v231 offset:40960
 mf v[44:47],v[40:43],v[128:131],v[44:47]
 v_exp_f32_e64 v112, v112
 mf v[48:51],v[40:43],v[132:135],v[48:51]
 tr v[204:205],v35,57344
 v_cvt_pk_bf16_f32 v156, v108, v109
 mf v[52:55],v[40:43],v[136:139],v[52:55]
 v_exp_f32_e64 v113, v113
 mf v[56:59],v[40:43],v[140:143],v[56:59]
 s_waitcnt lgkmcnt(14)
 s_nop 0
 mf v[80:83],v[176:179],a[0:3],0
 tr v[206:207],v35,61440
 v_cvt_pk_bf16_f32 v157, v110, v111
 mf v[84:87],v[176:179],a[16:19],0
 v_exp_f32_e64 v114, v114
 mf v[88:91],v[176:179],a[32:35],0
 mf v[92:95],v[176:179],a[48:51],0
 v_exp_f32_e64 v115, v115
 mf a[192:195],v[208:211],v[128:131],a[192:195]
 v_exp_f32_e64 v116, v116
 mf a[196:199],v[208:211],v[132:135],a[196:199]
 ds_read_b64 v[176:177], v20 offset:45056
 v_cvt_pk_bf16_f32 v146, v112, v113
 mf a[200:203],v[208:211],v[136:139],a[200:203]
 ds_read_b64 v[178:179], v228 offset:45056
 mf a[204:207],v[208:211],v[140:143],a[204:207]
 v_exp_f32_e64 v117, v117
 mf v[80:83],v[180:183],a[4:7],v[80:83]
 tr v[208:209],v36,57344
 v_cvt_pk_bf16_f32 v147, v114, v115
 mf v[84:87],v[180:183],a[20:23],v[84:87]
 v_exp_f32_e64 v118, v118
 mf v[88:91],v[180:183],a[36:39],v[88:91]
 tr v[210:211],v36,61440
 mf v[92:95],v[180:183],a[52:55],v[92:95]
 v_exp_f32_e64 v119, v119
 mf a[208:211],v[212:215],v[128:131],a[208:211]
 ds_read_b64 v[180:181], v21 offset:45056
 ds_read_b64 v[182:183], v229 offset:45056
 mf a[212:215],v[212:215],v[132:135],a[212:215]
 v_exp_f32_e64 v120, v120
 mf a[216:219],v[212:215],v[136:139],a[216:219]
 v_cvt_pk_bf16_f32 v150, v116, v117
 mf a[220:223],v[212:215],v[140:143],a[220:223]
 v_exp_f32_e64 v121, v121
 mf v[80:83],v[184:187],a[8:11],v[80:83]
 tr v[212:213],v37,57344
 v_cvt_pk_bf16_f32 v151, v118, v119
 mf v[84:87],v[184:187],a[24:27],v[84:87]
 tr v[214:215],v37,61440
 mf v[88:91],v[184:187],a[40:43],v[88:91]
 v_exp_f32_e64 v122, v122
 mf v[92:95],v[184:187],a[56:59],v[92:95]
 mf a[224:227],v[216:219],v[128:131],a[224:227]
 v_exp_f32_e64 v123, v123
 mf a[228:231],v[216:219],v[132:135],a[228:231]
 v_exp_f32_e64 v124, v124
 mf a[232:235],v[216:219],v[136:139],a[232:235]
 ds_read_b64 v[184:185], v22 offset:45056
 v_cvt_pk_bf16_f32 v154, v120, v121
 mf a[236:239],v[216:219],v[140:143],a[236:239]
 ds_read_b64 v[186:187], v230 offset:45056
 mf v[80:83],v[188:191],a[12:15],v[80:83]
 v_exp_f32_e64 v125, v125
 mf v[84:87],v[188:191],a[28:31],v[84:87]
 tr v[216:217],v38,57344
 v_cvt_pk_bf16_f32 v155, v122, v123
 mf v[88:91],v[188:191],a[44:47],v[88:91]
 v_exp_f32_e64 v126, v126
 mf v[92:95],v[188:191],a[60:63],v[92:95]
 tr v[218:219],v38,61440
 mf a[240:243],v[220:223],v[128:131],a[240:243]
 v_exp_f32_e64 v127, v127
 mf a[244:247],v[220:223],v[132:135],a[244:247]
 ds_read_b64 v[188:189], v23 offset:45056
 v_cvt_pk_bf16_f32 v158, v124, v125
 mf a[248:251],v[220:223],v[136:139],a[248:251]
 ds_read_b64 v[190:191], v231 offset:45056
 v_cvt_pk_bf16_f32 v159, v126, v127
 mf a[252:255],v[220:223],v[140:143],a[252:255]
 s_waitcnt lgkmcnt(14)
 s_nop 0
 mf v[96:99],v[160:163],a[0:3],0
 v_exp_f32_e64 v64, v64
 mf v[100:103],v[160:163],a[16:19],0
 v_exp_f32_e64 v65, v65
 mf v[104:107],v[160:163],a[32:35],0
 tr v[220:221],v39,57344
 tr v[222:223],v39,61440
 mf v[108:111],v[160:163],a[48:51],0
 v_exp_f32_e64 v66, v66
 mf a[128:131],v[192:195],v[144:147],a[128:131]
 mf a[132:135],v[192:195],v[148:151],a[132:135]
 v_exp_f32_e64 v67, v67
 mf a[136:139],v[192:195],v[152:155],a[136:139]
 v_exp_f32_e64 v68, v68
 mf a[140:143],v[192:195],v[156:159],a[140:143]
 v_cvt_pk_bf16_f32 v128, v64, v65
 mf v[96:99],v[164:167],a[4:7],v[96:99]
 mf v[100:103],v[164:167],a[20:23],v[100:103]
 v_exp_f32_e64 v69, v69
 mf v[104:107],v[164:167],a[36:39],v[104:107]
 v_cvt_pk_bf16_f32 v129, v66, v67
 mf v[108:111],v[164:167],a[52:55],v[108:111]
 s_waitcnt vmcnt(19) lgkmcnt(0)
 s_barrier
 mf a[144:147],v[196:199],v[144:147],a[144:147]
 v_exp_f32_e64 v70, v70
 mf a[148:151],v[196:199],v[148:151],a[148:151]
 v_exp_f32_e64 v71, v71
 mf a[152:155],v[196:199],v[152:155],a[152:155]
 ds_read_b64 v[160:161], v16 offset:0
 ds_read_b64 v[162:163], v224 offset:0
 mf a[156:159],v[196:199],v[156:159],a[156:159]
 v_exp_f32_e64 v72, v72
 mf v[96:99],v[168:171],a[8:11],v[96:99]
 tr v[192:193],v24,16384
 v_cvt_pk_bf16_f32 v132, v68, v69
 mf v[100:103],v[168:171],a[24:27],v[100:103]
 v_exp_f32_e64 v73, v73
 mf v[104:107],v[168:171],a[40:43],v[104:107]
 tr v[194:195],v24,20480
 v_cvt_pk_bf16_f32 v133, v70, v71
 mf v[108:111],v[168:171],a[56:59],v[108:111]
 ds_read_b64 v[164:165], v17 offset:0
 ds_read_b64 v[166:167], v225 offset:0
 mf a[160:163],v[200:203],v[144:147],a[160:163]
 v_exp_f32_e64 v74, v74
 mf a[164:167],v[200:203],v[148:151],a[164:167]
 tr v[196:197],v25,16384
 tr v[198:199],v25,20480
 mf a[168:171],v[200:203],v[152:155],a[168:171]
 v_exp_f32_e64 v75, v75
 mf a[172:175],v[200:203],v[156:159],a[172:175]
 v_exp_f32_e64 v76, v76
 mf v[96:99],v[172:175],a[12:15],v[96:99]
 ds_read_b64 v[168:169], v18 offset:0
 v_cvt_pk_bf16_f32 v136, v72, v73
 mf v[100:103],v[172:175],a[28:31],v[100:103]
 ds_read_b64 v[170:171], v226 offset:0
 tr v[200:201],v26,16384
 mf v[104:107],v[172:175],a[44:47],v[104:107]
 v_exp_f32_e64 v77, v77
 mf v[108:111],v[172:175],a[60:63],v[108:111]
 tr v[202:203],v26,20480
 v_cvt_pk_bf16_f32 v137, v74, v75
 mf a[176:179],v[204:207],v[144:147],a[176:179]
 v_exp_f32_e64 v78, v78
 mf a[180:183],v[204:207],v[148:151],a[180:183]
 ds_read_b64 v[172:173], v19 offset:0
 ds_read_b64 v[174:175], v227 offset:0
 mf a[184:187],v[204:207],v[152:155],a[184:187]
 v_exp_f32_e64 v79, v79
 mf a[188:191],v[204:207],v[156:159],a[188:191]
 s_add_u32 m0, s29, 98304
 s_add_u32 s26, s34, 49152
 mf v[44:47],v[40:43],v[144:147],v[44:47]
 buffer_load_dwordx4 v8, s[4:7], s26 offen offset:0 lds
 mf v[48:51],v[40:43],v[148:151],v[48:51]
 v_exp_f32_e64 v80, v80
 mf v[52:55],v[40:43],v[152:155],v[52:55]
 tr v[204:205],v27,16384
 v_cvt_pk_bf16_f32 v140, v76, v77
 mf v[56:59],v[40:43],v[156:159],v[56:59]
 v_exp_f32_e64 v81, v81
 mf v[112:115],v[176:179],a[0:3],0
 buffer_load_dwordx4 v9, s[4:7], s26 offen offset:1024 lds
 mf v[116:119],v[176:179],a[16:19],0
 tr v[206:207],v27,20480
 v_cvt_pk_bf16_f32 v141, v78, v79
 mf v[120:123],v[176:179],a[32:35],0
 v_exp_f32_e64 v82, v82
 mf v[124:127],v[176:179],a[48:51],0
 v_exp_f32_e64 v83, v83
 mf a[192:195],v[208:211],v[144:147],a[192:195]
 buffer_load_dwordx4 v10, s[4:7], s26 offen offset:2048 lds
 mf a[196:199],v[208:211],v[148:151],a[196:199]
 v_exp_f32_e64 v84, v84
 mf a[200:203],v[208:211],v[152:155],a[200:203]
 ds_read_b64 v[176:177], v16 offset:4096
 v_cvt_pk_bf16_f32 v130, v80, v81
 mf a[204:207],v[208:211],v[156:159],a[204:207]
 v_exp_f32_e64 v85, v85
 mf v[112:115],v[180:183],a[4:7],v[112:115]
 buffer_load_dwordx4 v11, s[4:7], s26 offen offset:3072 lds
 mf v[116:119],v[180:183],a[20:23],v[116:119]
 ds_read_b64 v[178:179], v224 offset:4096
 v_cvt_pk_bf16_f32 v131, v82, v83
 mf v[120:123],v[180:183],a[36:39],v[120:123]
 v_exp_f32_e64 v86, v86
 mf v[124:127],v[180:183],a[52:55],v[124:127]
 v_exp_f32_e64 v87, v87
 mf a[208:211],v[212:215],v[144:147],a[208:211]
 tr v[208:209],v28,16384
 tr v[210:211],v28,20480
 mf a[212:215],v[212:215],v[148:151],a[212:215]
 v_exp_f32_e64 v88, v88
 mf a[216:219],v[212:215],v[152:155],a[216:219]
 ds_read_b64 v[180:181], v17 offset:4096
 v_cvt_pk_bf16_f32 v134, v84, v85
 mf a[220:223],v[212:215],v[156:159],a[220:223]
 v_exp_f32_e64 v89, v89
 mf v[112:115],v[184:187],a[8:11],v[112:115]
 ds_read_b64 v[182:183], v225 offset:4096
 v_cvt_pk_bf16_f32 v135, v86, v87
 mf v[116:119],v[184:187],a[24:27],v[116:119]
 tr v[212:213],v29,16384
 tr v[214:215],v29,20480
 mf v[120:123],v[184:187],a[40:43],v[120:123]
 v_exp_f32_e64 v90, v90
 mf v[124:127],v[184:187],a[56:59],v[124:127]
 mf a[224:227],v[216:219],v[144:147],a[224:227]
 v_exp_f32_e64 v91, v91
 mf a[228:231],v[216:219],v[148:151],a[228:231]
 v_exp_f32_e64 v92, v92
 mf a[232:235],v[216:219],v[152:155],a[232:235]
 ds_read_b64 v[184:185], v18 offset:4096
 v_cvt_pk_bf16_f32 v138, v88, v89
 mf a[236:239],v[216:219],v[156:159],a[236:239]
 ds_read_b64 v[186:187], v226 offset:4096
 mf v[112:115],v[188:191],a[12:15],v[112:115]
 v_exp_f32_e64 v93, v93
 mf v[116:119],v[188:191],a[28:31],v[116:119]
 tr v[216:217],v30,16384
 v_cvt_pk_bf16_f32 v139, v90, v91
 mf v[120:123],v[188:191],a[44:47],v[120:123]
 v_exp_f32_e64 v94, v94
 mf v[124:127],v[188:191],a[60:63],v[124:127]
 tr v[218:219],v30,20480
 mf a[240:243],v[220:223],v[144:147],a[240:243]
 v_exp_f32_e64 v95, v95
 mf a[244:247],v[220:223],v[148:151],a[244:247]
 ds_read_b64 v[188:189], v19 offset:4096
 v_cvt_pk_bf16_f32 v142, v92, v93
 mf a[248:251],v[220:223],v[152:155],a[248:251]
 ds_read_b64 v[190:191], v227 offset:4096
 v_cvt_pk_bf16_f32 v143, v94, v95
 mf a[252:255],v[220:223],v[156:159],a[252:255]
 s_waitcnt lgkmcnt(14)
 s_nop 0
 mf v[64:67],v[160:163],a[64:67],0
 v_exp_f32_e64 v96, v96
 mf v[68:71],v[160:163],a[80:83],0
 v_exp_f32_e64 v97, v97
 mf v[72:75],v[160:163],a[96:99],0
 tr v[220:221],v31,16384
 tr v[222:223],v31,20480
 mf v[76:79],v[160:163],a[112:115],0
 v_exp_f32_e64 v98, v98
 mf a[128:131],v[192:195],v[128:131],a[128:131]
 ds_read_b64 v[160:161], v16 offset:8192
 ds_read_b64 v[162:163], v224 offset:8192
 mf a[132:135],v[192:195],v[132:135],a[132:135]
 v_exp_f32_e64 v99, v99
 mf a[136:139],v[192:195],v[136:139],a[136:139]
 v_exp_f32_e64 v100, v100
 mf a[140:143],v[192:195],v[140:143],a[140:143]
 s_add_u32 m0, s29, 114688
 v_cvt_pk_bf16_f32 v144, v96, v97
 mf v[64:67],v[164:167],a[68:71],v[64:67]
 tr v[192:193],v24,24576
 tr v[194:195],v24,28672
 mf v[68:71],v[164:167],a[84:87],v[68:71]
 v_exp_f32_e64 v101, v101
 mf v[72:75],v[164:167],a[100:103],v[72:75]
 s_add_u32 s27, s34, 32768
 v_cvt_pk_bf16_f32 v145, v98, v99
 mf v[76:79],v[164:167],a[116:119],v[76:79]
 buffer_load_dwordx4 v12, s[8:11], s27 offen offset:0 lds
 mf a[144:147],v[196:199],v[128:131],a[144:147]
 v_exp_f32_e64 v102, v102
 mf a[148:151],v[196:199],v[132:135],a[148:151]
 v_exp_f32_e64 v103, v103
 mf a[152:155],v[196:199],v[136:139],a[152:155]
 ds_read_b64 v[164:165], v17 offset:8192
 ds_read_b64 v[166:167], v225 offset:8192
 mf a[156:159],v[196:199],v[140:143],a[156:159]
 buffer_load_dwordx4 v13, s[8:11], s27 offen offset:1024 lds
 mf v[64:67],v[168:171],a[72:75],v[64:67]
 v_exp_f32_e64 v104, v104
 mf v[68:71],v[168:171],a[88:91],v[68:71]
 tr v[196:197],v25,24576
 v_cvt_pk_bf16_f32 v148, v100, v101
 mf v[72:75],v[168:171],a[104:107],v[72:75]
 v_exp_f32_e64 v105, v105
 mf v[76:79],v[168:171],a[120:123],v[76:79]
 buffer_load_dwordx4 v14, s[8:11], s27 offen offset:2048 lds
 mf a[160:163],v[200:203],v[128:131],a[160:163]
 tr v[198:199],v25,28672
 v_cvt_pk_bf16_f32 v149, v102, v103
 mf a[164:167],v[200:203],v[132:135],a[164:167]
 v_exp_f32_e64 v106, v106
 mf a[168:171],v[200:203],v[136:139],a[168:171]
 v_exp_f32_e64 v107, v107
 mf a[172:175],v[200:203],v[140:143],a[172:175]
 buffer_load_dwordx4 v15, s[8:11], s27 offen offset:3072 lds
 mf v[64:67],v[172:175],a[76:79],v[64:67]
 v_exp_f32_e64 v108, v108
 mf v[68:71],v[172:175],a[92:95],v[68:71]
 ds_read_b64 v[168:169], v18 offset:8192
 v_cvt_pk_bf16_f32 v152, v104, v105
 mf v[72:75],v[172:175],a[108:111],v[72:75]
 v_exp_f32_e64 v109, v109
 mf v[76:79],v[172:175],a[124:127],v[76:79]
 ds_read_b64 v[170:171], v226 offset:8192
 v_cvt_pk_bf16_f32 v153, v106, v107
 mf a[176:179],v[204:207],v[128:131],a[176:179]
 v_exp_f32_e64 v110, v110
 mf a[180:183],v[204:207],v[132:135],a[180:183]
 tr v[200:201],v26,24576
 tr v[202:203],v26,28672
 mf a[184:187],v[204:207],v[136:139],a[184:187]
 v_exp_f32_e64 v111, v111
 mf a[188:191],v[204:207],v[140:143],a[188:191]
 ds_read_b64 v[172:173], v19 offset:8192
 ds_read_b64 v[174:175], v227 offset:8192
 mf v[44:47],v[40:43],v[128:131],v[44:47]
 v_exp_f32_e64 v112, v112
 mf v[48:51],v[40:43],v[132:135],v[48:51]
 tr v[204:205],v27,24576
 v_cvt_pk_bf16_f32 v156, v108, v109
 mf v[52:55],v[40:43],v[136:139],v[52:55]
 v_exp_f32_e64 v113, v113
 mf v[56:59],v[40:43],v[140:143],v[56:59]
 s_waitcnt lgkmcnt(14)
 s_nop 0
 mf v[80:83],v[176:179],a[64:67],0
 tr v[206:207],v27,28672
 v_cvt_pk_bf16_f32 v157, v110, v111
 mf v[84:87],v[176:179],a[80:83],0
 v_exp_f32_e64 v114, v114
 mf v[88:91],v[176:179],a[96:99],0
 mf v[92:95],v[176:179],a[112:115],0
 v_exp_f32_e64 v115, v115
 mf a[192:195],v[208:211],v[128:131],a[192:195]
 v_exp_f32_e64 v116, v116
 mf a[196:199],v[208:211],v[132:135],a[196:199]
 ds_read_b64 v[176:177], v16 offset:12288
 v_cvt_pk_bf16_f32 v146, v112, v113
 mf a[200:203],v[208:211],v[136:139],a[200:203]
 ds_read_b64 v[178:179], v224 offset:12288
 mf a[204:207],v[208:211],v[140:143],a[204:207]
 v_exp_f32_e64 v117, v117
 mf v[80:83],v[180:183],a[68:71],v[80:83]
 tr v[208:209],v28,24576
 v_cvt_pk_bf16_f32 v147, v114, v115
 mf v[84:87],v[180:183],a[84:87],v[84:87]
 v_exp_f32_e64 v118, v118
 mf v[88:91],v[180:183],a[100:103],v[88:91]
 tr v[210:211],v28,28672
 mf v[92:95],v[180:183],a[116:119],v[92:95]
 v_exp_f32_e64 v119, v119
 mf a[208:211],v[212:215],v[128:131],a[208:211]
 ds_read_b64 v[180:181], v17 offset:12288
 ds_read_b64 v[182:183], v225 offset:12288
 mf a[212:215],v[212:215],v[132:135],a[212:215]
 v_exp_f32_e64 v120, v120
 mf a[216:219],v[212:215],v[136:139],a[216:219]
 v_cvt_pk_bf16_f32 v150, v116, v117
 mf a[220:223],v[212:215],v[140:143],a[220:223]
 v_exp_f32_e64 v121, v121
 mf v[80:83],v[184:187],a[72:75],v[80:83]
 tr v[212:213],v29,24576
 v_cvt_pk_bf16_f32 v151, v118, v119
 mf v[84:87],v[184:187],a[88:91],v[84:87]
 tr v[214:215],v29,28672
 mf v[88:91],v[184:187],a[104:107],v[88:91]
 s_branch L_skip_6027
.p2align 12
L_stub_wa_6027:
 s_branch L_stub_wa_7583
L_stub_wr3_6027:
 s_branch L_stub_wr3_8099
L_stub_wr11_6027:
 s_branch L_stub_wr11_8099
 s_nop 0
L_skip_6027:
 v_exp_f32_e64 v122, v122
 mf v[92:95],v[184:187],a[120:123],v[92:95]
 mf a[224:227],v[216:219],v[128:131],a[224:227]
 v_exp_f32_e64 v123, v123
 mf a[228:231],v[216:219],v[132:135],a[228:231]
 v_exp_f32_e64 v124, v124
 mf a[232:235],v[216:219],v[136:139],a[232:235]
 ds_read_b64 v[184:185], v18 offset:12288
 v_cvt_pk_bf16_f32 v154, v120, v121
 mf a[236:239],v[216:219],v[140:143],a[236:239]
 ds_read_b64 v[186:187], v226 offset:12288
 mf v[80:83],v[188:191],a[76:79],v[80:83]
 v_exp_f32_e64 v125, v125
 mf v[84:87],v[188:191],a[92:95],v[84:87]
 tr v[216:217],v30,24576
 v_cvt_pk_bf16_f32 v155, v122, v123
 mf v[88:91],v[188:191],a[108:111],v[88:91]
 v_exp_f32_e64 v126, v126
 mf v[92:95],v[188:191],a[124:127],v[92:95]
 tr v[218:219],v30,28672
 mf a[240:243],v[220:223],v[128:131],a[240:243]
 v_exp_f32_e64 v127, v127
 mf a[244:247],v[220:223],v[132:135],a[244:247]
 ds_read_b64 v[188:189], v19 offset:12288
 v_cvt_pk_bf16_f32 v158, v124, v125
 mf a[248:251],v[220:223],v[136:139],a[248:251]
 ds_read_b64 v[190:191], v227 offset:12288
 v_cvt_pk_bf16_f32 v159, v126, v127
 mf a[252:255],v[220:223],v[140:143],a[252:255]
 s_waitcnt lgkmcnt(14)
 s_nop 0
 mf v[96:99],v[160:163],a[64:67],0
 v_exp_f32_e64 v64, v64
 mf v[100:103],v[160:163],a[80:83],0
 v_exp_f32_e64 v65, v65
 mf v[104:107],v[160:163],a[96:99],0
 tr v[220:221],v31,24576
 tr v[222:223],v31,28672
 mf v[108:111],v[160:163],a[112:115],0
 v_exp_f32_e64 v66, v66
 mf a[128:131],v[192:195],v[144:147],a[128:131]
 mf a[132:135],v[192:195],v[148:151],a[132:135]
 v_exp_f32_e64 v67, v67
 mf a[136:139],v[192:195],v[152:155],a[136:139]
 v_exp_f32_e64 v68, v68
 mf a[140:143],v[192:195],v[156:159],a[140:143]
 v_cvt_pk_bf16_f32 v128, v64, v65
 mf v[96:99],v[164:167],a[68:71],v[96:99]
 mf v[100:103],v[164:167],a[84:87],v[100:103]
 v_exp_f32_e64 v69, v69
 mf v[104:107],v[164:167],a[100:103],v[104:107]
 v_cvt_pk_bf16_f32 v129, v66, v67
 mf v[108:111],v[164:167],a[116:119],v[108:111]
 s_waitcnt vmcnt(17) lgkmcnt(0)
 s_barrier
 mf a[144:147],v[196:199],v[144:147],a[144:147]
 v_exp_f32_e64 v70, v70
 mf a[148:151],v[196:199],v[148:151],a[148:151]
 v_exp_f32_e64 v71, v71
 mf a[152:155],v[196:199],v[152:155],a[152:155]
 ds_read_b64 v[160:161], v16 offset:32768
 ds_read_b64 v[162:163], v224 offset:32768
 mf a[156:159],v[196:199],v[156:159],a[156:159]
 v_exp_f32_e64 v72, v72
 mf v[96:99],v[168:171],a[72:75],v[96:99]
 tr v[192:193],v24,49152
 v_cvt_pk_bf16_f32 v132, v68, v69
 mf v[100:103],v[168:171],a[88:91],v[100:103]
 v_exp_f32_e64 v73, v73
 mf v[104:107],v[168:171],a[104:107],v[104:107]
 tr v[194:195],v24,53248
 v_cvt_pk_bf16_f32 v133, v70, v71
 mf v[108:111],v[168:171],a[120:123],v[108:111]
 ds_read_b64 v[164:165], v17 offset:32768
 ds_read_b64 v[166:167], v225 offset:32768
 mf a[160:163],v[200:203],v[144:147],a[160:163]
 v_exp_f32_e64 v74, v74
 mf a[164:167],v[200:203],v[148:151],a[164:167]
 tr v[196:197],v25,49152
 tr v[198:199],v25,53248
 mf a[168:171],v[200:203],v[152:155],a[168:171]
 v_exp_f32_e64 v75, v75
 mf a[172:175],v[200:203],v[156:159],a[172:175]
 v_exp_f32_e64 v76, v76
 mf v[96:99],v[172:175],a[76:79],v[96:99]
 ds_read_b64 v[168:169], v18 offset:32768
 v_cvt_pk_bf16_f32 v136, v72, v73
 mf v[100:103],v[172:175],a[92:95],v[100:103]
 ds_read_b64 v[170:171], v226 offset:32768
 tr v[200:201],v26,49152
 mf v[104:107],v[172:175],a[108:111],v[104:107]
 v_exp_f32_e64 v77, v77
 mf v[108:111],v[172:175],a[124:127],v[108:111]
 tr v[202:203],v26,53248
 v_cvt_pk_bf16_f32 v137, v74, v75
 mf a[176:179],v[204:207],v[144:147],a[176:179]
 v_exp_f32_e64 v78, v78
 mf a[180:183],v[204:207],v[148:151],a[180:183]
 ds_read_b64 v[172:173], v19 offset:32768
 ds_read_b64 v[174:175], v227 offset:32768
 mf a[184:187],v[204:207],v[152:155],a[184:187]
 v_exp_f32_e64 v79, v79
 mf a[188:191],v[204:207],v[156:159],a[188:191]
 s_add_u32 m0, s29, 0
 s_nop 0
 s_add_u32 s26, s34, 65536
 mf v[44:47],v[40:43],v[144:147],v[44:47]
 buffer_load_dwordx4 v8, s[4:7], s26 offen offset:0 lds
 mf v[48:51],v[40:43],v[148:151],v[48:51]
 v_exp_f32_e64 v80, v80
 mf v[52:55],v[40:43],v[152:155],v[52:55]
 tr v[204:205],v27,49152
 v_cvt_pk_bf16_f32 v140, v76, v77
 mf v[56:59],v[40:43],v[156:159],v[56:59]
 v_exp_f32_e64 v81, v81
 mf v[112:115],v[176:179],a[64:67],0
 buffer_load_dwordx4 v9, s[4:7], s26 offen offset:1024 lds
 mf v[116:119],v[176:179],a[80:83],0
 tr v[206:207],v27,53248
 v_cvt_pk_bf16_f32 v141, v78, v79
 mf v[120:123],v[176:179],a[96:99],0
 v_exp_f32_e64 v82, v82
 mf v[124:127],v[176:179],a[112:115],0
 v_exp_f32_e64 v83, v83
 mf a[192:195],v[208:211],v[144:147],a[192:195]
 buffer_load_dwordx4 v10, s[4:7], s26 offen offset:2048 lds
 mf a[196:199],v[208:211],v[148:151],a[196:199]
 v_exp_f32_e64 v84, v84
 mf a[200:203],v[208:211],v[152:155],a[200:203]
 ds_read_b64 v[176:177], v16 offset:36864
 v_cvt_pk_bf16_f32 v130, v80, v81
 mf a[204:207],v[208:211],v[156:159],a[204:207]
 v_exp_f32_e64 v85, v85
 mf v[112:115],v[180:183],a[68:71],v[112:115]
 buffer_load_dwordx4 v11, s[4:7], s26 offen offset:3072 lds
 mf v[116:119],v[180:183],a[84:87],v[116:119]
 ds_read_b64 v[178:179], v224 offset:36864
 v_cvt_pk_bf16_f32 v131, v82, v83
 mf v[120:123],v[180:183],a[100:103],v[120:123]
 v_exp_f32_e64 v86, v86
 mf v[124:127],v[180:183],a[116:119],v[124:127]
 v_exp_f32_e64 v87, v87
 mf a[208:211],v[212:215],v[144:147],a[208:211]
 tr v[208:209],v28,49152
 tr v[210:211],v28,53248
 mf a[212:215],v[212:215],v[148:151],a[212:215]
 v_exp_f32_e64 v88, v88
 mf a[216:219],v[212:215],v[152:155],a[216:219]
 ds_read_b64 v[180:181], v17 offset:36864
 v_cvt_pk_bf16_f32 v134, v84, v85
 mf a[220:223],v[212:215],v[156:159],a[220:223]
 v_exp_f32_e64 v89, v89
 mf v[112:115],v[184:187],a[72:75],v[112:115]
 ds_read_b64 v[182:183], v225 offset:36864
 v_cvt_pk_bf16_f32 v135, v86, v87
 mf v[116:119],v[184:187],a[88:91],v[116:119]
 tr v[212:213],v29,49152
 tr v[214:215],v29,53248
 mf v[120:123],v[184:187],a[104:107],v[120:123]
 v_exp_f32_e64 v90, v90
 mf v[124:127],v[184:187],a[120:123],v[124:127]
 mf a[224:227],v[216:219],v[144:147],a[224:227]
 v_exp_f32_e64 v91, v91
 mf a[228:231],v[216:219],v[148:151],a[228:231]
 v_exp_f32_e64 v92, v92
 mf a[232:235],v[216:219],v[152:155],a[232:235]
 ds_read_b64 v[184:185], v18 offset:36864
 v_cvt_pk_bf16_f32 v138, v88, v89
 mf a[236:239],v[216:219],v[156:159],a[236:239]
 ds_read_b64 v[186:187], v226 offset:36864
 mf v[112:115],v[188:191],a[76:79],v[112:115]
 v_exp_f32_e64 v93, v93
 mf v[116:119],v[188:191],a[92:95],v[116:119]
 tr v[216:217],v30,49152
 v_cvt_pk_bf16_f32 v139, v90, v91
 mf v[120:123],v[188:191],a[108:111],v[120:123]
 v_exp_f32_e64 v94, v94
 mf v[124:127],v[188:191],a[124:127],v[124:127]
 tr v[218:219],v30,53248
 mf a[240:243],v[220:223],v[144:147],a[240:243]
 v_exp_f32_e64 v95, v95
 mf a[244:247],v[220:223],v[148:151],a[244:247]
 ds_read_b64 v[188:189], v19 offset:36864
 v_cvt_pk_bf16_f32 v142, v92, v93
 mf a[248:251],v[220:223],v[152:155],a[248:251]
 ds_read_b64 v[190:191], v227 offset:36864
 v_cvt_pk_bf16_f32 v143, v94, v95
 mf a[252:255],v[220:223],v[156:159],a[252:255]
 tr v[220:221],v31,49152
 tr v[222:223],v31,53248
 s_nop 7
 s_nop 1
 s_mov_b32 s31, 0x33800000
 s_mov_b32 s3, 0x53800000
 v_cmp_nle_f32 vcc, s31, v44
 s_or_b64 s[50:51], s[50:51], vcc
 v_cmp_nge_f32 vcc, s3, v44
 s_or_b64 s[50:51], s[50:51], vcc
 v_rcp_f32 v252, v44
 v_cmp_nle_f32 vcc, s31, v48
 s_or_b64 s[50:51], s[50:51], vcc
 v_cmp_nge_f32 vcc, s3, v48
 s_or_b64 s[50:51], s[50:51], vcc
 v_rcp_f32 v253, v48
 v_cmp_nle_f32 vcc, s31, v52
 s_or_b64 s[50:51], s[50:51], vcc
 v_cmp_nge_f32 vcc, s3, v52
 s_or_b64 s[50:51], s[50:51], vcc
 v_rcp_f32_e64 v254, v52
 v_cmp_nle_f32 vcc, s31, v56
 s_or_b64 s[50:51], s[50:51], vcc
 v_cmp_nge_f32 vcc, s3, v56
 s_or_b64 s[50:51], s[50:51], vcc
 v_rcp_f32 v255, v56
 s_add_u32 s31, s35, 0
 ar v224,a128
 ar v228,a144
 ar v225,a129
 ar v229,a145
 ar v226,a130
 ar v230,a146
 ar v227,a131
 ar v231,a147
 v_pk_mul_f32 v[224:225], v[224:225], v[252:253] op_sel:[0,0] op_sel_hi:[1,0]
 v_pk_mul_f32 v[226:227], v[226:227], v[252:253] op_sel:[0,0] op_sel_hi:[1,0]
 v_pk_mul_f32 v[228:229], v[228:229], v[252:253] op_sel:[0,0] op_sel_hi:[1,0]
 v_pk_mul_f32 v[230:231], v[230:231], v[252:253] op_sel:[0,0] op_sel_hi:[1,0]
 v_cvt_pk_bf16_f32 v232, v224, v225
 v_cvt_pk_bf16_f32 v233, v226, v227
 v_cvt_pk_bf16_f32 v234, v228, v229
 v_cvt_pk_bf16_f32 v235, v230, v231
 buffer_store_dwordx4 v[232:235], v60, s[12:15], s31 offen offset:0 sc1
 ar v236,a132
 ar v240,a148
 ar v237,a133
 ar v241,a149
 ar v238,a134
 ar v242,a150
 ar v239,a135
 ar v243,a151
 v_pk_mul_f32 v[236:237], v[236:237], v[252:253] op_sel:[0,1] op_sel_hi:[1,1]
 v_pk_mul_f32 v[238:239], v[238:239], v[252:253] op_sel:[0,1] op_sel_hi:[1,1]
 v_pk_mul_f32 v[240:241], v[240:241], v[252:253] op_sel:[0,1] op_sel_hi:[1,1]
 v_pk_mul_f32 v[242:243], v[242:243], v[252:253] op_sel:[0,1] op_sel_hi:[1,1]
 v_cvt_pk_bf16_f32 v244, v236, v237
 v_cvt_pk_bf16_f32 v245, v238, v239
 v_cvt_pk_bf16_f32 v246, v240, v241
 v_cvt_pk_bf16_f32 v247, v242, v243
 buffer_store_dwordx4 v[244:247], v60, s[12:15], s31 offen offset:1024 sc1
 ar v224,a136
 ar v228,a152
 ar v225,a137
 ar v229,a153
 ar v226,a138
 ar v230,a154
 ar v227,a139
 ar v231,a155
 v_pk_mul_f32 v[224:225], v[224:225], v[254:255] op_sel:[0,0] op_sel_hi:[1,0]
 v_pk_mul_f32 v[226:227], v[226:227], v[254:255] op_sel:[0,0] op_sel_hi:[1,0]
 v_pk_mul_f32 v[228:229], v[228:229], v[254:255] op_sel:[0,0] op_sel_hi:[1,0]
 v_pk_mul_f32 v[230:231], v[230:231], v[254:255] op_sel:[0,0] op_sel_hi:[1,0]
 v_cvt_pk_bf16_f32 v232, v224, v225
 v_cvt_pk_bf16_f32 v233, v226, v227
 v_cvt_pk_bf16_f32 v234, v228, v229
 v_cvt_pk_bf16_f32 v235, v230, v231
 buffer_store_dwordx4 v[232:235], v60, s[12:15], s31 offen offset:2048 sc1
 ar v236,a140
 ar v240,a156
 ar v237,a141
 ar v241,a157
 ar v238,a142
 ar v242,a158
 ar v239,a143
 ar v243,a159
 v_pk_mul_f32 v[236:237], v[236:237], v[254:255] op_sel:[0,1] op_sel_hi:[1,1]
 v_pk_mul_f32 v[238:239], v[238:239], v[254:255] op_sel:[0,1] op_sel_hi:[1,1]
 v_pk_mul_f32 v[240:241], v[240:241], v[254:255] op_sel:[0,1] op_sel_hi:[1,1]
 v_pk_mul_f32 v[242:243], v[242:243], v[254:255] op_sel:[0,1] op_sel_hi:[1,1]
 v_cvt_pk_bf16_f32 v244, v236, v237
 v_cvt_pk_bf16_f32 v245, v238, v239
 v_cvt_pk_bf16_f32 v246, v240, v241
 v_cvt_pk_bf16_f32 v247, v242, v243
 buffer_store_dwordx4 v[244:247], v60, s[12:15], s31 offen offset:3072 sc1
 s_add_u32 s31, s35, 131072
 ar v224,a160
 ar v228,a176
 ar v225,a161
 ar v229,a177
 ar v226,a162
 ar v230,a178
 ar v227,a163
 ar v231,a179
 v_pk_mul_f32 v[224:225], v[224:225], v[252:253] op_sel:[0,0] op_sel_hi:[1,0]
 v_pk_mul_f32 v[226:227], v[226:227], v[252:253] op_sel:[0,0] op_sel_hi:[1,0]
 v_pk_mul_f32 v[228:229], v[228:229], v[252:253] op_sel:[0,0] op_sel_hi:[1,0]
 v_pk_mul_f32 v[230:231], v[230:231], v[252:253] op_sel:[0,0] op_sel_hi:[1,0]
 v_cvt_pk_bf16_f32 v232, v224, v225
 v_cvt_pk_bf16_f32 v233, v226, v227
 v_cvt_pk_bf16_f32 v234, v228, v229
 v_cvt_pk_bf16_f32 v235, v230, v231
 buffer_store_dwordx4 v[232:235], v60, s[12:15], s31 offen offset:0 sc1
 ar v236,a164
 ar v240,a180
 ar v237,a165
 ar v241,a181
 ar v238,a166
 ar v242,a182
 ar v239,a167
 ar v243,a183
 v_pk_mul_f32 v[236:237], v[236:237], v[252:253] op_sel:[0,1] op_sel_hi:[1,1]
 v_pk_mul_f32 v[238:239], v[238:239], v[252:253] op_sel:[0,1] op_sel_hi:[1,1]
 v_pk_mul_f32 v[240:241], v[240:241], v[252:253] op_sel:[0,1] op_sel_hi:[1,1]
 v_pk_mul_f32 v[242:243], v[242:243], v[252:253] op_sel:[0,1] op_sel_hi:[1,1]
 v_cvt_pk_bf16_f32 v244, v236, v237
 v_cvt_pk_bf16_f32 v245, v238, v239
 v_cvt_pk_bf16_f32 v246, v240, v241
 v_cvt_pk_bf16_f32 v247, v242, v243
 buffer_store_dwordx4 v[244:247], v60, s[12:15], s31 offen offset:1024 sc1
 ar v224,a168
 ar v228,a184
 ar v225,a169
 ar v229,a185
 ar v226,a170
 ar v230,a186
 ar v227,a171
 ar v231,a187
 v_pk_mul_f32 v[224:225], v[224:225], v[254:255] op_sel:[0,0] op_sel_hi:[1,0]
 v_pk_mul_f32 v[226:227], v[226:227], v[254:255] op_sel:[0,0] op_sel_hi:[1,0]
 v_pk_mul_f32 v[228:229], v[228:229], v[254:255] op_sel:[0,0] op_sel_hi:[1,0]
 v_pk_mul_f32 v[230:231], v[230:231], v[254:255] op_sel:[0,0] op_sel_hi:[1,0]
 v_cvt_pk_bf16_f32 v232, v224, v225
 v_cvt_pk_bf16_f32 v233, v226, v227
 v_cvt_pk_bf16_f32 v234, v228, v229
 v_cvt_pk_bf16_f32 v235, v230, v231
 buffer_store_dwordx4 v[232:235], v60, s[12:15], s31 offen offset:2048 sc1
 ar v236,a172
 ar v240,a188
 ar v237,a173
 ar v241,a189
 ar v238,a174
 ar v242,a190
 ar v239,a175
 ar v243,a191
 v_pk_mul_f32 v[236:237], v[236:237], v[254:255] op_sel:[0,1] op_sel_hi:[1,1]
 v_pk_mul_f32 v[238:239], v[238:239], v[254:255] op_sel:[0,1] op_sel_hi:[1,1]
 v_pk_mul_f32 v[240:241], v[240:241], v[254:255] op_sel:[0,1] op_sel_hi:[1,1]
 v_pk_mul_f32 v[242:243], v[242:243], v[254:255] op_sel:[0,1] op_sel_hi:[1,1]
 v_cvt_pk_bf16_f32 v244, v236, v237
 v_cvt_pk_bf16_f32 v245, v238, v239
 v_cvt_pk_bf16_f32 v246, v240, v241
 v_cvt_pk_bf16_f32 v247, v242, v243
 buffer_store_dwordx4 v[244:247], v60, s[12:15], s31 offen offset:3072 sc1
 s_add_u32 s31, s35, 262144
 ar v224,a192
 ar v228,a208
 ar v225,a193
 ar v229,a209
 ar v226,a194
 ar v230,a210
 ar v227,a195
 ar v231,a211
 v_pk_mul_f32 v[224:225], v[224:225], v[252:253] op_sel:[0,0] op_sel_hi:[1,0]
 v_pk_mul_f32 v[226:227], v[226:227], v[252:253] op_sel:[0,0] op_sel_hi:[1,0]
 v_pk_mul_f32 v[228:229], v[228:229], v[252:253] op_sel:[0,0] op_sel_hi:[1,0]
 v_pk_mul_f32 v[230:231], v[230:231], v[252:253] op_sel:[0,0] op_sel_hi:[1,0]
 v_cvt_pk_bf16_f32 v232, v224, v225
 v_cvt_pk_bf16_f32 v233, v226, v227
 v_cvt_pk_bf16_f32 v234, v228, v229
 v_cvt_pk_bf16_f32 v235, v230, v231
 buffer_store_dwordx4 v[232:235], v60, s[12:15], s31 offen offset:0 sc1
 ar v236,a196
 ar v240,a212
 ar v237,a197
 ar v241,a213
 ar v238,a198
 ar v242,a214
 ar v239,a199
 ar v243,a215
 v_pk_mul_f32 v[236:237], v[236:237], v[252:253] op_sel:[0,1] op_sel_hi:[1,1]
 v_pk_mul_f32 v[238:239], v[238:239], v[252:253] op_sel:[0,1] op_sel_hi:[1,1]
 v_pk_mul_f32 v[240:241], v[240:241], v[252:253] op_sel:[0,1] op_sel_hi:[1,1]
 v_pk_mul_f32 v[242:243], v[242:243], v[252:253] op_sel:[0,1] op_sel_hi:[1,1]
 v_cvt_pk_bf16_f32 v244, v236, v237
 v_cvt_pk_bf16_f32 v245, v238, v239
 v_cvt_pk_bf16_f32 v246, v240, v241
 v_cvt_pk_bf16_f32 v247, v242, v243
 buffer_store_dwordx4 v[244:247], v60, s[12:15], s31 offen offset:1024 sc1
 ar v224,a200
 ar v228,a216
 ar v225,a201
 ar v229,a217
 ar v226,a202
 ar v230,a218
 ar v227,a203
 ar v231,a219
 v_pk_mul_f32 v[224:225], v[224:225], v[254:255] op_sel:[0,0] op_sel_hi:[1,0]
 v_pk_mul_f32 v[226:227], v[226:227], v[254:255] op_sel:[0,0] op_sel_hi:[1,0]
 v_pk_mul_f32 v[228:229], v[228:229], v[254:255] op_sel:[0,0] op_sel_hi:[1,0]
 v_pk_mul_f32 v[230:231], v[230:231], v[254:255] op_sel:[0,0] op_sel_hi:[1,0]
 v_cvt_pk_bf16_f32 v232, v224, v225
 v_cvt_pk_bf16_f32 v233, v226, v227
 v_cvt_pk_bf16_f32 v234, v228, v229
 v_cvt_pk_bf16_f32 v235, v230, v231
 buffer_store_dwordx4 v[232:235], v60, s[12:15], s31 offen offset:2048 sc1
 ar v236,a204
 ar v240,a220
 ar v237,a205
 ar v241,a221
 ar v238,a206
 ar v242,a222
 ar v239,a207
 ar v243,a223
 v_pk_mul_f32 v[236:237], v[236:237], v[254:255] op_sel:[0,1] op_sel_hi:[1,1]
 v_pk_mul_f32 v[238:239], v[238:239], v[254:255] op_sel:[0,1] op_sel_hi:[1,1]
 v_pk_mul_f32 v[240:241], v[240:241], v[254:255] op_sel:[0,1] op_sel_hi:[1,1]
 v_pk_mul_f32 v[242:243], v[242:243], v[254:255] op_sel:[0,1] op_sel_hi:[1,1]
 v_cvt_pk_bf16_f32 v244, v236, v237
 v_cvt_pk_bf16_f32 v245, v238, v239
 v_cvt_pk_bf16_f32 v246, v240, v241
 v_cvt_pk_bf16_f32 v247, v242, v243
 buffer_store_dwordx4 v[244:247], v60, s[12:15], s31 offen offset:3072 sc1
 s_add_u32 s31, s35, 393216
 ar v224,a224
 ar v228,a240
 ar v225,a225
 ar v229,a241
 ar v226,a226
 ar v230,a242
 ar v227,a227
 ar v231,a243
 v_pk_mul_f32 v[224:225], v[224:225], v[252:253] op_sel:[0,0] op_sel_hi:[1,0]
 v_pk_mul_f32 v[226:227], v[226:227], v[252:253] op_sel:[0,0] op_sel_hi:[1,0]
 v_pk_mul_f32 v[228:229], v[228:229], v[252:253] op_sel:[0,0] op_sel_hi:[1,0]
 v_pk_mul_f32 v[230:231], v[230:231], v[252:253] op_sel:[0,0] op_sel_hi:[1,0]
 v_cvt_pk_bf16_f32 v232, v224, v225
 v_cvt_pk_bf16_f32 v233, v226, v227
 v_cvt_pk_bf16_f32 v234, v228, v229
 v_cvt_pk_bf16_f32 v235, v230, v231
 buffer_store_dwordx4 v[232:235], v60, s[12:15], s31 offen offset:0 sc1
 ar v236,a228
 ar v240,a244
 ar v237,a229
 ar v241,a245
 ar v238,a230
 ar v242,a246
 ar v239,a231
 ar v243,a247
 v_pk_mul_f32 v[236:237], v[236:237], v[252:253] op_sel:[0,1] op_sel_hi:[1,1]
 v_pk_mul_f32 v[238:239], v[238:239], v[252:253] op_sel:[0,1] op_sel_hi:[1,1]
 v_pk_mul_f32 v[240:241], v[240:241], v[252:253] op_sel:[0,1] op_sel_hi:[1,1]
 v_pk_mul_f32 v[242:243], v[242:243], v[252:253] op_sel:[0,1] op_sel_hi:[1,1]
 v_cvt_pk_bf16_f32 v244, v236, v237
 v_cvt_pk_bf16_f32 v245, v238, v239
 v_cvt_pk_bf16_f32 v246, v240, v241
 v_cvt_pk_bf16_f32 v247, v242, v243
 buffer_store_dwordx4 v[244:247], v60, s[12:15], s31 offen offset:1024 sc1
 ar v224,a232
 ar v228,a248
 ar v225,a233
 ar v229,a249
 ar v226,a234
 ar v230,a250
 ar v227,a235
 ar v231,a251
 v_pk_mul_f32 v[224:225], v[224:225], v[254:255] op_sel:[0,0] op_sel_hi:[1,0]
 v_pk_mul_f32 v[226:227], v[226:227], v[254:255] op_sel:[0,0] op_sel_hi:[1,0]
 v_pk_mul_f32 v[228:229], v[228:229], v[254:255] op_sel:[0,0] op_sel_hi:[1,0]
 v_pk_mul_f32 v[230:231], v[230:231], v[254:255] op_sel:[0,0] op_sel_hi:[1,0]
 v_cvt_pk_bf16_f32 v232, v224, v225
 v_cvt_pk_bf16_f32 v233, v226, v227
 v_cvt_pk_bf16_f32 v234, v228, v229
 v_cvt_pk_bf16_f32 v235, v230, v231
 buffer_store_dwordx4 v[232:235], v60, s[12:15], s31 offen offset:2048 sc1
 ar v236,a236
 ar v240,a252
 ar v237,a237
 ar v241,a253
 ar v238,a238
 ar v242,a254
 ar v239,a239
 ar v243,a255
 v_pk_mul_f32 v[236:237], v[236:237], v[254:255] op_sel:[0,1] op_sel_hi:[1,1]
 v_pk_mul_f32 v[238:239], v[238:239], v[254:255] op_sel:[0,1] op_sel_hi:[1,1]
 v_pk_mul_f32 v[240:241], v[240:241], v[254:255] op_sel:[0,1] op_sel_hi:[1,1]
 v_pk_mul_f32 v[242:243], v[242:243], v[254:255] op_sel:[0,1] op_sel_hi:[1,1]
 v_cvt_pk_bf16_f32 v244, v236, v237
 v_cvt_pk_bf16_f32 v245, v238, v239
 v_cvt_pk_bf16_f32 v246, v240, v241
 v_cvt_pk_bf16_f32 v247, v242, v243
 buffer_store_dwordx4 v[244:247], v60, s[12:15], s31 offen offset:3072 sc1
 v_xor_b32 v224, 32, v16
 v_xor_b32 v225, 32, v17
 v_xor_b32 v226, 32, v18
 v_xor_b32 v227, 32, v19
 v_xor_b32 v228, 32, v20
 v_xor_b32 v229, 32, v21
 v_xor_b32_e64 v230, 32, v22
 v_xor_b32 v231, 32, v23
 s_waitcnt lgkmcnt(14)
 mf v[64:67],v[160:163],a[64:67],0
 v_exp_f32_e64 v96, v96
 mf v[68:71],v[160:163],a[80:83],0
 v_exp_f32_e64 v97, v97
 mf v[72:75],v[160:163],a[96:99],0
 s_add_u32 m0, s29, 16384
 s_add_u32 s27, s34, 49152
 mf v[76:79],v[160:163],a[112:115],0
 buffer_load_dwordx4 v12, s[8:11], s27 offen offset:0 lds
 mf a[128:131],v[192:195],v[128:131],0
 v_exp_f32_e64 v98, v98
 mf a[132:135],v[192:195],v[132:135],0
 v_exp_f32_e64 v99, v99
 mf a[136:139],v[192:195],v[136:139],0
 v_exp_f32_e64 v100, v100
 mf a[140:143],v[192:195],v[140:143],0
 buffer_load_dwordx4 v13, s[8:11], s27 offen offset:1024 lds
 mf v[64:67],v[164:167],a[68:71],v[64:67]
 ds_read_b64 v[160:161], v16 offset:40960
 v_cvt_pk_bf16_f32 v144, v96, v97
 mf v[68:71],v[164:167],a[84:87],v[68:71]
 v_exp_f32_e64 v101, v101
 mf v[72:75],v[164:167],a[100:103],v[72:75]
 ds_read_b64 v[162:163], v224 offset:40960
 v_cvt_pk_bf16_f32 v145, v98, v99
 mf v[76:79],v[164:167],a[116:119],v[76:79]
 buffer_load_dwordx4 v14, s[8:11], s27 offen offset:2048 lds
 mf a[144:147],v[196:199],v[128:131],0
 s_branch L_skip_6554
.p2align 12
L_stub_wa_6554:
 s_branch L_stub_wa_8099
L_stub_wr3_6554:
 s_branch L_stub_wr3_8628
L_stub_wr11_6554:
 s_branch L_stub_wr11_8628
 s_nop 0
L_skip_6554:
 v_exp_f32_e64 v102, v102
 mf a[148:151],v[196:199],v[132:135],0
 v_exp_f32_e64 v103, v103
 mf a[152:155],v[196:199],v[136:139],0
 tr v[192:193],v24,57344
 tr v[194:195],v24,61440
 mf a[156:159],v[196:199],v[140:143],0
 buffer_load_dwordx4 v15, s[8:11], s27 offen offset:3072 lds
 mf v[64:67],v[168:171],a[72:75],v[64:67]
 v_exp_f32_e64 v104, v104
 mf v[68:71],v[168:171],a[88:91],v[68:71]
 ds_read_b64 v[164:165], v17 offset:40960
 v_cvt_pk_bf16_f32 v148, v100, v101
 mf v[72:75],v[168:171],a[104:107],v[72:75]
 v_exp_f32_e64 v105, v105
 mf v[76:79],v[168:171],a[120:123],v[76:79]
 ds_read_b64 v[166:167], v225 offset:40960
 v_cvt_pk_bf16_f32 v149, v102, v103
 mf a[160:163],v[200:203],v[128:131],0
 v_exp_f32_e64 v106, v106
 mf a[164:167],v[200:203],v[132:135],0
 tr v[196:197],v25,57344
 tr v[198:199],v25,61440
 mf a[168:171],v[200:203],v[136:139],0
 v_exp_f32_e64 v107, v107
 mf a[172:175],v[200:203],v[140:143],0
 v_exp_f32_e64 v108, v108
 mf v[64:67],v[172:175],a[76:79],v[64:67]
 ds_read_b64 v[168:169], v18 offset:40960
 v_cvt_pk_bf16_f32 v152, v104, v105
 mf v[68:71],v[172:175],a[92:95],v[68:71]
 ds_read_b64 v[170:171], v226 offset:40960
 tr v[200:201],v26,57344
 mf v[72:75],v[172:175],a[108:111],v[72:75]
 v_exp_f32_e64 v109, v109
 mf v[76:79],v[172:175],a[124:127],v[76:79]
 tr v[202:203],v26,61440
 v_cvt_pk_bf16_f32 v153, v106, v107
 mf a[176:179],v[204:207],v[128:131],0
 v_exp_f32_e64 v110, v110
 mf a[180:183],v[204:207],v[132:135],0
 ds_read_b64 v[172:173], v19 offset:40960
 ds_read_b64 v[174:175], v227 offset:40960
 mf a[184:187],v[204:207],v[136:139],0
 v_exp_f32_e64 v111, v111
 mf a[188:191],v[204:207],v[140:143],0
 mf v[44:47],v[40:43],v[128:131],0
 v_exp_f32_e64 v112, v112
 mf v[48:51],v[40:43],v[132:135],0
 tr v[204:205],v27,57344
 v_cvt_pk_bf16_f32 v156, v108, v109
 mf v[52:55],v[40:43],v[136:139],0
 v_exp_f32_e64 v113, v113
 mf v[56:59],v[40:43],v[140:143],0
 tr v[206:207],v27,61440
 v_cvt_pk_bf16_f32 v157, v110, v111
 mf v[80:83],v[176:179],a[64:67],0
 mf v[84:87],v[176:179],a[80:83],0
 v_exp_f32_e64 v114, v114
 mf v[88:91],v[176:179],a[96:99],0
 mf v[92:95],v[176:179],a[112:115],0
 s_waitcnt lgkmcnt(14)
 s_nop 0
 mf a[192:195],v[208:211],v[128:131],0
 v_exp_f32_e64 v115, v115
 mf a[196:199],v[208:211],v[132:135],0
 v_exp_f32_e64 v116, v116
 mf a[200:203],v[208:211],v[136:139],0
 ds_read_b64 v[176:177], v16 offset:45056
 v_cvt_pk_bf16_f32 v146, v112, v113
 mf a[204:207],v[208:211],v[140:143],0
 v_exp_f32_e64 v117, v117
 mf v[80:83],v[180:183],a[68:71],v[80:83]
 ds_read_b64 v[178:179], v224 offset:45056
 v_cvt_pk_bf16_f32 v147, v114, v115
 mf v[84:87],v[180:183],a[84:87],v[84:87]
 v_exp_f32_e64 v118, v118
 mf v[88:91],v[180:183],a[100:103],v[88:91]
 tr v[208:209],v28,57344
 tr v[210:211],v28,61440
 mf v[92:95],v[180:183],a[116:119],v[92:95]
 v_exp_f32_e64 v119, v119
 mf a[208:211],v[212:215],v[128:131],0
 ds_read_b64 v[180:181], v17 offset:45056
 ds_read_b64 v[182:183], v225 offset:45056
 mf a[212:215],v[212:215],v[132:135],0
 v_exp_f32_e64 v120, v120
 mf a[216:219],v[212:215],v[136:139],0
 v_cvt_pk_bf16_f32 v150, v116, v117
 mf a[220:223],v[212:215],v[140:143],0
 v_exp_f32_e64 v121, v121
 mf v[80:83],v[184:187],a[72:75],v[80:83]
 tr v[212:213],v29,57344
 v_cvt_pk_bf16_f32 v151, v118, v119
 mf v[84:87],v[184:187],a[88:91],v[84:87]
 tr v[214:215],v29,61440
 mf v[88:91],v[184:187],a[104:107],v[88:91]
 v_exp_f32_e64 v122, v122
 mf v[92:95],v[184:187],a[120:123],v[92:95]
 mf a[224:227],v[216:219],v[128:131],0
 v_exp_f32_e64 v123, v123
 mf a[228:231],v[216:219],v[132:135],0
 v_exp_f32_e64 v124, v124
 mf a[232:235],v[216:219],v[136:139],0
 ds_read_b64 v[184:185], v18 offset:45056
 v_cvt_pk_bf16_f32 v154, v120, v121
 mf a[236:239],v[216:219],v[140:143],0
 ds_read_b64 v[186:187], v226 offset:45056
 mf v[80:83],v[188:191],a[76:79],v[80:83]
 v_exp_f32_e64 v125, v125
 mf v[84:87],v[188:191],a[92:95],v[84:87]
 tr v[216:217],v30,57344
 v_cvt_pk_bf16_f32 v155, v122, v123
 mf v[88:91],v[188:191],a[108:111],v[88:91]
 v_exp_f32_e64 v126, v126
 mf v[92:95],v[188:191],a[124:127],v[92:95]
 tr v[218:219],v30,61440
 mf a[240:243],v[220:223],v[128:131],0
 v_exp_f32_e64 v127, v127
 mf a[244:247],v[220:223],v[132:135],0
 ds_read_b64 v[188:189], v19 offset:45056
 v_cvt_pk_bf16_f32 v158, v124, v125
 mf a[248:251],v[220:223],v[136:139],0
 ds_read_b64 v[190:191], v227 offset:45056
 v_cvt_pk_bf16_f32 v159, v126, v127
 mf a[252:255],v[220:223],v[140:143],0
 mf v[96:99],v[160:163],a[64:67],0
 v_exp_f32_e64 v64, v64
 mf v[100:103],v[160:163],a[80:83],0
 v_exp_f32_e64 v65, v65
 mf v[104:107],v[160:163],a[96:99],0
 tr v[220:221],v31,57344
 tr v[222:223],v31,61440
 mf v[108:111],v[160:163],a[112:115],0
 s_waitcnt lgkmcnt(14)
 s_nop 0
 mf a[128:131],v[192:195],v[144:147],a[128:131]
 v_exp_f32_e64 v66, v66
 mf a[132:135],v[192:195],v[148:151],a[132:135]
 v_exp_f32_e64 v67, v67
 mf a[136:139],v[192:195],v[152:155],a[136:139]
 v_exp_f32_e64 v68, v68
 mf a[140:143],v[192:195],v[156:159],a[140:143]
 v_cvt_pk_bf16_f32 v128, v64, v65
 mf v[96:99],v[164:167],a[68:71],v[96:99]
 mf v[100:103],v[164:167],a[84:87],v[100:103]
 v_exp_f32_e64 v69, v69
 mf v[104:107],v[164:167],a[100:103],v[104:107]
 v_cvt_pk_bf16_f32 v129, v66, v67
 mf v[108:111],v[164:167],a[116:119],v[108:111]
 s_waitcnt vmcnt(32) lgkmcnt(0)
 s_barrier
 mf a[144:147],v[196:199],v[144:147],a[144:147]
 v_exp_f32_e64 v70, v70
 mf a[148:151],v[196:199],v[148:151],a[148:151]
 v_exp_f32_e64 v71, v71
 mf a[152:155],v[196:199],v[152:155],a[152:155]
 ds_read_b64 v[160:161], v20 offset:0
 ds_read_b64 v[162:163], v228 offset:0
 mf a[156:159],v[196:199],v[156:159],a[156:159]
 v_exp_f32_e64 v72, v72
 mf v[96:99],v[168:171],a[72:75],v[96:99]
 tr v[192:193],v32,16384
 v_cvt_pk_bf16_f32 v132, v68, v69
 mf v[100:103],v[168:171],a[88:91],v[100:103]
 v_exp_f32_e64 v73, v73
 mf v[104:107],v[168:171],a[104:107],v[104:107]
 tr v[194:195],v32,20480
 v_cvt_pk_bf16_f32 v133, v70, v71
 mf v[108:111],v[168:171],a[120:123],v[108:111]
 ds_read_b64 v[164:165], v21 offset:0
 ds_read_b64 v[166:167], v229 offset:0
 mf a[160:163],v[200:203],v[144:147],a[160:163]
 v_exp_f32_e64 v74, v74
 mf a[164:167],v[200:203],v[148:151],a[164:167]
 tr v[196:197],v33,16384
 tr v[198:199],v33,20480
 mf a[168:171],v[200:203],v[152:155],a[168:171]
 v_exp_f32_e64 v75, v75
 mf a[172:175],v[200:203],v[156:159],a[172:175]
 v_exp_f32_e64 v76, v76
 mf v[96:99],v[172:175],a[76:79],v[96:99]
 ds_read_b64 v[168:169], v22 offset:0
 v_cvt_pk_bf16_f32 v136, v72, v73
 mf v[100:103],v[172:175],a[92:95],v[100:103]
 ds_read_b64 v[170:171], v230 offset:0
 tr v[200:201],v34,16384
 mf v[104:107],v[172:175],a[108:111],v[104:107]
 v_exp_f32_e64 v77, v77
 mf v[108:111],v[172:175],a[124:127],v[108:111]
 tr v[202:203],v34,20480
 v_cvt_pk_bf16_f32 v137, v74, v75
 mf a[176:179],v[204:207],v[144:147],a[176:179]
 v_exp_f32_e64 v78, v78
 mf a[180:183],v[204:207],v[148:151],a[180:183]
 ds_read_b64 v[172:173], v23 offset:0
 ds_read_b64 v[174:175], v231 offset:0
 mf a[184:187],v[204:207],v[152:155],a[184:187]
 v_exp_f32_e64 v79, v79
 mf a[188:191],v[204:207],v[156:159],a[188:191]
 s_add_u32 m0, s29, 32768
 s_add_u32 s26, s34, 81920
 mf v[44:47],v[40:43],v[144:147],v[44:47]
 buffer_load_dwordx4 v8, s[4:7], s26 offen offset:0 lds
 mf v[48:51],v[40:43],v[148:151],v[48:51]
 v_exp_f32_e64 v80, v80
 mf v[52:55],v[40:43],v[152:155],v[52:55]
 tr v[204:205],v35,16384
 v_cvt_pk_bf16_f32 v140, v76, v77
 mf v[56:59],v[40:43],v[156:159],v[56:59]
 v_exp_f32_e64 v81, v81
 mf v[112:115],v[176:179],a[64:67],0
 buffer_load_dwordx4 v9, s[4:7], s26 offen offset:1024 lds
 mf v[116:119],v[176:179],a[80:83],0
 tr v[206:207],v35,20480
 v_cvt_pk_bf16_f32 v141, v78, v79
 mf v[120:123],v[176:179],a[96:99],0
 v_exp_f32_e64 v82, v82
 mf v[124:127],v[176:179],a[112:115],0
 v_exp_f32_e64 v83, v83
 mf a[192:195],v[208:211],v[144:147],a[192:195]
 buffer_load_dwordx4 v10, s[4:7], s26 offen offset:2048 lds
 mf a[196:199],v[208:211],v[148:151],a[196:199]
 v_exp_f32_e64 v84, v84
 mf a[200:203],v[208:211],v[152:155],a[200:203]
 ds_read_b64 v[176:177], v20 offset:4096
 v_cvt_pk_bf16_f32 v130, v80, v81
 mf a[204:207],v[208:211],v[156:159],a[204:207]
 v_exp_f32_e64 v85, v85
 mf v[112:115],v[180:183],a[68:71],v[112:115]
 buffer_load_dwordx4 v11, s[4:7], s26 offen offset:3072 lds
 mf v[116:119],v[180:183],a[84:87],v[116:119]
 ds_read_b64 v[178:179], v228 offset:4096
 v_cvt_pk_bf16_f32 v131, v82, v83
 mf v[120:123],v[180:183],a[100:103],v[120:123]
 v_exp_f32_e64 v86, v86
 mf v[124:127],v[180:183],a[116:119],v[124:127]
 v_exp_f32_e64 v87, v87
 mf a[208:211],v[212:215],v[144:147],a[208:211]
 tr v[208:209],v36,16384
 tr v[210:211],v36,20480
 mf a[212:215],v[212:215],v[148:151],a[212:215]
 v_exp_f32_e64 v88, v88
 mf a[216:219],v[212:215],v[152:155],a[216:219]
 ds_read_b64 v[180:181], v21 offset:4096
 v_cvt_pk_bf16_f32 v134, v84, v85
 mf a[220:223],v[212:215],v[156:159],a[220:223]
 v_exp_f32_e64 v89, v89
 mf v[112:115],v[184:187],a[72:75],v[112:115]
 ds_read_b64 v[182:183], v229 offset:4096
 v_cvt_pk_bf16_f32 v135, v86, v87
 mf v[116:119],v[184:187],a[88:91],v[116:119]
 tr v[212:213],v37,16384
 tr v[214:215],v37,20480
 mf v[120:123],v[184:187],a[104:107],v[120:123]
 v_exp_f32_e64 v90, v90
 mf v[124:127],v[184:187],a[120:123],v[124:127]
 mf a[224:227],v[216:219],v[144:147],a[224:227]
 v_exp_f32_e64 v91, v91
 mf a[228:231],v[216:219],v[148:151],a[228:231]
 v_exp_f32_e64 v92, v92
 mf a[232:235],v[216:219],v[152:155],a[232:235]
 ds_read_b64 v[184:185], v22 offset:4096
 v_cvt_pk_bf16_f32 v138, v88, v89
 mf a[236:239],v[216:219],v[156:159],a[236:239]
 ds_read_b64 v[186:187], v230 offset:4096
 mf v[112:115],v[188:191],a[76:79],v[112:115]
 v_exp_f32_e64 v93, v93
 mf v[116:119],v[188:191],a[92:95],v[116:119]
 tr v[216:217],v38,16384
 v_cvt_pk_bf16_f32 v139, v90, v91
 mf v[120:123],v[188:191],a[108:111],v[120:123]
 v_exp_f32_e64 v94, v94
 mf v[124:127],v[188:191],a[124:127],v[124:127]
 tr v[218:219],v38,20480
 mf a[240:243],v[220:223],v[144:147],a[240:243]
 v_exp_f32_e64 v95, v95
 mf a[244:247],v[220:223],v[148:151],a[244:247]
 ds_read_b64 v[188:189], v23 offset:4096
 v_cvt_pk_bf16_f32 v142, v92, v93
 mf a[248:251],v[220:223],v[152:155],a[248:251]
 ds_read_b64 v[190:191], v231 offset:4096
 v_cvt_pk_bf16_f32 v143, v94, v95
 mf a[252:255],v[220:223],v[156:159],a[252:255]
 s_waitcnt lgkmcnt(14)
 s_nop 0
 mf v[64:67],v[160:163],a[64:67],0
 v_exp_f32_e64 v96, v96
 mf v[68:71],v[160:163],a[80:83],0
 v_exp_f32_e64 v97, v97
 mf v[72:75],v[160:163],a[96:99],0
 tr v[220:221],v39,16384
 tr v[222:223],v39,20480
 mf v[76:79],v[160:163],a[112:115],0
 v_exp_f32_e64 v98, v98
 mf a[128:131],v[192:195],v[128:131],a[128:131]
 ds_read_b64 v[160:161], v20 offset:8192
 ds_read_b64 v[162:163], v228 offset:8192
 mf a[132:135],v[192:195],v[132:135],a[132:135]
 v_exp_f32_e64 v99, v99
 mf a[136:139],v[192:195],v[136:139],a[136:139]
 v_exp_f32_e64 v100, v100
 mf a[140:143],v[192:195],v[140:143],a[140:143]
 s_add_u32 m0, s29, 49152
 v_cvt_pk_bf16_f32 v144, v96, v97
 mf v[64:67],v[164:167],a[68:71],v[64:67]
 tr v[192:193],v32,24576
 tr v[194:195],v32,28672
 mf v[68:71],v[164:167],a[84:87],v[68:71]
 v_exp_f32_e64 v101, v101
 mf v[72:75],v[164:167],a[100:103],v[72:75]
 s_add_u32 s27, s34, 65536
 v_cvt_pk_bf16_f32 v145, v98, v99
 mf v[76:79],v[164:167],a[116:119],v[76:79]
 buffer_load_dwordx4 v12, s[8:11], s27 offen offset:0 lds
 mf a[144:147],v[196:199],v[128:131],a[144:147]
 v_exp_f32_e64 v102, v102
 mf a[148:151],v[196:199],v[132:135],a[148:151]
 v_exp_f32_e64 v103, v103
 mf a[152:155],v[196:199],v[136:139],a[152:155]
 ds_read_b64 v[164:165], v21 offset:8192
 ds_read_b64 v[166:167], v229 offset:8192
 mf a[156:159],v[196:199],v[140:143],a[156:159]
 buffer_load_dwordx4 v13, s[8:11], s27 offen offset:1024 lds
 mf v[64:67],v[168:171],a[72:75],v[64:67]
 v_exp_f32_e64 v104, v104
 mf v[68:71],v[168:171],a[88:91],v[68:71]
 tr v[196:197],v33,24576
 v_cvt_pk_bf16_f32 v148, v100, v101
 mf v[72:75],v[168:171],a[104:107],v[72:75]
 v_exp_f32_e64 v105, v105
 mf v[76:79],v[168:171],a[120:123],v[76:79]
 buffer_load_dwordx4 v14, s[8:11], s27 offen offset:2048 lds
 mf a[160:163],v[200:203],v[128:131],a[160:163]
 tr v[198:199],v33,28672
 v_cvt_pk_bf16_f32 v149, v102, v103
 mf a[164:167],v[200:203],v[132:135],a[164:167]
 v_exp_f32_e64 v106, v106
 mf a[168:171],v[200:203],v[136:139],a[168:171]
 v_exp_f32_e64 v107, v107
 mf a[172:175],v[200:203],v[140:143],a[172:175]
 buffer_load_dwordx4 v15, s[8:11], s27 offen offset:3072 lds
 mf v[64:67],v[172:175],a[76:79],v[64:67]
 v_exp_f32_e64 v108, v108
 mf v[68:71],v[172:175],a[92:95],v[68:71]
 ds_read_b64 v[168:169], v22 offset:8192
 v_cvt_pk_bf16_f32 v152, v104, v105
 mf v[72:75],v[172:175],a[108:111],v[72:75]
 v_exp_f32_e64 v109, v109
 mf v[76:79],v[172:175],a[124:127],v[76:79]
 ds_read_b64 v[170:171], v230 offset:8192
 v_cvt_pk_bf16_f32 v153, v106, v107
 mf a[176:179],v[204:207],v[128:131],a[176:179]
 v_exp_f32_e64 v110, v110
 mf a[180:183],v[204:207],v[132:135],a[180:183]
 tr v[200:201],v34,24576
 tr v[202:203],v34,28672
 mf a[184:187],v[204:207],v[136:139],a[184:187]
 v_exp_f32_e64 v111, v111
 mf a[188:191],v[204:207],v[140:143],a[188:191]
 ds_read_b64 v[172:173], v23 offset:8192
 ds_read_b64 v[174:175], v231 offset:8192
 mf v[44:47],v[40:43],v[128:131],v[44:47]
 v_exp_f32_e64 v112, v112
 mf v[48:51],v[40:43],v[132:135],v[48:51]
 tr v[204:205],v35,24576
 v_cvt_pk_bf16_f32 v156, v108, v109
 mf v[52:55],v[40:43],v[136:139],v[52:55]
 v_exp_f32_e64 v113, v113
 mf v[56:59],v[40:43],v[140:143],v[56:59]
 s_waitcnt lgkmcnt(14)
 s_nop 0
 mf v[80:83],v[176:179],a[64:67],0
 tr v[206:207],v35,28672
 v_cvt_pk_bf16_f32 v157, v110, v111
 mf v[84:87],v[176:179],a[80:83],0
 v_exp_f32_e64 v114, v114
 mf v[88:91],v[176:179],a[96:99],0
 mf v[92:95],v[176:179],a[112:115],0
 v_exp_f32_e64 v115, v115
 mf a[192:195],v[208:211],v[128:131],a[192:195]
 v_exp_f32_e64 v116, v116
 mf a[196:199],v[208:211],v[132:135],a[196:199]
 ds_read_b64 v[176:177], v20 offset:12288
 v_cvt_pk_bf16_f32 v146, v112, v113
 mf a[200:203],v[208:211],v[136:139],a[200:203]
 ds_read_b64 v[178:179], v228 offset:12288
 mf a[204:207],v[208:211],v[140:143],a[204:207]
 v_exp_f32_e64 v117, v117
 mf v[80:83],v[180:183],a[68:71],v[80:83]
 tr v[208:209],v36,24576
 v_cvt_pk_bf16_f32 v147, v114, v115
 mf v[84:87],v[180:183],a[84:87],v[84:87]
 v_exp_f32_e64 v118, v118
 mf v[88:91],v[180:183],a[100:103],v[88:91]
 tr v[210:211],v36,28672
 mf v[92:95],v[180:183],a[116:119],v[92:95]
 v_exp_f32_e64 v119, v119
 mf a[208:211],v[212:215],v[128:131],a[208:211]
 ds_read_b64 v[180:181], v21 offset:12288
 ds_read_b64 v[182:183], v229 offset:12288
 mf a[212:215],v[212:215],v[132:135],a[212:215]
 v_exp_f32_e64 v120, v120
 mf a[216:219],v[212:215],v[136:139],a[216:219]
 v_cvt_pk_bf16_f32 v150, v116, v117
 mf a[220:223],v[212:215],v[140:143],a[220:223]
 v_exp_f32_e64 v121, v121
 mf v[80:83],v[184:187],a[72:75],v[80:83]
 tr v[212:213],v37,24576
 v_cvt_pk_bf16_f32 v151, v118, v119
 mf v[84:87],v[184:187],a[88:91],v[84:87]
 tr v[214:215],v37,28672
 mf v[88:91],v[184:187],a[104:107],v[88:91]
 v_exp_f32_e64 v122, v122
 mf v[92:95],v[184:187],a[120:123],v[92:95]
 mf a[224:227],v[216:219],v[128:131],a[224:227]
 v_exp_f32_e64 v123, v123
 mf a[228:231],v[216:219],v[132:135],a[228:231]
 v_exp_f32_e64 v124, v124
 mf a[232:235],v[216:219],v[136:139],a[232:235]
 ds_read_b64 v[184:185], v22 offset:12288
 v_cvt_pk_bf16_f32 v154, v120, v121
 mf a[236:239],v[216:219],v[140:143],a[236:239]
 ds_read_b64 v[186:187], v230 offset:12288
 mf v[80:83],v[188:191],a[76:79],v[80:83]
 v_exp_f32_e64 v125, v125
 mf v[84:87],v[188:191],a[92:95],v[84:87]
 tr v[216:217],v38,24576
 v_cvt_pk_bf16_f32 v155, v122, v123
 mf v[88:91],v[188:191],a[108:111],v[88:91]
 v_exp_f32_e64 v126, v126
 mf v[92:95],v[188:191],a[124:127],v[92:95]
 tr v[218:219],v38,28672
 mf a[240:243],v[220:223],v[128:131],a[240:243]
 v_exp_f32_e64 v127, v127
 mf a[244:247],v[220:223],v[132:135],a[244:247]
 ds_read_b64 v[188:189], v23 offset:12288
 v_cvt_pk_bf16_f32 v158, v124, v125
 mf a[248:251],v[220:223],v[136:139],a[248:251]
 ds_read_b64 v[190:191], v231 offset:12288
 v_cvt_pk_bf16_f32 v159, v126, v127
 mf a[252:255],v[220:223],v[140:143],a[252:255]
 s_waitcnt lgkmcnt(14)
 s_nop 0
 mf v[96:99],v[160:163],a[64:67],0
 v_exp_f32_e64 v64, v64
 mf v[100:103],v[160:163],a[80:83],0
 v_exp_f32_e64 v65, v65
 mf v[104:107],v[160:163],a[96:99],0
 tr v[220:221],v39,24576
 tr v[222:223],v39,28672
 mf v[108:111],v[160:163],a[112:115],0
 v_exp_f32_e64 v66, v66
 mf a[128:131],v[192:195],v[144:147],a[128:131]
 mf a[132:135],v[192:195],v[148:151],a[132:135]
 v_exp_f32_e64 v67, v67
 mf a[136:139],v[192:195],v[152:155],a[136:139]
 v_exp_f32_e64 v68, v68
 mf a[140:143],v[192:195],v[156:159],a[140:143]
 v_cvt_pk_bf16_f32 v128, v64, v65
 mf v[96:99],v[164:167],a[68:71],v[96:99]
 mf v[100:103],v[164:167],a[84:87],v[100:103]
 v_exp_f32_e64 v69, v69
 mf v[104:107],v[164:167],a[100:103],v[104:107]
 v_cvt_pk_bf16_f32 v129, v66, v67
 mf v[108:111],v[164:167],a[116:119],v[108:111]
 s_cmp_eq_u32 s20, 0
 s_cbranch_scc1 L_stub_wr19_7583
 s_cmp_eq_u32 s20, 1
 s_cbranch_scc1 L_stub_wr19_8099
 s_cmp_eq_u32 s20, 2
 s_cbranch_scc1 L_stub_wr19_8628
 s_branch L_stub_wr19_9211
 s_nop 0
L_rw19:
 s_waitcnt vmcnt(32) lgkmcnt(0)
 s_barrier
 mf a[144:147],v[196:199],v[144:147],a[144:147]
 v_exp_f32_e64 v70, v70
 mf a[148:151],v[196:199],v[148:151],a[148:151]
 v_exp_f32_e64 v71, v71
 mf a[152:155],v[196:199],v[152:155],a[152:155]
 ds_read_b64 v[160:161], v20 offset:32768
 ds_read_b64 v[162:163], v228 offset:32768
 mf a[156:159],v[196:199],v[156:159],a[156:159]
 v_exp_f32_e64 v72, v72
 mf v[96:99],v[168:171],a[72:75],v[96:99]
 tr v[192:193],v32,49152
 v_cvt_pk_bf16_f32 v132, v68, v69
 mf v[100:103],v[168:171],a[88:91],v[100:103]
 v_exp_f32_e64 v73, v73
 mf v[104:107],v[168:171],a[104:107],v[104:107]
 tr v[194:195],v32,53248
 v_cvt_pk_bf16_f32 v133, v70, v71
 mf v[108:111],v[168:171],a[120:123],v[108:111]
 ds_read_b64 v[164:165], v21 offset:32768
 ds_read_b64 v[166:167], v229 offset:32768
 mf a[160:163],v[200:203],v[144:147],a[160:163]
 v_exp_f32_e64 v74, v74
 mf a[164:167],v[200:203],v[148:151],a[164:167]
 tr v[196:197],v33,49152
 tr v[198:199],v33,53248
 mf a[168:171],v[200:203],v[152:155],a[168:171]
 v_exp_f32_e64 v75, v75
 mf a[172:175],v[200:203],v[156:159],a[172:175]
 v_exp_f32_e64 v76, v76
 mf v[96:99],v[172:175],a[76:79],v[96:99]
 ds_read_b64 v[168:169], v22 offset:32768
 v_cvt_pk_bf16_f32 v136, v72, v73
 mf v[100:103],v[172:175],a[92:95],v[100:103]
 ds_read_b64 v[170:171], v230 offset:32768
 tr v[200:201],v34,49152
 mf v[104:107],v[172:175],a[108:111],v[104:107]
 v_exp_f32_e64 v77, v77
 mf v[108:111],v[172:175],a[124:127],v[108:111]
 tr v[202:203],v34,53248
 v_cvt_pk_bf16_f32 v137, v74, v75
 mf a[176:179],v[204:207],v[144:147],a[176:179]
 v_exp_f32_e64 v78, v78
 mf a[180:183],v[204:207],v[148:151],a[180:183]
 ds_read_b64 v[172:173], v23 offset:32768
 s_branch L_skip_7068
.p2align 12
L_stub_wa_7068:
 s_branch L_stub_wa_8628
L_stub_wr3_7068:
 s_branch L_stub_wr3_9211
L_stub_wr11_7068:
 s_branch L_stub_wr11_9211
 s_nop 0
L_skip_7068:
 ds_read_b64 v[174:175], v231 offset:32768
 mf a[184:187],v[204:207],v[152:155],a[184:187]
 v_exp_f32_e64 v79, v79
 mf a[188:191],v[204:207],v[156:159],a[188:191]
 s_add_u32 m0, s29, 65536
 s_add_u32 s26, s34, 98304
 mf v[44:47],v[40:43],v[144:147],v[44:47]
 buffer_load_dwordx4 v8, s[4:7], s26 offen offset:0 lds
 mf v[48:51],v[40:43],v[148:151],v[48:51]
 v_exp_f32_e64 v80, v80
 mf v[52:55],v[40:43],v[152:155],v[52:55]
 tr v[204:205],v35,49152
 v_cvt_pk_bf16_f32 v140, v76, v77
 mf v[56:59],v[40:43],v[156:159],v[56:59]
 v_exp_f32_e64 v81, v81
 mf v[112:115],v[176:179],a[64:67],0
 buffer_load_dwordx4 v9, s[4:7], s26 offen offset:1024 lds
 mf v[116:119],v[176:179],a[80:83],0
 tr v[206:207],v35,53248
 v_cvt_pk_bf16_f32 v141, v78, v79
 mf v[120:123],v[176:179],a[96:99],0
 v_exp_f32_e64 v82, v82
 mf v[124:127],v[176:179],a[112:115],0
 v_exp_f32_e64 v83, v83
 mf a[192:195],v[208:211],v[144:147],a[192:195]
 buffer_load_dwordx4 v10, s[4:7], s26 offen offset:2048 lds
 mf a[196:199],v[208:211],v[148:151],a[196:199]
 v_exp_f32_e64 v84, v84
 mf a[200:203],v[208:211],v[152:155],a[200:203]
 ds_read_b64 v[176:177], v20 offset:36864
 v_cvt_pk_bf16_f32 v130, v80, v81
 mf a[204:207],v[208:211],v[156:159],a[204:207]
 v_exp_f32_e64 v85, v85
 mf v[112:115],v[180:183],a[68:71],v[112:115]
 buffer_load_dwordx4 v11, s[4:7], s26 offen offset:3072 lds
 mf v[116:119],v[180:183],a[84:87],v[116:119]
 ds_read_b64 v[178:179], v228 offset:36864
 v_cvt_pk_bf16_f32 v131, v82, v83
 mf v[120:123],v[180:183],a[100:103],v[120:123]
 v_exp_f32_e64 v86, v86
 mf v[124:127],v[180:183],a[116:119],v[124:127]
 v_exp_f32_e64 v87, v87
 mf a[208:211],v[212:215],v[144:147],a[208:211]
 tr v[208:209],v36,49152
 tr v[210:211],v36,53248
 mf a[212:215],v[212:215],v[148:151],a[212:215]
 v_exp_f32_e64 v88, v88
 mf a[216:219],v[212:215],v[152:155],a[216:219]
 ds_read_b64 v[180:181], v21 offset:36864
 v_cvt_pk_bf16_f32 v134, v84, v85
 mf a[220:223],v[212:215],v[156:159],a[220:223]
 v_exp_f32_e64 v89, v89
 mf v[112:115],v[184:187],a[72:75],v[112:115]
 ds_read_b64 v[182:183], v229 offset:36864
 v_cvt_pk_bf16_f32 v135, v86, v87
 mf v[116:119],v[184:187],a[88:91],v[116:119]
 tr v[212:213],v37,49152
 tr v[214:215],v37,53248
 mf v[120:123],v[184:187],a[104:107],v[120:123]
 v_exp_f32_e64 v90, v90
 mf v[124:127],v[184:187],a[120:123],v[124:127]
 mf a[224:227],v[216:219],v[144:147],a[224:227]
 v_exp_f32_e64 v91, v91
 mf a[228:231],v[216:219],v[148:151],a[228:231]
 v_exp_f32_e64 v92, v92
 mf a[232:235],v[216:219],v[152:155],a[232:235]
 ds_read_b64 v[184:185], v22 offset:36864
 v_cvt_pk_bf16_f32 v138, v88, v89
 mf a[236:239],v[216:219],v[156:159],a[236:239]
 ds_read_b64 v[186:187], v230 offset:36864
 mf v[112:115],v[188:191],a[76:79],v[112:115]
 v_exp_f32_e64 v93, v93
 mf v[116:119],v[188:191],a[92:95],v[116:119]
 tr v[216:217],v38,49152
 v_cvt_pk_bf16_f32 v139, v90, v91
 mf v[120:123],v[188:191],a[108:111],v[120:123]
 v_exp_f32_e64 v94, v94
 mf v[124:127],v[188:191],a[124:127],v[124:127]
 tr v[218:219],v38,53248
 mf a[240:243],v[220:223],v[144:147],a[240:243]
 v_exp_f32_e64 v95, v95
 mf a[244:247],v[220:223],v[148:151],a[244:247]
 ds_read_b64 v[188:189], v23 offset:36864
 v_cvt_pk_bf16_f32 v142, v92, v93
 mf a[248:251],v[220:223],v[152:155],a[248:251]
 ds_read_b64 v[190:191], v231 offset:36864
 v_cvt_pk_bf16_f32 v143, v94, v95
 mf a[252:255],v[220:223],v[156:159],a[252:255]
 s_waitcnt lgkmcnt(14)
 s_nop 0
 mf v[64:67],v[160:163],a[64:67],0
 v_exp_f32_e64 v96, v96
 mf v[68:71],v[160:163],a[80:83],0
 v_exp_f32_e64 v97, v97
 mf v[72:75],v[160:163],a[96:99],0
 tr v[220:221],v39,49152
 tr v[222:223],v39,53248
 mf v[76:79],v[160:163],a[112:115],0
 v_exp_f32_e64 v98, v98
 mf a[128:131],v[192:195],v[128:131],a[128:131]
 ds_read_b64 v[160:161], v20 offset:40960
 ds_read_b64 v[162:163], v228 offset:40960
 mf a[132:135],v[192:195],v[132:135],a[132:135]
 v_exp_f32_e64 v99, v99
 mf a[136:139],v[192:195],v[136:139],a[136:139]
 v_exp_f32_e64 v100, v100
 mf a[140:143],v[192:195],v[140:143],a[140:143]
 s_add_u32 m0, s29, 81920
 v_cvt_pk_bf16_f32 v144, v96, v97
 mf v[64:67],v[164:167],a[68:71],v[64:67]
 tr v[192:193],v32,57344
 tr v[194:195],v32,61440
 mf v[68:71],v[164:167],a[84:87],v[68:71]
 v_exp_f32_e64 v101, v101
 mf v[72:75],v[164:167],a[100:103],v[72:75]
 s_add_u32 s27, s34, 81920
 v_cvt_pk_bf16_f32 v145, v98, v99
 mf v[76:79],v[164:167],a[116:119],v[76:79]
 buffer_load_dwordx4 v12, s[8:11], s27 offen offset:0 lds
 mf a[144:147],v[196:199],v[128:131],a[144:147]
 v_exp_f32_e64 v102, v102
 mf a[148:151],v[196:199],v[132:135],a[148:151]
 v_exp_f32_e64 v103, v103
 mf a[152:155],v[196:199],v[136:139],a[152:155]
 ds_read_b64 v[164:165], v21 offset:40960
 ds_read_b64 v[166:167], v229 offset:40960
 mf a[156:159],v[196:199],v[140:143],a[156:159]
 buffer_load_dwordx4 v13, s[8:11], s27 offen offset:1024 lds
 mf v[64:67],v[168:171],a[72:75],v[64:67]
 v_exp_f32_e64 v104, v104
 mf v[68:71],v[168:171],a[88:91],v[68:71]
 tr v[196:197],v33,57344
 v_cvt_pk_bf16_f32 v148, v100, v101
 mf v[72:75],v[168:171],a[104:107],v[72:75]
 v_exp_f32_e64 v105, v105
 mf v[76:79],v[168:171],a[120:123],v[76:79]
 buffer_load_dwordx4 v14, s[8:11], s27 offen offset:2048 lds
 mf a[160:163],v[200:203],v[128:131],a[160:163]
 tr v[198:199],v33,61440
 v_cvt_pk_bf16_f32 v149, v102, v103
 mf a[164:167],v[200:203],v[132:135],a[164:167]
 v_exp_f32_e64 v106, v106
 mf a[168:171],v[200:203],v[136:139],a[168:171]
 v_exp_f32_e64 v107, v107
 mf a[172:175],v[200:203],v[140:143],a[172:175]
 buffer_load_dwordx4 v15, s[8:11], s27 offen offset:3072 lds
 mf v[64:67],v[172:175],a[76:79],v[64:67]
 v_exp_f32_e64 v108, v108
 mf v[68:71],v[172:175],a[92:95],v[68:71]
 ds_read_b64 v[168:169], v22 offset:40960
 v_cvt_pk_bf16_f32 v152, v104, v105
 mf v[72:75],v[172:175],a[108:111],v[72:75]
 v_exp_f32_e64 v109, v109
 mf v[76:79],v[172:175],a[124:127],v[76:79]
 ds_read_b64 v[170:171], v230 offset:40960
 v_cvt_pk_bf16_f32 v153, v106, v107
 mf a[176:179],v[204:207],v[128:131],a[176:179]
 v_exp_f32_e64 v110, v110
 mf a[180:183],v[204:207],v[132:135],a[180:183]
 tr v[200:201],v34,57344
 tr v[202:203],v34,61440
 mf a[184:187],v[204:207],v[136:139],a[184:187]
 v_exp_f32_e64 v111, v111
 mf a[188:191],v[204:207],v[140:143],a[188:191]
 ds_read_b64 v[172:173], v23 offset:40960
 ds_read_b64 v[174:175], v231 offset:40960
 mf v[44:47],v[40:43],v[128:131],v[44:47]
 v_exp_f32_e64 v112, v112
 mf v[48:51],v[40:43],v[132:135],v[48:51]
 tr v[204:205],v35,57344
 v_cvt_pk_bf16_f32 v156, v108, v109
 mf v[52:55],v[40:43],v[136:139],v[52:55]
 v_exp_f32_e64 v113, v113
 mf v[56:59],v[40:43],v[140:143],v[56:59]
 s_waitcnt lgkmcnt(14)
 s_nop 0
 mf v[80:83],v[176:179],a[64:67],0
 tr v[206:207],v35,61440
 v_cvt_pk_bf16_f32 v157, v110, v111
 mf v[84:87],v[176:179],a[80:83],0
 v_exp_f32_e64 v114, v114
 mf v[88:91],v[176:179],a[96:99],0
 mf v[92:95],v[176:179],a[112:115],0
 v_exp_f32_e64 v115, v115
 mf a[192:195],v[208:211],v[128:131],a[192:195]
 v_exp_f32_e64 v116, v116
 mf a[196:199],v[208:211],v[132:135],a[196:199]
 ds_read_b64 v[176:177], v20 offset:45056
 v_cvt_pk_bf16_f32 v146, v112, v113
 mf a[200:203],v[208:211],v[136:139],a[200:203]
 ds_read_b64 v[178:179], v228 offset:45056
 mf a[204:207],v[208:211],v[140:143],a[204:207]
 v_exp_f32_e64 v117, v117
 mf v[80:83],v[180:183],a[68:71],v[80:83]
 tr v[208:209],v36,57344
 v_cvt_pk_bf16_f32 v147, v114, v115
 mf v[84:87],v[180:183],a[84:87],v[84:87]
 v_exp_f32_e64 v118, v118
 mf v[88:91],v[180:183],a[100:103],v[88:91]
 tr v[210:211],v36,61440
 mf v[92:95],v[180:183],a[116:119],v[92:95]
 v_exp_f32_e64 v119, v119
 mf a[208:211],v[212:215],v[128:131],a[208:211]
 ds_read_b64 v[180:181], v21 offset:45056
 ds_read_b64 v[182:183], v229 offset:45056
 mf a[212:215],v[212:215],v[132:135],a[212:215]
 v_exp_f32_e64 v120, v120
 mf a[216:219],v[212:215],v[136:139],a[216:219]
 v_cvt_pk_bf16_f32 v150, v116, v117
 mf a[220:223],v[212:215],v[140:143],a[220:223]
 v_exp_f32_e64 v121, v121
 mf v[80:83],v[184:187],a[72:75],v[80:83]
 tr v[212:213],v37,57344
 v_cvt_pk_bf16_f32 v151, v118, v119
 mf v[84:87],v[184:187],a[88:91],v[84:87]
 tr v[214:215],v37,61440
 mf v[88:91],v[184:187],a[104:107],v[88:91]
 v_exp_f32_e64 v122, v122
 mf v[92:95],v[184:187],a[120:123],v[92:95]
 mf a[224:227],v[216:219],v[128:131],a[224:227]
 v_exp_f32_e64 v123, v123
 mf a[228:231],v[216:219],v[132:135],a[228:231]
 v_exp_f32_e64 v124, v124
 mf a[232:235],v[216:219],v[136:139],a[232:235]
 ds_read_b64 v[184:185], v22 offset:45056
 v_cvt_pk_bf16_f32 v154, v120, v121
 mf a[236:239],v[216:219],v[140:143],a[236:239]
 ds_read_b64 v[186:187], v230 offset:45056
 mf v[80:83],v[188:191],a[76:79],v[80:83]
 v_exp_f32_e64 v125, v125
 mf v[84:87],v[188:191],a[92:95],v[84:87]
 tr v[216:217],v38,57344
 v_cvt_pk_bf16_f32 v155, v122, v123
 mf v[88:91],v[188:191],a[108:111],v[88:91]
 v_exp_f32_e64 v126, v126
 mf v[92:95],v[188:191],a[124:127],v[92:95]
 tr v[218:219],v38,61440
 mf a[240:243],v[220:223],v[128:131],a[240:243]
 v_exp_f32_e64 v127, v127
 mf a[244:247],v[220:223],v[132:135],a[244:247]
 ds_read_b64 v[188:189], v23 offset:45056
 v_cvt_pk_bf16_f32 v158, v124, v125
 mf a[248:251],v[220:223],v[136:139],a[248:251]
 ds_read_b64 v[190:191], v231 offset:45056
 v_cvt_pk_bf16_f32 v159, v126, v127
 mf a[252:255],v[220:223],v[140:143],a[252:255]
 s_waitcnt lgkmcnt(14)
 s_nop 0
 mf v[96:99],v[160:163],a[64:67],0
 v_exp_f32_e64 v64, v64
 mf v[100:103],v[160:163],a[80:83],0
 v_exp_f32_e64 v65, v65
 mf v[104:107],v[160:163],a[96:99],0
 tr v[220:221],v39,57344
 tr v[222:223],v39,61440
 mf v[108:111],v[160:163],a[112:115],0
 v_exp_f32_e64 v66, v66
 mf a[128:131],v[192:195],v[144:147],a[128:131]
 mf a[132:135],v[192:195],v[148:151],a[132:135]
 v_exp_f32_e64 v67, v67
 mf a[136:139],v[192:195],v[152:155],a[136:139]
 v_exp_f32_e64 v68, v68
 mf a[140:143],v[192:195],v[156:159],a[140:143]
 v_cvt_pk_bf16_f32 v128, v64, v65
 mf v[96:99],v[164:167],a[68:71],v[96:99]
 mf v[100:103],v[164:167],a[84:87],v[100:103]
 v_exp_f32_e64 v69, v69
 mf v[104:107],v[164:167],a[100:103],v[104:107]
 v_cvt_pk_bf16_f32 v129, v66, v67
 mf v[108:111],v[164:167],a[116:119],v[108:111]
 s_waitcnt vmcnt(16) lgkmcnt(0)
 s_barrier
 mf a[144:147],v[196:199],v[144:147],a[144:147]
 v_exp_f32_e64 v70, v70
 mf a[148:151],v[196:199],v[148:151],a[148:151]
 v_exp_f32_e64 v71, v71
 mf a[152:155],v[196:199],v[152:155],a[152:155]
 ds_read_b64 v[160:161], v16 offset:0
 ds_read_b64 v[162:163], v224 offset:0
 mf a[156:159],v[196:199],v[156:159],a[156:159]
 v_exp_f32_e64 v72, v72
 mf v[96:99],v[168:171],a[72:75],v[96:99]
 tr v[192:193],v24,16384
 v_cvt_pk_bf16_f32 v132, v68, v69
 mf v[100:103],v[168:171],a[88:91],v[100:103]
 v_exp_f32_e64 v73, v73
 mf v[104:107],v[168:171],a[104:107],v[104:107]
 tr v[194:195],v24,20480
 v_cvt_pk_bf16_f32 v133, v70, v71
 mf v[108:111],v[168:171],a[120:123],v[108:111]
 ds_read_b64 v[164:165], v17 offset:0
 ds_read_b64 v[166:167], v225 offset:0
 mf a[160:163],v[200:203],v[144:147],a[160:163]
 v_exp_f32_e64 v74, v74
 mf a[164:167],v[200:203],v[148:151],a[164:167]
 tr v[196:197],v25,16384
 tr v[198:199],v25,20480
 mf a[168:171],v[200:203],v[152:155],a[168:171]
 v_exp_f32_e64 v75, v75
 mf a[172:175],v[200:203],v[156:159],a[172:175]
 v_exp_f32_e64 v76, v76
 mf v[96:99],v[172:175],a[76:79],v[96:99]
 ds_read_b64 v[168:169], v18 offset:0
 v_cvt_pk_bf16_f32 v136, v72, v73
 mf v[100:103],v[172:175],a[92:95],v[100:103]
 ds_read_b64 v[170:171], v226 offset:0
 tr v[200:201],v26,16384
 mf v[104:107],v[172:175],a[108:111],v[104:107]
 v_exp_f32_e64 v77, v77
 mf v[108:111],v[172:175],a[124:127],v[108:111]
 tr v[202:203],v26,20480
 v_cvt_pk_bf16_f32 v137, v74, v75
 mf a[176:179],v[204:207],v[144:147],a[176:179]
 v_exp_f32_e64 v78, v78
 mf a[180:183],v[204:207],v[148:151],a[180:183]
 ds_read_b64 v[172:173], v19 offset:0
 ds_read_b64 v[174:175], v227 offset:0
 mf a[184:187],v[204:207],v[152:155],a[184:187]
 v_exp_f32_e64 v79, v79
 mf a[188:191],v[204:207],v[156:159],a[188:191]
 s_add_u32 m0, s29, 98304
 s_add_u32 s26, s34, 114688
 mf v[44:47],v[40:43],v[144:147],v[44:47]
 buffer_load_dwordx4 v8, s[4:7], s26 offen offset:0 lds
 mf v[48:51],v[40:43],v[148:151],v[48:51]
 v_exp_f32_e64 v80, v80
 mf v[52:55],v[40:43],v[152:155],v[52:55]
 tr v[204:205],v27,16384
 v_cvt_pk_bf16_f32 v140, v76, v77
 mf v[56:59],v[40:43],v[156:159],v[56:59]
 v_exp_f32_e64 v81, v81
 mf v[112:115],v[176:179],a[64:67],0
 buffer_load_dwordx4 v9, s[4:7], s26 offen offset:1024 lds
 mf v[116:119],v[176:179],a[80:83],0
 tr v[206:207],v27,20480
 v_cvt_pk_bf16_f32 v141, v78, v79
 mf v[120:123],v[176:179],a[96:99],0
 v_exp_f32_e64 v82, v82
 mf v[124:127],v[176:179],a[112:115],0
 v_exp_f32_e64 v83, v83
 mf a[192:195],v[208:211],v[144:147],a[192:195]
 buffer_load_dwordx4 v10, s[4:7], s26 offen offset:2048 lds
 mf a[196:199],v[208:211],v[148:151],a[196:199]
 v_exp_f32_e64 v84, v84
 mf a[200:203],v[208:211],v[152:155],a[200:203]
 ds_read_b64 v[176:177], v16 offset:4096
 v_cvt_pk_bf16_f32 v130, v80, v81
 mf a[204:207],v[208:211],v[156:159],a[204:207]
 v_exp_f32_e64 v85, v85
 mf v[112:115],v[180:183],a[68:71],v[112:115]
 buffer_load_dwordx4 v11, s[4:7], s26 offen offset:3072 lds
 mf v[116:119],v[180:183],a[84:87],v[116:119]
 ds_read_b64 v[178:179], v224 offset:4096
 v_cvt_pk_bf16_f32 v131, v82, v83
 mf v[120:123],v[180:183],a[100:103],v[120:123]
 v_exp_f32_e64 v86, v86
 mf v[124:127],v[180:183],a[116:119],v[124:127]
 v_exp_f32_e64 v87, v87
 mf a[208:211],v[212:215],v[144:147],a[208:211]
 tr v[208:209],v28,16384
 tr v[210:211],v28,20480
 mf a[212:215],v[212:215],v[148:151],a[212:215]
 v_exp_f32_e64 v88, v88
 mf a[216:219],v[212:215],v[152:155],a[216:219]
 ds_read_b64 v[180:181], v17 offset:4096
 v_cvt_pk_bf16_f32 v134, v84, v85
 mf a[220:223],v[212:215],v[156:159],a[220:223]
 v_exp_f32_e64 v89, v89
 mf v[112:115],v[184:187],a[72:75],v[112:115]
 ds_read_b64 v[182:183], v225 offset:4096
 v_cvt_pk_bf16_f32 v135, v86, v87
 mf v[116:119],v[184:187],a[88:91],v[116:119]
 tr v[212:213],v29,16384
 tr v[214:215],v29,20480
 mf v[120:123],v[184:187],a[104:107],v[120:123]
 v_exp_f32_e64 v90, v90
 mf v[124:127],v[184:187],a[120:123],v[124:127]
 mf a[224:227],v[216:219],v[144:147],a[224:227]
 v_exp_f32_e64 v91, v91
 mf a[228:231],v[216:219],v[148:151],a[228:231]
 v_exp_f32_e64 v92, v92
 mf a[232:235],v[216:219],v[152:155],a[232:235]
 ds_read_b64 v[184:185], v18 offset:4096
 v_cvt_pk_bf16_f32 v138, v88, v89
 mf a[236:239],v[216:219],v[156:159],a[236:239]
 ds_read_b64 v[186:187], v226 offset:4096
 mf v[112:115],v[188:191],a[76:79],v[112:115]
 v_exp_f32_e64 v93, v93
 mf v[116:119],v[188:191],a[92:95],v[116:119]
 tr v[216:217],v30,16384
 v_cvt_pk_bf16_f32 v139, v90, v91
 mf v[120:123],v[188:191],a[108:111],v[120:123]
 v_exp_f32_e64 v94, v94
 mf v[124:127],v[188:191],a[124:127],v[124:127]
 tr v[218:219],v30,20480
 mf a[240:243],v[220:223],v[144:147],a[240:243]
 v_exp_f32_e64 v95, v95
 mf a[244:247],v[220:223],v[148:151],a[244:247]
 ds_read_b64 v[188:189], v19 offset:4096
 v_cvt_pk_bf16_f32 v142, v92, v93
 mf a[248:251],v[220:223],v[152:155],a[248:251]
 ds_read_b64 v[190:191], v227 offset:4096
 v_cvt_pk_bf16_f32 v143, v94, v95
 mf a[252:255],v[220:223],v[156:159],a[252:255]
 s_waitcnt lgkmcnt(14)
 s_nop 0
 mf v[64:67],v[160:163],a[64:67],0
 v_exp_f32_e64 v96, v96
 mf v[68:71],v[160:163],a[80:83],0
 v_exp_f32_e64 v97, v97
 mf v[72:75],v[160:163],a[96:99],0
 tr v[220:221],v31,16384
 tr v[222:223],v31,20480
 mf v[76:79],v[160:163],a[112:115],0
 v_exp_f32_e64 v98, v98
 mf a[128:131],v[192:195],v[128:131],a[128:131]
 ds_read_b64 v[160:161], v16 offset:8192
 ds_read_b64 v[162:163], v224 offset:8192
 mf a[132:135],v[192:195],v[132:135],a[132:135]
 v_exp_f32_e64 v99, v99
 mf a[136:139],v[192:195],v[136:139],a[136:139]
 v_exp_f32_e64 v100, v100
 mf a[140:143],v[192:195],v[140:143],a[140:143]
 s_add_u32 m0, s29, 114688
 v_cvt_pk_bf16_f32 v144, v96, v97
 mf v[64:67],v[164:167],a[68:71],v[64:67]
 tr v[192:193],v24,24576
 tr v[194:195],v24,28672
 mf v[68:71],v[164:167],a[84:87],v[68:71]
 v_exp_f32_e64 v101, v101
 mf v[72:75],v[164:167],a[100:103],v[72:75]
 s_add_u32 s27, s34, 98304
 v_cvt_pk_bf16_f32 v145, v98, v99
 mf v[76:79],v[164:167],a[116:119],v[76:79]
 buffer_load_dwordx4 v12, s[8:11], s27 offen offset:0 lds
 mf a[144:147],v[196:199],v[128:131],a[144:147]
 v_exp_f32_e64 v102, v102
 mf a[148:151],v[196:199],v[132:135],a[148:151]
 v_exp_f32_e64 v103, v103
 mf a[152:155],v[196:199],v[136:139],a[152:155]
 ds_read_b64 v[164:165], v17 offset:8192
 ds_read_b64 v[166:167], v225 offset:8192
 mf a[156:159],v[196:199],v[140:143],a[156:159]
 buffer_load_dwordx4 v13, s[8:11], s27 offen offset:1024 lds
 mf v[64:67],v[168:171],a[72:75],v[64:67]
 v_exp_f32_e64 v104, v104
 mf v[68:71],v[168:171],a[88:91],v[68:71]
 tr v[196:197],v25,24576
 v_cvt_pk_bf16_f32 v148, v100, v101
 mf v[72:75],v[168:171],a[104:107],v[72:75]
 v_exp_f32_e64 v105, v105
 mf v[76:79],v[168:171],a[120:123],v[76:79]
 buffer_load_dwordx4 v14, s[8:11], s27 offen offset:2048 lds
 mf a[160:163],v[200:203],v[128:131],a[160:163]
 tr v[198:199],v25,28672
 v_cvt_pk_bf16_f32 v149, v102, v103
 mf a[164:167],v[200:203],v[132:135],a[164:167]
 v_exp_f32_e64 v106, v106
 mf a[168:171],v[200:203],v[136:139],a[168:171]
 v_exp_f32_e64 v107, v107
 mf a[172:175],v[200:203],v[140:143],a[172:175]
 buffer_load_dwordx4 v15, s[8:11], s27 offen offset:3072 lds
 mf v[64:67],v[172:175],a[76:79],v[64:67]
 v_exp_f32_e64 v108, v108
 mf v[68:71],v[172:175],a[92:95],v[68:71]
 ds_read_b64 v[168:169], v18 offset:8192
 v_cvt_pk_bf16_f32 v152, v104, v105
 mf v[72:75],v[172:175],a[108:111],v[72:75]
 v_exp_f32_e64 v109, v109
 mf v[76:79],v[172:175],a[124:127],v[76:79]
 ds_read_b64 v[170:171], v226 offset:8192
 v_cvt_pk_bf16_f32 v153, v106, v107
 mf a[176:179],v[204:207],v[128:131],a[176:179]
 v_exp_f32_e64 v110, v110
 mf a[180:183],v[204:207],v[132:135],a[180:183]
 tr v[200:201],v26,24576
 tr v[202:203],v26,28672
 mf a[184:187],v[204:207],v[136:139],a[184:187]
 v_exp_f32_e64 v111, v111
 mf a[188:191],v[204:207],v[140:143],a[188:191]
 ds_read_b64 v[172:173], v19 offset:8192
 ds_read_b64 v[174:175], v227 offset:8192
 mf v[44:47],v[40:43],v[128:131],v[44:47]
 v_exp_f32_e64 v112, v112
 mf v[48:51],v[40:43],v[132:135],v[48:51]
 tr v[204:205],v27,24576
 v_cvt_pk_bf16_f32 v156, v108, v109
 mf v[52:55],v[40:43],v[136:139],v[52:55]
 v_exp_f32_e64 v113, v113
 mf v[56:59],v[40:43],v[140:143],v[56:59]
 s_waitcnt lgkmcnt(14)
 s_nop 0
 mf v[80:83],v[176:179],a[64:67],0
 tr v[206:207],v27,28672
 v_cvt_pk_bf16_f32 v157, v110, v111
 mf v[84:87],v[176:179],a[80:83],0
 v_exp_f32_e64 v114, v114
 mf v[88:91],v[176:179],a[96:99],0
 mf v[92:95],v[176:179],a[112:115],0
 v_exp_f32_e64 v115, v115
 mf a[192:195],v[208:211],v[128:131],a[192:195]
 v_exp_f32_e64 v116, v116
 mf a[196:199],v[208:211],v[132:135],a[196:199]
 ds_read_b64 v[176:177], v16 offset:12288
 v_cvt_pk_bf16_f32 v146, v112, v113
 mf a[200:203],v[208:211],v[136:139],a[200:203]
 ds_read_b64 v[178:179], v224 offset:12288
 mf a[204:207],v[208:211],v[140:143],a[204:207]
 v_exp_f32_e64 v117, v117
 mf v[80:83],v[180:183],a[68:71],v[80:83]
 tr v[208:209],v28,24576
 v_cvt_pk_bf16_f32 v147, v114, v115
 mf v[84:87],v[180:183],a[84:87],v[84:87]
 v_exp_f32_e64 v118, v118
 mf v[88:91],v[180:183],a[100:103],v[88:91]
 s_branch L_skip_7583
.p2align 12
L_stub_wa_7583:
 s_branch L_stub_wa_9211
L_stub_wr3_7583:
 s_branch L_rw3
L_stub_wr11_7583:
 s_branch L_rw11
L_stub_wr19_7583:
 s_branch L_rw19
L_skip_7583:
 tr v[210:211],v28,28672
 mf v[92:95],v[180:183],a[116:119],v[92:95]
 v_exp_f32_e64 v119, v119
 mf a[208:211],v[212:215],v[128:131],a[208:211]
 ds_read_b64 v[180:181], v17 offset:12288
 ds_read_b64 v[182:183], v225 offset:12288
 mf a[212:215],v[212:215],v[132:135],a[212:215]
 v_exp_f32_e64 v120, v120
 mf a[216:219],v[212:215],v[136:139],a[216:219]
 v_cvt_pk_bf16_f32 v150, v116, v117
 mf a[220:223],v[212:215],v[140:143],a[220:223]
 v_exp_f32_e64 v121, v121
 mf v[80:83],v[184:187],a[72:75],v[80:83]
 tr v[212:213],v29,24576
 v_cvt_pk_bf16_f32 v151, v118, v119
 mf v[84:87],v[184:187],a[88:91],v[84:87]
 tr v[214:215],v29,28672
 mf v[88:91],v[184:187],a[104:107],v[88:91]
 v_exp_f32_e64 v122, v122
 mf v[92:95],v[184:187],a[120:123],v[92:95]
 mf a[224:227],v[216:219],v[128:131],a[224:227]
 v_exp_f32_e64 v123, v123
 mf a[228:231],v[216:219],v[132:135],a[228:231]
 v_exp_f32_e64 v124, v124
 mf a[232:235],v[216:219],v[136:139],a[232:235]
 ds_read_b64 v[184:185], v18 offset:12288
 v_cvt_pk_bf16_f32 v154, v120, v121
 mf a[236:239],v[216:219],v[140:143],a[236:239]
 ds_read_b64 v[186:187], v226 offset:12288
 mf v[80:83],v[188:191],a[76:79],v[80:83]
 v_exp_f32_e64 v125, v125
 mf v[84:87],v[188:191],a[92:95],v[84:87]
 tr v[216:217],v30,24576
 v_cvt_pk_bf16_f32 v155, v122, v123
 mf v[88:91],v[188:191],a[108:111],v[88:91]
 v_exp_f32_e64 v126, v126
 mf v[92:95],v[188:191],a[124:127],v[92:95]
 tr v[218:219],v30,28672
 mf a[240:243],v[220:223],v[128:131],a[240:243]
 v_exp_f32_e64 v127, v127
 mf a[244:247],v[220:223],v[132:135],a[244:247]
 ds_read_b64 v[188:189], v19 offset:12288
 v_cvt_pk_bf16_f32 v158, v124, v125
 mf a[248:251],v[220:223],v[136:139],a[248:251]
 ds_read_b64 v[190:191], v227 offset:12288
 v_cvt_pk_bf16_f32 v159, v126, v127
 mf a[252:255],v[220:223],v[140:143],a[252:255]
 s_waitcnt lgkmcnt(14)
 s_nop 0
 mf v[96:99],v[160:163],a[64:67],0
 v_exp_f32_e64 v64, v64
 mf v[100:103],v[160:163],a[80:83],0
 v_exp_f32_e64 v65, v65
 mf v[104:107],v[160:163],a[96:99],0
 tr v[220:221],v31,24576
 tr v[222:223],v31,28672
 mf v[108:111],v[160:163],a[112:115],0
 v_exp_f32_e64 v66, v66
 mf a[128:131],v[192:195],v[144:147],a[128:131]
 mf a[132:135],v[192:195],v[148:151],a[132:135]
 v_exp_f32_e64 v67, v67
 mf a[136:139],v[192:195],v[152:155],a[136:139]
 v_exp_f32_e64 v68, v68
 mf a[140:143],v[192:195],v[156:159],a[140:143]
 v_cvt_pk_bf16_f32 v128, v64, v65
 mf v[96:99],v[164:167],a[68:71],v[96:99]
 mf v[100:103],v[164:167],a[84:87],v[100:103]
 v_exp_f32_e64 v69, v69
 mf v[104:107],v[164:167],a[100:103],v[104:107]
 v_cvt_pk_bf16_f32 v129, v66, v67
 mf v[108:111],v[164:167],a[116:119],v[108:111]
 s_waitcnt vmcnt(16) lgkmcnt(0)
 s_barrier
 mf a[144:147],v[196:199],v[144:147],a[144:147]
 v_exp_f32_e64 v70, v70
 mf a[148:151],v[196:199],v[148:151],a[148:151]
 v_exp_f32_e64 v71, v71
 mf a[152:155],v[196:199],v[152:155],a[152:155]
 ds_read_b64 v[160:161], v16 offset:32768
 ds_read_b64 v[162:163], v224 offset:32768
 mf a[156:159],v[196:199],v[156:159],a[156:159]
 v_exp_f32_e64 v72, v72
 mf v[96:99],v[168:171],a[72:75],v[96:99]
 tr v[192:193],v24,49152
 v_cvt_pk_bf16_f32 v132, v68, v69
 mf v[100:103],v[168:171],a[88:91],v[100:103]
 v_exp_f32_e64 v73, v73
 mf v[104:107],v[168:171],a[104:107],v[104:107]
 tr v[194:195],v24,53248
 v_cvt_pk_bf16_f32 v133, v70, v71
 mf v[108:111],v[168:171],a[120:123],v[108:111]
 ds_read_b64 v[164:165], v17 offset:32768
 ds_read_b64 v[166:167], v225 offset:32768
 mf a[160:163],v[200:203],v[144:147],a[160:163]
 v_exp_f32_e64 v74, v74
 mf a[164:167],v[200:203],v[148:151],a[164:167]
 tr v[196:197],v25,49152
 tr v[198:199],v25,53248
 mf a[168:171],v[200:203],v[152:155],a[168:171]
 v_exp_f32_e64 v75, v75
 mf a[172:175],v[200:203],v[156:159],a[172:175]
 v_exp_f32_e64 v76, v76
 mf v[96:99],v[172:175],a[76:79],v[96:99]
 ds_read_b64 v[168:169], v18 offset:32768
 v_cvt_pk_bf16_f32 v136, v72, v73
 mf v[100:103],v[172:175],a[92:95],v[100:103]
 ds_read_b64 v[170:171], v226 offset:32768
 tr v[200:201],v26,49152
 mf v[104:107],v[172:175],a[108:111],v[104:107]
 v_exp_f32_e64 v77, v77
 mf v[108:111],v[172:175],a[124:127],v[108:111]
 tr v[202:203],v26,53248
 v_cvt_pk_bf16_f32 v137, v74, v75
 mf a[176:179],v[204:207],v[144:147],a[176:179]
 v_exp_f32_e64 v78, v78
 mf a[180:183],v[204:207],v[148:151],a[180:183]
 ds_read_b64 v[172:173], v19 offset:32768
 ds_read_b64 v[174:175], v227 offset:32768
 mf a[184:187],v[204:207],v[152:155],a[184:187]
 v_exp_f32_e64 v79, v79
 mf a[188:191],v[204:207],v[156:159],a[188:191]
 s_add_u32 m0, s29, 16384
 s_add_u32 s27, s34, 114688
 mf v[44:47],v[40:43],v[144:147],v[44:47]
 buffer_load_dwordx4 v12, s[8:11], s27 offen offset:0 lds
 mf v[48:51],v[40:43],v[148:151],v[48:51]
 v_exp_f32_e64 v80, v80
 mf v[52:55],v[40:43],v[152:155],v[52:55]
 tr v[204:205],v27,49152
 v_cvt_pk_bf16_f32 v140, v76, v77
 mf v[56:59],v[40:43],v[156:159],v[56:59]
 v_exp_f32_e64 v81, v81
 mf v[112:115],v[176:179],a[64:67],0
 tr v[206:207],v27,53248
 v_cvt_pk_bf16_f32 v141, v78, v79
 mf v[116:119],v[176:179],a[80:83],0
 v_exp_f32_e64 v82, v82
 mf v[120:123],v[176:179],a[96:99],0
 mf v[124:127],v[176:179],a[112:115],0
 v_exp_f32_e64 v83, v83
 mf a[192:195],v[208:211],v[144:147],a[192:195]
 v_exp_f32_e64 v84, v84
 mf a[196:199],v[208:211],v[148:151],a[196:199]
 ds_read_b64 v[176:177], v16 offset:36864
 v_cvt_pk_bf16_f32 v130, v80, v81
 mf a[200:203],v[208:211],v[152:155],a[200:203]
 ds_read_b64 v[178:179], v224 offset:36864
 mf a[204:207],v[208:211],v[156:159],a[204:207]
 v_exp_f32_e64 v85, v85
 mf v[112:115],v[180:183],a[68:71],v[112:115]
 tr v[208:209],v28,49152
 v_cvt_pk_bf16_f32 v131, v82, v83
 mf v[116:119],v[180:183],a[84:87],v[116:119]
 v_exp_f32_e64 v86, v86
 mf v[120:123],v[180:183],a[100:103],v[120:123]
 tr v[210:211],v28,53248
 mf v[124:127],v[180:183],a[116:119],v[124:127]
 v_exp_f32_e64 v87, v87
 mf a[208:211],v[212:215],v[144:147],a[208:211]
 ds_read_b64 v[180:181], v17 offset:36864
 ds_read_b64 v[182:183], v225 offset:36864
 mf a[212:215],v[212:215],v[148:151],a[212:215]
 v_exp_f32_e64 v88, v88
 mf a[216:219],v[212:215],v[152:155],a[216:219]
 v_cvt_pk_bf16_f32 v134, v84, v85
 mf a[220:223],v[212:215],v[156:159],a[220:223]
 v_exp_f32_e64 v89, v89
 mf v[112:115],v[184:187],a[72:75],v[112:115]
 tr v[212:213],v29,49152
 v_cvt_pk_bf16_f32 v135, v86, v87
 mf v[116:119],v[184:187],a[88:91],v[116:119]
 tr v[214:215],v29,53248
 mf v[120:123],v[184:187],a[104:107],v[120:123]
 v_exp_f32_e64 v90, v90
 mf v[124:127],v[184:187],a[120:123],v[124:127]
 mf a[224:227],v[216:219],v[144:147],a[224:227]
 v_exp_f32_e64 v91, v91
 mf a[228:231],v[216:219],v[148:151],a[228:231]
 v_exp_f32_e64 v92, v92
 mf a[232:235],v[216:219],v[152:155],a[232:235]
 ds_read_b64 v[184:185], v18 offset:36864
 v_cvt_pk_bf16_f32 v138, v88, v89
 mf a[236:239],v[216:219],v[156:159],a[236:239]
 ds_read_b64 v[186:187], v226 offset:36864
 mf v[112:115],v[188:191],a[76:79],v[112:115]
 v_exp_f32_e64 v93, v93
 mf v[116:119],v[188:191],a[92:95],v[116:119]
 tr v[216:217],v30,49152
 v_cvt_pk_bf16_f32 v139, v90, v91
 mf v[120:123],v[188:191],a[108:111],v[120:123]
 v_exp_f32_e64 v94, v94
 mf v[124:127],v[188:191],a[124:127],v[124:127]
 tr v[218:219],v30,53248
 mf a[240:243],v[220:223],v[144:147],a[240:243]
 v_exp_f32_e64 v95, v95
 mf a[244:247],v[220:223],v[148:151],a[244:247]
 ds_read_b64 v[188:189], v19 offset:36864
 v_cvt_pk_bf16_f32 v142, v92, v93
 mf a[248:251],v[220:223],v[152:155],a[248:251]
 ds_read_b64 v[190:191], v227 offset:36864
 v_cvt_pk_bf16_f32 v143, v94, v95
 mf a[252:255],v[220:223],v[156:159],a[252:255]
 s_waitcnt lgkmcnt(14)
 s_nop 0
 mf v[64:67],v[160:163],a[64:67],0
 buffer_load_dwordx4 v13, s[8:11], s27 offen offset:1024 lds
 mf v[68:71],v[160:163],a[80:83],0
 v_exp_f32_e64 v96, v96
 mf v[72:75],v[160:163],a[96:99],0
 v_exp_f32_e64 v97, v97
 mf v[76:79],v[160:163],a[112:115],0
 v_exp_f32_e64 v98, v98
 mf a[128:131],v[192:195],v[128:131],a[128:131]
 buffer_load_dwordx4 v14, s[8:11], s27 offen offset:2048 lds
 mf a[132:135],v[192:195],v[132:135],a[132:135]
 v_exp_f32_e64 v99, v99
 mf a[136:139],v[192:195],v[136:139],a[136:139]
 v_exp_f32_e64 v100, v100
 mf a[140:143],v[192:195],v[140:143],a[140:143]
 tr v[220:221],v31,49152
 v_cvt_pk_bf16_f32 v144, v96, v97
 mf v[64:67],v[164:167],a[68:71],v[64:67]
 buffer_load_dwordx4 v15, s[8:11], s27 offen offset:3072 lds
 mf v[68:71],v[164:167],a[84:87],v[68:71]
 v_exp_f32_e64 v101, v101
 mf v[72:75],v[164:167],a[100:103],v[72:75]
 tr v[222:223],v31,53248
 v_cvt_pk_bf16_f32 v145, v98, v99
 mf v[76:79],v[164:167],a[116:119],v[76:79]
 v_exp_f32_e64 v102, v102
 mf a[144:147],v[196:199],v[128:131],a[144:147]
 ds_read_b64 v[160:161], v16 offset:40960
 ds_read_b64 v[162:163], v224 offset:40960
 mf a[148:151],v[196:199],v[132:135],a[148:151]
 v_exp_f32_e64 v103, v103
 mf a[152:155],v[196:199],v[136:139],a[152:155]
 tr v[192:193],v24,57344
 tr v[194:195],v24,61440
 mf a[156:159],v[196:199],v[140:143],a[156:159]
 v_exp_f32_e64 v104, v104
 mf v[64:67],v[168:171],a[72:75],v[64:67]
 ds_read_b64 v[164:165], v17 offset:40960
 v_cvt_pk_bf16_f32 v148, v100, v101
 mf v[68:71],v[168:171],a[88:91],v[68:71]
 v_exp_f32_e64 v105, v105
 mf v[72:75],v[168:171],a[104:107],v[72:75]
 ds_read_b64 v[166:167], v225 offset:40960
 v_cvt_pk_bf16_f32 v149, v102, v103
 mf v[76:79],v[168:171],a[120:123],v[76:79]
 tr v[196:197],v25,57344
 tr v[198:199],v25,61440
 mf a[160:163],v[200:203],v[128:131],a[160:163]
 v_exp_f32_e64 v106, v106
 mf a[164:167],v[200:203],v[132:135],a[164:167]
 ds_read_b64 v[168:169], v18 offset:40960
 ds_read_b64 v[170:171], v226 offset:40960
 mf a[168:171],v[200:203],v[136:139],a[168:171]
 v_exp_f32_e64 v107, v107
 mf a[172:175],v[200:203],v[140:143],a[172:175]
 v_exp_f32_e64 v108, v108
 mf v[64:67],v[172:175],a[76:79],v[64:67]
 tr v[200:201],v26,57344
 v_cvt_pk_bf16_f32 v152, v104, v105
 mf v[68:71],v[172:175],a[92:95],v[68:71]
 tr v[202:203],v26,61440
 mf v[72:75],v[172:175],a[108:111],v[72:75]
 v_exp_f32_e64 v109, v109
 mf v[76:79],v[172:175],a[124:127],v[76:79]
 v_cvt_pk_bf16_f32 v153, v106, v107
 mf a[176:179],v[204:207],v[128:131],a[176:179]
 v_exp_f32_e64 v110, v110
 mf a[180:183],v[204:207],v[132:135],a[180:183]
 ds_read_b64 v[172:173], v19 offset:40960
 ds_read_b64 v[174:175], v227 offset:40960
 mf a[184:187],v[204:207],v[136:139],a[184:187]
 v_exp_f32_e64 v111, v111
 mf a[188:191],v[204:207],v[140:143],a[188:191]
 mf v[44:47],v[40:43],v[128:131],v[44:47]
 v_exp_f32_e64 v112, v112
 mf v[48:51],v[40:43],v[132:135],v[48:51]
 tr v[204:205],v27,57344
 v_cvt_pk_bf16_f32 v156, v108, v109
 mf v[52:55],v[40:43],v[136:139],v[52:55]
 v_exp_f32_e64 v113, v113
 mf v[56:59],v[40:43],v[140:143],v[56:59]
 s_waitcnt lgkmcnt(14)
 s_nop 0
 mf v[80:83],v[176:179],a[64:67],0
 tr v[206:207],v27,61440
 v_cvt_pk_bf16_f32 v157, v110, v111
 mf v[84:87],v[176:179],a[80:83],0
 v_exp_f32_e64 v114, v114
 mf v[88:91],v[176:179],a[96:99],0
 mf v[92:95],v[176:179],a[112:115],0
 v_exp_f32_e64 v115, v115
 mf a[192:195],v[208:211],v[128:131],a[192:195]
 v_exp_f32_e64 v116, v116
 mf a[196:199],v[208:211],v[132:135],a[196:199]
 ds_read_b64 v[176:177], v16 offset:45056
 v_cvt_pk_bf16_f32 v146, v112, v113
 mf a[200:203],v[208:211],v[136:139],a[200:203]
 ds_read_b64 v[178:179], v224 offset:45056
 mf a[204:207],v[208:211],v[140:143],a[204:207]
 v_exp_f32_e64 v117, v117
 mf v[80:83],v[180:183],a[68:71],v[80:83]
 tr v[208:209],v28,57344
 v_cvt_pk_bf16_f32 v147, v114, v115
 mf v[84:87],v[180:183],a[84:87],v[84:87]
 v_exp_f32_e64 v118, v118
 mf v[88:91],v[180:183],a[100:103],v[88:91]
 tr v[210:211],v28,61440
 mf v[92:95],v[180:183],a[116:119],v[92:95]
 v_exp_f32_e64 v119, v119
 mf a[208:211],v[212:215],v[128:131],a[208:211]
 ds_read_b64 v[180:181], v17 offset:45056
 ds_read_b64 v[182:183], v225 offset:45056
 mf a[212:215],v[212:215],v[132:135],a[212:215]
 v_exp_f32_e64 v120, v120
 mf a[216:219],v[212:215],v[136:139],a[216:219]
 v_cvt_pk_bf16_f32 v150, v116, v117
 mf a[220:223],v[212:215],v[140:143],a[220:223]
 v_exp_f32_e64 v121, v121
 mf v[80:83],v[184:187],a[72:75],v[80:83]
 tr v[212:213],v29,57344
 v_cvt_pk_bf16_f32 v151, v118, v119
 mf v[84:87],v[184:187],a[88:91],v[84:87]
 tr v[214:215],v29,61440
 mf v[88:91],v[184:187],a[104:107],v[88:91]
 v_exp_f32_e64 v122, v122
 mf v[92:95],v[184:187],a[120:123],v[92:95]
 mf a[224:227],v[216:219],v[128:131],a[224:227]
 v_exp_f32_e64 v123, v123
 mf a[228:231],v[216:219],v[132:135],a[228:231]
 v_exp_f32_e64 v124, v124
 mf a[232:235],v[216:219],v[136:139],a[232:235]
 ds_read_b64 v[184:185], v18 offset:45056
 v_cvt_pk_bf16_f32 v154, v120, v121
 mf a[236:239],v[216:219],v[140:143],a[236:239]
 ds_read_b64 v[186:187], v226 offset:45056
 mf v[80:83],v[188:191],a[76:79],v[80:83]
 v_exp_f32_e64 v125, v125
 mf v[84:87],v[188:191],a[92:95],v[84:87]
 tr v[216:217],v30,57344
 v_cvt_pk_bf16_f32 v155, v122, v123
 mf v[88:91],v[188:191],a[108:111],v[88:91]
 v_exp_f32_e64 v126, v126
 mf v[92:95],v[188:191],a[124:127],v[92:95]
 tr v[218:219],v30,61440
 mf a[240:243],v[220:223],v[128:131],a[240:243]
 v_exp_f32_e64 v127, v127
 mf a[244:247],v[220:223],v[132:135],a[244:247]
 ds_read_b64 v[188:189], v19 offset:45056
 v_cvt_pk_bf16_f32 v158, v124, v125
 mf a[248:251],v[220:223],v[136:139],a[248:251]
 ds_read_b64 v[190:191], v227 offset:45056
 v_cvt_pk_bf16_f32 v159, v126, v127
 mf a[252:255],v[220:223],v[140:143],a[252:255]
 s_waitcnt lgkmcnt(14)
 s_nop 0
 mf v[96:99],v[160:163],a[64:67],0
 v_exp_f32_e64 v64, v64
 mf v[100:103],v[160:163],a[80:83],0
 v_exp_f32_e64 v65, v65
 mf v[104:107],v[160:163],a[96:99],0
 tr v[220:221],v31,57344
 tr v[222:223],v31,61440
 mf v[108:111],v[160:163],a[112:115],0
 v_exp_f32_e64 v66, v66
 mf a[128:131],v[192:195],v[144:147],a[128:131]
 mf a[132:135],v[192:195],v[148:151],a[132:135]
 v_exp_f32_e64 v67, v67
 mf a[136:139],v[192:195],v[152:155],a[136:139]
 v_exp_f32_e64 v68, v68
 mf a[140:143],v[192:195],v[156:159],a[140:143]
 v_cvt_pk_bf16_f32 v128, v64, v65
 mf v[96:99],v[164:167],a[68:71],v[96:99]
 mf v[100:103],v[164:167],a[84:87],v[100:103]
 v_exp_f32_e64 v69, v69
 mf v[104:107],v[164:167],a[100:103],v[104:107]
 v_cvt_pk_bf16_f32 v129, v66, v67
 mf v[108:111],v[164:167],a[116:119],v[108:111]
 s_waitcnt vmcnt(12) lgkmcnt(0)
 s_barrier
 mf a[144:147],v[196:199],v[144:147],a[144:147]
 v_exp_f32_e64 v70, v70
 mf a[148:151],v[196:199],v[148:151],a[148:151]
 v_exp_f32_e64 v71, v71
 mf a[152:155],v[196:199],v[152:155],a[152:155]
 ds_read_b64 v[160:161], v20 offset:0
 ds_read_b64 v[162:163], v228 offset:0
 mf a[156:159],v[196:199],v[156:159],a[156:159]
 v_exp_f32_e64 v72, v72
 mf v[96:99],v[168:171],a[72:75],v[96:99]
 tr v[192:193],v32,16384
 v_cvt_pk_bf16_f32 v132, v68, v69
 mf v[100:103],v[168:171],a[88:91],v[100:103]
 v_exp_f32_e64 v73, v73
 mf v[104:107],v[168:171],a[104:107],v[104:107]
 tr v[194:195],v32,20480
 v_cvt_pk_bf16_f32 v133, v70, v71
 mf v[108:111],v[168:171],a[120:123],v[108:111]
 ds_read_b64 v[164:165], v21 offset:0
 ds_read_b64 v[166:167], v229 offset:0
 mf a[160:163],v[200:203],v[144:147],a[160:163]
 v_exp_f32_e64 v74, v74
 mf a[164:167],v[200:203],v[148:151],a[164:167]
 tr v[196:197],v33,16384
 tr v[198:199],v33,20480
 mf a[168:171],v[200:203],v[152:155],a[168:171]
 v_exp_f32_e64 v75, v75
 mf a[172:175],v[200:203],v[156:159],a[172:175]
 v_exp_f32_e64 v76, v76
 mf v[96:99],v[172:175],a[76:79],v[96:99]
 ds_read_b64 v[168:169], v22 offset:0
 v_cvt_pk_bf16_f32 v136, v72, v73
 mf v[100:103],v[172:175],a[92:95],v[100:103]
 ds_read_b64 v[170:171], v230 offset:0
 tr v[200:201],v34,16384
 mf v[104:107],v[172:175],a[108:111],v[104:107]
 v_exp_f32_e64 v77, v77
 mf v[108:111],v[172:175],a[124:127],v[108:111]
 tr v[202:203],v34,20480
 v_cvt_pk_bf16_f32 v137, v74, v75
 mf a[176:179],v[204:207],v[144:147],a[176:179]
 v_exp_f32_e64 v78, v78
 mf a[180:183],v[204:207],v[148:151],a[180:183]
 ds_read_b64 v[172:173], v23 offset:0
 ds_read_b64 v[174:175], v231 offset:0
 mf a[184:187],v[204:207],v[152:155],a[184:187]
 v_exp_f32_e64 v79, v79
 mf a[188:191],v[204:207],v[156:159],a[188:191]
 mf v[44:47],v[40:43],v[144:147],v[44:47]
 v_exp_f32_e64 v80, v80
 mf v[48:51],v[40:43],v[148:151],v[48:51]
 tr v[204:205],v35,16384
 v_cvt_pk_bf16_f32 v140, v76, v77
 mf v[52:55],v[40:43],v[152:155],v[52:55]
 v_exp_f32_e64 v81, v81
 mf v[56:59],v[40:43],v[156:159],v[56:59]
 tr v[206:207],v35,20480
 v_cvt_pk_bf16_f32 v141, v78, v79
 mf v[112:115],v[176:179],a[64:67],0
 mf v[116:119],v[176:179],a[80:83],0
 v_exp_f32_e64 v82, v82
 mf v[120:123],v[176:179],a[96:99],0
 mf v[124:127],v[176:179],a[112:115],0
 v_exp_f32_e64 v83, v83
 mf a[192:195],v[208:211],v[144:147],a[192:195]
 v_exp_f32_e64 v84, v84
 mf a[196:199],v[208:211],v[148:151],a[196:199]
 ds_read_b64 v[176:177], v20 offset:4096
 v_cvt_pk_bf16_f32 v130, v80, v81
 mf a[200:203],v[208:211],v[152:155],a[200:203]
 ds_read_b64 v[178:179], v228 offset:4096
 mf a[204:207],v[208:211],v[156:159],a[204:207]
 v_exp_f32_e64 v85, v85
 mf v[112:115],v[180:183],a[68:71],v[112:115]
 tr v[208:209],v36,16384
 v_cvt_pk_bf16_f32 v131, v82, v83
 mf v[116:119],v[180:183],a[84:87],v[116:119]
 v_exp_f32_e64 v86, v86
 mf v[120:123],v[180:183],a[100:103],v[120:123]
 tr v[210:211],v36,20480
 mf v[124:127],v[180:183],a[116:119],v[124:127]
 v_exp_f32_e64 v87, v87
 mf a[208:211],v[212:215],v[144:147],a[208:211]
 ds_read_b64 v[180:181], v21 offset:4096
 ds_read_b64 v[182:183], v229 offset:4096
 mf a[212:215],v[212:215],v[148:151],a[212:215]
 v_exp_f32_e64 v88, v88
 mf a[216:219],v[212:215],v[152:155],a[216:219]
 v_cvt_pk_bf16_f32 v134, v84, v85
 mf a[220:223],v[212:215],v[156:159],a[220:223]
 v_exp_f32_e64 v89, v89
 mf v[112:115],v[184:187],a[72:75],v[112:115]
 tr v[212:213],v37,16384
 v_cvt_pk_bf16_f32 v135, v86, v87
 mf v[116:119],v[184:187],a[88:91],v[116:119]
 tr v[214:215],v37,20480
 mf v[120:123],v[184:187],a[104:107],v[120:123]
 v_exp_f32_e64 v90, v90
 mf v[124:127],v[184:187],a[120:123],v[124:127]
 mf a[224:227],v[216:219],v[144:147],a[224:227]
 v_exp_f32_e64 v91, v91
 mf a[228:231],v[216:219],v[148:151],a[228:231]
 v_exp_f32_e64 v92, v92
 mf a[232:235],v[216:219],v[152:155],a[232:235]
 ds_read_b64 v[184:185], v22 offset:4096
 v_cvt_pk_bf16_f32 v138, v88, v89
 mf a[236:239],v[216:219],v[156:159],a[236:239]
 ds_read_b64 v[186:187], v230 offset:4096
 mf v[112:115],v[188:191],a[76:79],v[112:115]
 v_exp_f32_e64 v93, v93
 mf v[116:119],v[188:191],a[92:95],v[116:119]
 tr v[216:217],v38,16384
 v_cvt_pk_bf16_f32 v139, v90, v91
 mf v[120:123],v[188:191],a[108:111],v[120:123]
 v_exp_f32_e64 v94, v94
 mf v[124:127],v[188:191],a[124:127],v[124:127]
 tr v[218:219],v38,20480
 mf a[240:243],v[220:223],v[144:147],a[240:243]
 v_exp_f32_e64 v95, v95
 mf a[244:247],v[220:223],v[148:151],a[244:247]
 ds_read_b64 v[188:189], v23 offset:4096
 v_cvt_pk_bf16_f32 v142, v92, v93
 mf a[248:251],v[220:223],v[152:155],a[248:251]
 ds_read_b64 v[190:191], v231 offset:4096
 v_cvt_pk_bf16_f32 v143, v94, v95
 mf a[252:255],v[220:223],v[156:159],a[252:255]
 s_waitcnt lgkmcnt(14)
 s_nop 0
 mf v[64:67],v[160:163],a[64:67],0
 v_exp_f32_e64 v96, v96
 mf v[68:71],v[160:163],a[80:83],0
 v_exp_f32_e64 v97, v97
 mf v[72:75],v[160:163],a[96:99],0
 s_branch L_skip_8099
.p2align 12
L_stub_wa_8099:
 s_branch L_walk_ret
L_stub_wr3_8099:
 s_branch L_rw3
L_stub_wr11_8099:
 s_branch L_rw11
L_stub_wr19_8099:
 s_branch L_rw19
L_skip_8099:
 tr v[220:221],v39,16384
 tr v[222:223],v39,20480
 mf v[76:79],v[160:163],a[112:115],0
 v_exp_f32_e64 v98, v98
 mf a[128:131],v[192:195],v[128:131],a[128:131]
 ds_read_b64 v[160:161], v20 offset:8192
 ds_read_b64 v[162:163], v228 offset:8192
 mf a[132:135],v[192:195],v[132:135],a[132:135]
 v_exp_f32_e64 v99, v99
 mf a[136:139],v[192:195],v[136:139],a[136:139]
 v_exp_f32_e64 v100, v100
 mf a[140:143],v[192:195],v[140:143],a[140:143]
 v_cvt_pk_bf16_f32 v144, v96, v97
 mf v[64:67],v[164:167],a[68:71],v[64:67]
 tr v[192:193],v32,24576
 tr v[194:195],v32,28672
 mf v[68:71],v[164:167],a[84:87],v[68:71]
 v_exp_f32_e64 v101, v101
 mf v[72:75],v[164:167],a[100:103],v[72:75]
 v_cvt_pk_bf16_f32 v145, v98, v99
 mf v[76:79],v[164:167],a[116:119],v[76:79]
 v_exp_f32_e64 v102, v102
 mf a[144:147],v[196:199],v[128:131],a[144:147]
 ds_read_b64 v[164:165], v21 offset:8192
 ds_read_b64 v[166:167], v229 offset:8192
 mf a[148:151],v[196:199],v[132:135],a[148:151]
 v_exp_f32_e64 v103, v103
 mf a[152:155],v[196:199],v[136:139],a[152:155]
 mf a[156:159],v[196:199],v[140:143],a[156:159]
 v_exp_f32_e64 v104, v104
 mf v[64:67],v[168:171],a[72:75],v[64:67]
 tr v[196:197],v33,24576
 v_cvt_pk_bf16_f32 v148, v100, v101
 mf v[68:71],v[168:171],a[88:91],v[68:71]
 v_exp_f32_e64 v105, v105
 mf v[72:75],v[168:171],a[104:107],v[72:75]
 tr v[198:199],v33,28672
 v_cvt_pk_bf16_f32 v149, v102, v103
 mf v[76:79],v[168:171],a[120:123],v[76:79]
 mf a[160:163],v[200:203],v[128:131],a[160:163]
 v_exp_f32_e64 v106, v106
 mf a[164:167],v[200:203],v[132:135],a[164:167]
 ds_read_b64 v[168:169], v22 offset:8192
 ds_read_b64 v[170:171], v230 offset:8192
 mf a[168:171],v[200:203],v[136:139],a[168:171]
 v_exp_f32_e64 v107, v107
 mf a[172:175],v[200:203],v[140:143],a[172:175]
 v_exp_f32_e64 v108, v108
 mf v[64:67],v[172:175],a[76:79],v[64:67]
 tr v[200:201],v34,24576
 v_cvt_pk_bf16_f32 v152, v104, v105
 mf v[68:71],v[172:175],a[92:95],v[68:71]
 tr v[202:203],v34,28672
 mf v[72:75],v[172:175],a[108:111],v[72:75]
 v_exp_f32_e64 v109, v109
 mf v[76:79],v[172:175],a[124:127],v[76:79]
 v_cvt_pk_bf16_f32 v153, v106, v107
 mf a[176:179],v[204:207],v[128:131],a[176:179]
 v_exp_f32_e64 v110, v110
 mf a[180:183],v[204:207],v[132:135],a[180:183]
 ds_read_b64 v[172:173], v23 offset:8192
 ds_read_b64 v[174:175], v231 offset:8192
 mf a[184:187],v[204:207],v[136:139],a[184:187]
 v_exp_f32_e64 v111, v111
 mf a[188:191],v[204:207],v[140:143],a[188:191]
 mf v[44:47],v[40:43],v[128:131],v[44:47]
 v_exp_f32_e64 v112, v112
 mf v[48:51],v[40:43],v[132:135],v[48:51]
 tr v[204:205],v35,24576
 v_cvt_pk_bf16_f32 v156, v108, v109
 mf v[52:55],v[40:43],v[136:139],v[52:55]
 v_exp_f32_e64 v113, v113
 mf v[56:59],v[40:43],v[140:143],v[56:59]
 s_waitcnt lgkmcnt(14)
 s_nop 0
 mf v[80:83],v[176:179],a[64:67],0
 tr v[206:207],v35,28672
 v_cvt_pk_bf16_f32 v157, v110, v111
 mf v[84:87],v[176:179],a[80:83],0
 v_exp_f32_e64 v114, v114
 mf v[88:91],v[176:179],a[96:99],0
 mf v[92:95],v[176:179],a[112:115],0
 v_exp_f32_e64 v115, v115
 mf a[192:195],v[208:211],v[128:131],a[192:195]
 v_exp_f32_e64 v116, v116
 mf a[196:199],v[208:211],v[132:135],a[196:199]
 ds_read_b64 v[176:177], v20 offset:12288
 v_cvt_pk_bf16_f32 v146, v112, v113
 mf a[200:203],v[208:211],v[136:139],a[200:203]
 ds_read_b64 v[178:179], v228 offset:12288
 mf a[204:207],v[208:211],v[140:143],a[204:207]
 v_exp_f32_e64 v117, v117
 mf v[80:83],v[180:183],a[68:71],v[80:83]
 tr v[208:209],v36,24576
 v_cvt_pk_bf16_f32 v147, v114, v115
 mf v[84:87],v[180:183],a[84:87],v[84:87]
 v_exp_f32_e64 v118, v118
 mf v[88:91],v[180:183],a[100:103],v[88:91]
 tr v[210:211],v36,28672
 mf v[92:95],v[180:183],a[116:119],v[92:95]
 v_exp_f32_e64 v119, v119
 mf a[208:211],v[212:215],v[128:131],a[208:211]
 ds_read_b64 v[180:181], v21 offset:12288
 ds_read_b64 v[182:183], v229 offset:12288
 mf a[212:215],v[212:215],v[132:135],a[212:215]
 v_exp_f32_e64 v120, v120
 mf a[216:219],v[212:215],v[136:139],a[216:219]
 v_cvt_pk_bf16_f32 v150, v116, v117
 mf a[220:223],v[212:215],v[140:143],a[220:223]
 v_exp_f32_e64 v121, v121
 mf v[80:83],v[184:187],a[72:75],v[80:83]
 tr v[212:213],v37,24576
 v_cvt_pk_bf16_f32 v151, v118, v119
 mf v[84:87],v[184:187],a[88:91],v[84:87]
 tr v[214:215],v37,28672
 mf v[88:91],v[184:187],a[104:107],v[88:91]
 v_exp_f32_e64 v122, v122
 mf v[92:95],v[184:187],a[120:123],v[92:95]
 mf a[224:227],v[216:219],v[128:131],a[224:227]
 v_exp_f32_e64 v123, v123
 mf a[228:231],v[216:219],v[132:135],a[228:231]
 v_exp_f32_e64 v124, v124
 mf a[232:235],v[216:219],v[136:139],a[232:235]
 ds_read_b64 v[184:185], v22 offset:12288
 v_cvt_pk_bf16_f32 v154, v120, v121
 mf a[236:239],v[216:219],v[140:143],a[236:239]
 ds_read_b64 v[186:187], v230 offset:12288
 mf v[80:83],v[188:191],a[76:79],v[80:83]
 v_exp_f32_e64 v125, v125
 mf v[84:87],v[188:191],a[92:95],v[84:87]
 tr v[216:217],v38,24576
 v_cvt_pk_bf16_f32 v155, v122, v123
 mf v[88:91],v[188:191],a[108:111],v[88:91]
 v_exp_f32_e64 v126, v126
 mf v[92:95],v[188:191],a[124:127],v[92:95]
 tr v[218:219],v38,28672
 mf a[240:243],v[220:223],v[128:131],a[240:243]
 v_exp_f32_e64 v127, v127
 mf a[244:247],v[220:223],v[132:135],a[244:247]
 ds_read_b64 v[188:189], v23 offset:12288
 v_cvt_pk_bf16_f32 v158, v124, v125
 mf a[248:251],v[220:223],v[136:139],a[248:251]
 ds_read_b64 v[190:191], v231 offset:12288
 v_cvt_pk_bf16_f32 v159, v126, v127
 mf a[252:255],v[220:223],v[140:143],a[252:255]
 s_waitcnt lgkmcnt(14)
 s_nop 0
 mf v[96:99],v[160:163],a[64:67],0
 v_exp_f32_e64 v64, v64
 mf v[100:103],v[160:163],a[80:83],0
 v_exp_f32_e64 v65, v65
 mf v[104:107],v[160:163],a[96:99],0
 tr v[220:221],v39,24576
 tr v[222:223],v39,28672
 mf v[108:111],v[160:163],a[112:115],0
 v_exp_f32_e64 v66, v66
 mf a[128:131],v[192:195],v[144:147],a[128:131]
 mf a[132:135],v[192:195],v[148:151],a[132:135]
 v_exp_f32_e64 v67, v67
 mf a[136:139],v[192:195],v[152:155],a[136:139]
 v_exp_f32_e64 v68, v68
 mf a[140:143],v[192:195],v[156:159],a[140:143]
 v_cvt_pk_bf16_f32 v128, v64, v65
 mf v[96:99],v[164:167],a[68:71],v[96:99]
 mf v[100:103],v[164:167],a[84:87],v[100:103]
 v_exp_f32_e64 v69, v69
 mf v[104:107],v[164:167],a[100:103],v[104:107]
 v_cvt_pk_bf16_f32 v129, v66, v67
 mf v[108:111],v[164:167],a[116:119],v[108:111]
 s_waitcnt vmcnt(4) lgkmcnt(0)
 s_barrier
 mf a[144:147],v[196:199],v[144:147],a[144:147]
 v_exp_f32_e64 v70, v70
 mf a[148:151],v[196:199],v[148:151],a[148:151]
 v_exp_f32_e64 v71, v71
 mf a[152:155],v[196:199],v[152:155],a[152:155]
 ds_read_b64 v[160:161], v20 offset:32768
 ds_read_b64 v[162:163], v228 offset:32768
 mf a[156:159],v[196:199],v[156:159],a[156:159]
 v_exp_f32_e64 v72, v72
 mf v[96:99],v[168:171],a[72:75],v[96:99]
 tr v[192:193],v32,49152
 v_cvt_pk_bf16_f32 v132, v68, v69
 mf v[100:103],v[168:171],a[88:91],v[100:103]
 v_exp_f32_e64 v73, v73
 mf v[104:107],v[168:171],a[104:107],v[104:107]
 tr v[194:195],v32,53248
 v_cvt_pk_bf16_f32 v133, v70, v71
 mf v[108:111],v[168:171],a[120:123],v[108:111]
 ds_read_b64 v[164:165], v21 offset:32768
 ds_read_b64 v[166:167], v229 offset:32768
 mf a[160:163],v[200:203],v[144:147],a[160:163]
 v_exp_f32_e64 v74, v74
 mf a[164:167],v[200:203],v[148:151],a[164:167]
 tr v[196:197],v33,49152
 tr v[198:199],v33,53248
 mf a[168:171],v[200:203],v[152:155],a[168:171]
 v_exp_f32_e64 v75, v75
 mf a[172:175],v[200:203],v[156:159],a[172:175]
 v_exp_f32_e64 v76, v76
 mf v[96:99],v[172:175],a[76:79],v[96:99]
 ds_read_b64 v[168:169], v22 offset:32768
 v_cvt_pk_bf16_f32 v136, v72, v73
 mf v[100:103],v[172:175],a[92:95],v[100:103]
 ds_read_b64 v[170:171], v230 offset:32768
 tr v[200:201],v34,49152
 mf v[104:107],v[172:175],a[108:111],v[104:107]
 v_exp_f32_e64 v77, v77
 mf v[108:111],v[172:175],a[124:127],v[108:111]
 tr v[202:203],v34,53248
 v_cvt_pk_bf16_f32 v137, v74, v75
 mf a[176:179],v[204:207],v[144:147],a[176:179]
 v_exp_f32_e64 v78, v78
 mf a[180:183],v[204:207],v[148:151],a[180:183]
 ds_read_b64 v[172:173], v23 offset:32768
 ds_read_b64 v[174:175], v231 offset:32768
 mf a[184:187],v[204:207],v[152:155],a[184:187]
 v_exp_f32_e64 v79, v79
 mf a[188:191],v[204:207],v[156:159],a[188:191]
 mf v[44:47],v[40:43],v[144:147],v[44:47]
 v_exp_f32_e64 v80, v80
 mf v[48:51],v[40:43],v[148:151],v[48:51]
 tr v[204:205],v35,49152
 v_cvt_pk_bf16_f32 v140, v76, v77
 mf v[52:55],v[40:43],v[152:155],v[52:55]
 v_exp_f32_e64 v81, v81
 mf v[56:59],v[40:43],v[156:159],v[56:59]
 tr v[206:207],v35,53248
 v_cvt_pk_bf16_f32 v141, v78, v79
 mf v[112:115],v[176:179],a[64:67],0
 mf v[116:119],v[176:179],a[80:83],0
 v_exp_f32_e64 v82, v82
 mf v[120:123],v[176:179],a[96:99],0
 mf v[124:127],v[176:179],a[112:115],0
 v_exp_f32_e64 v83, v83
 mf a[192:195],v[208:211],v[144:147],a[192:195]
 v_exp_f32_e64 v84, v84
 mf a[196:199],v[208:211],v[148:151],a[196:199]
 ds_read_b64 v[176:177], v20 offset:36864
 v_cvt_pk_bf16_f32 v130, v80, v81
 mf a[200:203],v[208:211],v[152:155],a[200:203]
 ds_read_b64 v[178:179], v228 offset:36864
 mf a[204:207],v[208:211],v[156:159],a[204:207]
 v_exp_f32_e64 v85, v85
 mf v[112:115],v[180:183],a[68:71],v[112:115]
 tr v[208:209],v36,49152
 v_cvt_pk_bf16_f32 v131, v82, v83
 mf v[116:119],v[180:183],a[84:87],v[116:119]
 v_exp_f32_e64 v86, v86
 mf v[120:123],v[180:183],a[100:103],v[120:123]
 tr v[210:211],v36,53248
 mf v[124:127],v[180:183],a[116:119],v[124:127]
 v_exp_f32_e64 v87, v87
 mf a[208:211],v[212:215],v[144:147],a[208:211]
 ds_read_b64 v[180:181], v21 offset:36864
 ds_read_b64 v[182:183], v229 offset:36864
 mf a[212:215],v[212:215],v[148:151],a[212:215]
 v_exp_f32_e64 v88, v88
 mf a[216:219],v[212:215],v[152:155],a[216:219]
 v_cvt_pk_bf16_f32 v134, v84, v85
 mf a[220:223],v[212:215],v[156:159],a[220:223]
 v_exp_f32_e64 v89, v89
 mf v[112:115],v[184:187],a[72:75],v[112:115]
 tr v[212:213],v37,49152
 v_cvt_pk_bf16_f32 v135, v86, v87
 mf v[116:119],v[184:187],a[88:91],v[116:119]
 tr v[214:215],v37,53248
 mf v[120:123],v[184:187],a[104:107],v[120:123]
 v_exp_f32_e64 v90, v90
 mf v[124:127],v[184:187],a[120:123],v[124:127]
 mf a[224:227],v[216:219],v[144:147],a[224:227]
 v_exp_f32_e64 v91, v91
 mf a[228:231],v[216:219],v[148:151],a[228:231]
 v_exp_f32_e64 v92, v92
 mf a[232:235],v[216:219],v[152:155],a[232:235]
 ds_read_b64 v[184:185], v22 offset:36864
 v_cvt_pk_bf16_f32 v138, v88, v89
 mf a[236:239],v[216:219],v[156:159],a[236:239]
 ds_read_b64 v[186:187], v230 offset:36864
 mf v[112:115],v[188:191],a[76:79],v[112:115]
 v_exp_f32_e64 v93, v93
 mf v[116:119],v[188:191],a[92:95],v[116:119]
 tr v[216:217],v38,49152
 v_cvt_pk_bf16_f32 v139, v90, v91
 mf v[120:123],v[188:191],a[108:111],v[120:123]
 v_exp_f32_e64 v94, v94
 mf v[124:127],v[188:191],a[124:127],v[124:127]
 tr v[218:219],v38,53248
 mf a[240:243],v[220:223],v[144:147],a[240:243]
 v_exp_f32_e64 v95, v95
 mf a[244:247],v[220:223],v[148:151],a[244:247]
 ds_read_b64 v[188:189], v23 offset:36864
 v_cvt_pk_bf16_f32 v142, v92, v93
 mf a[248:251],v[220:223],v[152:155],a[248:251]
 ds_read_b64 v[190:191], v231 offset:36864
 v_cvt_pk_bf16_f32 v143, v94, v95
 mf a[252:255],v[220:223],v[156:159],a[252:255]
 s_waitcnt lgkmcnt(14)
 s_nop 0
 mf v[64:67],v[160:163],a[64:67],0
 v_exp_f32_e64 v96, v96
 mf v[68:71],v[160:163],a[80:83],0
 v_exp_f32_e64 v97, v97
 mf v[72:75],v[160:163],a[96:99],0
 tr v[220:221],v39,49152
 tr v[222:223],v39,53248
 mf v[76:79],v[160:163],a[112:115],0
 v_exp_f32_e64 v98, v98
 mf a[128:131],v[192:195],v[128:131],a[128:131]
 ds_read_b64 v[160:161], v20 offset:40960
 ds_read_b64 v[162:163], v228 offset:40960
 mf a[132:135],v[192:195],v[132:135],a[132:135]
 v_exp_f32_e64 v99, v99
 mf a[136:139],v[192:195],v[136:139],a[136:139]
 v_exp_f32_e64 v100, v100
 mf a[140:143],v[192:195],v[140:143],a[140:143]
 v_cvt_pk_bf16_f32 v144, v96, v97
 mf v[64:67],v[164:167],a[68:71],v[64:67]
 tr v[192:193],v32,57344
 tr v[194:195],v32,61440
 mf v[68:71],v[164:167],a[84:87],v[68:71]
 v_exp_f32_e64 v101, v101
 mf v[72:75],v[164:167],a[100:103],v[72:75]
 v_cvt_pk_bf16_f32 v145, v98, v99
 mf v[76:79],v[164:167],a[116:119],v[76:79]
 v_exp_f32_e64 v102, v102
 mf a[144:147],v[196:199],v[128:131],a[144:147]
 ds_read_b64 v[164:165], v21 offset:40960
 ds_read_b64 v[166:167], v229 offset:40960
 mf a[148:151],v[196:199],v[132:135],a[148:151]
 v_exp_f32_e64 v103, v103
 mf a[152:155],v[196:199],v[136:139],a[152:155]
 mf a[156:159],v[196:199],v[140:143],a[156:159]
 v_exp_f32_e64 v104, v104
 mf v[64:67],v[168:171],a[72:75],v[64:67]
 tr v[196:197],v33,57344
 v_cvt_pk_bf16_f32 v148, v100, v101
 mf v[68:71],v[168:171],a[88:91],v[68:71]
 v_exp_f32_e64 v105, v105
 mf v[72:75],v[168:171],a[104:107],v[72:75]
 tr v[198:199],v33,61440
 v_cvt_pk_bf16_f32 v149, v102, v103
 mf v[76:79],v[168:171],a[120:123],v[76:79]
 mf a[160:163],v[200:203],v[128:131],a[160:163]
 v_exp_f32_e64 v106, v106
 mf a[164:167],v[200:203],v[132:135],a[164:167]
 ds_read_b64 v[168:169], v22 offset:40960
 ds_read_b64 v[170:171], v230 offset:40960
 mf a[168:171],v[200:203],v[136:139],a[168:171]
 v_exp_f32_e64 v107, v107
 mf a[172:175],v[200:203],v[140:143],a[172:175]
 v_exp_f32_e64 v108, v108
 mf v[64:67],v[172:175],a[76:79],v[64:67]
 tr v[200:201],v34,57344
 v_cvt_pk_bf16_f32 v152, v104, v105
 mf v[68:71],v[172:175],a[92:95],v[68:71]
 tr v[202:203],v34,61440
 mf v[72:75],v[172:175],a[108:111],v[72:75]
 v_exp_f32_e64 v109, v109
 mf v[76:79],v[172:175],a[124:127],v[76:79]
 v_cvt_pk_bf16_f32 v153, v106, v107
 mf a[176:179],v[204:207],v[128:131],a[176:179]
 v_exp_f32_e64 v110, v110
 mf a[180:183],v[204:207],v[132:135],a[180:183]
 ds_read_b64 v[172:173], v23 offset:40960
 ds_read_b64 v[174:175], v231 offset:40960
 mf a[184:187],v[204:207],v[136:139],a[184:187]
 v_exp_f32_e64 v111, v111
 mf a[188:191],v[204:207],v[140:143],a[188:191]
 mf v[44:47],v[40:43],v[128:131],v[44:47]
 v_exp_f32_e64 v112, v112
 mf v[48:51],v[40:43],v[132:135],v[48:51]
 tr v[204:205],v35,57344
 v_cvt_pk_bf16_f32 v156, v108, v109
 mf v[52:55],v[40:43],v[136:139],v[52:55]
 v_exp_f32_e64 v113, v113
 mf v[56:59],v[40:43],v[140:143],v[56:59]
 s_waitcnt lgkmcnt(14)
 s_nop 0
 mf v[80:83],v[176:179],a[64:67],0
 tr v[206:207],v35,61440
 v_cvt_pk_bf16_f32 v157, v110, v111
 mf v[84:87],v[176:179],a[80:83],0
 v_exp_f32_e64 v114, v114
 mf v[88:91],v[176:179],a[96:99],0
 mf v[92:95],v[176:179],a[112:115],0
 v_exp_f32_e64 v115, v115
 mf a[192:195],v[208:211],v[128:131],a[192:195]
 v_exp_f32_e64 v116, v116
 mf a[196:199],v[208:211],v[132:135],a[196:199]
 ds_read_b64 v[176:177], v20 offset:45056
 v_cvt_pk_bf16_f32 v146, v112, v113
 mf a[200:203],v[208:211],v[136:139],a[200:203]
 ds_read_b64 v[178:179], v228 offset:45056
 mf a[204:207],v[208:211],v[140:143],a[204:207]
 v_exp_f32_e64 v117, v117
 mf v[80:83],v[180:183],a[68:71],v[80:83]
 tr v[208:209],v36,57344
 v_cvt_pk_bf16_f32 v147, v114, v115
 mf v[84:87],v[180:183],a[84:87],v[84:87]
 v_exp_f32_e64 v118, v118
 mf v[88:91],v[180:183],a[100:103],v[88:91]
 tr v[210:211],v36,61440
 mf v[92:95],v[180:183],a[116:119],v[92:95]
 v_exp_f32_e64 v119, v119
 mf a[208:211],v[212:215],v[128:131],a[208:211]
 ds_read_b64 v[180:181], v21 offset:45056
 ds_read_b64 v[182:183], v229 offset:45056
 mf a[212:215],v[212:215],v[132:135],a[212:215]
 v_exp_f32_e64 v120, v120
 mf a[216:219],v[212:215],v[136:139],a[216:219]
 v_cvt_pk_bf16_f32 v150, v116, v117
 mf a[220:223],v[212:215],v[140:143],a[220:223]
 v_exp_f32_e64 v121, v121
 mf v[80:83],v[184:187],a[72:75],v[80:83]
 tr v[212:213],v37,57344
 v_cvt_pk_bf16_f32 v151, v118, v119
 mf v[84:87],v[184:187],a[88:91],v[84:87]
 tr v[214:215],v37,61440
 mf v[88:91],v[184:187],a[104:107],v[88:91]
 v_exp_f32_e64 v122, v122
 mf v[92:95],v[184:187],a[120:123],v[92:95]
 mf a[224:227],v[216:219],v[128:131],a[224:227]
 v_exp_f32_e64 v123, v123
 mf a[228:231],v[216:219],v[132:135],a[228:231]
 v_exp_f32_e64 v124, v124
 mf a[232:235],v[216:219],v[136:139],a[232:235]
 ds_read_b64 v[184:185], v22 offset:45056
 v_cvt_pk_bf16_f32 v154, v120, v121
 mf a[236:239],v[216:219],v[140:143],a[236:239]
 ds_read_b64 v[186:187], v230 offset:45056
 mf v[80:83],v[188:191],a[76:79],v[80:83]
 v_exp_f32_e64 v125, v125
 mf v[84:87],v[188:191],a[92:95],v[84:87]
 tr v[216:217],v38,57344
 v_cvt_pk_bf16_f32 v155, v122, v123
 mf v[88:91],v[188:191],a[108:111],v[88:91]
 v_exp_f32_e64 v126, v126
 mf v[92:95],v[188:191],a[124:127],v[92:95]
 tr v[218:219],v38,61440
 mf a[240:243],v[220:223],v[128:131],a[240:243]
 v_exp_f32_e64 v127, v127
 mf a[244:247],v[220:223],v[132:135],a[244:247]
 ds_read_b64 v[188:189], v23 offset:45056
 v_cvt_pk_bf16_f32 v158, v124, v125
 mf a[248:251],v[220:223],v[136:139],a[248:251]
 ds_read_b64 v[190:191], v231 offset:45056
 v_cvt_pk_bf16_f32 v159, v126, v127
 mf a[252:255],v[220:223],v[140:143],a[252:255]
 s_waitcnt lgkmcnt(14)
 s_nop 0
 mf v[96:99],v[160:163],a[64:67],0
 v_exp_f32_e64 v64, v64
 mf v[100:103],v[160:163],a[80:83],0
 tr v[220:221],v39,57344
 s_and_b32 s40, s39, 3
 s_nop 0
 mf v[104:107],v[160:163],a[96:99],0
 v_exp_f32_e64 v65, v65
 mf v[108:111],v[160:163],a[112:115],0
 tr v[222:223],v39,61440
 s_and_b32 s41, s96, 1
 s_nop 0
 mf a[128:131],v[192:195],v[144:147],a[128:131]
 v_exp_f32_e64 v66, v66
 mf a[132:135],v[192:195],v[148:151],a[132:135]
 s_lshl_b32 s41, s41, 2
 s_nop 0
 mf a[136:139],v[192:195],v[152:155],a[136:139]
 v_exp_f32_e64 v67, v67
 mf a[140:143],v[192:195],v[156:159],a[140:143]
 s_add_u32 s40, s40, s41
 s_nop 0
 mf v[96:99],v[164:167],a[68:71],v[96:99]
 v_exp_f32_e64 v68, v68
 mf v[100:103],v[164:167],a[84:87],v[100:103]
 s_bfe_u32 s41, s39, 0x20002
 v_cvt_pk_bf16_f32 v128, v64, v65
 mf v[104:107],v[164:167],a[100:103],v[104:107]
 s_and_b32 s42, s96, 2
 s_nop 0
 mf v[108:111],v[164:167],a[116:119],v[108:111]
 v_exp_f32_e64 v69, v69
 s_waitcnt vmcnt(0) lgkmcnt(0)
 s_barrier
 mf a[144:147],v[196:199],v[144:147],a[144:147]
 s_lshl_b32 s42, s42, 1
 s_add_u32 s41, s41, s42
 mf a[148:151],v[196:199],v[148:151],a[148:151]
 v_cvt_pk_bf16_f32 v129, v66, v67
 s_bfe_u32 s42, s96, 0x10002
 mf a[152:155],v[196:199],v[152:155],a[152:155]
 v_exp_f32_e64 v70, v70
 mf a[156:159],v[196:199],v[156:159],a[156:159]
 s_mul_i32 s98, s42, 0
 v_exp_f32 v71, v71
 mf v[96:99],v[168:171],a[72:75],v[96:99]
 tr v[192:193],v24,16384
 s_mul_i32 s97, s98, 3
 s_nop 0
 mf v[100:103],v[168:171],a[88:91],v[100:103]
 v_exp_f32_e64 v72, v72
 mf v[104:107],v[168:171],a[104:107],v[104:107]
 s_sub_u32 s97, 26, s97
 s_nop 0
 v_cvt_pk_bf16_f32 v132, v68, v69
 mf v[108:111],v[168:171],a[120:123],v[108:111]
 s_mul_i32 s81, s42, 3407872
 v_exp_f32_e64 v73, v73
 mf a[160:163],v[200:203],v[144:147],a[160:163]
 s_lshl_b32 s31, s41, 8
 s_nop 0
 v_cvt_pk_bf16_f32 v133, v70, v71
 mf a[164:167],v[200:203],v[148:151],a[164:167]
 s_add_u32 s81, s81, s31
 s_nop 0
 s_mul_i32 s82, s42, 6815744
 mf a[168:171],v[200:203],v[152:155],a[168:171]
 v_exp_f32_e64 v74, v74
 mf a[172:175],v[200:203],v[156:159],a[172:175]
 tr v[194:195],v24,20480
 s_lshl_b32 s31, s40, 14
 s_nop 0
 mf v[96:99],v[172:175],a[76:79],v[96:99]
 v_exp_f32_e64 v75, v75
 mf v[100:103],v[172:175],a[92:95],v[100:103]
 s_add_u32 s82, s82, s31
 v_exp_f32 v76, v76
 mf v[104:107],v[172:175],a[108:111],v[104:107]
 s_branch L_skip_8628
.p2align 12
L_stub_wa_8628:
 s_branch L_walk_ret
L_stub_wr3_8628:
 s_branch L_rw3
L_stub_wr11_8628:
 s_branch L_rw11
L_stub_wr19_8628:
 s_branch L_rw19
L_skip_8628:
 s_lshl_b32 s31, s22, 17
 s_nop 0
 v_cvt_pk_bf16_f32 v136, v72, v73
 mf v[108:111],v[172:175],a[124:127],v[108:111]
 tr v[196:197],v25,16384
 s_add_u32 s82, s82, s31
 s_nop 0
 mf a[176:179],v[204:207],v[144:147],a[176:179]
 v_exp_f32_e64 v77, v77
 mf a[180:183],v[204:207],v[148:151],a[180:183]
 s_lshl_b32 s31, s21, 13
 s_nop 0
 v_cvt_pk_bf16_f32 v137, v74, v75
 mf a[184:187],v[204:207],v[152:155],a[184:187]
 s_add_u32 s82, s82, s31
 v_exp_f32 v78, v78
 mf a[188:191],v[204:207],v[156:159],a[188:191]
 s_lshl_b32 s88, s40, 8
 s_nop 0
 s_add_u32 s88, s88, 8192
 mf v[44:47],v[40:43],v[144:147],v[44:47]
 v_exp_f32_e64 v79, v79
 mf v[48:51],v[40:43],v[148:151],v[48:51]
 tr v[198:199],v25,20480
 s_lshl_b32 s87, s40, 1
 s_nop 0
 mf v[52:55],v[40:43],v[152:155],v[52:55]
 v_exp_f32_e64 v80, v80
 mf v[56:59],v[40:43],v[156:159],v[56:59]
 s_add_u32 s87, s87, s22
 s_nop 0
 v_cvt_pk_bf16_f32 v140, v76, v77
 mf v[112:115],v[176:179],a[64:67],0
 s_lshl_b32 s87, s87, 3
 v_exp_f32 v81, v81
 mf v[116:119],v[176:179],a[80:83],0
 s_add_u32 s87, s87, s41
 s_nop 0
 v_cvt_pk_bf16_f32 v141, v78, v79
 mf v[120:123],v[176:179],a[96:99],0
 tr v[200:201],v26,16384
 s_lshl_b32 s87, s87, 15
 s_nop 0
 mf v[124:127],v[176:179],a[112:115],0
 v_exp_f32_e64 v82, v82
 mf a[192:195],v[208:211],v[144:147],a[192:195]
 s_lshl_b32 s31, s42, 22
 v_exp_f32 v83, v83
 mf a[196:199],v[208:211],v[148:151],a[196:199]
 s_add_u32 s87, s87, s31
 s_lshl_b32 s31, s21, 13
 mf a[200:203],v[208:211],v[152:155],a[200:203]
 v_exp_f32_e64 v84, v84
 mf a[204:207],v[208:211],v[156:159],a[204:207]
 s_add_u32 s87, s87, s31
 s_nop 0
 v_cvt_pk_bf16_f32 v130, v80, v81
 mf v[112:115],v[180:183],a[68:71],v[112:115]
 tr v[202:203],v26,20480
 s_lshl_b32 s86, s40, 3
 s_nop 0
 mf v[116:119],v[180:183],a[84:87],v[116:119]
 v_exp_f32_e64 v85, v85
 mf v[120:123],v[180:183],a[100:103],v[120:123]
 s_add_u32 s86, s86, s41
 s_nop 0
 v_cvt_pk_bf16_f32 v131, v82, v83
 mf v[124:127],v[180:183],a[116:119],v[124:127]
 s_lshl_b32 s86, s86, 6
 v_exp_f32 v86, v86
 mf a[208:211],v[212:215],v[144:147],a[208:211]
 tr v[204:205],v27,16384
 s_lshl_b32 s31, s42, 3
 s_nop 0
 mf a[212:215],v[212:215],v[148:151],a[212:215]
 v_exp_f32_e64 v87, v87
 mf a[216:219],v[212:215],v[152:155],a[216:219]
 s_add_u32 s86, s86, s31
 v_exp_f32 v88, v88
 mf a[220:223],v[212:215],v[156:159],a[220:223]
 s_add_u32 s86, s86, 12288
 s_bfe_u32 s43, s96, 0x20001
 mf v[112:115],v[184:187],a[72:75],v[112:115]
 v_cvt_pk_bf16_f32 v134, v84, v85
 s_lshl_b32 s89, s43, 5
 s_nop 0
 mf v[116:119],v[184:187],a[88:91],v[116:119]
 v_exp_f32_e64 v89, v89
 mf v[120:123],v[184:187],a[104:107],v[120:123]
 s_add_u32 s89, s89, s88
 s_nop 0
 v_cvt_pk_bf16_f32 v135, v86, v87
 mf v[124:127],v[184:187],a[120:123],v[124:127]
 tr v[206:207],v27,20480
 s_xor_b32 s88, s89, 32
 s_nop 0
 mf a[224:227],v[216:219],v[144:147],a[224:227]
 v_exp_f32_e64 v90, v90
 mf a[228:231],v[216:219],v[148:151],a[228:231]
 s_mul_i32 s42, s42, 26
 v_exp_f32 v91, v91
 mf a[232:235],v[216:219],v[152:155],a[232:235]
 tr v[208:209],v28,16384
 s_lshl_b32 s43, s43, 4
 s_nop 0
 mf a[236:239],v[216:219],v[156:159],a[236:239]
 v_exp_f32_e64 v92, v92
 mf v[112:115],v[188:191],a[76:79],v[112:115]
 s_sub_u32 s42, s43, s42
 s_nop 0
 v_cvt_pk_bf16_f32 v138, v88, v89
 mf v[116:119],v[188:191],a[92:95],v[116:119]
 s_lshl_b32 s31, s42, 17
 s_add_u32 s81, s81, s31
 mf v[120:123],v[188:191],a[108:111],v[120:123]
 v_exp_f32_e64 v93, v93
 mf v[124:127],v[188:191],a[124:127],v[124:127]
 s_lshl_b32 s31, s42, 18
 s_nop 0
 v_cvt_pk_bf16_f32 v139, v90, v91
 mf a[240:243],v[220:223],v[144:147],a[240:243]
 s_add_u32 s82, s82, s31
 v_exp_f32 v94, v94
 mf a[244:247],v[220:223],v[148:151],a[244:247]
 tr v[210:211],v28,20480
 s_and_b32 s43, s43, 16
 s_nop 0
 mf a[248:251],v[220:223],v[152:155],a[248:251]
 v_exp_f32_e64 v95, v95
 mf a[252:255],v[220:223],v[156:159],a[252:255]
 s_lshl_b32 s43, s43, 1
 s_nop 0
 v_cvt_pk_bf16_f32 v142, v92, v93
 s_sub_u32 s43, 4, s43
 s_nop 0
 v_cvt_pk_bf16_f32 v143, v94, v95
 s_lshl_b32 s85, s43, 17
 s_lshl_b32 s90, s43, 18
 tr v[212:213],v29,16384
 tr v[214:215],v29,20480
 tr v[216:217],v30,16384
 tr v[218:219],v30,20480
 tr v[220:221],v31,16384
 tr v[222:223],v31,20480
 s_waitcnt lgkmcnt(14)
 s_nop 0
 mf a[128:131],v[192:195],v[128:131],a[128:131]
 v_exp_f32_e64 v96, v96
 mf a[132:135],v[192:195],v[132:135],a[132:135]
 v_exp_f32_e64 v97, v97
 mf a[136:139],v[192:195],v[136:139],a[136:139]
 v_exp_f32_e64 v98, v98
 mf a[140:143],v[192:195],v[140:143],a[140:143]
 v_exp_f32 v99, v99
 s_waitcnt lgkmcnt(12)
 mf a[144:147],v[196:199],v[128:131],a[144:147]
 v_exp_f32_e64 v100, v100
 mf a[148:151],v[196:199],v[132:135],a[148:151]
 tr v[192:193],v24,24576
 v_cvt_pk_bf16_f32 v144, v96, v97
 mf a[152:155],v[196:199],v[136:139],a[152:155]
 v_exp_f32_e64 v101, v101
 mf a[156:159],v[196:199],v[140:143],a[156:159]
 tr v[194:195],v24,28672
 v_cvt_pk_bf16_f32 v145, v98, v99
 s_waitcnt lgkmcnt(12)
 s_nop 0
 mf a[160:163],v[200:203],v[128:131],a[160:163]
 v_exp_f32_e64 v102, v102
 mf a[164:167],v[200:203],v[132:135],a[164:167]
 v_exp_f32_e64 v103, v103
 mf a[168:171],v[200:203],v[136:139],a[168:171]
 v_exp_f32_e64 v104, v104
 mf a[172:175],v[200:203],v[140:143],a[172:175]
 v_cvt_pk_bf16_f32 v148, v100, v101
 v_exp_f32 v105, v105
 s_waitcnt lgkmcnt(10)
 mf a[176:179],v[204:207],v[128:131],a[176:179]
 tr v[196:197],v25,24576
 v_cvt_pk_bf16_f32 v149, v102, v103
 mf a[180:183],v[204:207],v[132:135],a[180:183]
 v_exp_f32 v106, v106
 v_exp_f32 v107, v107
 mf a[184:187],v[204:207],v[136:139],a[184:187]
 v_exp_f32_e64 v108, v108
 mf a[188:191],v[204:207],v[140:143],a[188:191]
 tr v[198:199],v25,28672
 v_cvt_pk_bf16_f32 v152, v104, v105
 mf v[44:47],v[40:43],v[128:131],v[44:47]
 v_exp_f32_e64 v109, v109
 mf v[48:51],v[40:43],v[132:135],v[48:51]
 v_cvt_pk_bf16_f32 v153, v106, v107
 v_exp_f32_e64 v110, v110
 mf v[52:55],v[40:43],v[136:139],v[52:55]
 v_exp_f32_e64 v111, v111
 mf v[56:59],v[40:43],v[140:143],v[56:59]
 v_exp_f32 v112, v112
 s_waitcnt lgkmcnt(10)
 mf a[192:195],v[208:211],v[128:131],a[192:195]
 v_cvt_pk_bf16_f32 v156, v108, v109
 v_exp_f32_e64 v113, v113
 mf a[196:199],v[208:211],v[132:135],a[196:199]
 tr v[200:201],v26,24576
 v_cvt_pk_bf16_f32 v157, v110, v111
 mf a[200:203],v[208:211],v[136:139],a[200:203]
 v_exp_f32 v114, v114
 v_exp_f32 v115, v115
 mf a[204:207],v[208:211],v[140:143],a[204:207]
 v_exp_f32 v116, v116
 s_waitcnt lgkmcnt(9)
 mf a[208:211],v[212:215],v[128:131],a[208:211]
 tr v[202:203],v26,28672
 v_cvt_pk_bf16_f32 v146, v112, v113
 mf a[212:215],v[212:215],v[132:135],a[212:215]
 v_exp_f32_e64 v117, v117
 mf a[216:219],v[212:215],v[136:139],a[216:219]
 v_cvt_pk_bf16_f32 v147, v114, v115
 v_exp_f32_e64 v118, v118
 mf a[220:223],v[212:215],v[140:143],a[220:223]
 v_exp_f32 v119, v119
 s_waitcnt lgkmcnt(8)
 mf a[224:227],v[216:219],v[128:131],a[224:227]
 v_exp_f32_e64 v120, v120
 mf a[228:231],v[216:219],v[132:135],a[228:231]
 v_cvt_pk_bf16_f32 v150, v116, v117
 v_exp_f32_e64 v121, v121
 mf a[232:235],v[216:219],v[136:139],a[232:235]
 tr v[204:205],v27,24576
 v_cvt_pk_bf16_f32 v151, v118, v119
 mf a[236:239],v[216:219],v[140:143],a[236:239]
 v_exp_f32_e64 v122, v122
 v_exp_f32 v123, v123
 s_waitcnt lgkmcnt(7)
 mf a[240:243],v[220:223],v[128:131],a[240:243]
 v_exp_f32_e64 v124, v124
 mf a[244:247],v[220:223],v[132:135],a[244:247]
 tr v[206:207],v27,28672
 v_cvt_pk_bf16_f32 v154, v120, v121
 mf a[248:251],v[220:223],v[136:139],a[248:251]
 v_exp_f32_e64 v125, v125
 mf a[252:255],v[220:223],v[140:143],a[252:255]
 v_cvt_pk_bf16_f32 v155, v122, v123
 v_exp_f32 v126, v126
 s_nop 0
 v_exp_f32 v127, v127
 s_nop 0
 v_cvt_pk_bf16_f32 v158, v124, v125
 v_cvt_pk_bf16_f32 v159, v126, v127
 tr v[208:209],v28,24576
 tr v[210:211],v28,28672
 tr v[212:213],v29,24576
 tr v[214:215],v29,28672
 tr v[216:217],v30,24576
 tr v[218:219],v30,28672
 tr v[220:221],v31,24576
 tr v[222:223],v31,28672
 s_waitcnt lgkmcnt(14)
 s_nop 0
 mf a[128:131],v[192:195],v[144:147],a[128:131]
 s_lshl_b32 s31, s20, 4
 v_add_u32 v5, s31, v2
 mf a[132:135],v[192:195],v[148:151],a[132:135]
 v_lshlrev_b32 v5, 11, v5
 v_and_b32 v6, 15, v1
 mf a[136:139],v[192:195],v[152:155],a[136:139]
 v_or_b32 v7, 0, v2
 v_lshlrev_b32 v7, 1, v7
 mf a[140:143],v[192:195],v[156:159],a[140:143]
 v_xor_b32_e64 v7, v7, v6
 v_lshl_add_u32 v7, v7, 4, v5
 s_waitcnt lgkmcnt(12)
 s_nop 0
 mf a[144:147],v[196:199],v[144:147],a[144:147]
 v_add_u32_e64 v8, 0, v7
 mf a[148:151],v[196:199],v[148:151],a[148:151]
 v_or_b32 v7, 4, v2
 v_lshlrev_b32 v7, 1, v7
 mf a[152:155],v[196:199],v[152:155],a[152:155]
 v_xor_b32_e64 v7, v7, v6
 mf a[156:159],v[196:199],v[156:159],a[156:159]
 v_lshl_add_u32 v7, v7, 4, v5
 v_add_u32 v9, 7168, v7
 s_waitcnt lgkmcnt(10)
 s_nop 0
 mf a[160:163],v[200:203],v[144:147],a[160:163]
 v_or_b32 v7, 0, v2
 v_lshlrev_b32 v7, 1, v7
 mf a[164:167],v[200:203],v[148:151],a[164:167]
 v_xor_b32_e64 v7, v7, v6
 mf a[168:171],v[200:203],v[152:155],a[168:171]
 v_lshl_add_u32 v7, v7, 4, v5
 v_add_u32 v10, 14336, v7
 mf a[172:175],v[200:203],v[156:159],a[172:175]
 v_or_b32 v7, 4, v2
 s_waitcnt lgkmcnt(8)
 mf a[176:179],v[204:207],v[144:147],a[176:179]
 v_lshlrev_b32 v7, 1, v7
 v_xor_b32 v7, v7, v6
 mf a[180:183],v[204:207],v[148:151],a[180:183]
 v_lshl_add_u32 v7, v7, 4, v5
 mf a[184:187],v[204:207],v[152:155],a[184:187]
 v_add_u32 v11, 21504, v7
 v_lshlrev_b32_e64 v12, 4, v1
 mf a[188:191],v[204:207],v[156:159],a[188:191]
 v_lshl_add_u32 v6, v2, 2, v3
 mf v[44:47],v[40:43],v[144:147],v[44:47]
 v_lshlrev_b32 v5, 8, v6
 v_and_b32 v7, 1, v4
 mf v[48:51],v[40:43],v[148:151],v[48:51]
 v_lshl_add_u32 v5, v7, 3, v5
 v_lshrrev_b32_e64 v7, 1, v4
 mf v[52:55],v[40:43],v[152:155],v[52:55]
 v_lshl_add_u32 v5, v7, 4, v5
 mf v[56:59],v[40:43],v[156:159],v[56:59]
 v_and_b32_e64 v6, 7, v6
 s_lshl_b32 s31, s21, 2
 s_waitcnt lgkmcnt(6)
 mf a[192:195],v[208:211],v[144:147],a[192:195]
 s_add_u32 s25, s31, 0
 s_nop 0
 mf a[196:199],v[208:211],v[148:151],a[196:199]
 v_xor_b32_e64 v7, s25, v6
 v_lshl_add_u32 v14, v7, 5, v5
 mf a[200:203],v[208:211],v[152:155],a[200:203]
 v_add_u32 v18, 98304, v14
 mf a[204:207],v[208:211],v[156:159],a[204:207]
 s_add_u32 s25, s31, 1
 v_xor_b32 v7, s25, v6
 s_waitcnt lgkmcnt(4)
 s_nop 0
 mf a[208:211],v[212:215],v[144:147],a[208:211]
 v_lshl_add_u32 v15, v7, 5, v5
 mf a[212:215],v[212:215],v[148:151],a[212:215]
 v_add_u32 v19, 98304, v15
 s_add_u32 s25, s31, 2
 s_nop 0
 mf a[216:219],v[212:215],v[152:155],a[216:219]
 v_xor_b32_e64 v7, s25, v6
 v_lshl_add_u32 v16, v7, 5, v5
 mf a[220:223],v[212:215],v[156:159],a[220:223]
 v_add_u32 v20, 98304, v16
 s_waitcnt lgkmcnt(2)
 s_nop 0
 mf a[224:227],v[216:219],v[144:147],a[224:227]
 s_add_u32 s25, s31, 3
 v_xor_b32 v7, s25, v6
 mf a[228:231],v[216:219],v[148:151],a[228:231]
 v_lshl_add_u32 v17, v7, 5, v5
 mf a[232:235],v[216:219],v[152:155],a[232:235]
 v_add_u32 v21, 98304, v17
 v_add_u32 v13, 4096, v12
 mf a[236:239],v[216:219],v[156:159],a[236:239]
 s_lshl_b32 s28, s20, 13
 s_waitcnt lgkmcnt(0)
 mf a[240:243],v[220:223],v[144:147],a[240:243]
 s_lshl_b32 s31, s22, 13
 s_nop 0
 s_add_u32 s31, s31, 16384
 mf a[244:247],v[220:223],v[148:151],a[244:247]
 v_add_u32_e64 v22, s31, v12
 mf a[248:251],v[220:223],v[152:155],a[248:251]
 v_add_u32 v23, 49152, v22
 v_add_u32 v24, 98304, v22
 mf a[252:255],v[220:223],v[156:159],a[252:255]
 s_nop 7
 s_nop 1
 s_mov_b32 s31, 0x33800000
 s_mov_b32 s3, 0x53800000
 v_cmp_nle_f32 vcc, s31, v44
 s_or_b64 s[50:51], s[50:51], vcc
 v_cmp_nge_f32 vcc, s3, v44
 s_or_b64 s[50:51], s[50:51], vcc
 v_rcp_f32 v252, v44
 v_cmp_nle_f32 vcc, s31, v48
 s_or_b64 s[50:51], s[50:51], vcc
 v_cmp_nge_f32 vcc, s3, v48
 s_or_b64 s[50:51], s[50:51], vcc
 v_rcp_f32 v253, v48
 v_cmp_nle_f32 vcc, s31, v52
 s_or_b64 s[50:51], s[50:51], vcc
 v_cmp_nge_f32 vcc, s3, v52
 s_or_b64 s[50:51], s[50:51], vcc
 v_rcp_f32 v254, v52
 v_cmp_nle_f32 vcc, s31, v56
 s_or_b64 s[50:51], s[50:51], vcc
 v_cmp_nge_f32 vcc, s3, v56
 s_or_b64 s[50:51], s[50:51], vcc
 v_rcp_f32 v255, v56
 s_add_u32 s31, s35, 4096
 ar v224,a128
 ar v228,a144
 ar v225,a129
 ar v229,a145
 ar v226,a130
 ar v230,a146
 ar v227,a131
 ar v231,a147
 v_pk_mul_f32 v[224:225], v[224:225], v[252:253] op_sel:[0,0] op_sel_hi:[1,0]
 v_pk_mul_f32 v[226:227], v[226:227], v[252:253] op_sel:[0,0] op_sel_hi:[1,0]
 v_pk_mul_f32 v[228:229], v[228:229], v[252:253] op_sel:[0,0] op_sel_hi:[1,0]
 v_pk_mul_f32 v[230:231], v[230:231], v[252:253] op_sel:[0,0] op_sel_hi:[1,0]
 v_cvt_pk_bf16_f32 v232, v224, v225
 v_cvt_pk_bf16_f32 v233, v226, v227
 v_cvt_pk_bf16_f32 v234, v228, v229
 v_cvt_pk_bf16_f32 v235, v230, v231
 buffer_store_dwordx4 v[232:235], v60, s[12:15], s31 offen offset:0 sc1
 ar v236,a132
 ar v240,a148
 ar v237,a133
 ar v241,a149
 ar v238,a134
 ar v242,a150
 ar v239,a135
 ar v243,a151
 v_pk_mul_f32 v[236:237], v[236:237], v[252:253] op_sel:[0,1] op_sel_hi:[1,1]
 v_pk_mul_f32 v[238:239], v[238:239], v[252:253] op_sel:[0,1] op_sel_hi:[1,1]
 v_pk_mul_f32 v[240:241], v[240:241], v[252:253] op_sel:[0,1] op_sel_hi:[1,1]
 v_pk_mul_f32 v[242:243], v[242:243], v[252:253] op_sel:[0,1] op_sel_hi:[1,1]
 v_cvt_pk_bf16_f32 v244, v236, v237
 v_cvt_pk_bf16_f32 v245, v238, v239
 v_cvt_pk_bf16_f32 v246, v240, v241
 v_cvt_pk_bf16_f32 v247, v242, v243
 buffer_store_dwordx4 v[244:247], v60, s[12:15], s31 offen offset:1024 sc1
 ar v224,a136
 ar v228,a152
 ar v225,a137
 ar v229,a153
 ar v226,a138
 ar v230,a154
 ar v227,a139
 ar v231,a155
 v_pk_mul_f32 v[224:225], v[224:225], v[254:255] op_sel:[0,0] op_sel_hi:[1,0]
 v_pk_mul_f32 v[226:227], v[226:227], v[254:255] op_sel:[0,0] op_sel_hi:[1,0]
 v_pk_mul_f32 v[228:229], v[228:229], v[254:255] op_sel:[0,0] op_sel_hi:[1,0]
 v_pk_mul_f32 v[230:231], v[230:231], v[254:255] op_sel:[0,0] op_sel_hi:[1,0]
 v_cvt_pk_bf16_f32 v232, v224, v225
 v_cvt_pk_bf16_f32 v233, v226, v227
 v_cvt_pk_bf16_f32 v234, v228, v229
 v_cvt_pk_bf16_f32 v235, v230, v231
 buffer_store_dwordx4 v[232:235], v60, s[12:15], s31 offen offset:2048 sc1
 ar v236,a140
 ar v240,a156
 ar v237,a141
 ar v241,a157
 ar v238,a142
 ar v242,a158
 ar v239,a143
 ar v243,a159
 v_pk_mul_f32 v[236:237], v[236:237], v[254:255] op_sel:[0,1] op_sel_hi:[1,1]
 v_pk_mul_f32 v[238:239], v[238:239], v[254:255] op_sel:[0,1] op_sel_hi:[1,1]
 v_pk_mul_f32 v[240:241], v[240:241], v[254:255] op_sel:[0,1] op_sel_hi:[1,1]
 v_pk_mul_f32 v[242:243], v[242:243], v[254:255] op_sel:[0,1] op_sel_hi:[1,1]
 v_cvt_pk_bf16_f32 v244, v236, v237
 v_cvt_pk_bf16_f32 v245, v238, v239
 v_cvt_pk_bf16_f32 v246, v240, v241
 v_cvt_pk_bf16_f32 v247, v242, v243
 buffer_store_dwordx4 v[244:247], v60, s[12:15], s31 offen offset:3072 sc1
 s_add_u32 s31, s35, 135168
 ar v224,a160
 ar v228,a176
 ar v225,a161
 ar v229,a177
 ar v226,a162
 ar v230,a178
 ar v227,a163
 ar v231,a179
 v_pk_mul_f32 v[224:225], v[224:225], v[252:253] op_sel:[0,0] op_sel_hi:[1,0]
 v_pk_mul_f32 v[226:227], v[226:227], v[252:253] op_sel:[0,0] op_sel_hi:[1,0]
 v_pk_mul_f32 v[228:229], v[228:229], v[252:253] op_sel:[0,0] op_sel_hi:[1,0]
 v_pk_mul_f32 v[230:231], v[230:231], v[252:253] op_sel:[0,0] op_sel_hi:[1,0]
 v_cvt_pk_bf16_f32 v232, v224, v225
 v_cvt_pk_bf16_f32 v233, v226, v227
 v_cvt_pk_bf16_f32 v234, v228, v229
 v_cvt_pk_bf16_f32 v235, v230, v231
 buffer_store_dwordx4 v[232:235], v60, s[12:15], s31 offen offset:0 sc1
 ar v236,a164
 ar v240,a180
 ar v237,a165
 ar v241,a181
 ar v238,a166
 ar v242,a182
 ar v239,a167
 ar v243,a183
 v_pk_mul_f32 v[236:237], v[236:237], v[252:253] op_sel:[0,1] op_sel_hi:[1,1]
 v_pk_mul_f32 v[238:239], v[238:239], v[252:253] op_sel:[0,1] op_sel_hi:[1,1]
 v_pk_mul_f32 v[240:241], v[240:241], v[252:253] op_sel:[0,1] op_sel_hi:[1,1]
 v_pk_mul_f32 v[242:243], v[242:243], v[252:253] op_sel:[0,1] op_sel_hi:[1,1]
 v_cvt_pk_bf16_f32 v244, v236, v237
 v_cvt_pk_bf16_f32 v245, v238, v239
 v_cvt_pk_bf16_f32 v246, v240, v241
 v_cvt_pk_bf16_f32 v247, v242, v243
 buffer_store_dwordx4 v[244:247], v60, s[12:15], s31 offen offset:1024 sc1
 ar v224,a168
 ar v228,a184
 ar v225,a169
 ar v229,a185
 ar v226,a170
 ar v230,a186
 ar v227,a171
 ar v231,a187
 v_pk_mul_f32 v[224:225], v[224:225], v[254:255] op_sel:[0,0] op_sel_hi:[1,0]
 v_pk_mul_f32 v[226:227], v[226:227], v[254:255] op_sel:[0,0] op_sel_hi:[1,0]
 v_pk_mul_f32 v[228:229], v[228:229], v[254:255] op_sel:[0,0] op_sel_hi:[1,0]
 v_pk_mul_f32 v[230:231], v[230:231], v[254:255] op_sel:[0,0] op_sel_hi:[1,0]
 v_cvt_pk_bf16_f32 v232, v224, v225
 v_cvt_pk_bf16_f32 v233, v226, v227
 v_cvt_pk_bf16_f32 v234, v228, v229
 v_cvt_pk_bf16_f32 v235, v230, v231
 buffer_store_dwordx4 v[232:235], v60, s[12:15], s31 offen offset:2048 sc1
 ar v236,a172
 ar v240,a188
 ar v237,a173
 ar v241,a189
 ar v238,a174
 ar v242,a190
 ar v239,a175
 ar v243,a191
 v_pk_mul_f32 v[236:237], v[236:237], v[254:255] op_sel:[0,1] op_sel_hi:[1,1]
 v_pk_mul_f32 v[238:239], v[238:239], v[254:255] op_sel:[0,1] op_sel_hi:[1,1]
 v_pk_mul_f32 v[240:241], v[240:241], v[254:255] op_sel:[0,1] op_sel_hi:[1,1]
 v_pk_mul_f32 v[242:243], v[242:243], v[254:255] op_sel:[0,1] op_sel_hi:[1,1]
 v_cvt_pk_bf16_f32 v244, v236, v237
 v_cvt_pk_bf16_f32 v245, v238, v239
 v_cvt_pk_bf16_f32 v246, v240, v241
 v_cvt_pk_bf16_f32 v247, v242, v243
 buffer_store_dwordx4 v[244:247], v60, s[12:15], s31 offen offset:3072 sc1
 s_add_u32 s31, s35, 266240
 ar v224,a192
 ar v228,a208
 ar v225,a193
 ar v229,a209
 ar v226,a194
 ar v230,a210
 ar v227,a195
 ar v231,a211
 v_pk_mul_f32 v[224:225], v[224:225], v[252:253] op_sel:[0,0] op_sel_hi:[1,0]
 v_pk_mul_f32 v[226:227], v[226:227], v[252:253] op_sel:[0,0] op_sel_hi:[1,0]
 v_pk_mul_f32 v[228:229], v[228:229], v[252:253] op_sel:[0,0] op_sel_hi:[1,0]
 v_pk_mul_f32 v[230:231], v[230:231], v[252:253] op_sel:[0,0] op_sel_hi:[1,0]
 v_cvt_pk_bf16_f32 v232, v224, v225
 v_cvt_pk_bf16_f32 v233, v226, v227
 v_cvt_pk_bf16_f32 v234, v228, v229
 v_cvt_pk_bf16_f32 v235, v230, v231
 buffer_store_dwordx4 v[232:235], v60, s[12:15], s31 offen offset:0 sc1
 ar v236,a196
 ar v240,a212
 ar v237,a197
 ar v241,a213
 ar v238,a198
 ar v242,a214
 ar v239,a199
 ar v243,a215
 v_pk_mul_f32 v[236:237], v[236:237], v[252:253] op_sel:[0,1] op_sel_hi:[1,1]
 v_pk_mul_f32 v[238:239], v[238:239], v[252:253] op_sel:[0,1] op_sel_hi:[1,1]
 v_pk_mul_f32 v[240:241], v[240:241], v[252:253] op_sel:[0,1] op_sel_hi:[1,1]
 v_pk_mul_f32 v[242:243], v[242:243], v[252:253] op_sel:[0,1] op_sel_hi:[1,1]
 v_cvt_pk_bf16_f32 v244, v236, v237
 v_cvt_pk_bf16_f32 v245, v238, v239
 v_cvt_pk_bf16_f32 v246, v240, v241
 v_cvt_pk_bf16_f32 v247, v242, v243
 buffer_store_dwordx4 v[244:247], v60, s[12:15], s31 offen offset:1024 sc1
 ar v224,a200
 ar v228,a216
 ar v225,a201
 ar v229,a217
 ar v226,a202
 ar v230,a218
 ar v227,a203
 ar v231,a219
 v_pk_mul_f32 v[224:225], v[224:225], v[254:255] op_sel:[0,0] op_sel_hi:[1,0]
 v_pk_mul_f32 v[226:227], v[226:227], v[254:255] op_sel:[0,0] op_sel_hi:[1,0]
 v_pk_mul_f32 v[228:229], v[228:229], v[254:255] op_sel:[0,0] op_sel_hi:[1,0]
 v_pk_mul_f32 v[230:231], v[230:231], v[254:255] op_sel:[0,0] op_sel_hi:[1,0]
 v_cvt_pk_bf16_f32 v232, v224, v225
 v_cvt_pk_bf16_f32 v233, v226, v227
 v_cvt_pk_bf16_f32 v234, v228, v229
 v_cvt_pk_bf16_f32 v235, v230, v231
 buffer_store_dwordx4 v[232:235], v60, s[12:15], s31 offen offset:2048 sc1
 ar v236,a204
 ar v240,a220
 ar v237,a205
 ar v241,a221
 ar v238,a206
 s_branch L_skip_9211
.p2align 12
L_stub_wa_9211:
 s_branch L_walk_ret
L_stub_wr3_9211:
 s_branch L_rw3
L_stub_wr11_9211:
 s_branch L_rw11
L_stub_wr19_9211:
 s_branch L_rw19
L_skip_9211:
 ar v242,a222
 ar v239,a207
 ar v243,a223
 v_pk_mul_f32 v[236:237], v[236:237], v[254:255] op_sel:[0,1] op_sel_hi:[1,1]
 v_pk_mul_f32 v[238:239], v[238:239], v[254:255] op_sel:[0,1] op_sel_hi:[1,1]
 v_pk_mul_f32 v[240:241], v[240:241], v[254:255] op_sel:[0,1] op_sel_hi:[1,1]
 v_pk_mul_f32 v[242:243], v[242:243], v[254:255] op_sel:[0,1] op_sel_hi:[1,1]
 v_cvt_pk_bf16_f32 v244, v236, v237
 v_cvt_pk_bf16_f32 v245, v238, v239
 v_cvt_pk_bf16_f32 v246, v240, v241
 v_cvt_pk_bf16_f32 v247, v242, v243
 buffer_store_dwordx4 v[244:247], v60, s[12:15], s31 offen offset:3072 sc1
 s_add_u32 s31, s35, 397312
 ar v224,a224
 ar v228,a240
 ar v225,a225
 ar v229,a241
 ar v226,a226
 ar v230,a242
 ar v227,a227
 ar v231,a243
 v_pk_mul_f32 v[224:225], v[224:225], v[252:253] op_sel:[0,0] op_sel_hi:[1,0]
 v_pk_mul_f32 v[226:227], v[226:227], v[252:253] op_sel:[0,0] op_sel_hi:[1,0]
 v_pk_mul_f32 v[228:229], v[228:229], v[252:253] op_sel:[0,0] op_sel_hi:[1,0]
 v_pk_mul_f32 v[230:231], v[230:231], v[252:253] op_sel:[0,0] op_sel_hi:[1,0]
 v_cvt_pk_bf16_f32 v232, v224, v225
 v_cvt_pk_bf16_f32 v233, v226, v227
 v_cvt_pk_bf16_f32 v234, v228, v229
 v_cvt_pk_bf16_f32 v235, v230, v231
 buffer_store_dwordx4 v[232:235], v60, s[12:15], s31 offen offset:0 sc1
 ar v236,a228
 ar v240,a244
 ar v237,a229
 ar v241,a245
 ar v238,a230
 ar v242,a246
 ar v239,a231
 ar v243,a247
 v_pk_mul_f32 v[236:237], v[236:237], v[252:253] op_sel:[0,1] op_sel_hi:[1,1]
 v_pk_mul_f32 v[238:239], v[238:239], v[252:253] op_sel:[0,1] op_sel_hi:[1,1]
 v_pk_mul_f32 v[240:241], v[240:241], v[252:253] op_sel:[0,1] op_sel_hi:[1,1]
 v_pk_mul_f32 v[242:243], v[242:243], v[252:253] op_sel:[0,1] op_sel_hi:[1,1]
 v_cvt_pk_bf16_f32 v244, v236, v237
 v_cvt_pk_bf16_f32 v245, v238, v239
 v_cvt_pk_bf16_f32 v246, v240, v241
 v_cvt_pk_bf16_f32 v247, v242, v243
 buffer_store_dwordx4 v[244:247], v60, s[12:15], s31 offen offset:1024 sc1
 ar v224,a232
 ar v228,a248
 ar v225,a233
 ar v229,a249
 ar v226,a234
 ar v230,a250
 ar v227,a235
 ar v231,a251
 v_pk_mul_f32 v[224:225], v[224:225], v[254:255] op_sel:[0,0] op_sel_hi:[1,0]
 v_pk_mul_f32 v[226:227], v[226:227], v[254:255] op_sel:[0,0] op_sel_hi:[1,0]
 v_pk_mul_f32 v[228:229], v[228:229], v[254:255] op_sel:[0,0] op_sel_hi:[1,0]
 v_pk_mul_f32 v[230:231], v[230:231], v[254:255] op_sel:[0,0] op_sel_hi:[1,0]
 v_cvt_pk_bf16_f32 v232, v224, v225
 v_cvt_pk_bf16_f32 v233, v226, v227
 v_cvt_pk_bf16_f32 v234, v228, v229
 v_cvt_pk_bf16_f32 v235, v230, v231
 buffer_store_dwordx4 v[232:235], v60, s[12:15], s31 offen offset:2048 sc1
 ar v236,a236
 ar v240,a252
 ar v237,a237
 ar v241,a253
 ar v238,a238
 ar v242,a254
 ar v239,a239
 ar v243,a255
 v_pk_mul_f32 v[236:237], v[236:237], v[254:255] op_sel:[0,1] op_sel_hi:[1,1]
 v_pk_mul_f32 v[238:239], v[238:239], v[254:255] op_sel:[0,1] op_sel_hi:[1,1]
 v_pk_mul_f32 v[240:241], v[240:241], v[254:255] op_sel:[0,1] op_sel_hi:[1,1]
 v_pk_mul_f32 v[242:243], v[242:243], v[254:255] op_sel:[0,1] op_sel_hi:[1,1]
 v_cvt_pk_bf16_f32 v244, v236, v237
 v_cvt_pk_bf16_f32 v245, v238, v239
 v_cvt_pk_bf16_f32 v246, v240, v241
 v_cvt_pk_bf16_f32 v247, v242, v243
 buffer_store_dwordx4 v[244:247], v60, s[12:15], s31 offen offset:3072 sc1
 s_barrier
 s_mov_b32 s4, s64
 s_mov_b32 s5, s65
 s_nop 0
 s_mov_b32 s6, 8388608
 s_add_u32 s8, s32, 4194304
 s_addc_u32 s9, s33, 0
 s_nop 0
 s_mov_b32 s10, 16777216
 s_mov_b32 s26, s81
 s_mov_b32 s27, s82
 s_add_u32 m0, s29, 0
 s_nop 0
 buffer_load_dwordx4 v8, s[4:7], s26 offen offset:0 lds
 buffer_load_dwordx4 v9, s[4:7], s26 offen offset:1024 lds
 buffer_load_dwordx4 v10, s[4:7], s26 offen offset:2048 lds
 buffer_load_dwordx4 v11, s[4:7], s26 offen offset:3072 lds
 s_add_u32 s26, s26, 131072
 s_add_u32 m0, s29, 49152
 s_nop 0
 s_nop 0
 buffer_load_dwordx4 v8, s[4:7], s26 offen offset:0 lds
 buffer_load_dwordx4 v9, s[4:7], s26 offen offset:1024 lds
 buffer_load_dwordx4 v10, s[4:7], s26 offen offset:2048 lds
 buffer_load_dwordx4 v11, s[4:7], s26 offen offset:3072 lds
 s_add_u32 s26, s26, 131072
 s_add_u32 m0, s29, 98304
 s_nop 0
 s_nop 0
 buffer_load_dwordx4 v8, s[4:7], s26 offen offset:0 lds
 buffer_load_dwordx4 v9, s[4:7], s26 offen offset:1024 lds
 buffer_load_dwordx4 v10, s[4:7], s26 offen offset:2048 lds
 buffer_load_dwordx4 v11, s[4:7], s26 offen offset:3072 lds
 s_add_u32 s26, s26, 131072
 s_cmp_lg_u64 s[50:51], 0
 s_cselect_b32 s31, 1, 0
 s_lshl_b32 s25, s20, 2
 s_nop 0
 s_add_u32 s25, s25, 147456
 v_mov_b32 v5, s25
 v_mov_b32 v6, s31
 ds_write_b32 v5, v6
 v_mov_b32 v5, 147456
 s_cmp_eq_u32 s20, 0
 s_cbranch_scc1 L_stub_w0_9574
 s_cmp_eq_u32 s20, 1
 s_cbranch_scc1 L_stub_w0_10096
 s_cmp_eq_u32 s20, 2
 s_cbranch_scc1 L_stub_w0_10426
 s_branch L_stub_w0_10948
 s_nop 0
L_walk_y_ret:
 s_lshl_b32 s40, s23, 8
 s_lshl_b32 s41, s24, 3
 s_add_u32 s40, s40, s41
 s_nop 0
 s_add_u32 s40, s40, 8192
 s_waitcnt vmcnt(12) lgkmcnt(0)
 s_barrier
 ds_read_b128 v[224:227], v5
 s_waitcnt lgkmcnt(0)
 v_or_b32 v224, v224, v225
 v_or3_b32 v224, v224, v226, v227
 s_nop 0
 v_readfirstlane_b32 s31, v224
 s_cmp_eq_u32 s31, 0
 s_cbranch_scc1 L_att_done_14
 s_getpc_b64 s[42:43]
L_far_15:
 s_nop 0
 s_add_u32 s42, s42, L_att_slow - L_far_15
 s_addc_u32 s43, s43, (L_att_slow - L_far_15) >> 32
 s_setpc_b64 s[42:43]
L_att_done_14:
 s_cmp_lg_u32 s20, 0
 s_cbranch_scc1 L_sig_16
 s_mov_b64 exec, 1
 v_mov_b32 v5, 0
 v_mov_b32 v6, s36
 v_mov_b32_e64 v7, s37
 buffer_store_dwordx2 v[6:7], v5, s[16:19], s40 offen sc1
 s_mov_b64 exec, -1
L_sig_16:
 s_and_b32 s42, s24, 3
 s_cmp_lg_u32 s20, 0
 s_cbranch_scc1 L_wt_17
 v_min_u32 v5, 3, v1
 v_cmp_eq_u32 vcc, s42, v5
 v_xor_b32 v6, 1, v5
 s_nop 0
 v_cndmask_b32 v5, v5, v6, vcc
 v_lshlrev_b32 v5, 3, v5
 s_mov_b32 s80, 0x20000
 s_branch L_poll_18
L_again_19:
 s_sub_u32 s80, s80, 1
 s_cbranch_scc1 L_wt_17
 s_sleep 2
L_poll_18:
 buffer_load_dwordx2 v[6:7], v5, s[16:19], s89 offen sc1
 s_waitcnt vmcnt(0)
 v_cmp_ne_u64 vcc, s[36:37], v[6:7]
 s_cmp_lg_u64 vcc, 0
 s_cbranch_scc1 L_again_19
L_wt_17:
 s_barrier
 s_nop 0
 s_add_u32 m0, s28, 16384
 s_nop 0
 s_nop 0
 buffer_load_dwordx4 v12, s[8:11], s27 offen offset:0 lds
 buffer_load_dwordx4 v12, s[8:11], s27 offen offset:1024 lds
 buffer_load_dwordx4 v12, s[8:11], s27 offen offset:2048 lds
 buffer_load_dwordx4 v12, s[8:11], s27 offen offset:3072 lds
 s_add_u32 m0, s28, 20480
 s_nop 0
 s_nop 0
 buffer_load_dwordx4 v13, s[8:11], s27 offen offset:0 lds
 buffer_load_dwordx4 v13, s[8:11], s27 offen offset:1024 lds
 buffer_load_dwordx4 v13, s[8:11], s27 offen offset:2048 lds
 buffer_load_dwordx4 v13, s[8:11], s27 offen offset:3072 lds
 s_add_u32 s27, s27, 262144
 s_add_u32 m0, s28, 65536
 s_nop 0
 s_nop 0
 buffer_load_dwordx4 v12, s[8:11], s27 offen offset:0 lds
 buffer_load_dwordx4 v12, s[8:11], s27 offen offset:1024 lds
 buffer_load_dwordx4 v12, s[8:11], s27 offen offset:2048 lds
 buffer_load_dwordx4 v12, s[8:11], s27 offen offset:3072 lds
 s_add_u32 m0, s28, 69632
 s_nop 0
 s_nop 0
 buffer_load_dwordx4 v13, s[8:11], s27 offen offset:0 lds
 buffer_load_dwordx4 v13, s[8:11], s27 offen offset:1024 lds
 buffer_load_dwordx4 v13, s[8:11], s27 offen offset:2048 lds
 buffer_load_dwordx4 v13, s[8:11], s27 offen offset:3072 lds
 s_add_u32 s27, s27, 262144
 s_add_u32 s12, s32, 0x2800000
 s_addc_u32 s13, s33, 0
 s_nop 0
 s_mov_b32 s14, 0x800000
 s_mov_b32 s15, 0x20000
 s_waitcnt vmcnt(8)
 s_barrier
 rd a[16:19],v22,0
 tr a[0:1],v14,0
 tr a[2:3],v14,4096
 rd a[20:23],v22,1024
 tr a[4:5],v15,0
 tr a[6:7],v15,4096
 rd a[24:27],v22,2048
 tr a[8:9],v16,0
 tr a[10:11],v16,4096
 rd a[28:31],v22,3072
 tr a[12:13],v17,0
 tr a[14:15],v17,4096
 rd a[32:35],v22,4096
 rd a[36:39],v22,5120
 rd a[40:43],v22,6144
 rd a[44:47],v22,7168
 v_min_u32 v5, 3, v1
 v_lshlrev_b32 v5, 3, v5
 s_waitcnt lgkmcnt(0)
 s_nop 0
 mf v[64:67],a[0:3],a[16:19],0
 rd a[64:67],v22,16384
 tr a[48:49],v14,8192
 mf v[96:99],a[4:7],a[16:19],0
 s_add_u32 m0, s28, 114688
 mf v[100:103],a[4:7],a[20:23],0
 buffer_load_dwordx4 v12, s[8:11], s27 offen offset:0 lds
 mf v[68:71],a[0:3],a[20:23],0
 tr a[50:51],v14,12288
 mf v[72:75],a[0:3],a[24:27],0
 rd a[68:71],v22,17408
 mf v[104:107],a[4:7],a[24:27],0
 buffer_load_dwordx4 v12, s[8:11], s27 offen offset:1024 lds
 mf v[108:111],a[4:7],a[28:31],0
 tr a[52:53],v15,8192
 tr a[54:55],v15,12288
 mf v[76:79],a[0:3],a[28:31],0
 rd a[72:75],v22,18432
 mf v[80:83],a[0:3],a[32:35],0
 tr a[56:57],v16,8192
 mf v[112:115],a[4:7],a[32:35],0
 buffer_load_dwordx4 v12, s[8:11], s27 offen offset:2048 lds
 mf v[116:119],a[4:7],a[36:39],0
 tr a[58:59],v16,12288
 mf v[84:87],a[0:3],a[36:39],0
 rd a[76:79],v22,19456
 mf v[88:91],a[0:3],a[40:43],0
 buffer_load_dwordx4 v12, s[8:11], s27 offen offset:3072 lds
 mf v[120:123],a[4:7],a[40:43],0
 tr a[60:61],v17,8192
 mf v[124:127],a[4:7],a[44:47],0
 tr a[62:63],v17,12288
 mf v[92:95],a[0:3],a[44:47],0
 rd a[80:83],v22,20480
 s_add_u32 m0, s28, 118784
 mf v[156:159],a[8:11],a[44:47],0
 buffer_load_dwordx4 v13, s[8:11], s27 offen offset:0 lds
 mf v[188:191],a[12:15],a[44:47],0
 rd a[84:87],v22,21504
 mf v[184:187],a[12:15],a[40:43],0
 rd a[88:91],v22,22528
 mf v[152:155],a[8:11],a[40:43],0
 rd a[92:95],v22,23552
 mf v[148:151],a[8:11],a[36:39],0
 buffer_load_dwordx4 v13, s[8:11], s27 offen offset:1024 lds
 mf v[180:183],a[12:15],a[36:39],0
 mf v[176:179],a[12:15],a[32:35],0
 mf v[144:147],a[8:11],a[32:35],0
 buffer_load_dwordx4 v13, s[8:11], s27 offen offset:2048 lds
 mf v[140:143],a[8:11],a[28:31],0
 mf v[172:175],a[12:15],a[28:31],0
 mf v[168:171],a[12:15],a[24:27],0
 mf v[136:139],a[8:11],a[24:27],0
 buffer_load_dwordx4 v13, s[8:11], s27 offen offset:3072 lds
 mf v[132:135],a[8:11],a[20:23],0
 s_add_u32 s27, s27, 262144
 mf v[164:167],a[12:15],a[20:23],0
 mf v[160:163],a[12:15],a[16:19],0
 s_waitcnt vmcnt(8) lgkmcnt(0)
 s_nop 0
 mf v[128:131],a[8:11],a[16:19],0
 s_barrier
 s_nop 0
 mf v[64:67],a[48:51],a[64:67],v[64:67]
 rd a[16:19],v23,0
 mf v[96:99],a[52:55],a[64:67],v[96:99]
 tr a[0:1],v14,49152
 mf v[100:103],a[52:55],a[68:71],v[100:103]
 tr a[2:3],v14,53248
 s_add_u32 m0, s29, 0
 s_nop 0
 mf v[68:71],a[48:51],a[68:71],v[68:71]
 buffer_load_dwordx4 v8, s[4:7], s26 offen offset:0 lds
 mf v[72:75],a[48:51],a[72:75],v[72:75]
 rd a[20:23],v23,1024
 mf v[104:107],a[52:55],a[72:75],v[104:107]
 tr a[4:5],v15,49152
 mf v[108:111],a[52:55],a[76:79],v[108:111]
 tr a[6:7],v15,53248
 mf v[76:79],a[48:51],a[76:79],v[76:79]
 buffer_load_dwordx4 v9, s[4:7], s26 offen offset:1024 lds
 mf v[80:83],a[48:51],a[80:83],v[80:83]
 rd a[24:27],v23,2048
 mf v[112:115],a[52:55],a[80:83],v[112:115]
 tr a[8:9],v16,49152
 mf v[116:119],a[52:55],a[84:87],v[116:119]
 tr a[10:11],v16,53248
 mf v[84:87],a[48:51],a[84:87],v[84:87]
 rd a[28:31],v23,3072
 mf v[88:91],a[48:51],a[88:91],v[88:91]
 buffer_load_dwordx4 v10, s[4:7], s26 offen offset:2048 lds
 mf v[120:123],a[52:55],a[88:91],v[120:123]
 tr a[12:13],v17,49152
 mf v[124:127],a[52:55],a[92:95],v[124:127]
 tr a[14:15],v17,53248
 mf v[92:95],a[48:51],a[92:95],v[92:95]
 rd a[32:35],v23,4096
 mf v[156:159],a[56:59],a[92:95],v[156:159]
 rd a[36:39],v23,5120
 mf v[188:191],a[60:63],a[92:95],v[188:191]
 buffer_load_dwordx4 v11, s[4:7], s26 offen offset:3072 lds
 mf v[184:187],a[60:63],a[88:91],v[184:187]
 rd a[40:43],v23,6144
 mf v[152:155],a[56:59],a[88:91],v[152:155]
 rd a[44:47],v23,7168
 mf v[148:151],a[56:59],a[84:87],v[148:151]
 s_add_u32 s26, s26, 131072
 mf v[180:183],a[60:63],a[84:87],v[180:183]
 s_add_u32 m0, s28, 16384
 mf v[176:179],a[60:63],a[80:83],v[176:179]
 buffer_load_dwordx4 v12, s[8:11], s27 offen offset:0 lds
 mf v[144:147],a[56:59],a[80:83],v[144:147]
 mf v[140:143],a[56:59],a[76:79],v[140:143]
 mf v[172:175],a[60:63],a[76:79],v[172:175]
 mf v[168:171],a[60:63],a[72:75],v[168:171]
 mf v[136:139],a[56:59],a[72:75],v[136:139]
 buffer_load_dwordx4 v12, s[8:11], s27 offen offset:1024 lds
 mf v[132:135],a[56:59],a[68:71],v[132:135]
 mf v[164:167],a[60:63],a[68:71],v[164:167]
 mf v[160:163],a[60:63],a[64:67],v[160:163]
 s_waitcnt lgkmcnt(0)
 s_nop 0
 mf v[128:131],a[56:59],a[64:67],v[128:131]
 s_sub_u32 s30, 2, s98
 s_branch L_skip_9574
.p2align 12
L_stub_w0_9574:
 s_branch L_walk_y_ret
 s_nop 0
 s_nop 0
 s_nop 0
L_skip_9574:
.p2align 6
L_fy_loop_20:
 mf v[64:67],a[0:3],a[16:19],v[64:67]
 rd a[64:67],v23,16384
 mf v[96:99],a[4:7],a[16:19],v[96:99]
 tr a[48:49],v14,57344
 mf v[100:103],a[4:7],a[20:23],v[100:103]
 tr a[50:51],v14,61440
 mf v[68:71],a[0:3],a[20:23],v[68:71]
 buffer_load_dwordx4 v12, s[8:11], s27 offen offset:2048 lds
 mf v[72:75],a[0:3],a[24:27],v[72:75]
 rd a[68:71],v23,17408
 mf v[104:107],a[4:7],a[24:27],v[104:107]
 tr a[52:53],v15,57344
 mf v[108:111],a[4:7],a[28:31],v[108:111]
 tr a[54:55],v15,61440
 mf v[76:79],a[0:3],a[28:31],v[76:79]
 buffer_load_dwordx4 v12, s[8:11], s27 offen offset:3072 lds
 mf v[80:83],a[0:3],a[32:35],v[80:83]
 rd a[72:75],v23,18432
 mf v[112:115],a[4:7],a[32:35],v[112:115]
 tr a[56:57],v16,57344
 mf v[116:119],a[4:7],a[36:39],v[116:119]
 tr a[58:59],v16,61440
 mf v[84:87],a[0:3],a[36:39],v[84:87]
 rd a[76:79],v23,19456
 s_add_u32 m0, s28, 20480
 mf v[88:91],a[0:3],a[40:43],v[88:91]
 buffer_load_dwordx4 v13, s[8:11], s27 offen offset:0 lds
 mf v[120:123],a[4:7],a[40:43],v[120:123]
 tr a[60:61],v17,57344
 mf v[124:127],a[4:7],a[44:47],v[124:127]
 tr a[62:63],v17,61440
 mf v[92:95],a[0:3],a[44:47],v[92:95]
 rd a[80:83],v23,20480
 mf v[156:159],a[8:11],a[44:47],v[156:159]
 rd a[84:87],v23,21504
 mf v[188:191],a[12:15],a[44:47],v[188:191]
 buffer_load_dwordx4 v13, s[8:11], s27 offen offset:1024 lds
 mf v[184:187],a[12:15],a[40:43],v[184:187]
 rd a[88:91],v23,22528
 mf v[152:155],a[8:11],a[40:43],v[152:155]
 rd a[92:95],v23,23552
 mf v[148:151],a[8:11],a[36:39],v[148:151]
 mf v[180:183],a[12:15],a[36:39],v[180:183]
 mf v[176:179],a[12:15],a[32:35],v[176:179]
 buffer_load_dwordx4 v13, s[8:11], s27 offen offset:2048 lds
 mf v[144:147],a[8:11],a[32:35],v[144:147]
 mf v[140:143],a[8:11],a[28:31],v[140:143]
 mf v[172:175],a[12:15],a[28:31],v[172:175]
 mf v[168:171],a[12:15],a[24:27],v[168:171]
 mf v[136:139],a[8:11],a[24:27],v[136:139]
 buffer_load_dwordx4 v13, s[8:11], s27 offen offset:3072 lds
 mf v[132:135],a[8:11],a[20:23],v[132:135]
 s_add_u32 s27, s27, 262144
 mf v[164:167],a[12:15],a[20:23],v[164:167]
 mf v[160:163],a[12:15],a[16:19],v[160:163]
 s_waitcnt vmcnt(12) lgkmcnt(0)
 s_nop 0
 mf v[128:131],a[8:11],a[16:19],v[128:131]
 s_barrier
 s_nop 0
 mf v[64:67],a[48:51],a[64:67],v[64:67]
 rd a[16:19],v24,0
 mf v[96:99],a[52:55],a[64:67],v[96:99]
 tr a[0:1],v18,0
 mf v[100:103],a[52:55],a[68:71],v[100:103]
 tr a[2:3],v18,4096
 s_add_u32 m0, s29, 49152
 mf v[68:71],a[48:51],a[68:71],v[68:71]
 buffer_load_dwordx4 v8, s[4:7], s26 offen offset:0 lds
 mf v[72:75],a[48:51],a[72:75],v[72:75]
 rd a[20:23],v24,1024
 mf v[104:107],a[52:55],a[72:75],v[104:107]
 tr a[4:5],v19,0
 mf v[108:111],a[52:55],a[76:79],v[108:111]
 tr a[6:7],v19,4096
 mf v[76:79],a[48:51],a[76:79],v[76:79]
 buffer_load_dwordx4 v9, s[4:7], s26 offen offset:1024 lds
 mf v[80:83],a[48:51],a[80:83],v[80:83]
 rd a[24:27],v24,2048
 mf v[112:115],a[52:55],a[80:83],v[112:115]
 tr a[8:9],v20,0
 mf v[116:119],a[52:55],a[84:87],v[116:119]
 tr a[10:11],v20,4096
 mf v[84:87],a[48:51],a[84:87],v[84:87]
 rd a[28:31],v24,3072
 mf v[88:91],a[48:51],a[88:91],v[88:91]
 buffer_load_dwordx4 v10, s[4:7], s26 offen offset:2048 lds
 mf v[120:123],a[52:55],a[88:91],v[120:123]
 tr a[12:13],v21,0
 mf v[124:127],a[52:55],a[92:95],v[124:127]
 tr a[14:15],v21,4096
 mf v[92:95],a[48:51],a[92:95],v[92:95]
 rd a[32:35],v24,4096
 mf v[156:159],a[56:59],a[92:95],v[156:159]
 rd a[36:39],v24,5120
 mf v[188:191],a[60:63],a[92:95],v[188:191]
 buffer_load_dwordx4 v11, s[4:7], s26 offen offset:3072 lds
 mf v[184:187],a[60:63],a[88:91],v[184:187]
 rd a[40:43],v24,6144
 mf v[152:155],a[56:59],a[88:91],v[152:155]
 rd a[44:47],v24,7168
 mf v[148:151],a[56:59],a[84:87],v[148:151]
 s_add_u32 s26, s26, 131072
 mf v[180:183],a[60:63],a[84:87],v[180:183]
 s_add_u32 m0, s28, 65536
 mf v[176:179],a[60:63],a[80:83],v[176:179]
 buffer_load_dwordx4 v12, s[8:11], s27 offen offset:0 lds
 mf v[144:147],a[56:59],a[80:83],v[144:147]
 mf v[140:143],a[56:59],a[76:79],v[140:143]
 mf v[172:175],a[60:63],a[76:79],v[172:175]
 mf v[168:171],a[60:63],a[72:75],v[168:171]
 mf v[136:139],a[56:59],a[72:75],v[136:139]
 buffer_load_dwordx4 v12, s[8:11], s27 offen offset:1024 lds
 mf v[132:135],a[56:59],a[68:71],v[132:135]
 mf v[164:167],a[60:63],a[68:71],v[164:167]
 mf v[160:163],a[60:63],a[64:67],v[160:163]
 s_waitcnt lgkmcnt(0)
 s_nop 0
 mf v[128:131],a[56:59],a[64:67],v[128:131]
 mf v[64:67],a[0:3],a[16:19],v[64:67]
 rd a[64:67],v24,16384
 mf v[96:99],a[4:7],a[16:19],v[96:99]
 tr a[48:49],v18,8192
 mf v[100:103],a[4:7],a[20:23],v[100:103]
 tr a[50:51],v18,12288
 mf v[68:71],a[0:3],a[20:23],v[68:71]
 buffer_load_dwordx4 v12, s[8:11], s27 offen offset:2048 lds
 mf v[72:75],a[0:3],a[24:27],v[72:75]
 rd a[68:71],v24,17408
 mf v[104:107],a[4:7],a[24:27],v[104:107]
 tr a[52:53],v19,8192
 mf v[108:111],a[4:7],a[28:31],v[108:111]
 tr a[54:55],v19,12288
 mf v[76:79],a[0:3],a[28:31],v[76:79]
 buffer_load_dwordx4 v12, s[8:11], s27 offen offset:3072 lds
 mf v[80:83],a[0:3],a[32:35],v[80:83]
 rd a[72:75],v24,18432
 mf v[112:115],a[4:7],a[32:35],v[112:115]
 tr a[56:57],v20,8192
 mf v[116:119],a[4:7],a[36:39],v[116:119]
 tr a[58:59],v20,12288
 mf v[84:87],a[0:3],a[36:39],v[84:87]
 rd a[76:79],v24,19456
 s_add_u32 m0, s28, 69632
 mf v[88:91],a[0:3],a[40:43],v[88:91]
 buffer_load_dwordx4 v13, s[8:11], s27 offen offset:0 lds
 mf v[120:123],a[4:7],a[40:43],v[120:123]
 tr a[60:61],v21,8192
 mf v[124:127],a[4:7],a[44:47],v[124:127]
 tr a[62:63],v21,12288
 mf v[92:95],a[0:3],a[44:47],v[92:95]
 rd a[80:83],v24,20480
 mf v[156:159],a[8:11],a[44:47],v[156:159]
 rd a[84:87],v24,21504
 mf v[188:191],a[12:15],a[44:47],v[188:191]
 buffer_load_dwordx4 v13, s[8:11], s27 offen offset:1024 lds
 mf v[184:187],a[12:15],a[40:43],v[184:187]
 rd a[88:91],v24,22528
 mf v[152:155],a[8:11],a[40:43],v[152:155]
 rd a[92:95],v24,23552
 mf v[148:151],a[8:11],a[36:39],v[148:151]
 mf v[180:183],a[12:15],a[36:39],v[180:183]
 mf v[176:179],a[12:15],a[32:35],v[176:179]
 buffer_load_dwordx4 v13, s[8:11], s27 offen offset:2048 lds
 mf v[144:147],a[8:11],a[32:35],v[144:147]
 mf v[140:143],a[8:11],a[28:31],v[140:143]
 mf v[172:175],a[12:15],a[28:31],v[172:175]
 mf v[168:171],a[12:15],a[24:27],v[168:171]
 mf v[136:139],a[8:11],a[24:27],v[136:139]
 buffer_load_dwordx4 v13, s[8:11], s27 offen offset:3072 lds
 mf v[132:135],a[8:11],a[20:23],v[132:135]
 s_add_u32 s27, s27, 262144
 mf v[164:167],a[12:15],a[20:23],v[164:167]
 mf v[160:163],a[12:15],a[16:19],v[160:163]
 s_waitcnt vmcnt(12) lgkmcnt(0)
 s_nop 0
 mf v[128:131],a[8:11],a[16:19],v[128:131]
 s_barrier
 s_nop 0
 mf v[64:67],a[48:51],a[64:67],v[64:67]
 rd a[16:19],v22,0
 mf v[96:99],a[52:55],a[64:67],v[96:99]
 tr a[0:1],v14,0
 mf v[100:103],a[52:55],a[68:71],v[100:103]
 tr a[2:3],v14,4096
 s_add_u32 m0, s29, 98304
 mf v[68:71],a[48:51],a[68:71],v[68:71]
 buffer_load_dwordx4 v8, s[4:7], s26 offen offset:0 lds
 mf v[72:75],a[48:51],a[72:75],v[72:75]
 rd a[20:23],v22,1024
 mf v[104:107],a[52:55],a[72:75],v[104:107]
 tr a[4:5],v15,0
 mf v[108:111],a[52:55],a[76:79],v[108:111]
 tr a[6:7],v15,4096
 mf v[76:79],a[48:51],a[76:79],v[76:79]
 buffer_load_dwordx4 v9, s[4:7], s26 offen offset:1024 lds
 mf v[80:83],a[48:51],a[80:83],v[80:83]
 rd a[24:27],v22,2048
 mf v[112:115],a[52:55],a[80:83],v[112:115]
 tr a[8:9],v16,0
 mf v[116:119],a[52:55],a[84:87],v[116:119]
 tr a[10:11],v16,4096
 mf v[84:87],a[48:51],a[84:87],v[84:87]
 rd a[28:31],v22,3072
 mf v[88:91],a[48:51],a[88:91],v[88:91]
 buffer_load_dwordx4 v10, s[4:7], s26 offen offset:2048 lds
 mf v[120:123],a[52:55],a[88:91],v[120:123]
 tr a[12:13],v17,0
 mf v[124:127],a[52:55],a[92:95],v[124:127]
 tr a[14:15],v17,4096
 mf v[92:95],a[48:51],a[92:95],v[92:95]
 rd a[32:35],v22,4096
 mf v[156:159],a[56:59],a[92:95],v[156:159]
 rd a[36:39],v22,5120
 mf v[188:191],a[60:63],a[92:95],v[188:191]
 buffer_load_dwordx4 v11, s[4:7], s26 offen offset:3072 lds
 mf v[184:187],a[60:63],a[88:91],v[184:187]
 rd a[40:43],v22,6144
 mf v[152:155],a[56:59],a[88:91],v[152:155]
 rd a[44:47],v22,7168
 mf v[148:151],a[56:59],a[84:87],v[148:151]
 s_add_u32 s26, s26, 131072
 mf v[180:183],a[60:63],a[84:87],v[180:183]
 s_add_u32 m0, s28, 114688
 mf v[176:179],a[60:63],a[80:83],v[176:179]
 buffer_load_dwordx4 v12, s[8:11], s27 offen offset:0 lds
 mf v[144:147],a[56:59],a[80:83],v[144:147]
 mf v[140:143],a[56:59],a[76:79],v[140:143]
 mf v[172:175],a[60:63],a[76:79],v[172:175]
 mf v[168:171],a[60:63],a[72:75],v[168:171]
 mf v[136:139],a[56:59],a[72:75],v[136:139]
 buffer_load_dwordx4 v12, s[8:11], s27 offen offset:1024 lds
 mf v[132:135],a[56:59],a[68:71],v[132:135]
 mf v[164:167],a[60:63],a[68:71],v[164:167]
 mf v[160:163],a[60:63],a[64:67],v[160:163]
 s_waitcnt lgkmcnt(0)
 s_nop 0
 mf v[128:131],a[56:59],a[64:67],v[128:131]
 mf v[64:67],a[0:3],a[16:19],v[64:67]
 rd a[64:67],v22,16384
 mf v[96:99],a[4:7],a[16:19],v[96:99]
 tr a[48:49],v14,8192
 mf v[100:103],a[4:7],a[20:23],v[100:103]
 tr a[50:51],v14,12288
 mf v[68:71],a[0:3],a[20:23],v[68:71]
 buffer_load_dwordx4 v12, s[8:11], s27 offen offset:2048 lds
 mf v[72:75],a[0:3],a[24:27],v[72:75]
 rd a[68:71],v22,17408
 mf v[104:107],a[4:7],a[24:27],v[104:107]
 tr a[52:53],v15,8192
 mf v[108:111],a[4:7],a[28:31],v[108:111]
 tr a[54:55],v15,12288
 mf v[76:79],a[0:3],a[28:31],v[76:79]
 buffer_load_dwordx4 v12, s[8:11], s27 offen offset:3072 lds
 mf v[80:83],a[0:3],a[32:35],v[80:83]
 rd a[72:75],v22,18432
 mf v[112:115],a[4:7],a[32:35],v[112:115]
 tr a[56:57],v16,8192
 mf v[116:119],a[4:7],a[36:39],v[116:119]
 tr a[58:59],v16,12288
 mf v[84:87],a[0:3],a[36:39],v[84:87]
 rd a[76:79],v22,19456
 s_add_u32 m0, s28, 118784
 mf v[88:91],a[0:3],a[40:43],v[88:91]
 buffer_load_dwordx4 v13, s[8:11], s27 offen offset:0 lds
 mf v[120:123],a[4:7],a[40:43],v[120:123]
 tr a[60:61],v17,8192
 mf v[124:127],a[4:7],a[44:47],v[124:127]
 tr a[62:63],v17,12288
 mf v[92:95],a[0:3],a[44:47],v[92:95]
 rd a[80:83],v22,20480
 mf v[156:159],a[8:11],a[44:47],v[156:159]
 rd a[84:87],v22,21504
 mf v[188:191],a[12:15],a[44:47],v[188:191]
 buffer_load_dwordx4 v13, s[8:11], s27 offen offset:1024 lds
 mf v[184:187],a[12:15],a[40:43],v[184:187]
 rd a[88:91],v22,22528
 mf v[152:155],a[8:11],a[40:43],v[152:155]
 rd a[92:95],v22,23552
 mf v[148:151],a[8:11],a[36:39],v[148:151]
 mf v[180:183],a[12:15],a[36:39],v[180:183]
 mf v[176:179],a[12:15],a[32:35],v[176:179]
 buffer_load_dwordx4 v13, s[8:11], s27 offen offset:2048 lds
 mf v[144:147],a[8:11],a[32:35],v[144:147]
 mf v[140:143],a[8:11],a[28:31],v[140:143]
 mf v[172:175],a[12:15],a[28:31],v[172:175]
 mf v[168:171],a[12:15],a[24:27],v[168:171]
 mf v[136:139],a[8:11],a[24:27],v[136:139]
 buffer_load_dwordx4 v13, s[8:11], s27 offen offset:3072 lds
 mf v[132:135],a[8:11],a[20:23],v[132:135]
 s_add_u32 s27, s27, 262144
 mf v[164:167],a[12:15],a[20:23],v[164:167]
 mf v[160:163],a[12:15],a[16:19],v[160:163]
 s_waitcnt vmcnt(12) lgkmcnt(0)
 s_nop 0
 mf v[128:131],a[8:11],a[16:19],v[128:131]
 s_barrier
 s_nop 0
 mf v[64:67],a[48:51],a[64:67],v[64:67]
 rd a[16:19],v23,0
 mf v[96:99],a[52:55],a[64:67],v[96:99]
 tr a[0:1],v14,49152
 mf v[100:103],a[52:55],a[68:71],v[100:103]
 tr a[2:3],v14,53248
 s_add_u32 m0, s29, 0
 s_nop 0
 mf v[68:71],a[48:51],a[68:71],v[68:71]
 buffer_load_dwordx4 v8, s[4:7], s26 offen offset:0 lds
 mf v[72:75],a[48:51],a[72:75],v[72:75]
 rd a[20:23],v23,1024
 mf v[104:107],a[52:55],a[72:75],v[104:107]
 tr a[4:5],v15,49152
 mf v[108:111],a[52:55],a[76:79],v[108:111]
 tr a[6:7],v15,53248
 mf v[76:79],a[48:51],a[76:79],v[76:79]
 buffer_load_dwordx4 v9, s[4:7], s26 offen offset:1024 lds
 mf v[80:83],a[48:51],a[80:83],v[80:83]
 rd a[24:27],v23,2048
 mf v[112:115],a[52:55],a[80:83],v[112:115]
 tr a[8:9],v16,49152
 mf v[116:119],a[52:55],a[84:87],v[116:119]
 tr a[10:11],v16,53248
 mf v[84:87],a[48:51],a[84:87],v[84:87]
 rd a[28:31],v23,3072
 mf v[88:91],a[48:51],a[88:91],v[88:91]
 buffer_load_dwordx4 v10, s[4:7], s26 offen offset:2048 lds
 mf v[120:123],a[52:55],a[88:91],v[120:123]
 tr a[12:13],v17,49152
 mf v[124:127],a[52:55],a[92:95],v[124:127]
 tr a[14:15],v17,53248
 mf v[92:95],a[48:51],a[92:95],v[92:95]
 rd a[32:35],v23,4096
 mf v[156:159],a[56:59],a[92:95],v[156:159]
 rd a[36:39],v23,5120
 mf v[188:191],a[60:63],a[92:95],v[188:191]
 buffer_load_dwordx4 v11, s[4:7], s26 offen offset:3072 lds
 mf v[184:187],a[60:63],a[88:91],v[184:187]
 rd a[40:43],v23,6144
 mf v[152:155],a[56:59],a[88:91],v[152:155]
 rd a[44:47],v23,7168
 mf v[148:151],a[56:59],a[84:87],v[148:151]
 s_add_u32 s26, s26, 131072
 mf v[180:183],a[60:63],a[84:87],v[180:183]
 s_add_u32 m0, s28, 16384
 mf v[176:179],a[60:63],a[80:83],v[176:179]
 buffer_load_dwordx4 v12, s[8:11], s27 offen offset:0 lds
 mf v[144:147],a[56:59],a[80:83],v[144:147]
 mf v[140:143],a[56:59],a[76:79],v[140:143]
 mf v[172:175],a[60:63],a[76:79],v[172:175]
 mf v[168:171],a[60:63],a[72:75],v[168:171]
 mf v[136:139],a[56:59],a[72:75],v[136:139]
 buffer_load_dwordx4 v12, s[8:11], s27 offen offset:1024 lds
 mf v[132:135],a[56:59],a[68:71],v[132:135]
 mf v[164:167],a[60:63],a[68:71],v[164:167]
 mf v[160:163],a[60:63],a[64:67],v[160:163]
 s_sub_u32 s30, s30, 1
 s_waitcnt lgkmcnt(0)
 s_cmp_lg_u32 s30, 0
 s_nop 0
 mf v[128:131],a[56:59],a[64:67],v[128:131]
 s_cbranch_scc1 L_fy_loop_20
 s_nop 0
 mf v[64:67],a[0:3],a[16:19],v[64:67]
 rd a[64:67],v23,16384
 mf v[96:99],a[4:7],a[16:19],v[96:99]
 tr a[48:49],v14,57344
 mf v[100:103],a[4:7],a[20:23],v[100:103]
 tr a[50:51],v14,61440
 mf v[68:71],a[0:3],a[20:23],v[68:71]
 buffer_load_dwordx4 v12, s[8:11], s27 offen offset:2048 lds
 mf v[72:75],a[0:3],a[24:27],v[72:75]
 rd a[68:71],v23,17408
 mf v[104:107],a[4:7],a[24:27],v[104:107]
 tr a[52:53],v15,57344
 mf v[108:111],a[4:7],a[28:31],v[108:111]
 tr a[54:55],v15,61440
 mf v[76:79],a[0:3],a[28:31],v[76:79]
 buffer_load_dwordx4 v12, s[8:11], s27 offen offset:3072 lds
 mf v[80:83],a[0:3],a[32:35],v[80:83]
 rd a[72:75],v23,18432
 mf v[112:115],a[4:7],a[32:35],v[112:115]
 tr a[56:57],v16,57344
 mf v[116:119],a[4:7],a[36:39],v[116:119]
 tr a[58:59],v16,61440
 mf v[84:87],a[0:3],a[36:39],v[84:87]
 rd a[76:79],v23,19456
 s_add_u32 m0, s28, 20480
 mf v[88:91],a[0:3],a[40:43],v[88:91]
 buffer_load_dwordx4 v13, s[8:11], s27 offen offset:0 lds
 mf v[120:123],a[4:7],a[40:43],v[120:123]
 tr a[60:61],v17,57344
 mf v[124:127],a[4:7],a[44:47],v[124:127]
 tr a[62:63],v17,61440
 mf v[92:95],a[0:3],a[44:47],v[92:95]
 rd a[80:83],v23,20480
 mf v[156:159],a[8:11],a[44:47],v[156:159]
 rd a[84:87],v23,21504
 mf v[188:191],a[12:15],a[44:47],v[188:191]
 buffer_load_dwordx4 v13, s[8:11], s27 offen offset:1024 lds
 mf v[184:187],a[12:15],a[40:43],v[184:187]
 rd a[88:91],v23,22528
 mf v[152:155],a[8:11],a[40:43],v[152:155]
 rd a[92:95],v23,23552
 mf v[148:151],a[8:11],a[36:39],v[148:151]
 mf v[180:183],a[12:15],a[36:39],v[180:183]
 mf v[176:179],a[12:15],a[32:35],v[176:179]
 buffer_load_dwordx4 v13, s[8:11], s27 offen offset:2048 lds
 mf v[144:147],a[8:11],a[32:35],v[144:147]
 mf v[140:143],a[8:11],a[28:31],v[140:143]
 mf v[172:175],a[12:15],a[28:31],v[172:175]
 mf v[168:171],a[12:15],a[24:27],v[168:171]
 mf v[136:139],a[8:11],a[24:27],v[136:139]
 buffer_load_dwordx4 v13, s[8:11], s27 offen offset:3072 lds
 mf v[132:135],a[8:11],a[20:23],v[132:135]
 s_add_u32 s27, s27, 262144
 mf v[164:167],a[12:15],a[20:23],v[164:167]
 mf v[160:163],a[12:15],a[16:19],v[160:163]
 s_waitcnt vmcnt(12) lgkmcnt(0)
 s_nop 0
 mf v[128:131],a[8:11],a[16:19],v[128:131]
 s_barrier
 s_nop 0
 mf v[64:67],a[48:51],a[64:67],v[64:67]
 rd a[16:19],v24,0
 mf v[96:99],a[52:55],a[64:67],v[96:99]
 tr a[0:1],v18,0
 mf v[100:103],a[52:55],a[68:71],v[100:103]
 tr a[2:3],v18,4096
 s_add_u32 m0, s29, 49152
 mf v[68:71],a[48:51],a[68:71],v[68:71]
 buffer_load_dwordx4 v8, s[4:7], s26 offen offset:0 lds
 mf v[72:75],a[48:51],a[72:75],v[72:75]
 rd a[20:23],v24,1024
 mf v[104:107],a[52:55],a[72:75],v[104:107]
 tr a[4:5],v19,0
 mf v[108:111],a[52:55],a[76:79],v[108:111]
 tr a[6:7],v19,4096
 mf v[76:79],a[48:51],a[76:79],v[76:79]
 buffer_load_dwordx4 v9, s[4:7], s26 offen offset:1024 lds
 mf v[80:83],a[48:51],a[80:83],v[80:83]
 rd a[24:27],v24,2048
 mf v[112:115],a[52:55],a[80:83],v[112:115]
 tr a[8:9],v20,0
 mf v[116:119],a[52:55],a[84:87],v[116:119]
 tr a[10:11],v20,4096
 mf v[84:87],a[48:51],a[84:87],v[84:87]
 rd a[28:31],v24,3072
 mf v[88:91],a[48:51],a[88:91],v[88:91]
 buffer_load_dwordx4 v10, s[4:7], s26 offen offset:2048 lds
 mf v[120:123],a[52:55],a[88:91],v[120:123]
 tr a[12:13],v21,0
 mf v[124:127],a[52:55],a[92:95],v[124:127]
 tr a[14:15],v21,4096
 mf v[92:95],a[48:51],a[92:95],v[92:95]
 rd a[32:35],v24,4096
 mf v[156:159],a[56:59],a[92:95],v[156:159]
 rd a[36:39],v24,5120
 mf v[188:191],a[60:63],a[92:95],v[188:191]
 buffer_load_dwordx4 v11, s[4:7], s26 offen offset:3072 lds
 mf v[184:187],a[60:63],a[88:91],v[184:187]
 rd a[40:43],v24,6144
 mf v[152:155],a[56:59],a[88:91],v[152:155]
 rd a[44:47],v24,7168
 mf v[148:151],a[56:59],a[84:87],v[148:151]
 s_add_u32 s26, s26, 131072
 mf v[180:183],a[60:63],a[84:87],v[180:183]
 s_add_u32 m0, s28, 65536
 mf v[176:179],a[60:63],a[80:83],v[176:179]
 buffer_load_dwordx4 v12, s[8:11], s27 offen offset:0 lds
 mf v[144:147],a[56:59],a[80:83],v[144:147]
 mf v[140:143],a[56:59],a[76:79],v[140:143]
 mf v[172:175],a[60:63],a[76:79],v[172:175]
 mf v[168:171],a[60:63],a[72:75],v[168:171]
 mf v[136:139],a[56:59],a[72:75],v[136:139]
 buffer_load_dwordx4 v12, s[8:11], s27 offen offset:1024 lds
 mf v[132:135],a[56:59],a[68:71],v[132:135]
 mf v[164:167],a[60:63],a[68:71],v[164:167]
 mf v[160:163],a[60:63],a[64:67],v[160:163]
 s_waitcnt lgkmcnt(0)
 s_nop 0
 mf v[128:131],a[56:59],a[64:67],v[128:131]
 mf v[64:67],a[0:3],a[16:19],v[64:67]
 rd a[64:67],v24,16384
 mf v[96:99],a[4:7],a[16:19],v[96:99]
 tr a[48:49],v18,8192
 mf v[100:103],a[4:7],a[20:23],v[100:103]
 tr a[50:51],v18,12288
 mf v[68:71],a[0:3],a[20:23],v[68:71]
 buffer_load_dwordx2 v[6:7], v5, s[16:19], s88 offen sc1
 mf v[72:75],a[0:3],a[24:27],v[72:75]
 rd a[68:71],v24,17408
 mf v[104:107],a[4:7],a[24:27],v[104:107]
 tr a[52:53],v19,8192
 mf v[108:111],a[4:7],a[28:31],v[108:111]
 tr a[54:55],v19,12288
 mf v[76:79],a[0:3],a[28:31],v[76:79]
 buffer_load_dwordx4 v12, s[8:11], s27 offen offset:2048 lds
 mf v[80:83],a[0:3],a[32:35],v[80:83]
 rd a[72:75],v24,18432
 mf v[112:115],a[4:7],a[32:35],v[112:115]
 tr a[56:57],v20,8192
 mf v[116:119],a[4:7],a[36:39],v[116:119]
 tr a[58:59],v20,12288
 mf v[84:87],a[0:3],a[36:39],v[84:87]
 buffer_load_dwordx4 v12, s[8:11], s27 offen offset:3072 lds
 mf v[88:91],a[0:3],a[40:43],v[88:91]
 rd a[76:79],v24,19456
 mf v[120:123],a[4:7],a[40:43],v[120:123]
 tr a[60:61],v21,8192
 mf v[124:127],a[4:7],a[44:47],v[124:127]
 tr a[62:63],v21,12288
 s_add_u32 m0, s28, 69632
 mf v[92:95],a[0:3],a[44:47],v[92:95]
 buffer_load_dwordx4 v13, s[8:11], s27 offen offset:0 lds
 mf v[156:159],a[8:11],a[44:47],v[156:159]
 rd a[80:83],v24,20480
 mf v[188:191],a[12:15],a[44:47],v[188:191]
 rd a[84:87],v24,21504
 s_branch L_skip_10096
.p2align 12
L_stub_w0_10096:
 s_branch L_walk_y_ret
 s_nop 0
 s_nop 0
 s_nop 0
L_skip_10096:
 mf v[184:187],a[12:15],a[40:43],v[184:187]
 rd a[88:91],v24,22528
 mf v[152:155],a[8:11],a[40:43],v[152:155]
 buffer_load_dwordx4 v13, s[8:11], s27 offen offset:1024 lds
 mf v[148:151],a[8:11],a[36:39],v[148:151]
 rd a[92:95],v24,23552
 mf v[180:183],a[12:15],a[36:39],v[180:183]
 mf v[176:179],a[12:15],a[32:35],v[176:179]
 mf v[144:147],a[8:11],a[32:35],v[144:147]
 buffer_load_dwordx4 v13, s[8:11], s27 offen offset:2048 lds
 mf v[140:143],a[8:11],a[28:31],v[140:143]
 mf v[172:175],a[12:15],a[28:31],v[172:175]
 mf v[168:171],a[12:15],a[24:27],v[168:171]
 mf v[136:139],a[8:11],a[24:27],v[136:139]
 buffer_load_dwordx4 v13, s[8:11], s27 offen offset:3072 lds
 mf v[132:135],a[8:11],a[20:23],v[132:135]
 s_add_u32 s27, s27, 262144
 mf v[164:167],a[12:15],a[20:23],v[164:167]
 mf v[160:163],a[12:15],a[16:19],v[160:163]
 s_waitcnt vmcnt(13) lgkmcnt(0)
 s_nop 0
 mf v[128:131],a[8:11],a[16:19],v[128:131]
 s_barrier
 s_nop 0
 mf v[64:67],a[48:51],a[64:67],v[64:67]
 rd a[16:19],v22,0
 mf v[96:99],a[52:55],a[64:67],v[96:99]
 tr a[0:1],v14,0
 mf v[100:103],a[52:55],a[68:71],v[100:103]
 tr a[2:3],v14,4096
 s_add_u32 m0, s29, 98304
 mf v[68:71],a[48:51],a[68:71],v[68:71]
 buffer_load_dwordx4 v8, s[4:7], s26 offen offset:0 lds
 mf v[72:75],a[48:51],a[72:75],v[72:75]
 rd a[20:23],v22,1024
 mf v[104:107],a[52:55],a[72:75],v[104:107]
 tr a[4:5],v15,0
 mf v[108:111],a[52:55],a[76:79],v[108:111]
 tr a[6:7],v15,4096
 mf v[76:79],a[48:51],a[76:79],v[76:79]
 buffer_load_dwordx4 v9, s[4:7], s26 offen offset:1024 lds
 mf v[80:83],a[48:51],a[80:83],v[80:83]
 rd a[24:27],v22,2048
 mf v[112:115],a[52:55],a[80:83],v[112:115]
 tr a[8:9],v16,0
 mf v[116:119],a[52:55],a[84:87],v[116:119]
 tr a[10:11],v16,4096
 mf v[84:87],a[48:51],a[84:87],v[84:87]
 rd a[28:31],v22,3072
 mf v[88:91],a[48:51],a[88:91],v[88:91]
 buffer_load_dwordx4 v10, s[4:7], s26 offen offset:2048 lds
 mf v[120:123],a[52:55],a[88:91],v[120:123]
 tr a[12:13],v17,0
 mf v[124:127],a[52:55],a[92:95],v[124:127]
 tr a[14:15],v17,4096
 mf v[92:95],a[48:51],a[92:95],v[92:95]
 rd a[32:35],v22,4096
 mf v[156:159],a[56:59],a[92:95],v[156:159]
 rd a[36:39],v22,5120
 mf v[188:191],a[60:63],a[92:95],v[188:191]
 buffer_load_dwordx4 v11, s[4:7], s26 offen offset:3072 lds
 mf v[184:187],a[60:63],a[88:91],v[184:187]
 rd a[40:43],v22,6144
 mf v[152:155],a[56:59],a[88:91],v[152:155]
 rd a[44:47],v22,7168
 mf v[148:151],a[56:59],a[84:87],v[148:151]
 s_add_u32 s26, s26, 131072
 mf v[180:183],a[60:63],a[84:87],v[180:183]
 s_add_u32 m0, s28, 114688
 mf v[176:179],a[60:63],a[80:83],v[176:179]
 buffer_load_dwordx4 v12, s[8:11], s27 offen offset:0 lds
 mf v[144:147],a[56:59],a[80:83],v[144:147]
 mf v[140:143],a[56:59],a[76:79],v[140:143]
 mf v[172:175],a[60:63],a[76:79],v[172:175]
 mf v[168:171],a[60:63],a[72:75],v[168:171]
 mf v[136:139],a[56:59],a[72:75],v[136:139]
 buffer_load_dwordx4 v12, s[8:11], s27 offen offset:1024 lds
 mf v[132:135],a[56:59],a[68:71],v[132:135]
 mf v[164:167],a[60:63],a[68:71],v[164:167]
 mf v[160:163],a[60:63],a[64:67],v[160:163]
 s_waitcnt lgkmcnt(0)
 s_nop 0
 mf v[128:131],a[56:59],a[64:67],v[128:131]
 mf v[64:67],a[0:3],a[16:19],v[64:67]
 rd a[64:67],v22,16384
 mf v[96:99],a[4:7],a[16:19],v[96:99]
 tr a[48:49],v14,8192
 mf v[100:103],a[4:7],a[20:23],v[100:103]
 tr a[50:51],v14,12288
 mf v[68:71],a[0:3],a[20:23],v[68:71]
 buffer_load_dwordx4 v12, s[8:11], s27 offen offset:2048 lds
 mf v[72:75],a[0:3],a[24:27],v[72:75]
 rd a[68:71],v22,17408
 mf v[104:107],a[4:7],a[24:27],v[104:107]
 tr a[52:53],v15,8192
 mf v[108:111],a[4:7],a[28:31],v[108:111]
 tr a[54:55],v15,12288
 mf v[76:79],a[0:3],a[28:31],v[76:79]
 buffer_load_dwordx4 v12, s[8:11], s27 offen offset:3072 lds
 mf v[80:83],a[0:3],a[32:35],v[80:83]
 rd a[72:75],v22,18432
 mf v[112:115],a[4:7],a[32:35],v[112:115]
 tr a[56:57],v16,8192
 mf v[116:119],a[4:7],a[36:39],v[116:119]
 tr a[58:59],v16,12288
 mf v[84:87],a[0:3],a[36:39],v[84:87]
 rd a[76:79],v22,19456
 s_add_u32 m0, s28, 118784
 mf v[88:91],a[0:3],a[40:43],v[88:91]
 buffer_load_dwordx4 v13, s[8:11], s27 offen offset:0 lds
 mf v[120:123],a[4:7],a[40:43],v[120:123]
 tr a[60:61],v17,8192
 mf v[124:127],a[4:7],a[44:47],v[124:127]
 tr a[62:63],v17,12288
 mf v[92:95],a[0:3],a[44:47],v[92:95]
 rd a[80:83],v22,20480
 mf v[156:159],a[8:11],a[44:47],v[156:159]
 rd a[84:87],v22,21504
 mf v[188:191],a[12:15],a[44:47],v[188:191]
 buffer_load_dwordx4 v13, s[8:11], s27 offen offset:1024 lds
 mf v[184:187],a[12:15],a[40:43],v[184:187]
 rd a[88:91],v22,22528
 mf v[152:155],a[8:11],a[40:43],v[152:155]
 rd a[92:95],v22,23552
 mf v[148:151],a[8:11],a[36:39],v[148:151]
 mf v[180:183],a[12:15],a[36:39],v[180:183]
 mf v[176:179],a[12:15],a[32:35],v[176:179]
 buffer_load_dwordx4 v13, s[8:11], s27 offen offset:2048 lds
 mf v[144:147],a[8:11],a[32:35],v[144:147]
 mf v[140:143],a[8:11],a[28:31],v[140:143]
 mf v[172:175],a[12:15],a[28:31],v[172:175]
 mf v[168:171],a[12:15],a[24:27],v[168:171]
 mf v[136:139],a[8:11],a[24:27],v[136:139]
 buffer_load_dwordx4 v13, s[8:11], s27 offen offset:3072 lds
 mf v[132:135],a[8:11],a[20:23],v[132:135]
 s_add_u32 s27, s27, 262144
 mf v[164:167],a[12:15],a[20:23],v[164:167]
 mf v[160:163],a[12:15],a[16:19],v[160:163]
 s_waitcnt vmcnt(12) lgkmcnt(0)
 s_nop 0
 mf v[128:131],a[8:11],a[16:19],v[128:131]
 s_barrier
 s_nop 0
 mf v[64:67],a[48:51],a[64:67],v[64:67]
 rd a[16:19],v23,0
 mf v[96:99],a[52:55],a[64:67],v[96:99]
 tr a[0:1],v14,49152
 mf v[100:103],a[52:55],a[68:71],v[100:103]
 tr a[2:3],v14,53248
 s_add_u32 m0, s29, 0
 s_nop 0
 mf v[68:71],a[48:51],a[68:71],v[68:71]
 buffer_load_dwordx4 v8, s[4:7], s26 offen offset:0 lds
 mf v[72:75],a[48:51],a[72:75],v[72:75]
 rd a[20:23],v23,1024
 mf v[104:107],a[52:55],a[72:75],v[104:107]
 tr a[4:5],v15,49152
 mf v[108:111],a[52:55],a[76:79],v[108:111]
 tr a[6:7],v15,53248
 mf v[76:79],a[48:51],a[76:79],v[76:79]
 buffer_load_dwordx4 v9, s[4:7], s26 offen offset:1024 lds
 mf v[80:83],a[48:51],a[80:83],v[80:83]
 rd a[24:27],v23,2048
 mf v[112:115],a[52:55],a[80:83],v[112:115]
 tr a[8:9],v16,49152
 mf v[116:119],a[52:55],a[84:87],v[116:119]
 tr a[10:11],v16,53248
 mf v[84:87],a[48:51],a[84:87],v[84:87]
 rd a[28:31],v23,3072
 mf v[88:91],a[48:51],a[88:91],v[88:91]
 buffer_load_dwordx4 v10, s[4:7], s26 offen offset:2048 lds
 mf v[120:123],a[52:55],a[88:91],v[120:123]
 tr a[12:13],v17,49152
 mf v[124:127],a[52:55],a[92:95],v[124:127]
 tr a[14:15],v17,53248
 mf v[92:95],a[48:51],a[92:95],v[92:95]
 rd a[32:35],v23,4096
 mf v[156:159],a[56:59],a[92:95],v[156:159]
 rd a[36:39],v23,5120
 mf v[188:191],a[60:63],a[92:95],v[188:191]
 buffer_load_dwordx4 v11, s[4:7], s26 offen offset:3072 lds
 mf v[184:187],a[60:63],a[88:91],v[184:187]
 rd a[40:43],v23,6144
 mf v[152:155],a[56:59],a[88:91],v[152:155]
 rd a[44:47],v23,7168
 mf v[148:151],a[56:59],a[84:87],v[148:151]
 s_add_u32 s26, s26, s85
 s_nop 0
 mf v[180:183],a[60:63],a[84:87],v[180:183]
 s_add_u32 m0, s28, 16384
 mf v[176:179],a[60:63],a[80:83],v[176:179]
 buffer_load_dwordx4 v12, s[8:11], s27 offen offset:0 lds
 mf v[144:147],a[56:59],a[80:83],v[144:147]
 mf v[140:143],a[56:59],a[76:79],v[140:143]
 mf v[172:175],a[60:63],a[76:79],v[172:175]
 mf v[168:171],a[60:63],a[72:75],v[168:171]
 mf v[136:139],a[56:59],a[72:75],v[136:139]
 buffer_load_dwordx4 v12, s[8:11], s27 offen offset:1024 lds
 mf v[132:135],a[56:59],a[68:71],v[132:135]
 mf v[164:167],a[60:63],a[68:71],v[164:167]
 mf v[160:163],a[60:63],a[64:67],v[160:163]
 s_waitcnt lgkmcnt(0)
 s_nop 0
 mf v[128:131],a[56:59],a[64:67],v[128:131]
 mf v[64:67],a[0:3],a[16:19],v[64:67]
 rd a[64:67],v23,16384
 mf v[96:99],a[4:7],a[16:19],v[96:99]
 tr a[48:49],v14,57344
 mf v[100:103],a[4:7],a[20:23],v[100:103]
 tr a[50:51],v14,61440
 mf v[68:71],a[0:3],a[20:23],v[68:71]
 buffer_load_dwordx4 v12, s[8:11], s27 offen offset:2048 lds
 mf v[72:75],a[0:3],a[24:27],v[72:75]
 rd a[68:71],v23,17408
 mf v[104:107],a[4:7],a[24:27],v[104:107]
 tr a[52:53],v15,57344
 mf v[108:111],a[4:7],a[28:31],v[108:111]
 tr a[54:55],v15,61440
 mf v[76:79],a[0:3],a[28:31],v[76:79]
 buffer_load_dwordx4 v12, s[8:11], s27 offen offset:3072 lds
 mf v[80:83],a[0:3],a[32:35],v[80:83]
 rd a[72:75],v23,18432
 mf v[112:115],a[4:7],a[32:35],v[112:115]
 tr a[56:57],v16,57344
 mf v[116:119],a[4:7],a[36:39],v[116:119]
 tr a[58:59],v16,61440
 mf v[84:87],a[0:3],a[36:39],v[84:87]
 rd a[76:79],v23,19456
 s_add_u32 m0, s28, 20480
 mf v[88:91],a[0:3],a[40:43],v[88:91]
 buffer_load_dwordx4 v13, s[8:11], s27 offen offset:0 lds
 mf v[120:123],a[4:7],a[40:43],v[120:123]
 tr a[60:61],v17,57344
 mf v[124:127],a[4:7],a[44:47],v[124:127]
 tr a[62:63],v17,61440
 mf v[92:95],a[0:3],a[44:47],v[92:95]
 rd a[80:83],v23,20480
 mf v[156:159],a[8:11],a[44:47],v[156:159]
 rd a[84:87],v23,21504
 mf v[188:191],a[12:15],a[44:47],v[188:191]
 buffer_load_dwordx4 v13, s[8:11], s27 offen offset:1024 lds
 mf v[184:187],a[12:15],a[40:43],v[184:187]
 rd a[88:91],v23,22528
 mf v[152:155],a[8:11],a[40:43],v[152:155]
 rd a[92:95],v23,23552
 mf v[148:151],a[8:11],a[36:39],v[148:151]
 mf v[180:183],a[12:15],a[36:39],v[180:183]
 mf v[176:179],a[12:15],a[32:35],v[176:179]
 buffer_load_dwordx4 v13, s[8:11], s27 offen offset:2048 lds
 mf v[144:147],a[8:11],a[32:35],v[144:147]
 mf v[140:143],a[8:11],a[28:31],v[140:143]
 mf v[172:175],a[12:15],a[28:31],v[172:175]
 mf v[168:171],a[12:15],a[24:27],v[168:171]
 mf v[136:139],a[8:11],a[24:27],v[136:139]
 buffer_load_dwordx4 v13, s[8:11], s27 offen offset:3072 lds
 mf v[132:135],a[8:11],a[20:23],v[132:135]
 s_add_u32 s27, s27, s90
 s_nop 0
 mf v[164:167],a[12:15],a[20:23],v[164:167]
 mf v[160:163],a[12:15],a[16:19],v[160:163]
 s_waitcnt vmcnt(12) lgkmcnt(0)
 s_nop 0
 mf v[128:131],a[8:11],a[16:19],v[128:131]
 s_barrier
 s_waitcnt vmcnt(30)
 v_cmp_ne_u64 vcc, s[36:37], v[6:7]
 s_cmp_lg_u64 vcc, 0
 s_cbranch_scc1 L_o2_late
L_o2_ok:
 s_nop 0
 mf v[64:67],a[48:51],a[64:67],v[64:67]
 rd a[16:19],v24,0
 mf v[96:99],a[52:55],a[64:67],v[96:99]
 tr a[0:1],v18,0
 mf v[100:103],a[52:55],a[68:71],v[100:103]
 tr a[2:3],v18,4096
 s_add_u32 m0, s29, 49152
 mf v[68:71],a[48:51],a[68:71],v[68:71]
 buffer_load_dwordx4 v8, s[4:7], s26 offen offset:0 lds
 mf v[72:75],a[48:51],a[72:75],v[72:75]
 rd a[20:23],v24,1024
 mf v[104:107],a[52:55],a[72:75],v[104:107]
 tr a[4:5],v19,0
 mf v[108:111],a[52:55],a[76:79],v[108:111]
 tr a[6:7],v19,4096
 mf v[76:79],a[48:51],a[76:79],v[76:79]
 buffer_load_dwordx4 v9, s[4:7], s26 offen offset:1024 lds
 mf v[80:83],a[48:51],a[80:83],v[80:83]
 rd a[24:27],v24,2048
 mf v[112:115],a[52:55],a[80:83],v[112:115]
 tr a[8:9],v20,0
 mf v[116:119],a[52:55],a[84:87],v[116:119]
 tr a[10:11],v20,4096
 mf v[84:87],a[48:51],a[84:87],v[84:87]
 rd a[28:31],v24,3072
 mf v[88:91],a[48:51],a[88:91],v[88:91]
 buffer_load_dwordx4 v10, s[4:7], s26 offen offset:2048 lds
 mf v[120:123],a[52:55],a[88:91],v[120:123]
 tr a[12:13],v21,0
 mf v[124:127],a[52:55],a[92:95],v[124:127]
 tr a[14:15],v21,4096
 mf v[92:95],a[48:51],a[92:95],v[92:95]
 rd a[32:35],v24,4096
 mf v[156:159],a[56:59],a[92:95],v[156:159]
 rd a[36:39],v24,5120
 mf v[188:191],a[60:63],a[92:95],v[188:191]
 buffer_load_dwordx4 v11, s[4:7], s26 offen offset:3072 lds
 mf v[184:187],a[60:63],a[88:91],v[184:187]
 rd a[40:43],v24,6144
 mf v[152:155],a[56:59],a[88:91],v[152:155]
 rd a[44:47],v24,7168
 mf v[148:151],a[56:59],a[84:87],v[148:151]
 s_add_u32 s26, s26, 131072
 mf v[180:183],a[60:63],a[84:87],v[180:183]
 s_add_u32 m0, s28, 65536
 mf v[176:179],a[60:63],a[80:83],v[176:179]
 buffer_load_dwordx4 v12, s[8:11], s27 offen offset:0 lds
 mf v[144:147],a[56:59],a[80:83],v[144:147]
 mf v[140:143],a[56:59],a[76:79],v[140:143]
 mf v[172:175],a[60:63],a[76:79],v[172:175]
 mf v[168:171],a[60:63],a[72:75],v[168:171]
 mf v[136:139],a[56:59],a[72:75],v[136:139]
 buffer_load_dwordx4 v12, s[8:11], s27 offen offset:1024 lds
 mf v[132:135],a[56:59],a[68:71],v[132:135]
 mf v[164:167],a[60:63],a[68:71],v[164:167]
 mf v[160:163],a[60:63],a[64:67],v[160:163]
 s_waitcnt lgkmcnt(0)
 s_nop 0
 mf v[128:131],a[56:59],a[64:67],v[128:131]
 s_sub_u32 s30, 4, s98
 s_branch L_skip_10426
.p2align 12
L_stub_w0_10426:
 s_branch L_walk_y_ret
 s_nop 0
 s_nop 0
 s_nop 0
L_skip_10426:
.p2align 6
L_fy_loop_21:
 mf v[64:67],a[0:3],a[16:19],v[64:67]
 rd a[64:67],v24,16384
 mf v[96:99],a[4:7],a[16:19],v[96:99]
 tr a[48:49],v18,8192
 mf v[100:103],a[4:7],a[20:23],v[100:103]
 tr a[50:51],v18,12288
 mf v[68:71],a[0:3],a[20:23],v[68:71]
 buffer_load_dwordx4 v12, s[8:11], s27 offen offset:2048 lds
 mf v[72:75],a[0:3],a[24:27],v[72:75]
 rd a[68:71],v24,17408
 mf v[104:107],a[4:7],a[24:27],v[104:107]
 tr a[52:53],v19,8192
 mf v[108:111],a[4:7],a[28:31],v[108:111]
 tr a[54:55],v19,12288
 mf v[76:79],a[0:3],a[28:31],v[76:79]
 buffer_load_dwordx4 v12, s[8:11], s27 offen offset:3072 lds
 mf v[80:83],a[0:3],a[32:35],v[80:83]
 rd a[72:75],v24,18432
 mf v[112:115],a[4:7],a[32:35],v[112:115]
 tr a[56:57],v20,8192
 mf v[116:119],a[4:7],a[36:39],v[116:119]
 tr a[58:59],v20,12288
 mf v[84:87],a[0:3],a[36:39],v[84:87]
 rd a[76:79],v24,19456
 s_add_u32 m0, s28, 69632
 mf v[88:91],a[0:3],a[40:43],v[88:91]
 buffer_load_dwordx4 v13, s[8:11], s27 offen offset:0 lds
 mf v[120:123],a[4:7],a[40:43],v[120:123]
 tr a[60:61],v21,8192
 mf v[124:127],a[4:7],a[44:47],v[124:127]
 tr a[62:63],v21,12288
 mf v[92:95],a[0:3],a[44:47],v[92:95]
 rd a[80:83],v24,20480
 mf v[156:159],a[8:11],a[44:47],v[156:159]
 rd a[84:87],v24,21504
 mf v[188:191],a[12:15],a[44:47],v[188:191]
 buffer_load_dwordx4 v13, s[8:11], s27 offen offset:1024 lds
 mf v[184:187],a[12:15],a[40:43],v[184:187]
 rd a[88:91],v24,22528
 mf v[152:155],a[8:11],a[40:43],v[152:155]
 rd a[92:95],v24,23552
 mf v[148:151],a[8:11],a[36:39],v[148:151]
 mf v[180:183],a[12:15],a[36:39],v[180:183]
 mf v[176:179],a[12:15],a[32:35],v[176:179]
 buffer_load_dwordx4 v13, s[8:11], s27 offen offset:2048 lds
 mf v[144:147],a[8:11],a[32:35],v[144:147]
 mf v[140:143],a[8:11],a[28:31],v[140:143]
 mf v[172:175],a[12:15],a[28:31],v[172:175]
 mf v[168:171],a[12:15],a[24:27],v[168:171]
 mf v[136:139],a[8:11],a[24:27],v[136:139]
 buffer_load_dwordx4 v13, s[8:11], s27 offen offset:3072 lds
 mf v[132:135],a[8:11],a[20:23],v[132:135]
 s_add_u32 s27, s27, 262144
 mf v[164:167],a[12:15],a[20:23],v[164:167]
 mf v[160:163],a[12:15],a[16:19],v[160:163]
 s_waitcnt vmcnt(12) lgkmcnt(0)
 s_nop 0
 mf v[128:131],a[8:11],a[16:19],v[128:131]
 s_barrier
 s_nop 0
 mf v[64:67],a[48:51],a[64:67],v[64:67]
 rd a[16:19],v22,0
 mf v[96:99],a[52:55],a[64:67],v[96:99]
 tr a[0:1],v14,0
 mf v[100:103],a[52:55],a[68:71],v[100:103]
 tr a[2:3],v14,4096
 s_add_u32 m0, s29, 98304
 mf v[68:71],a[48:51],a[68:71],v[68:71]
 buffer_load_dwordx4 v8, s[4:7], s26 offen offset:0 lds
 mf v[72:75],a[48:51],a[72:75],v[72:75]
 rd a[20:23],v22,1024
 mf v[104:107],a[52:55],a[72:75],v[104:107]
 tr a[4:5],v15,0
 mf v[108:111],a[52:55],a[76:79],v[108:111]
 tr a[6:7],v15,4096
 mf v[76:79],a[48:51],a[76:79],v[76:79]
 buffer_load_dwordx4 v9, s[4:7], s26 offen offset:1024 lds
 mf v[80:83],a[48:51],a[80:83],v[80:83]
 rd a[24:27],v22,2048
 mf v[112:115],a[52:55],a[80:83],v[112:115]
 tr a[8:9],v16,0
 mf v[116:119],a[52:55],a[84:87],v[116:119]
 tr a[10:11],v16,4096
 mf v[84:87],a[48:51],a[84:87],v[84:87]
 rd a[28:31],v22,3072
 mf v[88:91],a[48:51],a[88:91],v[88:91]
 buffer_load_dwordx4 v10, s[4:7], s26 offen offset:2048 lds
 mf v[120:123],a[52:55],a[88:91],v[120:123]
 tr a[12:13],v17,0
 mf v[124:127],a[52:55],a[92:95],v[124:127]
 tr a[14:15],v17,4096
 mf v[92:95],a[48:51],a[92:95],v[92:95]
 rd a[32:35],v22,4096
 mf v[156:159],a[56:59],a[92:95],v[156:159]
 rd a[36:39],v22,5120
 mf v[188:191],a[60:63],a[92:95],v[188:191]
 buffer_load_dwordx4 v11, s[4:7], s26 offen offset:3072 lds
 mf v[184:187],a[60:63],a[88:91],v[184:187]
 rd a[40:43],v22,6144
 mf v[152:155],a[56:59],a[88:91],v[152:155]
 rd a[44:47],v22,7168
 mf v[148:151],a[56:59],a[84:87],v[148:151]
 s_add_u32 s26, s26, 131072
 mf v[180:183],a[60:63],a[84:87],v[180:183]
 s_add_u32 m0, s28, 114688
 mf v[176:179],a[60:63],a[80:83],v[176:179]
 buffer_load_dwordx4 v12, s[8:11], s27 offen offset:0 lds
 mf v[144:147],a[56:59],a[80:83],v[144:147]
 mf v[140:143],a[56:59],a[76:79],v[140:143]
 mf v[172:175],a[60:63],a[76:79],v[172:175]
 mf v[168:171],a[60:63],a[72:75],v[168:171]
 mf v[136:139],a[56:59],a[72:75],v[136:139]
 buffer_load_dwordx4 v12, s[8:11], s27 offen offset:1024 lds
 mf v[132:135],a[56:59],a[68:71],v[132:135]
 mf v[164:167],a[60:63],a[68:71],v[164:167]
 mf v[160:163],a[60:63],a[64:67],v[160:163]
 s_waitcnt lgkmcnt(0)
 s_nop 0
 mf v[128:131],a[56:59],a[64:67],v[128:131]
 mf v[64:67],a[0:3],a[16:19],v[64:67]
 rd a[64:67],v22,16384
 mf v[96:99],a[4:7],a[16:19],v[96:99]
 tr a[48:49],v14,8192
 mf v[100:103],a[4:7],a[20:23],v[100:103]
 tr a[50:51],v14,12288
 mf v[68:71],a[0:3],a[20:23],v[68:71]
 buffer_load_dwordx4 v12, s[8:11], s27 offen offset:2048 lds
 mf v[72:75],a[0:3],a[24:27],v[72:75]
 rd a[68:71],v22,17408
 mf v[104:107],a[4:7],a[24:27],v[104:107]
 tr a[52:53],v15,8192
 mf v[108:111],a[4:7],a[28:31],v[108:111]
 tr a[54:55],v15,12288
 mf v[76:79],a[0:3],a[28:31],v[76:79]
 buffer_load_dwordx4 v12, s[8:11], s27 offen offset:3072 lds
 mf v[80:83],a[0:3],a[32:35],v[80:83]
 rd a[72:75],v22,18432
 mf v[112:115],a[4:7],a[32:35],v[112:115]
 tr a[56:57],v16,8192
 mf v[116:119],a[4:7],a[36:39],v[116:119]
 tr a[58:59],v16,12288
 mf v[84:87],a[0:3],a[36:39],v[84:87]
 rd a[76:79],v22,19456
 s_add_u32 m0, s28, 118784
 mf v[88:91],a[0:3],a[40:43],v[88:91]
 buffer_load_dwordx4 v13, s[8:11], s27 offen offset:0 lds
 mf v[120:123],a[4:7],a[40:43],v[120:123]
 tr a[60:61],v17,8192
 mf v[124:127],a[4:7],a[44:47],v[124:127]
 tr a[62:63],v17,12288
 mf v[92:95],a[0:3],a[44:47],v[92:95]
 rd a[80:83],v22,20480
 mf v[156:159],a[8:11],a[44:47],v[156:159]
 rd a[84:87],v22,21504
 mf v[188:191],a[12:15],a[44:47],v[188:191]
 buffer_load_dwordx4 v13, s[8:11], s27 offen offset:1024 lds
 mf v[184:187],a[12:15],a[40:43],v[184:187]
 rd a[88:91],v22,22528
 mf v[152:155],a[8:11],a[40:43],v[152:155]
 rd a[92:95],v22,23552
 mf v[148:151],a[8:11],a[36:39],v[148:151]
 mf v[180:183],a[12:15],a[36:39],v[180:183]
 mf v[176:179],a[12:15],a[32:35],v[176:179]
 buffer_load_dwordx4 v13, s[8:11], s27 offen offset:2048 lds
 mf v[144:147],a[8:11],a[32:35],v[144:147]
 mf v[140:143],a[8:11],a[28:31],v[140:143]
 mf v[172:175],a[12:15],a[28:31],v[172:175]
 mf v[168:171],a[12:15],a[24:27],v[168:171]
 mf v[136:139],a[8:11],a[24:27],v[136:139]
 buffer_load_dwordx4 v13, s[8:11], s27 offen offset:3072 lds
 mf v[132:135],a[8:11],a[20:23],v[132:135]
 s_add_u32 s27, s27, 262144
 mf v[164:167],a[12:15],a[20:23],v[164:167]
 mf v[160:163],a[12:15],a[16:19],v[160:163]
 s_waitcnt vmcnt(12) lgkmcnt(0)
 s_nop 0
 mf v[128:131],a[8:11],a[16:19],v[128:131]
 s_barrier
 s_nop 0
 mf v[64:67],a[48:51],a[64:67],v[64:67]
 rd a[16:19],v23,0
 mf v[96:99],a[52:55],a[64:67],v[96:99]
 tr a[0:1],v14,49152
 mf v[100:103],a[52:55],a[68:71],v[100:103]
 tr a[2:3],v14,53248
 s_add_u32 m0, s29, 0
 s_nop 0
 mf v[68:71],a[48:51],a[68:71],v[68:71]
 buffer_load_dwordx4 v8, s[4:7], s26 offen offset:0 lds
 mf v[72:75],a[48:51],a[72:75],v[72:75]
 rd a[20:23],v23,1024
 mf v[104:107],a[52:55],a[72:75],v[104:107]
 tr a[4:5],v15,49152
 mf v[108:111],a[52:55],a[76:79],v[108:111]
 tr a[6:7],v15,53248
 mf v[76:79],a[48:51],a[76:79],v[76:79]
 buffer_load_dwordx4 v9, s[4:7], s26 offen offset:1024 lds
 mf v[80:83],a[48:51],a[80:83],v[80:83]
 rd a[24:27],v23,2048
 mf v[112:115],a[52:55],a[80:83],v[112:115]
 tr a[8:9],v16,49152
 mf v[116:119],a[52:55],a[84:87],v[116:119]
 tr a[10:11],v16,53248
 mf v[84:87],a[48:51],a[84:87],v[84:87]
 rd a[28:31],v23,3072
 mf v[88:91],a[48:51],a[88:91],v[88:91]
 buffer_load_dwordx4 v10, s[4:7], s26 offen offset:2048 lds
 mf v[120:123],a[52:55],a[88:91],v[120:123]
 tr a[12:13],v17,49152
 mf v[124:127],a[52:55],a[92:95],v[124:127]
 tr a[14:15],v17,53248
 mf v[92:95],a[48:51],a[92:95],v[92:95]
 rd a[32:35],v23,4096
 mf v[156:159],a[56:59],a[92:95],v[156:159]
 rd a[36:39],v23,5120
 mf v[188:191],a[60:63],a[92:95],v[188:191]
 buffer_load_dwordx4 v11, s[4:7], s26 offen offset:3072 lds
 mf v[184:187],a[60:63],a[88:91],v[184:187]
 rd a[40:43],v23,6144
 mf v[152:155],a[56:59],a[88:91],v[152:155]
 rd a[44:47],v23,7168
 mf v[148:151],a[56:59],a[84:87],v[148:151]
 s_add_u32 s26, s26, 131072
 mf v[180:183],a[60:63],a[84:87],v[180:183]
 s_add_u32 m0, s28, 16384
 mf v[176:179],a[60:63],a[80:83],v[176:179]
 buffer_load_dwordx4 v12, s[8:11], s27 offen offset:0 lds
 mf v[144:147],a[56:59],a[80:83],v[144:147]
 mf v[140:143],a[56:59],a[76:79],v[140:143]
 mf v[172:175],a[60:63],a[76:79],v[172:175]
 mf v[168:171],a[60:63],a[72:75],v[168:171]
 mf v[136:139],a[56:59],a[72:75],v[136:139]
 buffer_load_dwordx4 v12, s[8:11], s27 offen offset:1024 lds
 mf v[132:135],a[56:59],a[68:71],v[132:135]
 mf v[164:167],a[60:63],a[68:71],v[164:167]
 mf v[160:163],a[60:63],a[64:67],v[160:163]
 s_waitcnt lgkmcnt(0)
 s_nop 0
 mf v[128:131],a[56:59],a[64:67],v[128:131]
 mf v[64:67],a[0:3],a[16:19],v[64:67]
 rd a[64:67],v23,16384
 mf v[96:99],a[4:7],a[16:19],v[96:99]
 tr a[48:49],v14,57344
 mf v[100:103],a[4:7],a[20:23],v[100:103]
 tr a[50:51],v14,61440
 mf v[68:71],a[0:3],a[20:23],v[68:71]
 buffer_load_dwordx4 v12, s[8:11], s27 offen offset:2048 lds
 mf v[72:75],a[0:3],a[24:27],v[72:75]
 rd a[68:71],v23,17408
 mf v[104:107],a[4:7],a[24:27],v[104:107]
 tr a[52:53],v15,57344
 mf v[108:111],a[4:7],a[28:31],v[108:111]
 tr a[54:55],v15,61440
 mf v[76:79],a[0:3],a[28:31],v[76:79]
 buffer_load_dwordx4 v12, s[8:11], s27 offen offset:3072 lds
 mf v[80:83],a[0:3],a[32:35],v[80:83]
 rd a[72:75],v23,18432
 mf v[112:115],a[4:7],a[32:35],v[112:115]
 tr a[56:57],v16,57344
 mf v[116:119],a[4:7],a[36:39],v[116:119]
 tr a[58:59],v16,61440
 mf v[84:87],a[0:3],a[36:39],v[84:87]
 rd a[76:79],v23,19456
 s_add_u32 m0, s28, 20480
 mf v[88:91],a[0:3],a[40:43],v[88:91]
 buffer_load_dwordx4 v13, s[8:11], s27 offen offset:0 lds
 mf v[120:123],a[4:7],a[40:43],v[120:123]
 tr a[60:61],v17,57344
 mf v[124:127],a[4:7],a[44:47],v[124:127]
 tr a[62:63],v17,61440
 mf v[92:95],a[0:3],a[44:47],v[92:95]
 rd a[80:83],v23,20480
 mf v[156:159],a[8:11],a[44:47],v[156:159]
 rd a[84:87],v23,21504
 mf v[188:191],a[12:15],a[44:47],v[188:191]
 buffer_load_dwordx4 v13, s[8:11], s27 offen offset:1024 lds
 mf v[184:187],a[12:15],a[40:43],v[184:187]
 rd a[88:91],v23,22528
 mf v[152:155],a[8:11],a[40:43],v[152:155]
 rd a[92:95],v23,23552
 mf v[148:151],a[8:11],a[36:39],v[148:151]
 mf v[180:183],a[12:15],a[36:39],v[180:183]
 mf v[176:179],a[12:15],a[32:35],v[176:179]
 buffer_load_dwordx4 v13, s[8:11], s27 offen offset:2048 lds
 mf v[144:147],a[8:11],a[32:35],v[144:147]
 mf v[140:143],a[8:11],a[28:31],v[140:143]
 mf v[172:175],a[12:15],a[28:31],v[172:175]
 mf v[168:171],a[12:15],a[24:27],v[168:171]
 mf v[136:139],a[8:11],a[24:27],v[136:139]
 buffer_load_dwordx4 v13, s[8:11], s27 offen offset:3072 lds
 mf v[132:135],a[8:11],a[20:23],v[132:135]
 s_add_u32 s27, s27, 262144
 mf v[164:167],a[12:15],a[20:23],v[164:167]
 mf v[160:163],a[12:15],a[16:19],v[160:163]
 s_waitcnt vmcnt(12) lgkmcnt(0)
 s_nop 0
 mf v[128:131],a[8:11],a[16:19],v[128:131]
 s_barrier
 s_nop 0
 mf v[64:67],a[48:51],a[64:67],v[64:67]
 rd a[16:19],v24,0
 mf v[96:99],a[52:55],a[64:67],v[96:99]
 tr a[0:1],v18,0
 mf v[100:103],a[52:55],a[68:71],v[100:103]
 tr a[2:3],v18,4096
 s_add_u32 m0, s29, 49152
 mf v[68:71],a[48:51],a[68:71],v[68:71]
 buffer_load_dwordx4 v8, s[4:7], s26 offen offset:0 lds
 mf v[72:75],a[48:51],a[72:75],v[72:75]
 rd a[20:23],v24,1024
 mf v[104:107],a[52:55],a[72:75],v[104:107]
 tr a[4:5],v19,0
 mf v[108:111],a[52:55],a[76:79],v[108:111]
 tr a[6:7],v19,4096
 mf v[76:79],a[48:51],a[76:79],v[76:79]
 buffer_load_dwordx4 v9, s[4:7], s26 offen offset:1024 lds
 mf v[80:83],a[48:51],a[80:83],v[80:83]
 rd a[24:27],v24,2048
 mf v[112:115],a[52:55],a[80:83],v[112:115]
 tr a[8:9],v20,0
 mf v[116:119],a[52:55],a[84:87],v[116:119]
 tr a[10:11],v20,4096
 mf v[84:87],a[48:51],a[84:87],v[84:87]
 rd a[28:31],v24,3072
 mf v[88:91],a[48:51],a[88:91],v[88:91]
 buffer_load_dwordx4 v10, s[4:7], s26 offen offset:2048 lds
 mf v[120:123],a[52:55],a[88:91],v[120:123]
 tr a[12:13],v21,0
 mf v[124:127],a[52:55],a[92:95],v[124:127]
 tr a[14:15],v21,4096
 mf v[92:95],a[48:51],a[92:95],v[92:95]
 rd a[32:35],v24,4096
 mf v[156:159],a[56:59],a[92:95],v[156:159]
 rd a[36:39],v24,5120
 mf v[188:191],a[60:63],a[92:95],v[188:191]
 buffer_load_dwordx4 v11, s[4:7], s26 offen offset:3072 lds
 mf v[184:187],a[60:63],a[88:91],v[184:187]
 rd a[40:43],v24,6144
 mf v[152:155],a[56:59],a[88:91],v[152:155]
 rd a[44:47],v24,7168
 mf v[148:151],a[56:59],a[84:87],v[148:151]
 s_add_u32 s26, s26, 131072
 mf v[180:183],a[60:63],a[84:87],v[180:183]
 s_add_u32 m0, s28, 65536
 mf v[176:179],a[60:63],a[80:83],v[176:179]
 buffer_load_dwordx4 v12, s[8:11], s27 offen offset:0 lds
 mf v[144:147],a[56:59],a[80:83],v[144:147]
 mf v[140:143],a[56:59],a[76:79],v[140:143]
 mf v[172:175],a[60:63],a[76:79],v[172:175]
 mf v[168:171],a[60:63],a[72:75],v[168:171]
 mf v[136:139],a[56:59],a[72:75],v[136:139]
 buffer_load_dwordx4 v12, s[8:11], s27 offen offset:1024 lds
 mf v[132:135],a[56:59],a[68:71],v[132:135]
 mf v[164:167],a[60:63],a[68:71],v[164:167]
 mf v[160:163],a[60:63],a[64:67],v[160:163]
 s_sub_u32 s30, s30, 1
 s_waitcnt lgkmcnt(0)
 s_cmp_lg_u32 s30, 0
 s_nop 0
 mf v[128:131],a[56:59],a[64:67],v[128:131]
 s_cbranch_scc1 L_fy_loop_21
 s_nop 0
 mf v[64:67],a[0:3],a[16:19],v[64:67]
 rd a[64:67],v24,16384
 mf v[96:99],a[4:7],a[16:19],v[96:99]
 tr a[48:49],v18,8192
 mf v[100:103],a[4:7],a[20:23],v[100:103]
 tr a[50:51],v18,12288
 mf v[68:71],a[0:3],a[20:23],v[68:71]
 buffer_load_dwordx4 v12, s[8:11], s27 offen offset:2048 lds
 mf v[72:75],a[0:3],a[24:27],v[72:75]
 rd a[68:71],v24,17408
 mf v[104:107],a[4:7],a[24:27],v[104:107]
 tr a[52:53],v19,8192
 mf v[108:111],a[4:7],a[28:31],v[108:111]
 tr a[54:55],v19,12288
 mf v[76:79],a[0:3],a[28:31],v[76:79]
 buffer_load_dwordx4 v12, s[8:11], s27 offen offset:3072 lds
 mf v[80:83],a[0:3],a[32:35],v[80:83]
 rd a[72:75],v24,18432
 mf v[112:115],a[4:7],a[32:35],v[112:115]
 tr a[56:57],v20,8192
 mf v[116:119],a[4:7],a[36:39],v[116:119]
 tr a[58:59],v20,12288
 mf v[84:87],a[0:3],a[36:39],v[84:87]
 rd a[76:79],v24,19456
 s_add_u32 m0, s28, 69632
 mf v[88:91],a[0:3],a[40:43],v[88:91]
 buffer_load_dwordx4 v13, s[8:11], s27 offen offset:0 lds
 mf v[120:123],a[4:7],a[40:43],v[120:123]
 tr a[60:61],v21,8192
 mf v[124:127],a[4:7],a[44:47],v[124:127]
 tr a[62:63],v21,12288
 mf v[92:95],a[0:3],a[44:47],v[92:95]
 rd a[80:83],v24,20480
 mf v[156:159],a[8:11],a[44:47],v[156:159]
 rd a[84:87],v24,21504
 mf v[188:191],a[12:15],a[44:47],v[188:191]
 buffer_load_dwordx4 v13, s[8:11], s27 offen offset:1024 lds
 mf v[184:187],a[12:15],a[40:43],v[184:187]
 rd a[88:91],v24,22528
 mf v[152:155],a[8:11],a[40:43],v[152:155]
 rd a[92:95],v24,23552
 mf v[148:151],a[8:11],a[36:39],v[148:151]
 mf v[180:183],a[12:15],a[36:39],v[180:183]
 mf v[176:179],a[12:15],a[32:35],v[176:179]
 buffer_load_dwordx4 v13, s[8:11], s27 offen offset:2048 lds
 mf v[144:147],a[8:11],a[32:35],v[144:147]
 mf v[140:143],a[8:11],a[28:31],v[140:143]
 mf v[172:175],a[12:15],a[28:31],v[172:175]
 mf v[168:171],a[12:15],a[24:27],v[168:171]
 mf v[136:139],a[8:11],a[24:27],v[136:139]
 buffer_load_dwordx4 v13, s[8:11], s27 offen offset:3072 lds
 mf v[132:135],a[8:11],a[20:23],v[132:135]
 s_add_u32 s27, s27, 262144
 mf v[164:167],a[12:15],a[20:23],v[164:167]
 mf v[160:163],a[12:15],a[16:19],v[160:163]
 s_waitcnt vmcnt(12) lgkmcnt(0)
 s_nop 0
 mf v[128:131],a[8:11],a[16:19],v[128:131]
 s_barrier
 s_nop 0
 mf v[64:67],a[48:51],a[64:67],v[64:67]
 rd a[16:19],v22,0
 mf v[96:99],a[52:55],a[64:67],v[96:99]
 tr a[0:1],v14,0
 mf v[100:103],a[52:55],a[68:71],v[100:103]
 tr a[2:3],v14,4096
 mf v[68:71],a[48:51],a[68:71],v[68:71]
 rd a[20:23],v22,1024
 mf v[72:75],a[48:51],a[72:75],v[72:75]
 mf v[104:107],a[52:55],a[72:75],v[104:107]
 tr a[4:5],v15,0
 mf v[108:111],a[52:55],a[76:79],v[108:111]
 tr a[6:7],v15,4096
 mf v[76:79],a[48:51],a[76:79],v[76:79]
 rd a[24:27],v22,2048
 mf v[80:83],a[48:51],a[80:83],v[80:83]
 mf v[112:115],a[52:55],a[80:83],v[112:115]
 tr a[8:9],v16,0
 mf v[116:119],a[52:55],a[84:87],v[116:119]
 tr a[10:11],v16,4096
 mf v[84:87],a[48:51],a[84:87],v[84:87]
 rd a[28:31],v22,3072
 mf v[88:91],a[48:51],a[88:91],v[88:91]
 mf v[120:123],a[52:55],a[88:91],v[120:123]
 tr a[12:13],v17,0
 mf v[124:127],a[52:55],a[92:95],v[124:127]
 tr a[14:15],v17,4096
 mf v[92:95],a[48:51],a[92:95],v[92:95]
 rd a[32:35],v22,4096
 mf v[156:159],a[56:59],a[92:95],v[156:159]
 mf v[188:191],a[60:63],a[92:95],v[188:191]
 rd a[36:39],v22,5120
 mf v[184:187],a[60:63],a[88:91],v[184:187]
 rd a[40:43],v22,6144
 mf v[152:155],a[56:59],a[88:91],v[152:155]
 rd a[44:47],v22,7168
 mf v[148:151],a[56:59],a[84:87],v[148:151]
 mf v[180:183],a[60:63],a[84:87],v[180:183]
 mf v[176:179],a[60:63],a[80:83],v[176:179]
 mf v[144:147],a[56:59],a[80:83],v[144:147]
 mf v[140:143],a[56:59],a[76:79],v[140:143]
 mf v[172:175],a[60:63],a[76:79],v[172:175]
 mf v[168:171],a[60:63],a[72:75],v[168:171]
 mf v[136:139],a[56:59],a[72:75],v[136:139]
 mf v[132:135],a[56:59],a[68:71],v[132:135]
 mf v[164:167],a[60:63],a[68:71],v[164:167]
 mf v[160:163],a[60:63],a[64:67],v[160:163]
 s_waitcnt lgkmcnt(0)
 s_nop 0
 mf v[128:131],a[56:59],a[64:67],v[128:131]
 mf v[64:67],a[0:3],a[16:19],v[64:67]
 rd a[64:67],v22,16384
 mf v[96:99],a[4:7],a[16:19],v[96:99]
 tr a[48:49],v14,8192
 mf v[100:103],a[4:7],a[20:23],v[100:103]
 tr a[50:51],v14,12288
 mf v[68:71],a[0:3],a[20:23],v[68:71]
 rd a[68:71],v22,17408
 mf v[72:75],a[0:3],a[24:27],v[72:75]
 mf v[104:107],a[4:7],a[24:27],v[104:107]
 tr a[52:53],v15,8192
 mf v[108:111],a[4:7],a[28:31],v[108:111]
 tr a[54:55],v15,12288
 mf v[76:79],a[0:3],a[28:31],v[76:79]
 rd a[72:75],v22,18432
 mf v[80:83],a[0:3],a[32:35],v[80:83]
 mf v[112:115],a[4:7],a[32:35],v[112:115]
 tr a[56:57],v16,8192
 mf v[116:119],a[4:7],a[36:39],v[116:119]
 tr a[58:59],v16,12288
 mf v[84:87],a[0:3],a[36:39],v[84:87]
 rd a[76:79],v22,19456
 mf v[88:91],a[0:3],a[40:43],v[88:91]
 mf v[120:123],a[4:7],a[40:43],v[120:123]
 tr a[60:61],v17,8192
 mf v[124:127],a[4:7],a[44:47],v[124:127]
 tr a[62:63],v17,12288
 mf v[92:95],a[0:3],a[44:47],v[92:95]
 rd a[80:83],v22,20480
 mf v[156:159],a[8:11],a[44:47],v[156:159]
 mf v[188:191],a[12:15],a[44:47],v[188:191]
 rd a[84:87],v22,21504
 mf v[184:187],a[12:15],a[40:43],v[184:187]
 rd a[88:91],v22,22528
 mf v[152:155],a[8:11],a[40:43],v[152:155]
 rd a[92:95],v22,23552
 mf v[148:151],a[8:11],a[36:39],v[148:151]
 mf v[180:183],a[12:15],a[36:39],v[180:183]
 mf v[176:179],a[12:15],a[32:35],v[176:179]
 mf v[144:147],a[8:11],a[32:35],v[144:147]
 mf v[140:143],a[8:11],a[28:31],v[140:143]
 mf v[172:175],a[12:15],a[28:31],v[172:175]
 mf v[168:171],a[12:15],a[24:27],v[168:171]
 mf v[136:139],a[8:11],a[24:27],v[136:139]
 mf v[132:135],a[8:11],a[20:23],v[132:135]
 mf v[164:167],a[12:15],a[20:23],v[164:167]
 s_branch L_skip_10948
.p2align 12
L_stub_w0_10948:
 s_branch L_walk_y_ret
 s_nop 0
 s_nop 0
 s_nop 0
L_skip_10948:
 mf v[160:163],a[12:15],a[16:19],v[160:163]
 s_waitcnt vmcnt(0) lgkmcnt(0)
 s_nop 0
 mf v[128:131],a[8:11],a[16:19],v[128:131]
 s_barrier
 s_nop 0
 mf v[64:67],a[48:51],a[64:67],v[64:67]
 rd a[16:19],v23,0
 mf v[96:99],a[52:55],a[64:67],v[96:99]
 tr a[0:1],v14,49152
 mf v[100:103],a[52:55],a[68:71],v[100:103]
 tr a[2:3],v14,53248
 mf v[68:71],a[48:51],a[68:71],v[68:71]
 rd a[20:23],v23,1024
 mf v[72:75],a[48:51],a[72:75],v[72:75]
 mf v[104:107],a[52:55],a[72:75],v[104:107]
 tr a[4:5],v15,49152
 mf v[108:111],a[52:55],a[76:79],v[108:111]
 tr a[6:7],v15,53248
 mf v[76:79],a[48:51],a[76:79],v[76:79]
 rd a[24:27],v23,2048
 mf v[80:83],a[48:51],a[80:83],v[80:83]
 mf v[112:115],a[52:55],a[80:83],v[112:115]
 tr a[8:9],v16,49152
 mf v[116:119],a[52:55],a[84:87],v[116:119]
 tr a[10:11],v16,53248
 mf v[84:87],a[48:51],a[84:87],v[84:87]
 rd a[28:31],v23,3072
 mf v[88:91],a[48:51],a[88:91],v[88:91]
 mf v[120:123],a[52:55],a[88:91],v[120:123]
 tr a[12:13],v17,49152
 mf v[124:127],a[52:55],a[92:95],v[124:127]
 tr a[14:15],v17,53248
 mf v[92:95],a[48:51],a[92:95],v[92:95]
 rd a[32:35],v23,4096
 mf v[156:159],a[56:59],a[92:95],v[156:159]
 mf v[188:191],a[60:63],a[92:95],v[188:191]
 rd a[36:39],v23,5120
 mf v[184:187],a[60:63],a[88:91],v[184:187]
 rd a[40:43],v23,6144
 mf v[152:155],a[56:59],a[88:91],v[152:155]
 rd a[44:47],v23,7168
 mf v[148:151],a[56:59],a[84:87],v[148:151]
 mf v[180:183],a[60:63],a[84:87],v[180:183]
 mf v[176:179],a[60:63],a[80:83],v[176:179]
 mf v[144:147],a[56:59],a[80:83],v[144:147]
 mf v[140:143],a[56:59],a[76:79],v[140:143]
 mf v[172:175],a[60:63],a[76:79],v[172:175]
 mf v[168:171],a[60:63],a[72:75],v[168:171]
 mf v[136:139],a[56:59],a[72:75],v[136:139]
 mf v[132:135],a[56:59],a[68:71],v[132:135]
 mf v[164:167],a[60:63],a[68:71],v[164:167]
 mf v[160:163],a[60:63],a[64:67],v[160:163]
 s_waitcnt lgkmcnt(0)
 s_nop 0
 mf v[128:131],a[56:59],a[64:67],v[128:131]
 mf v[64:67],a[0:3],a[16:19],v[64:67]
 rd a[64:67],v23,16384
 mf v[96:99],a[4:7],a[16:19],v[96:99]
 tr a[48:49],v14,57344
 mf v[100:103],a[4:7],a[20:23],v[100:103]
 tr a[50:51],v14,61440
 mf v[68:71],a[0:3],a[20:23],v[68:71]
 rd a[68:71],v23,17408
 mf v[72:75],a[0:3],a[24:27],v[72:75]
 mf v[104:107],a[4:7],a[24:27],v[104:107]
 tr a[52:53],v15,57344
 mf v[108:111],a[4:7],a[28:31],v[108:111]
 tr a[54:55],v15,61440
 mf v[76:79],a[0:3],a[28:31],v[76:79]
 rd a[72:75],v23,18432
 mf v[80:83],a[0:3],a[32:35],v[80:83]
 mf v[112:115],a[4:7],a[32:35],v[112:115]
 tr a[56:57],v16,57344
 mf v[116:119],a[4:7],a[36:39],v[116:119]
 tr a[58:59],v16,61440
 mf v[84:87],a[0:3],a[36:39],v[84:87]
 rd a[76:79],v23,19456
 mf v[88:91],a[0:3],a[40:43],v[88:91]
 mf v[120:123],a[4:7],a[40:43],v[120:123]
 tr a[60:61],v17,57344
 mf v[124:127],a[4:7],a[44:47],v[124:127]
 tr a[62:63],v17,61440
 mf v[92:95],a[0:3],a[44:47],v[92:95]
 rd a[80:83],v23,20480
 mf v[156:159],a[8:11],a[44:47],v[156:159]
 mf v[188:191],a[12:15],a[44:47],v[188:191]
 rd a[84:87],v23,21504
 mf v[184:187],a[12:15],a[40:43],v[184:187]
 rd a[88:91],v23,22528
 mf v[152:155],a[8:11],a[40:43],v[152:155]
 rd a[92:95],v23,23552
 mf v[148:151],a[8:11],a[36:39],v[148:151]
 mf v[180:183],a[12:15],a[36:39],v[180:183]
 mf v[176:179],a[12:15],a[32:35],v[176:179]
 mf v[144:147],a[8:11],a[32:35],v[144:147]
 mf v[140:143],a[8:11],a[28:31],v[140:143]
 mf v[172:175],a[12:15],a[28:31],v[172:175]
 mf v[168:171],a[12:15],a[24:27],v[168:171]
 mf v[136:139],a[8:11],a[24:27],v[136:139]
 mf v[132:135],a[8:11],a[20:23],v[132:135]
 mf v[164:167],a[12:15],a[20:23],v[164:167]
 mf v[160:163],a[12:15],a[16:19],v[160:163]
 s_waitcnt lgkmcnt(0)
 s_nop 0
 mf v[128:131],a[8:11],a[16:19],v[128:131]
 mf v[64:67],a[48:51],a[64:67],v[64:67]
 mf v[68:71],a[48:51],a[68:71],v[68:71]
 mf v[76:79],a[48:51],a[76:79],v[76:79]
 mf v[72:75],a[48:51],a[72:75],v[72:75]
 mf v[96:99],a[52:55],a[64:67],v[96:99]
 mf v[100:103],a[52:55],a[68:71],v[100:103]
 mf v[108:111],a[52:55],a[76:79],v[108:111]
 mf v[104:107],a[52:55],a[72:75],v[104:107]
 mf v[128:131],a[56:59],a[64:67],v[128:131]
 mf v[132:135],a[56:59],a[68:71],v[132:135]
 mf v[140:143],a[56:59],a[76:79],v[140:143]
 mf v[136:139],a[56:59],a[72:75],v[136:139]
 mf v[160:163],a[60:63],a[64:67],v[160:163]
 mf v[164:167],a[60:63],a[68:71],v[164:167]
 mf v[172:175],a[60:63],a[76:79],v[172:175]
 mf v[168:171],a[60:63],a[72:75],v[168:171]
 mf v[80:83],a[48:51],a[80:83],v[80:83]
 v_cvt_pk_bf16_f32 v192, v64, v65
 v_cvt_pk_bf16_f32 v193, v66, v67
 mf v[84:87],a[48:51],a[84:87],v[84:87]
 v_cvt_pk_bf16_f32 v194, v68, v69
 v_cvt_pk_bf16_f32 v195, v70, v71
 mf v[92:95],a[48:51],a[92:95],v[92:95]
 s_add_u32 s31, s87, 0
 s_nop 0
 buffer_store_dwordx4 v[192:195], v12, s[12:15], s31 offen offset:0 sc1
 v_cvt_pk_bf16_f32 v196, v72, v73
 v_cvt_pk_bf16_f32 v197, v74, v75
 mf v[88:91],a[48:51],a[88:91],v[88:91]
 v_cvt_pk_bf16_f32 v198, v76, v77
 v_cvt_pk_bf16_f32 v199, v78, v79
 mf v[112:115],a[52:55],a[80:83],v[112:115]
 buffer_store_dwordx4 v[196:199], v12, s[12:15], s31 offen offset:1024 sc1
 v_cvt_pk_bf16_f32 v200, v96, v97
 v_cvt_pk_bf16_f32 v201, v98, v99
 mf v[116:119],a[52:55],a[84:87],v[116:119]
 v_cvt_pk_bf16_f32 v202, v100, v101
 v_cvt_pk_bf16_f32 v203, v102, v103
 mf v[124:127],a[52:55],a[92:95],v[124:127]
 buffer_store_dwordx4 v[200:203], v12, s[12:15], s31 offen offset:2048 sc1
 v_cvt_pk_bf16_f32 v204, v104, v105
 v_cvt_pk_bf16_f32 v205, v106, v107
 mf v[120:123],a[52:55],a[88:91],v[120:123]
 v_cvt_pk_bf16_f32 v206, v108, v109
 v_cvt_pk_bf16_f32 v207, v110, v111
 mf v[144:147],a[56:59],a[80:83],v[144:147]
 buffer_store_dwordx4 v[204:207], v12, s[12:15], s31 offen offset:3072 sc1
 v_cvt_pk_bf16_f32 v208, v128, v129
 v_cvt_pk_bf16_f32 v209, v130, v131
 mf v[148:151],a[56:59],a[84:87],v[148:151]
 v_cvt_pk_bf16_f32 v210, v132, v133
 v_cvt_pk_bf16_f32 v211, v134, v135
 mf v[156:159],a[56:59],a[92:95],v[156:159]
 s_add_u32 s31, s87, 4096
 buffer_store_dwordx4 v[208:211], v12, s[12:15], s31 offen offset:0 sc1
 v_cvt_pk_bf16_f32 v212, v136, v137
 v_cvt_pk_bf16_f32 v213, v138, v139
 mf v[152:155],a[56:59],a[88:91],v[152:155]
 v_cvt_pk_bf16_f32 v214, v140, v141
 v_cvt_pk_bf16_f32 v215, v142, v143
 mf v[176:179],a[60:63],a[80:83],v[176:179]
 buffer_store_dwordx4 v[212:215], v12, s[12:15], s31 offen offset:1024 sc1
 v_cvt_pk_bf16_f32 v216, v160, v161
 v_cvt_pk_bf16_f32 v217, v162, v163
 mf v[180:183],a[60:63],a[84:87],v[180:183]
 v_cvt_pk_bf16_f32 v218, v164, v165
 v_cvt_pk_bf16_f32 v219, v166, v167
 mf v[188:191],a[60:63],a[92:95],v[188:191]
 buffer_store_dwordx4 v[216:219], v12, s[12:15], s31 offen offset:2048 sc1
 v_cvt_pk_bf16_f32 v220, v168, v169
 v_cvt_pk_bf16_f32 v221, v170, v171
 mf v[184:187],a[60:63],a[88:91],v[184:187]
 v_cvt_pk_bf16_f32 v222, v172, v173
 v_cvt_pk_bf16_f32 v223, v174, v175
 buffer_store_dwordx4 v[220:223], v12, s[12:15], s31 offen offset:3072 sc1
 s_nop 5
 s_nop 0
 v_cvt_pk_bf16_f32 v224, v80, v81
 v_cvt_pk_bf16_f32 v225, v82, v83
 v_cvt_pk_bf16_f32 v226, v84, v85
 v_cvt_pk_bf16_f32 v227, v86, v87
 s_add_u32 s31, s87, 16384
 buffer_store_dwordx4 v[224:227], v12, s[12:15], s31 offen offset:0 sc1
 v_cvt_pk_bf16_f32 v228, v88, v89
 v_cvt_pk_bf16_f32 v229, v90, v91
 v_cvt_pk_bf16_f32 v230, v92, v93
 v_cvt_pk_bf16_f32 v231, v94, v95
 buffer_store_dwordx4 v[228:231], v12, s[12:15], s31 offen offset:1024 sc1
 v_cvt_pk_bf16_f32 v232, v112, v113
 v_cvt_pk_bf16_f32 v233, v114, v115
 v_cvt_pk_bf16_f32 v234, v116, v117
 v_cvt_pk_bf16_f32 v235, v118, v119
 buffer_store_dwordx4 v[232:235], v12, s[12:15], s31 offen offset:2048 sc1
 v_cvt_pk_bf16_f32 v236, v120, v121
 v_cvt_pk_bf16_f32 v237, v122, v123
 v_cvt_pk_bf16_f32 v238, v124, v125
 v_cvt_pk_bf16_f32 v239, v126, v127
 buffer_store_dwordx4 v[236:239], v12, s[12:15], s31 offen offset:3072 sc1
 v_cvt_pk_bf16_f32 v240, v144, v145
 v_cvt_pk_bf16_f32 v241, v146, v147
 v_cvt_pk_bf16_f32 v242, v148, v149
 v_cvt_pk_bf16_f32 v243, v150, v151
 s_add_u32 s31, s87, 20480
 buffer_store_dwordx4 v[240:243], v12, s[12:15], s31 offen offset:0 sc1
 v_cvt_pk_bf16_f32 v244, v152, v153
 v_cvt_pk_bf16_f32 v245, v154, v155
 v_cvt_pk_bf16_f32 v246, v156, v157
 v_cvt_pk_bf16_f32 v247, v158, v159
 buffer_store_dwordx4 v[244:247], v12, s[12:15], s31 offen offset:1024 sc1
 v_cvt_pk_bf16_f32 v248, v176, v177
 v_cvt_pk_bf16_f32 v249, v178, v179
 v_cvt_pk_bf16_f32 v250, v180, v181
 v_cvt_pk_bf16_f32 v251, v182, v183
 buffer_store_dwordx4 v[248:251], v12, s[12:15], s31 offen offset:2048 sc1
 v_cvt_pk_bf16_f32 v252, v184, v185
 v_cvt_pk_bf16_f32 v253, v186, v187
 v_cvt_pk_bf16_f32 v254, v188, v189
 v_cvt_pk_bf16_f32 v255, v190, v191
 buffer_store_dwordx4 v[252:255], v12, s[12:15], s31 offen offset:3072 sc1
 s_waitcnt vmcnt(0)
 s_barrier
 s_cmp_lg_u32 s20, 0
 s_cbranch_scc1 L_sig_22
 s_mov_b64 exec, 1
 v_mov_b32 v5, 0
 v_mov_b32 v6, s36
 v_mov_b32 v7, s37
 buffer_store_dwordx2 v[6:7], v5, s[16:19], s86 offen sc1
 s_mov_b64 exec, -1
L_sig_22:
 s_getpc_b64 s[42:43]
L_far_23:
 s_add_u32 s42, s42, L_fin - L_far_23
 s_addc_u32 s43, s43, (L_fin - L_far_23) >> 32
 s_setpc_b64 s[42:43]
 s_branch L_skip_11190
.p2align 12
L_stub_wg_11190:
 s_branch L_stub_wg_13061
 s_nop 0
 s_nop 0
 s_nop 0
L_skip_11190:
.p2align 3
L_gm:
 s_barrier
 s_nop 0
 mf a[128:131],a[64:67],a[96:99],a[128:131]
 s_mov_b32 s12, s72
 s_nop 0
 mf a[160:163],a[68:71],a[96:99],a[160:163]
 s_mov_b32 s13, s73
 s_nop 0
 mf a[164:167],a[68:71],a[100:103],a[164:167]
 s_mov_b32 s14, 0x1000
 mf a[132:135],a[64:67],a[100:103],a[132:135]
 s_mov_b32 s15, 0x20000
 mf a[136:139],a[64:67],a[104:107],a[136:139]
 s_lshl_b32 s31, s23, 9
 s_nop 0
 mf a[168:171],a[68:71],a[104:107],a[168:171]
 s_lshl_b32 s25, s22, 8
 s_nop 0
 mf a[172:175],a[68:71],a[108:111],a[172:175]
 s_add_u32 s31, s31, s25
 s_nop 0
 mf a[140:143],a[64:67],a[108:111],a[140:143]
 buffer_load_ushort v28, v17, s[12:15], s31 offen offset:0
 mf a[144:147],a[64:67],a[112:115],a[144:147]
 buffer_load_ushort v29, v17, s[12:15], s31 offen offset:32
 mf a[176:179],a[68:71],a[112:115],a[176:179]
 buffer_load_ushort v30, v17, s[12:15], s31 offen offset:64
 mf a[180:183],a[68:71],a[116:119],a[180:183]
 mf a[148:151],a[64:67],a[116:119],a[148:151]
 mf a[152:155],a[64:67],a[120:123],a[152:155]
 mf a[184:187],a[68:71],a[120:123],a[184:187]
 buffer_load_ushort v31, v17, s[12:15], s31 offen offset:96
 mf a[188:191],a[68:71],a[124:127],a[188:191]
 mf a[156:159],a[64:67],a[124:127],a[156:159]
 mf a[220:223],a[72:75],a[124:127],a[220:223]
 mf a[252:255],a[76:79],a[124:127],a[252:255]
 buffer_load_ushort v32, v17, s[12:15], s31 offen offset:128
 mf a[248:251],a[76:79],a[120:123],a[248:251]
 mf a[216:219],a[72:75],a[120:123],a[216:219]
 mf a[212:215],a[72:75],a[116:119],a[212:215]
 mf a[244:247],a[76:79],a[116:119],a[244:247]
 buffer_load_ushort v33, v17, s[12:15], s31 offen offset:160
 mf a[240:243],a[76:79],a[112:115],a[240:243]
 mf a[208:211],a[72:75],a[112:115],a[208:211]
 mf a[204:207],a[72:75],a[108:111],a[204:207]
 buffer_load_ushort v34, v17, s[12:15], s31 offen offset:192
 mf a[236:239],a[76:79],a[108:111],a[236:239]
 mf a[232:235],a[76:79],a[104:107],a[232:235]
 mf a[200:203],a[72:75],a[104:107],a[200:203]
 mf a[196:199],a[72:75],a[100:103],a[196:199]
 buffer_load_ushort v35, v17, s[12:15], s31 offen offset:224
 mf a[228:231],a[76:79],a[100:103],a[228:231]
 s_mov_b32 s8, s70
 s_mov_b32 s9, s71
 s_mov_b32 s10, 0x800000
 mf a[224:227],a[76:79],a[96:99],a[224:227]
 s_mov_b32 s11, 0x20000
 s_lshl_b32 s28, s20, 13
 s_nop 0
 mf a[192:195],a[72:75],a[96:99],a[192:195]
 s_lshl_b32 s27, s23, 20
 s_mov_b32 s51, s27
 mf v[64:67],a[80:83],a[96:99],v[64:67]
 s_and_b32 s53, s23, 4
 s_lshl_b32 s53, s53, 2
 mf v[68:71],a[84:87],a[96:99],v[68:71]
 s_lshl_b32 s52, s53, 14
 s_lshl_b32 s53, s53, 7
 mf v[84:87],a[84:87],a[100:103],v[84:87]
 s_add_u32 s27, s27, s53
 s_nop 0
 s_mov_b32 s54, 0xbdd2d3e8
 mf v[80:83],a[80:83],a[100:103],v[80:83]
 s_mov_b32 s55, 0xbdd2d3e8
 s_add_u32 m0, s28, 16384
 mf v[96:99],a[80:83],a[104:107],v[96:99]
 buffer_load_dwordx4 v9, s[8:11], s27 offen offset:0 lds
 mf v[100:103],a[84:87],a[104:107],v[100:103]
 buffer_load_dwordx4 v10, s[8:11], s27 offen offset:1024 lds
 mf v[116:119],a[84:87],a[108:111],v[116:119]
 mf v[112:115],a[80:83],a[108:111],v[112:115]
 mf v[128:131],a[80:83],a[112:115],v[128:131]
 buffer_load_dwordx4 v11, s[8:11], s27 offen offset:2048 lds
 mf v[132:135],a[84:87],a[112:115],v[132:135]
 mf v[148:151],a[84:87],a[116:119],v[148:151]
 mf v[144:147],a[80:83],a[116:119],v[144:147]
 buffer_load_dwordx4 v12, s[8:11], s27 offen offset:3072 lds
 mf v[160:163],a[80:83],a[120:123],v[160:163]
 mf v[164:167],a[84:87],a[120:123],v[164:167]
 mf v[180:183],a[84:87],a[124:127],v[180:183]
 s_add_u32 m0, s28, 20480
 mf v[176:179],a[80:83],a[124:127],v[176:179]
 buffer_load_dwordx4 v13, s[8:11], s27 offen offset:0 lds
 mf v[184:187],a[88:91],a[124:127],v[184:187]
 mf v[188:191],a[92:95],a[124:127],v[188:191]
 mf v[172:175],a[92:95],a[120:123],v[172:175]
 mf v[168:171],a[88:91],a[120:123],v[168:171]
 buffer_load_dwordx4 v14, s[8:11], s27 offen offset:1024 lds
 mf v[152:155],a[88:91],a[116:119],v[152:155]
 mf v[156:159],a[92:95],a[116:119],v[156:159]
 mf v[140:143],a[92:95],a[112:115],v[140:143]
 mf v[136:139],a[88:91],a[112:115],v[136:139]
 buffer_load_dwordx4 v15, s[8:11], s27 offen offset:2048 lds
 mf v[120:123],a[88:91],a[108:111],v[120:123]
 mf v[124:127],a[92:95],a[108:111],v[124:127]
 mf v[108:111],a[92:95],a[104:107],v[108:111]
 mf v[104:107],a[88:91],a[104:107],v[104:107]
 buffer_load_dwordx4 v16, s[8:11], s27 offen offset:3072 lds
 mf v[88:91],a[88:91],a[100:103],v[88:91]
 s_add_u32 s53, s53, 128
 mf v[92:95],a[92:95],a[100:103],v[92:95]
 mf v[76:79],a[92:95],a[96:99],v[76:79]
 mf v[72:75],a[88:91],a[96:99],v[72:75]
 s_nop 7
 s_nop 0
 v_pk_mul_f32 v[60:61], v[64:65], v[64:65]
 v_pk_mul_f32 v[62:63], v[66:67], v[66:67]
 v_pk_fma_f32 v[60:61], v[60:61], s[54:55], v[58:59]
 v_pk_fma_f32 v[62:63], v[62:63], s[54:55], v[58:59]
 v_pk_mul_f32 v[60:61], v[60:61], v[64:65]
 v_pk_mul_f32 v[62:63], v[62:63], v[66:67]
 v_exp_f32 v60, v60
 v_exp_f32 v61, v61
 v_exp_f32 v62, v62
 v_exp_f32 v63, v63
 v_pk_add_f32 v[60:61], v[60:61], 1.0 op_sel_hi:[1,0]
 v_pk_add_f32 v[62:63], v[62:63], 1.0 op_sel_hi:[1,0]
 v_rcp_f32 v60, v60
 v_rcp_f32 v61, v61
 v_rcp_f32 v62, v62
 v_rcp_f32 v63, v63
 v_pk_mul_f32 v[64:65], v[64:65], v[60:61]
 v_pk_mul_f32 v[66:67], v[66:67], v[62:63]
 v_pk_mul_f32 v[194:195], v[64:65], v[64:65]
 v_pk_add_f32 v[192:193], v[64:65], v[66:67]
 v_pk_fma_f32 v[194:195], v[66:67], v[66:67], v[194:195]
 s_and_b32 s53, s53, 0xfff
 v_pk_mul_f32 v[60:61], v[68:69], v[68:69]
 v_pk_mul_f32 v[62:63], v[70:71], v[70:71]
 v_pk_fma_f32 v[60:61], v[60:61], s[54:55], v[58:59]
 v_pk_fma_f32 v[62:63], v[62:63], s[54:55], v[58:59]
 v_pk_mul_f32 v[60:61], v[60:61], v[68:69]
 v_pk_mul_f32 v[62:63], v[62:63], v[70:71]
 v_exp_f32 v60, v60
 v_exp_f32 v61, v61
 v_exp_f32 v62, v62
 v_exp_f32 v63, v63
 v_pk_add_f32 v[60:61], v[60:61], 1.0 op_sel_hi:[1,0]
 v_pk_add_f32 v[62:63], v[62:63], 1.0 op_sel_hi:[1,0]
 v_rcp_f32 v60, v60
 v_rcp_f32 v61, v61
 v_rcp_f32 v62, v62
 v_rcp_f32 v63, v63
 v_pk_mul_f32 v[68:69], v[68:69], v[60:61]
 v_pk_mul_f32 v[70:71], v[70:71], v[62:63]
 v_pk_add_f32 v[192:193], v[192:193], v[68:69]
 v_pk_fma_f32 v[194:195], v[68:69], v[68:69], v[194:195]
 v_pk_add_f32 v[192:193], v[192:193], v[70:71]
 v_pk_fma_f32 v[194:195], v[70:71], v[70:71], v[194:195]
 s_add_u32 s27, s51, s53
 s_nop 0
 v_pk_mul_f32 v[60:61], v[72:73], v[72:73]
 v_pk_mul_f32 v[62:63], v[74:75], v[74:75]
 v_pk_fma_f32 v[60:61], v[60:61], s[54:55], v[58:59]
 v_pk_fma_f32 v[62:63], v[62:63], s[54:55], v[58:59]
 v_pk_mul_f32 v[60:61], v[60:61], v[72:73]
 v_pk_mul_f32 v[62:63], v[62:63], v[74:75]
 v_exp_f32 v60, v60
 v_exp_f32 v61, v61
 v_exp_f32 v62, v62
 v_exp_f32 v63, v63
 v_pk_add_f32 v[60:61], v[60:61], 1.0 op_sel_hi:[1,0]
 v_pk_add_f32 v[62:63], v[62:63], 1.0 op_sel_hi:[1,0]
 v_rcp_f32 v60, v60
 v_rcp_f32 v61, v61
 v_rcp_f32 v62, v62
 v_rcp_f32 v63, v63
 v_pk_mul_f32 v[72:73], v[72:73], v[60:61]
 v_pk_mul_f32 v[74:75], v[74:75], v[62:63]
 v_pk_add_f32 v[192:193], v[192:193], v[72:73]
 v_pk_fma_f32 v[194:195], v[72:73], v[72:73], v[194:195]
 v_pk_add_f32 v[192:193], v[192:193], v[74:75]
 v_pk_fma_f32 v[194:195], v[74:75], v[74:75], v[194:195]
 s_add_u32 m0, s28, 65536
 v_pk_mul_f32 v[60:61], v[76:77], v[76:77]
 v_pk_mul_f32 v[62:63], v[78:79], v[78:79]
 v_pk_fma_f32 v[60:61], v[60:61], s[54:55], v[58:59]
 v_pk_fma_f32 v[62:63], v[62:63], s[54:55], v[58:59]
 v_pk_mul_f32 v[60:61], v[60:61], v[76:77]
 v_pk_mul_f32 v[62:63], v[62:63], v[78:79]
 v_exp_f32 v60, v60
 v_exp_f32 v61, v61
 v_exp_f32 v62, v62
 v_exp_f32 v63, v63
 v_pk_add_f32 v[60:61], v[60:61], 1.0 op_sel_hi:[1,0]
 v_pk_add_f32 v[62:63], v[62:63], 1.0 op_sel_hi:[1,0]
 v_rcp_f32 v60, v60
 v_rcp_f32 v61, v61
 v_rcp_f32 v62, v62
 v_rcp_f32 v63, v63
 v_pk_mul_f32 v[76:77], v[76:77], v[60:61]
 v_pk_mul_f32 v[78:79], v[78:79], v[62:63]
 v_pk_add_f32 v[192:193], v[192:193], v[76:77]
 v_pk_fma_f32 v[194:195], v[76:77], v[76:77], v[194:195]
 v_pk_add_f32 v[192:193], v[192:193], v[78:79]
 v_pk_fma_f32 v[194:195], v[78:79], v[78:79], v[194:195]
 buffer_load_dwordx4 v9, s[8:11], s27 offen offset:0 lds
 v_pk_mul_f32 v[60:61], v[80:81], v[80:81]
 v_pk_mul_f32 v[62:63], v[82:83], v[82:83]
 v_pk_fma_f32 v[60:61], v[60:61], s[54:55], v[58:59]
 v_pk_fma_f32 v[62:63], v[62:63], s[54:55], v[58:59]
 v_pk_mul_f32 v[60:61], v[60:61], v[80:81]
 v_pk_mul_f32 v[62:63], v[62:63], v[82:83]
 v_exp_f32 v60, v60
 v_exp_f32 v61, v61
 v_exp_f32 v62, v62
 v_exp_f32 v63, v63
 v_pk_add_f32 v[60:61], v[60:61], 1.0 op_sel_hi:[1,0]
 v_pk_add_f32 v[62:63], v[62:63], 1.0 op_sel_hi:[1,0]
 v_rcp_f32 v60, v60
 v_rcp_f32 v61, v61
 v_rcp_f32 v62, v62
 v_rcp_f32 v63, v63
 v_pk_mul_f32 v[80:81], v[80:81], v[60:61]
 v_pk_mul_f32 v[82:83], v[82:83], v[62:63]
 v_pk_mul_f32 v[198:199], v[80:81], v[80:81]
 v_pk_add_f32 v[196:197], v[80:81], v[82:83]
 v_pk_fma_f32 v[198:199], v[82:83], v[82:83], v[198:199]
 buffer_load_dwordx4 v10, s[8:11], s27 offen offset:1024 lds
 v_pk_mul_f32 v[60:61], v[84:85], v[84:85]
 v_pk_mul_f32 v[62:63], v[86:87], v[86:87]
 v_pk_fma_f32 v[60:61], v[60:61], s[54:55], v[58:59]
 v_pk_fma_f32 v[62:63], v[62:63], s[54:55], v[58:59]
 v_pk_mul_f32 v[60:61], v[60:61], v[84:85]
 v_pk_mul_f32 v[62:63], v[62:63], v[86:87]
 v_exp_f32 v60, v60
 v_exp_f32 v61, v61
 v_exp_f32 v62, v62
 v_exp_f32 v63, v63
 v_pk_add_f32 v[60:61], v[60:61], 1.0 op_sel_hi:[1,0]
 v_pk_add_f32 v[62:63], v[62:63], 1.0 op_sel_hi:[1,0]
 v_rcp_f32 v60, v60
 v_rcp_f32 v61, v61
 v_rcp_f32 v62, v62
 v_rcp_f32 v63, v63
 v_pk_mul_f32 v[84:85], v[84:85], v[60:61]
 v_pk_mul_f32 v[86:87], v[86:87], v[62:63]
 v_pk_add_f32 v[196:197], v[196:197], v[84:85]
 v_pk_fma_f32 v[198:199], v[84:85], v[84:85], v[198:199]
 v_pk_add_f32 v[196:197], v[196:197], v[86:87]
 v_pk_fma_f32 v[198:199], v[86:87], v[86:87], v[198:199]
 buffer_load_dwordx4 v11, s[8:11], s27 offen offset:2048 lds
 v_pk_mul_f32 v[60:61], v[88:89], v[88:89]
 v_pk_mul_f32 v[62:63], v[90:91], v[90:91]
 v_pk_fma_f32 v[60:61], v[60:61], s[54:55], v[58:59]
 v_pk_fma_f32 v[62:63], v[62:63], s[54:55], v[58:59]
 v_pk_mul_f32 v[60:61], v[60:61], v[88:89]
 v_pk_mul_f32 v[62:63], v[62:63], v[90:91]
 v_exp_f32 v60, v60
 v_exp_f32 v61, v61
 v_exp_f32 v62, v62
 v_exp_f32 v63, v63
 v_pk_add_f32 v[60:61], v[60:61], 1.0 op_sel_hi:[1,0]
 v_pk_add_f32 v[62:63], v[62:63], 1.0 op_sel_hi:[1,0]
 v_rcp_f32 v60, v60
 v_rcp_f32 v61, v61
 v_rcp_f32 v62, v62
 v_rcp_f32 v63, v63
 v_pk_mul_f32 v[88:89], v[88:89], v[60:61]
 v_pk_mul_f32 v[90:91], v[90:91], v[62:63]
 v_pk_add_f32 v[196:197], v[196:197], v[88:89]
 v_pk_fma_f32 v[198:199], v[88:89], v[88:89], v[198:199]
 v_pk_add_f32 v[196:197], v[196:197], v[90:91]
 v_pk_fma_f32 v[198:199], v[90:91], v[90:91], v[198:199]
 buffer_load_dwordx4 v12, s[8:11], s27 offen offset:3072 lds
 v_pk_mul_f32 v[60:61], v[92:93], v[92:93]
 v_pk_mul_f32 v[62:63], v[94:95], v[94:95]
 v_pk_fma_f32 v[60:61], v[60:61], s[54:55], v[58:59]
 v_pk_fma_f32 v[62:63], v[62:63], s[54:55], v[58:59]
 v_pk_mul_f32 v[60:61], v[60:61], v[92:93]
 v_pk_mul_f32 v[62:63], v[62:63], v[94:95]
 v_exp_f32 v60, v60
 v_exp_f32 v61, v61
 v_exp_f32 v62, v62
 v_exp_f32 v63, v63
 v_pk_add_f32 v[60:61], v[60:61], 1.0 op_sel_hi:[1,0]
 v_pk_add_f32 v[62:63], v[62:63], 1.0 op_sel_hi:[1,0]
 v_rcp_f32 v60, v60
 v_rcp_f32 v61, v61
 v_rcp_f32 v62, v62
 v_rcp_f32 v63, v63
 v_pk_mul_f32 v[92:93], v[92:93], v[60:61]
 v_pk_mul_f32 v[94:95], v[94:95], v[62:63]
 v_pk_add_f32 v[196:197], v[196:197], v[92:93]
 v_pk_fma_f32 v[198:199], v[92:93], v[92:93], v[198:199]
 v_pk_add_f32 v[196:197], v[196:197], v[94:95]
 v_pk_fma_f32 v[198:199], v[94:95], v[94:95], v[198:199]
 s_add_u32 m0, s28, 69632
 v_pk_mul_f32 v[60:61], v[96:97], v[96:97]
 v_pk_mul_f32 v[62:63], v[98:99], v[98:99]
 v_pk_fma_f32 v[60:61], v[60:61], s[54:55], v[58:59]
 v_pk_fma_f32 v[62:63], v[62:63], s[54:55], v[58:59]
 v_pk_mul_f32 v[60:61], v[60:61], v[96:97]
 v_pk_mul_f32 v[62:63], v[62:63], v[98:99]
 v_exp_f32 v60, v60
 v_exp_f32 v61, v61
 v_exp_f32 v62, v62
 v_exp_f32 v63, v63
 v_pk_add_f32 v[60:61], v[60:61], 1.0 op_sel_hi:[1,0]
 v_pk_add_f32 v[62:63], v[62:63], 1.0 op_sel_hi:[1,0]
 v_rcp_f32 v60, v60
 v_rcp_f32 v61, v61
 v_rcp_f32 v62, v62
 v_rcp_f32 v63, v63
 v_pk_mul_f32 v[96:97], v[96:97], v[60:61]
 v_pk_mul_f32 v[98:99], v[98:99], v[62:63]
 v_pk_mul_f32 v[202:203], v[96:97], v[96:97]
 v_pk_add_f32 v[200:201], v[96:97], v[98:99]
 v_pk_fma_f32 v[202:203], v[98:99], v[98:99], v[202:203]
 buffer_load_dwordx4 v13, s[8:11], s27 offen offset:0 lds
 v_pk_mul_f32 v[60:61], v[100:101], v[100:101]
 v_pk_mul_f32 v[62:63], v[102:103], v[102:103]
 v_pk_fma_f32 v[60:61], v[60:61], s[54:55], v[58:59]
 v_pk_fma_f32 v[62:63], v[62:63], s[54:55], v[58:59]
 v_pk_mul_f32 v[60:61], v[60:61], v[100:101]
 v_pk_mul_f32 v[62:63], v[62:63], v[102:103]
 v_exp_f32 v60, v60
 v_exp_f32 v61, v61
 v_exp_f32 v62, v62
 v_exp_f32 v63, v63
 v_pk_add_f32 v[60:61], v[60:61], 1.0 op_sel_hi:[1,0]
 v_pk_add_f32 v[62:63], v[62:63], 1.0 op_sel_hi:[1,0]
 v_rcp_f32 v60, v60
 v_rcp_f32 v61, v61
 v_rcp_f32 v62, v62
 v_rcp_f32 v63, v63
 v_pk_mul_f32 v[100:101], v[100:101], v[60:61]
 v_pk_mul_f32 v[102:103], v[102:103], v[62:63]
 v_pk_add_f32 v[200:201], v[200:201], v[100:101]
 v_pk_fma_f32 v[202:203], v[100:101], v[100:101], v[202:203]
 v_pk_add_f32 v[200:201], v[200:201], v[102:103]
 v_pk_fma_f32 v[202:203], v[102:103], v[102:103], v[202:203]
 buffer_load_dwordx4 v14, s[8:11], s27 offen offset:1024 lds
 v_pk_mul_f32 v[60:61], v[104:105], v[104:105]
 v_pk_mul_f32 v[62:63], v[106:107], v[106:107]
 v_pk_fma_f32 v[60:61], v[60:61], s[54:55], v[58:59]
 v_pk_fma_f32 v[62:63], v[62:63], s[54:55], v[58:59]
 v_pk_mul_f32 v[60:61], v[60:61], v[104:105]
 v_pk_mul_f32 v[62:63], v[62:63], v[106:107]
 v_exp_f32 v60, v60
 v_exp_f32 v61, v61
 v_exp_f32 v62, v62
 v_exp_f32 v63, v63
 v_pk_add_f32 v[60:61], v[60:61], 1.0 op_sel_hi:[1,0]
 v_pk_add_f32 v[62:63], v[62:63], 1.0 op_sel_hi:[1,0]
 v_rcp_f32 v60, v60
 v_rcp_f32 v61, v61
 v_rcp_f32 v62, v62
 v_rcp_f32 v63, v63
 v_pk_mul_f32 v[104:105], v[104:105], v[60:61]
 v_pk_mul_f32 v[106:107], v[106:107], v[62:63]
 v_pk_add_f32 v[200:201], v[200:201], v[104:105]
 v_pk_fma_f32 v[202:203], v[104:105], v[104:105], v[202:203]
 v_pk_add_f32 v[200:201], v[200:201], v[106:107]
 v_pk_fma_f32 v[202:203], v[106:107], v[106:107], v[202:203]
 buffer_load_dwordx4 v15, s[8:11], s27 offen offset:2048 lds
 v_pk_mul_f32 v[60:61], v[108:109], v[108:109]
 v_pk_mul_f32 v[62:63], v[110:111], v[110:111]
 v_pk_fma_f32 v[60:61], v[60:61], s[54:55], v[58:59]
 v_pk_fma_f32 v[62:63], v[62:63], s[54:55], v[58:59]
 v_pk_mul_f32 v[60:61], v[60:61], v[108:109]
 v_pk_mul_f32 v[62:63], v[62:63], v[110:111]
 v_exp_f32 v60, v60
 v_exp_f32 v61, v61
 v_exp_f32 v62, v62
 v_exp_f32 v63, v63
 v_pk_add_f32 v[60:61], v[60:61], 1.0 op_sel_hi:[1,0]
 v_pk_add_f32 v[62:63], v[62:63], 1.0 op_sel_hi:[1,0]
 v_rcp_f32 v60, v60
 v_rcp_f32 v61, v61
 v_rcp_f32 v62, v62
 v_rcp_f32 v63, v63
 v_pk_mul_f32 v[108:109], v[108:109], v[60:61]
 v_pk_mul_f32 v[110:111], v[110:111], v[62:63]
 v_pk_add_f32 v[200:201], v[200:201], v[108:109]
 v_pk_fma_f32 v[202:203], v[108:109], v[108:109], v[202:203]
 v_pk_add_f32 v[200:201], v[200:201], v[110:111]
 v_pk_fma_f32 v[202:203], v[110:111], v[110:111], v[202:203]
 buffer_load_dwordx4 v16, s[8:11], s27 offen offset:3072 lds
 v_pk_mul_f32 v[60:61], v[112:113], v[112:113]
 v_pk_mul_f32 v[62:63], v[114:115], v[114:115]
 v_pk_fma_f32 v[60:61], v[60:61], s[54:55], v[58:59]
 v_pk_fma_f32 v[62:63], v[62:63], s[54:55], v[58:59]
 v_pk_mul_f32 v[60:61], v[60:61], v[112:113]
 v_pk_mul_f32 v[62:63], v[62:63], v[114:115]
 v_exp_f32 v60, v60
 v_exp_f32 v61, v61
 v_exp_f32 v62, v62
 v_exp_f32 v63, v63
 v_pk_add_f32 v[60:61], v[60:61], 1.0 op_sel_hi:[1,0]
 v_pk_add_f32 v[62:63], v[62:63], 1.0 op_sel_hi:[1,0]
 v_rcp_f32 v60, v60
 v_rcp_f32 v61, v61
 v_rcp_f32 v62, v62
 v_rcp_f32 v63, v63
 v_pk_mul_f32 v[112:113], v[112:113], v[60:61]
 v_pk_mul_f32 v[114:115], v[114:115], v[62:63]
 v_pk_mul_f32 v[206:207], v[112:113], v[112:113]
 v_pk_add_f32 v[204:205], v[112:113], v[114:115]
 v_pk_fma_f32 v[206:207], v[114:115], v[114:115], v[206:207]
 s_add_u32 s53, s53, 128
 v_pk_mul_f32 v[60:61], v[116:117], v[116:117]
 v_pk_mul_f32 v[62:63], v[118:119], v[118:119]
 v_pk_fma_f32 v[60:61], v[60:61], s[54:55], v[58:59]
 v_pk_fma_f32 v[62:63], v[62:63], s[54:55], v[58:59]
 v_pk_mul_f32 v[60:61], v[60:61], v[116:117]
 v_pk_mul_f32 v[62:63], v[62:63], v[118:119]
 v_exp_f32 v60, v60
 v_exp_f32 v61, v61
 v_exp_f32 v62, v62
 v_exp_f32 v63, v63
 v_pk_add_f32 v[60:61], v[60:61], 1.0 op_sel_hi:[1,0]
 v_pk_add_f32 v[62:63], v[62:63], 1.0 op_sel_hi:[1,0]
 v_rcp_f32 v60, v60
 v_rcp_f32 v61, v61
 v_rcp_f32 v62, v62
 v_rcp_f32 v63, v63
 v_pk_mul_f32 v[116:117], v[116:117], v[60:61]
 v_pk_mul_f32 v[118:119], v[118:119], v[62:63]
 v_pk_add_f32 v[204:205], v[204:205], v[116:117]
 v_pk_fma_f32 v[206:207], v[116:117], v[116:117], v[206:207]
 v_pk_add_f32 v[204:205], v[204:205], v[118:119]
 v_pk_fma_f32 v[206:207], v[118:119], v[118:119], v[206:207]
 s_and_b32 s53, s53, 0xfff
 v_pk_mul_f32 v[60:61], v[120:121], v[120:121]
 v_pk_mul_f32 v[62:63], v[122:123], v[122:123]
 v_pk_fma_f32 v[60:61], v[60:61], s[54:55], v[58:59]
 v_pk_fma_f32 v[62:63], v[62:63], s[54:55], v[58:59]
 v_pk_mul_f32 v[60:61], v[60:61], v[120:121]
 v_pk_mul_f32 v[62:63], v[62:63], v[122:123]
 v_exp_f32 v60, v60
 v_exp_f32 v61, v61
 v_exp_f32 v62, v62
 v_exp_f32 v63, v63
 v_pk_add_f32 v[60:61], v[60:61], 1.0 op_sel_hi:[1,0]
 v_pk_add_f32 v[62:63], v[62:63], 1.0 op_sel_hi:[1,0]
 v_rcp_f32 v60, v60
 v_rcp_f32 v61, v61
 v_rcp_f32 v62, v62
 v_rcp_f32 v63, v63
 v_pk_mul_f32 v[120:121], v[120:121], v[60:61]
 v_pk_mul_f32 v[122:123], v[122:123], v[62:63]
 v_pk_add_f32 v[204:205], v[204:205], v[120:121]
 v_pk_fma_f32 v[206:207], v[120:121], v[120:121], v[206:207]
 v_pk_add_f32 v[204:205], v[204:205], v[122:123]
 v_pk_fma_f32 v[206:207], v[122:123], v[122:123], v[206:207]
 v_pk_mul_f32 v[60:61], v[124:125], v[124:125]
 v_pk_mul_f32 v[62:63], v[126:127], v[126:127]
 v_pk_fma_f32 v[60:61], v[60:61], s[54:55], v[58:59]
 v_pk_fma_f32 v[62:63], v[62:63], s[54:55], v[58:59]
 v_pk_mul_f32 v[60:61], v[60:61], v[124:125]
 v_pk_mul_f32 v[62:63], v[62:63], v[126:127]
 v_exp_f32 v60, v60
 v_exp_f32 v61, v61
 v_exp_f32 v62, v62
 v_exp_f32 v63, v63
 v_pk_add_f32 v[60:61], v[60:61], 1.0 op_sel_hi:[1,0]
 v_pk_add_f32 v[62:63], v[62:63], 1.0 op_sel_hi:[1,0]
 v_rcp_f32 v60, v60
 v_rcp_f32 v61, v61
 v_rcp_f32 v62, v62
 v_rcp_f32 v63, v63
 v_pk_mul_f32 v[124:125], v[124:125], v[60:61]
 v_pk_mul_f32 v[126:127], v[126:127], v[62:63]
 v_pk_add_f32 v[204:205], v[204:205], v[124:125]
 v_pk_fma_f32 v[206:207], v[124:125], v[124:125], v[206:207]
 v_pk_add_f32 v[204:205], v[204:205], v[126:127]
 v_pk_fma_f32 v[206:207], v[126:127], v[126:127], v[206:207]
 s_add_u32 s27, s51, s53
 s_nop 0
 v_pk_mul_f32 v[60:61], v[128:129], v[128:129]
 v_pk_mul_f32 v[62:63], v[130:131], v[130:131]
 v_pk_fma_f32 v[60:61], v[60:61], s[54:55], v[58:59]
 v_pk_fma_f32 v[62:63], v[62:63], s[54:55], v[58:59]
 v_pk_mul_f32 v[60:61], v[60:61], v[128:129]
 v_pk_mul_f32 v[62:63], v[62:63], v[130:131]
 v_exp_f32 v60, v60
 v_exp_f32 v61, v61
 v_exp_f32 v62, v62
 v_exp_f32 v63, v63
 v_pk_add_f32 v[60:61], v[60:61], 1.0 op_sel_hi:[1,0]
 v_pk_add_f32 v[62:63], v[62:63], 1.0 op_sel_hi:[1,0]
 v_rcp_f32 v60, v60
 v_rcp_f32 v61, v61
 v_rcp_f32 v62, v62
 v_rcp_f32 v63, v63
 v_pk_mul_f32 v[128:129], v[128:129], v[60:61]
 v_pk_mul_f32 v[130:131], v[130:131], v[62:63]
 v_pk_mul_f32 v[210:211], v[128:129], v[128:129]
 v_pk_add_f32 v[208:209], v[128:129], v[130:131]
 v_pk_fma_f32 v[210:211], v[130:131], v[130:131], v[210:211]
 s_add_u32 m0, s28, 114688
 v_pk_mul_f32 v[60:61], v[132:133], v[132:133]
 v_pk_mul_f32 v[62:63], v[134:135], v[134:135]
 v_pk_fma_f32 v[60:61], v[60:61], s[54:55], v[58:59]
 v_pk_fma_f32 v[62:63], v[62:63], s[54:55], v[58:59]
 v_pk_mul_f32 v[60:61], v[60:61], v[132:133]
 v_pk_mul_f32 v[62:63], v[62:63], v[134:135]
 v_exp_f32 v60, v60
 v_exp_f32 v61, v61
 v_exp_f32 v62, v62
 v_exp_f32 v63, v63
 v_pk_add_f32 v[60:61], v[60:61], 1.0 op_sel_hi:[1,0]
 v_pk_add_f32 v[62:63], v[62:63], 1.0 op_sel_hi:[1,0]
 v_rcp_f32 v60, v60
 v_rcp_f32 v61, v61
 v_rcp_f32 v62, v62
 v_rcp_f32 v63, v63
 v_pk_mul_f32 v[132:133], v[132:133], v[60:61]
 v_pk_mul_f32 v[134:135], v[134:135], v[62:63]
 v_pk_add_f32 v[208:209], v[208:209], v[132:133]
 v_pk_fma_f32 v[210:211], v[132:133], v[132:133], v[210:211]
 v_pk_add_f32 v[208:209], v[208:209], v[134:135]
 v_pk_fma_f32 v[210:211], v[134:135], v[134:135], v[210:211]
 buffer_load_dwordx4 v9, s[8:11], s27 offen offset:0 lds
 v_pk_mul_f32 v[60:61], v[136:137], v[136:137]
 v_pk_mul_f32 v[62:63], v[138:139], v[138:139]
 v_pk_fma_f32 v[60:61], v[60:61], s[54:55], v[58:59]
 v_pk_fma_f32 v[62:63], v[62:63], s[54:55], v[58:59]
 v_pk_mul_f32 v[60:61], v[60:61], v[136:137]
 v_pk_mul_f32 v[62:63], v[62:63], v[138:139]
 v_exp_f32 v60, v60
 v_exp_f32 v61, v61
 v_exp_f32 v62, v62
 v_exp_f32 v63, v63
 v_pk_add_f32 v[60:61], v[60:61], 1.0 op_sel_hi:[1,0]
 v_pk_add_f32 v[62:63], v[62:63], 1.0 op_sel_hi:[1,0]
 v_rcp_f32 v60, v60
 v_rcp_f32 v61, v61
 v_rcp_f32 v62, v62
 v_rcp_f32 v63, v63
 v_pk_mul_f32 v[136:137], v[136:137], v[60:61]
 v_pk_mul_f32 v[138:139], v[138:139], v[62:63]
 v_pk_add_f32 v[208:209], v[208:209], v[136:137]
 v_pk_fma_f32 v[210:211], v[136:137], v[136:137], v[210:211]
 v_pk_add_f32 v[208:209], v[208:209], v[138:139]
 v_pk_fma_f32 v[210:211], v[138:139], v[138:139], v[210:211]
 buffer_load_dwordx4 v10, s[8:11], s27 offen offset:1024 lds
 v_pk_mul_f32 v[60:61], v[140:141], v[140:141]
 v_pk_mul_f32 v[62:63], v[142:143], v[142:143]
 v_pk_fma_f32 v[60:61], v[60:61], s[54:55], v[58:59]
 v_pk_fma_f32 v[62:63], v[62:63], s[54:55], v[58:59]
 v_pk_mul_f32 v[60:61], v[60:61], v[140:141]
 v_pk_mul_f32 v[62:63], v[62:63], v[142:143]
 v_exp_f32 v60, v60
 v_exp_f32 v61, v61
 v_exp_f32 v62, v62
 v_exp_f32 v63, v63
 v_pk_add_f32 v[60:61], v[60:61], 1.0 op_sel_hi:[1,0]
 v_pk_add_f32 v[62:63], v[62:63], 1.0 op_sel_hi:[1,0]
 v_rcp_f32 v60, v60
 v_rcp_f32 v61, v61
 v_rcp_f32 v62, v62
 v_rcp_f32 v63, v63
 v_pk_mul_f32 v[140:141], v[140:141], v[60:61]
 v_pk_mul_f32 v[142:143], v[142:143], v[62:63]
 v_pk_add_f32 v[208:209], v[208:209], v[140:141]
 v_pk_fma_f32 v[210:211], v[140:141], v[140:141], v[210:211]
 v_pk_add_f32 v[208:209], v[208:209], v[142:143]
 v_pk_fma_f32 v[210:211], v[142:143], v[142:143], v[210:211]
 buffer_load_dwordx4 v11, s[8:11], s27 offen offset:2048 lds
 v_pk_mul_f32 v[60:61], v[144:145], v[144:145]
 v_pk_mul_f32 v[62:63], v[146:147], v[146:147]
 v_pk_fma_f32 v[60:61], v[60:61], s[54:55], v[58:59]
 v_pk_fma_f32 v[62:63], v[62:63], s[54:55], v[58:59]
 v_pk_mul_f32 v[60:61], v[60:61], v[144:145]
 v_pk_mul_f32 v[62:63], v[62:63], v[146:147]
 v_exp_f32 v60, v60
 v_exp_f32 v61, v61
 v_exp_f32 v62, v62
 v_exp_f32 v63, v63
 v_pk_add_f32 v[60:61], v[60:61], 1.0 op_sel_hi:[1,0]
 v_pk_add_f32 v[62:63], v[62:63], 1.0 op_sel_hi:[1,0]
 v_rcp_f32 v60, v60
 v_rcp_f32 v61, v61
 v_rcp_f32 v62, v62
 v_rcp_f32 v63, v63
 v_pk_mul_f32 v[144:145], v[144:145], v[60:61]
 v_pk_mul_f32 v[146:147], v[146:147], v[62:63]
 v_pk_mul_f32 v[214:215], v[144:145], v[144:145]
 v_pk_add_f32 v[212:213], v[144:145], v[146:147]
 v_pk_fma_f32 v[214:215], v[146:147], v[146:147], v[214:215]
 buffer_load_dwordx4 v12, s[8:11], s27 offen offset:3072 lds
 v_pk_mul_f32 v[60:61], v[148:149], v[148:149]
 v_pk_mul_f32 v[62:63], v[150:151], v[150:151]
 v_pk_fma_f32 v[60:61], v[60:61], s[54:55], v[58:59]
 v_pk_fma_f32 v[62:63], v[62:63], s[54:55], v[58:59]
 v_pk_mul_f32 v[60:61], v[60:61], v[148:149]
 v_pk_mul_f32 v[62:63], v[62:63], v[150:151]
 v_exp_f32 v60, v60
 v_exp_f32 v61, v61
 v_exp_f32 v62, v62
 v_exp_f32 v63, v63
 v_pk_add_f32 v[60:61], v[60:61], 1.0 op_sel_hi:[1,0]
 v_pk_add_f32 v[62:63], v[62:63], 1.0 op_sel_hi:[1,0]
 v_rcp_f32 v60, v60
 v_rcp_f32 v61, v61
 v_rcp_f32 v62, v62
 v_rcp_f32 v63, v63
 v_pk_mul_f32 v[148:149], v[148:149], v[60:61]
 v_pk_mul_f32 v[150:151], v[150:151], v[62:63]
 v_pk_add_f32 v[212:213], v[212:213], v[148:149]
 s_branch L_skip_11805
.p2align 12
L_stub_wg_11805:
 s_branch L_stub_wg_13604
 s_nop 0
 s_nop 0
 s_nop 0
L_skip_11805:
 v_pk_fma_f32 v[214:215], v[148:149], v[148:149], v[214:215]
 v_pk_add_f32 v[212:213], v[212:213], v[150:151]
 v_pk_fma_f32 v[214:215], v[150:151], v[150:151], v[214:215]
 s_add_u32 m0, s28, 118784
 v_pk_mul_f32 v[60:61], v[152:153], v[152:153]
 v_pk_mul_f32 v[62:63], v[154:155], v[154:155]
 v_pk_fma_f32 v[60:61], v[60:61], s[54:55], v[58:59]
 v_pk_fma_f32 v[62:63], v[62:63], s[54:55], v[58:59]
 v_pk_mul_f32 v[60:61], v[60:61], v[152:153]
 v_pk_mul_f32 v[62:63], v[62:63], v[154:155]
 v_exp_f32 v60, v60
 v_exp_f32 v61, v61
 v_exp_f32 v62, v62
 v_exp_f32 v63, v63
 v_pk_add_f32 v[60:61], v[60:61], 1.0 op_sel_hi:[1,0]
 v_pk_add_f32 v[62:63], v[62:63], 1.0 op_sel_hi:[1,0]
 v_rcp_f32 v60, v60
 v_rcp_f32 v61, v61
 v_rcp_f32 v62, v62
 v_rcp_f32 v63, v63
 v_pk_mul_f32 v[152:153], v[152:153], v[60:61]
 v_pk_mul_f32 v[154:155], v[154:155], v[62:63]
 v_pk_add_f32 v[212:213], v[212:213], v[152:153]
 v_pk_fma_f32 v[214:215], v[152:153], v[152:153], v[214:215]
 v_pk_add_f32 v[212:213], v[212:213], v[154:155]
 v_pk_fma_f32 v[214:215], v[154:155], v[154:155], v[214:215]
 buffer_load_dwordx4 v13, s[8:11], s27 offen offset:0 lds
 v_pk_mul_f32 v[60:61], v[156:157], v[156:157]
 v_pk_mul_f32 v[62:63], v[158:159], v[158:159]
 v_pk_fma_f32 v[60:61], v[60:61], s[54:55], v[58:59]
 v_pk_fma_f32 v[62:63], v[62:63], s[54:55], v[58:59]
 v_pk_mul_f32 v[60:61], v[60:61], v[156:157]
 v_pk_mul_f32 v[62:63], v[62:63], v[158:159]
 v_exp_f32 v60, v60
 v_exp_f32 v61, v61
 v_exp_f32 v62, v62
 v_exp_f32 v63, v63
 v_pk_add_f32 v[60:61], v[60:61], 1.0 op_sel_hi:[1,0]
 v_pk_add_f32 v[62:63], v[62:63], 1.0 op_sel_hi:[1,0]
 v_rcp_f32 v60, v60
 v_rcp_f32 v61, v61
 v_rcp_f32 v62, v62
 v_rcp_f32 v63, v63
 v_pk_mul_f32 v[156:157], v[156:157], v[60:61]
 v_pk_mul_f32 v[158:159], v[158:159], v[62:63]
 v_pk_add_f32 v[212:213], v[212:213], v[156:157]
 v_pk_fma_f32 v[214:215], v[156:157], v[156:157], v[214:215]
 v_pk_add_f32 v[212:213], v[212:213], v[158:159]
 v_pk_fma_f32 v[214:215], v[158:159], v[158:159], v[214:215]
 buffer_load_dwordx4 v14, s[8:11], s27 offen offset:1024 lds
 v_pk_mul_f32 v[60:61], v[160:161], v[160:161]
 v_pk_mul_f32 v[62:63], v[162:163], v[162:163]
 v_pk_fma_f32 v[60:61], v[60:61], s[54:55], v[58:59]
 v_pk_fma_f32 v[62:63], v[62:63], s[54:55], v[58:59]
 v_pk_mul_f32 v[60:61], v[60:61], v[160:161]
 v_pk_mul_f32 v[62:63], v[62:63], v[162:163]
 v_exp_f32 v60, v60
 v_exp_f32 v61, v61
 v_exp_f32 v62, v62
 v_exp_f32 v63, v63
 v_pk_add_f32 v[60:61], v[60:61], 1.0 op_sel_hi:[1,0]
 v_pk_add_f32 v[62:63], v[62:63], 1.0 op_sel_hi:[1,0]
 v_rcp_f32 v60, v60
 v_rcp_f32 v61, v61
 v_rcp_f32 v62, v62
 v_rcp_f32 v63, v63
 v_pk_mul_f32 v[160:161], v[160:161], v[60:61]
 v_pk_mul_f32 v[162:163], v[162:163], v[62:63]
 v_pk_mul_f32 v[218:219], v[160:161], v[160:161]
 v_pk_add_f32 v[216:217], v[160:161], v[162:163]
 v_pk_fma_f32 v[218:219], v[162:163], v[162:163], v[218:219]
 buffer_load_dwordx4 v15, s[8:11], s27 offen offset:2048 lds
 v_pk_mul_f32 v[60:61], v[164:165], v[164:165]
 v_pk_mul_f32 v[62:63], v[166:167], v[166:167]
 v_pk_fma_f32 v[60:61], v[60:61], s[54:55], v[58:59]
 v_pk_fma_f32 v[62:63], v[62:63], s[54:55], v[58:59]
 v_pk_mul_f32 v[60:61], v[60:61], v[164:165]
 v_pk_mul_f32 v[62:63], v[62:63], v[166:167]
 v_exp_f32 v60, v60
 v_exp_f32 v61, v61
 v_exp_f32 v62, v62
 v_exp_f32 v63, v63
 v_pk_add_f32 v[60:61], v[60:61], 1.0 op_sel_hi:[1,0]
 v_pk_add_f32 v[62:63], v[62:63], 1.0 op_sel_hi:[1,0]
 v_rcp_f32 v60, v60
 v_rcp_f32 v61, v61
 v_rcp_f32 v62, v62
 v_rcp_f32 v63, v63
 v_pk_mul_f32 v[164:165], v[164:165], v[60:61]
 v_pk_mul_f32 v[166:167], v[166:167], v[62:63]
 v_pk_add_f32 v[216:217], v[216:217], v[164:165]
 v_pk_fma_f32 v[218:219], v[164:165], v[164:165], v[218:219]
 v_pk_add_f32 v[216:217], v[216:217], v[166:167]
 v_pk_fma_f32 v[218:219], v[166:167], v[166:167], v[218:219]
 buffer_load_dwordx4 v16, s[8:11], s27 offen offset:3072 lds
 v_pk_mul_f32 v[60:61], v[168:169], v[168:169]
 v_pk_mul_f32 v[62:63], v[170:171], v[170:171]
 v_pk_fma_f32 v[60:61], v[60:61], s[54:55], v[58:59]
 v_pk_fma_f32 v[62:63], v[62:63], s[54:55], v[58:59]
 v_pk_mul_f32 v[60:61], v[60:61], v[168:169]
 v_pk_mul_f32 v[62:63], v[62:63], v[170:171]
 v_exp_f32 v60, v60
 v_exp_f32 v61, v61
 v_exp_f32 v62, v62
 v_exp_f32 v63, v63
 v_pk_add_f32 v[60:61], v[60:61], 1.0 op_sel_hi:[1,0]
 v_pk_add_f32 v[62:63], v[62:63], 1.0 op_sel_hi:[1,0]
 v_rcp_f32 v60, v60
 v_rcp_f32 v61, v61
 v_rcp_f32 v62, v62
 v_rcp_f32 v63, v63
 v_pk_mul_f32 v[168:169], v[168:169], v[60:61]
 v_pk_mul_f32 v[170:171], v[170:171], v[62:63]
 v_pk_add_f32 v[216:217], v[216:217], v[168:169]
 v_pk_fma_f32 v[218:219], v[168:169], v[168:169], v[218:219]
 v_pk_add_f32 v[216:217], v[216:217], v[170:171]
 v_pk_fma_f32 v[218:219], v[170:171], v[170:171], v[218:219]
 s_add_u32 s53, s53, 128
 v_pk_mul_f32 v[60:61], v[172:173], v[172:173]
 v_pk_mul_f32 v[62:63], v[174:175], v[174:175]
 v_pk_fma_f32 v[60:61], v[60:61], s[54:55], v[58:59]
 v_pk_fma_f32 v[62:63], v[62:63], s[54:55], v[58:59]
 v_pk_mul_f32 v[60:61], v[60:61], v[172:173]
 v_pk_mul_f32 v[62:63], v[62:63], v[174:175]
 v_exp_f32 v60, v60
 v_exp_f32 v61, v61
 v_exp_f32 v62, v62
 v_exp_f32 v63, v63
 v_pk_add_f32 v[60:61], v[60:61], 1.0 op_sel_hi:[1,0]
 v_pk_add_f32 v[62:63], v[62:63], 1.0 op_sel_hi:[1,0]
 v_rcp_f32 v60, v60
 v_rcp_f32 v61, v61
 v_rcp_f32 v62, v62
 v_rcp_f32 v63, v63
 v_pk_mul_f32 v[172:173], v[172:173], v[60:61]
 v_pk_mul_f32 v[174:175], v[174:175], v[62:63]
 v_pk_add_f32 v[216:217], v[216:217], v[172:173]
 v_pk_fma_f32 v[218:219], v[172:173], v[172:173], v[218:219]
 v_pk_add_f32 v[216:217], v[216:217], v[174:175]
 v_pk_fma_f32 v[218:219], v[174:175], v[174:175], v[218:219]
 s_and_b32 s53, s53, 0xfff
 v_pk_mul_f32 v[60:61], v[176:177], v[176:177]
 v_pk_mul_f32 v[62:63], v[178:179], v[178:179]
 v_pk_fma_f32 v[60:61], v[60:61], s[54:55], v[58:59]
 v_pk_fma_f32 v[62:63], v[62:63], s[54:55], v[58:59]
 v_pk_mul_f32 v[60:61], v[60:61], v[176:177]
 v_pk_mul_f32 v[62:63], v[62:63], v[178:179]
 v_exp_f32 v60, v60
 v_exp_f32 v61, v61
 v_exp_f32 v62, v62
 v_exp_f32 v63, v63
 v_pk_add_f32 v[60:61], v[60:61], 1.0 op_sel_hi:[1,0]
 v_pk_add_f32 v[62:63], v[62:63], 1.0 op_sel_hi:[1,0]
 v_rcp_f32 v60, v60
 v_rcp_f32 v61, v61
 v_rcp_f32 v62, v62
 v_rcp_f32 v63, v63
 v_pk_mul_f32 v[176:177], v[176:177], v[60:61]
 v_pk_mul_f32 v[178:179], v[178:179], v[62:63]
 v_pk_mul_f32 v[222:223], v[176:177], v[176:177]
 v_pk_add_f32 v[220:221], v[176:177], v[178:179]
 v_pk_fma_f32 v[222:223], v[178:179], v[178:179], v[222:223]
 s_add_u32 s27, s51, s53
 s_nop 0
 v_pk_mul_f32 v[60:61], v[180:181], v[180:181]
 v_pk_mul_f32 v[62:63], v[182:183], v[182:183]
 v_pk_fma_f32 v[60:61], v[60:61], s[54:55], v[58:59]
 v_pk_fma_f32 v[62:63], v[62:63], s[54:55], v[58:59]
 v_pk_mul_f32 v[60:61], v[60:61], v[180:181]
 v_pk_mul_f32 v[62:63], v[62:63], v[182:183]
 v_exp_f32 v60, v60
 v_exp_f32 v61, v61
 v_exp_f32 v62, v62
 v_exp_f32 v63, v63
 v_pk_add_f32 v[60:61], v[60:61], 1.0 op_sel_hi:[1,0]
 v_pk_add_f32 v[62:63], v[62:63], 1.0 op_sel_hi:[1,0]
 v_rcp_f32 v60, v60
 v_rcp_f32 v61, v61
 v_rcp_f32 v62, v62
 v_rcp_f32 v63, v63
 v_pk_mul_f32 v[180:181], v[180:181], v[60:61]
 v_pk_mul_f32 v[182:183], v[182:183], v[62:63]
 v_pk_add_f32 v[220:221], v[220:221], v[180:181]
 v_pk_fma_f32 v[222:223], v[180:181], v[180:181], v[222:223]
 v_pk_add_f32 v[220:221], v[220:221], v[182:183]
 v_pk_fma_f32 v[222:223], v[182:183], v[182:183], v[222:223]
 v_pk_mul_f32 v[60:61], v[184:185], v[184:185]
 v_pk_mul_f32 v[62:63], v[186:187], v[186:187]
 v_pk_fma_f32 v[60:61], v[60:61], s[54:55], v[58:59]
 v_pk_fma_f32 v[62:63], v[62:63], s[54:55], v[58:59]
 v_pk_mul_f32 v[60:61], v[60:61], v[184:185]
 v_pk_mul_f32 v[62:63], v[62:63], v[186:187]
 v_exp_f32 v60, v60
 v_exp_f32 v61, v61
 v_exp_f32 v62, v62
 v_exp_f32 v63, v63
 v_pk_add_f32 v[60:61], v[60:61], 1.0 op_sel_hi:[1,0]
 v_pk_add_f32 v[62:63], v[62:63], 1.0 op_sel_hi:[1,0]
 v_rcp_f32 v60, v60
 v_rcp_f32 v61, v61
 v_rcp_f32 v62, v62
 v_rcp_f32 v63, v63
 v_pk_mul_f32 v[184:185], v[184:185], v[60:61]
 v_pk_mul_f32 v[186:187], v[186:187], v[62:63]
 v_pk_add_f32 v[220:221], v[220:221], v[184:185]
 v_pk_fma_f32 v[222:223], v[184:185], v[184:185], v[222:223]
 v_pk_add_f32 v[220:221], v[220:221], v[186:187]
 v_pk_fma_f32 v[222:223], v[186:187], v[186:187], v[222:223]
 v_pk_mul_f32 v[60:61], v[188:189], v[188:189]
 v_pk_mul_f32 v[62:63], v[190:191], v[190:191]
 v_pk_fma_f32 v[60:61], v[60:61], s[54:55], v[58:59]
 v_pk_fma_f32 v[62:63], v[62:63], s[54:55], v[58:59]
 v_pk_mul_f32 v[60:61], v[60:61], v[188:189]
 v_pk_mul_f32 v[62:63], v[62:63], v[190:191]
 v_exp_f32 v60, v60
 v_exp_f32 v61, v61
 v_exp_f32 v62, v62
 v_exp_f32 v63, v63
 v_pk_add_f32 v[60:61], v[60:61], 1.0 op_sel_hi:[1,0]
 v_pk_add_f32 v[62:63], v[62:63], 1.0 op_sel_hi:[1,0]
 v_rcp_f32 v60, v60
 v_rcp_f32 v61, v61
 v_rcp_f32 v62, v62
 v_rcp_f32 v63, v63
 v_pk_mul_f32 v[188:189], v[188:189], v[60:61]
 v_pk_mul_f32 v[190:191], v[190:191], v[62:63]
 v_pk_add_f32 v[220:221], v[220:221], v[188:189]
 v_pk_fma_f32 v[222:223], v[188:189], v[188:189], v[222:223]
 v_pk_add_f32 v[220:221], v[220:221], v[190:191]
 v_pk_fma_f32 v[222:223], v[190:191], v[190:191], v[222:223]
 v_add_f32 v40, v192, v193
 v_add_f32 v48, v194, v195
 v_add_f32 v41, v196, v197
 v_add_f32 v49, v198, v199
 v_add_f32 v42, v200, v201
 v_add_f32 v50, v202, v203
 v_add_f32 v43, v204, v205
 v_add_f32 v51, v206, v207
 v_add_f32 v44, v208, v209
 v_add_f32 v52, v210, v211
 v_add_f32 v45, v212, v213
 v_add_f32 v53, v214, v215
 v_add_f32 v46, v216, v217
 v_add_f32 v54, v218, v219
 v_add_f32 v47, v220, v221
 v_add_f32 v55, v222, v223
 s_lshl_b32 s31, s21, 11
 s_lshl_b32 s25, s22, 10
 v_permlane16_swap_b32 v40, v41
 v_permlane16_swap_b32 v42, v43
 v_permlane16_swap_b32 v44, v45
 v_permlane16_swap_b32 v46, v47
 v_permlane16_swap_b32 v48, v49
 v_permlane16_swap_b32 v50, v51
 v_permlane16_swap_b32 v52, v53
 v_permlane16_swap_b32 v54, v55
 s_add_u32 s31, s31, s25
 v_add_f32 v40, v40, v41
 v_add_f32 v42, v42, v43
 v_add_f32 v44, v44, v45
 v_add_f32 v46, v46, v47
 v_add_f32 v48, v48, v49
 v_add_f32 v50, v50, v51
 v_add_f32 v52, v52, v53
 v_add_f32_e64 v54, v54, v55
 s_add_u32 s31, s31, 147456
 v_lshlrev_b32 v5, 3, v1
 v_permlane32_swap_b32 v40, v42
 v_permlane32_swap_b32 v44, v46
 v_permlane32_swap_b32 v48, v50
 v_permlane32_swap_b32 v52, v54
 v_add_u32 v5, s31, v5
 v_add_f32 v60, v40, v42
 v_add_f32 v61, v48, v50
 v_add_f32 v62, v44, v46
 v_add_f32 v63, v52, v54
 ds_write_b64 v5, v[60:61]
 ds_write_b64 v5, v[62:63] offset:512
 v_lshlrev_b32_e64 v56, 3, v0
 v_add_u32 v57, 147456, v56
 s_add_u32 s12, s32, 0x2400000
 s_addc_u32 s13, s33, 0
 s_nop 0
 s_mov_b32 s14, 0x38000
 s_mov_b32 s15, 0x20000
 s_waitcnt lgkmcnt(0)
 s_barrier
 ds_read_b64 v[60:61], v57
 ds_read_b64 v[62:63], v57 offset:2048
 s_mul_i32 s35, s23, 28672
 s_lshl_b32 s31, s24, 11
 s_add_u32 s31, s31, s35
 s_waitcnt lgkmcnt(0)
 s_nop 0
 v_pk_add_f32 v[60:61], v[60:61], v[62:63]
 buffer_store_dwordx2 v[60:61], v56, s[12:15], s31 offen sc1
 ar v20,a128
 ar v21,a129
 ar v22,a130
 ar v23,a131
 v_pk_mul_f32 v[24:25], v[20:21], v[20:21]
 v_pk_mul_f32 v[26:27], v[22:23], v[22:23]
 v_pk_fma_f32 v[24:25], v[24:25], s[54:55], v[58:59]
 v_pk_fma_f32 v[26:27], v[26:27], s[54:55], v[58:59]
 v_pk_mul_f32 v[24:25], v[24:25], v[20:21]
 v_pk_mul_f32 v[26:27], v[26:27], v[22:23]
 v_exp_f32 v24, v24
 v_exp_f32 v25, v25
 v_exp_f32 v26, v26
 v_exp_f32 v27, v27
 v_pk_add_f32 v[24:25], v[24:25], 1.0 op_sel_hi:[1,0]
 v_pk_add_f32 v[26:27], v[26:27], 1.0 op_sel_hi:[1,0]
 v_rcp_f32 v24, v24
 v_rcp_f32 v25, v25
 v_rcp_f32 v26, v26
 v_rcp_f32 v27, v27
 v_pk_mul_f32 v[20:21], v[20:21], v[24:25]
 v_pk_mul_f32 v[22:23], v[22:23], v[26:27]
 v_cvt_pk_bf16_f32 v192, v20, v21
 v_cvt_pk_bf16_f32 v193, v22, v23
 ar v20,a160
 ar v21,a161
 ar v22,a162
 ar v23,a163
 v_pk_mul_f32 v[24:25], v[20:21], v[20:21]
 v_pk_mul_f32 v[26:27], v[22:23], v[22:23]
 v_pk_fma_f32 v[24:25], v[24:25], s[54:55], v[58:59]
 v_pk_fma_f32 v[26:27], v[26:27], s[54:55], v[58:59]
 v_pk_mul_f32 v[24:25], v[24:25], v[20:21]
 v_pk_mul_f32 v[26:27], v[26:27], v[22:23]
 v_exp_f32 v24, v24
 v_exp_f32 v25, v25
 v_exp_f32 v26, v26
 v_exp_f32 v27, v27
 v_pk_add_f32 v[24:25], v[24:25], 1.0 op_sel_hi:[1,0]
 v_pk_add_f32 v[26:27], v[26:27], 1.0 op_sel_hi:[1,0]
 v_rcp_f32 v24, v24
 v_rcp_f32 v25, v25
 v_rcp_f32 v26, v26
 v_rcp_f32 v27, v27
 v_pk_mul_f32 v[20:21], v[20:21], v[24:25]
 v_pk_mul_f32 v[22:23], v[22:23], v[26:27]
 v_cvt_pk_bf16_f32 v194, v20, v21
 v_cvt_pk_bf16_f32 v195, v22, v23
 ar v20,a192
 ar v21,a193
 ar v22,a194
 ar v23,a195
 v_pk_mul_f32 v[24:25], v[20:21], v[20:21]
 v_pk_mul_f32 v[26:27], v[22:23], v[22:23]
 v_pk_fma_f32 v[24:25], v[24:25], s[54:55], v[58:59]
 v_pk_fma_f32 v[26:27], v[26:27], s[54:55], v[58:59]
 v_pk_mul_f32 v[24:25], v[24:25], v[20:21]
 v_pk_mul_f32 v[26:27], v[26:27], v[22:23]
 v_exp_f32 v24, v24
 v_exp_f32 v25, v25
 v_exp_f32 v26, v26
 v_exp_f32 v27, v27
 v_pk_add_f32 v[24:25], v[24:25], 1.0 op_sel_hi:[1,0]
 v_pk_add_f32 v[26:27], v[26:27], 1.0 op_sel_hi:[1,0]
 v_rcp_f32 v24, v24
 v_rcp_f32 v25, v25
 v_rcp_f32 v26, v26
 v_rcp_f32 v27, v27
 v_pk_mul_f32 v[20:21], v[20:21], v[24:25]
 v_pk_mul_f32 v[22:23], v[22:23], v[26:27]
 v_cvt_pk_bf16_f32 v196, v20, v21
 v_cvt_pk_bf16_f32 v197, v22, v23
 s_lshl_b32 s40, s23, 8
 s_nop 0
 s_add_u32 s40, s40, 2048
 s_lshl_b32 s41, s24, 3
 s_add_u32 s41, s41, s40
 s_waitcnt vmcnt(0)
 s_barrier
 s_cmp_lg_u32 s20, 0
 s_cbranch_scc1 L_sig_24
 s_mov_b64 exec, 1
 v_mov_b32 v5, 0
 v_mov_b32 v6, s36
 v_mov_b32 v7, s37
 buffer_store_dwordx2 v[6:7], v5, s[16:19], s41 offen sc1
 s_mov_b64 exec, -1
L_sig_24:
 s_nop 0
 ar v20,a224
 ar v21,a225
 ar v22,a226
 ar v23,a227
 v_pk_mul_f32 v[24:25], v[20:21], v[20:21]
 v_pk_mul_f32 v[26:27], v[22:23], v[22:23]
 v_pk_fma_f32 v[24:25], v[24:25], s[54:55], v[58:59]
 v_pk_fma_f32 v[26:27], v[26:27], s[54:55], v[58:59]
 v_pk_mul_f32 v[24:25], v[24:25], v[20:21]
 v_pk_mul_f32 v[26:27], v[26:27], v[22:23]
 v_exp_f32 v24, v24
 v_exp_f32 v25, v25
 v_exp_f32 v26, v26
 v_exp_f32 v27, v27
 v_pk_add_f32 v[24:25], v[24:25], 1.0 op_sel_hi:[1,0]
 v_pk_add_f32 v[26:27], v[26:27], 1.0 op_sel_hi:[1,0]
 v_rcp_f32 v24, v24
 v_rcp_f32 v25, v25
 v_rcp_f32 v26, v26
 v_rcp_f32 v27, v27
 v_pk_mul_f32 v[20:21], v[20:21], v[24:25]
 v_pk_mul_f32 v[22:23], v[22:23], v[26:27]
 v_cvt_pk_bf16_f32 v198, v20, v21
 v_cvt_pk_bf16_f32 v199, v22, v23
 ar v20,a132
 ar v21,a133
 ar v22,a134
 ar v23,a135
 v_pk_mul_f32 v[24:25], v[20:21], v[20:21]
 v_pk_mul_f32 v[26:27], v[22:23], v[22:23]
 v_pk_fma_f32 v[24:25], v[24:25], s[54:55], v[58:59]
 v_pk_fma_f32 v[26:27], v[26:27], s[54:55], v[58:59]
 v_pk_mul_f32 v[24:25], v[24:25], v[20:21]
 v_pk_mul_f32 v[26:27], v[26:27], v[22:23]
 v_exp_f32 v24, v24
 v_exp_f32 v25, v25
 v_exp_f32 v26, v26
 v_exp_f32 v27, v27
 v_pk_add_f32 v[24:25], v[24:25], 1.0 op_sel_hi:[1,0]
 v_pk_add_f32 v[26:27], v[26:27], 1.0 op_sel_hi:[1,0]
 v_rcp_f32 v24, v24
 v_rcp_f32 v25, v25
 v_rcp_f32 v26, v26
 v_rcp_f32 v27, v27
 v_pk_mul_f32 v[20:21], v[20:21], v[24:25]
 v_pk_mul_f32 v[22:23], v[22:23], v[26:27]
 v_cvt_pk_bf16_f32 v200, v20, v21
 v_cvt_pk_bf16_f32 v201, v22, v23
 ar v20,a164
 ar v21,a165
 ar v22,a166
 ar v23,a167
 v_pk_mul_f32 v[24:25], v[20:21], v[20:21]
 v_pk_mul_f32 v[26:27], v[22:23], v[22:23]
 v_pk_fma_f32 v[24:25], v[24:25], s[54:55], v[58:59]
 v_pk_fma_f32 v[26:27], v[26:27], s[54:55], v[58:59]
 v_pk_mul_f32 v[24:25], v[24:25], v[20:21]
 v_pk_mul_f32 v[26:27], v[26:27], v[22:23]
 v_exp_f32 v24, v24
 v_exp_f32 v25, v25
 v_exp_f32 v26, v26
 v_exp_f32 v27, v27
 v_pk_add_f32 v[24:25], v[24:25], 1.0 op_sel_hi:[1,0]
 v_pk_add_f32 v[26:27], v[26:27], 1.0 op_sel_hi:[1,0]
 v_rcp_f32 v24, v24
 v_rcp_f32 v25, v25
 v_rcp_f32 v26, v26
 v_rcp_f32 v27, v27
 v_pk_mul_f32 v[20:21], v[20:21], v[24:25]
 v_pk_mul_f32 v[22:23], v[22:23], v[26:27]
 v_cvt_pk_bf16_f32 v202, v20, v21
 v_cvt_pk_bf16_f32 v203, v22, v23
 ar v20,a196
 ar v21,a197
 ar v22,a198
 ar v23,a199
 v_pk_mul_f32 v[24:25], v[20:21], v[20:21]
 v_pk_mul_f32 v[26:27], v[22:23], v[22:23]
 v_pk_fma_f32 v[24:25], v[24:25], s[54:55], v[58:59]
 v_pk_fma_f32 v[26:27], v[26:27], s[54:55], v[58:59]
 v_pk_mul_f32 v[24:25], v[24:25], v[20:21]
 v_pk_mul_f32 v[26:27], v[26:27], v[22:23]
 v_exp_f32 v24, v24
 v_exp_f32 v25, v25
 v_exp_f32 v26, v26
 v_exp_f32 v27, v27
 v_pk_add_f32 v[24:25], v[24:25], 1.0 op_sel_hi:[1,0]
 v_pk_add_f32 v[26:27], v[26:27], 1.0 op_sel_hi:[1,0]
 v_rcp_f32 v24, v24
 v_rcp_f32 v25, v25
 v_rcp_f32 v26, v26
 v_rcp_f32 v27, v27
 v_pk_mul_f32 v[20:21], v[20:21], v[24:25]
 v_pk_mul_f32 v[22:23], v[22:23], v[26:27]
 v_cvt_pk_bf16_f32 v204, v20, v21
 v_cvt_pk_bf16_f32 v205, v22, v23
 ar v20,a228
 ar v21,a229
 ar v22,a230
 ar v23,a231
 v_pk_mul_f32 v[24:25], v[20:21], v[20:21]
 v_pk_mul_f32 v[26:27], v[22:23], v[22:23]
 v_pk_fma_f32 v[24:25], v[24:25], s[54:55], v[58:59]
 v_pk_fma_f32 v[26:27], v[26:27], s[54:55], v[58:59]
 v_pk_mul_f32 v[24:25], v[24:25], v[20:21]
 v_pk_mul_f32 v[26:27], v[26:27], v[22:23]
 v_exp_f32 v24, v24
 v_exp_f32 v25, v25
 v_exp_f32 v26, v26
 v_exp_f32 v27, v27
 v_pk_add_f32 v[24:25], v[24:25], 1.0 op_sel_hi:[1,0]
 v_pk_add_f32 v[26:27], v[26:27], 1.0 op_sel_hi:[1,0]
 v_rcp_f32 v24, v24
 v_rcp_f32 v25, v25
 v_rcp_f32 v26, v26
 v_rcp_f32 v27, v27
 v_pk_mul_f32 v[20:21], v[20:21], v[24:25]
 v_pk_mul_f32 v[22:23], v[22:23], v[26:27]
 v_cvt_pk_bf16_f32 v206, v20, v21
 v_cvt_pk_bf16_f32 v207, v22, v23
 ar v20,a136
 ar v21,a137
 ar v22,a138
 ar v23,a139
 v_pk_mul_f32 v[24:25], v[20:21], v[20:21]
 v_pk_mul_f32 v[26:27], v[22:23], v[22:23]
 v_pk_fma_f32 v[24:25], v[24:25], s[54:55], v[58:59]
 v_pk_fma_f32 v[26:27], v[26:27], s[54:55], v[58:59]
 v_pk_mul_f32 v[24:25], v[24:25], v[20:21]
 v_pk_mul_f32 v[26:27], v[26:27], v[22:23]
 v_exp_f32 v24, v24
 v_exp_f32 v25, v25
 v_exp_f32 v26, v26
 v_exp_f32 v27, v27
 v_pk_add_f32 v[24:25], v[24:25], 1.0 op_sel_hi:[1,0]
 v_pk_add_f32 v[26:27], v[26:27], 1.0 op_sel_hi:[1,0]
 v_rcp_f32 v24, v24
 v_rcp_f32 v25, v25
 v_rcp_f32 v26, v26
 v_rcp_f32 v27, v27
 v_pk_mul_f32 v[20:21], v[20:21], v[24:25]
 v_pk_mul_f32 v[22:23], v[22:23], v[26:27]
 v_cvt_pk_bf16_f32 v208, v20, v21
 v_cvt_pk_bf16_f32 v209, v22, v23
 s_cmp_lg_u32 s20, 0
 s_cbranch_scc1 L_wt_25
 v_min_u32 v5, 13, v1
 v_cmp_eq_u32 vcc, s24, v5
 v_xor_b32 v6, 1, v5
 s_nop 0
 v_cndmask_b32 v5, v5, v6, vcc
 v_lshlrev_b32 v5, 3, v5
 s_mov_b32 s80, 0x20000
 s_branch L_poll_26
L_again_27:
 s_sub_u32 s80, s80, 1
 s_cbranch_scc1 L_wt_25
 s_sleep 2
L_poll_26:
 buffer_load_dwordx2 v[6:7], v5, s[16:19], s40 offen sc1
 s_waitcnt vmcnt(0)
 v_cmp_ne_u64 vcc, s[36:37], v[6:7]
 s_cmp_lg_u64 vcc, 0
 s_cbranch_scc1 L_again_27
L_wt_25:
 s_barrier
 s_add_u32 s31, s35, 0
 buffer_load_dwordx2 v[36:37], v56, s[12:15], s31 offen sc1
 s_add_u32 s31, s35, 2048
 buffer_load_dwordx2 v[38:39], v56, s[12:15], s31 offen sc1
 s_add_u32 s31, s35, 4096
 buffer_load_dwordx2 v[40:41], v56, s[12:15], s31 offen sc1
 s_add_u32 s31, s35, 6144
 buffer_load_dwordx2 v[42:43], v56, s[12:15], s31 offen sc1
 s_add_u32 s31, s35, 8192
 buffer_load_dwordx2 v[44:45], v56, s[12:15], s31 offen sc1
 s_add_u32 s31, s35, 10240
 buffer_load_dwordx2 v[46:47], v56, s[12:15], s31 offen sc1
 s_add_u32 s31, s35, 12288
 buffer_load_dwordx2 v[48:49], v56, s[12:15], s31 offen sc1
 s_add_u32 s31, s35, 14336
 buffer_load_dwordx2 v[50:51], v56, s[12:15], s31 offen sc1
 s_add_u32 s31, s35, 16384
 buffer_load_dwordx2 v[52:53], v56, s[12:15], s31 offen sc1
 s_add_u32 s31, s35, 18432
 buffer_load_dwordx2 v[54:55], v56, s[12:15], s31 offen sc1
 s_add_u32 s31, s35, 20480
 buffer_load_dwordx2 v[60:61], v56, s[12:15], s31 offen sc1
 s_add_u32 s31, s35, 22528
 buffer_load_dwordx2 v[62:63], v56, s[12:15], s31 offen sc1
 s_add_u32 s31, s35, 24576
 buffer_load_dwordx2 v[6:7], v56, s[12:15], s31 offen sc1
 s_add_u32 s31, s35, 26624
 buffer_load_dwordx2 v[18:19], v56, s[12:15], s31 offen sc1
 ar v20,a168
 ar v21,a169
 ar v22,a170
 ar v23,a171
 v_pk_mul_f32 v[24:25], v[20:21], v[20:21]
 v_pk_mul_f32 v[26:27], v[22:23], v[22:23]
 v_pk_fma_f32 v[24:25], v[24:25], s[54:55], v[58:59]
 v_pk_fma_f32 v[26:27], v[26:27], s[54:55], v[58:59]
 v_pk_mul_f32 v[24:25], v[24:25], v[20:21]
 v_pk_mul_f32 v[26:27], v[26:27], v[22:23]
 v_exp_f32 v24, v24
 v_exp_f32 v25, v25
 v_exp_f32 v26, v26
 v_exp_f32 v27, v27
 v_pk_add_f32 v[24:25], v[24:25], 1.0 op_sel_hi:[1,0]
 v_pk_add_f32 v[26:27], v[26:27], 1.0 op_sel_hi:[1,0]
 v_rcp_f32 v24, v24
 v_rcp_f32 v25, v25
 v_rcp_f32 v26, v26
 v_rcp_f32 v27, v27
 v_pk_mul_f32 v[20:21], v[20:21], v[24:25]
 v_pk_mul_f32 v[22:23], v[22:23], v[26:27]
 v_cvt_pk_bf16_f32 v210, v20, v21
 v_cvt_pk_bf16_f32 v211, v22, v23
 ar v20,a200
 ar v21,a201
 ar v22,a202
 ar v23,a203
 v_pk_mul_f32 v[24:25], v[20:21], v[20:21]
 v_pk_mul_f32 v[26:27], v[22:23], v[22:23]
 v_pk_fma_f32 v[24:25], v[24:25], s[54:55], v[58:59]
 v_pk_fma_f32 v[26:27], v[26:27], s[54:55], v[58:59]
 v_pk_mul_f32 v[24:25], v[24:25], v[20:21]
 v_pk_mul_f32 v[26:27], v[26:27], v[22:23]
 v_exp_f32 v24, v24
 v_exp_f32 v25, v25
 v_exp_f32 v26, v26
 v_exp_f32 v27, v27
 v_pk_add_f32 v[24:25], v[24:25], 1.0 op_sel_hi:[1,0]
 v_pk_add_f32 v[26:27], v[26:27], 1.0 op_sel_hi:[1,0]
 v_rcp_f32 v24, v24
 v_rcp_f32 v25, v25
 v_rcp_f32 v26, v26
 v_rcp_f32 v27, v27
 v_pk_mul_f32 v[20:21], v[20:21], v[24:25]
 v_pk_mul_f32 v[22:23], v[22:23], v[26:27]
 v_cvt_pk_bf16_f32 v212, v20, v21
 v_cvt_pk_bf16_f32 v213, v22, v23
 ar v20,a232
 ar v21,a233
 ar v22,a234
 ar v23,a235
 v_pk_mul_f32 v[24:25], v[20:21], v[20:21]
 v_pk_mul_f32 v[26:27], v[22:23], v[22:23]
 v_pk_fma_f32 v[24:25], v[24:25], s[54:55], v[58:59]
 v_pk_fma_f32 v[26:27], v[26:27], s[54:55], v[58:59]
 v_pk_mul_f32 v[24:25], v[24:25], v[20:21]
 v_pk_mul_f32 v[26:27], v[26:27], v[22:23]
 v_exp_f32 v24, v24
 v_exp_f32 v25, v25
 v_exp_f32 v26, v26
 v_exp_f32 v27, v27
 v_pk_add_f32 v[24:25], v[24:25], 1.0 op_sel_hi:[1,0]
 s_branch L_skip_12447
.p2align 12
L_stub_wg_12447:
 s_branch L_stub_wg_14141
 s_nop 0
 s_nop 0
 s_nop 0
L_skip_12447:
 v_pk_add_f32 v[26:27], v[26:27], 1.0 op_sel_hi:[1,0]
 v_rcp_f32 v24, v24
 v_rcp_f32 v25, v25
 v_rcp_f32 v26, v26
 v_rcp_f32 v27, v27
 v_pk_mul_f32 v[20:21], v[20:21], v[24:25]
 v_pk_mul_f32 v[22:23], v[22:23], v[26:27]
 v_cvt_pk_bf16_f32 v214, v20, v21
 v_cvt_pk_bf16_f32 v215, v22, v23
 ar v20,a140
 ar v21,a141
 ar v22,a142
 ar v23,a143
 v_pk_mul_f32 v[24:25], v[20:21], v[20:21]
 v_pk_mul_f32 v[26:27], v[22:23], v[22:23]
 v_pk_fma_f32 v[24:25], v[24:25], s[54:55], v[58:59]
 v_pk_fma_f32 v[26:27], v[26:27], s[54:55], v[58:59]
 v_pk_mul_f32 v[24:25], v[24:25], v[20:21]
 v_pk_mul_f32 v[26:27], v[26:27], v[22:23]
 v_exp_f32 v24, v24
 v_exp_f32 v25, v25
 v_exp_f32 v26, v26
 v_exp_f32 v27, v27
 v_pk_add_f32 v[24:25], v[24:25], 1.0 op_sel_hi:[1,0]
 v_pk_add_f32 v[26:27], v[26:27], 1.0 op_sel_hi:[1,0]
 v_rcp_f32 v24, v24
 v_rcp_f32 v25, v25
 v_rcp_f32 v26, v26
 v_rcp_f32 v27, v27
 v_pk_mul_f32 v[20:21], v[20:21], v[24:25]
 v_pk_mul_f32 v[22:23], v[22:23], v[26:27]
 v_cvt_pk_bf16_f32 v216, v20, v21
 v_cvt_pk_bf16_f32 v217, v22, v23
 ar v20,a172
 ar v21,a173
 ar v22,a174
 ar v23,a175
 v_pk_mul_f32 v[24:25], v[20:21], v[20:21]
 v_pk_mul_f32 v[26:27], v[22:23], v[22:23]
 v_pk_fma_f32 v[24:25], v[24:25], s[54:55], v[58:59]
 v_pk_fma_f32 v[26:27], v[26:27], s[54:55], v[58:59]
 v_pk_mul_f32 v[24:25], v[24:25], v[20:21]
 v_pk_mul_f32 v[26:27], v[26:27], v[22:23]
 v_exp_f32 v24, v24
 v_exp_f32 v25, v25
 v_exp_f32 v26, v26
 v_exp_f32 v27, v27
 v_pk_add_f32 v[24:25], v[24:25], 1.0 op_sel_hi:[1,0]
 v_pk_add_f32 v[26:27], v[26:27], 1.0 op_sel_hi:[1,0]
 v_rcp_f32 v24, v24
 v_rcp_f32 v25, v25
 v_rcp_f32 v26, v26
 v_rcp_f32 v27, v27
 v_pk_mul_f32 v[20:21], v[20:21], v[24:25]
 v_pk_mul_f32 v[22:23], v[22:23], v[26:27]
 v_cvt_pk_bf16_f32 v218, v20, v21
 v_cvt_pk_bf16_f32 v219, v22, v23
 ar v20,a204
 ar v21,a205
 ar v22,a206
 ar v23,a207
 v_pk_mul_f32 v[24:25], v[20:21], v[20:21]
 v_pk_mul_f32 v[26:27], v[22:23], v[22:23]
 v_pk_fma_f32 v[24:25], v[24:25], s[54:55], v[58:59]
 v_pk_fma_f32 v[26:27], v[26:27], s[54:55], v[58:59]
 v_pk_mul_f32 v[24:25], v[24:25], v[20:21]
 v_pk_mul_f32 v[26:27], v[26:27], v[22:23]
 v_exp_f32 v24, v24
 v_exp_f32 v25, v25
 v_exp_f32 v26, v26
 v_exp_f32 v27, v27
 v_pk_add_f32 v[24:25], v[24:25], 1.0 op_sel_hi:[1,0]
 v_pk_add_f32 v[26:27], v[26:27], 1.0 op_sel_hi:[1,0]
 v_rcp_f32 v24, v24
 v_rcp_f32 v25, v25
 v_rcp_f32 v26, v26
 v_rcp_f32 v27, v27
 v_pk_mul_f32 v[20:21], v[20:21], v[24:25]
 v_pk_mul_f32 v[22:23], v[22:23], v[26:27]
 v_cvt_pk_bf16_f32 v220, v20, v21
 v_cvt_pk_bf16_f32 v221, v22, v23
 ar v20,a236
 ar v21,a237
 ar v22,a238
 ar v23,a239
 v_pk_mul_f32 v[24:25], v[20:21], v[20:21]
 v_pk_mul_f32 v[26:27], v[22:23], v[22:23]
 v_pk_fma_f32 v[24:25], v[24:25], s[54:55], v[58:59]
 v_pk_fma_f32 v[26:27], v[26:27], s[54:55], v[58:59]
 v_pk_mul_f32 v[24:25], v[24:25], v[20:21]
 v_pk_mul_f32 v[26:27], v[26:27], v[22:23]
 v_exp_f32 v24, v24
 v_exp_f32 v25, v25
 v_exp_f32 v26, v26
 v_exp_f32 v27, v27
 v_pk_add_f32 v[24:25], v[24:25], 1.0 op_sel_hi:[1,0]
 v_pk_add_f32 v[26:27], v[26:27], 1.0 op_sel_hi:[1,0]
 v_rcp_f32 v24, v24
 v_rcp_f32 v25, v25
 v_rcp_f32 v26, v26
 v_rcp_f32 v27, v27
 v_pk_mul_f32 v[20:21], v[20:21], v[24:25]
 v_pk_mul_f32 v[22:23], v[22:23], v[26:27]
 v_cvt_pk_bf16_f32 v222, v20, v21
 v_cvt_pk_bf16_f32 v223, v22, v23
 ar v20,a144
 ar v21,a145
 ar v22,a146
 ar v23,a147
 v_pk_mul_f32 v[24:25], v[20:21], v[20:21]
 v_pk_mul_f32 v[26:27], v[22:23], v[22:23]
 v_pk_fma_f32 v[24:25], v[24:25], s[54:55], v[58:59]
 v_pk_fma_f32 v[26:27], v[26:27], s[54:55], v[58:59]
 v_pk_mul_f32 v[24:25], v[24:25], v[20:21]
 v_pk_mul_f32 v[26:27], v[26:27], v[22:23]
 v_exp_f32 v24, v24
 v_exp_f32 v25, v25
 v_exp_f32 v26, v26
 v_exp_f32 v27, v27
 v_pk_add_f32 v[24:25], v[24:25], 1.0 op_sel_hi:[1,0]
 v_pk_add_f32 v[26:27], v[26:27], 1.0 op_sel_hi:[1,0]
 v_rcp_f32 v24, v24
 v_rcp_f32 v25, v25
 v_rcp_f32 v26, v26
 v_rcp_f32 v27, v27
 v_pk_mul_f32 v[20:21], v[20:21], v[24:25]
 v_pk_mul_f32 v[22:23], v[22:23], v[26:27]
 v_cvt_pk_bf16_f32 v224, v20, v21
 v_cvt_pk_bf16_f32 v225, v22, v23
 s_add_u32 s4, s32, 0x1c00000
 s_addc_u32 s5, s33, 0
 s_nop 0
 s_mov_b32 s6, 0x700000
 s_mov_b32 s7, 0x20000
 s_waitcnt vmcnt(0)
 s_nop 0
 v_pk_add_f32 v[36:37], v[36:37], v[38:39]
 v_pk_add_f32 v[40:41], v[40:41], v[42:43]
 v_pk_add_f32 v[44:45], v[44:45], v[46:47]
 v_pk_add_f32 v[48:49], v[48:49], v[50:51]
 v_pk_add_f32 v[52:53], v[52:53], v[54:55]
 v_pk_add_f32 v[60:61], v[60:61], v[62:63]
 v_pk_add_f32 v[6:7], v[6:7], v[18:19]
 v_pk_add_f32 v[36:37], v[36:37], v[40:41]
 v_pk_add_f32 v[44:45], v[44:45], v[48:49]
 v_pk_add_f32 v[52:53], v[52:53], v[60:61]
 v_pk_add_f32 v[36:37], v[36:37], v[44:45]
 v_pk_add_f32 v[52:53], v[52:53], v[6:7]
 v_pk_add_f32 v[36:37], v[36:37], v[52:53]
 v_mul_f32 v36, 0x3a124925, v36
 v_mul_f32 v37, 0x3a124925, v37
 v_fma_f32 v37, -v36, v36, v37
 v_max_f32_e64 v37, 0, v37
 v_cvt_pk_bf16_f32 v36, v36, v36
 v_and_b32 v36, 0xffff0000, v36
 v_cvt_pk_bf16_f32 v37, v37, v37
 v_and_b32 v37, 0xffff0000, v37
 v_add_f32 v37, 0x3727c5ac, v37
 v_cvt_pk_bf16_f32 v37, v37, v37
 v_and_b32 v37, 0xffff0000, v37
 v_sqrt_f32 v37, v37
 v_and_b32 v6, 15, v1
 v_cvt_pk_bf16_f32 v37, v37, v37
 v_and_b32 v37, 0xffff0000, v37
 v_rcp_f32 v37, v37
 s_lshl_b32 s31, s22, 10
 v_mul_f32 v36, v36, v37
 v_sub_f32 v36, 0, v36
 ds_write_b64 v57, v[36:37] offset:4096
 s_add_u32 s31, s31, 151552
 v_lshlrev_b32 v5, 3, v6
 v_add_u32 v5, s31, v5
 s_waitcnt lgkmcnt(0)
 s_barrier
 ds_read_b64 v[40:41], v5 offset:0
 ds_read_b64 v[42:43], v5 offset:128
 ds_read_b64 v[44:45], v5 offset:256
 ds_read_b64 v[46:47], v5 offset:384
 ds_read_b64 v[48:49], v5 offset:512
 ds_read_b64 v[50:51], v5 offset:640
 ds_read_b64 v[52:53], v5 offset:768
 ds_read_b64 v[54:55], v5 offset:896
 v_and_b32 v6, 15, v1
 v_and_b32 v5, 1, v2
 v_lshlrev_b32 v5, 1, v5
 v_lshrrev_b32 v7, 1, v2
 v_or_b32 v7, v7, v5
 v_lshlrev_b32 v19, 4, v1
 v_bfe_u32 v5, v1, 3, 1
 v_lshlrev_b32 v5, 1, v5
 v_xor_b32 v7, v7, v5
 v_lshlrev_b32_e64 v7, 4, v7
 v_lshl_add_u32 v7, v6, 6, v7
 s_lshl_b32 s26, s24, 19
 s_lshl_b32 s31, s23, 16
 s_add_u32 s35, s26, s31
 s_lshl_b32 s31, s22, 15
 s_add_u32 s35, s35, s31
 s_lshl_b32 s31, s21, 13
 s_add_u32 s35, s35, s31
 s_add_u32 s26, s26, s29
 s_mov_b32 s50, s26
 s_add_u32 s26, s26, s52
 s_waitcnt lgkmcnt(0)
 s_nop 0
 v_pk_fma_f32 v[64:65], v[64:65], v[40:41], v[40:41] op_sel:[0,1,0] op_sel_hi:[1,1,0]
 v_pk_fma_f32 v[66:67], v[66:67], v[40:41], v[40:41] op_sel:[0,1,0] op_sel_hi:[1,1,0]
 v_pk_fma_f32 v[68:69], v[68:69], v[40:41], v[40:41] op_sel:[0,1,0] op_sel_hi:[1,1,0]
 v_pk_fma_f32 v[70:71], v[70:71], v[40:41], v[40:41] op_sel:[0,1,0] op_sel_hi:[1,1,0]
 v_cvt_pk_bf16_f32 v36, v64, v65
 v_cvt_pk_bf16_f32 v37, v66, v67
 v_cvt_pk_bf16_f32 v38, v68, v69
 v_cvt_pk_bf16_f32 v39, v70, v71
 s_add_u32 s31, s35, 0
 v_permlane16_swap_b32 v36, v38
 v_permlane16_swap_b32_e64 v37, v39
 buffer_store_dwordx4 v[36:39], v7, s[4:7], s31 offen offset:0 sc1
 v_pk_fma_f32 v[72:73], v[72:73], v[40:41], v[40:41] op_sel:[0,1,0] op_sel_hi:[1,1,0]
 v_pk_fma_f32 v[74:75], v[74:75], v[40:41], v[40:41] op_sel:[0,1,0] op_sel_hi:[1,1,0]
 v_pk_fma_f32 v[76:77], v[76:77], v[40:41], v[40:41] op_sel:[0,1,0] op_sel_hi:[1,1,0]
 v_pk_fma_f32 v[78:79], v[78:79], v[40:41], v[40:41] op_sel:[0,1,0] op_sel_hi:[1,1,0]
 v_cvt_pk_bf16_f32 v60, v72, v73
 v_cvt_pk_bf16_f32 v61, v74, v75
 v_cvt_pk_bf16_f32 v62, v76, v77
 v_cvt_pk_bf16_f32 v63, v78, v79
 s_add_u32 s31, s35, 4096
 v_permlane16_swap_b32 v60, v62
 v_permlane16_swap_b32 v61, v63
 buffer_store_dwordx4 v[60:63], v7, s[4:7], s31 offen offset:0 sc1
 v_pk_fma_f32 v[80:81], v[80:81], v[42:43], v[42:43] op_sel:[0,1,0] op_sel_hi:[1,1,0]
 v_pk_fma_f32 v[82:83], v[82:83], v[42:43], v[42:43] op_sel:[0,1,0] op_sel_hi:[1,1,0]
 v_pk_fma_f32 v[84:85], v[84:85], v[42:43], v[42:43] op_sel:[0,1,0] op_sel_hi:[1,1,0]
 v_pk_fma_f32 v[86:87], v[86:87], v[42:43], v[42:43] op_sel:[0,1,0] op_sel_hi:[1,1,0]
 v_cvt_pk_bf16_f32 v36, v80, v81
 v_cvt_pk_bf16_f32 v37, v82, v83
 v_cvt_pk_bf16_f32 v38, v84, v85
 v_cvt_pk_bf16_f32 v39, v86, v87
 s_add_u32 s31, s35, 0
 v_permlane16_swap_b32 v36, v38
 v_permlane16_swap_b32_e64 v37, v39
 buffer_store_dwordx4 v[36:39], v7, s[4:7], s31 offen offset:1024 sc1
 v_pk_fma_f32 v[88:89], v[88:89], v[42:43], v[42:43] op_sel:[0,1,0] op_sel_hi:[1,1,0]
 v_pk_fma_f32 v[90:91], v[90:91], v[42:43], v[42:43] op_sel:[0,1,0] op_sel_hi:[1,1,0]
 v_pk_fma_f32 v[92:93], v[92:93], v[42:43], v[42:43] op_sel:[0,1,0] op_sel_hi:[1,1,0]
 v_pk_fma_f32 v[94:95], v[94:95], v[42:43], v[42:43] op_sel:[0,1,0] op_sel_hi:[1,1,0]
 v_cvt_pk_bf16_f32 v60, v88, v89
 v_cvt_pk_bf16_f32 v61, v90, v91
 v_cvt_pk_bf16_f32 v62, v92, v93
 v_cvt_pk_bf16_f32 v63, v94, v95
 s_add_u32 s31, s35, 4096
 v_permlane16_swap_b32 v60, v62
 v_permlane16_swap_b32 v61, v63
 buffer_store_dwordx4 v[60:63], v7, s[4:7], s31 offen offset:1024 sc1
 v_pk_fma_f32 v[96:97], v[96:97], v[44:45], v[44:45] op_sel:[0,1,0] op_sel_hi:[1,1,0]
 v_pk_fma_f32 v[98:99], v[98:99], v[44:45], v[44:45] op_sel:[0,1,0] op_sel_hi:[1,1,0]
 v_pk_fma_f32 v[100:101], v[100:101], v[44:45], v[44:45] op_sel:[0,1,0] op_sel_hi:[1,1,0]
 v_pk_fma_f32 v[102:103], v[102:103], v[44:45], v[44:45] op_sel:[0,1,0] op_sel_hi:[1,1,0]
 v_cvt_pk_bf16_f32 v36, v96, v97
 v_cvt_pk_bf16_f32 v37, v98, v99
 v_cvt_pk_bf16_f32 v38, v100, v101
 v_cvt_pk_bf16_f32 v39, v102, v103
 s_add_u32 s31, s35, 0
 v_permlane16_swap_b32 v36, v38
 v_permlane16_swap_b32_e64 v37, v39
 buffer_store_dwordx4 v[36:39], v7, s[4:7], s31 offen offset:2048 sc1
 v_pk_fma_f32 v[104:105], v[104:105], v[44:45], v[44:45] op_sel:[0,1,0] op_sel_hi:[1,1,0]
 v_pk_fma_f32 v[106:107], v[106:107], v[44:45], v[44:45] op_sel:[0,1,0] op_sel_hi:[1,1,0]
 v_pk_fma_f32 v[108:109], v[108:109], v[44:45], v[44:45] op_sel:[0,1,0] op_sel_hi:[1,1,0]
 v_pk_fma_f32 v[110:111], v[110:111], v[44:45], v[44:45] op_sel:[0,1,0] op_sel_hi:[1,1,0]
 v_cvt_pk_bf16_f32 v60, v104, v105
 v_cvt_pk_bf16_f32 v61, v106, v107
 v_cvt_pk_bf16_f32 v62, v108, v109
 v_cvt_pk_bf16_f32 v63, v110, v111
 s_add_u32 s31, s35, 4096
 v_permlane16_swap_b32 v60, v62
 v_permlane16_swap_b32 v61, v63
 buffer_store_dwordx4 v[60:63], v7, s[4:7], s31 offen offset:2048 sc1
 v_pk_fma_f32 v[112:113], v[112:113], v[46:47], v[46:47] op_sel:[0,1,0] op_sel_hi:[1,1,0]
 v_pk_fma_f32 v[114:115], v[114:115], v[46:47], v[46:47] op_sel:[0,1,0] op_sel_hi:[1,1,0]
 v_pk_fma_f32 v[116:117], v[116:117], v[46:47], v[46:47] op_sel:[0,1,0] op_sel_hi:[1,1,0]
 v_pk_fma_f32 v[118:119], v[118:119], v[46:47], v[46:47] op_sel:[0,1,0] op_sel_hi:[1,1,0]
 v_cvt_pk_bf16_f32 v36, v112, v113
 v_cvt_pk_bf16_f32 v37, v114, v115
 v_cvt_pk_bf16_f32 v38, v116, v117
 v_cvt_pk_bf16_f32 v39, v118, v119
 s_add_u32 s31, s35, 0
 v_permlane16_swap_b32 v36, v38
 v_permlane16_swap_b32_e64 v37, v39
 buffer_store_dwordx4 v[36:39], v7, s[4:7], s31 offen offset:3072 sc1
 v_pk_fma_f32 v[120:121], v[120:121], v[46:47], v[46:47] op_sel:[0,1,0] op_sel_hi:[1,1,0]
 v_pk_fma_f32 v[122:123], v[122:123], v[46:47], v[46:47] op_sel:[0,1,0] op_sel_hi:[1,1,0]
 v_pk_fma_f32 v[124:125], v[124:125], v[46:47], v[46:47] op_sel:[0,1,0] op_sel_hi:[1,1,0]
 v_pk_fma_f32 v[126:127], v[126:127], v[46:47], v[46:47] op_sel:[0,1,0] op_sel_hi:[1,1,0]
 v_cvt_pk_bf16_f32 v60, v120, v121
 v_cvt_pk_bf16_f32 v61, v122, v123
 v_cvt_pk_bf16_f32 v62, v124, v125
 v_cvt_pk_bf16_f32 v63, v126, v127
 s_add_u32 s31, s35, 4096
 v_permlane16_swap_b32 v60, v62
 v_permlane16_swap_b32 v61, v63
 buffer_store_dwordx4 v[60:63], v7, s[4:7], s31 offen offset:3072 sc1
 v_pk_fma_f32 v[128:129], v[128:129], v[48:49], v[48:49] op_sel:[0,1,0] op_sel_hi:[1,1,0]
 v_pk_fma_f32 v[130:131], v[130:131], v[48:49], v[48:49] op_sel:[0,1,0] op_sel_hi:[1,1,0]
 v_pk_fma_f32 v[132:133], v[132:133], v[48:49], v[48:49] op_sel:[0,1,0] op_sel_hi:[1,1,0]
 v_pk_fma_f32 v[134:135], v[134:135], v[48:49], v[48:49] op_sel:[0,1,0] op_sel_hi:[1,1,0]
 v_cvt_pk_bf16_f32 v36, v128, v129
 v_cvt_pk_bf16_f32 v37, v130, v131
 v_cvt_pk_bf16_f32 v38, v132, v133
 v_cvt_pk_bf16_f32 v39, v134, v135
 s_add_u32 s31, s35, 16384
 v_permlane16_swap_b32 v36, v38
 v_permlane16_swap_b32 v37, v39
 buffer_store_dwordx4 v[36:39], v7, s[4:7], s31 offen offset:0 sc1
 v_pk_fma_f32 v[136:137], v[136:137], v[48:49], v[48:49] op_sel:[0,1,0] op_sel_hi:[1,1,0]
 v_pk_fma_f32 v[138:139], v[138:139], v[48:49], v[48:49] op_sel:[0,1,0] op_sel_hi:[1,1,0]
 v_pk_fma_f32 v[140:141], v[140:141], v[48:49], v[48:49] op_sel:[0,1,0] op_sel_hi:[1,1,0]
 v_pk_fma_f32 v[142:143], v[142:143], v[48:49], v[48:49] op_sel:[0,1,0] op_sel_hi:[1,1,0]
 v_cvt_pk_bf16_f32 v60, v136, v137
 v_cvt_pk_bf16_f32 v61, v138, v139
 v_cvt_pk_bf16_f32 v62, v140, v141
 v_cvt_pk_bf16_f32 v63, v142, v143
 s_add_u32 s31, s35, 20480
 v_permlane16_swap_b32 v60, v62
 v_permlane16_swap_b32 v61, v63
 buffer_store_dwordx4 v[60:63], v7, s[4:7], s31 offen offset:0 sc1
 v_pk_fma_f32 v[144:145], v[144:145], v[50:51], v[50:51] op_sel:[0,1,0] op_sel_hi:[1,1,0]
 v_pk_fma_f32 v[146:147], v[146:147], v[50:51], v[50:51] op_sel:[0,1,0] op_sel_hi:[1,1,0]
 v_pk_fma_f32 v[148:149], v[148:149], v[50:51], v[50:51] op_sel:[0,1,0] op_sel_hi:[1,1,0]
 v_pk_fma_f32 v[150:151], v[150:151], v[50:51], v[50:51] op_sel:[0,1,0] op_sel_hi:[1,1,0]
 v_cvt_pk_bf16_f32 v36, v144, v145
 v_cvt_pk_bf16_f32 v37, v146, v147
 v_cvt_pk_bf16_f32 v38, v148, v149
 v_cvt_pk_bf16_f32 v39, v150, v151
 s_add_u32 s31, s35, 16384
 v_permlane16_swap_b32 v36, v38
 v_permlane16_swap_b32 v37, v39
 buffer_store_dwordx4 v[36:39], v7, s[4:7], s31 offen offset:1024 sc1
 v_pk_fma_f32 v[152:153], v[152:153], v[50:51], v[50:51] op_sel:[0,1,0] op_sel_hi:[1,1,0]
 v_pk_fma_f32 v[154:155], v[154:155], v[50:51], v[50:51] op_sel:[0,1,0] op_sel_hi:[1,1,0]
 v_pk_fma_f32 v[156:157], v[156:157], v[50:51], v[50:51] op_sel:[0,1,0] op_sel_hi:[1,1,0]
 v_pk_fma_f32 v[158:159], v[158:159], v[50:51], v[50:51] op_sel:[0,1,0] op_sel_hi:[1,1,0]
 v_cvt_pk_bf16_f32 v60, v152, v153
 v_cvt_pk_bf16_f32 v61, v154, v155
 v_cvt_pk_bf16_f32 v62, v156, v157
 v_cvt_pk_bf16_f32 v63, v158, v159
 s_add_u32 s31, s35, 20480
 v_permlane16_swap_b32 v60, v62
 v_permlane16_swap_b32 v61, v63
 buffer_store_dwordx4 v[60:63], v7, s[4:7], s31 offen offset:1024 sc1
 v_pk_fma_f32 v[160:161], v[160:161], v[52:53], v[52:53] op_sel:[0,1,0] op_sel_hi:[1,1,0]
 v_pk_fma_f32 v[162:163], v[162:163], v[52:53], v[52:53] op_sel:[0,1,0] op_sel_hi:[1,1,0]
 v_pk_fma_f32 v[164:165], v[164:165], v[52:53], v[52:53] op_sel:[0,1,0] op_sel_hi:[1,1,0]
 v_pk_fma_f32 v[166:167], v[166:167], v[52:53], v[52:53] op_sel:[0,1,0] op_sel_hi:[1,1,0]
 v_cvt_pk_bf16_f32 v36, v160, v161
 v_cvt_pk_bf16_f32 v37, v162, v163
 v_cvt_pk_bf16_f32 v38, v164, v165
 v_cvt_pk_bf16_f32 v39, v166, v167
 s_add_u32 s31, s35, 16384
 v_permlane16_swap_b32 v36, v38
 v_permlane16_swap_b32 v37, v39
 buffer_store_dwordx4 v[36:39], v7, s[4:7], s31 offen offset:2048 sc1
 v_pk_fma_f32 v[168:169], v[168:169], v[52:53], v[52:53] op_sel:[0,1,0] op_sel_hi:[1,1,0]
 v_pk_fma_f32 v[170:171], v[170:171], v[52:53], v[52:53] op_sel:[0,1,0] op_sel_hi:[1,1,0]
 v_pk_fma_f32 v[172:173], v[172:173], v[52:53], v[52:53] op_sel:[0,1,0] op_sel_hi:[1,1,0]
 v_pk_fma_f32 v[174:175], v[174:175], v[52:53], v[52:53] op_sel:[0,1,0] op_sel_hi:[1,1,0]
 v_cvt_pk_bf16_f32 v60, v168, v169
 v_cvt_pk_bf16_f32 v61, v170, v171
 v_cvt_pk_bf16_f32 v62, v172, v173
 v_cvt_pk_bf16_f32 v63, v174, v175
 s_add_u32 s31, s35, 20480
 v_permlane16_swap_b32 v60, v62
 v_permlane16_swap_b32 v61, v63
 buffer_store_dwordx4 v[60:63], v7, s[4:7], s31 offen offset:2048 sc1
 v_pk_fma_f32 v[176:177], v[176:177], v[54:55], v[54:55] op_sel:[0,1,0] op_sel_hi:[1,1,0]
 v_pk_fma_f32 v[178:179], v[178:179], v[54:55], v[54:55] op_sel:[0,1,0] op_sel_hi:[1,1,0]
 v_pk_fma_f32 v[180:181], v[180:181], v[54:55], v[54:55] op_sel:[0,1,0] op_sel_hi:[1,1,0]
 v_pk_fma_f32 v[182:183], v[182:183], v[54:55], v[54:55] op_sel:[0,1,0] op_sel_hi:[1,1,0]
 v_cvt_pk_bf16_f32 v36, v176, v177
 v_cvt_pk_bf16_f32 v37, v178, v179
 v_cvt_pk_bf16_f32 v38, v180, v181
 v_cvt_pk_bf16_f32 v39, v182, v183
 s_add_u32 s31, s35, 16384
 v_permlane16_swap_b32 v36, v38
 v_permlane16_swap_b32 v37, v39
 buffer_store_dwordx4 v[36:39], v7, s[4:7], s31 offen offset:3072 sc1
 v_pk_fma_f32 v[184:185], v[184:185], v[54:55], v[54:55] op_sel:[0,1,0] op_sel_hi:[1,1,0]
 v_pk_fma_f32 v[186:187], v[186:187], v[54:55], v[54:55] op_sel:[0,1,0] op_sel_hi:[1,1,0]
 v_pk_fma_f32 v[188:189], v[188:189], v[54:55], v[54:55] op_sel:[0,1,0] op_sel_hi:[1,1,0]
 v_pk_fma_f32 v[190:191], v[190:191], v[54:55], v[54:55] op_sel:[0,1,0] op_sel_hi:[1,1,0]
 v_cvt_pk_bf16_f32 v60, v184, v185
 v_cvt_pk_bf16_f32 v61, v186, v187
 v_cvt_pk_bf16_f32 v62, v188, v189
 v_cvt_pk_bf16_f32 v63, v190, v191
 s_add_u32 s31, s35, 20480
 v_permlane16_swap_b32 v60, v62
 v_permlane16_swap_b32 v61, v63
 buffer_store_dwordx4 v[60:63], v7, s[4:7], s31 offen offset:3072 sc1
 ar v20,a176
 ar v21,a177
 ar v22,a178
 ar v23,a179
 v_pk_mul_f32 v[24:25], v[20:21], v[20:21]
 v_pk_mul_f32 v[26:27], v[22:23], v[22:23]
 v_pk_fma_f32 v[24:25], v[24:25], s[54:55], v[58:59]
 v_pk_fma_f32 v[26:27], v[26:27], s[54:55], v[58:59]
 v_pk_mul_f32 v[24:25], v[24:25], v[20:21]
 v_pk_mul_f32 v[26:27], v[26:27], v[22:23]
 v_exp_f32 v24, v24
 v_exp_f32 v25, v25
 v_exp_f32 v26, v26
 v_exp_f32 v27, v27
 v_pk_add_f32 v[24:25], v[24:25], 1.0 op_sel_hi:[1,0]
 v_pk_add_f32 v[26:27], v[26:27], 1.0 op_sel_hi:[1,0]
 v_rcp_f32 v24, v24
 v_rcp_f32 v25, v25
 v_rcp_f32 v26, v26
 v_rcp_f32 v27, v27
 v_pk_mul_f32 v[20:21], v[20:21], v[24:25]
 v_pk_mul_f32 v[22:23], v[22:23], v[26:27]
 v_cvt_pk_bf16_f32 v226, v20, v21
 v_cvt_pk_bf16_f32 v227, v22, v23
 ar v20,a208
 ar v21,a209
 ar v22,a210
 ar v23,a211
 v_pk_mul_f32 v[24:25], v[20:21], v[20:21]
 v_pk_mul_f32 v[26:27], v[22:23], v[22:23]
 v_pk_fma_f32 v[24:25], v[24:25], s[54:55], v[58:59]
 v_pk_fma_f32 v[26:27], v[26:27], s[54:55], v[58:59]
 v_pk_mul_f32 v[24:25], v[24:25], v[20:21]
 v_pk_mul_f32 v[26:27], v[26:27], v[22:23]
 v_exp_f32 v24, v24
 v_exp_f32 v25, v25
 v_exp_f32 v26, v26
 v_exp_f32 v27, v27
 v_pk_add_f32 v[24:25], v[24:25], 1.0 op_sel_hi:[1,0]
 v_pk_add_f32 v[26:27], v[26:27], 1.0 op_sel_hi:[1,0]
 v_rcp_f32 v24, v24
 v_rcp_f32 v25, v25
 v_rcp_f32 v26, v26
 v_rcp_f32 v27, v27
 v_pk_mul_f32 v[20:21], v[20:21], v[24:25]
 v_pk_mul_f32 v[22:23], v[22:23], v[26:27]
 v_cvt_pk_bf16_f32 v228, v20, v21
 v_cvt_pk_bf16_f32 v229, v22, v23
 ar v20,a240
 ar v21,a241
 ar v22,a242
 ar v23,a243
 v_pk_mul_f32 v[24:25], v[20:21], v[20:21]
 v_pk_mul_f32 v[26:27], v[22:23], v[22:23]
 v_pk_fma_f32 v[24:25], v[24:25], s[54:55], v[58:59]
 v_pk_fma_f32 v[26:27], v[26:27], s[54:55], v[58:59]
 v_pk_mul_f32 v[24:25], v[24:25], v[20:21]
 v_pk_mul_f32 v[26:27], v[26:27], v[22:23]
 v_exp_f32 v24, v24
 v_exp_f32 v25, v25
 v_exp_f32 v26, v26
 v_exp_f32 v27, v27
 v_pk_add_f32 v[24:25], v[24:25], 1.0 op_sel_hi:[1,0]
 v_pk_add_f32 v[26:27], v[26:27], 1.0 op_sel_hi:[1,0]
 v_rcp_f32 v24, v24
 v_rcp_f32 v25, v25
 v_rcp_f32 v26, v26
 v_rcp_f32 v27, v27
 v_pk_mul_f32 v[20:21], v[20:21], v[24:25]
 v_pk_mul_f32 v[22:23], v[22:23], v[26:27]
 v_cvt_pk_bf16_f32 v230, v20, v21
 v_cvt_pk_bf16_f32 v231, v22, v23
 ar v20,a148
 ar v21,a149
 ar v22,a150
 ar v23,a151
 v_pk_mul_f32 v[24:25], v[20:21], v[20:21]
 v_pk_mul_f32 v[26:27], v[22:23], v[22:23]
 v_pk_fma_f32 v[24:25], v[24:25], s[54:55], v[58:59]
 v_pk_fma_f32 v[26:27], v[26:27], s[54:55], v[58:59]
 v_pk_mul_f32 v[24:25], v[24:25], v[20:21]
 v_pk_mul_f32 v[26:27], v[26:27], v[22:23]
 v_exp_f32 v24, v24
 v_exp_f32 v25, v25
 v_exp_f32 v26, v26
 v_exp_f32 v27, v27
 v_pk_add_f32 v[24:25], v[24:25], 1.0 op_sel_hi:[1,0]
 v_pk_add_f32 v[26:27], v[26:27], 1.0 op_sel_hi:[1,0]
 v_rcp_f32 v24, v24
 v_rcp_f32 v25, v25
 v_rcp_f32 v26, v26
 v_rcp_f32 v27, v27
 v_pk_mul_f32 v[20:21], v[20:21], v[24:25]
 v_pk_mul_f32 v[22:23], v[22:23], v[26:27]
 v_cvt_pk_bf16_f32 v232, v20, v21
 v_cvt_pk_bf16_f32 v233, v22, v23
 ar v20,a180
 ar v21,a181
 ar v22,a182
 ar v23,a183
 v_pk_mul_f32 v[24:25], v[20:21], v[20:21]
 v_pk_mul_f32 v[26:27], v[22:23], v[22:23]
 v_pk_fma_f32 v[24:25], v[24:25], s[54:55], v[58:59]
 v_pk_fma_f32 v[26:27], v[26:27], s[54:55], v[58:59]
 v_pk_mul_f32 v[24:25], v[24:25], v[20:21]
 v_pk_mul_f32 v[26:27], v[26:27], v[22:23]
 v_exp_f32 v24, v24
 v_exp_f32 v25, v25
 v_exp_f32 v26, v26
 v_exp_f32 v27, v27
 v_pk_add_f32 v[24:25], v[24:25], 1.0 op_sel_hi:[1,0]
 v_pk_add_f32 v[26:27], v[26:27], 1.0 op_sel_hi:[1,0]
 v_rcp_f32 v24, v24
 v_rcp_f32 v25, v25
 v_rcp_f32 v26, v26
 v_rcp_f32 v27, v27
 v_pk_mul_f32 v[20:21], v[20:21], v[24:25]
 v_pk_mul_f32 v[22:23], v[22:23], v[26:27]
 v_cvt_pk_bf16_f32 v234, v20, v21
 v_cvt_pk_bf16_f32 v235, v22, v23
 ar v20,a212
 ar v21,a213
 ar v22,a214
 ar v23,a215
 v_pk_mul_f32 v[24:25], v[20:21], v[20:21]
 v_pk_mul_f32 v[26:27], v[22:23], v[22:23]
 v_pk_fma_f32 v[24:25], v[24:25], s[54:55], v[58:59]
 v_pk_fma_f32 v[26:27], v[26:27], s[54:55], v[58:59]
 v_pk_mul_f32 v[24:25], v[24:25], v[20:21]
 v_pk_mul_f32 v[26:27], v[26:27], v[22:23]
 v_exp_f32 v24, v24
 v_exp_f32 v25, v25
 v_exp_f32 v26, v26
 v_exp_f32 v27, v27
 v_pk_add_f32 v[24:25], v[24:25], 1.0 op_sel_hi:[1,0]
 v_pk_add_f32 v[26:27], v[26:27], 1.0 op_sel_hi:[1,0]
 v_rcp_f32 v24, v24
 v_rcp_f32 v25, v25
 v_rcp_f32 v26, v26
 v_rcp_f32 v27, v27
 v_pk_mul_f32 v[20:21], v[20:21], v[24:25]
 v_pk_mul_f32 v[22:23], v[22:23], v[26:27]
 v_cvt_pk_bf16_f32 v236, v20, v21
 v_cvt_pk_bf16_f32 v237, v22, v23
 s_lshl_b32 s40, s24, 8
 s_nop 0
 s_add_u32 s40, s40, 4096
 s_lshl_b32 s41, s23, 3
 s_add_u32 s41, s41, s40
 s_waitcnt vmcnt(0)
 s_barrier
 s_cmp_lg_u32 s20, 0
 s_cbranch_scc1 L_sig_28
 s_mov_b64 exec, 1
 v_mov_b32 v5, 0
 v_mov_b32 v6, s36
 v_mov_b32 v7, s37
 buffer_store_dwordx2 v[6:7], v5, s[16:19], s41 offen sc1
 s_mov_b64 exec, -1
L_sig_28:
 s_cmp_eq_u32 s20, 0
 s_cbranch_scc1 L_stub_wg2_13604
 s_cmp_eq_u32 s20, 1
 s_cbranch_scc1 L_stub_wg2_14141
 s_cmp_eq_u32 s20, 2
 s_cbranch_scc1 L_stub_wg2_14709
 s_branch L_stub_wg2_15252
 s_nop 0
L_rwg2:
 s_nop 0
 v_lshl_add_u32 v5, v2, 3, v3
 v_lshlrev_b32 v5, 6, v5
 v_and_b32 v6, 1, v4
 v_lshl_add_u32 v5, v6, 3, v5
 s_lshl_b32 s31, s21, 13
 v_add_u32 v5, s31, v5
 v_and_b32 v6, 1, v2
 v_lshlrev_b32 v6, 1, v6
 v_lshrrev_b32 v7, 1, v4
 v_add_u32 v17, 0, v7
 v_xor_b32_e64 v17, v17, v6
 v_lshl_add_u32 v20, v17, 4, v5
 v_add_u32 v22, 98304, v20
 v_add_u32 v17, 2, v7
 v_xor_b32 v17, v17, v6
 v_lshl_add_u32 v21, v17, 4, v5
 v_add_u32 v23, 98304, v21
 v_and_b32 v6, 15, v1
 s_lshl_b32 s31, s22, 14
 s_add_u32 s31, s31, 16384
 v_lshlrev_b32 v5, 7, v6
 v_add_u32 v5, s31, v5
 v_lshrrev_b32 v6, 1, v6
 v_add_u32 v7, 0, v2
 v_xor_b32_e64 v7, v7, v6
 v_lshl_add_u32 v24, v7, 4, v5
 v_add_u32 v26, 98304, v24
 v_add_u32 v7, 4, v2
 v_xor_b32 v7, v7, v6
 v_lshl_add_u32 v25, v7, 4, v5
 v_add_u32 v27, 98304, v25
 s_lshl_b32 s40, s24, 8
 s_nop 0
 s_add_u32 s40, s40, 4096
 s_and_b32 s41, s23, 4
 s_lshl_b32 s41, s41, 3
 s_add_u32 s41, s41, s40
 s_and_b32 s42, s23, 3
 s_cmp_lg_u32 s20, 0
 s_cbranch_scc1 L_wt_29
 v_min_u32 v5, 3, v1
 v_cmp_eq_u32 vcc, s42, v5
 v_xor_b32 v6, 1, v5
 s_nop 0
 v_cndmask_b32 v5, v5, v6, vcc
 v_lshlrev_b32 v5, 3, v5
 s_mov_b32 s80, 0x20000
 s_branch L_poll_30
L_again_31:
 s_sub_u32 s80, s80, 1
 s_cbranch_scc1 L_wt_29
 s_sleep 2
L_poll_30:
 buffer_load_dwordx2 v[6:7], v5, s[16:19], s41 offen sc1
 s_branch L_skip_13061
.p2align 12
L_stub_wg_13061:
 s_branch L_stub_wg_14709
 s_nop 0
 s_nop 0
 s_nop 0
L_skip_13061:
 s_waitcnt vmcnt(0)
 v_cmp_ne_u64 vcc, s[36:37], v[6:7]
 s_cmp_lg_u64 vcc, 0
 s_cbranch_scc1 L_again_31
L_wt_29:
 s_barrier
 s_add_u32 m0, s29, 0
 s_nop 0
 s_nop 0
 buffer_load_dwordx4 v8, s[4:7], s26 offen offset:0 sc1 lds
 buffer_load_dwordx4 v8, s[4:7], s26 offen offset:1024 sc1 lds
 buffer_load_dwordx4 v8, s[4:7], s26 offen offset:2048 sc1 lds
 buffer_load_dwordx4 v8, s[4:7], s26 offen offset:3072 sc1 lds
 s_add_u32 s52, s52, 16384
 s_and_b32 s52, s52, 0x7ffff
 s_add_u32 s26, s50, s52
 s_nop 0
 s_add_u32 m0, s29, 49152
 s_nop 0
 s_nop 0
 buffer_load_dwordx4 v8, s[4:7], s26 offen offset:0 sc1 lds
 buffer_load_dwordx4 v8, s[4:7], s26 offen offset:1024 sc1 lds
 buffer_load_dwordx4 v8, s[4:7], s26 offen offset:2048 sc1 lds
 buffer_load_dwordx4 v8, s[4:7], s26 offen offset:3072 sc1 lds
 s_add_u32 s52, s52, 16384
 s_and_b32 s52, s52, 0x7ffff
 s_add_u32 s26, s50, s52
 s_waitcnt vmcnt(4)
 s_barrier
 s_nop 0
 rd a[16:19],v24,0
 tr a[0:1],v20,0
 tr a[2:3],v20,256
 rd a[20:23],v24,2048
 tr a[4:5],v21,0
 tr a[6:7],v21,256
 rd a[24:27],v24,4096
 tr a[8:9],v20,4096
 tr a[10:11],v20,4352
 rd a[28:31],v24,6144
 tr a[12:13],v21,4096
 tr a[14:15],v21,4352
 rd a[32:35],v24,8192
 rd a[36:39],v24,10240
 rd a[40:43],v24,12288
 rd a[44:47],v24,14336
 v_min_u32 v5, 7, v1
 v_lshlrev_b32 v5, 3, v5
 s_waitcnt lgkmcnt(0)
 s_nop 0
 mf v[64:67],a[0:3],a[16:19],0
 rd a[64:67],v25,0
 ar v36,a244
 mf v[68:71],a[4:7],a[16:19],0
 tr a[48:49],v20,2048
 mf v[84:87],a[4:7],a[20:23],0
 tr a[50:51],v20,2304
 ar v37,a245
 mf v[80:83],a[0:3],a[20:23],0
 rd a[68:71],v25,2048
 s_add_u32 m0, s29, 98304
 mf v[96:99],a[0:3],a[24:27],0
 buffer_load_dwordx4 v8, s[4:7], s26 offen offset:0 sc1 lds
 mf v[100:103],a[4:7],a[24:27],0
 tr a[52:53],v21,2048
 ar v38,a246
 mf v[116:119],a[4:7],a[28:31],0
 tr a[54:55],v21,2304
 mf v[112:115],a[0:3],a[28:31],0
 rd a[72:75],v25,4096
 ar v39,a247
 mf v[128:131],a[0:3],a[32:35],0
 tr a[56:57],v20,6144
 v_mul_f32_e64 v40, v36, v36
 mf v[132:135],a[4:7],a[32:35],0
 v_mul_f32_e64 v41, v37, v37
 mf v[148:151],a[4:7],a[36:39],0
 tr a[58:59],v20,6400
 mf v[144:147],a[0:3],a[36:39],0
 buffer_load_dwordx4 v8, s[4:7], s26 offen offset:1024 sc1 lds
 mf v[160:163],a[0:3],a[40:43],0
 rd a[76:79],v25,6144
 v_mul_f32_e64 v42, v38, v38
 mf v[164:167],a[4:7],a[40:43],0
 tr a[60:61],v21,6144
 v_mul_f32_e64 v43, v39, v39
 mf v[180:183],a[4:7],a[44:47],0
 tr a[62:63],v21,6400
 mf v[176:179],a[0:3],a[44:47],0
 rd a[80:83],v25,8192
 v_fma_f32 v40, v40, s54, v58
 mf v[184:187],a[8:11],a[44:47],0
 rd a[84:87],v25,10240
 v_fma_f32 v41, v41, s54, v58
 mf v[188:191],a[12:15],a[44:47],0
 rd a[88:91],v25,12288
 mf v[172:175],a[12:15],a[40:43],0
 buffer_load_dwordx4 v8, s[4:7], s26 offen offset:2048 sc1 lds
 mf v[168:171],a[8:11],a[40:43],0
 rd a[92:95],v25,14336
 v_fma_f32 v42, v42, s54, v58
 mf v[152:155],a[8:11],a[36:39],0
 v_fma_f32 v43, v43, s54, v58
 mf v[156:159],a[12:15],a[36:39],0
 v_mul_f32 v40, v40, v36
 v_mul_f32 v41, v41, v37
 mf v[140:143],a[12:15],a[32:35],0
 v_mul_f32_e64 v42, v42, v38
 mf v[136:139],a[8:11],a[32:35],0
 v_mul_f32_e64 v43, v43, v39
 mf v[120:123],a[8:11],a[28:31],0
 mf v[124:127],a[12:15],a[28:31],0
 buffer_load_dwordx4 v8, s[4:7], s26 offen offset:3072 sc1 lds
 mf v[108:111],a[12:15],a[24:27],0
 s_add_u32 s52, s52, 16384
 v_exp_f32_e64 v40, v40
 mf v[104:107],a[8:11],a[24:27],0
 s_and_b32 s52, s52, 0x7ffff
 mf v[88:91],a[8:11],a[20:23],0
 s_add_u32 s26, s50, s52
 s_nop 0
 mf v[92:95],a[12:15],a[20:23],0
 v_exp_f32_e64 v41, v41
 mf v[76:79],a[12:15],a[16:19],0
 s_waitcnt vmcnt(4) lgkmcnt(0)
 s_nop 0
 mf v[72:75],a[8:11],a[16:19],0
 v_exp_f32 v42, v42
 s_barrier
 mf v[64:67],a[48:51],a[64:67],v[64:67]
 rd a[16:19],v24,49152
 mf v[68:71],a[52:55],a[64:67],v[68:71]
 tr a[0:1],v20,49152
 v_exp_f32_e64 v43, v43
 mf v[84:87],a[52:55],a[68:71],v[84:87]
 tr a[2:3],v20,49408
 s_add_u32 m0, s29, 0
 s_nop 0
 mf v[80:83],a[48:51],a[68:71],v[80:83]
 buffer_load_dwordx4 v8, s[4:7], s26 offen offset:0 sc1 lds
 mf v[96:99],a[48:51],a[72:75],v[96:99]
 rd a[20:23],v24,51200
 v_add_f32_e64 v40, 1.0, v40
 mf v[100:103],a[52:55],a[72:75],v[100:103]
 tr a[4:5],v21,49152
 mf v[116:119],a[52:55],a[76:79],v[116:119]
 tr a[6:7],v21,49408
 v_add_f32_e64 v41, 1.0, v41
 mf v[112:115],a[48:51],a[76:79],v[112:115]
 buffer_load_dwordx4 v8, s[4:7], s26 offen offset:1024 sc1 lds
 mf v[128:131],a[48:51],a[80:83],v[128:131]
 rd a[24:27],v24,53248
 v_add_f32_e64 v42, 1.0, v42
 mf v[132:135],a[52:55],a[80:83],v[132:135]
 tr a[8:9],v20,53248
 v_add_f32_e64 v43, 1.0, v43
 mf v[148:151],a[52:55],a[84:87],v[148:151]
 tr a[10:11],v20,53504
 mf v[144:147],a[48:51],a[84:87],v[144:147]
 rd a[28:31],v24,55296
 v_rcp_f32_e64 v40, v40
 mf v[160:163],a[48:51],a[88:91],v[160:163]
 buffer_load_dwordx4 v8, s[4:7], s26 offen offset:2048 sc1 lds
 mf v[164:167],a[52:55],a[88:91],v[164:167]
 tr a[12:13],v21,53248
 mf v[180:183],a[52:55],a[92:95],v[180:183]
 tr a[14:15],v21,53504
 mf v[176:179],a[48:51],a[92:95],v[176:179]
 rd a[32:35],v24,57344
 v_rcp_f32_e64 v41, v41
 mf v[184:187],a[56:59],a[92:95],v[184:187]
 rd a[36:39],v24,59392
 mf v[188:191],a[60:63],a[92:95],v[188:191]
 buffer_load_dwordx4 v8, s[4:7], s26 offen offset:3072 sc1 lds
 mf v[172:175],a[60:63],a[88:91],v[172:175]
 rd a[40:43],v24,61440
 s_add_u32 s52, s52, 16384
 mf v[168:171],a[56:59],a[88:91],v[168:171]
 rd a[44:47],v24,63488
 s_and_b32 s52, s52, 0x7ffff
 mf v[152:155],a[56:59],a[84:87],v[152:155]
 s_add_u32 s26, s50, s52
 v_rcp_f32 v42, v42
 mf v[156:159],a[60:63],a[84:87],v[156:159]
 s_add_u32 m0, s28, 16384
 mf v[140:143],a[60:63],a[80:83],v[140:143]
 buffer_load_dwordx4 v9, s[8:11], s27 offen offset:0 lds
 mf v[136:139],a[56:59],a[80:83],v[136:139]
 v_rcp_f32 v43, v43
 v_mul_f32 v36, v36, v40
 mf v[120:123],a[56:59],a[76:79],v[120:123]
 v_mul_f32_e64 v37, v37, v41
 mf v[124:127],a[60:63],a[76:79],v[124:127]
 v_mul_f32 v38, v38, v42
 v_mul_f32 v39, v39, v43
 mf v[108:111],a[60:63],a[72:75],v[108:111]
 v_cvt_pk_bf16_f32 v238, v36, v37
 v_cvt_pk_bf16_f32 v239, v38, v39
 mf v[104:107],a[56:59],a[72:75],v[104:107]
 buffer_load_dwordx4 v10, s[8:11], s27 offen offset:1024 lds
 mf v[88:91],a[56:59],a[68:71],v[88:91]
 ar v36,a152
 ar v37,a153
 mf v[92:95],a[60:63],a[68:71],v[92:95]
 ar v38,a154
 mf v[76:79],a[60:63],a[64:67],v[76:79]
 ar v39,a155
 s_waitcnt lgkmcnt(0)
 s_nop 0
 mf v[72:75],a[56:59],a[64:67],v[72:75]
 v_mul_f32_e64 v40, v36, v36
 mf v[64:67],a[0:3],a[16:19],v[64:67]
 rd a[64:67],v25,49152
 v_mul_f32_e64 v41, v37, v37
 mf v[68:71],a[4:7],a[16:19],v[68:71]
 tr a[48:49],v20,51200
 v_mul_f32_e64 v42, v38, v38
 mf v[84:87],a[4:7],a[20:23],v[84:87]
 tr a[50:51],v20,51456
 mf v[80:83],a[0:3],a[20:23],v[80:83]
 buffer_load_dwordx4 v11, s[8:11], s27 offen offset:2048 lds
 mf v[96:99],a[0:3],a[24:27],v[96:99]
 rd a[68:71],v25,51200
 v_mul_f32_e64 v43, v39, v39
 mf v[100:103],a[4:7],a[24:27],v[100:103]
 tr a[52:53],v21,51200
 v_fma_f32 v40, v40, s54, v58
 mf v[116:119],a[4:7],a[28:31],v[116:119]
 tr a[54:55],v21,51456
 v_fma_f32 v41, v41, s54, v58
 mf v[112:115],a[0:3],a[28:31],v[112:115]
 buffer_load_dwordx4 v12, s[8:11], s27 offen offset:3072 lds
 mf v[128:131],a[0:3],a[32:35],v[128:131]
 rd a[72:75],v25,53248
 mf v[132:135],a[4:7],a[32:35],v[132:135]
 tr a[56:57],v20,55296
 v_fma_f32 v42, v42, s54, v58
 mf v[148:151],a[4:7],a[36:39],v[148:151]
 tr a[58:59],v20,55552
 v_fma_f32 v43, v43, s54, v58
 mf v[144:147],a[0:3],a[36:39],v[144:147]
 rd a[76:79],v25,55296
 s_add_u32 m0, s28, 20480
 mf v[160:163],a[0:3],a[40:43],v[160:163]
 buffer_load_dwordx4 v13, s[8:11], s27 offen offset:0 lds
 mf v[164:167],a[4:7],a[40:43],v[164:167]
 tr a[60:61],v21,55296
 v_mul_f32_e64 v40, v40, v36
 mf v[180:183],a[4:7],a[44:47],v[180:183]
 tr a[62:63],v21,55552
 mf v[176:179],a[0:3],a[44:47],v[176:179]
 rd a[80:83],v25,57344
 v_mul_f32_e64 v41, v41, v37
 mf v[184:187],a[8:11],a[44:47],v[184:187]
 rd a[84:87],v25,59392
 v_mul_f32_e64 v42, v42, v38
 mf v[188:191],a[12:15],a[44:47],v[188:191]
 buffer_load_dwordx4 v14, s[8:11], s27 offen offset:1024 lds
 mf v[172:175],a[12:15],a[40:43],v[172:175]
 rd a[88:91],v25,61440
 v_mul_f32_e64 v43, v43, v39
 mf v[168:171],a[8:11],a[40:43],v[168:171]
 rd a[92:95],v25,63488
 mf v[152:155],a[8:11],a[36:39],v[152:155]
 v_exp_f32_e64 v40, v40
 mf v[156:159],a[12:15],a[36:39],v[156:159]
 v_exp_f32_e64 v41, v41
 mf v[140:143],a[12:15],a[32:35],v[140:143]
 buffer_load_dwordx4 v15, s[8:11], s27 offen offset:2048 lds
 mf v[136:139],a[8:11],a[32:35],v[136:139]
 mf v[120:123],a[8:11],a[28:31],v[120:123]
 v_exp_f32_e64 v42, v42
 mf v[124:127],a[12:15],a[28:31],v[124:127]
 v_exp_f32_e64 v43, v43
 mf v[108:111],a[12:15],a[24:27],v[108:111]
 v_add_f32 v40, 1.0, v40
 v_add_f32 v41, 1.0, v41
 mf v[104:107],a[8:11],a[24:27],v[104:107]
 buffer_load_dwordx4 v16, s[8:11], s27 offen offset:3072 lds
 mf v[88:91],a[8:11],a[20:23],v[88:91]
 s_add_u32 s53, s53, 128
 s_and_b32 s53, s53, 0xfff
 mf v[92:95],a[12:15],a[20:23],v[92:95]
 s_add_u32 s27, s51, s53
 s_nop 0
 mf v[76:79],a[12:15],a[16:19],v[76:79]
 v_add_f32 v42, 1.0, v42
 s_waitcnt vmcnt(12) lgkmcnt(0)
 mf v[72:75],a[8:11],a[16:19],v[72:75]
 v_add_f32 v43, 1.0, v43
 s_barrier
 mf v[64:67],a[48:51],a[64:67],v[64:67]
 rd a[16:19],v26,0
 mf v[68:71],a[52:55],a[64:67],v[68:71]
 tr a[0:1],v22,0
 v_rcp_f32_e64 v40, v40
 mf v[84:87],a[52:55],a[68:71],v[84:87]
 tr a[2:3],v22,256
 s_add_u32 m0, s29, 49152
 mf v[80:83],a[48:51],a[68:71],v[80:83]
 buffer_load_dwordx4 v8, s[4:7], s26 offen offset:0 sc1 lds
 mf v[96:99],a[48:51],a[72:75],v[96:99]
 rd a[20:23],v26,2048
 mf v[100:103],a[52:55],a[72:75],v[100:103]
 tr a[4:5],v23,0
 mf v[116:119],a[52:55],a[76:79],v[116:119]
 tr a[6:7],v23,256
 v_rcp_f32_e64 v41, v41
 mf v[112:115],a[48:51],a[76:79],v[112:115]
 buffer_load_dwordx4 v8, s[4:7], s26 offen offset:1024 sc1 lds
 mf v[128:131],a[48:51],a[80:83],v[128:131]
 rd a[24:27],v26,4096
 mf v[132:135],a[52:55],a[80:83],v[132:135]
 tr a[8:9],v22,4096
 v_rcp_f32_e64 v42, v42
 mf v[148:151],a[52:55],a[84:87],v[148:151]
 tr a[10:11],v22,4352
 mf v[144:147],a[48:51],a[84:87],v[144:147]
 rd a[28:31],v26,6144
 mf v[160:163],a[48:51],a[88:91],v[160:163]
 buffer_load_dwordx4 v8, s[4:7], s26 offen offset:2048 sc1 lds
 mf v[164:167],a[52:55],a[88:91],v[164:167]
 tr a[12:13],v23,4096
 v_rcp_f32_e64 v43, v43
 mf v[180:183],a[52:55],a[92:95],v[180:183]
 tr a[14:15],v23,4352
 v_mul_f32_e64 v36, v36, v40
 mf v[176:179],a[48:51],a[92:95],v[176:179]
 rd a[32:35],v26,8192
 v_mul_f32_e64 v37, v37, v41
 mf v[184:187],a[56:59],a[92:95],v[184:187]
 rd a[36:39],v26,10240
 v_mul_f32_e64 v38, v38, v42
 mf v[188:191],a[60:63],a[92:95],v[188:191]
 buffer_load_dwordx4 v8, s[4:7], s26 offen offset:3072 sc1 lds
 mf v[172:175],a[60:63],a[88:91],v[172:175]
 rd a[40:43],v26,12288
 s_add_u32 s52, s52, 16384
 mf v[168:171],a[56:59],a[88:91],v[168:171]
 rd a[44:47],v26,14336
 s_and_b32 s52, s52, 0x7ffff
 mf v[152:155],a[56:59],a[84:87],v[152:155]
 s_add_u32 s26, s50, s52
 v_mul_f32 v39, v39, v43
 mf v[156:159],a[60:63],a[84:87],v[156:159]
 s_add_u32 m0, s28, 65536
 mf v[140:143],a[60:63],a[80:83],v[140:143]
 buffer_load_dwordx4 v9, s[8:11], s27 offen offset:0 lds
 mf v[136:139],a[56:59],a[80:83],v[136:139]
 v_cvt_pk_bf16_f32 v240, v36, v37
 v_cvt_pk_bf16_f32 v241, v38, v39
 mf v[120:123],a[56:59],a[76:79],v[120:123]
 ar v36,a184
 ar v37,a185
 mf v[124:127],a[60:63],a[76:79],v[124:127]
 ar v38,a186
 mf v[108:111],a[60:63],a[72:75],v[108:111]
 ar v39,a187
 v_mul_f32_e64 v40, v36, v36
 mf v[104:107],a[56:59],a[72:75],v[104:107]
 buffer_load_dwordx4 v10, s[8:11], s27 offen offset:1024 lds
 mf v[88:91],a[56:59],a[68:71],v[88:91]
 v_mul_f32 v41, v37, v37
 v_mul_f32 v42, v38, v38
 mf v[92:95],a[60:63],a[68:71],v[92:95]
 v_mul_f32_e64 v43, v39, v39
 mf v[76:79],a[60:63],a[64:67],v[76:79]
 v_fma_f32 v40, v40, s54, v58
 s_waitcnt lgkmcnt(0)
 s_nop 0
 mf v[72:75],a[56:59],a[64:67],v[72:75]
 v_fma_f32 v41, v41, s54, v58
 mf v[64:67],a[0:3],a[16:19],v[64:67]
 rd a[64:67],v27,0
 v_fma_f32 v42, v42, s54, v58
 mf v[68:71],a[4:7],a[16:19],v[68:71]
 tr a[48:49],v22,2048
 v_fma_f32 v43, v43, s54, v58
 mf v[84:87],a[4:7],a[20:23],v[84:87]
 tr a[50:51],v22,2304
 v_mul_f32_e64 v40, v40, v36
 mf v[80:83],a[0:3],a[20:23],v[80:83]
 buffer_load_dwordx2 v[6:7], v5, s[16:19], s40 offen sc1
 mf v[96:99],a[0:3],a[24:27],v[96:99]
 rd a[68:71],v27,2048
 v_mul_f32_e64 v41, v41, v37
 mf v[100:103],a[4:7],a[24:27],v[100:103]
 tr a[52:53],v23,2048
 v_mul_f32_e64 v42, v42, v38
 mf v[116:119],a[4:7],a[28:31],v[116:119]
 tr a[54:55],v23,2304
 v_mul_f32_e64 v43, v43, v39
 mf v[112:115],a[0:3],a[28:31],v[112:115]
 buffer_load_dwordx4 v11, s[8:11], s27 offen offset:2048 lds
 mf v[128:131],a[0:3],a[32:35],v[128:131]
 rd a[72:75],v27,4096
 mf v[132:135],a[4:7],a[32:35],v[132:135]
 tr a[56:57],v22,6144
 v_exp_f32_e64 v40, v40
 mf v[148:151],a[4:7],a[36:39],v[148:151]
 tr a[58:59],v22,6400
 mf v[144:147],a[0:3],a[36:39],v[144:147]
 buffer_load_dwordx4 v12, s[8:11], s27 offen offset:3072 lds
 mf v[160:163],a[0:3],a[40:43],v[160:163]
 rd a[76:79],v27,6144
 v_exp_f32_e64 v41, v41
 mf v[164:167],a[4:7],a[40:43],v[164:167]
 tr a[60:61],v23,6144
 mf v[180:183],a[4:7],a[44:47],v[180:183]
 tr a[62:63],v23,6400
 s_add_u32 m0, s28, 69632
 mf v[176:179],a[0:3],a[44:47],v[176:179]
 buffer_load_dwordx4 v13, s[8:11], s27 offen offset:0 lds
 mf v[184:187],a[8:11],a[44:47],v[184:187]
 rd a[80:83],v27,8192
 v_exp_f32_e64 v42, v42
 mf v[188:191],a[12:15],a[44:47],v[188:191]
 rd a[84:87],v27,10240
 mf v[172:175],a[12:15],a[40:43],v[172:175]
 rd a[88:91],v27,12288
 v_exp_f32_e64 v43, v43
 mf v[168:171],a[8:11],a[40:43],v[168:171]
 buffer_load_dwordx4 v14, s[8:11], s27 offen offset:1024 lds
 mf v[152:155],a[8:11],a[36:39],v[152:155]
 rd a[92:95],v27,14336
 v_add_f32_e64 v40, 1.0, v40
 mf v[156:159],a[12:15],a[36:39],v[156:159]
 v_add_f32 v41, 1.0, v41
 v_add_f32 v42, 1.0, v42
 mf v[140:143],a[12:15],a[32:35],v[140:143]
 v_add_f32_e64 v43, 1.0, v43
 mf v[136:139],a[8:11],a[32:35],v[136:139]
 buffer_load_dwordx4 v15, s[8:11], s27 offen offset:2048 lds
 mf v[120:123],a[8:11],a[28:31],v[120:123]
 v_rcp_f32_e64 v40, v40
 mf v[124:127],a[12:15],a[28:31],v[124:127]
 v_rcp_f32_e64 v41, v41
 mf v[108:111],a[12:15],a[24:27],v[108:111]
 v_rcp_f32_e64 v42, v42
 mf v[104:107],a[8:11],a[24:27],v[104:107]
 buffer_load_dwordx4 v16, s[8:11], s27 offen offset:3072 lds
 mf v[88:91],a[8:11],a[20:23],v[88:91]
 s_add_u32 s53, s53, 128
 s_and_b32 s53, s53, 0xfff
 mf v[92:95],a[12:15],a[20:23],v[92:95]
 s_add_u32 s27, s51, s53
 v_rcp_f32 v43, v43
 mf v[76:79],a[12:15],a[16:19],v[76:79]
 v_mul_f32 v36, v36, v40
 s_waitcnt vmcnt(13) lgkmcnt(0)
 mf v[72:75],a[8:11],a[16:19],v[72:75]
 v_mul_f32 v37, v37, v41
 s_barrier
 mf v[64:67],a[48:51],a[64:67],v[64:67]
 rd a[16:19],v24,0
 v_mul_f32_e64 v38, v38, v42
 mf v[68:71],a[52:55],a[64:67],v[68:71]
 tr a[0:1],v20,0
 mf v[84:87],a[52:55],a[68:71],v[84:87]
 tr a[2:3],v20,256
 s_add_u32 m0, s29, 98304
 mf v[80:83],a[48:51],a[68:71],v[80:83]
 buffer_load_dwordx4 v8, s[4:7], s26 offen offset:0 sc1 lds
 mf v[96:99],a[48:51],a[72:75],v[96:99]
 rd a[20:23],v24,2048
 v_mul_f32_e64 v39, v39, v43
 mf v[100:103],a[52:55],a[72:75],v[100:103]
 tr a[4:5],v21,0
 v_cvt_pk_bf16_f32 v242, v36, v37
 mf v[116:119],a[52:55],a[76:79],v[116:119]
 tr a[6:7],v21,256
 mf v[112:115],a[48:51],a[76:79],v[112:115]
 buffer_load_dwordx4 v8, s[4:7], s26 offen offset:1024 sc1 lds
 mf v[128:131],a[48:51],a[80:83],v[128:131]
 rd a[24:27],v24,4096
 v_cvt_pk_bf16_f32 v243, v38, v39
 mf v[132:135],a[52:55],a[80:83],v[132:135]
 tr a[8:9],v20,4096
 ar v36,a216
 mf v[148:151],a[52:55],a[84:87],v[148:151]
 tr a[10:11],v20,4352
 mf v[144:147],a[48:51],a[84:87],v[144:147]
 rd a[28:31],v24,6144
 ar v37,a217
 mf v[160:163],a[48:51],a[88:91],v[160:163]
 buffer_load_dwordx4 v8, s[4:7], s26 offen offset:2048 sc1 lds
 mf v[164:167],a[52:55],a[88:91],v[164:167]
 tr a[12:13],v21,4096
 ar v38,a218
 mf v[180:183],a[52:55],a[92:95],v[180:183]
 tr a[14:15],v21,4352
 mf v[176:179],a[48:51],a[92:95],v[176:179]
 rd a[32:35],v24,8192
 ar v39,a219
 mf v[184:187],a[56:59],a[92:95],v[184:187]
 rd a[36:39],v24,10240
 v_mul_f32_e64 v40, v36, v36
 mf v[188:191],a[60:63],a[92:95],v[188:191]
 buffer_load_dwordx4 v8, s[4:7], s26 offen offset:3072 sc1 lds
 mf v[172:175],a[60:63],a[88:91],v[172:175]
 rd a[40:43],v24,12288
 s_add_u32 s52, s52, 16384
 mf v[168:171],a[56:59],a[88:91],v[168:171]
 rd a[44:47],v24,14336
 s_and_b32 s52, s52, 0x7ffff
 mf v[152:155],a[56:59],a[84:87],v[152:155]
 s_add_u32 s26, s50, s52
 s_nop 0
 mf v[156:159],a[60:63],a[84:87],v[156:159]
 s_add_u32 m0, s28, 114688
 v_mul_f32_e64 v41, v37, v37
 mf v[140:143],a[60:63],a[80:83],v[140:143]
 buffer_load_dwordx4 v9, s[8:11], s27 offen offset:0 lds
 mf v[136:139],a[56:59],a[80:83],v[136:139]
 v_mul_f32_e64 v42, v38, v38
 mf v[120:123],a[56:59],a[76:79],v[120:123]
 v_mul_f32_e64 v43, v39, v39
 mf v[124:127],a[60:63],a[76:79],v[124:127]
 v_fma_f32 v40, v40, s54, v58
 v_fma_f32 v41, v41, s54, v58
 mf v[108:111],a[60:63],a[72:75],v[108:111]
 v_fma_f32 v42, v42, s54, v58
 mf v[104:107],a[56:59],a[72:75],v[104:107]
 buffer_load_dwordx4 v10, s[8:11], s27 offen offset:1024 lds
 mf v[88:91],a[56:59],a[68:71],v[88:91]
 v_fma_f32 v43, v43, s54, v58
 mf v[92:95],a[60:63],a[68:71],v[92:95]
 v_mul_f32 v40, v40, v36
 v_mul_f32 v41, v41, v37
 mf v[76:79],a[60:63],a[64:67],v[76:79]
 s_waitcnt lgkmcnt(0)
 s_nop 0
 mf v[72:75],a[56:59],a[64:67],v[72:75]
 v_mul_f32_e64 v42, v42, v38
 mf v[64:67],a[0:3],a[16:19],v[64:67]
 rd a[64:67],v25,0
 v_mul_f32_e64 v43, v43, v39
 mf v[68:71],a[4:7],a[16:19],v[68:71]
 tr a[48:49],v20,2048
 mf v[84:87],a[4:7],a[20:23],v[84:87]
 tr a[50:51],v20,2304
 v_exp_f32_e64 v40, v40
 mf v[80:83],a[0:3],a[20:23],v[80:83]
 s_branch L_skip_13604
.p2align 12
L_stub_wg_13604:
 s_branch L_stub_wg_15252
L_stub_wg2_13604:
 s_branch L_stub_wg2_15788
 s_nop 0
 s_nop 0
L_skip_13604:
 buffer_load_dwordx4 v11, s[8:11], s27 offen offset:2048 lds
 mf v[96:99],a[0:3],a[24:27],v[96:99]
 rd a[68:71],v25,2048
 mf v[100:103],a[4:7],a[24:27],v[100:103]
 tr a[52:53],v21,2048
 v_exp_f32_e64 v41, v41
 mf v[116:119],a[4:7],a[28:31],v[116:119]
 tr a[54:55],v21,2304
 mf v[112:115],a[0:3],a[28:31],v[112:115]
 buffer_load_dwordx4 v12, s[8:11], s27 offen offset:3072 lds
 mf v[128:131],a[0:3],a[32:35],v[128:131]
 rd a[72:75],v25,4096
 v_exp_f32_e64 v42, v42
 mf v[132:135],a[4:7],a[32:35],v[132:135]
 tr a[56:57],v20,6144
 mf v[148:151],a[4:7],a[36:39],v[148:151]
 tr a[58:59],v20,6400
 mf v[144:147],a[0:3],a[36:39],v[144:147]
 rd a[76:79],v25,6144
 s_add_u32 m0, s28, 118784
 mf v[160:163],a[0:3],a[40:43],v[160:163]
 buffer_load_dwordx4 v13, s[8:11], s27 offen offset:0 lds
 mf v[164:167],a[4:7],a[40:43],v[164:167]
 tr a[60:61],v21,6144
 v_exp_f32_e64 v43, v43
 mf v[180:183],a[4:7],a[44:47],v[180:183]
 tr a[62:63],v21,6400
 v_add_f32_e64 v40, 1.0, v40
 mf v[176:179],a[0:3],a[44:47],v[176:179]
 rd a[80:83],v25,8192
 v_add_f32_e64 v41, 1.0, v41
 mf v[184:187],a[8:11],a[44:47],v[184:187]
 rd a[84:87],v25,10240
 v_add_f32_e64 v42, 1.0, v42
 mf v[188:191],a[12:15],a[44:47],v[188:191]
 buffer_load_dwordx4 v14, s[8:11], s27 offen offset:1024 lds
 mf v[172:175],a[12:15],a[40:43],v[172:175]
 rd a[88:91],v25,12288
 v_add_f32_e64 v43, 1.0, v43
 mf v[168:171],a[8:11],a[40:43],v[168:171]
 rd a[92:95],v25,14336
 mf v[152:155],a[8:11],a[36:39],v[152:155]
 v_rcp_f32_e64 v40, v40
 mf v[156:159],a[12:15],a[36:39],v[156:159]
 v_rcp_f32_e64 v41, v41
 mf v[140:143],a[12:15],a[32:35],v[140:143]
 buffer_load_dwordx4 v15, s[8:11], s27 offen offset:2048 lds
 mf v[136:139],a[8:11],a[32:35],v[136:139]
 v_rcp_f32_e64 v42, v42
 mf v[120:123],a[8:11],a[28:31],v[120:123]
 v_rcp_f32_e64 v43, v43
 mf v[124:127],a[12:15],a[28:31],v[124:127]
 v_mul_f32 v36, v36, v40
 v_mul_f32 v37, v37, v41
 mf v[108:111],a[12:15],a[24:27],v[108:111]
 v_mul_f32 v38, v38, v42
 v_mul_f32 v39, v39, v43
 mf v[104:107],a[8:11],a[24:27],v[104:107]
 buffer_load_dwordx4 v16, s[8:11], s27 offen offset:3072 lds
 mf v[88:91],a[8:11],a[20:23],v[88:91]
 s_add_u32 s53, s53, 128
 s_and_b32 s53, s53, 0xfff
 mf v[92:95],a[12:15],a[20:23],v[92:95]
 s_add_u32 s27, s51, s53
 s_nop 0
 v_cvt_pk_bf16_f32 v244, v36, v37
 mf v[76:79],a[12:15],a[16:19],v[76:79]
 v_cvt_pk_bf16_f32 v245, v38, v39
 s_waitcnt vmcnt(12) lgkmcnt(0)
 s_nop 0
 mf v[72:75],a[8:11],a[16:19],v[72:75]
 ar v36,a248
 s_barrier
 s_waitcnt vmcnt(18)
 v_cmp_ne_u64 vcc, s[36:37], v[6:7]
 s_cmp_lg_u64 vcc, 0
 s_cbranch_scc1 L_z2_late
L_z2_ok:
 s_nop 0
 mf v[64:67],a[48:51],a[64:67],v[64:67]
 rd a[16:19],v24,49152
 ar v37,a249
 mf v[68:71],a[52:55],a[64:67],v[68:71]
 tr a[0:1],v20,49152
 ar v38,a250
 mf v[84:87],a[52:55],a[68:71],v[84:87]
 tr a[2:3],v20,49408
 s_add_u32 m0, s29, 0
 s_nop 0
 mf v[80:83],a[48:51],a[68:71],v[80:83]
 buffer_load_dwordx4 v8, s[4:7], s26 offen offset:0 sc1 lds
 mf v[96:99],a[48:51],a[72:75],v[96:99]
 rd a[20:23],v24,51200
 mf v[100:103],a[52:55],a[72:75],v[100:103]
 tr a[4:5],v21,49152
 ar v39,a251
 mf v[116:119],a[52:55],a[76:79],v[116:119]
 tr a[6:7],v21,49408
 v_mul_f32_e64 v40, v36, v36
 mf v[112:115],a[48:51],a[76:79],v[112:115]
 buffer_load_dwordx4 v8, s[4:7], s26 offen offset:1024 sc1 lds
 mf v[128:131],a[48:51],a[80:83],v[128:131]
 rd a[24:27],v24,53248
 v_mul_f32_e64 v41, v37, v37
 mf v[132:135],a[52:55],a[80:83],v[132:135]
 tr a[8:9],v20,53248
 v_mul_f32_e64 v42, v38, v38
 mf v[148:151],a[52:55],a[84:87],v[148:151]
 tr a[10:11],v20,53504
 v_mul_f32_e64 v43, v39, v39
 mf v[144:147],a[48:51],a[84:87],v[144:147]
 rd a[28:31],v24,55296
 mf v[160:163],a[48:51],a[88:91],v[160:163]
 buffer_load_dwordx4 v8, s[4:7], s26 offen offset:2048 sc1 lds
 mf v[164:167],a[52:55],a[88:91],v[164:167]
 tr a[12:13],v21,53248
 v_fma_f32 v40, v40, s54, v58
 mf v[180:183],a[52:55],a[92:95],v[180:183]
 tr a[14:15],v21,53504
 v_fma_f32 v41, v41, s54, v58
 mf v[176:179],a[48:51],a[92:95],v[176:179]
 rd a[32:35],v24,57344
 v_fma_f32 v42, v42, s54, v58
 mf v[184:187],a[56:59],a[92:95],v[184:187]
 rd a[36:39],v24,59392
 v_fma_f32 v43, v43, s54, v58
 mf v[188:191],a[60:63],a[92:95],v[188:191]
 buffer_load_dwordx4 v8, s[4:7], s26 offen offset:3072 sc1 lds
 mf v[172:175],a[60:63],a[88:91],v[172:175]
 rd a[40:43],v24,61440
 s_add_u32 s52, s52, 16384
 mf v[168:171],a[56:59],a[88:91],v[168:171]
 rd a[44:47],v24,63488
 s_and_b32 s52, s52, 0x7ffff
 mf v[152:155],a[56:59],a[84:87],v[152:155]
 s_add_u32 s26, s50, s52
 v_mul_f32 v40, v40, v36
 mf v[156:159],a[60:63],a[84:87],v[156:159]
 s_add_u32 m0, s28, 16384
 mf v[140:143],a[60:63],a[80:83],v[140:143]
 buffer_load_dwordx4 v9, s[8:11], s27 offen offset:0 lds
 mf v[136:139],a[56:59],a[80:83],v[136:139]
 v_mul_f32 v41, v41, v37
 v_mul_f32 v42, v42, v38
 mf v[120:123],a[56:59],a[76:79],v[120:123]
 v_mul_f32_e64 v43, v43, v39
 mf v[124:127],a[60:63],a[76:79],v[124:127]
 v_exp_f32_e64 v40, v40
 mf v[108:111],a[60:63],a[72:75],v[108:111]
 v_exp_f32_e64 v41, v41
 mf v[104:107],a[56:59],a[72:75],v[104:107]
 buffer_load_dwordx4 v10, s[8:11], s27 offen offset:1024 lds
 mf v[88:91],a[56:59],a[68:71],v[88:91]
 v_exp_f32_e64 v42, v42
 mf v[92:95],a[60:63],a[68:71],v[92:95]
 mf v[76:79],a[60:63],a[64:67],v[76:79]
 v_exp_f32 v43, v43
 s_waitcnt lgkmcnt(0)
 mf v[72:75],a[56:59],a[64:67],v[72:75]
 v_add_f32_e64 v40, 1.0, v40
 mf v[64:67],a[0:3],a[16:19],v[64:67]
 rd a[64:67],v25,49152
 v_add_f32_e64 v41, 1.0, v41
 mf v[68:71],a[4:7],a[16:19],v[68:71]
 tr a[48:49],v20,51200
 v_add_f32_e64 v42, 1.0, v42
 mf v[84:87],a[4:7],a[20:23],v[84:87]
 tr a[50:51],v20,51456
 mf v[80:83],a[0:3],a[20:23],v[80:83]
 buffer_load_dwordx4 v11, s[8:11], s27 offen offset:2048 lds
 mf v[96:99],a[0:3],a[24:27],v[96:99]
 rd a[68:71],v25,51200
 v_add_f32_e64 v43, 1.0, v43
 mf v[100:103],a[4:7],a[24:27],v[100:103]
 tr a[52:53],v21,51200
 mf v[116:119],a[4:7],a[28:31],v[116:119]
 tr a[54:55],v21,51456
 v_rcp_f32_e64 v40, v40
 mf v[112:115],a[0:3],a[28:31],v[112:115]
 buffer_load_dwordx4 v12, s[8:11], s27 offen offset:3072 lds
 mf v[128:131],a[0:3],a[32:35],v[128:131]
 rd a[72:75],v25,53248
 mf v[132:135],a[4:7],a[32:35],v[132:135]
 tr a[56:57],v20,55296
 mf v[148:151],a[4:7],a[36:39],v[148:151]
 tr a[58:59],v20,55552
 v_rcp_f32_e64 v41, v41
 mf v[144:147],a[0:3],a[36:39],v[144:147]
 rd a[76:79],v25,55296
 s_add_u32 m0, s28, 20480
 mf v[160:163],a[0:3],a[40:43],v[160:163]
 buffer_load_dwordx4 v13, s[8:11], s27 offen offset:0 lds
 mf v[164:167],a[4:7],a[40:43],v[164:167]
 tr a[60:61],v21,55296
 mf v[180:183],a[4:7],a[44:47],v[180:183]
 tr a[62:63],v21,55552
 mf v[176:179],a[0:3],a[44:47],v[176:179]
 rd a[80:83],v25,57344
 v_rcp_f32_e64 v42, v42
 mf v[184:187],a[8:11],a[44:47],v[184:187]
 rd a[84:87],v25,59392
 mf v[188:191],a[12:15],a[44:47],v[188:191]
 buffer_load_dwordx4 v14, s[8:11], s27 offen offset:1024 lds
 mf v[172:175],a[12:15],a[40:43],v[172:175]
 rd a[88:91],v25,61440
 v_rcp_f32_e64 v43, v43
 mf v[168:171],a[8:11],a[40:43],v[168:171]
 rd a[92:95],v25,63488
 v_mul_f32_e64 v36, v36, v40
 mf v[152:155],a[8:11],a[36:39],v[152:155]
 v_mul_f32_e64 v37, v37, v41
 mf v[156:159],a[12:15],a[36:39],v[156:159]
 v_mul_f32 v38, v38, v42
 v_mul_f32 v39, v39, v43
 mf v[140:143],a[12:15],a[32:35],v[140:143]
 buffer_load_dwordx4 v15, s[8:11], s27 offen offset:2048 lds
 mf v[136:139],a[8:11],a[32:35],v[136:139]
 v_cvt_pk_bf16_f32 v246, v36, v37
 mf v[120:123],a[8:11],a[28:31],v[120:123]
 v_cvt_pk_bf16_f32 v247, v38, v39
 ar v36,a156
 mf v[124:127],a[12:15],a[28:31],v[124:127]
 ar v37,a157
 mf v[108:111],a[12:15],a[24:27],v[108:111]
 ar v38,a158
 ar v39,a159
 mf v[104:107],a[8:11],a[24:27],v[104:107]
 buffer_load_dwordx4 v16, s[8:11], s27 offen offset:3072 lds
 mf v[88:91],a[8:11],a[20:23],v[88:91]
 s_add_u32 s53, s53, 128
 s_and_b32 s53, s53, 0xfff
 mf v[92:95],a[12:15],a[20:23],v[92:95]
 s_add_u32 s27, s51, s53
 s_nop 0
 mf v[76:79],a[12:15],a[16:19],v[76:79]
 v_mul_f32 v40, v36, v36
 s_waitcnt vmcnt(12) lgkmcnt(0)
 mf v[72:75],a[8:11],a[16:19],v[72:75]
 v_mul_f32 v41, v37, v37
 s_barrier
 mf v[64:67],a[48:51],a[64:67],v[64:67]
 rd a[16:19],v26,0
 v_mul_f32_e64 v42, v38, v38
 mf v[68:71],a[52:55],a[64:67],v[68:71]
 tr a[0:1],v22,0
 v_mul_f32_e64 v43, v39, v39
 mf v[84:87],a[52:55],a[68:71],v[84:87]
 tr a[2:3],v22,256
 s_add_u32 m0, s29, 49152
 mf v[80:83],a[48:51],a[68:71],v[80:83]
 buffer_load_dwordx4 v8, s[4:7], s26 offen offset:0 sc1 lds
 mf v[96:99],a[48:51],a[72:75],v[96:99]
 rd a[20:23],v26,2048
 v_fma_f32 v40, v40, s54, v58
 mf v[100:103],a[52:55],a[72:75],v[100:103]
 tr a[4:5],v23,0
 v_fma_f32 v41, v41, s54, v58
 mf v[116:119],a[52:55],a[76:79],v[116:119]
 tr a[6:7],v23,256
 mf v[112:115],a[48:51],a[76:79],v[112:115]
 buffer_load_dwordx4 v8, s[4:7], s26 offen offset:1024 sc1 lds
 mf v[128:131],a[48:51],a[80:83],v[128:131]
 rd a[24:27],v26,4096
 v_fma_f32 v42, v42, s54, v58
 mf v[132:135],a[52:55],a[80:83],v[132:135]
 tr a[8:9],v22,4096
 v_fma_f32 v43, v43, s54, v58
 mf v[148:151],a[52:55],a[84:87],v[148:151]
 tr a[10:11],v22,4352
 v_mul_f32_e64 v40, v40, v36
 mf v[144:147],a[48:51],a[84:87],v[144:147]
 rd a[28:31],v26,6144
 v_mul_f32_e64 v41, v41, v37
 mf v[160:163],a[48:51],a[88:91],v[160:163]
 buffer_load_dwordx4 v8, s[4:7], s26 offen offset:2048 sc1 lds
 mf v[164:167],a[52:55],a[88:91],v[164:167]
 tr a[12:13],v23,4096
 v_mul_f32_e64 v42, v42, v38
 mf v[180:183],a[52:55],a[92:95],v[180:183]
 tr a[14:15],v23,4352
 v_mul_f32_e64 v43, v43, v39
 mf v[176:179],a[48:51],a[92:95],v[176:179]
 rd a[32:35],v26,8192
 mf v[184:187],a[56:59],a[92:95],v[184:187]
 rd a[36:39],v26,10240
 v_exp_f32_e64 v40, v40
 mf v[188:191],a[60:63],a[92:95],v[188:191]
 buffer_load_dwordx4 v8, s[4:7], s26 offen offset:3072 sc1 lds
 mf v[172:175],a[60:63],a[88:91],v[172:175]
 rd a[40:43],v26,12288
 s_add_u32 s52, s52, 16384
 mf v[168:171],a[56:59],a[88:91],v[168:171]
 rd a[44:47],v26,14336
 s_and_b32 s52, s52, 0x7ffff
 mf v[152:155],a[56:59],a[84:87],v[152:155]
 s_add_u32 s26, s50, s52
 s_nop 0
 mf v[156:159],a[60:63],a[84:87],v[156:159]
 s_add_u32 m0, s28, 65536
 mf v[140:143],a[60:63],a[80:83],v[140:143]
 buffer_load_dwordx4 v9, s[8:11], s27 offen offset:0 lds
 mf v[136:139],a[56:59],a[80:83],v[136:139]
 v_exp_f32_e64 v41, v41
 mf v[120:123],a[56:59],a[76:79],v[120:123]
 v_exp_f32_e64 v42, v42
 mf v[124:127],a[60:63],a[76:79],v[124:127]
 v_exp_f32 v43, v43
 v_add_f32 v40, 1.0, v40
 mf v[108:111],a[60:63],a[72:75],v[108:111]
 v_add_f32 v41, 1.0, v41
 v_add_f32 v42, 1.0, v42
 mf v[104:107],a[56:59],a[72:75],v[104:107]
 buffer_load_dwordx4 v10, s[8:11], s27 offen offset:1024 lds
 mf v[88:91],a[56:59],a[68:71],v[88:91]
 v_add_f32_e64 v43, 1.0, v43
 mf v[92:95],a[60:63],a[68:71],v[92:95]
 v_rcp_f32_e64 v40, v40
 mf v[76:79],a[60:63],a[64:67],v[76:79]
 s_waitcnt lgkmcnt(0)
 s_nop 0
 mf v[72:75],a[56:59],a[64:67],v[72:75]
 v_rcp_f32_e64 v41, v41
 mf v[64:67],a[0:3],a[16:19],v[64:67]
 rd a[64:67],v27,0
 mf v[68:71],a[4:7],a[16:19],v[68:71]
 tr a[48:49],v22,2048
 mf v[84:87],a[4:7],a[20:23],v[84:87]
 tr a[50:51],v22,2304
 v_rcp_f32_e64 v42, v42
 mf v[80:83],a[0:3],a[20:23],v[80:83]
 buffer_load_dwordx4 v11, s[8:11], s27 offen offset:2048 lds
 mf v[96:99],a[0:3],a[24:27],v[96:99]
 rd a[68:71],v27,2048
 mf v[100:103],a[4:7],a[24:27],v[100:103]
 tr a[52:53],v23,2048
 v_rcp_f32_e64 v43, v43
 mf v[116:119],a[4:7],a[28:31],v[116:119]
 tr a[54:55],v23,2304
 mf v[112:115],a[0:3],a[28:31],v[112:115]
 buffer_load_dwordx4 v12, s[8:11], s27 offen offset:3072 lds
 mf v[128:131],a[0:3],a[32:35],v[128:131]
 rd a[72:75],v27,4096
 v_mul_f32_e64 v36, v36, v40
 mf v[132:135],a[4:7],a[32:35],v[132:135]
 tr a[56:57],v22,6144
 v_mul_f32_e64 v37, v37, v41
 mf v[148:151],a[4:7],a[36:39],v[148:151]
 tr a[58:59],v22,6400
 mf v[144:147],a[0:3],a[36:39],v[144:147]
 rd a[76:79],v27,6144
 s_add_u32 m0, s28, 69632
 mf v[160:163],a[0:3],a[40:43],v[160:163]
 buffer_load_dwordx4 v13, s[8:11], s27 offen offset:0 lds
 mf v[164:167],a[4:7],a[40:43],v[164:167]
 tr a[60:61],v23,6144
 v_mul_f32_e64 v38, v38, v42
 mf v[180:183],a[4:7],a[44:47],v[180:183]
 tr a[62:63],v23,6400
 v_mul_f32_e64 v39, v39, v43
 mf v[176:179],a[0:3],a[44:47],v[176:179]
 rd a[80:83],v27,8192
 mf v[184:187],a[8:11],a[44:47],v[184:187]
 rd a[84:87],v27,10240
 v_cvt_pk_bf16_f32 v248, v36, v37
 mf v[188:191],a[12:15],a[44:47],v[188:191]
 buffer_load_dwordx4 v14, s[8:11], s27 offen offset:1024 lds
 mf v[172:175],a[12:15],a[40:43],v[172:175]
 rd a[88:91],v27,12288
 v_cvt_pk_bf16_f32 v249, v38, v39
 mf v[168:171],a[8:11],a[40:43],v[168:171]
 rd a[92:95],v27,14336
 ar v36,a188
 mf v[152:155],a[8:11],a[36:39],v[152:155]
 ar v37,a189
 mf v[156:159],a[12:15],a[36:39],v[156:159]
 ar v38,a190
 mf v[140:143],a[12:15],a[32:35],v[140:143]
 buffer_load_dwordx4 v15, s[8:11], s27 offen offset:2048 lds
 mf v[136:139],a[8:11],a[32:35],v[136:139]
 ar v39,a191
 v_mul_f32_e64 v40, v36, v36
 mf v[120:123],a[8:11],a[28:31],v[120:123]
 v_mul_f32_e64 v41, v37, v37
 mf v[124:127],a[12:15],a[28:31],v[124:127]
 v_mul_f32 v42, v38, v38
 v_mul_f32 v43, v39, v39
 mf v[108:111],a[12:15],a[24:27],v[108:111]
 v_fma_f32 v40, v40, s54, v58
 mf v[104:107],a[8:11],a[24:27],v[104:107]
 buffer_load_dwordx4 v16, s[8:11], s27 offen offset:3072 lds
 mf v[88:91],a[8:11],a[20:23],v[88:91]
 s_add_u32 s53, s53, 128
 s_and_b32 s53, s53, 0xfff
 mf v[92:95],a[12:15],a[20:23],v[92:95]
 s_add_u32 s27, s51, s53
 s_nop 0
 v_fma_f32 v41, v41, s54, v58
 mf v[76:79],a[12:15],a[16:19],v[76:79]
 s_waitcnt vmcnt(12) lgkmcnt(0)
 s_nop 0
 mf v[72:75],a[8:11],a[16:19],v[72:75]
 v_fma_f32 v42, v42, s54, v58
 s_barrier
 s_nop 0
 mf v[64:67],a[48:51],a[64:67],v[64:67]
 rd a[16:19],v24,0
 v_fma_f32 v43, v43, s54, v58
 mf v[68:71],a[52:55],a[64:67],v[68:71]
 tr a[0:1],v20,0
 v_mul_f32_e64 v40, v40, v36
 mf v[84:87],a[52:55],a[68:71],v[84:87]
 tr a[2:3],v20,256
 s_add_u32 m0, s29, 98304
 mf v[80:83],a[48:51],a[68:71],v[80:83]
 buffer_load_dwordx4 v8, s[4:7], s26 offen offset:0 sc1 lds
 mf v[96:99],a[48:51],a[72:75],v[96:99]
 rd a[20:23],v24,2048
 v_mul_f32_e64 v41, v41, v37
 mf v[100:103],a[52:55],a[72:75],v[100:103]
 tr a[4:5],v21,0
 v_mul_f32_e64 v42, v42, v38
 mf v[116:119],a[52:55],a[76:79],v[116:119]
 tr a[6:7],v21,256
 v_mul_f32_e64 v43, v43, v39
 mf v[112:115],a[48:51],a[76:79],v[112:115]
 buffer_load_dwordx4 v8, s[4:7], s26 offen offset:1024 sc1 lds
 mf v[128:131],a[48:51],a[80:83],v[128:131]
 rd a[24:27],v24,4096
 mf v[132:135],a[52:55],a[80:83],v[132:135]
 tr a[8:9],v20,4096
 v_exp_f32_e64 v40, v40
 mf v[148:151],a[52:55],a[84:87],v[148:151]
 tr a[10:11],v20,4352
 mf v[144:147],a[48:51],a[84:87],v[144:147]
 rd a[28:31],v24,6144
 v_exp_f32_e64 v41, v41
 mf v[160:163],a[48:51],a[88:91],v[160:163]
 buffer_load_dwordx4 v8, s[4:7], s26 offen offset:2048 sc1 lds
 mf v[164:167],a[52:55],a[88:91],v[164:167]
 tr a[12:13],v21,4096
 mf v[180:183],a[52:55],a[92:95],v[180:183]
 tr a[14:15],v21,4352
 v_exp_f32_e64 v42, v42
 mf v[176:179],a[48:51],a[92:95],v[176:179]
 rd a[32:35],v24,8192
 mf v[184:187],a[56:59],a[92:95],v[184:187]
 rd a[36:39],v24,10240
 v_exp_f32_e64 v43, v43
 mf v[188:191],a[60:63],a[92:95],v[188:191]
 buffer_load_dwordx4 v8, s[4:7], s26 offen offset:3072 sc1 lds
 mf v[172:175],a[60:63],a[88:91],v[172:175]
 rd a[40:43],v24,12288
 s_add_u32 s52, s52, 16384
 mf v[168:171],a[56:59],a[88:91],v[168:171]
 rd a[44:47],v24,14336
 s_and_b32 s52, s52, 0x7ffff
 mf v[152:155],a[56:59],a[84:87],v[152:155]
 s_add_u32 s26, s50, s52
 v_add_f32 v40, 1.0, v40
 mf v[156:159],a[60:63],a[84:87],v[156:159]
 s_add_u32 m0, s28, 114688
 mf v[140:143],a[60:63],a[80:83],v[140:143]
 buffer_load_dwordx4 v9, s[8:11], s27 offen offset:0 lds
 mf v[136:139],a[56:59],a[80:83],v[136:139]
 v_add_f32 v41, 1.0, v41
 v_add_f32 v42, 1.0, v42
 mf v[120:123],a[56:59],a[76:79],v[120:123]
 v_add_f32_e64 v43, 1.0, v43
 mf v[124:127],a[60:63],a[76:79],v[124:127]
 v_rcp_f32_e64 v40, v40
 mf v[108:111],a[60:63],a[72:75],v[108:111]
 v_rcp_f32_e64 v41, v41
 mf v[104:107],a[56:59],a[72:75],v[104:107]
 buffer_load_dwordx4 v10, s[8:11], s27 offen offset:1024 lds
 mf v[88:91],a[56:59],a[68:71],v[88:91]
 v_rcp_f32_e64 v42, v42
 mf v[92:95],a[60:63],a[68:71],v[92:95]
 v_rcp_f32 v43, v43
 v_mul_f32 v36, v36, v40
 mf v[76:79],a[60:63],a[64:67],v[76:79]
 v_mul_f32 v37, v37, v41
 s_waitcnt lgkmcnt(0)
 mf v[72:75],a[56:59],a[64:67],v[72:75]
 v_mul_f32_e64 v38, v38, v42
 mf v[64:67],a[0:3],a[16:19],v[64:67]
 rd a[64:67],v25,0
 v_mul_f32_e64 v39, v39, v43
 mf v[68:71],a[4:7],a[16:19],v[68:71]
 tr a[48:49],v20,2048
 mf v[84:87],a[4:7],a[20:23],v[84:87]
 tr a[50:51],v20,2304
 v_cvt_pk_bf16_f32 v250, v36, v37
 mf v[80:83],a[0:3],a[20:23],v[80:83]
 buffer_load_dwordx4 v11, s[8:11], s27 offen offset:2048 lds
 mf v[96:99],a[0:3],a[24:27],v[96:99]
 rd a[68:71],v25,2048
 v_cvt_pk_bf16_f32 v251, v38, v39
 mf v[100:103],a[4:7],a[24:27],v[100:103]
 tr a[52:53],v21,2048
 ar v36,a220
 mf v[116:119],a[4:7],a[28:31],v[116:119]
 tr a[54:55],v21,2304
 mf v[112:115],a[0:3],a[28:31],v[112:115]
 buffer_load_dwordx4 v12, s[8:11], s27 offen offset:3072 lds
 mf v[128:131],a[0:3],a[32:35],v[128:131]
 rd a[72:75],v25,4096
 ar v37,a221
 mf v[132:135],a[4:7],a[32:35],v[132:135]
 tr a[56:57],v20,6144
 ar v38,a222
 mf v[148:151],a[4:7],a[36:39],v[148:151]
 tr a[58:59],v20,6400
 mf v[144:147],a[0:3],a[36:39],v[144:147]
 rd a[76:79],v25,6144
 s_add_u32 m0, s28, 118784
 mf v[160:163],a[0:3],a[40:43],v[160:163]
 buffer_load_dwordx4 v13, s[8:11], s27 offen offset:0 lds
 mf v[164:167],a[4:7],a[40:43],v[164:167]
 tr a[60:61],v21,6144
 ar v39,a223
 mf v[180:183],a[4:7],a[44:47],v[180:183]
 tr a[62:63],v21,6400
 v_mul_f32_e64 v40, v36, v36
 mf v[176:179],a[0:3],a[44:47],v[176:179]
 rd a[80:83],v25,8192
 mf v[184:187],a[8:11],a[44:47],v[184:187]
 rd a[84:87],v25,10240
 v_mul_f32_e64 v41, v37, v37
 mf v[188:191],a[12:15],a[44:47],v[188:191]
 buffer_load_dwordx4 v14, s[8:11], s27 offen offset:1024 lds
 mf v[172:175],a[12:15],a[40:43],v[172:175]
 rd a[88:91],v25,12288
 v_mul_f32_e64 v42, v38, v38
 mf v[168:171],a[8:11],a[40:43],v[168:171]
 rd a[92:95],v25,14336
 v_mul_f32_e64 v43, v39, v39
 mf v[152:155],a[8:11],a[36:39],v[152:155]
 s_branch L_skip_14141
.p2align 12
L_stub_wg_14141:
 s_branch L_stub_wg_15788
L_stub_wg2_14141:
 s_branch L_rwg2
 s_nop 0
 s_nop 0
L_skip_14141:
 v_fma_f32 v40, v40, s54, v58
 mf v[156:159],a[12:15],a[36:39],v[156:159]
 v_fma_f32 v41, v41, s54, v58
 mf v[140:143],a[12:15],a[32:35],v[140:143]
 buffer_load_dwordx4 v15, s[8:11], s27 offen offset:2048 lds
 mf v[136:139],a[8:11],a[32:35],v[136:139]
 v_fma_f32 v42, v42, s54, v58
 v_fma_f32 v43, v43, s54, v58
 mf v[120:123],a[8:11],a[28:31],v[120:123]
 v_mul_f32_e64 v40, v40, v36
 mf v[124:127],a[12:15],a[28:31],v[124:127]
 v_mul_f32 v41, v41, v37
 v_mul_f32 v42, v42, v38
 mf v[108:111],a[12:15],a[24:27],v[108:111]
 v_mul_f32_e64 v43, v43, v39
 mf v[104:107],a[8:11],a[24:27],v[104:107]
 buffer_load_dwordx4 v16, s[8:11], s27 offen offset:3072 lds
 mf v[88:91],a[8:11],a[20:23],v[88:91]
 s_add_u32 s53, s53, 128
 s_and_b32 s53, s53, 0xfff
 mf v[92:95],a[12:15],a[20:23],v[92:95]
 s_add_u32 s27, s51, s53
 s_nop 0
 mf v[76:79],a[12:15],a[16:19],v[76:79]
 s_waitcnt vmcnt(12) lgkmcnt(0)
 s_nop 0
 mf v[72:75],a[8:11],a[16:19],v[72:75]
 v_exp_f32 v40, v40
 s_barrier
 mf v[64:67],a[48:51],a[64:67],v[64:67]
 rd a[16:19],v24,49152
 mf v[68:71],a[52:55],a[64:67],v[68:71]
 tr a[0:1],v20,49152
 v_exp_f32_e64 v41, v41
 mf v[84:87],a[52:55],a[68:71],v[84:87]
 tr a[2:3],v20,49408
 s_add_u32 m0, s29, 0
 s_nop 0
 mf v[80:83],a[48:51],a[68:71],v[80:83]
 buffer_load_dwordx4 v8, s[4:7], s26 offen offset:0 sc1 lds
 mf v[96:99],a[48:51],a[72:75],v[96:99]
 rd a[20:23],v24,51200
 mf v[100:103],a[52:55],a[72:75],v[100:103]
 tr a[4:5],v21,49152
 v_exp_f32_e64 v42, v42
 mf v[116:119],a[52:55],a[76:79],v[116:119]
 tr a[6:7],v21,49408
 mf v[112:115],a[48:51],a[76:79],v[112:115]
 buffer_load_dwordx4 v8, s[4:7], s26 offen offset:1024 sc1 lds
 mf v[128:131],a[48:51],a[80:83],v[128:131]
 rd a[24:27],v24,53248
 mf v[132:135],a[52:55],a[80:83],v[132:135]
 tr a[8:9],v20,53248
 v_exp_f32_e64 v43, v43
 mf v[148:151],a[52:55],a[84:87],v[148:151]
 tr a[10:11],v20,53504
 v_add_f32_e64 v40, 1.0, v40
 mf v[144:147],a[48:51],a[84:87],v[144:147]
 rd a[28:31],v24,55296
 v_add_f32_e64 v41, 1.0, v41
 mf v[160:163],a[48:51],a[88:91],v[160:163]
 buffer_load_dwordx4 v8, s[4:7], s26 offen offset:2048 sc1 lds
 mf v[164:167],a[52:55],a[88:91],v[164:167]
 tr a[12:13],v21,53248
 v_add_f32_e64 v42, 1.0, v42
 mf v[180:183],a[52:55],a[92:95],v[180:183]
 tr a[14:15],v21,53504
 v_add_f32_e64 v43, 1.0, v43
 mf v[176:179],a[48:51],a[92:95],v[176:179]
 rd a[32:35],v24,57344
 mf v[184:187],a[56:59],a[92:95],v[184:187]
 rd a[36:39],v24,59392
 v_rcp_f32_e64 v40, v40
 mf v[188:191],a[60:63],a[92:95],v[188:191]
 buffer_load_dwordx4 v8, s[4:7], s26 offen offset:3072 sc1 lds
 mf v[172:175],a[60:63],a[88:91],v[172:175]
 rd a[40:43],v24,61440
 s_add_u32 s52, s52, 16384
 mf v[168:171],a[56:59],a[88:91],v[168:171]
 rd a[44:47],v24,63488
 s_and_b32 s52, s52, 0x7ffff
 mf v[152:155],a[56:59],a[84:87],v[152:155]
 s_add_u32 s26, s50, s52
 s_nop 0
 mf v[156:159],a[60:63],a[84:87],v[156:159]
 s_add_u32 m0, s28, 16384
 mf v[140:143],a[60:63],a[80:83],v[140:143]
 buffer_load_dwordx4 v9, s[8:11], s27 offen offset:0 lds
 mf v[136:139],a[56:59],a[80:83],v[136:139]
 v_rcp_f32_e64 v41, v41
 mf v[120:123],a[56:59],a[76:79],v[120:123]
 v_rcp_f32_e64 v42, v42
 mf v[124:127],a[60:63],a[76:79],v[124:127]
 v_rcp_f32 v43, v43
 v_mul_f32 v36, v36, v40
 mf v[108:111],a[60:63],a[72:75],v[108:111]
 v_mul_f32 v37, v37, v41
 v_mul_f32 v38, v38, v42
 mf v[104:107],a[56:59],a[72:75],v[104:107]
 buffer_load_dwordx4 v10, s[8:11], s27 offen offset:1024 lds
 mf v[88:91],a[56:59],a[68:71],v[88:91]
 v_mul_f32_e64 v39, v39, v43
 mf v[92:95],a[60:63],a[68:71],v[92:95]
 v_cvt_pk_bf16_f32 v252, v36, v37
 v_cvt_pk_bf16_f32 v253, v38, v39
 mf v[76:79],a[60:63],a[64:67],v[76:79]
 ar v36,a252
 s_waitcnt lgkmcnt(0)
 s_nop 0
 mf v[72:75],a[56:59],a[64:67],v[72:75]
 ar v37,a253
 mf v[64:67],a[0:3],a[16:19],v[64:67]
 rd a[64:67],v25,49152
 ar v38,a254
 mf v[68:71],a[4:7],a[16:19],v[68:71]
 tr a[48:49],v20,51200
 ar v39,a255
 mf v[84:87],a[4:7],a[20:23],v[84:87]
 tr a[50:51],v20,51456
 mf v[80:83],a[0:3],a[20:23],v[80:83]
 buffer_load_dwordx4 v11, s[8:11], s27 offen offset:2048 lds
 mf v[96:99],a[0:3],a[24:27],v[96:99]
 rd a[68:71],v25,51200
 v_mul_f32_e64 v40, v36, v36
 mf v[100:103],a[4:7],a[24:27],v[100:103]
 tr a[52:53],v21,51200
 v_mul_f32_e64 v41, v37, v37
 mf v[116:119],a[4:7],a[28:31],v[116:119]
 tr a[54:55],v21,51456
 v_mul_f32_e64 v42, v38, v38
 mf v[112:115],a[0:3],a[28:31],v[112:115]
 buffer_load_dwordx4 v12, s[8:11], s27 offen offset:3072 lds
 mf v[128:131],a[0:3],a[32:35],v[128:131]
 rd a[72:75],v25,53248
 v_mul_f32_e64 v43, v39, v39
 mf v[132:135],a[4:7],a[32:35],v[132:135]
 tr a[56:57],v20,55296
 mf v[148:151],a[4:7],a[36:39],v[148:151]
 tr a[58:59],v20,55552
 v_fma_f32 v40, v40, s54, v58
 mf v[144:147],a[0:3],a[36:39],v[144:147]
 rd a[76:79],v25,55296
 s_add_u32 m0, s28, 20480
 mf v[160:163],a[0:3],a[40:43],v[160:163]
 buffer_load_dwordx4 v13, s[8:11], s27 offen offset:0 lds
 mf v[164:167],a[4:7],a[40:43],v[164:167]
 tr a[60:61],v21,55296
 v_fma_f32 v41, v41, s54, v58
 mf v[180:183],a[4:7],a[44:47],v[180:183]
 tr a[62:63],v21,55552
 v_fma_f32 v42, v42, s54, v58
 mf v[176:179],a[0:3],a[44:47],v[176:179]
 rd a[80:83],v25,57344
 v_fma_f32 v43, v43, s54, v58
 mf v[184:187],a[8:11],a[44:47],v[184:187]
 rd a[84:87],v25,59392
 mf v[188:191],a[12:15],a[44:47],v[188:191]
 buffer_load_dwordx4 v14, s[8:11], s27 offen offset:1024 lds
 mf v[172:175],a[12:15],a[40:43],v[172:175]
 rd a[88:91],v25,61440
 v_mul_f32_e64 v40, v40, v36
 mf v[168:171],a[8:11],a[40:43],v[168:171]
 rd a[92:95],v25,63488
 v_mul_f32_e64 v41, v41, v37
 mf v[152:155],a[8:11],a[36:39],v[152:155]
 v_mul_f32 v42, v42, v38
 v_mul_f32 v43, v43, v39
 mf v[156:159],a[12:15],a[36:39],v[156:159]
 mf v[140:143],a[12:15],a[32:35],v[140:143]
 buffer_load_dwordx4 v15, s[8:11], s27 offen offset:2048 lds
 mf v[136:139],a[8:11],a[32:35],v[136:139]
 v_exp_f32_e64 v40, v40
 mf v[120:123],a[8:11],a[28:31],v[120:123]
 v_exp_f32_e64 v41, v41
 mf v[124:127],a[12:15],a[28:31],v[124:127]
 v_exp_f32_e64 v42, v42
 mf v[108:111],a[12:15],a[24:27],v[108:111]
 v_exp_f32_e64 v43, v43
 mf v[104:107],a[8:11],a[24:27],v[104:107]
 buffer_load_dwordx4 v16, s[8:11], s27 offen offset:3072 lds
 mf v[88:91],a[8:11],a[20:23],v[88:91]
 s_add_u32 s53, s53, 128
 s_and_b32 s53, s53, 0xfff
 mf v[92:95],a[12:15],a[20:23],v[92:95]
 s_add_u32 s27, s51, s53
 s_nop 0
 mf v[76:79],a[12:15],a[16:19],v[76:79]
 v_add_f32 v40, 1.0, v40
 s_waitcnt vmcnt(12) lgkmcnt(0)
 mf v[72:75],a[8:11],a[16:19],v[72:75]
 v_add_f32 v41, 1.0, v41
 s_barrier
 mf v[64:67],a[48:51],a[64:67],v[64:67]
 rd a[16:19],v26,0
 v_add_f32_e64 v42, 1.0, v42
 mf v[68:71],a[52:55],a[64:67],v[68:71]
 tr a[0:1],v22,0
 v_add_f32_e64 v43, 1.0, v43
 mf v[84:87],a[52:55],a[68:71],v[84:87]
 tr a[2:3],v22,256
 s_add_u32 m0, s29, 49152
 mf v[80:83],a[48:51],a[68:71],v[80:83]
 buffer_load_dwordx4 v8, s[4:7], s26 offen offset:0 sc1 lds
 mf v[96:99],a[48:51],a[72:75],v[96:99]
 rd a[20:23],v26,2048
 mf v[100:103],a[52:55],a[72:75],v[100:103]
 tr a[4:5],v23,0
 mf v[116:119],a[52:55],a[76:79],v[116:119]
 tr a[6:7],v23,256
 v_rcp_f32_e64 v40, v40
 mf v[112:115],a[48:51],a[76:79],v[112:115]
 buffer_load_dwordx4 v8, s[4:7], s26 offen offset:1024 sc1 lds
 mf v[128:131],a[48:51],a[80:83],v[128:131]
 rd a[24:27],v26,4096
 mf v[132:135],a[52:55],a[80:83],v[132:135]
 tr a[8:9],v22,4096
 v_rcp_f32_e64 v41, v41
 mf v[148:151],a[52:55],a[84:87],v[148:151]
 tr a[10:11],v22,4352
 mf v[144:147],a[48:51],a[84:87],v[144:147]
 rd a[28:31],v26,6144
 mf v[160:163],a[48:51],a[88:91],v[160:163]
 buffer_load_dwordx4 v8, s[4:7], s26 offen offset:2048 sc1 lds
 mf v[164:167],a[52:55],a[88:91],v[164:167]
 tr a[12:13],v23,4096
 v_rcp_f32_e64 v42, v42
 mf v[180:183],a[52:55],a[92:95],v[180:183]
 tr a[14:15],v23,4352
 mf v[176:179],a[48:51],a[92:95],v[176:179]
 rd a[32:35],v26,8192
 v_rcp_f32_e64 v43, v43
 mf v[184:187],a[56:59],a[92:95],v[184:187]
 rd a[36:39],v26,10240
 v_mul_f32_e64 v36, v36, v40
 mf v[188:191],a[60:63],a[92:95],v[188:191]
 buffer_load_dwordx4 v8, s[4:7], s26 offen offset:3072 sc1 lds
 mf v[172:175],a[60:63],a[88:91],v[172:175]
 rd a[40:43],v26,12288
 s_add_u32 s52, s52, 16384
 mf v[168:171],a[56:59],a[88:91],v[168:171]
 rd a[44:47],v26,14336
 s_and_b32 s52, s52, 0x7ffff
 mf v[152:155],a[56:59],a[84:87],v[152:155]
 s_add_u32 s26, s50, s52
 v_mul_f32 v37, v37, v41
 mf v[156:159],a[60:63],a[84:87],v[156:159]
 s_add_u32 m0, s28, 65536
 mf v[140:143],a[60:63],a[80:83],v[140:143]
 buffer_load_dwordx4 v9, s[8:11], s27 offen offset:0 lds
 mf v[136:139],a[56:59],a[80:83],v[136:139]
 v_mul_f32 v38, v38, v42
 v_mul_f32 v39, v39, v43
 mf v[120:123],a[56:59],a[76:79],v[120:123]
 v_cvt_pk_bf16_f32 v254, v36, v37
 v_cvt_pk_bf16_f32 v255, v38, v39
 mf v[124:127],a[60:63],a[76:79],v[124:127]
 v_lshlrev_b32_e64 v28, 16, v28
 mf v[108:111],a[60:63],a[72:75],v[108:111]
 v_lshlrev_b32 v29, 16, v29
 v_lshlrev_b32 v30, 16, v30
 mf v[104:107],a[56:59],a[72:75],v[104:107]
 buffer_load_dwordx4 v10, s[8:11], s27 offen offset:1024 lds
 mf v[88:91],a[56:59],a[68:71],v[88:91]
 v_lshlrev_b32 v31, 16, v31
 v_lshlrev_b32 v32, 16, v32
 mf v[92:95],a[60:63],a[68:71],v[92:95]
 v_lshlrev_b32_e64 v33, 16, v33
 mf v[76:79],a[60:63],a[64:67],v[76:79]
 v_lshlrev_b32 v34, 16, v34
 s_waitcnt lgkmcnt(0)
 mf v[72:75],a[56:59],a[64:67],v[72:75]
 v_lshlrev_b32_e64 v35, 16, v35
 mf v[64:67],a[0:3],a[16:19],v[64:67]
 rd a[64:67],v27,0
 s_and_b32 s40, s39, 3
 s_nop 0
 mf v[68:71],a[4:7],a[16:19],v[68:71]
 tr a[48:49],v22,2048
 s_and_b32 s41, s2, 3
 s_nop 0
 mf v[84:87],a[4:7],a[20:23],v[84:87]
 tr a[50:51],v22,2304
 s_lshl_b32 s41, s41, 2
 s_nop 0
 mf v[80:83],a[0:3],a[20:23],v[80:83]
 buffer_load_dwordx4 v11, s[8:11], s27 offen offset:2048 lds
 mf v[96:99],a[0:3],a[24:27],v[96:99]
 rd a[68:71],v27,2048
 s_add_u32 s40, s40, s41
 s_nop 0
 mf v[100:103],a[4:7],a[24:27],v[100:103]
 tr a[52:53],v23,2048
 s_bfe_u32 s41, s39, 0x20002
 mf v[116:119],a[4:7],a[28:31],v[116:119]
 tr a[54:55],v23,2304
 s_and_b32 s42, s2, 4
 s_nop 0
 mf v[112:115],a[0:3],a[28:31],v[112:115]
 buffer_load_dwordx4 v12, s[8:11], s27 offen offset:3072 lds
 mf v[128:131],a[0:3],a[32:35],v[128:131]
 rd a[72:75],v27,4096
 s_add_u32 s41, s41, s42
 s_nop 0
 mf v[132:135],a[4:7],a[32:35],v[132:135]
 tr a[56:57],v22,6144
 mf v[148:151],a[4:7],a[36:39],v[148:151]
 tr a[58:59],v22,6400
 s_lshl_b32 s83, s41, 8
 s_nop 0
 mf v[144:147],a[0:3],a[36:39],v[144:147]
 rd a[76:79],v27,6144
 s_add_u32 m0, s28, 69632
 mf v[160:163],a[0:3],a[40:43],v[160:163]
 buffer_load_dwordx4 v13, s[8:11], s27 offen offset:0 lds
 mf v[164:167],a[4:7],a[40:43],v[164:167]
 tr a[60:61],v23,6144
 s_mul_i32 s81, s41, 655360
 mf v[180:183],a[4:7],a[44:47],v[180:183]
 tr a[62:63],v23,6400
 s_add_u32 s81, s81, s29
 s_nop 0
 mf v[176:179],a[0:3],a[44:47],v[176:179]
 rd a[80:83],v27,8192
 s_lshl_b32 s84, s22, 17
 s_nop 0
 mf v[184:187],a[8:11],a[44:47],v[184:187]
 rd a[84:87],v27,10240
 s_lshl_b32 s31, s40, 13
 s_nop 0
 mf v[188:191],a[12:15],a[44:47],v[188:191]
 buffer_load_dwordx4 v14, s[8:11], s27 offen offset:1024 lds
 mf v[172:175],a[12:15],a[40:43],v[172:175]
 rd a[88:91],v27,12288
 s_add_u32 s84, s84, s31
 s_nop 0
 mf v[168:171],a[8:11],a[40:43],v[168:171]
 rd a[92:95],v27,14336
 s_lshl_b32 s31, s21, 12
 s_nop 0
 mf v[152:155],a[8:11],a[36:39],v[152:155]
 s_add_u32 s84, s84, s31
 s_nop 0
 s_add_u32 s82, s84, 3407872
 mf v[156:159],a[12:15],a[36:39],v[156:159]
 s_lshr_b32 s42, s40, 1
 s_lshl_b32 s31, s42, 8
 mf v[140:143],a[12:15],a[32:35],v[140:143]
 buffer_load_dwordx4 v15, s[8:11], s27 offen offset:2048 lds
 mf v[136:139],a[8:11],a[32:35],v[136:139]
 s_add_u32 s88, s31, 8216
 s_add_u32 s89, s31, 10240
 mf v[120:123],a[8:11],a[28:31],v[120:123]
 s_lshl_b32 s86, s42, 3
 s_nop 0
 mf v[124:127],a[12:15],a[28:31],v[124:127]
 s_add_u32 s86, s86, s41
 s_lshl_b32 s86, s86, 6
 mf v[108:111],a[12:15],a[24:27],v[108:111]
 s_add_u32 s86, s86, 12288
 s_lshl_b32 s87, s40, 3
 s_nop 0
 mf v[104:107],a[8:11],a[24:27],v[104:107]
 buffer_load_dwordx4 v16, s[8:11], s27 offen offset:3072 lds
 mf v[88:91],a[8:11],a[20:23],v[88:91]
 s_add_u32 s53, s53, 128
 s_and_b32 s53, s53, 0xfff
 mf v[92:95],a[12:15],a[20:23],v[92:95]
 s_add_u32 s27, s51, s53
 s_add_u32 s87, s87, s41
 mf v[76:79],a[12:15],a[16:19],v[76:79]
 s_lshl_b32 s87, s87, 15
 s_waitcnt vmcnt(12) lgkmcnt(0)
 mf v[72:75],a[8:11],a[16:19],v[72:75]
 s_lshl_b32 s31, s20, 13
 s_barrier
 mf v[64:67],a[48:51],a[64:67],v[64:67]
 rd a[16:19],v24,0
 s_add_u32 s87, s87, s31
 s_nop 0
 mf v[68:71],a[52:55],a[64:67],v[68:71]
 tr a[0:1],v20,0
 s_lshl_b32 s85, s40, 18
 s_nop 0
 mf v[84:87],a[52:55],a[68:71],v[84:87]
 tr a[2:3],v20,256
 s_add_u32 m0, s29, 98304
 mf v[80:83],a[48:51],a[68:71],v[80:83]
 buffer_load_dwordx4 v8, s[4:7], s26 offen offset:0 sc1 lds
 mf v[96:99],a[48:51],a[72:75],v[96:99]
 rd a[20:23],v24,2048
 s_lshl_b32 s31, s22, 17
 s_nop 0
 mf v[100:103],a[52:55],a[72:75],v[100:103]
 tr a[4:5],v21,0
 s_add_u32 s85, s85, s31
 s_nop 0
 mf v[116:119],a[52:55],a[76:79],v[116:119]
 tr a[6:7],v21,256
 s_add_u32 s85, s85, s83
 s_nop 0
 mf v[112:115],a[48:51],a[76:79],v[112:115]
 buffer_load_dwordx4 v8, s[4:7], s26 offen offset:1024 sc1 lds
 mf v[128:131],a[48:51],a[80:83],v[128:131]
 rd a[24:27],v24,4096
 s_lshl_b32 s31, s21, 7
 s_nop 0
 mf v[132:135],a[52:55],a[80:83],v[132:135]
 tr a[8:9],v20,4096
 s_add_u32 s85, s85, s31
 s_nop 0
 mf v[148:151],a[52:55],a[84:87],v[148:151]
 tr a[10:11],v20,4352
 s_lshl_b32 s31, s20, 4
 s_nop 0
 mf v[144:147],a[48:51],a[84:87],v[144:147]
 rd a[28:31],v24,6144
 v_add_u32_e64 v5, s31, v2
 mf v[160:163],a[48:51],a[88:91],v[160:163]
 buffer_load_dwordx4 v8, s[4:7], s26 offen offset:2048 sc1 lds
 mf v[164:167],a[52:55],a[88:91],v[164:167]
 tr a[12:13],v21,4096
 v_lshlrev_b32_e64 v5, 11, v5
 mf v[180:183],a[52:55],a[92:95],v[180:183]
 tr a[14:15],v21,4352
 v_and_b32_e64 v6, 15, v1
 mf v[176:179],a[48:51],a[92:95],v[176:179]
 rd a[32:35],v24,8192
 v_or_b32_e64 v7, 0, v2
 mf v[184:187],a[56:59],a[92:95],v[184:187]
 rd a[36:39],v24,10240
 v_lshlrev_b32_e64 v7, 1, v7
 mf v[188:191],a[60:63],a[92:95],v[188:191]
 buffer_load_dwordx4 v8, s[4:7], s26 offen offset:3072 sc1 lds
 mf v[172:175],a[60:63],a[88:91],v[172:175]
 rd a[40:43],v24,12288
 s_add_u32 s52, s52, 16384
 mf v[168:171],a[56:59],a[88:91],v[168:171]
 rd a[44:47],v24,14336
 s_and_b32 s52, s52, 0x7ffff
 mf v[152:155],a[56:59],a[84:87],v[152:155]
 s_add_u32 s26, s50, s52
 v_xor_b32 v7, v7, v6
 mf v[156:159],a[60:63],a[84:87],v[156:159]
 s_add_u32 m0, s28, 114688
 v_lshl_add_u32 v7, v7, 4, v5
 mf v[140:143],a[60:63],a[80:83],v[140:143]
 buffer_load_dwordx4 v9, s[8:11], s27 offen offset:0 lds
 mf v[136:139],a[56:59],a[80:83],v[136:139]
 v_add_u32 v36, 0, v7
 v_or_b32 v7, 4, v2
 mf v[120:123],a[56:59],a[76:79],v[120:123]
 v_lshlrev_b32 v7, 1, v7
 v_xor_b32 v7, v7, v6
 mf v[124:127],a[60:63],a[76:79],v[124:127]
 v_lshl_add_u32 v7, v7, 4, v5
 v_add_u32 v37, 7168, v7
 mf v[108:111],a[60:63],a[72:75],v[108:111]
 v_or_b32 v7, 0, v2
 v_lshlrev_b32 v7, 1, v7
 mf v[104:107],a[56:59],a[72:75],v[104:107]
 buffer_load_dwordx4 v10, s[8:11], s27 offen offset:1024 lds
 mf v[88:91],a[56:59],a[68:71],v[88:91]
 v_xor_b32_e64 v7, v7, v6
 v_lshl_add_u32 v7, v7, 4, v5
 mf v[92:95],a[60:63],a[68:71],v[92:95]
 v_add_u32 v38, 14336, v7
 v_or_b32_e64 v7, 4, v2
 mf v[76:79],a[60:63],a[64:67],v[76:79]
 v_lshlrev_b32 v7, 1, v7
 s_waitcnt lgkmcnt(0)
 mf v[72:75],a[56:59],a[64:67],v[72:75]
 v_xor_b32_e64 v7, v7, v6
 mf v[64:67],a[0:3],a[16:19],v[64:67]
 rd a[64:67],v25,0
 v_lshl_add_u32 v7, v7, 4, v5
 mf v[68:71],a[4:7],a[16:19],v[68:71]
 tr a[48:49],v20,2048
 v_add_u32 v39, 21504, v7
 mf v[84:87],a[4:7],a[20:23],v[84:87]
 tr a[50:51],v20,2304
 v_lshlrev_b32_e64 v40, 4, v1
 mf v[80:83],a[0:3],a[20:23],v[80:83]
 buffer_load_dwordx4 v11, s[8:11], s27 offen offset:2048 lds
 mf v[96:99],a[0:3],a[24:27],v[96:99]
 rd a[68:71],v25,2048
 v_lshl_add_u32 v6, v2, 2, v3
 mf v[100:103],a[4:7],a[24:27],v[100:103]
 tr a[52:53],v21,2048
 v_lshlrev_b32_e64 v5, 8, v6
 mf v[116:119],a[4:7],a[28:31],v[116:119]
 tr a[54:55],v21,2304
 v_and_b32_e64 v7, 1, v4
 mf v[112:115],a[0:3],a[28:31],v[112:115]
 buffer_load_dwordx4 v12, s[8:11], s27 offen offset:3072 lds
 mf v[128:131],a[0:3],a[32:35],v[128:131]
 rd a[72:75],v25,4096
 v_lshl_add_u32 v5, v7, 3, v5
 mf v[132:135],a[4:7],a[32:35],v[132:135]
 tr a[56:57],v20,6144
 v_lshrrev_b32_e64 v7, 1, v4
 mf v[148:151],a[4:7],a[36:39],v[148:151]
 tr a[58:59],v20,6400
 v_lshl_add_u32 v5, v7, 4, v5
 mf v[144:147],a[0:3],a[36:39],v[144:147]
 rd a[76:79],v25,6144
 s_add_u32 m0, s28, 118784
 mf v[160:163],a[0:3],a[40:43],v[160:163]
 buffer_load_dwordx4 v13, s[8:11], s27 offen offset:0 lds
 mf v[164:167],a[4:7],a[40:43],v[164:167]
 tr a[60:61],v21,6144
 v_and_b32_e64 v6, 7, v6
 mf v[180:183],a[4:7],a[44:47],v[180:183]
 tr a[62:63],v21,6400
 s_lshl_b32 s31, s21, 2
 s_nop 0
 mf v[176:179],a[0:3],a[44:47],v[176:179]
 rd a[80:83],v25,8192
 s_add_u32 s25, s31, 0
 s_nop 0
 mf v[184:187],a[8:11],a[44:47],v[184:187]
 rd a[84:87],v25,10240
 v_xor_b32_e64 v7, s25, v6
 mf v[188:191],a[12:15],a[44:47],v[188:191]
 buffer_load_dwordx4 v14, s[8:11], s27 offen offset:1024 lds
 mf v[172:175],a[12:15],a[40:43],v[172:175]
 rd a[88:91],v25,12288
 v_lshl_add_u32 v44, v7, 5, v5
 mf v[168:171],a[8:11],a[40:43],v[168:171]
 rd a[92:95],v25,14336
 v_add_u32 v48, 65536, v44
 mf v[152:155],a[8:11],a[36:39],v[152:155]
 s_add_u32 s25, s31, 1
 s_nop 0
 mf v[156:159],a[12:15],a[36:39],v[156:159]
 v_xor_b32_e64 v7, s25, v6
 v_lshl_add_u32 v45, v7, 5, v5
 mf v[140:143],a[12:15],a[32:35],v[140:143]
 buffer_load_dwordx4 v15, s[8:11], s27 offen offset:2048 lds
 mf v[136:139],a[8:11],a[32:35],v[136:139]
 v_add_u32 v49, 65536, v45
 s_add_u32 s25, s31, 2
 s_nop 0
 mf v[120:123],a[8:11],a[28:31],v[120:123]
 v_xor_b32_e64 v7, s25, v6
 v_lshl_add_u32 v46, v7, 5, v5
 mf v[124:127],a[12:15],a[28:31],v[124:127]
 v_add_u32 v50, 65536, v46
 s_add_u32 s25, s31, 3
 s_nop 0
 mf v[108:111],a[12:15],a[24:27],v[108:111]
 v_xor_b32_e64 v7, s25, v6
 v_lshl_add_u32 v47, v7, 5, v5
 mf v[104:107],a[8:11],a[24:27],v[104:107]
 buffer_load_dwordx4 v16, s[8:11], s27 offen offset:3072 lds
 mf v[88:91],a[8:11],a[20:23],v[88:91]
 s_add_u32 s53, s53, 128
 s_and_b32 s53, s53, 0xfff
 mf v[92:95],a[12:15],a[20:23],v[92:95]
 s_add_u32 s27, s51, s53
 s_nop 0
 v_add_u32 v51, 65536, v47
 mf v[76:79],a[12:15],a[16:19],v[76:79]
 s_lshl_b32 s31, s22, 12
 s_waitcnt vmcnt(12) lgkmcnt(0)
 mf v[72:75],a[8:11],a[16:19],v[72:75]
 s_add_u32 s31, s31, 16384
 s_barrier
 s_nop 0
 s_branch L_skip_14709
.p2align 12
L_stub_wg_14709:
 s_branch L_walk_ret
L_stub_wg2_14709:
 s_branch L_rwg2
 s_nop 0
 s_nop 0
L_skip_14709:
 mf v[64:67],a[48:51],a[64:67],v[64:67]
 rd a[16:19],v24,49152
 v_add_u32_e64 v56, s31, v40
 mf v[68:71],a[52:55],a[64:67],v[68:71]
 tr a[0:1],v20,49152
 v_add_u32 v57, 65536, v56
 mf v[84:87],a[52:55],a[68:71],v[84:87]
 tr a[2:3],v20,49408
 s_add_u32 m0, s29, 0
 s_nop 0
 mf v[80:83],a[48:51],a[68:71],v[80:83]
 buffer_load_dwordx4 v8, s[4:7], s26 offen offset:0 sc1 lds
 mf v[96:99],a[48:51],a[72:75],v[96:99]
 rd a[20:23],v24,51200
 v_min_u32 v41, 13, v1
 s_nop 0
 mf v[100:103],a[52:55],a[72:75],v[100:103]
 tr a[4:5],v21,49152
 v_lshlrev_b32_e64 v41, 3, v41
 mf v[116:119],a[52:55],a[76:79],v[116:119]
 tr a[6:7],v21,49408
 v_and_b32_e64 v5, 1, v2
 mf v[112:115],a[48:51],a[76:79],v[112:115]
 buffer_load_dwordx4 v8, s[4:7], s26 offen offset:1024 sc1 lds
 mf v[128:131],a[48:51],a[80:83],v[128:131]
 rd a[24:27],v24,53248
 v_lshlrev_b32_e64 v5, 1, v5
 mf v[132:135],a[52:55],a[80:83],v[132:135]
 tr a[8:9],v20,53248
 v_lshrrev_b32_e64 v7, 1, v2
 mf v[148:151],a[52:55],a[84:87],v[148:151]
 tr a[10:11],v20,53504
 v_or_b32_e64 v7, v7, v5
 mf v[144:147],a[48:51],a[84:87],v[144:147]
 rd a[28:31],v24,55296
 v_and_b32_e64 v6, 15, v1
 mf v[160:163],a[48:51],a[88:91],v[160:163]
 buffer_load_dwordx4 v8, s[4:7], s26 offen offset:2048 sc1 lds
 mf v[164:167],a[52:55],a[88:91],v[164:167]
 tr a[12:13],v21,53248
 v_lshlrev_b32_e64 v59, 11, v6
 mf v[180:183],a[52:55],a[92:95],v[180:183]
 tr a[14:15],v21,53504
 v_lshl_add_u32 v59, v7, 4, v59
 mf v[176:179],a[48:51],a[92:95],v[176:179]
 rd a[32:35],v24,57344
 v_and_b32_e64 v5, 1, v1
 mf v[184:187],a[56:59],a[92:95],v[184:187]
 rd a[36:39],v24,59392
 s_lshr_b32 s31, s83, 4
 s_nop 0
 mf v[188:191],a[60:63],a[92:95],v[188:191]
 buffer_load_dwordx4 v8, s[4:7], s26 offen offset:3072 sc1 lds
 mf v[172:175],a[60:63],a[88:91],v[172:175]
 rd a[40:43],v24,61440
 s_add_u32 s52, s52, 16384
 mf v[168:171],a[56:59],a[88:91],v[168:171]
 rd a[44:47],v24,63488
 s_and_b32 s52, s52, 0x7ffff
 mf v[152:155],a[56:59],a[84:87],v[152:155]
 s_add_u32 s26, s50, s52
 s_nop 0
 s_add_u32 s31, s31, 20480
 mf v[156:159],a[60:63],a[84:87],v[156:159]
 s_add_u32 m0, s28, 16384
 v_lshlrev_b32_e64 v5, 3, v5
 mf v[140:143],a[60:63],a[80:83],v[140:143]
 buffer_load_dwordx4 v9, s[8:11], s27 offen offset:0 lds
 mf v[136:139],a[56:59],a[80:83],v[136:139]
 v_add_u32 v5, s31, v5
 v_lshlrev_b32 v60, 5, v1
 mf v[120:123],a[56:59],a[76:79],v[120:123]
 v_cmp_gt_u32 vcc, 4, v1
 v_add_u32 v60, s88, v60
 mf v[124:127],a[60:63],a[76:79],v[124:127]
 s_nop 0
 v_cndmask_b32 v60, v5, v60, vcc
 mf v[108:111],a[60:63],a[72:75],v[108:111]
 s_lshl_b32 s90, s23, 8
 s_lshl_b32 s31, s24, 3
 mf v[104:107],a[56:59],a[72:75],v[104:107]
 buffer_load_dwordx4 v10, s[8:11], s27 offen offset:1024 lds
 mf v[88:91],a[56:59],a[68:71],v[88:91]
 s_add_u32 s90, s90, s31
 s_nop 0
 s_add_u32 s90, s90, 10240
 mf v[92:95],a[60:63],a[68:71],v[92:95]
 s_mul_i32 s31, s20, s20
 s_min_u32 s31, s31, 1
 mf v[76:79],a[60:63],a[64:67],v[76:79]
 s_sub_u32 s31, s31, 1
 s_waitcnt lgkmcnt(0)
 mf v[72:75],a[56:59],a[64:67],v[72:75]
 s_and_b32 s90, s90, s31
 s_mov_b32 s30, 6
.p2align 6
L_sp_loop_32:
 mf v[64:67],a[0:3],a[16:19],v[64:67]
 rd a[64:67],v25,49152
 mf v[68:71],a[4:7],a[16:19],v[68:71]
 tr a[48:49],v20,51200
 mf v[84:87],a[4:7],a[20:23],v[84:87]
 tr a[50:51],v20,51456
 mf v[80:83],a[0:3],a[20:23],v[80:83]
 buffer_load_dwordx4 v11, s[8:11], s27 offen offset:2048 lds
 mf v[96:99],a[0:3],a[24:27],v[96:99]
 rd a[68:71],v25,51200
 mf v[100:103],a[4:7],a[24:27],v[100:103]
 tr a[52:53],v21,51200
 mf v[116:119],a[4:7],a[28:31],v[116:119]
 tr a[54:55],v21,51456
 mf v[112:115],a[0:3],a[28:31],v[112:115]
 buffer_load_dwordx4 v12, s[8:11], s27 offen offset:3072 lds
 mf v[128:131],a[0:3],a[32:35],v[128:131]
 rd a[72:75],v25,53248
 mf v[132:135],a[4:7],a[32:35],v[132:135]
 tr a[56:57],v20,55296
 mf v[148:151],a[4:7],a[36:39],v[148:151]
 tr a[58:59],v20,55552
 mf v[144:147],a[0:3],a[36:39],v[144:147]
 rd a[76:79],v25,55296
 s_add_u32 m0, s28, 20480
 mf v[160:163],a[0:3],a[40:43],v[160:163]
 buffer_load_dwordx4 v13, s[8:11], s27 offen offset:0 lds
 mf v[164:167],a[4:7],a[40:43],v[164:167]
 tr a[60:61],v21,55296
 mf v[180:183],a[4:7],a[44:47],v[180:183]
 tr a[62:63],v21,55552
 mf v[176:179],a[0:3],a[44:47],v[176:179]
 rd a[80:83],v25,57344
 mf v[184:187],a[8:11],a[44:47],v[184:187]
 rd a[84:87],v25,59392
 mf v[188:191],a[12:15],a[44:47],v[188:191]
 buffer_load_dwordx4 v14, s[8:11], s27 offen offset:1024 lds
 mf v[172:175],a[12:15],a[40:43],v[172:175]
 rd a[88:91],v25,61440
 mf v[168:171],a[8:11],a[40:43],v[168:171]
 rd a[92:95],v25,63488
 mf v[152:155],a[8:11],a[36:39],v[152:155]
 mf v[156:159],a[12:15],a[36:39],v[156:159]
 mf v[140:143],a[12:15],a[32:35],v[140:143]
 buffer_load_dwordx4 v15, s[8:11], s27 offen offset:2048 lds
 mf v[136:139],a[8:11],a[32:35],v[136:139]
 mf v[120:123],a[8:11],a[28:31],v[120:123]
 mf v[124:127],a[12:15],a[28:31],v[124:127]
 mf v[108:111],a[12:15],a[24:27],v[108:111]
 mf v[104:107],a[8:11],a[24:27],v[104:107]
 buffer_load_dwordx4 v16, s[8:11], s27 offen offset:3072 lds
 mf v[88:91],a[8:11],a[20:23],v[88:91]
 s_add_u32 s53, s53, 128
 s_and_b32 s53, s53, 0xfff
 mf v[92:95],a[12:15],a[20:23],v[92:95]
 s_add_u32 s27, s51, s53
 s_nop 0
 mf v[76:79],a[12:15],a[16:19],v[76:79]
 s_waitcnt vmcnt(12) lgkmcnt(0)
 s_nop 0
 mf v[72:75],a[8:11],a[16:19],v[72:75]
 s_barrier
 s_nop 0
 mf v[64:67],a[48:51],a[64:67],v[64:67]
 rd a[16:19],v26,0
 mf v[68:71],a[52:55],a[64:67],v[68:71]
 tr a[0:1],v22,0
 mf v[84:87],a[52:55],a[68:71],v[84:87]
 tr a[2:3],v22,256
 s_add_u32 m0, s29, 49152
 mf v[80:83],a[48:51],a[68:71],v[80:83]
 buffer_load_dwordx4 v8, s[4:7], s26 offen offset:0 sc1 lds
 mf v[96:99],a[48:51],a[72:75],v[96:99]
 rd a[20:23],v26,2048
 mf v[100:103],a[52:55],a[72:75],v[100:103]
 tr a[4:5],v23,0
 mf v[116:119],a[52:55],a[76:79],v[116:119]
 tr a[6:7],v23,256
 mf v[112:115],a[48:51],a[76:79],v[112:115]
 buffer_load_dwordx4 v8, s[4:7], s26 offen offset:1024 sc1 lds
 mf v[128:131],a[48:51],a[80:83],v[128:131]
 rd a[24:27],v26,4096
 mf v[132:135],a[52:55],a[80:83],v[132:135]
 tr a[8:9],v22,4096
 mf v[148:151],a[52:55],a[84:87],v[148:151]
 tr a[10:11],v22,4352
 mf v[144:147],a[48:51],a[84:87],v[144:147]
 rd a[28:31],v26,6144
 mf v[160:163],a[48:51],a[88:91],v[160:163]
 buffer_load_dwordx4 v8, s[4:7], s26 offen offset:2048 sc1 lds
 mf v[164:167],a[52:55],a[88:91],v[164:167]
 tr a[12:13],v23,4096
 mf v[180:183],a[52:55],a[92:95],v[180:183]
 tr a[14:15],v23,4352
 mf v[176:179],a[48:51],a[92:95],v[176:179]
 rd a[32:35],v26,8192
 mf v[184:187],a[56:59],a[92:95],v[184:187]
 rd a[36:39],v26,10240
 mf v[188:191],a[60:63],a[92:95],v[188:191]
 buffer_load_dwordx4 v8, s[4:7], s26 offen offset:3072 sc1 lds
 mf v[172:175],a[60:63],a[88:91],v[172:175]
 rd a[40:43],v26,12288
 s_add_u32 s52, s52, 16384
 mf v[168:171],a[56:59],a[88:91],v[168:171]
 rd a[44:47],v26,14336
 s_and_b32 s52, s52, 0x7ffff
 mf v[152:155],a[56:59],a[84:87],v[152:155]
 s_add_u32 s26, s50, s52
 s_nop 0
 mf v[156:159],a[60:63],a[84:87],v[156:159]
 s_add_u32 m0, s28, 65536
 mf v[140:143],a[60:63],a[80:83],v[140:143]
 buffer_load_dwordx4 v9, s[8:11], s27 offen offset:0 lds
 mf v[136:139],a[56:59],a[80:83],v[136:139]
 mf v[120:123],a[56:59],a[76:79],v[120:123]
 mf v[124:127],a[60:63],a[76:79],v[124:127]
 mf v[108:111],a[60:63],a[72:75],v[108:111]
 mf v[104:107],a[56:59],a[72:75],v[104:107]
 buffer_load_dwordx4 v10, s[8:11], s27 offen offset:1024 lds
 mf v[88:91],a[56:59],a[68:71],v[88:91]
 mf v[92:95],a[60:63],a[68:71],v[92:95]
 mf v[76:79],a[60:63],a[64:67],v[76:79]
 s_waitcnt lgkmcnt(0)
 s_nop 0
 mf v[72:75],a[56:59],a[64:67],v[72:75]
 mf v[64:67],a[0:3],a[16:19],v[64:67]
 rd a[64:67],v27,0
 mf v[68:71],a[4:7],a[16:19],v[68:71]
 tr a[48:49],v22,2048
 mf v[84:87],a[4:7],a[20:23],v[84:87]
 tr a[50:51],v22,2304
 mf v[80:83],a[0:3],a[20:23],v[80:83]
 buffer_load_dwordx4 v11, s[8:11], s27 offen offset:2048 lds
 mf v[96:99],a[0:3],a[24:27],v[96:99]
 rd a[68:71],v27,2048
 mf v[100:103],a[4:7],a[24:27],v[100:103]
 tr a[52:53],v23,2048
 mf v[116:119],a[4:7],a[28:31],v[116:119]
 tr a[54:55],v23,2304
 mf v[112:115],a[0:3],a[28:31],v[112:115]
 buffer_load_dwordx4 v12, s[8:11], s27 offen offset:3072 lds
 mf v[128:131],a[0:3],a[32:35],v[128:131]
 rd a[72:75],v27,4096
 mf v[132:135],a[4:7],a[32:35],v[132:135]
 tr a[56:57],v22,6144
 mf v[148:151],a[4:7],a[36:39],v[148:151]
 tr a[58:59],v22,6400
 mf v[144:147],a[0:3],a[36:39],v[144:147]
 rd a[76:79],v27,6144
 s_add_u32 m0, s28, 69632
 mf v[160:163],a[0:3],a[40:43],v[160:163]
 buffer_load_dwordx4 v13, s[8:11], s27 offen offset:0 lds
 mf v[164:167],a[4:7],a[40:43],v[164:167]
 tr a[60:61],v23,6144
 mf v[180:183],a[4:7],a[44:47],v[180:183]
 tr a[62:63],v23,6400
 mf v[176:179],a[0:3],a[44:47],v[176:179]
 rd a[80:83],v27,8192
 mf v[184:187],a[8:11],a[44:47],v[184:187]
 rd a[84:87],v27,10240
 mf v[188:191],a[12:15],a[44:47],v[188:191]
 buffer_load_dwordx4 v14, s[8:11], s27 offen offset:1024 lds
 mf v[172:175],a[12:15],a[40:43],v[172:175]
 rd a[88:91],v27,12288
 mf v[168:171],a[8:11],a[40:43],v[168:171]
 rd a[92:95],v27,14336
 mf v[152:155],a[8:11],a[36:39],v[152:155]
 mf v[156:159],a[12:15],a[36:39],v[156:159]
 mf v[140:143],a[12:15],a[32:35],v[140:143]
 buffer_load_dwordx4 v15, s[8:11], s27 offen offset:2048 lds
 mf v[136:139],a[8:11],a[32:35],v[136:139]
 mf v[120:123],a[8:11],a[28:31],v[120:123]
 mf v[124:127],a[12:15],a[28:31],v[124:127]
 mf v[108:111],a[12:15],a[24:27],v[108:111]
 mf v[104:107],a[8:11],a[24:27],v[104:107]
 buffer_load_dwordx4 v16, s[8:11], s27 offen offset:3072 lds
 mf v[88:91],a[8:11],a[20:23],v[88:91]
 s_add_u32 s53, s53, 128
 s_and_b32 s53, s53, 0xfff
 mf v[92:95],a[12:15],a[20:23],v[92:95]
 s_add_u32 s27, s51, s53
 s_nop 0
 mf v[76:79],a[12:15],a[16:19],v[76:79]
 s_waitcnt vmcnt(12) lgkmcnt(0)
 s_nop 0
 mf v[72:75],a[8:11],a[16:19],v[72:75]
 s_barrier
 s_nop 0
 mf v[64:67],a[48:51],a[64:67],v[64:67]
 rd a[16:19],v24,0
 mf v[68:71],a[52:55],a[64:67],v[68:71]
 tr a[0:1],v20,0
 mf v[84:87],a[52:55],a[68:71],v[84:87]
 tr a[2:3],v20,256
 s_add_u32 m0, s29, 98304
 mf v[80:83],a[48:51],a[68:71],v[80:83]
 buffer_load_dwordx4 v8, s[4:7], s26 offen offset:0 sc1 lds
 mf v[96:99],a[48:51],a[72:75],v[96:99]
 rd a[20:23],v24,2048
 mf v[100:103],a[52:55],a[72:75],v[100:103]
 tr a[4:5],v21,0
 mf v[116:119],a[52:55],a[76:79],v[116:119]
 tr a[6:7],v21,256
 mf v[112:115],a[48:51],a[76:79],v[112:115]
 buffer_load_dwordx4 v8, s[4:7], s26 offen offset:1024 sc1 lds
 mf v[128:131],a[48:51],a[80:83],v[128:131]
 rd a[24:27],v24,4096
 mf v[132:135],a[52:55],a[80:83],v[132:135]
 tr a[8:9],v20,4096
 mf v[148:151],a[52:55],a[84:87],v[148:151]
 tr a[10:11],v20,4352
 mf v[144:147],a[48:51],a[84:87],v[144:147]
 rd a[28:31],v24,6144
 mf v[160:163],a[48:51],a[88:91],v[160:163]
 buffer_load_dwordx4 v8, s[4:7], s26 offen offset:2048 sc1 lds
 mf v[164:167],a[52:55],a[88:91],v[164:167]
 tr a[12:13],v21,4096
 mf v[180:183],a[52:55],a[92:95],v[180:183]
 tr a[14:15],v21,4352
 mf v[176:179],a[48:51],a[92:95],v[176:179]
 rd a[32:35],v24,8192
 mf v[184:187],a[56:59],a[92:95],v[184:187]
 rd a[36:39],v24,10240
 mf v[188:191],a[60:63],a[92:95],v[188:191]
 buffer_load_dwordx4 v8, s[4:7], s26 offen offset:3072 sc1 lds
 mf v[172:175],a[60:63],a[88:91],v[172:175]
 rd a[40:43],v24,12288
 s_add_u32 s52, s52, 16384
 mf v[168:171],a[56:59],a[88:91],v[168:171]
 rd a[44:47],v24,14336
 s_and_b32 s52, s52, 0x7ffff
 mf v[152:155],a[56:59],a[84:87],v[152:155]
 s_add_u32 s26, s50, s52
 s_nop 0
 mf v[156:159],a[60:63],a[84:87],v[156:159]
 s_add_u32 m0, s28, 114688
 mf v[140:143],a[60:63],a[80:83],v[140:143]
 buffer_load_dwordx4 v9, s[8:11], s27 offen offset:0 lds
 mf v[136:139],a[56:59],a[80:83],v[136:139]
 mf v[120:123],a[56:59],a[76:79],v[120:123]
 mf v[124:127],a[60:63],a[76:79],v[124:127]
 mf v[108:111],a[60:63],a[72:75],v[108:111]
 mf v[104:107],a[56:59],a[72:75],v[104:107]
 buffer_load_dwordx4 v10, s[8:11], s27 offen offset:1024 lds
 mf v[88:91],a[56:59],a[68:71],v[88:91]
 mf v[92:95],a[60:63],a[68:71],v[92:95]
 mf v[76:79],a[60:63],a[64:67],v[76:79]
 s_waitcnt lgkmcnt(0)
 s_nop 0
 mf v[72:75],a[56:59],a[64:67],v[72:75]
 mf v[64:67],a[0:3],a[16:19],v[64:67]
 rd a[64:67],v25,0
 mf v[68:71],a[4:7],a[16:19],v[68:71]
 tr a[48:49],v20,2048
 mf v[84:87],a[4:7],a[20:23],v[84:87]
 tr a[50:51],v20,2304
 mf v[80:83],a[0:3],a[20:23],v[80:83]
 buffer_load_dwordx4 v11, s[8:11], s27 offen offset:2048 lds
 mf v[96:99],a[0:3],a[24:27],v[96:99]
 rd a[68:71],v25,2048
 mf v[100:103],a[4:7],a[24:27],v[100:103]
 tr a[52:53],v21,2048
 mf v[116:119],a[4:7],a[28:31],v[116:119]
 tr a[54:55],v21,2304
 mf v[112:115],a[0:3],a[28:31],v[112:115]
 buffer_load_dwordx4 v12, s[8:11], s27 offen offset:3072 lds
 mf v[128:131],a[0:3],a[32:35],v[128:131]
 rd a[72:75],v25,4096
 mf v[132:135],a[4:7],a[32:35],v[132:135]
 tr a[56:57],v20,6144
 mf v[148:151],a[4:7],a[36:39],v[148:151]
 tr a[58:59],v20,6400
 mf v[144:147],a[0:3],a[36:39],v[144:147]
 rd a[76:79],v25,6144
 s_add_u32 m0, s28, 118784
 mf v[160:163],a[0:3],a[40:43],v[160:163]
 buffer_load_dwordx4 v13, s[8:11], s27 offen offset:0 lds
 mf v[164:167],a[4:7],a[40:43],v[164:167]
 tr a[60:61],v21,6144
 mf v[180:183],a[4:7],a[44:47],v[180:183]
 tr a[62:63],v21,6400
 mf v[176:179],a[0:3],a[44:47],v[176:179]
 rd a[80:83],v25,8192
 mf v[184:187],a[8:11],a[44:47],v[184:187]
 rd a[84:87],v25,10240
 mf v[188:191],a[12:15],a[44:47],v[188:191]
 buffer_load_dwordx4 v14, s[8:11], s27 offen offset:1024 lds
 mf v[172:175],a[12:15],a[40:43],v[172:175]
 rd a[88:91],v25,12288
 mf v[168:171],a[8:11],a[40:43],v[168:171]
 rd a[92:95],v25,14336
 mf v[152:155],a[8:11],a[36:39],v[152:155]
 mf v[156:159],a[12:15],a[36:39],v[156:159]
 mf v[140:143],a[12:15],a[32:35],v[140:143]
 buffer_load_dwordx4 v15, s[8:11], s27 offen offset:2048 lds
 mf v[136:139],a[8:11],a[32:35],v[136:139]
 mf v[120:123],a[8:11],a[28:31],v[120:123]
 mf v[124:127],a[12:15],a[28:31],v[124:127]
 mf v[108:111],a[12:15],a[24:27],v[108:111]
 mf v[104:107],a[8:11],a[24:27],v[104:107]
 buffer_load_dwordx4 v16, s[8:11], s27 offen offset:3072 lds
 mf v[88:91],a[8:11],a[20:23],v[88:91]
 s_add_u32 s53, s53, 128
 s_and_b32 s53, s53, 0xfff
 mf v[92:95],a[12:15],a[20:23],v[92:95]
 s_add_u32 s27, s51, s53
 s_nop 0
 mf v[76:79],a[12:15],a[16:19],v[76:79]
 s_waitcnt vmcnt(12) lgkmcnt(0)
 s_nop 0
 mf v[72:75],a[8:11],a[16:19],v[72:75]
 s_barrier
 s_nop 0
 mf v[64:67],a[48:51],a[64:67],v[64:67]
 rd a[16:19],v24,49152
 mf v[68:71],a[52:55],a[64:67],v[68:71]
 tr a[0:1],v20,49152
 mf v[84:87],a[52:55],a[68:71],v[84:87]
 tr a[2:3],v20,49408
 s_add_u32 m0, s29, 0
 s_nop 0
 mf v[80:83],a[48:51],a[68:71],v[80:83]
 buffer_load_dwordx4 v8, s[4:7], s26 offen offset:0 sc1 lds
 mf v[96:99],a[48:51],a[72:75],v[96:99]
 rd a[20:23],v24,51200
 mf v[100:103],a[52:55],a[72:75],v[100:103]
 tr a[4:5],v21,49152
 mf v[116:119],a[52:55],a[76:79],v[116:119]
 tr a[6:7],v21,49408
 mf v[112:115],a[48:51],a[76:79],v[112:115]
 buffer_load_dwordx4 v8, s[4:7], s26 offen offset:1024 sc1 lds
 mf v[128:131],a[48:51],a[80:83],v[128:131]
 rd a[24:27],v24,53248
 mf v[132:135],a[52:55],a[80:83],v[132:135]
 tr a[8:9],v20,53248
 mf v[148:151],a[52:55],a[84:87],v[148:151]
 tr a[10:11],v20,53504
 mf v[144:147],a[48:51],a[84:87],v[144:147]
 rd a[28:31],v24,55296
 mf v[160:163],a[48:51],a[88:91],v[160:163]
 buffer_load_dwordx4 v8, s[4:7], s26 offen offset:2048 sc1 lds
 mf v[164:167],a[52:55],a[88:91],v[164:167]
 tr a[12:13],v21,53248
 mf v[180:183],a[52:55],a[92:95],v[180:183]
 tr a[14:15],v21,53504
 mf v[176:179],a[48:51],a[92:95],v[176:179]
 rd a[32:35],v24,57344
 mf v[184:187],a[56:59],a[92:95],v[184:187]
 rd a[36:39],v24,59392
 mf v[188:191],a[60:63],a[92:95],v[188:191]
 buffer_load_dwordx4 v8, s[4:7], s26 offen offset:3072 sc1 lds
 mf v[172:175],a[60:63],a[88:91],v[172:175]
 rd a[40:43],v24,61440
 s_add_u32 s52, s52, 16384
 mf v[168:171],a[56:59],a[88:91],v[168:171]
 rd a[44:47],v24,63488
 s_and_b32 s52, s52, 0x7ffff
 mf v[152:155],a[56:59],a[84:87],v[152:155]
 s_add_u32 s26, s50, s52
 s_nop 0
 mf v[156:159],a[60:63],a[84:87],v[156:159]
 s_add_u32 m0, s28, 16384
 mf v[140:143],a[60:63],a[80:83],v[140:143]
 buffer_load_dwordx4 v9, s[8:11], s27 offen offset:0 lds
 mf v[136:139],a[56:59],a[80:83],v[136:139]
 mf v[120:123],a[56:59],a[76:79],v[120:123]
 mf v[124:127],a[60:63],a[76:79],v[124:127]
 mf v[108:111],a[60:63],a[72:75],v[108:111]
 mf v[104:107],a[56:59],a[72:75],v[104:107]
 buffer_load_dwordx4 v10, s[8:11], s27 offen offset:1024 lds
 mf v[88:91],a[56:59],a[68:71],v[88:91]
 mf v[92:95],a[60:63],a[68:71],v[92:95]
 mf v[76:79],a[60:63],a[64:67],v[76:79]
 s_sub_u32 s30, s30, 1
 s_waitcnt lgkmcnt(0)
 s_cmp_lg_u32 s30, 0
 s_nop 0
 mf v[72:75],a[56:59],a[64:67],v[72:75]
 s_cbranch_scc1 L_sp_loop_32
 s_nop 0
 mf v[64:67],a[0:3],a[16:19],v[64:67]
 rd a[64:67],v25,49152
 mf v[68:71],a[4:7],a[16:19],v[68:71]
 tr a[48:49],v20,51200
 mf v[84:87],a[4:7],a[20:23],v[84:87]
 tr a[50:51],v20,51456
 mf v[80:83],a[0:3],a[20:23],v[80:83]
 buffer_load_dwordx4 v11, s[8:11], s27 offen offset:2048 lds
 mf v[96:99],a[0:3],a[24:27],v[96:99]
 rd a[68:71],v25,51200
 mf v[100:103],a[4:7],a[24:27],v[100:103]
 tr a[52:53],v21,51200
 mf v[116:119],a[4:7],a[28:31],v[116:119]
 tr a[54:55],v21,51456
 mf v[112:115],a[0:3],a[28:31],v[112:115]
 buffer_load_dwordx4 v12, s[8:11], s27 offen offset:3072 lds
 mf v[128:131],a[0:3],a[32:35],v[128:131]
 rd a[72:75],v25,53248
 mf v[132:135],a[4:7],a[32:35],v[132:135]
 tr a[56:57],v20,55296
 mf v[148:151],a[4:7],a[36:39],v[148:151]
 tr a[58:59],v20,55552
 mf v[144:147],a[0:3],a[36:39],v[144:147]
 rd a[76:79],v25,55296
 s_add_u32 m0, s28, 20480
 mf v[160:163],a[0:3],a[40:43],v[160:163]
 buffer_load_dwordx4 v13, s[8:11], s27 offen offset:0 lds
 mf v[164:167],a[4:7],a[40:43],v[164:167]
 tr a[60:61],v21,55296
 mf v[180:183],a[4:7],a[44:47],v[180:183]
 tr a[62:63],v21,55552
 mf v[176:179],a[0:3],a[44:47],v[176:179]
 rd a[80:83],v25,57344
 mf v[184:187],a[8:11],a[44:47],v[184:187]
 rd a[84:87],v25,59392
 mf v[188:191],a[12:15],a[44:47],v[188:191]
 buffer_load_dwordx4 v14, s[8:11], s27 offen offset:1024 lds
 mf v[172:175],a[12:15],a[40:43],v[172:175]
 rd a[88:91],v25,61440
 mf v[168:171],a[8:11],a[40:43],v[168:171]
 rd a[92:95],v25,63488
 mf v[152:155],a[8:11],a[36:39],v[152:155]
 mf v[156:159],a[12:15],a[36:39],v[156:159]
 mf v[140:143],a[12:15],a[32:35],v[140:143]
 buffer_load_dwordx4 v15, s[8:11], s27 offen offset:2048 lds
 mf v[136:139],a[8:11],a[32:35],v[136:139]
 mf v[120:123],a[8:11],a[28:31],v[120:123]
 mf v[124:127],a[12:15],a[28:31],v[124:127]
 mf v[108:111],a[12:15],a[24:27],v[108:111]
 mf v[104:107],a[8:11],a[24:27],v[104:107]
 buffer_load_dwordx4 v16, s[8:11], s27 offen offset:3072 lds
 mf v[88:91],a[8:11],a[20:23],v[88:91]
 s_add_u32 s53, s53, 128
 s_and_b32 s53, s53, 0xfff
 mf v[92:95],a[12:15],a[20:23],v[92:95]
 s_add_u32 s27, s51, s53
 s_nop 0
 mf v[76:79],a[12:15],a[16:19],v[76:79]
 s_waitcnt vmcnt(12) lgkmcnt(0)
 s_nop 0
 mf v[72:75],a[8:11],a[16:19],v[72:75]
 s_barrier
 s_nop 0
 mf v[64:67],a[48:51],a[64:67],v[64:67]
 s_branch L_skip_15252
.p2align 12
L_stub_wg_15252:
 s_branch L_walk_ret
L_stub_wg2_15252:
 s_branch L_rwg2
 s_nop 0
 s_nop 0
L_skip_15252:
 rd a[16:19],v26,0
 mf v[68:71],a[52:55],a[64:67],v[68:71]
 tr a[0:1],v22,0
 mf v[84:87],a[52:55],a[68:71],v[84:87]
 tr a[2:3],v22,256
 s_add_u32 m0, s29, 49152
 mf v[80:83],a[48:51],a[68:71],v[80:83]
 buffer_load_dwordx4 v8, s[4:7], s26 offen offset:0 sc1 lds
 mf v[96:99],a[48:51],a[72:75],v[96:99]
 rd a[20:23],v26,2048
 mf v[100:103],a[52:55],a[72:75],v[100:103]
 tr a[4:5],v23,0
 mf v[116:119],a[52:55],a[76:79],v[116:119]
 tr a[6:7],v23,256
 mf v[112:115],a[48:51],a[76:79],v[112:115]
 buffer_load_dwordx4 v8, s[4:7], s26 offen offset:1024 sc1 lds
 mf v[128:131],a[48:51],a[80:83],v[128:131]
 rd a[24:27],v26,4096
 mf v[132:135],a[52:55],a[80:83],v[132:135]
 tr a[8:9],v22,4096
 mf v[148:151],a[52:55],a[84:87],v[148:151]
 tr a[10:11],v22,4352
 mf v[144:147],a[48:51],a[84:87],v[144:147]
 rd a[28:31],v26,6144
 mf v[160:163],a[48:51],a[88:91],v[160:163]
 buffer_load_dwordx4 v8, s[4:7], s26 offen offset:2048 sc1 lds
 mf v[164:167],a[52:55],a[88:91],v[164:167]
 tr a[12:13],v23,4096
 mf v[180:183],a[52:55],a[92:95],v[180:183]
 tr a[14:15],v23,4352
 mf v[176:179],a[48:51],a[92:95],v[176:179]
 rd a[32:35],v26,8192
 mf v[184:187],a[56:59],a[92:95],v[184:187]
 rd a[36:39],v26,10240
 mf v[188:191],a[60:63],a[92:95],v[188:191]
 buffer_load_dwordx4 v8, s[4:7], s26 offen offset:3072 sc1 lds
 mf v[172:175],a[60:63],a[88:91],v[172:175]
 rd a[40:43],v26,12288
 s_add_u32 s52, s52, 16384
 mf v[168:171],a[56:59],a[88:91],v[168:171]
 rd a[44:47],v26,14336
 s_and_b32 s52, s52, 0x7ffff
 mf v[152:155],a[56:59],a[84:87],v[152:155]
 s_add_u32 s26, s50, s52
 s_nop 0
 mf v[156:159],a[60:63],a[84:87],v[156:159]
 s_add_u32 m0, s28, 65536
 mf v[140:143],a[60:63],a[80:83],v[140:143]
 buffer_load_dwordx4 v9, s[8:11], s27 offen offset:0 lds
 mf v[136:139],a[56:59],a[80:83],v[136:139]
 mf v[120:123],a[56:59],a[76:79],v[120:123]
 mf v[124:127],a[60:63],a[76:79],v[124:127]
 mf v[108:111],a[60:63],a[72:75],v[108:111]
 mf v[104:107],a[56:59],a[72:75],v[104:107]
 buffer_load_dwordx4 v10, s[8:11], s27 offen offset:1024 lds
 mf v[88:91],a[56:59],a[68:71],v[88:91]
 mf v[92:95],a[60:63],a[68:71],v[92:95]
 mf v[76:79],a[60:63],a[64:67],v[76:79]
 s_waitcnt lgkmcnt(0)
 s_nop 0
 mf v[72:75],a[56:59],a[64:67],v[72:75]
 mf v[64:67],a[0:3],a[16:19],v[64:67]
 rd a[64:67],v27,0
 mf v[68:71],a[4:7],a[16:19],v[68:71]
 tr a[48:49],v22,2048
 mf v[84:87],a[4:7],a[20:23],v[84:87]
 tr a[50:51],v22,2304
 mf v[80:83],a[0:3],a[20:23],v[80:83]
 buffer_load_dwordx4 v11, s[8:11], s27 offen offset:2048 lds
 mf v[96:99],a[0:3],a[24:27],v[96:99]
 rd a[68:71],v27,2048
 mf v[100:103],a[4:7],a[24:27],v[100:103]
 tr a[52:53],v23,2048
 mf v[116:119],a[4:7],a[28:31],v[116:119]
 tr a[54:55],v23,2304
 mf v[112:115],a[0:3],a[28:31],v[112:115]
 buffer_load_dwordx4 v12, s[8:11], s27 offen offset:3072 lds
 mf v[128:131],a[0:3],a[32:35],v[128:131]
 rd a[72:75],v27,4096
 mf v[132:135],a[4:7],a[32:35],v[132:135]
 tr a[56:57],v22,6144
 mf v[148:151],a[4:7],a[36:39],v[148:151]
 tr a[58:59],v22,6400
 mf v[144:147],a[0:3],a[36:39],v[144:147]
 rd a[76:79],v27,6144
 s_add_u32 m0, s28, 69632
 mf v[160:163],a[0:3],a[40:43],v[160:163]
 buffer_load_dwordx4 v13, s[8:11], s27 offen offset:0 lds
 mf v[164:167],a[4:7],a[40:43],v[164:167]
 tr a[60:61],v23,6144
 mf v[180:183],a[4:7],a[44:47],v[180:183]
 tr a[62:63],v23,6400
 mf v[176:179],a[0:3],a[44:47],v[176:179]
 rd a[80:83],v27,8192
 mf v[184:187],a[8:11],a[44:47],v[184:187]
 rd a[84:87],v27,10240
 mf v[188:191],a[12:15],a[44:47],v[188:191]
 buffer_load_dwordx4 v14, s[8:11], s27 offen offset:1024 lds
 mf v[172:175],a[12:15],a[40:43],v[172:175]
 rd a[88:91],v27,12288
 mf v[168:171],a[8:11],a[40:43],v[168:171]
 rd a[92:95],v27,14336
 mf v[152:155],a[8:11],a[36:39],v[152:155]
 mf v[156:159],a[12:15],a[36:39],v[156:159]
 mf v[140:143],a[12:15],a[32:35],v[140:143]
 buffer_load_dwordx4 v15, s[8:11], s27 offen offset:2048 lds
 mf v[136:139],a[8:11],a[32:35],v[136:139]
 mf v[120:123],a[8:11],a[28:31],v[120:123]
 mf v[124:127],a[12:15],a[28:31],v[124:127]
 mf v[108:111],a[12:15],a[24:27],v[108:111]
 mf v[104:107],a[8:11],a[24:27],v[104:107]
 buffer_load_dwordx4 v16, s[8:11], s27 offen offset:3072 lds
 mf v[88:91],a[8:11],a[20:23],v[88:91]
 s_add_u32 s53, s53, 128
 s_and_b32 s53, s53, 0xfff
 mf v[92:95],a[12:15],a[20:23],v[92:95]
 s_add_u32 s27, s51, s53
 s_nop 0
 mf v[76:79],a[12:15],a[16:19],v[76:79]
 s_waitcnt vmcnt(12) lgkmcnt(0)
 s_nop 0
 mf v[72:75],a[8:11],a[16:19],v[72:75]
 s_barrier
 s_cmp_eq_u32 s20, 0
 s_cbranch_scc1 L_stub_w1_16317
 s_cmp_eq_u32 s20, 1
 s_cbranch_scc1 L_stub_w1_16854
 s_cmp_eq_u32 s20, 2
 s_cbranch_scc1 L_stub_w1_17391
 s_branch L_stub_w1_17954
 s_nop 0
L_walk_z_ret:
 s_nop 0
 mf v[64:67],a[48:51],a[64:67],v[64:67]
 rd a[16:19],v24,0
 mf v[68:71],a[52:55],a[64:67],v[68:71]
 tr a[0:1],v20,0
 mf v[84:87],a[52:55],a[68:71],v[84:87]
 tr a[2:3],v20,256
 mf v[80:83],a[48:51],a[68:71],v[80:83]
 rd a[20:23],v24,2048
 mf v[96:99],a[48:51],a[72:75],v[96:99]
 mf v[100:103],a[52:55],a[72:75],v[100:103]
 tr a[4:5],v21,0
 mf v[116:119],a[52:55],a[76:79],v[116:119]
 tr a[6:7],v21,256
 mf v[112:115],a[48:51],a[76:79],v[112:115]
 rd a[24:27],v24,4096
 mf v[128:131],a[48:51],a[80:83],v[128:131]
 mf v[132:135],a[52:55],a[80:83],v[132:135]
 tr a[8:9],v20,4096
 mf v[148:151],a[52:55],a[84:87],v[148:151]
 tr a[10:11],v20,4352
 mf v[144:147],a[48:51],a[84:87],v[144:147]
 rd a[28:31],v24,6144
 mf v[160:163],a[48:51],a[88:91],v[160:163]
 mf v[164:167],a[52:55],a[88:91],v[164:167]
 tr a[12:13],v21,4096
 mf v[180:183],a[52:55],a[92:95],v[180:183]
 tr a[14:15],v21,4352
 mf v[176:179],a[48:51],a[92:95],v[176:179]
 rd a[32:35],v24,8192
 mf v[184:187],a[56:59],a[92:95],v[184:187]
 mf v[188:191],a[60:63],a[92:95],v[188:191]
 rd a[36:39],v24,10240
 mf v[172:175],a[60:63],a[88:91],v[172:175]
 rd a[40:43],v24,12288
 mf v[168:171],a[56:59],a[88:91],v[168:171]
 rd a[44:47],v24,14336
 mf v[152:155],a[56:59],a[84:87],v[152:155]
 mf v[156:159],a[60:63],a[84:87],v[156:159]
 mf v[140:143],a[60:63],a[80:83],v[140:143]
 mf v[136:139],a[56:59],a[80:83],v[136:139]
 mf v[120:123],a[56:59],a[76:79],v[120:123]
 mf v[124:127],a[60:63],a[76:79],v[124:127]
 mf v[108:111],a[60:63],a[72:75],v[108:111]
 mf v[104:107],a[56:59],a[72:75],v[104:107]
 mf v[88:91],a[56:59],a[68:71],v[88:91]
 mf v[92:95],a[60:63],a[68:71],v[92:95]
 mf v[76:79],a[60:63],a[64:67],v[76:79]
 s_waitcnt lgkmcnt(0)
 s_nop 0
 mf v[72:75],a[56:59],a[64:67],v[72:75]
 mf v[64:67],a[0:3],a[16:19],v[64:67]
 rd a[64:67],v25,0
 mf v[68:71],a[4:7],a[16:19],v[68:71]
 tr a[48:49],v20,2048
 mf v[84:87],a[4:7],a[20:23],v[84:87]
 tr a[50:51],v20,2304
 mf v[80:83],a[0:3],a[20:23],v[80:83]
 rd a[68:71],v25,2048
 mf v[96:99],a[0:3],a[24:27],v[96:99]
 mf v[100:103],a[4:7],a[24:27],v[100:103]
 tr a[52:53],v21,2048
 mf v[116:119],a[4:7],a[28:31],v[116:119]
 tr a[54:55],v21,2304
 mf v[112:115],a[0:3],a[28:31],v[112:115]
 rd a[72:75],v25,4096
 mf v[128:131],a[0:3],a[32:35],v[128:131]
 tr a[56:57],v20,6144
 mf v[132:135],a[4:7],a[32:35],v[132:135]
 mf v[148:151],a[4:7],a[36:39],v[148:151]
 tr a[58:59],v20,6400
 mf v[144:147],a[0:3],a[36:39],v[144:147]
 rd a[76:79],v25,6144
 mf v[160:163],a[0:3],a[40:43],v[160:163]
 tr a[60:61],v21,6144
 mf v[164:167],a[4:7],a[40:43],v[164:167]
 tr a[62:63],v21,6400
 mf v[180:183],a[4:7],a[44:47],v[180:183]
 mf v[176:179],a[0:3],a[44:47],v[176:179]
 buffer_load_dwordx2 v[42:43], v60, s[16:19], 0 offen sc1
 mf v[184:187],a[8:11],a[44:47],v[184:187]
 rd a[80:83],v25,8192
 mf v[188:191],a[12:15],a[44:47],v[188:191]
 rd a[84:87],v25,10240
 mf v[172:175],a[12:15],a[40:43],v[172:175]
 rd a[88:91],v25,12288
 mf v[168:171],a[8:11],a[40:43],v[168:171]
 rd a[92:95],v25,14336
 mf v[152:155],a[8:11],a[36:39],v[152:155]
 mf v[156:159],a[12:15],a[36:39],v[156:159]
 mf v[140:143],a[12:15],a[32:35],v[140:143]
 mf v[136:139],a[8:11],a[32:35],v[136:139]
 mf v[120:123],a[8:11],a[28:31],v[120:123]
 mf v[124:127],a[12:15],a[28:31],v[124:127]
 mf v[108:111],a[12:15],a[24:27],v[108:111]
 mf v[104:107],a[8:11],a[24:27],v[104:107]
 mf v[88:91],a[8:11],a[20:23],v[88:91]
 mf v[92:95],a[12:15],a[20:23],v[92:95]
 mf v[76:79],a[12:15],a[16:19],v[76:79]
 s_waitcnt vmcnt(1) lgkmcnt(0)
 s_nop 0
 mf v[72:75],a[8:11],a[16:19],v[72:75]
 s_barrier
 s_nop 0
 mf v[64:67],a[48:51],a[64:67],v[64:67]
 rd a[16:19],v24,49152
 mf v[68:71],a[52:55],a[64:67],v[68:71]
 tr a[0:1],v20,49152
 mf v[84:87],a[52:55],a[68:71],v[84:87]
 tr a[2:3],v20,49408
 mf v[80:83],a[48:51],a[68:71],v[80:83]
 rd a[20:23],v24,51200
 mf v[96:99],a[48:51],a[72:75],v[96:99]
 mf v[100:103],a[52:55],a[72:75],v[100:103]
 tr a[4:5],v21,49152
 mf v[116:119],a[52:55],a[76:79],v[116:119]
 tr a[6:7],v21,49408
 mf v[112:115],a[48:51],a[76:79],v[112:115]
 rd a[24:27],v24,53248
 mf v[128:131],a[48:51],a[80:83],v[128:131]
 mf v[132:135],a[52:55],a[80:83],v[132:135]
 tr a[8:9],v20,53248
 mf v[148:151],a[52:55],a[84:87],v[148:151]
 tr a[10:11],v20,53504
 mf v[144:147],a[48:51],a[84:87],v[144:147]
 rd a[28:31],v24,55296
 mf v[160:163],a[48:51],a[88:91],v[160:163]
 mf v[164:167],a[52:55],a[88:91],v[164:167]
 tr a[12:13],v21,53248
 mf v[180:183],a[52:55],a[92:95],v[180:183]
 tr a[14:15],v21,53504
 mf v[176:179],a[48:51],a[92:95],v[176:179]
 rd a[32:35],v24,57344
 mf v[184:187],a[56:59],a[92:95],v[184:187]
 mf v[188:191],a[60:63],a[92:95],v[188:191]
 rd a[36:39],v24,59392
 mf v[172:175],a[60:63],a[88:91],v[172:175]
 rd a[40:43],v24,61440
 mf v[168:171],a[56:59],a[88:91],v[168:171]
 rd a[44:47],v24,63488
 mf v[152:155],a[56:59],a[84:87],v[152:155]
 mf v[156:159],a[60:63],a[84:87],v[156:159]
 mf v[140:143],a[60:63],a[80:83],v[140:143]
 mf v[136:139],a[56:59],a[80:83],v[136:139]
 mf v[120:123],a[56:59],a[76:79],v[120:123]
 mf v[124:127],a[60:63],a[76:79],v[124:127]
 mf v[108:111],a[60:63],a[72:75],v[108:111]
 mf v[104:107],a[56:59],a[72:75],v[104:107]
 mf v[88:91],a[56:59],a[68:71],v[88:91]
 mf v[92:95],a[60:63],a[68:71],v[92:95]
 mf v[76:79],a[60:63],a[64:67],v[76:79]
 s_waitcnt lgkmcnt(0)
 s_nop 0
 mf v[72:75],a[56:59],a[64:67],v[72:75]
 mf v[64:67],a[0:3],a[16:19],v[64:67]
 rd a[64:67],v25,49152
 mf v[68:71],a[4:7],a[16:19],v[68:71]
 tr a[48:49],v20,51200
 mf v[84:87],a[4:7],a[20:23],v[84:87]
 tr a[50:51],v20,51456
 mf v[80:83],a[0:3],a[20:23],v[80:83]
 rd a[68:71],v25,51200
 mf v[96:99],a[0:3],a[24:27],v[96:99]
 mf v[100:103],a[4:7],a[24:27],v[100:103]
 tr a[52:53],v21,51200
 mf v[116:119],a[4:7],a[28:31],v[116:119]
 tr a[54:55],v21,51456
 mf v[112:115],a[0:3],a[28:31],v[112:115]
 rd a[72:75],v25,53248
 mf v[128:131],a[0:3],a[32:35],v[128:131]
 mf v[132:135],a[4:7],a[32:35],v[132:135]
 tr a[56:57],v20,55296
 mf v[148:151],a[4:7],a[36:39],v[148:151]
 tr a[58:59],v20,55552
 mf v[144:147],a[0:3],a[36:39],v[144:147]
 rd a[76:79],v25,55296
 mf v[160:163],a[0:3],a[40:43],v[160:163]
 mf v[164:167],a[4:7],a[40:43],v[164:167]
 tr a[60:61],v21,55296
 mf v[180:183],a[4:7],a[44:47],v[180:183]
 tr a[62:63],v21,55552
 mf v[176:179],a[0:3],a[44:47],v[176:179]
 rd a[80:83],v25,57344
 mf v[184:187],a[8:11],a[44:47],v[184:187]
 mf v[188:191],a[12:15],a[44:47],v[188:191]
 rd a[84:87],v25,59392
 mf v[172:175],a[12:15],a[40:43],v[172:175]
 rd a[88:91],v25,61440
 mf v[168:171],a[8:11],a[40:43],v[168:171]
 rd a[92:95],v25,63488
 mf v[152:155],a[8:11],a[36:39],v[152:155]
 mf v[156:159],a[12:15],a[36:39],v[156:159]
 mf v[140:143],a[12:15],a[32:35],v[140:143]
 mf v[136:139],a[8:11],a[32:35],v[136:139]
 mf v[120:123],a[8:11],a[28:31],v[120:123]
 mf v[124:127],a[12:15],a[28:31],v[124:127]
 mf v[108:111],a[12:15],a[24:27],v[108:111]
 mf v[104:107],a[8:11],a[24:27],v[104:107]
 mf v[88:91],a[8:11],a[20:23],v[88:91]
 mf v[92:95],a[12:15],a[20:23],v[92:95]
 mf v[76:79],a[12:15],a[16:19],v[76:79]
 s_waitcnt lgkmcnt(0)
 s_nop 0
 mf v[72:75],a[8:11],a[16:19],v[72:75]
 s_barrier
 s_waitcnt vmcnt(0)
 v_cmp_ne_u64 vcc, s[36:37], v[42:43]
 s_cmp_lg_u64 vcc, 0
 s_cbranch_scc1 L_o_late
L_o_ok:
 s_nop 0
 mf v[64:67],a[48:51],a[64:67],v[64:67]
 s_add_u32 s4, s32, 50331648
 s_addc_u32 s5, s33, 0
 s_nop 0
 s_mov_b32 s6, 5242880
 mf v[68:71],a[52:55],a[64:67],v[68:71]
 s_add_u32 s8, s32, 4194304
 s_addc_u32 s9, s33, 0
 s_nop 0
 s_mov_b32 s10, 16777216
 mf v[84:87],a[52:55],a[68:71],v[84:87]
 s_mov_b32 s26, s81
 s_mov_b32 s27, s82
 s_add_u32 m0, s29, 0
 s_nop 0
 mf v[80:83],a[48:51],a[68:71],v[80:83]
 buffer_load_dwordx4 v40, s[4:7], s26 offen offset:0 lds
 mf v[96:99],a[48:51],a[72:75],v[96:99]
 mf v[100:103],a[52:55],a[72:75],v[100:103]
 buffer_load_dwordx4 v40, s[4:7], s26 offen offset:1024 lds
 mf v[116:119],a[52:55],a[76:79],v[116:119]
 mf v[112:115],a[48:51],a[76:79],v[112:115]
 mf v[128:131],a[48:51],a[80:83],v[128:131]
 mf v[132:135],a[52:55],a[80:83],v[132:135]
 buffer_load_dwordx4 v40, s[4:7], s26 offen offset:2048 lds
 mf v[148:151],a[52:55],a[84:87],v[148:151]
 mf v[144:147],a[48:51],a[84:87],v[144:147]
 mf v[160:163],a[48:51],a[88:91],v[160:163]
 buffer_load_dwordx4 v40, s[4:7], s26 offen offset:3072 lds
 mf v[164:167],a[52:55],a[88:91],v[164:167]
 mf v[180:183],a[52:55],a[92:95],v[180:183]
 s_add_u32 s26, s26, 16384
 mf v[176:179],a[48:51],a[92:95],v[176:179]
 s_add_u32 m0, s29, 16384
 mf v[184:187],a[56:59],a[92:95],v[184:187]
 buffer_load_dwordx4 v40, s[8:11], s27 offen offset:0 lds
 mf v[188:191],a[60:63],a[92:95],v[188:191]
 mf v[172:175],a[60:63],a[88:91],v[172:175]
 mf v[168:171],a[56:59],a[88:91],v[168:171]
 mf v[152:155],a[56:59],a[84:87],v[152:155]
 buffer_load_dwordx4 v40, s[8:11], s27 offen offset:1024 lds
 mf v[156:159],a[60:63],a[84:87],v[156:159]
 mf v[140:143],a[60:63],a[80:83],v[140:143]
 mf v[136:139],a[56:59],a[80:83],v[136:139]
 buffer_load_dwordx4 v40, s[8:11], s27 offen offset:2048 lds
 mf v[120:123],a[56:59],a[76:79],v[120:123]
 mf v[124:127],a[60:63],a[76:79],v[124:127]
 mf v[108:111],a[60:63],a[72:75],v[108:111]
 mf v[104:107],a[56:59],a[72:75],v[104:107]
 buffer_load_dwordx4 v40, s[8:11], s27 offen offset:3072 lds
 mf v[88:91],a[56:59],a[68:71],v[88:91]
 s_add_u32 s27, s27, 262144
 mf v[92:95],a[60:63],a[68:71],v[92:95]
 mf v[76:79],a[60:63],a[64:67],v[76:79]
 mf v[72:75],a[56:59],a[64:67],v[72:75]
 s_add_u32 s12, s32, 0x1400000
 s_addc_u32 s13, s33, 0
 s_nop 0
 s_mov_b32 s14, 0x700000
 s_mov_b32 s15, 0x20000
 s_lshl_b32 s35, s24, 2
 s_lshl_b32 s31, s21, 1
 s_add_u32 s35, s35, s31
 s_lshl_b32 s35, s35, 7
 s_lshl_b32 s31, s23, 4
 s_add_u32 s35, s35, s31
 s_lshl_b32 s31, s22, 3
 s_add_u32 s35, s35, s31
 s_lshl_b32 s35, s35, 10
 s_nop 0
 s_add_u32 m0, s29, 32768
 s_nop 0
 s_nop 0
 buffer_load_dwordx4 v40, s[4:7], s26 offen offset:0 lds
 v_lshlrev_b32_e64 v8, 16, v192
 v_and_b32 v9, 0xffff0000, v192
 v_lshlrev_b32_e64 v10, 16, v193
 v_and_b32 v11, 0xffff0000, v193
 v_lshlrev_b32_e64 v12, 16, v194
 v_and_b32 v13, 0xffff0000, v194
 v_lshlrev_b32_e64 v14, 16, v195
 v_and_b32 v15, 0xffff0000, v195
 v_pk_add_f32 v[64:65], v[64:65], v[28:29] op_sel:[0,0] op_sel_hi:[1,0]
 v_pk_add_f32 v[66:67], v[66:67], v[28:29] op_sel:[0,0] op_sel_hi:[1,0]
 v_pk_add_f32 v[68:69], v[68:69], v[28:29] op_sel:[0,0] op_sel_hi:[1,0]
 v_pk_add_f32 v[70:71], v[70:71], v[28:29] op_sel:[0,0] op_sel_hi:[1,0]
 v_pk_mul_f32 v[64:65], v[64:65], v[8:9]
 v_pk_mul_f32 v[66:67], v[66:67], v[10:11]
 v_pk_mul_f32 v[68:69], v[68:69], v[12:13]
 v_pk_mul_f32 v[70:71], v[70:71], v[14:15]
 v_cvt_pk_bf16_f32 v192, v64, v65
 v_cvt_pk_bf16_f32 v193, v66, v67
 v_cvt_pk_bf16_f32 v194, v68, v69
 v_cvt_pk_bf16_f32 v195, v70, v71
 s_add_u32 s41, s35, 0
 s_nop 0
 buffer_store_dwordx4 v[192:195], v19, s[12:15], s41 offen offset:0 sc1
 buffer_load_dwordx4 v40, s[4:7], s26 offen offset:1024 lds
 buffer_load_dwordx4 v40, s[4:7], s26 offen offset:2048 lds
 v_lshlrev_b32_e64 v20, 16, v196
 v_and_b32 v21, 0xffff0000, v196
 v_lshlrev_b32_e64 v22, 16, v197
 v_and_b32 v23, 0xffff0000, v197
 v_lshlrev_b32_e64 v24, 16, v198
 v_and_b32 v25, 0xffff0000, v198
 v_lshlrev_b32_e64 v26, 16, v199
 v_and_b32 v27, 0xffff0000, v199
 v_pk_add_f32 v[72:73], v[72:73], v[28:29] op_sel:[0,0] op_sel_hi:[1,0]
 v_pk_add_f32 v[74:75], v[74:75], v[28:29] op_sel:[0,0] op_sel_hi:[1,0]
 v_pk_add_f32 v[76:77], v[76:77], v[28:29] op_sel:[0,0] op_sel_hi:[1,0]
 v_pk_add_f32 v[78:79], v[78:79], v[28:29] op_sel:[0,0] op_sel_hi:[1,0]
 v_pk_mul_f32 v[72:73], v[72:73], v[20:21]
 v_pk_mul_f32 v[74:75], v[74:75], v[22:23]
 v_pk_mul_f32 v[76:77], v[76:77], v[24:25]
 v_pk_mul_f32 v[78:79], v[78:79], v[26:27]
 v_cvt_pk_bf16_f32 v196, v72, v73
 v_cvt_pk_bf16_f32 v197, v74, v75
 v_cvt_pk_bf16_f32 v198, v76, v77
 v_cvt_pk_bf16_f32 v199, v78, v79
 s_add_u32 s41, s35, 131072
 buffer_store_dwordx4 v[196:199], v19, s[12:15], s41 offen offset:0 sc1
 buffer_load_dwordx4 v40, s[4:7], s26 offen offset:3072 lds
 s_add_u32 s26, s26, 16384
 v_lshlrev_b32_e64 v8, 16, v200
 v_and_b32 v9, 0xffff0000, v200
 v_lshlrev_b32_e64 v10, 16, v201
 v_and_b32 v11, 0xffff0000, v201
 v_lshlrev_b32_e64 v12, 16, v202
 v_and_b32 v13, 0xffff0000, v202
 v_lshlrev_b32_e64 v14, 16, v203
 v_and_b32 v15, 0xffff0000, v203
 v_pk_add_f32 v[80:81], v[80:81], v[28:29] op_sel:[0,1] op_sel_hi:[1,1]
 v_pk_add_f32 v[82:83], v[82:83], v[28:29] op_sel:[0,1] op_sel_hi:[1,1]
 v_pk_add_f32 v[84:85], v[84:85], v[28:29] op_sel:[0,1] op_sel_hi:[1,1]
 v_pk_add_f32 v[86:87], v[86:87], v[28:29] op_sel:[0,1] op_sel_hi:[1,1]
 v_pk_mul_f32 v[80:81], v[80:81], v[8:9]
 v_pk_mul_f32 v[82:83], v[82:83], v[10:11]
 v_pk_mul_f32 v[84:85], v[84:85], v[12:13]
 v_pk_mul_f32 v[86:87], v[86:87], v[14:15]
 v_cvt_pk_bf16_f32 v200, v80, v81
 v_cvt_pk_bf16_f32 v201, v82, v83
 v_cvt_pk_bf16_f32 v202, v84, v85
 v_cvt_pk_bf16_f32 v203, v86, v87
 s_add_u32 s41, s35, 0
 s_nop 0
 buffer_store_dwordx4 v[200:203], v19, s[12:15], s41 offen offset:1024 sc1
 s_add_u32 m0, s29, 49152
 s_nop 0
 s_nop 0
 buffer_load_dwordx4 v40, s[8:11], s27 offen offset:0 lds
 v_lshlrev_b32_e64 v20, 16, v204
 v_and_b32 v21, 0xffff0000, v204
 v_lshlrev_b32_e64 v22, 16, v205
 v_and_b32 v23, 0xffff0000, v205
 v_lshlrev_b32_e64 v24, 16, v206
 v_and_b32 v25, 0xffff0000, v206
 v_lshlrev_b32_e64 v26, 16, v207
 v_and_b32 v27, 0xffff0000, v207
 v_pk_add_f32 v[88:89], v[88:89], v[28:29] op_sel:[0,1] op_sel_hi:[1,1]
 v_pk_add_f32 v[90:91], v[90:91], v[28:29] op_sel:[0,1] op_sel_hi:[1,1]
 v_pk_add_f32 v[92:93], v[92:93], v[28:29] op_sel:[0,1] op_sel_hi:[1,1]
 v_pk_add_f32 v[94:95], v[94:95], v[28:29] op_sel:[0,1] op_sel_hi:[1,1]
 v_pk_mul_f32 v[88:89], v[88:89], v[20:21]
 v_pk_mul_f32 v[90:91], v[90:91], v[22:23]
 v_pk_mul_f32 v[92:93], v[92:93], v[24:25]
 v_pk_mul_f32 v[94:95], v[94:95], v[26:27]
 v_cvt_pk_bf16_f32 v204, v88, v89
 v_cvt_pk_bf16_f32 v205, v90, v91
 v_cvt_pk_bf16_f32 v206, v92, v93
 v_cvt_pk_bf16_f32 v207, v94, v95
 s_add_u32 s41, s35, 131072
 buffer_store_dwordx4 v[204:207], v19, s[12:15], s41 offen offset:1024 sc1
 buffer_load_dwordx4 v40, s[8:11], s27 offen offset:1024 lds
 buffer_load_dwordx4 v40, s[8:11], s27 offen offset:2048 lds
 v_lshlrev_b32_e64 v8, 16, v208
 v_and_b32 v9, 0xffff0000, v208
 v_lshlrev_b32_e64 v10, 16, v209
 v_and_b32 v11, 0xffff0000, v209
 v_lshlrev_b32_e64 v12, 16, v210
 v_and_b32 v13, 0xffff0000, v210
 v_lshlrev_b32_e64 v14, 16, v211
 v_and_b32 v15, 0xffff0000, v211
 v_pk_add_f32 v[96:97], v[96:97], v[30:31] op_sel:[0,0] op_sel_hi:[1,0]
 v_pk_add_f32 v[98:99], v[98:99], v[30:31] op_sel:[0,0] op_sel_hi:[1,0]
 v_pk_add_f32 v[100:101], v[100:101], v[30:31] op_sel:[0,0] op_sel_hi:[1,0]
 v_pk_add_f32 v[102:103], v[102:103], v[30:31] op_sel:[0,0] op_sel_hi:[1,0]
 v_pk_mul_f32 v[96:97], v[96:97], v[8:9]
 v_pk_mul_f32 v[98:99], v[98:99], v[10:11]
 v_pk_mul_f32 v[100:101], v[100:101], v[12:13]
 v_pk_mul_f32 v[102:103], v[102:103], v[14:15]
 v_cvt_pk_bf16_f32 v208, v96, v97
 v_cvt_pk_bf16_f32 v209, v98, v99
 v_cvt_pk_bf16_f32 v210, v100, v101
 v_cvt_pk_bf16_f32 v211, v102, v103
 s_add_u32 s41, s35, 0
 s_nop 0
 buffer_store_dwordx4 v[208:211], v19, s[12:15], s41 offen offset:2048 sc1
 buffer_load_dwordx4 v40, s[8:11], s27 offen offset:3072 lds
 s_add_u32 s27, s27, 262144
 v_lshlrev_b32_e64 v20, 16, v212
 s_branch L_skip_15788
.p2align 12
L_stub_wg_15788:
 s_branch L_walk_ret
L_stub_wg2_15788:
 s_branch L_rwg2
 s_nop 0
 s_nop 0
L_skip_15788:
 v_and_b32 v21, 0xffff0000, v212
 v_lshlrev_b32_e64 v22, 16, v213
 v_and_b32 v23, 0xffff0000, v213
 v_lshlrev_b32_e64 v24, 16, v214
 v_and_b32 v25, 0xffff0000, v214
 v_lshlrev_b32_e64 v26, 16, v215
 v_and_b32 v27, 0xffff0000, v215
 v_pk_add_f32 v[104:105], v[104:105], v[30:31] op_sel:[0,0] op_sel_hi:[1,0]
 v_pk_add_f32 v[106:107], v[106:107], v[30:31] op_sel:[0,0] op_sel_hi:[1,0]
 v_pk_add_f32 v[108:109], v[108:109], v[30:31] op_sel:[0,0] op_sel_hi:[1,0]
 v_pk_add_f32 v[110:111], v[110:111], v[30:31] op_sel:[0,0] op_sel_hi:[1,0]
 v_pk_mul_f32 v[104:105], v[104:105], v[20:21]
 v_pk_mul_f32 v[106:107], v[106:107], v[22:23]
 v_pk_mul_f32 v[108:109], v[108:109], v[24:25]
 v_pk_mul_f32 v[110:111], v[110:111], v[26:27]
 v_cvt_pk_bf16_f32 v212, v104, v105
 v_cvt_pk_bf16_f32 v213, v106, v107
 v_cvt_pk_bf16_f32 v214, v108, v109
 v_cvt_pk_bf16_f32 v215, v110, v111
 s_add_u32 s41, s35, 131072
 buffer_store_dwordx4 v[212:215], v19, s[12:15], s41 offen offset:2048 sc1
 s_add_u32 m0, s29, 65536
 s_nop 0
 s_nop 0
 buffer_load_dwordx4 v40, s[4:7], s26 offen offset:0 lds
 v_lshlrev_b32_e64 v8, 16, v216
 v_and_b32 v9, 0xffff0000, v216
 v_lshlrev_b32_e64 v10, 16, v217
 v_and_b32 v11, 0xffff0000, v217
 v_lshlrev_b32_e64 v12, 16, v218
 v_and_b32 v13, 0xffff0000, v218
 v_lshlrev_b32_e64 v14, 16, v219
 v_and_b32 v15, 0xffff0000, v219
 v_pk_add_f32 v[112:113], v[112:113], v[30:31] op_sel:[0,1] op_sel_hi:[1,1]
 v_pk_add_f32 v[114:115], v[114:115], v[30:31] op_sel:[0,1] op_sel_hi:[1,1]
 v_pk_add_f32 v[116:117], v[116:117], v[30:31] op_sel:[0,1] op_sel_hi:[1,1]
 v_pk_add_f32 v[118:119], v[118:119], v[30:31] op_sel:[0,1] op_sel_hi:[1,1]
 v_pk_mul_f32 v[112:113], v[112:113], v[8:9]
 v_pk_mul_f32 v[114:115], v[114:115], v[10:11]
 v_pk_mul_f32 v[116:117], v[116:117], v[12:13]
 v_pk_mul_f32 v[118:119], v[118:119], v[14:15]
 v_cvt_pk_bf16_f32 v216, v112, v113
 v_cvt_pk_bf16_f32 v217, v114, v115
 v_cvt_pk_bf16_f32 v218, v116, v117
 v_cvt_pk_bf16_f32 v219, v118, v119
 s_add_u32 s41, s35, 0
 s_nop 0
 buffer_store_dwordx4 v[216:219], v19, s[12:15], s41 offen offset:3072 sc1
 buffer_load_dwordx4 v40, s[4:7], s26 offen offset:1024 lds
 buffer_load_dwordx4 v40, s[4:7], s26 offen offset:2048 lds
 v_lshlrev_b32_e64 v20, 16, v220
 v_and_b32 v21, 0xffff0000, v220
 v_lshlrev_b32_e64 v22, 16, v221
 v_and_b32 v23, 0xffff0000, v221
 v_lshlrev_b32_e64 v24, 16, v222
 v_and_b32 v25, 0xffff0000, v222
 v_lshlrev_b32_e64 v26, 16, v223
 v_and_b32 v27, 0xffff0000, v223
 v_pk_add_f32 v[120:121], v[120:121], v[30:31] op_sel:[0,1] op_sel_hi:[1,1]
 v_pk_add_f32 v[122:123], v[122:123], v[30:31] op_sel:[0,1] op_sel_hi:[1,1]
 v_pk_add_f32 v[124:125], v[124:125], v[30:31] op_sel:[0,1] op_sel_hi:[1,1]
 v_pk_add_f32 v[126:127], v[126:127], v[30:31] op_sel:[0,1] op_sel_hi:[1,1]
 v_pk_mul_f32 v[120:121], v[120:121], v[20:21]
 v_pk_mul_f32 v[122:123], v[122:123], v[22:23]
 v_pk_mul_f32 v[124:125], v[124:125], v[24:25]
 v_pk_mul_f32 v[126:127], v[126:127], v[26:27]
 v_cvt_pk_bf16_f32 v220, v120, v121
 v_cvt_pk_bf16_f32 v221, v122, v123
 v_cvt_pk_bf16_f32 v222, v124, v125
 v_cvt_pk_bf16_f32 v223, v126, v127
 s_add_u32 s41, s35, 131072
 buffer_store_dwordx4 v[220:223], v19, s[12:15], s41 offen offset:3072 sc1
 buffer_load_dwordx4 v40, s[4:7], s26 offen offset:3072 lds
 s_add_u32 s26, s26, 16384
 v_lshlrev_b32_e64 v8, 16, v224
 v_and_b32 v9, 0xffff0000, v224
 v_lshlrev_b32_e64 v10, 16, v225
 v_and_b32 v11, 0xffff0000, v225
 v_lshlrev_b32_e64 v12, 16, v226
 v_and_b32 v13, 0xffff0000, v226
 v_lshlrev_b32_e64 v14, 16, v227
 v_and_b32 v15, 0xffff0000, v227
 v_pk_add_f32 v[128:129], v[128:129], v[32:33] op_sel:[0,0] op_sel_hi:[1,0]
 v_pk_add_f32 v[130:131], v[130:131], v[32:33] op_sel:[0,0] op_sel_hi:[1,0]
 v_pk_add_f32 v[132:133], v[132:133], v[32:33] op_sel:[0,0] op_sel_hi:[1,0]
 v_pk_add_f32 v[134:135], v[134:135], v[32:33] op_sel:[0,0] op_sel_hi:[1,0]
 v_pk_mul_f32 v[128:129], v[128:129], v[8:9]
 v_pk_mul_f32 v[130:131], v[130:131], v[10:11]
 v_pk_mul_f32 v[132:133], v[132:133], v[12:13]
 v_pk_mul_f32 v[134:135], v[134:135], v[14:15]
 v_cvt_pk_bf16_f32 v224, v128, v129
 v_cvt_pk_bf16_f32 v225, v130, v131
 v_cvt_pk_bf16_f32 v226, v132, v133
 v_cvt_pk_bf16_f32 v227, v134, v135
 s_add_u32 s41, s35, 4096
 buffer_store_dwordx4 v[224:227], v19, s[12:15], s41 offen offset:0 sc1
 s_add_u32 m0, s29, 81920
 s_nop 0
 s_nop 0
 buffer_load_dwordx4 v40, s[8:11], s27 offen offset:0 lds
 v_lshlrev_b32_e64 v20, 16, v228
 v_and_b32 v21, 0xffff0000, v228
 v_lshlrev_b32_e64 v22, 16, v229
 v_and_b32 v23, 0xffff0000, v229
 v_lshlrev_b32_e64 v24, 16, v230
 v_and_b32 v25, 0xffff0000, v230
 v_lshlrev_b32_e64 v26, 16, v231
 v_and_b32 v27, 0xffff0000, v231
 v_pk_add_f32 v[136:137], v[136:137], v[32:33] op_sel:[0,0] op_sel_hi:[1,0]
 v_pk_add_f32 v[138:139], v[138:139], v[32:33] op_sel:[0,0] op_sel_hi:[1,0]
 v_pk_add_f32 v[140:141], v[140:141], v[32:33] op_sel:[0,0] op_sel_hi:[1,0]
 v_pk_add_f32 v[142:143], v[142:143], v[32:33] op_sel:[0,0] op_sel_hi:[1,0]
 v_pk_mul_f32 v[136:137], v[136:137], v[20:21]
 v_pk_mul_f32 v[138:139], v[138:139], v[22:23]
 v_pk_mul_f32 v[140:141], v[140:141], v[24:25]
 v_pk_mul_f32 v[142:143], v[142:143], v[26:27]
 v_cvt_pk_bf16_f32 v228, v136, v137
 v_cvt_pk_bf16_f32 v229, v138, v139
 v_cvt_pk_bf16_f32 v230, v140, v141
 v_cvt_pk_bf16_f32 v231, v142, v143
 s_add_u32 s41, s35, 135168
 buffer_store_dwordx4 v[228:231], v19, s[12:15], s41 offen offset:0 sc1
 buffer_load_dwordx4 v40, s[8:11], s27 offen offset:1024 lds
 buffer_load_dwordx4 v40, s[8:11], s27 offen offset:2048 lds
 v_lshlrev_b32_e64 v8, 16, v232
 v_and_b32 v9, 0xffff0000, v232
 v_lshlrev_b32_e64 v10, 16, v233
 v_and_b32 v11, 0xffff0000, v233
 v_lshlrev_b32_e64 v12, 16, v234
 v_and_b32 v13, 0xffff0000, v234
 v_lshlrev_b32_e64 v14, 16, v235
 v_and_b32 v15, 0xffff0000, v235
 v_pk_add_f32 v[144:145], v[144:145], v[32:33] op_sel:[0,1] op_sel_hi:[1,1]
 v_pk_add_f32 v[146:147], v[146:147], v[32:33] op_sel:[0,1] op_sel_hi:[1,1]
 v_pk_add_f32 v[148:149], v[148:149], v[32:33] op_sel:[0,1] op_sel_hi:[1,1]
 v_pk_add_f32 v[150:151], v[150:151], v[32:33] op_sel:[0,1] op_sel_hi:[1,1]
 v_pk_mul_f32 v[144:145], v[144:145], v[8:9]
 v_pk_mul_f32 v[146:147], v[146:147], v[10:11]
 v_pk_mul_f32 v[148:149], v[148:149], v[12:13]
 v_pk_mul_f32 v[150:151], v[150:151], v[14:15]
 v_cvt_pk_bf16_f32 v232, v144, v145
 v_cvt_pk_bf16_f32 v233, v146, v147
 v_cvt_pk_bf16_f32 v234, v148, v149
 v_cvt_pk_bf16_f32 v235, v150, v151
 s_add_u32 s41, s35, 4096
 buffer_store_dwordx4 v[232:235], v19, s[12:15], s41 offen offset:1024 sc1
 buffer_load_dwordx4 v40, s[8:11], s27 offen offset:3072 lds
 s_add_u32 s27, s27, 3670016
 v_lshlrev_b32_e64 v20, 16, v236
 v_and_b32 v21, 0xffff0000, v236
 v_lshlrev_b32_e64 v22, 16, v237
 v_and_b32 v23, 0xffff0000, v237
 v_lshlrev_b32_e64 v24, 16, v238
 v_and_b32 v25, 0xffff0000, v238
 v_lshlrev_b32_e64 v26, 16, v239
 v_and_b32 v27, 0xffff0000, v239
 v_pk_add_f32 v[152:153], v[152:153], v[32:33] op_sel:[0,1] op_sel_hi:[1,1]
 v_pk_add_f32 v[154:155], v[154:155], v[32:33] op_sel:[0,1] op_sel_hi:[1,1]
 v_pk_add_f32 v[156:157], v[156:157], v[32:33] op_sel:[0,1] op_sel_hi:[1,1]
 v_pk_add_f32 v[158:159], v[158:159], v[32:33] op_sel:[0,1] op_sel_hi:[1,1]
 v_pk_mul_f32 v[152:153], v[152:153], v[20:21]
 v_pk_mul_f32 v[154:155], v[154:155], v[22:23]
 v_pk_mul_f32 v[156:157], v[156:157], v[24:25]
 v_pk_mul_f32 v[158:159], v[158:159], v[26:27]
 v_cvt_pk_bf16_f32 v236, v152, v153
 v_cvt_pk_bf16_f32 v237, v154, v155
 v_cvt_pk_bf16_f32 v238, v156, v157
 v_cvt_pk_bf16_f32 v239, v158, v159
 s_add_u32 s41, s35, 135168
 buffer_store_dwordx4 v[236:239], v19, s[12:15], s41 offen offset:1024 sc1
 v_lshlrev_b32_e64 v8, 16, v240
 v_and_b32 v9, 0xffff0000, v240
 v_lshlrev_b32_e64 v10, 16, v241
 v_and_b32 v11, 0xffff0000, v241
 v_lshlrev_b32_e64 v12, 16, v242
 v_and_b32 v13, 0xffff0000, v242
 v_lshlrev_b32_e64 v14, 16, v243
 v_and_b32 v15, 0xffff0000, v243
 v_pk_add_f32 v[160:161], v[160:161], v[34:35] op_sel:[0,0] op_sel_hi:[1,0]
 v_pk_add_f32 v[162:163], v[162:163], v[34:35] op_sel:[0,0] op_sel_hi:[1,0]
 v_pk_add_f32 v[164:165], v[164:165], v[34:35] op_sel:[0,0] op_sel_hi:[1,0]
 v_pk_add_f32 v[166:167], v[166:167], v[34:35] op_sel:[0,0] op_sel_hi:[1,0]
 v_pk_mul_f32 v[160:161], v[160:161], v[8:9]
 v_pk_mul_f32 v[162:163], v[162:163], v[10:11]
 v_pk_mul_f32 v[164:165], v[164:165], v[12:13]
 v_pk_mul_f32 v[166:167], v[166:167], v[14:15]
 v_cvt_pk_bf16_f32 v240, v160, v161
 v_cvt_pk_bf16_f32 v241, v162, v163
 v_cvt_pk_bf16_f32 v242, v164, v165
 v_cvt_pk_bf16_f32 v243, v166, v167
 s_add_u32 s41, s35, 4096
 buffer_store_dwordx4 v[240:243], v19, s[12:15], s41 offen offset:2048 sc1
 v_lshlrev_b32_e64 v20, 16, v244
 v_and_b32 v21, 0xffff0000, v244
 v_lshlrev_b32_e64 v22, 16, v245
 v_and_b32 v23, 0xffff0000, v245
 v_lshlrev_b32_e64 v24, 16, v246
 v_and_b32 v25, 0xffff0000, v246
 v_lshlrev_b32_e64 v26, 16, v247
 v_and_b32 v27, 0xffff0000, v247
 v_pk_add_f32 v[168:169], v[168:169], v[34:35] op_sel:[0,0] op_sel_hi:[1,0]
 v_pk_add_f32 v[170:171], v[170:171], v[34:35] op_sel:[0,0] op_sel_hi:[1,0]
 v_pk_add_f32 v[172:173], v[172:173], v[34:35] op_sel:[0,0] op_sel_hi:[1,0]
 v_pk_add_f32 v[174:175], v[174:175], v[34:35] op_sel:[0,0] op_sel_hi:[1,0]
 v_pk_mul_f32 v[168:169], v[168:169], v[20:21]
 v_pk_mul_f32 v[170:171], v[170:171], v[22:23]
 v_pk_mul_f32 v[172:173], v[172:173], v[24:25]
 v_pk_mul_f32 v[174:175], v[174:175], v[26:27]
 v_cvt_pk_bf16_f32 v244, v168, v169
 v_cvt_pk_bf16_f32 v245, v170, v171
 v_cvt_pk_bf16_f32 v246, v172, v173
 v_cvt_pk_bf16_f32 v247, v174, v175
 s_add_u32 s41, s35, 135168
 buffer_store_dwordx4 v[244:247], v19, s[12:15], s41 offen offset:2048 sc1
 v_lshlrev_b32_e64 v8, 16, v248
 v_and_b32 v9, 0xffff0000, v248
 v_lshlrev_b32_e64 v10, 16, v249
 v_and_b32 v11, 0xffff0000, v249
 v_lshlrev_b32_e64 v12, 16, v250
 v_and_b32 v13, 0xffff0000, v250
 v_lshlrev_b32_e64 v14, 16, v251
 v_and_b32 v15, 0xffff0000, v251
 v_pk_add_f32 v[176:177], v[176:177], v[34:35] op_sel:[0,1] op_sel_hi:[1,1]
 v_pk_add_f32 v[178:179], v[178:179], v[34:35] op_sel:[0,1] op_sel_hi:[1,1]
 v_pk_add_f32 v[180:181], v[180:181], v[34:35] op_sel:[0,1] op_sel_hi:[1,1]
 v_pk_add_f32 v[182:183], v[182:183], v[34:35] op_sel:[0,1] op_sel_hi:[1,1]
 v_pk_mul_f32 v[176:177], v[176:177], v[8:9]
 v_pk_mul_f32 v[178:179], v[178:179], v[10:11]
 v_pk_mul_f32 v[180:181], v[180:181], v[12:13]
 v_pk_mul_f32 v[182:183], v[182:183], v[14:15]
 v_cvt_pk_bf16_f32 v248, v176, v177
 v_cvt_pk_bf16_f32 v249, v178, v179
 v_cvt_pk_bf16_f32 v250, v180, v181
 v_cvt_pk_bf16_f32 v251, v182, v183
 s_add_u32 s41, s35, 4096
 buffer_store_dwordx4 v[248:251], v19, s[12:15], s41 offen offset:3072 sc1
 v_lshlrev_b32_e64 v20, 16, v252
 v_and_b32 v21, 0xffff0000, v252
 v_lshlrev_b32_e64 v22, 16, v253
 v_and_b32 v23, 0xffff0000, v253
 v_lshlrev_b32_e64 v24, 16, v254
 v_and_b32 v25, 0xffff0000, v254
 v_lshlrev_b32_e64 v26, 16, v255
 v_and_b32 v27, 0xffff0000, v255
 v_pk_add_f32 v[184:185], v[184:185], v[34:35] op_sel:[0,1] op_sel_hi:[1,1]
 v_pk_add_f32 v[186:187], v[186:187], v[34:35] op_sel:[0,1] op_sel_hi:[1,1]
 v_pk_add_f32 v[188:189], v[188:189], v[34:35] op_sel:[0,1] op_sel_hi:[1,1]
 v_pk_add_f32 v[190:191], v[190:191], v[34:35] op_sel:[0,1] op_sel_hi:[1,1]
 v_pk_mul_f32 v[184:185], v[184:185], v[20:21]
 v_pk_mul_f32 v[186:187], v[186:187], v[22:23]
 v_pk_mul_f32 v[188:189], v[188:189], v[24:25]
 v_pk_mul_f32 v[190:191], v[190:191], v[26:27]
 v_cvt_pk_bf16_f32 v252, v184, v185
 v_cvt_pk_bf16_f32 v253, v186, v187
 v_cvt_pk_bf16_f32 v254, v188, v189
 v_cvt_pk_bf16_f32 v255, v190, v191
 s_add_u32 s41, s35, 135168
 buffer_store_dwordx4 v[252:255], v19, s[12:15], s41 offen offset:3072 sc1
L_z_go:
 s_waitcnt vmcnt(32)
 s_barrier
 rd a[16:19],v56,0
 tr a[0:1],v44,0
 tr a[2:3],v44,4096
 rd a[20:23],v56,1024
 tr a[4:5],v45,0
 tr a[6:7],v45,4096
 rd a[24:27],v56,2048
 tr a[8:9],v46,0
 tr a[10:11],v46,4096
 rd a[28:31],v56,3072
 tr a[12:13],v47,0
 tr a[14:15],v47,4096
 v_min_u32 v60, 1, v1
 v_lshlrev_b32 v60, 3, v60
 s_waitcnt lgkmcnt(0)
 s_nop 0
 mf v[64:67],a[0:3],a[16:19],0
 rd a[48:51],v56,8192
 tr a[32:33],v44,8192
 s_add_u32 m0, s29, 98304
 mf v[80:83],a[4:7],a[16:19],0
 buffer_load_dwordx4 v40, s[4:7], s26 offen offset:0 lds
 mf v[84:87],a[4:7],a[20:23],0
 buffer_load_dwordx4 v40, s[4:7], s26 offen offset:1024 lds
 mf v[68:71],a[0:3],a[20:23],0
 tr a[34:35],v44,12288
 rd a[52:55],v56,9216
 tr a[36:37],v45,8192
 mf v[72:75],a[0:3],a[24:27],0
 buffer_load_dwordx4 v40, s[4:7], s26 offen offset:2048 lds
 mf v[88:91],a[4:7],a[24:27],0
 buffer_load_dwordx4 v40, s[4:7], s26 offen offset:3072 lds
 mf v[92:95],a[4:7],a[28:31],0
 tr a[38:39],v45,12288
 s_add_u32 s26, s26, 16384
 mf v[76:79],a[0:3],a[28:31],0
 rd a[56:59],v56,10240
 tr a[40:41],v46,8192
 s_add_u32 m0, s29, 114688
 mf v[108:111],a[8:11],a[28:31],0
 buffer_load_dwordx4 v40, s[8:11], s27 offen offset:0 lds
 mf v[124:127],a[12:15],a[28:31],0
 buffer_load_dwordx4 v40, s[8:11], s27 offen offset:1024 lds
 mf v[120:123],a[12:15],a[24:27],0
 buffer_load_dwordx4 v40, s[8:11], s27 offen offset:2048 lds
 mf v[104:107],a[8:11],a[24:27],0
 tr a[42:43],v46,12288
 rd a[60:63],v56,11264
 tr a[44:45],v47,8192
 mf v[100:103],a[8:11],a[20:23],0
 buffer_load_dwordx4 v40, s[8:11], s27 offen offset:3072 lds
 mf v[116:119],a[12:15],a[20:23],0
 tr a[46:47],v47,12288
 s_add_u32 s27, s27, 262144
 mf v[112:115],a[12:15],a[16:19],0
 s_waitcnt vmcnt(27) lgkmcnt(0)
 s_nop 0
 mf v[96:99],a[8:11],a[16:19],0
 s_barrier
 s_nop 0
 mf v[64:67],a[32:35],a[48:51],v[64:67]
 rd a[16:19],v56,32768
 tr a[0:1],v44,32768
 mf v[80:83],a[36:39],a[48:51],v[80:83]
 tr a[2:3],v44,36864
 s_add_u32 m0, s29, 0
 s_nop 0
 mf v[84:87],a[36:39],a[52:55],v[84:87]
 buffer_load_dwordx4 v40, s[4:7], s26 offen offset:0 lds
 mf v[68:71],a[32:35],a[52:55],v[68:71]
 rd a[20:23],v56,33792
 tr a[4:5],v45,32768
 mf v[72:75],a[32:35],a[56:59],v[72:75]
 tr a[6:7],v45,36864
 rd a[24:27],v56,34816
 mf v[88:91],a[36:39],a[56:59],v[88:91]
 buffer_load_dwordx4 v40, s[4:7], s26 offen offset:1024 lds
 mf v[92:95],a[36:39],a[60:63],v[92:95]
 tr a[8:9],v46,32768
 tr a[10:11],v46,36864
 mf v[76:79],a[32:35],a[60:63],v[76:79]
 rd a[28:31],v56,35840
 tr a[12:13],v47,32768
 mf v[108:111],a[40:43],a[60:63],v[108:111]
 buffer_load_dwordx4 v40, s[4:7], s26 offen offset:2048 lds
 mf v[124:127],a[44:47],a[60:63],v[124:127]
 tr a[14:15],v47,36864
 mf v[120:123],a[44:47],a[56:59],v[120:123]
 mf v[104:107],a[40:43],a[56:59],v[104:107]
 buffer_load_dwordx4 v40, s[4:7], s26 offen offset:3072 lds
 mf v[100:103],a[40:43],a[52:55],v[100:103]
 mf v[116:119],a[44:47],a[52:55],v[116:119]
 mf v[112:115],a[44:47],a[48:51],v[112:115]
 s_waitcnt lgkmcnt(0)
 s_nop 0
 mf v[96:99],a[40:43],a[48:51],v[96:99]
 mf v[64:67],a[0:3],a[16:19],v[64:67]
 rd a[48:51],v56,40960
 s_add_u32 s26, s26, 16384
 mf v[80:83],a[4:7],a[16:19],v[80:83]
 tr a[32:33],v44,40960
 s_add_u32 m0, s29, 16384
 mf v[84:87],a[4:7],a[20:23],v[84:87]
 buffer_load_dwordx4 v40, s[8:11], s27 offen offset:0 lds
 mf v[68:71],a[0:3],a[20:23],v[68:71]
 tr a[34:35],v44,45056
 rd a[52:55],v56,41984
 mf v[72:75],a[0:3],a[24:27],v[72:75]
 tr a[36:37],v45,40960
 tr a[38:39],v45,45056
 mf v[88:91],a[4:7],a[24:27],v[88:91]
 buffer_load_dwordx4 v40, s[8:11], s27 offen offset:1024 lds
 mf v[92:95],a[4:7],a[28:31],v[92:95]
 rd a[56:59],v56,43008
 tr a[40:41],v46,40960
 mf v[76:79],a[0:3],a[28:31],v[76:79]
 tr a[42:43],v46,45056
 rd a[60:63],v56,44032
 mf v[108:111],a[8:11],a[28:31],v[108:111]
 buffer_load_dwordx4 v40, s[8:11], s27 offen offset:2048 lds
 mf v[124:127],a[12:15],a[28:31],v[124:127]
 tr a[44:45],v47,40960
 tr a[46:47],v47,45056
 mf v[120:123],a[12:15],a[24:27],v[120:123]
 mf v[104:107],a[8:11],a[24:27],v[104:107]
 buffer_load_dwordx4 v40, s[8:11], s27 offen offset:3072 lds
 mf v[100:103],a[8:11],a[20:23],v[100:103]
 s_add_u32 s27, s27, 262144
 mf v[116:119],a[12:15],a[20:23],v[116:119]
 mf v[112:115],a[12:15],a[16:19],v[112:115]
 s_waitcnt vmcnt(21) lgkmcnt(0)
 s_nop 0
 mf v[96:99],a[8:11],a[16:19],v[96:99]
 s_barrier
 s_nop 0
 mf v[64:67],a[32:35],a[48:51],v[64:67]
 rd a[16:19],v57,0
 tr a[0:1],v48,0
 mf v[80:83],a[36:39],a[48:51],v[80:83]
 tr a[2:3],v48,4096
 s_add_u32 m0, s29, 32768
 mf v[84:87],a[36:39],a[52:55],v[84:87]
 buffer_load_dwordx4 v40, s[4:7], s26 offen offset:0 lds
 mf v[68:71],a[32:35],a[52:55],v[68:71]
 rd a[20:23],v57,1024
 tr a[4:5],v49,0
 mf v[72:75],a[32:35],a[56:59],v[72:75]
 tr a[6:7],v49,4096
 rd a[24:27],v57,2048
 mf v[88:91],a[36:39],a[56:59],v[88:91]
 buffer_load_dwordx4 v40, s[4:7], s26 offen offset:1024 lds
 mf v[92:95],a[36:39],a[60:63],v[92:95]
 tr a[8:9],v50,0
 tr a[10:11],v50,4096
 mf v[76:79],a[32:35],a[60:63],v[76:79]
 rd a[28:31],v57,3072
 tr a[12:13],v51,0
 mf v[108:111],a[40:43],a[60:63],v[108:111]
 buffer_load_dwordx4 v40, s[4:7], s26 offen offset:2048 lds
 mf v[124:127],a[44:47],a[60:63],v[124:127]
 tr a[14:15],v51,4096
 mf v[120:123],a[44:47],a[56:59],v[120:123]
 mf v[104:107],a[40:43],a[56:59],v[104:107]
 buffer_load_dwordx4 v40, s[4:7], s26 offen offset:3072 lds
 mf v[100:103],a[40:43],a[52:55],v[100:103]
 mf v[116:119],a[44:47],a[52:55],v[116:119]
 mf v[112:115],a[44:47],a[48:51],v[112:115]
 s_waitcnt lgkmcnt(0)
 s_nop 0
 mf v[96:99],a[40:43],a[48:51],v[96:99]
 mf v[64:67],a[0:3],a[16:19],v[64:67]
 rd a[48:51],v57,8192
 s_add_u32 s26, s26, 16384
 mf v[80:83],a[4:7],a[16:19],v[80:83]
 tr a[32:33],v48,8192
 s_add_u32 m0, s29, 49152
 mf v[84:87],a[4:7],a[20:23],v[84:87]
 buffer_load_dwordx4 v40, s[8:11], s27 offen offset:0 lds
 mf v[68:71],a[0:3],a[20:23],v[68:71]
 tr a[34:35],v48,12288
 rd a[52:55],v57,9216
 mf v[72:75],a[0:3],a[24:27],v[72:75]
 tr a[36:37],v49,8192
 tr a[38:39],v49,12288
 mf v[88:91],a[4:7],a[24:27],v[88:91]
 buffer_load_dwordx4 v40, s[8:11], s27 offen offset:1024 lds
 mf v[92:95],a[4:7],a[28:31],v[92:95]
 rd a[56:59],v57,10240
 tr a[40:41],v50,8192
 mf v[76:79],a[0:3],a[28:31],v[76:79]
 tr a[42:43],v50,12288
 rd a[60:63],v57,11264
 mf v[108:111],a[8:11],a[28:31],v[108:111]
 buffer_load_dwordx4 v40, s[8:11], s27 offen offset:2048 lds
 mf v[124:127],a[12:15],a[28:31],v[124:127]
 tr a[44:45],v51,8192
 tr a[46:47],v51,12288
 mf v[120:123],a[12:15],a[24:27],v[120:123]
 mf v[104:107],a[8:11],a[24:27],v[104:107]
 buffer_load_dwordx4 v40, s[8:11], s27 offen offset:3072 lds
 mf v[100:103],a[8:11],a[20:23],v[100:103]
 s_add_u32 s27, s27, 3670016
 mf v[116:119],a[12:15],a[20:23],v[116:119]
 mf v[112:115],a[12:15],a[16:19],v[112:115]
 s_waitcnt vmcnt(16) lgkmcnt(0)
 s_nop 0
 mf v[96:99],a[8:11],a[16:19],v[96:99]
 s_barrier
 s_cmp_lg_u32 s90, 0
 s_cbranch_scc1 L_u_sig
L_u_sig_ok:
 s_nop 0
 mf v[64:67],a[32:35],a[48:51],v[64:67]
 rd a[16:19],v57,32768
 tr a[0:1],v48,32768
 mf v[80:83],a[36:39],a[48:51],v[80:83]
 tr a[2:3],v48,36864
 s_add_u32 m0, s29, 65536
 mf v[84:87],a[36:39],a[52:55],v[84:87]
 buffer_load_dwordx4 v40, s[4:7], s26 offen offset:0 lds
 mf v[68:71],a[32:35],a[52:55],v[68:71]
 rd a[20:23],v57,33792
 tr a[4:5],v49,32768
 mf v[72:75],a[32:35],a[56:59],v[72:75]
 tr a[6:7],v49,36864
 rd a[24:27],v57,34816
 mf v[88:91],a[36:39],a[56:59],v[88:91]
 buffer_load_dwordx4 v40, s[4:7], s26 offen offset:1024 lds
 mf v[92:95],a[36:39],a[60:63],v[92:95]
 tr a[8:9],v50,32768
 tr a[10:11],v50,36864
 mf v[76:79],a[32:35],a[60:63],v[76:79]
 rd a[28:31],v57,35840
 tr a[12:13],v51,32768
 mf v[108:111],a[40:43],a[60:63],v[108:111]
 buffer_load_dwordx4 v40, s[4:7], s26 offen offset:2048 lds
 mf v[124:127],a[44:47],a[60:63],v[124:127]
 tr a[14:15],v51,36864
 mf v[120:123],a[44:47],a[56:59],v[120:123]
 mf v[104:107],a[40:43],a[56:59],v[104:107]
 buffer_load_dwordx4 v40, s[4:7], s26 offen offset:3072 lds
 mf v[100:103],a[40:43],a[52:55],v[100:103]
 mf v[116:119],a[44:47],a[52:55],v[116:119]
 mf v[112:115],a[44:47],a[48:51],v[112:115]
 s_waitcnt lgkmcnt(0)
 s_nop 0
 mf v[96:99],a[40:43],a[48:51],v[96:99]
 mf v[64:67],a[0:3],a[16:19],v[64:67]
 rd a[48:51],v57,40960
 s_add_u32 s26, s26, 16384
 mf v[80:83],a[4:7],a[16:19],v[80:83]
 tr a[32:33],v48,40960
 s_add_u32 m0, s29, 81920
 mf v[84:87],a[4:7],a[20:23],v[84:87]
 buffer_load_dwordx4 v40, s[8:11], s27 offen offset:0 lds
 mf v[68:71],a[0:3],a[20:23],v[68:71]
 tr a[34:35],v48,45056
 rd a[52:55],v57,41984
 mf v[72:75],a[0:3],a[24:27],v[72:75]
 tr a[36:37],v49,40960
 tr a[38:39],v49,45056
 mf v[88:91],a[4:7],a[24:27],v[88:91]
 buffer_load_dwordx4 v40, s[8:11], s27 offen offset:1024 lds
 mf v[92:95],a[4:7],a[28:31],v[92:95]
 rd a[56:59],v57,43008
 tr a[40:41],v50,40960
 mf v[76:79],a[0:3],a[28:31],v[76:79]
 s_branch L_skip_16317
.p2align 12
L_stub_w1_16317:
 s_branch L_stub_w1_18565
 s_nop 0
 s_nop 0
 s_nop 0
L_skip_16317:
 tr a[42:43],v50,45056
 rd a[60:63],v57,44032
 mf v[108:111],a[8:11],a[28:31],v[108:111]
 buffer_load_dwordx4 v40, s[8:11], s27 offen offset:2048 lds
 mf v[124:127],a[12:15],a[28:31],v[124:127]
 tr a[44:45],v51,40960
 tr a[46:47],v51,45056
 mf v[120:123],a[12:15],a[24:27],v[120:123]
 mf v[104:107],a[8:11],a[24:27],v[104:107]
 buffer_load_dwordx4 v40, s[8:11], s27 offen offset:3072 lds
 mf v[100:103],a[8:11],a[20:23],v[100:103]
 s_add_u32 s27, s27, 262144
 mf v[116:119],a[12:15],a[20:23],v[116:119]
 mf v[112:115],a[12:15],a[16:19],v[112:115]
 s_waitcnt vmcnt(16) lgkmcnt(0)
 s_nop 0
 mf v[96:99],a[8:11],a[16:19],v[96:99]
 s_barrier
 s_nop 0
 mf v[64:67],a[32:35],a[48:51],v[64:67]
 rd a[16:19],v56,0
 tr a[0:1],v44,0
 mf v[80:83],a[36:39],a[48:51],v[80:83]
 tr a[2:3],v44,4096
 s_add_u32 m0, s29, 98304
 mf v[84:87],a[36:39],a[52:55],v[84:87]
 buffer_load_dwordx4 v40, s[4:7], s26 offen offset:0 lds
 mf v[68:71],a[32:35],a[52:55],v[68:71]
 rd a[20:23],v56,1024
 tr a[4:5],v45,0
 mf v[72:75],a[32:35],a[56:59],v[72:75]
 tr a[6:7],v45,4096
 rd a[24:27],v56,2048
 mf v[88:91],a[36:39],a[56:59],v[88:91]
 buffer_load_dwordx4 v40, s[4:7], s26 offen offset:1024 lds
 mf v[92:95],a[36:39],a[60:63],v[92:95]
 tr a[8:9],v46,0
 tr a[10:11],v46,4096
 mf v[76:79],a[32:35],a[60:63],v[76:79]
 rd a[28:31],v56,3072
 tr a[12:13],v47,0
 mf v[108:111],a[40:43],a[60:63],v[108:111]
 buffer_load_dwordx4 v40, s[4:7], s26 offen offset:2048 lds
 mf v[124:127],a[44:47],a[60:63],v[124:127]
 tr a[14:15],v47,4096
 mf v[120:123],a[44:47],a[56:59],v[120:123]
 mf v[104:107],a[40:43],a[56:59],v[104:107]
 buffer_load_dwordx4 v40, s[4:7], s26 offen offset:3072 lds
 mf v[100:103],a[40:43],a[52:55],v[100:103]
 mf v[116:119],a[44:47],a[52:55],v[116:119]
 mf v[112:115],a[44:47],a[48:51],v[112:115]
 s_waitcnt lgkmcnt(0)
 s_nop 0
 mf v[96:99],a[40:43],a[48:51],v[96:99]
 mf v[64:67],a[0:3],a[16:19],v[64:67]
 rd a[48:51],v56,8192
 s_add_u32 s26, s26, 16384
 mf v[80:83],a[4:7],a[16:19],v[80:83]
 tr a[32:33],v44,8192
 s_add_u32 m0, s29, 114688
 mf v[84:87],a[4:7],a[20:23],v[84:87]
 buffer_load_dwordx4 v40, s[8:11], s27 offen offset:0 lds
 mf v[68:71],a[0:3],a[20:23],v[68:71]
 tr a[34:35],v44,12288
 rd a[52:55],v56,9216
 mf v[72:75],a[0:3],a[24:27],v[72:75]
 tr a[36:37],v45,8192
 tr a[38:39],v45,12288
 mf v[88:91],a[4:7],a[24:27],v[88:91]
 buffer_load_dwordx4 v40, s[8:11], s27 offen offset:1024 lds
 mf v[92:95],a[4:7],a[28:31],v[92:95]
 rd a[56:59],v56,10240
 tr a[40:41],v46,8192
 mf v[76:79],a[0:3],a[28:31],v[76:79]
 tr a[42:43],v46,12288
 rd a[60:63],v56,11264
 mf v[108:111],a[8:11],a[28:31],v[108:111]
 buffer_load_dwordx4 v40, s[8:11], s27 offen offset:2048 lds
 mf v[124:127],a[12:15],a[28:31],v[124:127]
 tr a[44:45],v47,8192
 tr a[46:47],v47,12288
 mf v[120:123],a[12:15],a[24:27],v[120:123]
 mf v[104:107],a[8:11],a[24:27],v[104:107]
 buffer_load_dwordx4 v40, s[8:11], s27 offen offset:3072 lds
 mf v[100:103],a[8:11],a[20:23],v[100:103]
 s_add_u32 s27, s27, 262144
 mf v[116:119],a[12:15],a[20:23],v[116:119]
 mf v[112:115],a[12:15],a[16:19],v[112:115]
 s_waitcnt vmcnt(16) lgkmcnt(0)
 s_nop 0
 mf v[96:99],a[8:11],a[16:19],v[96:99]
 s_barrier
 s_nop 0
 mf v[64:67],a[32:35],a[48:51],v[64:67]
 rd a[16:19],v56,32768
 tr a[0:1],v44,32768
 mf v[80:83],a[36:39],a[48:51],v[80:83]
 tr a[2:3],v44,36864
 s_add_u32 m0, s29, 0
 s_nop 0
 mf v[84:87],a[36:39],a[52:55],v[84:87]
 buffer_load_dwordx4 v40, s[4:7], s26 offen offset:0 lds
 mf v[68:71],a[32:35],a[52:55],v[68:71]
 rd a[20:23],v56,33792
 tr a[4:5],v45,32768
 mf v[72:75],a[32:35],a[56:59],v[72:75]
 tr a[6:7],v45,36864
 rd a[24:27],v56,34816
 mf v[88:91],a[36:39],a[56:59],v[88:91]
 buffer_load_dwordx4 v40, s[4:7], s26 offen offset:1024 lds
 mf v[92:95],a[36:39],a[60:63],v[92:95]
 tr a[8:9],v46,32768
 tr a[10:11],v46,36864
 mf v[76:79],a[32:35],a[60:63],v[76:79]
 rd a[28:31],v56,35840
 tr a[12:13],v47,32768
 mf v[108:111],a[40:43],a[60:63],v[108:111]
 buffer_load_dwordx4 v40, s[4:7], s26 offen offset:2048 lds
 mf v[124:127],a[44:47],a[60:63],v[124:127]
 tr a[14:15],v47,36864
 mf v[120:123],a[44:47],a[56:59],v[120:123]
 mf v[104:107],a[40:43],a[56:59],v[104:107]
 buffer_load_dwordx4 v40, s[4:7], s26 offen offset:3072 lds
 mf v[100:103],a[40:43],a[52:55],v[100:103]
 mf v[116:119],a[44:47],a[52:55],v[116:119]
 mf v[112:115],a[44:47],a[48:51],v[112:115]
 s_waitcnt lgkmcnt(0)
 s_nop 0
 mf v[96:99],a[40:43],a[48:51],v[96:99]
 mf v[64:67],a[0:3],a[16:19],v[64:67]
 rd a[48:51],v56,40960
 s_add_u32 s26, s26, 16384
 mf v[80:83],a[4:7],a[16:19],v[80:83]
 tr a[32:33],v44,40960
 s_add_u32 m0, s29, 16384
 mf v[84:87],a[4:7],a[20:23],v[84:87]
 buffer_load_dwordx4 v40, s[8:11], s27 offen offset:0 lds
 mf v[68:71],a[0:3],a[20:23],v[68:71]
 tr a[34:35],v44,45056
 rd a[52:55],v56,41984
 mf v[72:75],a[0:3],a[24:27],v[72:75]
 tr a[36:37],v45,40960
 tr a[38:39],v45,45056
 mf v[88:91],a[4:7],a[24:27],v[88:91]
 buffer_load_dwordx4 v40, s[8:11], s27 offen offset:1024 lds
 mf v[92:95],a[4:7],a[28:31],v[92:95]
 rd a[56:59],v56,43008
 tr a[40:41],v46,40960
 mf v[76:79],a[0:3],a[28:31],v[76:79]
 tr a[42:43],v46,45056
 rd a[60:63],v56,44032
 mf v[108:111],a[8:11],a[28:31],v[108:111]
 buffer_load_dwordx4 v40, s[8:11], s27 offen offset:2048 lds
 mf v[124:127],a[12:15],a[28:31],v[124:127]
 tr a[44:45],v47,40960
 tr a[46:47],v47,45056
 mf v[120:123],a[12:15],a[24:27],v[120:123]
 mf v[104:107],a[8:11],a[24:27],v[104:107]
 buffer_load_dwordx4 v40, s[8:11], s27 offen offset:3072 lds
 mf v[100:103],a[8:11],a[20:23],v[100:103]
 s_add_u32 s27, s27, 3670016
 mf v[116:119],a[12:15],a[20:23],v[116:119]
 mf v[112:115],a[12:15],a[16:19],v[112:115]
 s_waitcnt vmcnt(16) lgkmcnt(0)
 s_nop 0
 mf v[96:99],a[8:11],a[16:19],v[96:99]
 s_barrier
 s_nop 0
 mf v[64:67],a[32:35],a[48:51],v[64:67]
 rd a[16:19],v57,0
 tr a[0:1],v48,0
 mf v[80:83],a[36:39],a[48:51],v[80:83]
 tr a[2:3],v48,4096
 s_add_u32 m0, s29, 32768
 mf v[84:87],a[36:39],a[52:55],v[84:87]
 buffer_load_dwordx4 v40, s[4:7], s26 offen offset:0 lds
 mf v[68:71],a[32:35],a[52:55],v[68:71]
 rd a[20:23],v57,1024
 tr a[4:5],v49,0
 mf v[72:75],a[32:35],a[56:59],v[72:75]
 tr a[6:7],v49,4096
 rd a[24:27],v57,2048
 mf v[88:91],a[36:39],a[56:59],v[88:91]
 buffer_load_dwordx4 v40, s[4:7], s26 offen offset:1024 lds
 mf v[92:95],a[36:39],a[60:63],v[92:95]
 tr a[8:9],v50,0
 tr a[10:11],v50,4096
 mf v[76:79],a[32:35],a[60:63],v[76:79]
 rd a[28:31],v57,3072
 tr a[12:13],v51,0
 mf v[108:111],a[40:43],a[60:63],v[108:111]
 buffer_load_dwordx4 v40, s[4:7], s26 offen offset:2048 lds
 mf v[124:127],a[44:47],a[60:63],v[124:127]
 tr a[14:15],v51,4096
 mf v[120:123],a[44:47],a[56:59],v[120:123]
 mf v[104:107],a[40:43],a[56:59],v[104:107]
 buffer_load_dwordx4 v40, s[4:7], s26 offen offset:3072 lds
 mf v[100:103],a[40:43],a[52:55],v[100:103]
 mf v[116:119],a[44:47],a[52:55],v[116:119]
 mf v[112:115],a[44:47],a[48:51],v[112:115]
 s_waitcnt lgkmcnt(0)
 s_nop 0
 mf v[96:99],a[40:43],a[48:51],v[96:99]
 mf v[64:67],a[0:3],a[16:19],v[64:67]
 rd a[48:51],v57,8192
 tr a[32:33],v48,8192
 mf v[80:83],a[4:7],a[16:19],v[80:83]
 tr a[34:35],v48,12288
 rd a[52:55],v57,9216
 mf v[84:87],a[4:7],a[20:23],v[84:87]
 buffer_load_dwordx2 v[42:43], v41, s[16:19], s89 offen sc1
 mf v[68:71],a[0:3],a[20:23],v[68:71]
 tr a[36:37],v49,8192
 s_add_u32 s26, s26, 16384
 mf v[72:75],a[0:3],a[24:27],v[72:75]
 tr a[38:39],v49,12288
 s_add_u32 m0, s29, 49152
 mf v[88:91],a[4:7],a[24:27],v[88:91]
 buffer_load_dwordx4 v40, s[8:11], s27 offen offset:0 lds
 mf v[92:95],a[4:7],a[28:31],v[92:95]
 rd a[56:59],v57,10240
 tr a[40:41],v50,8192
 mf v[76:79],a[0:3],a[28:31],v[76:79]
 buffer_load_dwordx4 v40, s[8:11], s27 offen offset:1024 lds
 mf v[108:111],a[8:11],a[28:31],v[108:111]
 tr a[42:43],v50,12288
 rd a[60:63],v57,11264
 mf v[124:127],a[12:15],a[28:31],v[124:127]
 buffer_load_dwordx4 v40, s[8:11], s27 offen offset:2048 lds
 mf v[120:123],a[12:15],a[24:27],v[120:123]
 tr a[44:45],v51,8192
 tr a[46:47],v51,12288
 mf v[104:107],a[8:11],a[24:27],v[104:107]
 mf v[100:103],a[8:11],a[20:23],v[100:103]
 buffer_load_dwordx4 v40, s[8:11], s27 offen offset:3072 lds
 mf v[116:119],a[12:15],a[20:23],v[116:119]
 s_add_u32 s27, s27, 262144
 mf v[112:115],a[12:15],a[16:19],v[112:115]
 s_waitcnt vmcnt(17) lgkmcnt(0)
 s_nop 0
 mf v[96:99],a[8:11],a[16:19],v[96:99]
 s_barrier
 s_nop 0
 mf v[64:67],a[32:35],a[48:51],v[64:67]
 rd a[16:19],v57,32768
 tr a[0:1],v48,32768
 mf v[80:83],a[36:39],a[48:51],v[80:83]
 tr a[2:3],v48,36864
 s_add_u32 m0, s29, 65536
 mf v[84:87],a[36:39],a[52:55],v[84:87]
 buffer_load_dwordx4 v40, s[4:7], s26 offen offset:0 lds
 mf v[68:71],a[32:35],a[52:55],v[68:71]
 rd a[20:23],v57,33792
 tr a[4:5],v49,32768
 mf v[72:75],a[32:35],a[56:59],v[72:75]
 tr a[6:7],v49,36864
 rd a[24:27],v57,34816
 mf v[88:91],a[36:39],a[56:59],v[88:91]
 buffer_load_dwordx4 v40, s[4:7], s26 offen offset:1024 lds
 mf v[92:95],a[36:39],a[60:63],v[92:95]
 tr a[8:9],v50,32768
 tr a[10:11],v50,36864
 mf v[76:79],a[32:35],a[60:63],v[76:79]
 rd a[28:31],v57,35840
 tr a[12:13],v51,32768
 mf v[108:111],a[40:43],a[60:63],v[108:111]
 buffer_load_dwordx4 v40, s[4:7], s26 offen offset:2048 lds
 mf v[124:127],a[44:47],a[60:63],v[124:127]
 tr a[14:15],v51,36864
 mf v[120:123],a[44:47],a[56:59],v[120:123]
 mf v[104:107],a[40:43],a[56:59],v[104:107]
 buffer_load_dwordx4 v40, s[4:7], s26 offen offset:3072 lds
 mf v[100:103],a[40:43],a[52:55],v[100:103]
 mf v[116:119],a[44:47],a[52:55],v[116:119]
 mf v[112:115],a[44:47],a[48:51],v[112:115]
 s_waitcnt lgkmcnt(0)
 s_nop 0
 mf v[96:99],a[40:43],a[48:51],v[96:99]
 mf v[64:67],a[0:3],a[16:19],v[64:67]
 rd a[48:51],v57,40960
 s_add_u32 s26, s26, 16384
 mf v[80:83],a[4:7],a[16:19],v[80:83]
 tr a[32:33],v48,40960
 s_add_u32 m0, s29, 81920
 mf v[84:87],a[4:7],a[20:23],v[84:87]
 buffer_load_dwordx4 v40, s[8:11], s27 offen offset:0 lds
 mf v[68:71],a[0:3],a[20:23],v[68:71]
 tr a[34:35],v48,45056
 rd a[52:55],v57,41984
 mf v[72:75],a[0:3],a[24:27],v[72:75]
 tr a[36:37],v49,40960
 tr a[38:39],v49,45056
 mf v[88:91],a[4:7],a[24:27],v[88:91]
 buffer_load_dwordx4 v40, s[8:11], s27 offen offset:1024 lds
 mf v[92:95],a[4:7],a[28:31],v[92:95]
 rd a[56:59],v57,43008
 tr a[40:41],v50,40960
 mf v[76:79],a[0:3],a[28:31],v[76:79]
 tr a[42:43],v50,45056
 rd a[60:63],v57,44032
 mf v[108:111],a[8:11],a[28:31],v[108:111]
 buffer_load_dwordx4 v40, s[8:11], s27 offen offset:2048 lds
 mf v[124:127],a[12:15],a[28:31],v[124:127]
 tr a[44:45],v51,40960
 tr a[46:47],v51,45056
 mf v[120:123],a[12:15],a[24:27],v[120:123]
 mf v[104:107],a[8:11],a[24:27],v[104:107]
 buffer_load_dwordx4 v40, s[8:11], s27 offen offset:3072 lds
 mf v[100:103],a[8:11],a[20:23],v[100:103]
 s_add_u32 s27, s27, 262144
 mf v[116:119],a[12:15],a[20:23],v[116:119]
 mf v[112:115],a[12:15],a[16:19],v[112:115]
 s_waitcnt vmcnt(17) lgkmcnt(0)
 s_nop 0
 mf v[96:99],a[8:11],a[16:19],v[96:99]
 s_barrier
 s_nop 0
 mf v[64:67],a[32:35],a[48:51],v[64:67]
 rd a[16:19],v56,0
 tr a[0:1],v44,0
 mf v[80:83],a[36:39],a[48:51],v[80:83]
 tr a[2:3],v44,4096
 s_add_u32 m0, s29, 98304
 mf v[84:87],a[36:39],a[52:55],v[84:87]
 buffer_load_dwordx4 v40, s[4:7], s26 offen offset:0 lds
 mf v[68:71],a[32:35],a[52:55],v[68:71]
 rd a[20:23],v56,1024
 tr a[4:5],v45,0
 mf v[72:75],a[32:35],a[56:59],v[72:75]
 tr a[6:7],v45,4096
 rd a[24:27],v56,2048
 mf v[88:91],a[36:39],a[56:59],v[88:91]
 buffer_load_dwordx4 v40, s[4:7], s26 offen offset:1024 lds
 mf v[92:95],a[36:39],a[60:63],v[92:95]
 tr a[8:9],v46,0
 tr a[10:11],v46,4096
 mf v[76:79],a[32:35],a[60:63],v[76:79]
 rd a[28:31],v56,3072
 tr a[12:13],v47,0
 mf v[108:111],a[40:43],a[60:63],v[108:111]
 buffer_load_dwordx4 v40, s[4:7], s26 offen offset:2048 lds
 mf v[124:127],a[44:47],a[60:63],v[124:127]
 tr a[14:15],v47,4096
 mf v[120:123],a[44:47],a[56:59],v[120:123]
 mf v[104:107],a[40:43],a[56:59],v[104:107]
 buffer_load_dwordx4 v40, s[4:7], s26 offen offset:3072 lds
 mf v[100:103],a[40:43],a[52:55],v[100:103]
 mf v[116:119],a[44:47],a[52:55],v[116:119]
 mf v[112:115],a[44:47],a[48:51],v[112:115]
 s_waitcnt lgkmcnt(0)
 s_nop 0
 mf v[96:99],a[40:43],a[48:51],v[96:99]
 mf v[64:67],a[0:3],a[16:19],v[64:67]
 rd a[48:51],v56,8192
 s_add_u32 s26, s26, 16384
 mf v[80:83],a[4:7],a[16:19],v[80:83]
 tr a[32:33],v44,8192
 s_add_u32 m0, s29, 114688
 mf v[84:87],a[4:7],a[20:23],v[84:87]
 buffer_load_dwordx4 v40, s[8:11], s27 offen offset:0 lds
 mf v[68:71],a[0:3],a[20:23],v[68:71]
 tr a[34:35],v44,12288
 rd a[52:55],v56,9216
 mf v[72:75],a[0:3],a[24:27],v[72:75]
 tr a[36:37],v45,8192
 tr a[38:39],v45,12288
 mf v[88:91],a[4:7],a[24:27],v[88:91]
 buffer_load_dwordx4 v40, s[8:11], s27 offen offset:1024 lds
 mf v[92:95],a[4:7],a[28:31],v[92:95]
 rd a[56:59],v56,10240
 tr a[40:41],v46,8192
 mf v[76:79],a[0:3],a[28:31],v[76:79]
 tr a[42:43],v46,12288
 rd a[60:63],v56,11264
 mf v[108:111],a[8:11],a[28:31],v[108:111]
 buffer_load_dwordx4 v40, s[8:11], s27 offen offset:2048 lds
 mf v[124:127],a[12:15],a[28:31],v[124:127]
 tr a[44:45],v47,8192
 tr a[46:47],v47,12288
 mf v[120:123],a[12:15],a[24:27],v[120:123]
 mf v[104:107],a[8:11],a[24:27],v[104:107]
 buffer_load_dwordx4 v40, s[8:11], s27 offen offset:3072 lds
 mf v[100:103],a[8:11],a[20:23],v[100:103]
 s_add_u32 s27, s27, 262144
 mf v[116:119],a[12:15],a[20:23],v[116:119]
 mf v[112:115],a[12:15],a[16:19],v[112:115]
 s_waitcnt vmcnt(16) lgkmcnt(0)
 s_nop 0
 mf v[96:99],a[8:11],a[16:19],v[96:99]
 s_barrier
 s_waitcnt vmcnt(20)
 v_cmp_ne_u64 vcc, s[36:37], v[42:43]
 s_cmp_lg_u64 vcc, 0
 s_cbranch_scc1 L_u_late
L_u_ok:
 s_nop 0
 mf v[64:67],a[32:35],a[48:51],v[64:67]
 s_add_u32 s8, s32, 20971520
 s_addc_u32 s9, s33, 0
 s_nop 0
 mf v[80:83],a[36:39],a[48:51],v[80:83]
 s_mov_b32 s10, 7340032
 s_mov_b32 s27, s84
 s_nop 0
 mf v[84:87],a[36:39],a[52:55],v[84:87]
 rd a[16:19],v56,32768
 s_add_u32 m0, s29, 0
 s_nop 0
 mf v[68:71],a[32:35],a[52:55],v[68:71]
 buffer_load_dwordx4 v40, s[4:7], s26 offen offset:0 lds
 mf v[72:75],a[32:35],a[56:59],v[72:75]
 tr a[0:1],v44,32768
 tr a[2:3],v44,36864
 mf v[88:91],a[36:39],a[56:59],v[88:91]
 buffer_load_dwordx4 v40, s[4:7], s26 offen offset:1024 lds
 mf v[92:95],a[36:39],a[60:63],v[92:95]
 rd a[20:23],v56,33792
 tr a[4:5],v45,32768
 mf v[76:79],a[32:35],a[60:63],v[76:79]
 tr a[6:7],v45,36864
 rd a[24:27],v56,34816
 mf v[108:111],a[40:43],a[60:63],v[108:111]
 buffer_load_dwordx4 v40, s[4:7], s26 offen offset:2048 lds
 mf v[124:127],a[44:47],a[60:63],v[124:127]
 tr a[8:9],v46,32768
 tr a[10:11],v46,36864
 mf v[120:123],a[44:47],a[56:59],v[120:123]
 rd a[28:31],v56,35840
 tr a[12:13],v47,32768
 mf v[104:107],a[40:43],a[56:59],v[104:107]
 buffer_load_dwordx4 v40, s[4:7], s26 offen offset:3072 lds
 mf v[100:103],a[40:43],a[52:55],v[100:103]
 tr a[14:15],v47,36864
 mf v[116:119],a[44:47],a[52:55],v[116:119]
 mf v[112:115],a[44:47],a[48:51],v[112:115]
 s_waitcnt lgkmcnt(0)
 s_nop 0
 mf v[96:99],a[40:43],a[48:51],v[96:99]
 mf v[64:67],a[0:3],a[16:19],v[64:67]
 rd a[48:51],v56,40960
 s_add_u32 s26, s26, 16384
 mf v[80:83],a[4:7],a[16:19],v[80:83]
 tr a[32:33],v44,40960
 s_add_u32 m0, s29, 16384
 mf v[84:87],a[4:7],a[20:23],v[84:87]
 buffer_load_dwordx4 v40, s[8:11], s27 offen offset:0 lds
 mf v[68:71],a[0:3],a[20:23],v[68:71]
 tr a[34:35],v44,45056
 rd a[52:55],v56,41984
 mf v[72:75],a[0:3],a[24:27],v[72:75]
 tr a[36:37],v45,40960
 tr a[38:39],v45,45056
 mf v[88:91],a[4:7],a[24:27],v[88:91]
 buffer_load_dwordx4 v40, s[8:11], s27 offen offset:1024 lds
 mf v[92:95],a[4:7],a[28:31],v[92:95]
 rd a[56:59],v56,43008
 tr a[40:41],v46,40960
 mf v[76:79],a[0:3],a[28:31],v[76:79]
 tr a[42:43],v46,45056
 rd a[60:63],v56,44032
 mf v[108:111],a[8:11],a[28:31],v[108:111]
 buffer_load_dwordx4 v40, s[8:11], s27 offen offset:2048 lds
 mf v[124:127],a[12:15],a[28:31],v[124:127]
 tr a[44:45],v47,40960
 tr a[46:47],v47,45056
 mf v[120:123],a[12:15],a[24:27],v[120:123]
 mf v[104:107],a[8:11],a[24:27],v[104:107]
 buffer_load_dwordx4 v40, s[8:11], s27 offen offset:3072 lds
 mf v[100:103],a[8:11],a[20:23],v[100:103]
 s_add_u32 s27, s27, 262144
 mf v[116:119],a[12:15],a[20:23],v[116:119]
 mf v[112:115],a[12:15],a[16:19],v[112:115]
 s_waitcnt vmcnt(16) lgkmcnt(0)
 s_nop 0
 mf v[96:99],a[8:11],a[16:19],v[96:99]
 s_barrier
 s_nop 0
 mf v[64:67],a[32:35],a[48:51],v[64:67]
 rd a[16:19],v57,0
 tr a[0:1],v48,0
 mf v[80:83],a[36:39],a[48:51],v[80:83]
 tr a[2:3],v48,4096
 s_add_u32 m0, s29, 32768
 mf v[84:87],a[36:39],a[52:55],v[84:87]
 buffer_load_dwordx4 v40, s[4:7], s26 offen offset:0 lds
 mf v[68:71],a[32:35],a[52:55],v[68:71]
 rd a[20:23],v57,1024
 tr a[4:5],v49,0
 mf v[72:75],a[32:35],a[56:59],v[72:75]
 tr a[6:7],v49,4096
 rd a[24:27],v57,2048
 mf v[88:91],a[36:39],a[56:59],v[88:91]
 buffer_load_dwordx4 v40, s[4:7], s26 offen offset:1024 lds
 mf v[92:95],a[36:39],a[60:63],v[92:95]
 tr a[8:9],v50,0
 tr a[10:11],v50,4096
 mf v[76:79],a[32:35],a[60:63],v[76:79]
 rd a[28:31],v57,3072
 tr a[12:13],v51,0
 mf v[108:111],a[40:43],a[60:63],v[108:111]
 buffer_load_dwordx4 v40, s[4:7], s26 offen offset:2048 lds
 mf v[124:127],a[44:47],a[60:63],v[124:127]
 tr a[14:15],v51,4096
 mf v[120:123],a[44:47],a[56:59],v[120:123]
 mf v[104:107],a[40:43],a[56:59],v[104:107]
 buffer_load_dwordx4 v40, s[4:7], s26 offen offset:3072 lds
 mf v[100:103],a[40:43],a[52:55],v[100:103]
 mf v[116:119],a[44:47],a[52:55],v[116:119]
 mf v[112:115],a[44:47],a[48:51],v[112:115]
 s_waitcnt lgkmcnt(0)
 s_nop 0
 mf v[96:99],a[40:43],a[48:51],v[96:99]
 mf v[64:67],a[0:3],a[16:19],v[64:67]
 rd a[48:51],v57,8192
 s_add_u32 s26, s26, 16384
 mf v[80:83],a[4:7],a[16:19],v[80:83]
 tr a[32:33],v48,8192
 s_add_u32 m0, s29, 49152
 mf v[84:87],a[4:7],a[20:23],v[84:87]
 buffer_load_dwordx4 v40, s[8:11], s27 offen offset:0 lds
 mf v[68:71],a[0:3],a[20:23],v[68:71]
 tr a[34:35],v48,12288
 rd a[52:55],v57,9216
 mf v[72:75],a[0:3],a[24:27],v[72:75]
 tr a[36:37],v49,8192
 tr a[38:39],v49,12288
 mf v[88:91],a[4:7],a[24:27],v[88:91]
 buffer_load_dwordx4 v40, s[8:11], s27 offen offset:1024 lds
 mf v[92:95],a[4:7],a[28:31],v[92:95]
 rd a[56:59],v57,10240
 tr a[40:41],v50,8192
 mf v[76:79],a[0:3],a[28:31],v[76:79]
 tr a[42:43],v50,12288
 rd a[60:63],v57,11264
 mf v[108:111],a[8:11],a[28:31],v[108:111]
 buffer_load_dwordx4 v40, s[8:11], s27 offen offset:2048 lds
 mf v[124:127],a[12:15],a[28:31],v[124:127]
 s_branch L_skip_16854
.p2align 12
L_stub_w1_16854:
 s_branch L_walk_z_ret
 s_nop 0
 s_nop 0
 s_nop 0
L_skip_16854:
 tr a[44:45],v51,8192
 tr a[46:47],v51,12288
 mf v[120:123],a[12:15],a[24:27],v[120:123]
 mf v[104:107],a[8:11],a[24:27],v[104:107]
 buffer_load_dwordx4 v40, s[8:11], s27 offen offset:3072 lds
 mf v[100:103],a[8:11],a[20:23],v[100:103]
 s_add_u32 s27, s27, 262144
 mf v[116:119],a[12:15],a[20:23],v[116:119]
 mf v[112:115],a[12:15],a[16:19],v[112:115]
 s_waitcnt vmcnt(16) lgkmcnt(0)
 s_nop 0
 mf v[96:99],a[8:11],a[16:19],v[96:99]
 s_barrier
 s_nop 0
 mf v[64:67],a[32:35],a[48:51],v[64:67]
 rd a[16:19],v57,32768
 tr a[0:1],v48,32768
 mf v[80:83],a[36:39],a[48:51],v[80:83]
 tr a[2:3],v48,36864
 s_add_u32 m0, s29, 65536
 mf v[84:87],a[36:39],a[52:55],v[84:87]
 buffer_load_dwordx4 v40, s[4:7], s26 offen offset:0 lds
 mf v[68:71],a[32:35],a[52:55],v[68:71]
 rd a[20:23],v57,33792
 tr a[4:5],v49,32768
 mf v[72:75],a[32:35],a[56:59],v[72:75]
 tr a[6:7],v49,36864
 rd a[24:27],v57,34816
 mf v[88:91],a[36:39],a[56:59],v[88:91]
 buffer_load_dwordx4 v40, s[4:7], s26 offen offset:1024 lds
 mf v[92:95],a[36:39],a[60:63],v[92:95]
 tr a[8:9],v50,32768
 tr a[10:11],v50,36864
 mf v[76:79],a[32:35],a[60:63],v[76:79]
 rd a[28:31],v57,35840
 tr a[12:13],v51,32768
 mf v[108:111],a[40:43],a[60:63],v[108:111]
 buffer_load_dwordx4 v40, s[4:7], s26 offen offset:2048 lds
 mf v[124:127],a[44:47],a[60:63],v[124:127]
 tr a[14:15],v51,36864
 mf v[120:123],a[44:47],a[56:59],v[120:123]
 mf v[104:107],a[40:43],a[56:59],v[104:107]
 buffer_load_dwordx4 v40, s[4:7], s26 offen offset:3072 lds
 mf v[100:103],a[40:43],a[52:55],v[100:103]
 mf v[116:119],a[44:47],a[52:55],v[116:119]
 mf v[112:115],a[44:47],a[48:51],v[112:115]
 s_waitcnt lgkmcnt(0)
 s_nop 0
 mf v[96:99],a[40:43],a[48:51],v[96:99]
 mf v[64:67],a[0:3],a[16:19],v[64:67]
 rd a[48:51],v57,40960
 s_add_u32 s26, s26, 16384
 mf v[80:83],a[4:7],a[16:19],v[80:83]
 tr a[32:33],v48,40960
 s_add_u32 m0, s29, 81920
 mf v[84:87],a[4:7],a[20:23],v[84:87]
 buffer_load_dwordx4 v40, s[8:11], s27 offen offset:0 lds
 mf v[68:71],a[0:3],a[20:23],v[68:71]
 tr a[34:35],v48,45056
 rd a[52:55],v57,41984
 mf v[72:75],a[0:3],a[24:27],v[72:75]
 tr a[36:37],v49,40960
 tr a[38:39],v49,45056
 mf v[88:91],a[4:7],a[24:27],v[88:91]
 buffer_load_dwordx4 v40, s[8:11], s27 offen offset:1024 lds
 mf v[92:95],a[4:7],a[28:31],v[92:95]
 rd a[56:59],v57,43008
 tr a[40:41],v50,40960
 mf v[76:79],a[0:3],a[28:31],v[76:79]
 tr a[42:43],v50,45056
 rd a[60:63],v57,44032
 mf v[108:111],a[8:11],a[28:31],v[108:111]
 buffer_load_dwordx4 v40, s[8:11], s27 offen offset:2048 lds
 mf v[124:127],a[12:15],a[28:31],v[124:127]
 tr a[44:45],v51,40960
 tr a[46:47],v51,45056
 mf v[120:123],a[12:15],a[24:27],v[120:123]
 mf v[104:107],a[8:11],a[24:27],v[104:107]
 buffer_load_dwordx4 v40, s[8:11], s27 offen offset:3072 lds
 mf v[100:103],a[8:11],a[20:23],v[100:103]
 s_add_u32 s27, s27, 262144
 mf v[116:119],a[12:15],a[20:23],v[116:119]
 mf v[112:115],a[12:15],a[16:19],v[112:115]
 s_waitcnt vmcnt(16) lgkmcnt(0)
 s_nop 0
 mf v[96:99],a[8:11],a[16:19],v[96:99]
 s_barrier
 s_nop 0
 mf v[64:67],a[32:35],a[48:51],v[64:67]
 rd a[16:19],v56,0
 tr a[0:1],v44,0
 mf v[80:83],a[36:39],a[48:51],v[80:83]
 tr a[2:3],v44,4096
 s_add_u32 m0, s29, 98304
 mf v[84:87],a[36:39],a[52:55],v[84:87]
 buffer_load_dwordx4 v40, s[4:7], s26 offen offset:0 lds
 mf v[68:71],a[32:35],a[52:55],v[68:71]
 rd a[20:23],v56,1024
 tr a[4:5],v45,0
 mf v[72:75],a[32:35],a[56:59],v[72:75]
 tr a[6:7],v45,4096
 rd a[24:27],v56,2048
 mf v[88:91],a[36:39],a[56:59],v[88:91]
 buffer_load_dwordx4 v40, s[4:7], s26 offen offset:1024 lds
 mf v[92:95],a[36:39],a[60:63],v[92:95]
 tr a[8:9],v46,0
 tr a[10:11],v46,4096
 mf v[76:79],a[32:35],a[60:63],v[76:79]
 rd a[28:31],v56,3072
 tr a[12:13],v47,0
 mf v[108:111],a[40:43],a[60:63],v[108:111]
 buffer_load_dwordx4 v40, s[4:7], s26 offen offset:2048 lds
 mf v[124:127],a[44:47],a[60:63],v[124:127]
 tr a[14:15],v47,4096
 mf v[120:123],a[44:47],a[56:59],v[120:123]
 mf v[104:107],a[40:43],a[56:59],v[104:107]
 buffer_load_dwordx4 v40, s[4:7], s26 offen offset:3072 lds
 mf v[100:103],a[40:43],a[52:55],v[100:103]
 mf v[116:119],a[44:47],a[52:55],v[116:119]
 mf v[112:115],a[44:47],a[48:51],v[112:115]
 s_waitcnt lgkmcnt(0)
 s_nop 0
 mf v[96:99],a[40:43],a[48:51],v[96:99]
 mf v[128:131],a[0:3],a[16:19],0
 rd a[48:51],v56,8192
 s_add_u32 s26, s26, 16384
 mf v[144:147],a[4:7],a[16:19],0
 tr a[32:33],v44,8192
 s_add_u32 m0, s29, 114688
 mf v[148:151],a[4:7],a[20:23],0
 buffer_load_dwordx4 v40, s[8:11], s27 offen offset:0 lds
 mf v[132:135],a[0:3],a[20:23],0
 tr a[34:35],v44,12288
 rd a[52:55],v56,9216
 mf v[136:139],a[0:3],a[24:27],0
 tr a[36:37],v45,8192
 tr a[38:39],v45,12288
 mf v[152:155],a[4:7],a[24:27],0
 buffer_load_dwordx4 v40, s[8:11], s27 offen offset:1024 lds
 mf v[156:159],a[4:7],a[28:31],0
 rd a[56:59],v56,10240
 tr a[40:41],v46,8192
 mf v[140:143],a[0:3],a[28:31],0
 tr a[42:43],v46,12288
 rd a[60:63],v56,11264
 mf v[172:175],a[8:11],a[28:31],0
 buffer_load_dwordx4 v40, s[8:11], s27 offen offset:2048 lds
 mf v[188:191],a[12:15],a[28:31],0
 tr a[44:45],v47,8192
 tr a[46:47],v47,12288
 mf v[184:187],a[12:15],a[24:27],0
 mf v[168:171],a[8:11],a[24:27],0
 buffer_load_dwordx4 v40, s[8:11], s27 offen offset:3072 lds
 mf v[164:167],a[8:11],a[20:23],0
 s_add_u32 s27, s27, 262144
 mf v[180:183],a[12:15],a[20:23],0
 mf v[176:179],a[12:15],a[16:19],0
 s_waitcnt vmcnt(16) lgkmcnt(0)
 s_nop 0
 mf v[160:163],a[8:11],a[16:19],0
 s_barrier
 s_nop 0
 mf v[128:131],a[32:35],a[48:51],v[128:131]
 rd a[16:19],v56,32768
 tr a[0:1],v44,32768
 mf v[144:147],a[36:39],a[48:51],v[144:147]
 tr a[2:3],v44,36864
 s_add_u32 m0, s29, 0
 s_nop 0
 mf v[148:151],a[36:39],a[52:55],v[148:151]
 buffer_load_dwordx4 v40, s[4:7], s26 offen offset:0 lds
 mf v[132:135],a[32:35],a[52:55],v[132:135]
 rd a[20:23],v56,33792
 tr a[4:5],v45,32768
 mf v[136:139],a[32:35],a[56:59],v[136:139]
 tr a[6:7],v45,36864
 rd a[24:27],v56,34816
 mf v[152:155],a[36:39],a[56:59],v[152:155]
 buffer_load_dwordx4 v40, s[4:7], s26 offen offset:1024 lds
 mf v[156:159],a[36:39],a[60:63],v[156:159]
 tr a[8:9],v46,32768
 tr a[10:11],v46,36864
 mf v[140:143],a[32:35],a[60:63],v[140:143]
 rd a[28:31],v56,35840
 tr a[12:13],v47,32768
 mf v[172:175],a[40:43],a[60:63],v[172:175]
 buffer_load_dwordx4 v40, s[4:7], s26 offen offset:2048 lds
 mf v[188:191],a[44:47],a[60:63],v[188:191]
 tr a[14:15],v47,36864
 mf v[184:187],a[44:47],a[56:59],v[184:187]
 mf v[168:171],a[40:43],a[56:59],v[168:171]
 buffer_load_dwordx4 v40, s[4:7], s26 offen offset:3072 lds
 mf v[164:167],a[40:43],a[52:55],v[164:167]
 mf v[180:183],a[44:47],a[52:55],v[180:183]
 mf v[176:179],a[44:47],a[48:51],v[176:179]
 s_waitcnt lgkmcnt(0)
 s_nop 0
 mf v[160:163],a[40:43],a[48:51],v[160:163]
 s_mov_b32 s30, 5
.p2align 6
L_fz_loop_33:
 mf v[128:131],a[0:3],a[16:19],v[128:131]
 rd a[48:51],v56,40960
 s_add_u32 s26, s26, 16384
 mf v[144:147],a[4:7],a[16:19],v[144:147]
 tr a[32:33],v44,40960
 s_add_u32 m0, s29, 16384
 mf v[148:151],a[4:7],a[20:23],v[148:151]
 buffer_load_dwordx4 v40, s[8:11], s27 offen offset:0 lds
 mf v[132:135],a[0:3],a[20:23],v[132:135]
 tr a[34:35],v44,45056
 rd a[52:55],v56,41984
 mf v[136:139],a[0:3],a[24:27],v[136:139]
 tr a[36:37],v45,40960
 tr a[38:39],v45,45056
 mf v[152:155],a[4:7],a[24:27],v[152:155]
 buffer_load_dwordx4 v40, s[8:11], s27 offen offset:1024 lds
 mf v[156:159],a[4:7],a[28:31],v[156:159]
 rd a[56:59],v56,43008
 tr a[40:41],v46,40960
 mf v[140:143],a[0:3],a[28:31],v[140:143]
 tr a[42:43],v46,45056
 rd a[60:63],v56,44032
 mf v[172:175],a[8:11],a[28:31],v[172:175]
 buffer_load_dwordx4 v40, s[8:11], s27 offen offset:2048 lds
 mf v[188:191],a[12:15],a[28:31],v[188:191]
 tr a[44:45],v47,40960
 tr a[46:47],v47,45056
 mf v[184:187],a[12:15],a[24:27],v[184:187]
 mf v[168:171],a[8:11],a[24:27],v[168:171]
 buffer_load_dwordx4 v40, s[8:11], s27 offen offset:3072 lds
 mf v[164:167],a[8:11],a[20:23],v[164:167]
 s_add_u32 s27, s27, 262144
 mf v[180:183],a[12:15],a[20:23],v[180:183]
 mf v[176:179],a[12:15],a[16:19],v[176:179]
 s_waitcnt vmcnt(16) lgkmcnt(0)
 s_nop 0
 mf v[160:163],a[8:11],a[16:19],v[160:163]
 s_barrier
 s_nop 0
 mf v[128:131],a[32:35],a[48:51],v[128:131]
 rd a[16:19],v57,0
 tr a[0:1],v48,0
 mf v[144:147],a[36:39],a[48:51],v[144:147]
 tr a[2:3],v48,4096
 s_add_u32 m0, s29, 32768
 mf v[148:151],a[36:39],a[52:55],v[148:151]
 buffer_load_dwordx4 v40, s[4:7], s26 offen offset:0 lds
 mf v[132:135],a[32:35],a[52:55],v[132:135]
 rd a[20:23],v57,1024
 tr a[4:5],v49,0
 mf v[136:139],a[32:35],a[56:59],v[136:139]
 tr a[6:7],v49,4096
 rd a[24:27],v57,2048
 mf v[152:155],a[36:39],a[56:59],v[152:155]
 buffer_load_dwordx4 v40, s[4:7], s26 offen offset:1024 lds
 mf v[156:159],a[36:39],a[60:63],v[156:159]
 tr a[8:9],v50,0
 tr a[10:11],v50,4096
 mf v[140:143],a[32:35],a[60:63],v[140:143]
 rd a[28:31],v57,3072
 tr a[12:13],v51,0
 mf v[172:175],a[40:43],a[60:63],v[172:175]
 buffer_load_dwordx4 v40, s[4:7], s26 offen offset:2048 lds
 mf v[188:191],a[44:47],a[60:63],v[188:191]
 tr a[14:15],v51,4096
 mf v[184:187],a[44:47],a[56:59],v[184:187]
 mf v[168:171],a[40:43],a[56:59],v[168:171]
 buffer_load_dwordx4 v40, s[4:7], s26 offen offset:3072 lds
 mf v[164:167],a[40:43],a[52:55],v[164:167]
 mf v[180:183],a[44:47],a[52:55],v[180:183]
 mf v[176:179],a[44:47],a[48:51],v[176:179]
 s_waitcnt lgkmcnt(0)
 s_nop 0
 mf v[160:163],a[40:43],a[48:51],v[160:163]
 mf v[128:131],a[0:3],a[16:19],v[128:131]
 rd a[48:51],v57,8192
 s_add_u32 s26, s26, 16384
 mf v[144:147],a[4:7],a[16:19],v[144:147]
 tr a[32:33],v48,8192
 s_add_u32 m0, s29, 49152
 mf v[148:151],a[4:7],a[20:23],v[148:151]
 buffer_load_dwordx4 v40, s[8:11], s27 offen offset:0 lds
 mf v[132:135],a[0:3],a[20:23],v[132:135]
 tr a[34:35],v48,12288
 rd a[52:55],v57,9216
 mf v[136:139],a[0:3],a[24:27],v[136:139]
 tr a[36:37],v49,8192
 tr a[38:39],v49,12288
 mf v[152:155],a[4:7],a[24:27],v[152:155]
 buffer_load_dwordx4 v40, s[8:11], s27 offen offset:1024 lds
 mf v[156:159],a[4:7],a[28:31],v[156:159]
 rd a[56:59],v57,10240
 tr a[40:41],v50,8192
 mf v[140:143],a[0:3],a[28:31],v[140:143]
 tr a[42:43],v50,12288
 rd a[60:63],v57,11264
 mf v[172:175],a[8:11],a[28:31],v[172:175]
 buffer_load_dwordx4 v40, s[8:11], s27 offen offset:2048 lds
 mf v[188:191],a[12:15],a[28:31],v[188:191]
 tr a[44:45],v51,8192
 tr a[46:47],v51,12288
 mf v[184:187],a[12:15],a[24:27],v[184:187]
 mf v[168:171],a[8:11],a[24:27],v[168:171]
 buffer_load_dwordx4 v40, s[8:11], s27 offen offset:3072 lds
 mf v[164:167],a[8:11],a[20:23],v[164:167]
 s_add_u32 s27, s27, 262144
 mf v[180:183],a[12:15],a[20:23],v[180:183]
 mf v[176:179],a[12:15],a[16:19],v[176:179]
 s_waitcnt vmcnt(16) lgkmcnt(0)
 s_nop 0
 mf v[160:163],a[8:11],a[16:19],v[160:163]
 s_barrier
 s_nop 0
 mf v[128:131],a[32:35],a[48:51],v[128:131]
 rd a[16:19],v57,32768
 tr a[0:1],v48,32768
 mf v[144:147],a[36:39],a[48:51],v[144:147]
 tr a[2:3],v48,36864
 s_add_u32 m0, s29, 65536
 mf v[148:151],a[36:39],a[52:55],v[148:151]
 buffer_load_dwordx4 v40, s[4:7], s26 offen offset:0 lds
 mf v[132:135],a[32:35],a[52:55],v[132:135]
 rd a[20:23],v57,33792
 tr a[4:5],v49,32768
 mf v[136:139],a[32:35],a[56:59],v[136:139]
 tr a[6:7],v49,36864
 rd a[24:27],v57,34816
 mf v[152:155],a[36:39],a[56:59],v[152:155]
 buffer_load_dwordx4 v40, s[4:7], s26 offen offset:1024 lds
 mf v[156:159],a[36:39],a[60:63],v[156:159]
 tr a[8:9],v50,32768
 tr a[10:11],v50,36864
 mf v[140:143],a[32:35],a[60:63],v[140:143]
 rd a[28:31],v57,35840
 tr a[12:13],v51,32768
 mf v[172:175],a[40:43],a[60:63],v[172:175]
 buffer_load_dwordx4 v40, s[4:7], s26 offen offset:2048 lds
 mf v[188:191],a[44:47],a[60:63],v[188:191]
 tr a[14:15],v51,36864
 mf v[184:187],a[44:47],a[56:59],v[184:187]
 mf v[168:171],a[40:43],a[56:59],v[168:171]
 buffer_load_dwordx4 v40, s[4:7], s26 offen offset:3072 lds
 mf v[164:167],a[40:43],a[52:55],v[164:167]
 mf v[180:183],a[44:47],a[52:55],v[180:183]
 mf v[176:179],a[44:47],a[48:51],v[176:179]
 s_waitcnt lgkmcnt(0)
 s_nop 0
 mf v[160:163],a[40:43],a[48:51],v[160:163]
 mf v[128:131],a[0:3],a[16:19],v[128:131]
 rd a[48:51],v57,40960
 s_add_u32 s26, s26, 16384
 mf v[144:147],a[4:7],a[16:19],v[144:147]
 tr a[32:33],v48,40960
 s_add_u32 m0, s29, 81920
 mf v[148:151],a[4:7],a[20:23],v[148:151]
 buffer_load_dwordx4 v40, s[8:11], s27 offen offset:0 lds
 mf v[132:135],a[0:3],a[20:23],v[132:135]
 tr a[34:35],v48,45056
 rd a[52:55],v57,41984
 mf v[136:139],a[0:3],a[24:27],v[136:139]
 tr a[36:37],v49,40960
 tr a[38:39],v49,45056
 mf v[152:155],a[4:7],a[24:27],v[152:155]
 buffer_load_dwordx4 v40, s[8:11], s27 offen offset:1024 lds
 mf v[156:159],a[4:7],a[28:31],v[156:159]
 rd a[56:59],v57,43008
 tr a[40:41],v50,40960
 mf v[140:143],a[0:3],a[28:31],v[140:143]
 tr a[42:43],v50,45056
 rd a[60:63],v57,44032
 mf v[172:175],a[8:11],a[28:31],v[172:175]
 buffer_load_dwordx4 v40, s[8:11], s27 offen offset:2048 lds
 mf v[188:191],a[12:15],a[28:31],v[188:191]
 tr a[44:45],v51,40960
 tr a[46:47],v51,45056
 mf v[184:187],a[12:15],a[24:27],v[184:187]
 mf v[168:171],a[8:11],a[24:27],v[168:171]
 buffer_load_dwordx4 v40, s[8:11], s27 offen offset:3072 lds
 mf v[164:167],a[8:11],a[20:23],v[164:167]
 s_add_u32 s27, s27, 262144
 mf v[180:183],a[12:15],a[20:23],v[180:183]
 mf v[176:179],a[12:15],a[16:19],v[176:179]
 s_waitcnt vmcnt(16) lgkmcnt(0)
 s_nop 0
 mf v[160:163],a[8:11],a[16:19],v[160:163]
 s_barrier
 s_nop 0
 mf v[128:131],a[32:35],a[48:51],v[128:131]
 rd a[16:19],v56,0
 tr a[0:1],v44,0
 mf v[144:147],a[36:39],a[48:51],v[144:147]
 tr a[2:3],v44,4096
 s_add_u32 m0, s29, 98304
 mf v[148:151],a[36:39],a[52:55],v[148:151]
 buffer_load_dwordx4 v40, s[4:7], s26 offen offset:0 lds
 mf v[132:135],a[32:35],a[52:55],v[132:135]
 rd a[20:23],v56,1024
 tr a[4:5],v45,0
 mf v[136:139],a[32:35],a[56:59],v[136:139]
 tr a[6:7],v45,4096
 rd a[24:27],v56,2048
 mf v[152:155],a[36:39],a[56:59],v[152:155]
 buffer_load_dwordx4 v40, s[4:7], s26 offen offset:1024 lds
 mf v[156:159],a[36:39],a[60:63],v[156:159]
 tr a[8:9],v46,0
 tr a[10:11],v46,4096
 mf v[140:143],a[32:35],a[60:63],v[140:143]
 rd a[28:31],v56,3072
 tr a[12:13],v47,0
 mf v[172:175],a[40:43],a[60:63],v[172:175]
 buffer_load_dwordx4 v40, s[4:7], s26 offen offset:2048 lds
 mf v[188:191],a[44:47],a[60:63],v[188:191]
 tr a[14:15],v47,4096
 mf v[184:187],a[44:47],a[56:59],v[184:187]
 mf v[168:171],a[40:43],a[56:59],v[168:171]
 buffer_load_dwordx4 v40, s[4:7], s26 offen offset:3072 lds
 mf v[164:167],a[40:43],a[52:55],v[164:167]
 mf v[180:183],a[44:47],a[52:55],v[180:183]
 mf v[176:179],a[44:47],a[48:51],v[176:179]
 s_waitcnt lgkmcnt(0)
 s_nop 0
 mf v[160:163],a[40:43],a[48:51],v[160:163]
 mf v[128:131],a[0:3],a[16:19],v[128:131]
 rd a[48:51],v56,8192
 s_add_u32 s26, s26, 16384
 mf v[144:147],a[4:7],a[16:19],v[144:147]
 tr a[32:33],v44,8192
 s_add_u32 m0, s29, 114688
 mf v[148:151],a[4:7],a[20:23],v[148:151]
 buffer_load_dwordx4 v40, s[8:11], s27 offen offset:0 lds
 mf v[132:135],a[0:3],a[20:23],v[132:135]
 tr a[34:35],v44,12288
 rd a[52:55],v56,9216
 mf v[136:139],a[0:3],a[24:27],v[136:139]
 tr a[36:37],v45,8192
 tr a[38:39],v45,12288
 mf v[152:155],a[4:7],a[24:27],v[152:155]
 buffer_load_dwordx4 v40, s[8:11], s27 offen offset:1024 lds
 mf v[156:159],a[4:7],a[28:31],v[156:159]
 rd a[56:59],v56,10240
 tr a[40:41],v46,8192
 mf v[140:143],a[0:3],a[28:31],v[140:143]
 tr a[42:43],v46,12288
 rd a[60:63],v56,11264
 mf v[172:175],a[8:11],a[28:31],v[172:175]
 buffer_load_dwordx4 v40, s[8:11], s27 offen offset:2048 lds
 mf v[188:191],a[12:15],a[28:31],v[188:191]
 tr a[44:45],v47,8192
 tr a[46:47],v47,12288
 mf v[184:187],a[12:15],a[24:27],v[184:187]
 mf v[168:171],a[8:11],a[24:27],v[168:171]
 buffer_load_dwordx4 v40, s[8:11], s27 offen offset:3072 lds
 mf v[164:167],a[8:11],a[20:23],v[164:167]
 s_add_u32 s27, s27, 262144
 mf v[180:183],a[12:15],a[20:23],v[180:183]
 mf v[176:179],a[12:15],a[16:19],v[176:179]
 s_waitcnt vmcnt(16) lgkmcnt(0)
 s_nop 0
 mf v[160:163],a[8:11],a[16:19],v[160:163]
 s_barrier
 s_nop 0
 mf v[128:131],a[32:35],a[48:51],v[128:131]
 rd a[16:19],v56,32768
 tr a[0:1],v44,32768
 mf v[144:147],a[36:39],a[48:51],v[144:147]
 tr a[2:3],v44,36864
 s_add_u32 m0, s29, 0
 s_nop 0
 mf v[148:151],a[36:39],a[52:55],v[148:151]
 buffer_load_dwordx4 v40, s[4:7], s26 offen offset:0 lds
 mf v[132:135],a[32:35],a[52:55],v[132:135]
 rd a[20:23],v56,33792
 tr a[4:5],v45,32768
 mf v[136:139],a[32:35],a[56:59],v[136:139]
 tr a[6:7],v45,36864
 rd a[24:27],v56,34816
 mf v[152:155],a[36:39],a[56:59],v[152:155]
 buffer_load_dwordx4 v40, s[4:7], s26 offen offset:1024 lds
 mf v[156:159],a[36:39],a[60:63],v[156:159]
 tr a[8:9],v46,32768
 tr a[10:11],v46,36864
 mf v[140:143],a[32:35],a[60:63],v[140:143]
 rd a[28:31],v56,35840
 tr a[12:13],v47,32768
 mf v[172:175],a[40:43],a[60:63],v[172:175]
 buffer_load_dwordx4 v40, s[4:7], s26 offen offset:2048 lds
 mf v[188:191],a[44:47],a[60:63],v[188:191]
 tr a[14:15],v47,36864
 mf v[184:187],a[44:47],a[56:59],v[184:187]
 mf v[168:171],a[40:43],a[56:59],v[168:171]
 buffer_load_dwordx4 v40, s[4:7], s26 offen offset:3072 lds
 mf v[164:167],a[40:43],a[52:55],v[164:167]
 mf v[180:183],a[44:47],a[52:55],v[180:183]
 mf v[176:179],a[44:47],a[48:51],v[176:179]
 s_sub_u32 s30, s30, 1
 s_waitcnt lgkmcnt(0)
 s_cmp_lg_u32 s30, 0
 s_nop 0
 mf v[160:163],a[40:43],a[48:51],v[160:163]
 s_cbranch_scc1 L_fz_loop_33
 s_nop 0
 mf v[128:131],a[0:3],a[16:19],v[128:131]
 rd a[48:51],v56,40960
 s_add_u32 s26, s26, 16384
 mf v[144:147],a[4:7],a[16:19],v[144:147]
 tr a[32:33],v44,40960
 s_add_u32 m0, s29, 16384
 mf v[148:151],a[4:7],a[20:23],v[148:151]
 buffer_load_dwordx4 v40, s[8:11], s27 offen offset:0 lds
 mf v[132:135],a[0:3],a[20:23],v[132:135]
 tr a[34:35],v44,45056
 rd a[52:55],v56,41984
 mf v[136:139],a[0:3],a[24:27],v[136:139]
 tr a[36:37],v45,40960
 tr a[38:39],v45,45056
 mf v[152:155],a[4:7],a[24:27],v[152:155]
 buffer_load_dwordx4 v40, s[8:11], s27 offen offset:1024 lds
 mf v[156:159],a[4:7],a[28:31],v[156:159]
 rd a[56:59],v56,43008
 tr a[40:41],v46,40960
 mf v[140:143],a[0:3],a[28:31],v[140:143]
 tr a[42:43],v46,45056
 rd a[60:63],v56,44032
 mf v[172:175],a[8:11],a[28:31],v[172:175]
 buffer_load_dwordx4 v40, s[8:11], s27 offen offset:2048 lds
 mf v[188:191],a[12:15],a[28:31],v[188:191]
 tr a[44:45],v47,40960
 tr a[46:47],v47,45056
 mf v[184:187],a[12:15],a[24:27],v[184:187]
 mf v[168:171],a[8:11],a[24:27],v[168:171]
 buffer_load_dwordx4 v40, s[8:11], s27 offen offset:3072 lds
 mf v[164:167],a[8:11],a[20:23],v[164:167]
 s_add_u32 s27, s27, 262144
 mf v[180:183],a[12:15],a[20:23],v[180:183]
 s_branch L_skip_17391
.p2align 12
L_stub_w1_17391:
 s_branch L_walk_z_ret
 s_nop 0
 s_nop 0
 s_nop 0
L_skip_17391:
 mf v[176:179],a[12:15],a[16:19],v[176:179]
 s_waitcnt vmcnt(16) lgkmcnt(0)
 s_nop 0
 mf v[160:163],a[8:11],a[16:19],v[160:163]
 s_barrier
 s_nop 0
 mf v[128:131],a[32:35],a[48:51],v[128:131]
 rd a[16:19],v57,0
 tr a[0:1],v48,0
 mf v[144:147],a[36:39],a[48:51],v[144:147]
 tr a[2:3],v48,4096
 s_add_u32 m0, s29, 32768
 mf v[148:151],a[36:39],a[52:55],v[148:151]
 buffer_load_dwordx4 v40, s[4:7], s26 offen offset:0 lds
 mf v[132:135],a[32:35],a[52:55],v[132:135]
 rd a[20:23],v57,1024
 tr a[4:5],v49,0
 mf v[136:139],a[32:35],a[56:59],v[136:139]
 tr a[6:7],v49,4096
 rd a[24:27],v57,2048
 mf v[152:155],a[36:39],a[56:59],v[152:155]
 buffer_load_dwordx4 v40, s[4:7], s26 offen offset:1024 lds
 mf v[156:159],a[36:39],a[60:63],v[156:159]
 tr a[8:9],v50,0
 tr a[10:11],v50,4096
 mf v[140:143],a[32:35],a[60:63],v[140:143]
 rd a[28:31],v57,3072
 tr a[12:13],v51,0
 mf v[172:175],a[40:43],a[60:63],v[172:175]
 buffer_load_dwordx4 v40, s[4:7], s26 offen offset:2048 lds
 mf v[188:191],a[44:47],a[60:63],v[188:191]
 tr a[14:15],v51,4096
 mf v[184:187],a[44:47],a[56:59],v[184:187]
 mf v[168:171],a[40:43],a[56:59],v[168:171]
 buffer_load_dwordx4 v40, s[4:7], s26 offen offset:3072 lds
 mf v[164:167],a[40:43],a[52:55],v[164:167]
 mf v[180:183],a[44:47],a[52:55],v[180:183]
 mf v[176:179],a[44:47],a[48:51],v[176:179]
 s_waitcnt lgkmcnt(0)
 s_nop 0
 mf v[160:163],a[40:43],a[48:51],v[160:163]
 mf v[128:131],a[0:3],a[16:19],v[128:131]
 rd a[48:51],v57,8192
 s_add_u32 s26, s26, 16384
 mf v[144:147],a[4:7],a[16:19],v[144:147]
 tr a[32:33],v48,8192
 s_add_u32 m0, s29, 49152
 mf v[148:151],a[4:7],a[20:23],v[148:151]
 buffer_load_dwordx4 v40, s[8:11], s27 offen offset:0 lds
 mf v[132:135],a[0:3],a[20:23],v[132:135]
 tr a[34:35],v48,12288
 rd a[52:55],v57,9216
 mf v[136:139],a[0:3],a[24:27],v[136:139]
 tr a[36:37],v49,8192
 tr a[38:39],v49,12288
 mf v[152:155],a[4:7],a[24:27],v[152:155]
 buffer_load_dwordx4 v40, s[8:11], s27 offen offset:1024 lds
 mf v[156:159],a[4:7],a[28:31],v[156:159]
 rd a[56:59],v57,10240
 tr a[40:41],v50,8192
 mf v[140:143],a[0:3],a[28:31],v[140:143]
 tr a[42:43],v50,12288
 rd a[60:63],v57,11264
 mf v[172:175],a[8:11],a[28:31],v[172:175]
 buffer_load_dwordx4 v40, s[8:11], s27 offen offset:2048 lds
 mf v[188:191],a[12:15],a[28:31],v[188:191]
 tr a[44:45],v51,8192
 tr a[46:47],v51,12288
 mf v[184:187],a[12:15],a[24:27],v[184:187]
 mf v[168:171],a[8:11],a[24:27],v[168:171]
 buffer_load_dwordx4 v40, s[8:11], s27 offen offset:3072 lds
 mf v[164:167],a[8:11],a[20:23],v[164:167]
 s_add_u32 s27, s27, 262144
 mf v[180:183],a[12:15],a[20:23],v[180:183]
 mf v[176:179],a[12:15],a[16:19],v[176:179]
 s_waitcnt vmcnt(16) lgkmcnt(0)
 s_nop 0
 mf v[160:163],a[8:11],a[16:19],v[160:163]
 s_barrier
 s_nop 0
 mf v[128:131],a[32:35],a[48:51],v[128:131]
 rd a[16:19],v57,32768
 tr a[0:1],v48,32768
 mf v[144:147],a[36:39],a[48:51],v[144:147]
 tr a[2:3],v48,36864
 s_add_u32 m0, s29, 65536
 mf v[148:151],a[36:39],a[52:55],v[148:151]
 buffer_load_dwordx4 v40, s[4:7], s26 offen offset:0 lds
 mf v[132:135],a[32:35],a[52:55],v[132:135]
 rd a[20:23],v57,33792
 tr a[4:5],v49,32768
 mf v[136:139],a[32:35],a[56:59],v[136:139]
 tr a[6:7],v49,36864
 rd a[24:27],v57,34816
 mf v[152:155],a[36:39],a[56:59],v[152:155]
 buffer_load_dwordx4 v40, s[4:7], s26 offen offset:1024 lds
 mf v[156:159],a[36:39],a[60:63],v[156:159]
 tr a[8:9],v50,32768
 tr a[10:11],v50,36864
 mf v[140:143],a[32:35],a[60:63],v[140:143]
 rd a[28:31],v57,35840
 tr a[12:13],v51,32768
 mf v[172:175],a[40:43],a[60:63],v[172:175]
 buffer_load_dwordx4 v40, s[4:7], s26 offen offset:2048 lds
 mf v[188:191],a[44:47],a[60:63],v[188:191]
 tr a[14:15],v51,36864
 mf v[184:187],a[44:47],a[56:59],v[184:187]
 mf v[168:171],a[40:43],a[56:59],v[168:171]
 buffer_load_dwordx4 v40, s[4:7], s26 offen offset:3072 lds
 mf v[164:167],a[40:43],a[52:55],v[164:167]
 mf v[180:183],a[44:47],a[52:55],v[180:183]
 mf v[176:179],a[44:47],a[48:51],v[176:179]
 s_waitcnt lgkmcnt(0)
 s_nop 0
 mf v[160:163],a[40:43],a[48:51],v[160:163]
 mf v[128:131],a[0:3],a[16:19],v[128:131]
 rd a[48:51],v57,40960
 s_add_u32 s26, s26, 16384
 mf v[144:147],a[4:7],a[16:19],v[144:147]
 tr a[32:33],v48,40960
 s_add_u32 m0, s29, 81920
 mf v[148:151],a[4:7],a[20:23],v[148:151]
 buffer_load_dwordx4 v40, s[8:11], s27 offen offset:0 lds
 mf v[132:135],a[0:3],a[20:23],v[132:135]
 tr a[34:35],v48,45056
 rd a[52:55],v57,41984
 mf v[136:139],a[0:3],a[24:27],v[136:139]
 tr a[36:37],v49,40960
 tr a[38:39],v49,45056
 mf v[152:155],a[4:7],a[24:27],v[152:155]
 buffer_load_dwordx4 v40, s[8:11], s27 offen offset:1024 lds
 mf v[156:159],a[4:7],a[28:31],v[156:159]
 rd a[56:59],v57,43008
 tr a[40:41],v50,40960
 mf v[140:143],a[0:3],a[28:31],v[140:143]
 tr a[42:43],v50,45056
 rd a[60:63],v57,44032
 mf v[172:175],a[8:11],a[28:31],v[172:175]
 buffer_load_dwordx4 v40, s[8:11], s27 offen offset:2048 lds
 mf v[188:191],a[12:15],a[28:31],v[188:191]
 tr a[44:45],v51,40960
 tr a[46:47],v51,45056
 mf v[184:187],a[12:15],a[24:27],v[184:187]
 mf v[168:171],a[8:11],a[24:27],v[168:171]
 buffer_load_dwordx4 v40, s[8:11], s27 offen offset:3072 lds
 mf v[164:167],a[8:11],a[20:23],v[164:167]
 s_add_u32 s27, s27, 262144
 mf v[180:183],a[12:15],a[20:23],v[180:183]
 mf v[176:179],a[12:15],a[16:19],v[176:179]
 s_waitcnt vmcnt(16) lgkmcnt(0)
 s_nop 0
 mf v[160:163],a[8:11],a[16:19],v[160:163]
 s_barrier
 s_nop 0
 mf v[128:131],a[32:35],a[48:51],v[128:131]
 rd a[16:19],v56,0
 tr a[0:1],v44,0
 mf v[144:147],a[36:39],a[48:51],v[144:147]
 tr a[2:3],v44,4096
 s_add_u32 m0, s29, 98304
 mf v[148:151],a[36:39],a[52:55],v[148:151]
 buffer_load_dwordx4 v40, s[4:7], s26 offen offset:0 lds
 mf v[132:135],a[32:35],a[52:55],v[132:135]
 rd a[20:23],v56,1024
 tr a[4:5],v45,0
 mf v[136:139],a[32:35],a[56:59],v[136:139]
 tr a[6:7],v45,4096
 rd a[24:27],v56,2048
 mf v[152:155],a[36:39],a[56:59],v[152:155]
 buffer_load_dwordx4 v40, s[4:7], s26 offen offset:1024 lds
 mf v[156:159],a[36:39],a[60:63],v[156:159]
 tr a[8:9],v46,0
 tr a[10:11],v46,4096
 mf v[140:143],a[32:35],a[60:63],v[140:143]
 rd a[28:31],v56,3072
 tr a[12:13],v47,0
 mf v[172:175],a[40:43],a[60:63],v[172:175]
 buffer_load_dwordx4 v40, s[4:7], s26 offen offset:2048 lds
 mf v[188:191],a[44:47],a[60:63],v[188:191]
 tr a[14:15],v47,4096
 mf v[184:187],a[44:47],a[56:59],v[184:187]
 mf v[168:171],a[40:43],a[56:59],v[168:171]
 buffer_load_dwordx4 v40, s[4:7], s26 offen offset:3072 lds
 mf v[164:167],a[40:43],a[52:55],v[164:167]
 mf v[180:183],a[44:47],a[52:55],v[180:183]
 mf v[176:179],a[44:47],a[48:51],v[176:179]
 s_waitcnt lgkmcnt(0)
 s_nop 0
 mf v[160:163],a[40:43],a[48:51],v[160:163]
 mf v[128:131],a[0:3],a[16:19],v[128:131]
 rd a[48:51],v56,8192
 s_add_u32 s26, s26, 16384
 mf v[144:147],a[4:7],a[16:19],v[144:147]
 tr a[32:33],v44,8192
 s_add_u32 m0, s29, 114688
 mf v[148:151],a[4:7],a[20:23],v[148:151]
 buffer_load_dwordx4 v40, s[8:11], s27 offen offset:0 lds
 mf v[132:135],a[0:3],a[20:23],v[132:135]
 tr a[34:35],v44,12288
 rd a[52:55],v56,9216
 mf v[136:139],a[0:3],a[24:27],v[136:139]
 tr a[36:37],v45,8192
 tr a[38:39],v45,12288
 mf v[152:155],a[4:7],a[24:27],v[152:155]
 buffer_load_dwordx4 v40, s[8:11], s27 offen offset:1024 lds
 mf v[156:159],a[4:7],a[28:31],v[156:159]
 rd a[56:59],v56,10240
 tr a[40:41],v46,8192
 mf v[140:143],a[0:3],a[28:31],v[140:143]
 tr a[42:43],v46,12288
 rd a[60:63],v56,11264
 mf v[172:175],a[8:11],a[28:31],v[172:175]
 buffer_load_dwordx4 v40, s[8:11], s27 offen offset:2048 lds
 mf v[188:191],a[12:15],a[28:31],v[188:191]
 tr a[44:45],v47,8192
 tr a[46:47],v47,12288
 mf v[184:187],a[12:15],a[24:27],v[184:187]
 mf v[168:171],a[8:11],a[24:27],v[168:171]
 buffer_load_dwordx4 v40, s[8:11], s27 offen offset:3072 lds
 mf v[164:167],a[8:11],a[20:23],v[164:167]
 s_add_u32 s27, s27, 262144
 mf v[180:183],a[12:15],a[20:23],v[180:183]
 mf v[176:179],a[12:15],a[16:19],v[176:179]
 s_waitcnt vmcnt(16) lgkmcnt(0)
 s_nop 0
 mf v[160:163],a[8:11],a[16:19],v[160:163]
 s_barrier
 s_nop 0
 mf v[128:131],a[32:35],a[48:51],v[128:131]
 rd a[16:19],v56,32768
 tr a[0:1],v44,32768
 mf v[144:147],a[36:39],a[48:51],v[144:147]
 tr a[2:3],v44,36864
 rd a[20:23],v56,33792
 mf v[148:151],a[36:39],a[52:55],v[148:151]
 tr a[4:5],v45,32768
 tr a[6:7],v45,36864
 mf v[132:135],a[32:35],a[52:55],v[132:135]
 rd a[24:27],v56,34816
 tr a[8:9],v46,32768
 mf v[136:139],a[32:35],a[56:59],v[136:139]
 tr a[10:11],v46,36864
 rd a[28:31],v56,35840
 mf v[152:155],a[36:39],a[56:59],v[152:155]
 tr a[12:13],v47,32768
 tr a[14:15],v47,36864
 mf v[156:159],a[36:39],a[60:63],v[156:159]
 mf v[140:143],a[32:35],a[60:63],v[140:143]
 mf v[172:175],a[40:43],a[60:63],v[172:175]
 mf v[188:191],a[44:47],a[60:63],v[188:191]
 mf v[184:187],a[44:47],a[56:59],v[184:187]
 mf v[168:171],a[40:43],a[56:59],v[168:171]
 mf v[164:167],a[40:43],a[52:55],v[164:167]
 mf v[180:183],a[44:47],a[52:55],v[180:183]
 mf v[176:179],a[44:47],a[48:51],v[176:179]
 s_waitcnt lgkmcnt(0)
 s_nop 0
 mf v[160:163],a[40:43],a[48:51],v[160:163]
 mf v[128:131],a[0:3],a[16:19],v[128:131]
 s_mov_b32 s44, s56
 s_mov_b32 s45, s57
 mf v[144:147],a[4:7],a[16:19],v[144:147]
 rd a[48:51],v56,40960
 s_mov_b32 s46, 0x400000
 mf v[148:151],a[4:7],a[20:23],v[148:151]
 tr a[32:33],v44,40960
 s_mov_b32 s47, 0x20000
 mf v[132:135],a[0:3],a[20:23],v[132:135]
 tr a[34:35],v44,45056
 s_add_u32 s25, s85, 0
 s_nop 0
 mf v[136:139],a[0:3],a[24:27],v[136:139]
 buffer_load_dwordx4 v[192:195], v59, s[44:47], s25 offen offset:0
 mf v[152:155],a[4:7],a[24:27],v[152:155]
 rd a[52:55],v56,41984
 tr a[36:37],v45,40960
 mf v[156:159],a[4:7],a[28:31],v[156:159]
 tr a[38:39],v45,45056
 rd a[56:59],v56,43008
 mf v[140:143],a[0:3],a[28:31],v[140:143]
 tr a[40:41],v46,40960
 tr a[42:43],v46,45056
 mf v[172:175],a[8:11],a[28:31],v[172:175]
 rd a[60:63],v56,44032
 tr a[44:45],v47,40960
 mf v[188:191],a[12:15],a[28:31],v[188:191]
 tr a[46:47],v47,45056
 mf v[184:187],a[12:15],a[24:27],v[184:187]
 buffer_load_dwordx4 v[196:199], v59, s[44:47], s25 offen offset:64
 mf v[168:171],a[8:11],a[24:27],v[168:171]
 mf v[164:167],a[8:11],a[20:23],v[164:167]
 mf v[180:183],a[12:15],a[20:23],v[180:183]
 mf v[176:179],a[12:15],a[16:19],v[176:179]
 s_waitcnt vmcnt(10) lgkmcnt(0)
 s_nop 0
 mf v[160:163],a[8:11],a[16:19],v[160:163]
 s_barrier
 s_nop 0
 mf v[128:131],a[32:35],a[48:51],v[128:131]
 rd a[16:19],v57,0
 tr a[0:1],v48,0
 mf v[144:147],a[36:39],a[48:51],v[144:147]
 tr a[2:3],v48,4096
 rd a[20:23],v57,1024
 mf v[148:151],a[36:39],a[52:55],v[148:151]
 tr a[4:5],v49,0
 tr a[6:7],v49,4096
 mf v[132:135],a[32:35],a[52:55],v[132:135]
 rd a[24:27],v57,2048
 s_add_u32 s25, s85, 32768
 mf v[136:139],a[32:35],a[56:59],v[136:139]
 buffer_load_dwordx4 v[200:203], v59, s[44:47], s25 offen offset:0
 mf v[152:155],a[36:39],a[56:59],v[152:155]
 tr a[8:9],v50,0
 tr a[10:11],v50,4096
 mf v[156:159],a[36:39],a[60:63],v[156:159]
 rd a[28:31],v57,3072
 tr a[12:13],v51,0
 mf v[140:143],a[32:35],a[60:63],v[140:143]
 tr a[14:15],v51,4096
 mf v[172:175],a[40:43],a[60:63],v[172:175]
 mf v[188:191],a[44:47],a[60:63],v[188:191]
 mf v[184:187],a[44:47],a[56:59],v[184:187]
 buffer_load_dwordx4 v[204:207], v59, s[44:47], s25 offen offset:64
 mf v[168:171],a[40:43],a[56:59],v[168:171]
 mf v[164:167],a[40:43],a[52:55],v[164:167]
 mf v[180:183],a[44:47],a[52:55],v[180:183]
 mf v[176:179],a[44:47],a[48:51],v[176:179]
 s_waitcnt lgkmcnt(0)
 s_nop 0
 mf v[160:163],a[40:43],a[48:51],v[160:163]
 mf v[128:131],a[0:3],a[16:19],v[128:131]
 rd a[48:51],v57,8192
 tr a[32:33],v48,8192
 mf v[144:147],a[4:7],a[16:19],v[144:147]
 tr a[34:35],v48,12288
 rd a[52:55],v57,9216
 mf v[148:151],a[4:7],a[20:23],v[148:151]
 tr a[36:37],v49,8192
 tr a[38:39],v49,12288
 mf v[132:135],a[0:3],a[20:23],v[132:135]
 rd a[56:59],v57,10240
 s_add_u32 s25, s85, 65536
 mf v[136:139],a[0:3],a[24:27],v[136:139]
 buffer_load_dwordx4 v[208:211], v59, s[44:47], s25 offen offset:0
 mf v[152:155],a[4:7],a[24:27],v[152:155]
 tr a[40:41],v50,8192
 tr a[42:43],v50,12288
 mf v[156:159],a[4:7],a[28:31],v[156:159]
 rd a[60:63],v57,11264
 tr a[44:45],v51,8192
 mf v[140:143],a[0:3],a[28:31],v[140:143]
 tr a[46:47],v51,12288
 mf v[172:175],a[8:11],a[28:31],v[172:175]
 mf v[188:191],a[12:15],a[28:31],v[188:191]
 mf v[184:187],a[12:15],a[24:27],v[184:187]
 buffer_load_dwordx4 v[212:215], v59, s[44:47], s25 offen offset:64
 mf v[168:171],a[8:11],a[24:27],v[168:171]
 mf v[164:167],a[8:11],a[20:23],v[164:167]
 mf v[180:183],a[12:15],a[20:23],v[180:183]
 mf v[176:179],a[12:15],a[16:19],v[176:179]
 s_waitcnt vmcnt(6) lgkmcnt(0)
 s_nop 0
 mf v[160:163],a[8:11],a[16:19],v[160:163]
 s_barrier
 s_nop 0
 mf v[128:131],a[32:35],a[48:51],v[128:131]
 rd a[16:19],v57,32768
 tr a[0:1],v48,32768
 mf v[144:147],a[36:39],a[48:51],v[144:147]
 tr a[2:3],v48,36864
 rd a[20:23],v57,33792
 mf v[148:151],a[36:39],a[52:55],v[148:151]
 tr a[4:5],v49,32768
 tr a[6:7],v49,36864
 mf v[132:135],a[32:35],a[52:55],v[132:135]
 rd a[24:27],v57,34816
 s_add_u32 s25, s85, 98304
 mf v[136:139],a[32:35],a[56:59],v[136:139]
 buffer_load_dwordx4 v[216:219], v59, s[44:47], s25 offen offset:0
 mf v[152:155],a[36:39],a[56:59],v[152:155]
 tr a[8:9],v50,32768
 tr a[10:11],v50,36864
 mf v[156:159],a[36:39],a[60:63],v[156:159]
 rd a[28:31],v57,35840
 tr a[12:13],v51,32768
 mf v[140:143],a[32:35],a[60:63],v[140:143]
 tr a[14:15],v51,36864
 mf v[172:175],a[40:43],a[60:63],v[172:175]
 mf v[188:191],a[44:47],a[60:63],v[188:191]
 mf v[184:187],a[44:47],a[56:59],v[184:187]
 buffer_load_dwordx4 v[220:223], v59, s[44:47], s25 offen offset:64
 mf v[168:171],a[40:43],a[56:59],v[168:171]
 mf v[164:167],a[40:43],a[52:55],v[164:167]
 mf v[180:183],a[44:47],a[52:55],v[180:183]
 mf v[176:179],a[44:47],a[48:51],v[176:179]
 s_waitcnt lgkmcnt(0)
 s_nop 0
 mf v[160:163],a[40:43],a[48:51],v[160:163]
 mf v[128:131],a[0:3],a[16:19],v[128:131]
 rd a[48:51],v57,40960
 tr a[32:33],v48,40960
 mf v[144:147],a[4:7],a[16:19],v[144:147]
 tr a[34:35],v48,45056
 rd a[52:55],v57,41984
 mf v[148:151],a[4:7],a[20:23],v[148:151]
 tr a[36:37],v49,40960
 tr a[38:39],v49,45056
 mf v[132:135],a[0:3],a[20:23],v[132:135]
 rd a[56:59],v57,43008
 tr a[40:41],v50,40960
 mf v[136:139],a[0:3],a[24:27],v[136:139]
 tr a[42:43],v50,45056
 rd a[60:63],v57,44032
 mf v[152:155],a[4:7],a[24:27],v[152:155]
 tr a[44:45],v51,40960
 tr a[46:47],v51,45056
 mf v[156:159],a[4:7],a[28:31],v[156:159]
 mf v[140:143],a[0:3],a[28:31],v[140:143]
 mf v[172:175],a[8:11],a[28:31],v[172:175]
 mf v[188:191],a[12:15],a[28:31],v[188:191]
 mf v[184:187],a[12:15],a[24:27],v[184:187]
 mf v[168:171],a[8:11],a[24:27],v[168:171]
 mf v[164:167],a[8:11],a[20:23],v[164:167]
 mf v[180:183],a[12:15],a[20:23],v[180:183]
 mf v[176:179],a[12:15],a[16:19],v[176:179]
 s_waitcnt lgkmcnt(0)
 s_nop 0
 mf v[160:163],a[8:11],a[16:19],v[160:163]
 mf v[128:131],a[32:35],a[48:51],v[128:131]
 mf v[144:147],a[36:39],a[48:51],v[144:147]
 mf v[148:151],a[36:39],a[52:55],v[148:151]
 mf v[132:135],a[32:35],a[52:55],v[132:135]
 mf v[136:139],a[32:35],a[56:59],v[136:139]
 mf v[152:155],a[36:39],a[56:59],v[152:155]
 mf v[156:159],a[36:39],a[60:63],v[156:159]
 mf v[140:143],a[32:35],a[60:63],v[140:143]
 mf v[172:175],a[40:43],a[60:63],v[172:175]
 mf v[188:191],a[44:47],a[60:63],v[188:191]
 mf v[184:187],a[44:47],a[56:59],v[184:187]
 mf v[168:171],a[40:43],a[56:59],v[168:171]
 mf v[164:167],a[40:43],a[52:55],v[164:167]
 mf v[180:183],a[44:47],a[52:55],v[180:183]
 mf v[176:179],a[44:47],a[48:51],v[176:179]
 mf v[160:163],a[40:43],a[48:51],v[160:163]
 v_min_u32 v5, 1, v1
 v_lshlrev_b32 v5, 3, v5
 buffer_load_dwordx2 v[42:43], v5, s[16:19], s86 offen sc1
 s_add_u32 s12, s32, 0x2800000
 s_addc_u32 s13, s33, 0
 s_nop 0
 s_mov_b32 s14, 0x800000
 s_mov_b32 s15, 0x20000
 s_mov_b32 s8, s76
 s_mov_b32 s9, s77
 s_mov_b32 s10, 0x400000
 s_mov_b32 s11, 0x20000
 v_mov_b32 v8, 0xbfb8aa3b
 v_mov_b32_e64 v9, v8
 v_pk_mul_f32 v[16:17], v[128:129], v[8:9]
 v_pk_mul_f32 v[18:19], v[130:131], v[8:9]
 v_exp_f32 v16, v16
 v_exp_f32 v17, v17
 v_exp_f32 v18, v18
 v_exp_f32 v19, v19
 v_pk_add_f32 v[16:17], v[16:17], 1.0 op_sel_hi:[1,0]
 v_pk_add_f32 v[18:19], v[18:19], 1.0 op_sel_hi:[1,0]
 v_rcp_f32 v16, v16
 v_rcp_f32 v17, v17
 v_rcp_f32 v18, v18
 v_rcp_f32 v19, v19
 v_pk_mul_f32 v[128:129], v[128:129], v[16:17]
 v_pk_mul_f32 v[130:131], v[130:131], v[18:19]
 v_pk_mul_f32 v[20:21], v[132:133], v[8:9]
 v_pk_mul_f32 v[22:23], v[134:135], v[8:9]
 v_exp_f32 v20, v20
 v_exp_f32 v21, v21
 v_exp_f32 v22, v22
 v_exp_f32 v23, v23
 v_pk_add_f32 v[20:21], v[20:21], 1.0 op_sel_hi:[1,0]
 v_pk_add_f32 v[22:23], v[22:23], 1.0 op_sel_hi:[1,0]
 v_rcp_f32 v20, v20
 v_rcp_f32 v21, v21
 v_rcp_f32 v22, v22
 v_rcp_f32 v23, v23
 v_pk_mul_f32 v[132:133], v[132:133], v[20:21]
 v_pk_mul_f32 v[134:135], v[134:135], v[22:23]
 v_pk_mul_f32 v[16:17], v[136:137], v[8:9]
 v_pk_mul_f32 v[18:19], v[138:139], v[8:9]
 v_exp_f32 v16, v16
 v_exp_f32 v17, v17
 v_exp_f32 v18, v18
 v_exp_f32 v19, v19
 v_pk_add_f32 v[16:17], v[16:17], 1.0 op_sel_hi:[1,0]
 v_pk_add_f32 v[18:19], v[18:19], 1.0 op_sel_hi:[1,0]
 v_rcp_f32 v16, v16
 v_rcp_f32 v17, v17
 v_rcp_f32 v18, v18
 v_rcp_f32 v19, v19
 v_pk_mul_f32 v[136:137], v[136:137], v[16:17]
 v_pk_mul_f32 v[138:139], v[138:139], v[18:19]
 v_pk_mul_f32 v[20:21], v[140:141], v[8:9]
 v_pk_mul_f32 v[22:23], v[142:143], v[8:9]
 v_exp_f32 v20, v20
 v_exp_f32 v21, v21
 v_exp_f32 v22, v22
 v_exp_f32 v23, v23
 v_pk_add_f32 v[20:21], v[20:21], 1.0 op_sel_hi:[1,0]
 v_pk_add_f32 v[22:23], v[22:23], 1.0 op_sel_hi:[1,0]
 v_rcp_f32 v20, v20
 v_rcp_f32 v21, v21
 v_rcp_f32 v22, v22
 v_rcp_f32 v23, v23
 v_pk_mul_f32 v[140:141], v[140:141], v[20:21]
 v_pk_mul_f32 v[142:143], v[142:143], v[22:23]
 v_pk_mul_f32 v[16:17], v[144:145], v[8:9]
 v_pk_mul_f32 v[18:19], v[146:147], v[8:9]
 v_exp_f32 v16, v16
 v_exp_f32 v17, v17
 v_exp_f32 v18, v18
 v_exp_f32 v19, v19
 v_pk_add_f32 v[16:17], v[16:17], 1.0 op_sel_hi:[1,0]
 v_pk_add_f32 v[18:19], v[18:19], 1.0 op_sel_hi:[1,0]
 v_rcp_f32 v16, v16
 v_rcp_f32 v17, v17
 v_rcp_f32 v18, v18
 v_rcp_f32 v19, v19
 v_pk_mul_f32 v[144:145], v[144:145], v[16:17]
 v_pk_mul_f32 v[146:147], v[146:147], v[18:19]
 v_pk_mul_f32 v[20:21], v[148:149], v[8:9]
 v_pk_mul_f32 v[22:23], v[150:151], v[8:9]
 v_exp_f32 v20, v20
 v_exp_f32 v21, v21
 v_exp_f32 v22, v22
 v_exp_f32 v23, v23
 v_pk_add_f32 v[20:21], v[20:21], 1.0 op_sel_hi:[1,0]
 v_pk_add_f32 v[22:23], v[22:23], 1.0 op_sel_hi:[1,0]
 v_rcp_f32 v20, v20
 v_rcp_f32 v21, v21
 v_rcp_f32 v22, v22
 v_rcp_f32 v23, v23
 v_pk_mul_f32 v[148:149], v[148:149], v[20:21]
 v_pk_mul_f32 v[150:151], v[150:151], v[22:23]
 v_pk_mul_f32 v[16:17], v[152:153], v[8:9]
 v_pk_mul_f32 v[18:19], v[154:155], v[8:9]
 v_exp_f32 v16, v16
 v_exp_f32 v17, v17
 v_exp_f32 v18, v18
 v_exp_f32 v19, v19
 v_pk_add_f32 v[16:17], v[16:17], 1.0 op_sel_hi:[1,0]
 v_pk_add_f32 v[18:19], v[18:19], 1.0 op_sel_hi:[1,0]
 v_rcp_f32 v16, v16
 v_rcp_f32 v17, v17
 v_rcp_f32 v18, v18
 v_rcp_f32 v19, v19
 v_pk_mul_f32 v[152:153], v[152:153], v[16:17]
 v_pk_mul_f32 v[154:155], v[154:155], v[18:19]
 v_pk_mul_f32 v[20:21], v[156:157], v[8:9]
 v_pk_mul_f32 v[22:23], v[158:159], v[8:9]
 v_exp_f32 v20, v20
 v_exp_f32 v21, v21
 v_exp_f32 v22, v22
 v_exp_f32 v23, v23
 s_branch L_skip_17954
.p2align 12
L_stub_w1_17954:
 s_branch L_walk_z_ret
 s_nop 0
 s_nop 0
 s_nop 0
L_skip_17954:
 v_pk_add_f32 v[20:21], v[20:21], 1.0 op_sel_hi:[1,0]
 v_pk_add_f32 v[22:23], v[22:23], 1.0 op_sel_hi:[1,0]
 v_rcp_f32 v20, v20
 v_rcp_f32 v21, v21
 v_rcp_f32 v22, v22
 v_rcp_f32 v23, v23
 v_pk_mul_f32 v[156:157], v[156:157], v[20:21]
 v_pk_mul_f32 v[158:159], v[158:159], v[22:23]
 s_waitcnt vmcnt(0)
 v_cmp_ne_u64 vcc, s[36:37], v[42:43]
 s_cmp_lg_u64 vcc, 0
 s_cbranch_scc1 L_p_late
 s_add_u32 s25, s87, 0
 s_nop 0
 buffer_load_dwordx4 v[224:227], v40, s[12:15], s25 offen offset:0 sc1
 buffer_load_dwordx4 v[232:235], v40, s[12:15], s25 offen offset:2048 sc1
 s_add_u32 s25, s87, 4096
 buffer_load_dwordx4 v[240:243], v40, s[12:15], s25 offen offset:0 sc1
 buffer_load_dwordx4 v[248:251], v40, s[12:15], s25 offen offset:2048 sc1
 s_add_u32 s25, s87, 4194304
 buffer_load_dwordx4 a[64:67], v40, s[12:15], s25 offen offset:0 sc1
 buffer_load_dwordx4 a[72:75], v40, s[12:15], s25 offen offset:2048 sc1
 s_add_u32 s25, s87, 4198400
 buffer_load_dwordx4 a[80:83], v40, s[12:15], s25 offen offset:0 sc1
 buffer_load_dwordx4 a[88:91], v40, s[12:15], s25 offen offset:2048 sc1
 s_add_u32 s25, s87, 0
 s_nop 0
 buffer_load_dwordx4 v[228:231], v40, s[12:15], s25 offen offset:1024 sc1
 buffer_load_dwordx4 v[236:239], v40, s[12:15], s25 offen offset:3072 sc1
 s_add_u32 s25, s87, 4096
 buffer_load_dwordx4 v[244:247], v40, s[12:15], s25 offen offset:1024 sc1
 buffer_load_dwordx4 v[252:255], v40, s[12:15], s25 offen offset:3072 sc1
 s_add_u32 s25, s87, 4194304
 buffer_load_dwordx4 a[68:71], v40, s[12:15], s25 offen offset:1024 sc1
 buffer_load_dwordx4 a[76:79], v40, s[12:15], s25 offen offset:3072 sc1
 s_add_u32 s25, s87, 4198400
 buffer_load_dwordx4 a[84:87], v40, s[12:15], s25 offen offset:1024 sc1
 buffer_load_dwordx4 a[92:95], v40, s[12:15], s25 offen offset:3072 sc1
 v_pk_mul_f32 v[16:17], v[160:161], v[8:9]
 v_pk_mul_f32 v[18:19], v[162:163], v[8:9]
 v_exp_f32 v16, v16
 v_exp_f32 v17, v17
 v_exp_f32 v18, v18
 v_exp_f32 v19, v19
 v_pk_add_f32 v[16:17], v[16:17], 1.0 op_sel_hi:[1,0]
 v_pk_add_f32 v[18:19], v[18:19], 1.0 op_sel_hi:[1,0]
 v_rcp_f32 v16, v16
 v_rcp_f32 v17, v17
 v_rcp_f32 v18, v18
 v_rcp_f32 v19, v19
 v_pk_mul_f32 v[160:161], v[160:161], v[16:17]
 v_pk_mul_f32 v[162:163], v[162:163], v[18:19]
 v_pk_mul_f32 v[20:21], v[164:165], v[8:9]
 v_pk_mul_f32 v[22:23], v[166:167], v[8:9]
 v_exp_f32 v20, v20
 v_exp_f32 v21, v21
 v_exp_f32 v22, v22
 v_exp_f32 v23, v23
 v_pk_add_f32 v[20:21], v[20:21], 1.0 op_sel_hi:[1,0]
 v_pk_add_f32 v[22:23], v[22:23], 1.0 op_sel_hi:[1,0]
 v_rcp_f32 v20, v20
 v_rcp_f32 v21, v21
 v_rcp_f32 v22, v22
 v_rcp_f32 v23, v23
 v_pk_mul_f32 v[164:165], v[164:165], v[20:21]
 v_pk_mul_f32 v[166:167], v[166:167], v[22:23]
 v_pk_mul_f32 v[16:17], v[168:169], v[8:9]
 v_pk_mul_f32 v[18:19], v[170:171], v[8:9]
 v_exp_f32 v16, v16
 v_exp_f32 v17, v17
 v_exp_f32 v18, v18
 v_exp_f32 v19, v19
 v_pk_add_f32 v[16:17], v[16:17], 1.0 op_sel_hi:[1,0]
 v_pk_add_f32 v[18:19], v[18:19], 1.0 op_sel_hi:[1,0]
 v_rcp_f32 v16, v16
 v_rcp_f32 v17, v17
 v_rcp_f32 v18, v18
 v_rcp_f32 v19, v19
 v_pk_mul_f32 v[168:169], v[168:169], v[16:17]
 v_pk_mul_f32 v[170:171], v[170:171], v[18:19]
 v_pk_mul_f32 v[20:21], v[172:173], v[8:9]
 v_pk_mul_f32 v[22:23], v[174:175], v[8:9]
 v_exp_f32 v20, v20
 v_exp_f32 v21, v21
 v_exp_f32 v22, v22
 v_exp_f32 v23, v23
 v_pk_add_f32 v[20:21], v[20:21], 1.0 op_sel_hi:[1,0]
 v_pk_add_f32 v[22:23], v[22:23], 1.0 op_sel_hi:[1,0]
 v_rcp_f32 v20, v20
 v_rcp_f32 v21, v21
 v_rcp_f32 v22, v22
 v_rcp_f32 v23, v23
 v_pk_mul_f32 v[172:173], v[172:173], v[20:21]
 v_pk_mul_f32 v[174:175], v[174:175], v[22:23]
 v_pk_mul_f32 v[16:17], v[176:177], v[8:9]
 v_pk_mul_f32 v[18:19], v[178:179], v[8:9]
 v_exp_f32 v16, v16
 v_exp_f32 v17, v17
 v_exp_f32 v18, v18
 v_exp_f32 v19, v19
 v_pk_add_f32 v[16:17], v[16:17], 1.0 op_sel_hi:[1,0]
 v_pk_add_f32 v[18:19], v[18:19], 1.0 op_sel_hi:[1,0]
 v_rcp_f32 v16, v16
 v_rcp_f32 v17, v17
 v_rcp_f32 v18, v18
 v_rcp_f32 v19, v19
 v_pk_mul_f32 v[176:177], v[176:177], v[16:17]
 v_pk_mul_f32 v[178:179], v[178:179], v[18:19]
 v_pk_mul_f32 v[20:21], v[180:181], v[8:9]
 v_pk_mul_f32 v[22:23], v[182:183], v[8:9]
 v_exp_f32 v20, v20
 v_exp_f32 v21, v21
 v_exp_f32 v22, v22
 v_exp_f32 v23, v23
 v_pk_add_f32 v[20:21], v[20:21], 1.0 op_sel_hi:[1,0]
 v_pk_add_f32 v[22:23], v[22:23], 1.0 op_sel_hi:[1,0]
 v_rcp_f32 v20, v20
 v_rcp_f32 v21, v21
 v_rcp_f32 v22, v22
 v_rcp_f32 v23, v23
 v_pk_mul_f32 v[180:181], v[180:181], v[20:21]
 v_pk_mul_f32 v[182:183], v[182:183], v[22:23]
 v_pk_mul_f32 v[16:17], v[184:185], v[8:9]
 v_pk_mul_f32 v[18:19], v[186:187], v[8:9]
 v_exp_f32 v16, v16
 v_exp_f32 v17, v17
 v_exp_f32 v18, v18
 v_exp_f32 v19, v19
 v_pk_add_f32 v[16:17], v[16:17], 1.0 op_sel_hi:[1,0]
 v_pk_add_f32 v[18:19], v[18:19], 1.0 op_sel_hi:[1,0]
 v_rcp_f32 v16, v16
 v_rcp_f32 v17, v17
 v_rcp_f32 v18, v18
 v_rcp_f32 v19, v19
 v_pk_mul_f32 v[184:185], v[184:185], v[16:17]
 v_pk_mul_f32 v[186:187], v[186:187], v[18:19]
 v_pk_mul_f32 v[20:21], v[188:189], v[8:9]
 v_pk_mul_f32 v[22:23], v[190:191], v[8:9]
 v_exp_f32 v20, v20
 v_exp_f32 v21, v21
 v_exp_f32 v22, v22
 v_exp_f32 v23, v23
 v_pk_add_f32 v[20:21], v[20:21], 1.0 op_sel_hi:[1,0]
 v_pk_add_f32 v[22:23], v[22:23], 1.0 op_sel_hi:[1,0]
 v_rcp_f32 v20, v20
 v_rcp_f32 v21, v21
 v_rcp_f32 v22, v22
 v_rcp_f32 v23, v23
 v_pk_mul_f32 v[188:189], v[188:189], v[20:21]
 v_pk_mul_f32 v[190:191], v[190:191], v[22:23]
 v_permlane16_swap_b32 v192, v194
 v_permlane16_swap_b32 v193, v195
 v_permlane16_swap_b32 v196, v198
 v_permlane16_swap_b32 v197, v199
 v_permlane16_swap_b32 v200, v202
 v_permlane16_swap_b32 v201, v203
 v_permlane16_swap_b32 v204, v206
 v_permlane16_swap_b32 v205, v207
 v_permlane16_swap_b32 v208, v210
 v_permlane16_swap_b32 v209, v211
 v_permlane16_swap_b32 v212, v214
 v_permlane16_swap_b32 v213, v215
 v_permlane16_swap_b32 v216, v218
 v_permlane16_swap_b32 v217, v219
 v_permlane16_swap_b32 v220, v222
 v_permlane16_swap_b32 v221, v223
 v_lshlrev_b32_e64 v16, 16, v192
 v_and_b32 v17, 0xffff0000, v192
 v_lshlrev_b32_e64 v18, 16, v193
 v_and_b32 v19, 0xffff0000, v193
 v_pk_fma_f32 v[64:65], v[64:65], v[128:129], v[16:17]
 v_pk_fma_f32 v[66:67], v[66:67], v[130:131], v[18:19]
 v_lshlrev_b32_e64 v20, 16, v200
 v_and_b32 v21, 0xffff0000, v200
 v_lshlrev_b32_e64 v22, 16, v201
 v_and_b32 v23, 0xffff0000, v201
 v_pk_fma_f32 v[68:69], v[68:69], v[132:133], v[20:21]
 v_pk_fma_f32 v[70:71], v[70:71], v[134:135], v[22:23]
 v_lshlrev_b32_e64 v16, 16, v208
 v_and_b32 v17, 0xffff0000, v208
 v_lshlrev_b32_e64 v18, 16, v209
 v_and_b32 v19, 0xffff0000, v209
 v_pk_fma_f32 v[72:73], v[72:73], v[136:137], v[16:17]
 v_pk_fma_f32 v[74:75], v[74:75], v[138:139], v[18:19]
 v_lshlrev_b32_e64 v20, 16, v216
 v_and_b32 v21, 0xffff0000, v216
 v_lshlrev_b32_e64 v22, 16, v217
 v_and_b32 v23, 0xffff0000, v217
 v_pk_fma_f32 v[76:77], v[76:77], v[140:141], v[20:21]
 v_pk_fma_f32 v[78:79], v[78:79], v[142:143], v[22:23]
 v_lshlrev_b32_e64 v16, 16, v194
 v_and_b32 v17, 0xffff0000, v194
 v_lshlrev_b32_e64 v18, 16, v195
 v_and_b32 v19, 0xffff0000, v195
 v_pk_fma_f32 v[80:81], v[80:81], v[144:145], v[16:17]
 v_pk_fma_f32 v[82:83], v[82:83], v[146:147], v[18:19]
 v_lshlrev_b32_e64 v20, 16, v202
 v_and_b32 v21, 0xffff0000, v202
 v_lshlrev_b32_e64 v22, 16, v203
 v_and_b32 v23, 0xffff0000, v203
 v_pk_fma_f32 v[84:85], v[84:85], v[148:149], v[20:21]
 v_pk_fma_f32 v[86:87], v[86:87], v[150:151], v[22:23]
 v_lshlrev_b32_e64 v16, 16, v210
 v_and_b32 v17, 0xffff0000, v210
 v_lshlrev_b32_e64 v18, 16, v211
 v_and_b32 v19, 0xffff0000, v211
 v_pk_fma_f32 v[88:89], v[88:89], v[152:153], v[16:17]
 v_pk_fma_f32 v[90:91], v[90:91], v[154:155], v[18:19]
 v_lshlrev_b32_e64 v20, 16, v218
 v_and_b32 v21, 0xffff0000, v218
 v_lshlrev_b32_e64 v22, 16, v219
 v_and_b32 v23, 0xffff0000, v219
 v_pk_fma_f32 v[92:93], v[92:93], v[156:157], v[20:21]
 v_pk_fma_f32 v[94:95], v[94:95], v[158:159], v[22:23]
 v_lshlrev_b32_e64 v16, 16, v196
 v_and_b32 v17, 0xffff0000, v196
 v_lshlrev_b32_e64 v18, 16, v197
 v_and_b32 v19, 0xffff0000, v197
 v_pk_fma_f32 v[96:97], v[96:97], v[160:161], v[16:17]
 v_pk_fma_f32 v[98:99], v[98:99], v[162:163], v[18:19]
 v_lshlrev_b32_e64 v20, 16, v204
 v_and_b32 v21, 0xffff0000, v204
 v_lshlrev_b32_e64 v22, 16, v205
 v_and_b32 v23, 0xffff0000, v205
 v_pk_fma_f32 v[100:101], v[100:101], v[164:165], v[20:21]
 v_pk_fma_f32 v[102:103], v[102:103], v[166:167], v[22:23]
 v_lshlrev_b32_e64 v16, 16, v212
 v_and_b32 v17, 0xffff0000, v212
 v_lshlrev_b32_e64 v18, 16, v213
 v_and_b32 v19, 0xffff0000, v213
 v_pk_fma_f32 v[104:105], v[104:105], v[168:169], v[16:17]
 v_pk_fma_f32 v[106:107], v[106:107], v[170:171], v[18:19]
 v_lshlrev_b32_e64 v20, 16, v220
 v_and_b32 v21, 0xffff0000, v220
 v_lshlrev_b32_e64 v22, 16, v221
 v_and_b32 v23, 0xffff0000, v221
 v_pk_fma_f32 v[108:109], v[108:109], v[172:173], v[20:21]
 v_pk_fma_f32 v[110:111], v[110:111], v[174:175], v[22:23]
 v_lshlrev_b32_e64 v16, 16, v198
 v_and_b32 v17, 0xffff0000, v198
 v_lshlrev_b32_e64 v18, 16, v199
 v_and_b32 v19, 0xffff0000, v199
 v_pk_fma_f32 v[112:113], v[112:113], v[176:177], v[16:17]
 v_pk_fma_f32 v[114:115], v[114:115], v[178:179], v[18:19]
 v_lshlrev_b32_e64 v20, 16, v206
 v_and_b32 v21, 0xffff0000, v206
 v_lshlrev_b32_e64 v22, 16, v207
 v_and_b32 v23, 0xffff0000, v207
 v_pk_fma_f32 v[116:117], v[116:117], v[180:181], v[20:21]
 v_pk_fma_f32 v[118:119], v[118:119], v[182:183], v[22:23]
 v_lshlrev_b32_e64 v16, 16, v214
 v_and_b32 v17, 0xffff0000, v214
 v_lshlrev_b32_e64 v18, 16, v215
 v_and_b32 v19, 0xffff0000, v215
 v_pk_fma_f32 v[120:121], v[120:121], v[184:185], v[16:17]
 v_pk_fma_f32 v[122:123], v[122:123], v[186:187], v[18:19]
 v_lshlrev_b32_e64 v20, 16, v222
 v_and_b32 v21, 0xffff0000, v222
 v_lshlrev_b32_e64 v22, 16, v223
 v_and_b32 v23, 0xffff0000, v223
 v_pk_fma_f32 v[124:125], v[124:125], v[188:189], v[20:21]
 v_pk_fma_f32 v[126:127], v[126:127], v[190:191], v[22:23]
 s_branch L_comb
L_p_late:
 s_nop 0
 v_pk_mul_f32 v[16:17], v[160:161], v[8:9]
 v_pk_mul_f32 v[18:19], v[162:163], v[8:9]
 v_exp_f32 v16, v16
 v_exp_f32 v17, v17
 v_exp_f32 v18, v18
 v_exp_f32 v19, v19
 v_pk_add_f32 v[16:17], v[16:17], 1.0 op_sel_hi:[1,0]
 v_pk_add_f32 v[18:19], v[18:19], 1.0 op_sel_hi:[1,0]
 v_rcp_f32 v16, v16
 v_rcp_f32 v17, v17
 v_rcp_f32 v18, v18
 v_rcp_f32 v19, v19
 v_pk_mul_f32 v[160:161], v[160:161], v[16:17]
 v_pk_mul_f32 v[162:163], v[162:163], v[18:19]
 v_pk_mul_f32 v[20:21], v[164:165], v[8:9]
 v_pk_mul_f32 v[22:23], v[166:167], v[8:9]
 v_exp_f32 v20, v20
 v_exp_f32 v21, v21
 v_exp_f32 v22, v22
 v_exp_f32 v23, v23
 v_pk_add_f32 v[20:21], v[20:21], 1.0 op_sel_hi:[1,0]
 v_pk_add_f32 v[22:23], v[22:23], 1.0 op_sel_hi:[1,0]
 v_rcp_f32 v20, v20
 v_rcp_f32 v21, v21
 v_rcp_f32 v22, v22
 v_rcp_f32 v23, v23
 v_pk_mul_f32 v[164:165], v[164:165], v[20:21]
 v_pk_mul_f32 v[166:167], v[166:167], v[22:23]
 v_pk_mul_f32 v[16:17], v[168:169], v[8:9]
 v_pk_mul_f32 v[18:19], v[170:171], v[8:9]
 v_exp_f32 v16, v16
 v_exp_f32 v17, v17
 v_exp_f32 v18, v18
 v_exp_f32 v19, v19
 v_pk_add_f32 v[16:17], v[16:17], 1.0 op_sel_hi:[1,0]
 v_pk_add_f32 v[18:19], v[18:19], 1.0 op_sel_hi:[1,0]
 v_rcp_f32 v16, v16
 v_rcp_f32 v17, v17
 v_rcp_f32 v18, v18
 v_rcp_f32 v19, v19
 v_pk_mul_f32 v[168:169], v[168:169], v[16:17]
 v_pk_mul_f32 v[170:171], v[170:171], v[18:19]
 v_pk_mul_f32 v[20:21], v[172:173], v[8:9]
 v_pk_mul_f32 v[22:23], v[174:175], v[8:9]
 v_exp_f32 v20, v20
 v_exp_f32 v21, v21
 v_exp_f32 v22, v22
 v_exp_f32 v23, v23
 v_pk_add_f32 v[20:21], v[20:21], 1.0 op_sel_hi:[1,0]
 v_pk_add_f32 v[22:23], v[22:23], 1.0 op_sel_hi:[1,0]
 v_rcp_f32 v20, v20
 v_rcp_f32 v21, v21
 v_rcp_f32 v22, v22
 v_rcp_f32 v23, v23
 v_pk_mul_f32 v[172:173], v[172:173], v[20:21]
 v_pk_mul_f32 v[174:175], v[174:175], v[22:23]
 v_pk_mul_f32 v[16:17], v[176:177], v[8:9]
 v_pk_mul_f32 v[18:19], v[178:179], v[8:9]
 v_exp_f32 v16, v16
 v_exp_f32 v17, v17
 v_exp_f32 v18, v18
 v_exp_f32 v19, v19
 v_pk_add_f32 v[16:17], v[16:17], 1.0 op_sel_hi:[1,0]
 v_pk_add_f32 v[18:19], v[18:19], 1.0 op_sel_hi:[1,0]
 v_rcp_f32 v16, v16
 v_rcp_f32 v17, v17
 v_rcp_f32 v18, v18
 v_rcp_f32 v19, v19
 v_pk_mul_f32 v[176:177], v[176:177], v[16:17]
 v_pk_mul_f32 v[178:179], v[178:179], v[18:19]
 v_pk_mul_f32 v[20:21], v[180:181], v[8:9]
 v_pk_mul_f32 v[22:23], v[182:183], v[8:9]
 v_exp_f32 v20, v20
 v_exp_f32 v21, v21
 v_exp_f32 v22, v22
 v_exp_f32 v23, v23
 v_pk_add_f32 v[20:21], v[20:21], 1.0 op_sel_hi:[1,0]
 v_pk_add_f32 v[22:23], v[22:23], 1.0 op_sel_hi:[1,0]
 v_rcp_f32 v20, v20
 v_rcp_f32 v21, v21
 v_rcp_f32 v22, v22
 v_rcp_f32 v23, v23
 v_pk_mul_f32 v[180:181], v[180:181], v[20:21]
 v_pk_mul_f32 v[182:183], v[182:183], v[22:23]
 v_pk_mul_f32 v[16:17], v[184:185], v[8:9]
 v_pk_mul_f32 v[18:19], v[186:187], v[8:9]
 v_exp_f32 v16, v16
 v_exp_f32 v17, v17
 v_exp_f32 v18, v18
 v_exp_f32 v19, v19
 v_pk_add_f32 v[16:17], v[16:17], 1.0 op_sel_hi:[1,0]
 v_pk_add_f32 v[18:19], v[18:19], 1.0 op_sel_hi:[1,0]
 v_rcp_f32 v16, v16
 v_rcp_f32 v17, v17
 v_rcp_f32 v18, v18
 v_rcp_f32 v19, v19
 v_pk_mul_f32 v[184:185], v[184:185], v[16:17]
 v_pk_mul_f32 v[186:187], v[186:187], v[18:19]
 v_pk_mul_f32 v[20:21], v[188:189], v[8:9]
 v_pk_mul_f32 v[22:23], v[190:191], v[8:9]
 v_exp_f32 v20, v20
 v_exp_f32 v21, v21
 v_exp_f32 v22, v22
 v_exp_f32 v23, v23
 v_pk_add_f32 v[20:21], v[20:21], 1.0 op_sel_hi:[1,0]
 v_pk_add_f32 v[22:23], v[22:23], 1.0 op_sel_hi:[1,0]
 v_rcp_f32 v20, v20
 v_rcp_f32 v21, v21
 v_rcp_f32 v22, v22
 v_rcp_f32 v23, v23
 v_pk_mul_f32 v[188:189], v[188:189], v[20:21]
 v_pk_mul_f32 v[190:191], v[190:191], v[22:23]
 v_permlane16_swap_b32 v192, v194
 v_permlane16_swap_b32 v193, v195
 v_permlane16_swap_b32 v196, v198
 v_permlane16_swap_b32 v197, v199
 v_permlane16_swap_b32 v200, v202
 v_permlane16_swap_b32 v201, v203
 v_permlane16_swap_b32 v204, v206
 v_permlane16_swap_b32 v205, v207
 v_permlane16_swap_b32 v208, v210
 v_permlane16_swap_b32 v209, v211
 v_permlane16_swap_b32 v212, v214
 v_permlane16_swap_b32 v213, v215
 v_permlane16_swap_b32 v216, v218
 v_permlane16_swap_b32 v217, v219
 v_permlane16_swap_b32 v220, v222
 v_permlane16_swap_b32 v221, v223
 v_lshlrev_b32_e64 v16, 16, v192
 v_and_b32 v17, 0xffff0000, v192
 v_lshlrev_b32_e64 v18, 16, v193
 v_and_b32 v19, 0xffff0000, v193
 v_pk_fma_f32 v[64:65], v[64:65], v[128:129], v[16:17]
 v_pk_fma_f32 v[66:67], v[66:67], v[130:131], v[18:19]
 v_lshlrev_b32_e64 v20, 16, v200
 v_and_b32 v21, 0xffff0000, v200
 v_lshlrev_b32_e64 v22, 16, v201
 v_and_b32 v23, 0xffff0000, v201
 v_pk_fma_f32 v[68:69], v[68:69], v[132:133], v[20:21]
 v_pk_fma_f32 v[70:71], v[70:71], v[134:135], v[22:23]
 v_lshlrev_b32_e64 v16, 16, v208
 v_and_b32 v17, 0xffff0000, v208
 v_lshlrev_b32_e64 v18, 16, v209
 v_and_b32 v19, 0xffff0000, v209
 v_pk_fma_f32 v[72:73], v[72:73], v[136:137], v[16:17]
 v_pk_fma_f32 v[74:75], v[74:75], v[138:139], v[18:19]
 v_lshlrev_b32_e64 v20, 16, v216
 v_and_b32 v21, 0xffff0000, v216
 v_lshlrev_b32_e64 v22, 16, v217
 v_and_b32 v23, 0xffff0000, v217
 v_pk_fma_f32 v[76:77], v[76:77], v[140:141], v[20:21]
 v_pk_fma_f32 v[78:79], v[78:79], v[142:143], v[22:23]
 v_lshlrev_b32_e64 v16, 16, v194
 v_and_b32 v17, 0xffff0000, v194
 v_lshlrev_b32_e64 v18, 16, v195
 v_and_b32 v19, 0xffff0000, v195
 v_pk_fma_f32 v[80:81], v[80:81], v[144:145], v[16:17]
 v_pk_fma_f32 v[82:83], v[82:83], v[146:147], v[18:19]
 v_lshlrev_b32_e64 v20, 16, v202
 v_and_b32 v21, 0xffff0000, v202
 v_lshlrev_b32_e64 v22, 16, v203
 v_and_b32 v23, 0xffff0000, v203
 v_pk_fma_f32 v[84:85], v[84:85], v[148:149], v[20:21]
 v_pk_fma_f32 v[86:87], v[86:87], v[150:151], v[22:23]
 v_lshlrev_b32_e64 v16, 16, v210
 v_and_b32 v17, 0xffff0000, v210
 v_lshlrev_b32_e64 v18, 16, v211
 v_and_b32 v19, 0xffff0000, v211
 v_pk_fma_f32 v[88:89], v[88:89], v[152:153], v[16:17]
 v_pk_fma_f32 v[90:91], v[90:91], v[154:155], v[18:19]
 v_lshlrev_b32_e64 v20, 16, v218
 v_and_b32 v21, 0xffff0000, v218
 v_lshlrev_b32_e64 v22, 16, v219
 v_and_b32 v23, 0xffff0000, v219
 v_pk_fma_f32 v[92:93], v[92:93], v[156:157], v[20:21]
 v_pk_fma_f32 v[94:95], v[94:95], v[158:159], v[22:23]
 v_lshlrev_b32_e64 v16, 16, v196
 v_and_b32 v17, 0xffff0000, v196
 v_lshlrev_b32_e64 v18, 16, v197
 v_and_b32 v19, 0xffff0000, v197
 v_pk_fma_f32 v[96:97], v[96:97], v[160:161], v[16:17]
 v_pk_fma_f32 v[98:99], v[98:99], v[162:163], v[18:19]
 v_lshlrev_b32_e64 v20, 16, v204
 v_and_b32 v21, 0xffff0000, v204
 v_lshlrev_b32_e64 v22, 16, v205
 v_and_b32 v23, 0xffff0000, v205
 v_pk_fma_f32 v[100:101], v[100:101], v[164:165], v[20:21]
 v_pk_fma_f32 v[102:103], v[102:103], v[166:167], v[22:23]
 v_lshlrev_b32_e64 v16, 16, v212
 v_and_b32 v17, 0xffff0000, v212
 v_lshlrev_b32_e64 v18, 16, v213
 v_and_b32 v19, 0xffff0000, v213
 v_pk_fma_f32 v[104:105], v[104:105], v[168:169], v[16:17]
 v_pk_fma_f32 v[106:107], v[106:107], v[170:171], v[18:19]
 v_lshlrev_b32_e64 v20, 16, v220
 v_and_b32 v21, 0xffff0000, v220
 v_lshlrev_b32_e64 v22, 16, v221
 v_and_b32 v23, 0xffff0000, v221
 v_pk_fma_f32 v[108:109], v[108:109], v[172:173], v[20:21]
 v_pk_fma_f32 v[110:111], v[110:111], v[174:175], v[22:23]
 v_lshlrev_b32_e64 v16, 16, v198
 v_and_b32 v17, 0xffff0000, v198
 v_lshlrev_b32_e64 v18, 16, v199
 v_and_b32 v19, 0xffff0000, v199
 v_pk_fma_f32 v[112:113], v[112:113], v[176:177], v[16:17]
 v_pk_fma_f32 v[114:115], v[114:115], v[178:179], v[18:19]
 v_lshlrev_b32_e64 v20, 16, v206
 v_and_b32 v21, 0xffff0000, v206
 v_lshlrev_b32_e64 v22, 16, v207
 v_and_b32 v23, 0xffff0000, v207
 v_pk_fma_f32 v[116:117], v[116:117], v[180:181], v[20:21]
 v_pk_fma_f32 v[118:119], v[118:119], v[182:183], v[22:23]
 v_lshlrev_b32_e64 v16, 16, v214
 v_and_b32 v17, 0xffff0000, v214
 v_lshlrev_b32_e64 v18, 16, v215
 v_and_b32 v19, 0xffff0000, v215
 v_pk_fma_f32 v[120:121], v[120:121], v[184:185], v[16:17]
 v_pk_fma_f32 v[122:123], v[122:123], v[186:187], v[18:19]
 v_lshlrev_b32_e64 v20, 16, v222
 v_and_b32 v21, 0xffff0000, v222
 v_lshlrev_b32_e64 v22, 16, v223
 v_and_b32 v23, 0xffff0000, v223
 v_pk_fma_f32 v[124:125], v[124:125], v[188:189], v[20:21]
 v_pk_fma_f32 v[126:127], v[126:127], v[190:191], v[22:23]
 v_min_u32 v5, 1, v1
 v_lshlrev_b32 v5, 3, v5
 s_mov_b32 s80, 0x20000
 s_branch L_poll_35
L_again_36:
 s_sub_u32 s80, s80, 1
 s_cbranch_scc1 L_wt_34
 s_sleep 1
L_poll_35:
 buffer_load_dwordx2 v[6:7], v5, s[16:19], s86 offen sc1
 s_waitcnt vmcnt(0)
 v_cmp_ne_u64 vcc, s[36:37], v[6:7]
 s_cmp_lg_u64 vcc, 0
 s_cbranch_scc1 L_again_36
L_wt_34:
 s_add_u32 s25, s87, 0
 s_nop 0
 buffer_load_dwordx4 v[224:227], v40, s[12:15], s25 offen offset:0 sc1
 buffer_load_dwordx4 v[232:235], v40, s[12:15], s25 offen offset:2048 sc1
 s_add_u32 s25, s87, 4096
 buffer_load_dwordx4 v[240:243], v40, s[12:15], s25 offen offset:0 sc1
 buffer_load_dwordx4 v[248:251], v40, s[12:15], s25 offen offset:2048 sc1
 s_add_u32 s25, s87, 4194304
 buffer_load_dwordx4 a[64:67], v40, s[12:15], s25 offen offset:0 sc1
 buffer_load_dwordx4 a[72:75], v40, s[12:15], s25 offen offset:2048 sc1
 s_add_u32 s25, s87, 4198400
 buffer_load_dwordx4 a[80:83], v40, s[12:15], s25 offen offset:0 sc1
 buffer_load_dwordx4 a[88:91], v40, s[12:15], s25 offen offset:2048 sc1
 s_add_u32 s25, s87, 0
 s_nop 0
 buffer_load_dwordx4 v[228:231], v40, s[12:15], s25 offen offset:1024 sc1
 buffer_load_dwordx4 v[236:239], v40, s[12:15], s25 offen offset:3072 sc1
 s_add_u32 s25, s87, 4096
 buffer_load_dwordx4 v[244:247], v40, s[12:15], s25 offen offset:1024 sc1
 buffer_load_dwordx4 v[252:255], v40, s[12:15], s25 offen offset:3072 sc1
 s_add_u32 s25, s87, 4194304
 buffer_load_dwordx4 a[68:71], v40, s[12:15], s25 offen offset:1024 sc1
 buffer_load_dwordx4 a[76:79], v40, s[12:15], s25 offen offset:3072 sc1
 s_add_u32 s25, s87, 4198400
 buffer_load_dwordx4 a[84:87], v40, s[12:15], s25 offen offset:1024 sc1
 buffer_load_dwordx4 a[92:95], v40, s[12:15], s25 offen offset:3072 sc1
L_comb:
 s_waitcnt vmcnt(8)
 s_add_u32 s31, s85, 0
 ar v32,a64
 ar v33,a65
 ar v34,a72
 ar v35,a73
 v_lshlrev_b32_e64 v8, 16, v224
 v_and_b32 v9, 0xffff0000, v224
 v_lshlrev_b32_e64 v10, 16, v225
 v_and_b32 v11, 0xffff0000, v225
 v_lshlrev_b32_e64 v12, 16, v232
 v_and_b32 v13, 0xffff0000, v232
 v_lshlrev_b32_e64 v14, 16, v233
 v_and_b32 v15, 0xffff0000, v233
 v_lshlrev_b32_e64 v16, 16, v32
 v_and_b32 v17, 0xffff0000, v32
 v_lshlrev_b32_e64 v18, 16, v33
 v_and_b32 v19, 0xffff0000, v33
 v_lshlrev_b32_e64 v20, 16, v34
 v_and_b32 v21, 0xffff0000, v34
 v_lshlrev_b32_e64 v22, 16, v35
 v_and_b32 v23, 0xffff0000, v35
 v_pk_add_f32 v[8:9], v[8:9], v[16:17]
 v_pk_add_f32 v[10:11], v[10:11], v[18:19]
 v_pk_add_f32 v[12:13], v[12:13], v[20:21]
 v_pk_add_f32 v[14:15], v[14:15], v[22:23]
 v_pk_fma_f32 v[64:65], v[8:9], v[128:129], v[64:65]
 v_pk_fma_f32 v[66:67], v[10:11], v[130:131], v[66:67]
 v_pk_fma_f32 v[80:81], v[12:13], v[144:145], v[80:81]
 v_pk_fma_f32 v[82:83], v[14:15], v[146:147], v[82:83]
 v_cvt_pk_bf16_f32 v24, v64, v65
 v_cvt_pk_bf16_f32 v25, v66, v67
 v_cvt_pk_bf16_f32 v26, v80, v81
 v_cvt_pk_bf16_f32 v27, v82, v83
 s_nop 0
 v_permlane16_swap_b32 v24, v26
 v_permlane16_swap_b32_e64 v25, v27
 buffer_store_dwordx4 v[24:27], v59, s[8:11], s31 offen offset:0 sc1
 ar v32,a80
 ar v33,a81
 ar v34,a88
 ar v35,a89
 v_lshlrev_b32_e64 v8, 16, v240
 v_and_b32 v9, 0xffff0000, v240
 v_lshlrev_b32_e64 v10, 16, v241
 v_and_b32 v11, 0xffff0000, v241
 v_lshlrev_b32_e64 v12, 16, v248
 v_and_b32 v13, 0xffff0000, v248
 v_lshlrev_b32_e64 v14, 16, v249
 v_and_b32 v15, 0xffff0000, v249
 v_lshlrev_b32_e64 v16, 16, v32
 v_and_b32 v17, 0xffff0000, v32
 v_lshlrev_b32_e64 v18, 16, v33
 v_and_b32 v19, 0xffff0000, v33
 v_lshlrev_b32_e64 v20, 16, v34
 v_and_b32 v21, 0xffff0000, v34
 v_lshlrev_b32_e64 v22, 16, v35
 v_and_b32 v23, 0xffff0000, v35
 v_pk_add_f32 v[8:9], v[8:9], v[16:17]
 v_pk_add_f32 v[10:11], v[10:11], v[18:19]
 v_pk_add_f32 v[12:13], v[12:13], v[20:21]
 v_pk_add_f32 v[14:15], v[14:15], v[22:23]
 v_pk_fma_f32 v[96:97], v[8:9], v[160:161], v[96:97]
 v_pk_fma_f32 v[98:99], v[10:11], v[162:163], v[98:99]
 v_pk_fma_f32 v[112:113], v[12:13], v[176:177], v[112:113]
 v_pk_fma_f32 v[114:115], v[14:15], v[178:179], v[114:115]
 v_cvt_pk_bf16_f32 v28, v96, v97
 v_cvt_pk_bf16_f32 v29, v98, v99
 v_cvt_pk_bf16_f32 v30, v112, v113
 v_cvt_pk_bf16_f32 v31, v114, v115
 s_nop 0
 v_permlane16_swap_b32 v28, v30
 v_permlane16_swap_b32_e64 v29, v31
 buffer_store_dwordx4 v[28:31], v59, s[8:11], s31 offen offset:64 sc1
 s_add_u32 s31, s85, 32768
 ar v32,a66
 ar v33,a67
 ar v34,a74
 ar v35,a75
 v_lshlrev_b32_e64 v8, 16, v226
 s_branch L_skip_18565
.p2align 12
L_stub_w1_18565:
 s_branch L_walk_z_ret
 s_nop 0
 s_nop 0
 s_nop 0
L_skip_18565:
 v_and_b32 v9, 0xffff0000, v226
 v_lshlrev_b32_e64 v10, 16, v227
 v_and_b32 v11, 0xffff0000, v227
 v_lshlrev_b32_e64 v12, 16, v234
 v_and_b32 v13, 0xffff0000, v234
 v_lshlrev_b32_e64 v14, 16, v235
 v_and_b32 v15, 0xffff0000, v235
 v_lshlrev_b32_e64 v16, 16, v32
 v_and_b32 v17, 0xffff0000, v32
 v_lshlrev_b32_e64 v18, 16, v33
 v_and_b32 v19, 0xffff0000, v33
 v_lshlrev_b32_e64 v20, 16, v34
 v_and_b32 v21, 0xffff0000, v34
 v_lshlrev_b32_e64 v22, 16, v35
 v_and_b32 v23, 0xffff0000, v35
 v_pk_add_f32 v[8:9], v[8:9], v[16:17]
 v_pk_add_f32 v[10:11], v[10:11], v[18:19]
 v_pk_add_f32 v[12:13], v[12:13], v[20:21]
 v_pk_add_f32 v[14:15], v[14:15], v[22:23]
 v_pk_fma_f32 v[68:69], v[8:9], v[132:133], v[68:69]
 v_pk_fma_f32 v[70:71], v[10:11], v[134:135], v[70:71]
 v_pk_fma_f32 v[84:85], v[12:13], v[148:149], v[84:85]
 v_pk_fma_f32 v[86:87], v[14:15], v[150:151], v[86:87]
 v_cvt_pk_bf16_f32 v24, v68, v69
 v_cvt_pk_bf16_f32 v25, v70, v71
 v_cvt_pk_bf16_f32 v26, v84, v85
 v_cvt_pk_bf16_f32 v27, v86, v87
 s_nop 0
 v_permlane16_swap_b32 v24, v26
 v_permlane16_swap_b32_e64 v25, v27
 buffer_store_dwordx4 v[24:27], v59, s[8:11], s31 offen offset:0 sc1
 ar v32,a82
 ar v33,a83
 ar v34,a90
 ar v35,a91
 v_lshlrev_b32_e64 v8, 16, v242
 v_and_b32 v9, 0xffff0000, v242
 v_lshlrev_b32_e64 v10, 16, v243
 v_and_b32 v11, 0xffff0000, v243
 v_lshlrev_b32_e64 v12, 16, v250
 v_and_b32 v13, 0xffff0000, v250
 v_lshlrev_b32_e64 v14, 16, v251
 v_and_b32 v15, 0xffff0000, v251
 v_lshlrev_b32_e64 v16, 16, v32
 v_and_b32 v17, 0xffff0000, v32
 v_lshlrev_b32_e64 v18, 16, v33
 v_and_b32 v19, 0xffff0000, v33
 v_lshlrev_b32_e64 v20, 16, v34
 v_and_b32 v21, 0xffff0000, v34
 v_lshlrev_b32_e64 v22, 16, v35
 v_and_b32 v23, 0xffff0000, v35
 v_pk_add_f32 v[8:9], v[8:9], v[16:17]
 v_pk_add_f32 v[10:11], v[10:11], v[18:19]
 v_pk_add_f32 v[12:13], v[12:13], v[20:21]
 v_pk_add_f32 v[14:15], v[14:15], v[22:23]
 v_pk_fma_f32 v[100:101], v[8:9], v[164:165], v[100:101]
 v_pk_fma_f32 v[102:103], v[10:11], v[166:167], v[102:103]
 v_pk_fma_f32 v[116:117], v[12:13], v[180:181], v[116:117]
 v_pk_fma_f32 v[118:119], v[14:15], v[182:183], v[118:119]
 v_cvt_pk_bf16_f32 v28, v100, v101
 v_cvt_pk_bf16_f32 v29, v102, v103
 v_cvt_pk_bf16_f32 v30, v116, v117
 v_cvt_pk_bf16_f32 v31, v118, v119
 s_nop 0
 v_permlane16_swap_b32 v28, v30
 v_permlane16_swap_b32_e64 v29, v31
 buffer_store_dwordx4 v[28:31], v59, s[8:11], s31 offen offset:64 sc1
 s_waitcnt vmcnt(4)
 s_nop 0
 s_add_u32 s31, s85, 65536
 ar v32,a68
 ar v33,a69
 ar v34,a76
 ar v35,a77
 v_lshlrev_b32_e64 v8, 16, v228
 v_and_b32 v9, 0xffff0000, v228
 v_lshlrev_b32_e64 v10, 16, v229
 v_and_b32 v11, 0xffff0000, v229
 v_lshlrev_b32_e64 v12, 16, v236
 v_and_b32 v13, 0xffff0000, v236
 v_lshlrev_b32_e64 v14, 16, v237
 v_and_b32 v15, 0xffff0000, v237
 v_lshlrev_b32_e64 v16, 16, v32
 v_and_b32 v17, 0xffff0000, v32
 v_lshlrev_b32_e64 v18, 16, v33
 v_and_b32 v19, 0xffff0000, v33
 v_lshlrev_b32_e64 v20, 16, v34
 v_and_b32 v21, 0xffff0000, v34
 v_lshlrev_b32_e64 v22, 16, v35
 v_and_b32 v23, 0xffff0000, v35
 v_pk_add_f32 v[8:9], v[8:9], v[16:17]
 v_pk_add_f32 v[10:11], v[10:11], v[18:19]
 v_pk_add_f32 v[12:13], v[12:13], v[20:21]
 v_pk_add_f32 v[14:15], v[14:15], v[22:23]
 v_pk_fma_f32 v[72:73], v[8:9], v[136:137], v[72:73]
 v_pk_fma_f32 v[74:75], v[10:11], v[138:139], v[74:75]
 v_pk_fma_f32 v[88:89], v[12:13], v[152:153], v[88:89]
 v_pk_fma_f32 v[90:91], v[14:15], v[154:155], v[90:91]
 v_cvt_pk_bf16_f32 v24, v72, v73
 v_cvt_pk_bf16_f32 v25, v74, v75
 v_cvt_pk_bf16_f32 v26, v88, v89
 v_cvt_pk_bf16_f32 v27, v90, v91
 s_nop 0
 v_permlane16_swap_b32 v24, v26
 v_permlane16_swap_b32_e64 v25, v27
 buffer_store_dwordx4 v[24:27], v59, s[8:11], s31 offen offset:0 sc1
 ar v32,a84
 ar v33,a85
 ar v34,a92
 ar v35,a93
 v_lshlrev_b32_e64 v8, 16, v244
 v_and_b32 v9, 0xffff0000, v244
 v_lshlrev_b32_e64 v10, 16, v245
 v_and_b32 v11, 0xffff0000, v245
 v_lshlrev_b32_e64 v12, 16, v252
 v_and_b32 v13, 0xffff0000, v252
 v_lshlrev_b32_e64 v14, 16, v253
 v_and_b32 v15, 0xffff0000, v253
 v_lshlrev_b32_e64 v16, 16, v32
 v_and_b32 v17, 0xffff0000, v32
 v_lshlrev_b32_e64 v18, 16, v33
 v_and_b32 v19, 0xffff0000, v33
 v_lshlrev_b32_e64 v20, 16, v34
 v_and_b32 v21, 0xffff0000, v34
 v_lshlrev_b32_e64 v22, 16, v35
 v_and_b32 v23, 0xffff0000, v35
 v_pk_add_f32 v[8:9], v[8:9], v[16:17]
 v_pk_add_f32 v[10:11], v[10:11], v[18:19]
 v_pk_add_f32 v[12:13], v[12:13], v[20:21]
 v_pk_add_f32 v[14:15], v[14:15], v[22:23]
 v_pk_fma_f32 v[104:105], v[8:9], v[168:169], v[104:105]
 v_pk_fma_f32 v[106:107], v[10:11], v[170:171], v[106:107]
 v_pk_fma_f32 v[120:121], v[12:13], v[184:185], v[120:121]
 v_pk_fma_f32 v[122:123], v[14:15], v[186:187], v[122:123]
 v_cvt_pk_bf16_f32 v28, v104, v105
 v_cvt_pk_bf16_f32 v29, v106, v107
 v_cvt_pk_bf16_f32 v30, v120, v121
 v_cvt_pk_bf16_f32 v31, v122, v123
 s_nop 0
 v_permlane16_swap_b32 v28, v30
 v_permlane16_swap_b32_e64 v29, v31
 buffer_store_dwordx4 v[28:31], v59, s[8:11], s31 offen offset:64 sc1
 s_add_u32 s31, s85, 98304
 ar v32,a70
 ar v33,a71
 ar v34,a78
 ar v35,a79
 v_lshlrev_b32_e64 v8, 16, v230
 v_and_b32 v9, 0xffff0000, v230
 v_lshlrev_b32_e64 v10, 16, v231
 v_and_b32 v11, 0xffff0000, v231
 v_lshlrev_b32_e64 v12, 16, v238
 v_and_b32 v13, 0xffff0000, v238
 v_lshlrev_b32_e64 v14, 16, v239
 v_and_b32 v15, 0xffff0000, v239
 v_lshlrev_b32_e64 v16, 16, v32
 v_and_b32 v17, 0xffff0000, v32
 v_lshlrev_b32_e64 v18, 16, v33
 v_and_b32 v19, 0xffff0000, v33
 v_lshlrev_b32_e64 v20, 16, v34
 v_and_b32 v21, 0xffff0000, v34
 v_lshlrev_b32_e64 v22, 16, v35
 v_and_b32 v23, 0xffff0000, v35
 v_pk_add_f32 v[8:9], v[8:9], v[16:17]
 v_pk_add_f32 v[10:11], v[10:11], v[18:19]
 v_pk_add_f32 v[12:13], v[12:13], v[20:21]
 v_pk_add_f32 v[14:15], v[14:15], v[22:23]
 v_pk_fma_f32 v[76:77], v[8:9], v[140:141], v[76:77]
 v_pk_fma_f32 v[78:79], v[10:11], v[142:143], v[78:79]
 v_pk_fma_f32 v[92:93], v[12:13], v[156:157], v[92:93]
 v_pk_fma_f32 v[94:95], v[14:15], v[158:159], v[94:95]
 v_cvt_pk_bf16_f32 v24, v76, v77
 v_cvt_pk_bf16_f32 v25, v78, v79
 v_cvt_pk_bf16_f32 v26, v92, v93
 v_cvt_pk_bf16_f32 v27, v94, v95
 s_nop 0
 v_permlane16_swap_b32 v24, v26
 v_permlane16_swap_b32_e64 v25, v27
 buffer_store_dwordx4 v[24:27], v59, s[8:11], s31 offen offset:0 sc1
 ar v32,a86
 ar v33,a87
 ar v34,a94
 ar v35,a95
 v_lshlrev_b32_e64 v8, 16, v246
 v_and_b32 v9, 0xffff0000, v246
 v_lshlrev_b32_e64 v10, 16, v247
 v_and_b32 v11, 0xffff0000, v247
 v_lshlrev_b32_e64 v12, 16, v254
 v_and_b32 v13, 0xffff0000, v254
 v_lshlrev_b32_e64 v14, 16, v255
 v_and_b32 v15, 0xffff0000, v255
 v_lshlrev_b32_e64 v16, 16, v32
 v_and_b32 v17, 0xffff0000, v32
 v_lshlrev_b32_e64 v18, 16, v33
 v_and_b32 v19, 0xffff0000, v33
 v_lshlrev_b32_e64 v20, 16, v34
 v_and_b32 v21, 0xffff0000, v34
 v_lshlrev_b32_e64 v22, 16, v35
 v_and_b32 v23, 0xffff0000, v35
 v_pk_add_f32 v[8:9], v[8:9], v[16:17]
 v_pk_add_f32 v[10:11], v[10:11], v[18:19]
 v_pk_add_f32 v[12:13], v[12:13], v[20:21]
 v_pk_add_f32 v[14:15], v[14:15], v[22:23]
 v_pk_fma_f32 v[108:109], v[8:9], v[172:173], v[108:109]
 v_pk_fma_f32 v[110:111], v[10:11], v[174:175], v[110:111]
 v_pk_fma_f32 v[124:125], v[12:13], v[188:189], v[124:125]
 v_pk_fma_f32 v[126:127], v[14:15], v[190:191], v[126:127]
 v_cvt_pk_bf16_f32 v28, v108, v109
 v_cvt_pk_bf16_f32 v29, v110, v111
 v_cvt_pk_bf16_f32 v30, v124, v125
 v_cvt_pk_bf16_f32 v31, v126, v127
 s_nop 0
 v_permlane16_swap_b32 v28, v30
 v_permlane16_swap_b32_e64 v29, v31
 buffer_store_dwordx4 v[28:31], v59, s[8:11], s31 offen offset:64 sc1
L_fin:
 s_endpgm
L_hot_end:
L_att_slow:
 s_waitcnt vmcnt(0)
 s_barrier
 s_mov_b32 s4, s58
 s_mov_b32 s5, s59
 s_nop 0
 s_mov_b32 s6, 0x200000
 s_mov_b32 s7, 0x20000
 s_mov_b32 s8, s60
 s_mov_b32 s9, s61
 s_mov_b32 s10, 0x200000
 s_mov_b32 s11, 0x20000
 s_lshr_b32 s34, s24, 2
 s_lshl_b32 s34, s34, 19
 s_add_u32 s34, s34, 393216
 s_lshl_b32 s31, s20, 4
 v_add_u32 v5, s31, v2
 v_lshlrev_b32 v5, 8, v5
 v_and_b32 v6, 15, v1
 v_add_u32 v7, 0, v2
 v_xor_b32 v61, v7, v6
 v_lshl_add_u32 v8, v61, 4, v5
 v_and_b32 v7, 7, v7
 v_lshlrev_b32 v7, 1, v7
 v_xor_b32_e64 v61, v7, v6
 v_lshl_add_u32 v12, v61, 4, v5
 v_add_u32 v7, 4, v2
 v_xor_b32 v61, v7, v6
 v_lshl_add_u32 v9, v61, 4, v5
 v_and_b32 v7, 7, v7
 v_lshlrev_b32 v7, 1, v7
 v_xor_b32_e64 v61, v7, v6
 v_lshl_add_u32 v13, v61, 4, v5
 v_add_u32 v7, 8, v2
 v_xor_b32 v61, v7, v6
 v_lshl_add_u32 v10, v61, 4, v5
 v_and_b32 v7, 7, v7
 v_lshlrev_b32 v7, 1, v7
 v_xor_b32_e64 v61, v7, v6
 v_lshl_add_u32 v14, v61, 4, v5
 v_add_u32 v7, 12, v2
 v_xor_b32 v61, v7, v6
 v_lshl_add_u32 v11, v61, 4, v5
 v_and_b32 v7, 7, v7
 v_lshlrev_b32 v7, 1, v7
 v_xor_b32_e64 v61, v7, v6
 v_lshl_add_u32 v15, v61, 4, v5
 v_lshrrev_b32 v62, 1, v2
 v_and_b32 v63, 1, v2
 v_and_b32 v6, 15, v1
 v_lshlrev_b32 v61, 8, v6
 v_lshl_add_u32 v61, v63, 3, v61
 v_add_u32 v7, 0, v62
 v_xor_b32 v7, v7, v6
 v_lshl_add_u32 v16, v7, 4, v61
 v_add_u32 v20, 0x10000, v16
 v_add_u32 v7, 4, v62
 v_xor_b32 v7, v7, v6
 v_lshl_add_u32 v17, v7, 4, v61
 v_add_u32 v21, 0x10000, v17
 v_add_u32 v7, 8, v62
 v_xor_b32 v7, v7, v6
 v_lshl_add_u32 v18, v7, 4, v61
 v_add_u32 v22, 0x10000, v18
 v_add_u32 v7, 12, v62
 v_xor_b32 v7, v7, v6
 v_lshl_add_u32 v19, v7, 4, v61
 v_add_u32 v23, 0x10000, v19
 v_lshl_add_u32 v5, v2, 2, v3
 v_and_b32 v7, 7, v5
 v_lshlrev_b32 v5, 8, v5
 v_lshrrev_b32_e64 v61, 1, v4
 v_lshl_add_u32 v5, v61, 4, v5
 v_and_b32_e64 v61, 1, v4
 v_lshl_add_u32 v5, v61, 3, v5
 v_xor_b32_e64 v61, 0, v7
 v_lshl_add_u32 v24, v61, 5, v5
 v_add_u32 v32, 0x10000, v24
 v_xor_b32_e64 v61, 1, v7
 v_lshl_add_u32 v25, v61, 5, v5
 v_add_u32 v33, 0x10000, v25
 v_xor_b32_e64 v61, 2, v7
 v_lshl_add_u32 v26, v61, 5, v5
 v_add_u32 v34, 0x10000, v26
 v_xor_b32_e64 v61, 3, v7
 v_lshl_add_u32 v27, v61, 5, v5
 v_add_u32 v35, 0x10000, v27
 v_xor_b32_e64 v61, 4, v7
 v_lshl_add_u32 v28, v61, 5, v5
 v_add_u32 v36, 0x10000, v28
 v_xor_b32_e64 v61, 5, v7
 v_lshl_add_u32 v29, v61, 5, v5
 v_add_u32 v37, 0x10000, v29
 v_xor_b32_e64 v61, 6, v7
 v_lshl_add_u32 v30, v61, 5, v5
 v_add_u32 v38, 0x10000, v30
 v_xor_b32_e64 v61, 7, v7
 v_lshl_add_u32 v31, v61, 5, v5
 v_add_u32 v39, 0x10000, v31
 v_mov_b32 v40, 0x3f803f80
 v_mov_b32 v41, 0x3f803f80
 v_mov_b32 v42, 0x3f803f80
 v_mov_b32 v43, 0x3f803f80
 v_mov_b32 v144, 0xff800000
 v_mov_b32 v145, 0xff800000
 v_mov_b32 v146, 0xff800000
 v_mov_b32 v147, 0xff800000
 s_mov_b32 s30, 0
L_slow_max_100001:
 s_mov_b32 m0, s29
 s_add_u32 s26, s34, s30
 s_nop 0
 buffer_load_dwordx4 v8, s[4:7], s26 offen offset:0 lds
 buffer_load_dwordx4 v9, s[4:7], s26 offen offset:1024 lds
 buffer_load_dwordx4 v10, s[4:7], s26 offen offset:2048 lds
 buffer_load_dwordx4 v11, s[4:7], s26 offen offset:3072 lds
 s_waitcnt vmcnt(0)
 s_barrier
 v_xor_b32_e64 v224, 32, v16
 ds_read_b64 v[160:161], v16 offset:0
 ds_read_b64 v[162:163], v224 offset:0
 v_xor_b32_e64 v224, 32, v17
 ds_read_b64 v[164:165], v17 offset:0
 ds_read_b64 v[166:167], v224 offset:0
 v_xor_b32_e64 v224, 32, v18
 ds_read_b64 v[168:169], v18 offset:0
 ds_read_b64 v[170:171], v224 offset:0
 v_xor_b32_e64 v224, 32, v19
 ds_read_b64 v[172:173], v19 offset:0
 ds_read_b64 v[174:175], v224 offset:0
 v_xor_b32_e64 v224, 32, v16
 ds_read_b64 v[176:177], v16 offset:4096
 ds_read_b64 v[178:179], v224 offset:4096
 v_xor_b32_e64 v224, 32, v17
 ds_read_b64 v[180:181], v17 offset:4096
 ds_read_b64 v[182:183], v224 offset:4096
 v_xor_b32_e64 v224, 32, v18
 ds_read_b64 v[184:185], v18 offset:4096
 ds_read_b64 v[186:187], v224 offset:4096
 v_xor_b32_e64 v224, 32, v19
 ds_read_b64 v[188:189], v19 offset:4096
 ds_read_b64 v[190:191], v224 offset:4096
 s_waitcnt lgkmcnt(0)
 s_nop 0
 mf v[64:67],v[160:163],a[0:3],0
 mf v[68:71],v[160:163],a[16:19],0
 mf v[72:75],v[160:163],a[32:35],0
 mf v[76:79],v[160:163],a[48:51],0
 mf v[64:67],v[164:167],a[4:7],v[64:67]
 mf v[68:71],v[164:167],a[20:23],v[68:71]
 mf v[72:75],v[164:167],a[36:39],v[72:75]
 mf v[76:79],v[164:167],a[52:55],v[76:79]
 mf v[64:67],v[168:171],a[8:11],v[64:67]
 mf v[68:71],v[168:171],a[24:27],v[68:71]
 mf v[72:75],v[168:171],a[40:43],v[72:75]
 mf v[76:79],v[168:171],a[56:59],v[76:79]
 mf v[64:67],v[172:175],a[12:15],v[64:67]
 mf v[68:71],v[172:175],a[28:31],v[68:71]
 mf v[72:75],v[172:175],a[44:47],v[72:75]
 mf v[76:79],v[172:175],a[60:63],v[76:79]
 mf v[80:83],v[176:179],a[0:3],0
 mf v[84:87],v[176:179],a[16:19],0
 mf v[88:91],v[176:179],a[32:35],0
 mf v[92:95],v[176:179],a[48:51],0
 mf v[80:83],v[180:183],a[4:7],v[80:83]
 mf v[84:87],v[180:183],a[20:23],v[84:87]
 mf v[88:91],v[180:183],a[36:39],v[88:91]
 mf v[92:95],v[180:183],a[52:55],v[92:95]
 mf v[80:83],v[184:187],a[8:11],v[80:83]
 mf v[84:87],v[184:187],a[24:27],v[84:87]
 mf v[88:91],v[184:187],a[40:43],v[88:91]
 mf v[92:95],v[184:187],a[56:59],v[92:95]
 mf v[80:83],v[188:191],a[12:15],v[80:83]
 mf v[84:87],v[188:191],a[28:31],v[84:87]
 mf v[88:91],v[188:191],a[44:47],v[88:91]
 mf v[92:95],v[188:191],a[60:63],v[92:95]
 s_nop 7
 s_nop 1
 v_max3_f32 v144, v144, v64, v65
 v_max3_f32 v144, v144, v66, v67
 v_max3_f32 v144, v144, v80, v81
 v_max3_f32 v144, v144, v82, v83
 v_max3_f32 v145, v145, v68, v69
 v_max3_f32 v145, v145, v70, v71
 v_max3_f32 v145, v145, v84, v85
 v_max3_f32 v145, v145, v86, v87
 v_max3_f32 v146, v146, v72, v73
 v_max3_f32 v146, v146, v74, v75
 v_max3_f32 v146, v146, v88, v89
 v_max3_f32 v146, v146, v90, v91
 v_max3_f32 v147, v147, v76, v77
 v_max3_f32 v147, v147, v78, v79
 v_max3_f32 v147, v147, v92, v93
 v_max3_f32 v147, v147, v94, v95
 v_xor_b32_e64 v224, 32, v16
 ds_read_b64 v[160:161], v16 offset:8192
 ds_read_b64 v[162:163], v224 offset:8192
 v_xor_b32_e64 v224, 32, v17
 ds_read_b64 v[164:165], v17 offset:8192
 ds_read_b64 v[166:167], v224 offset:8192
 v_xor_b32_e64 v224, 32, v18
 ds_read_b64 v[168:169], v18 offset:8192
 ds_read_b64 v[170:171], v224 offset:8192
 v_xor_b32_e64 v224, 32, v19
 ds_read_b64 v[172:173], v19 offset:8192
 ds_read_b64 v[174:175], v224 offset:8192
 v_xor_b32_e64 v224, 32, v16
 ds_read_b64 v[176:177], v16 offset:12288
 ds_read_b64 v[178:179], v224 offset:12288
 v_xor_b32_e64 v224, 32, v17
 ds_read_b64 v[180:181], v17 offset:12288
 ds_read_b64 v[182:183], v224 offset:12288
 v_xor_b32_e64 v224, 32, v18
 ds_read_b64 v[184:185], v18 offset:12288
 ds_read_b64 v[186:187], v224 offset:12288
 v_xor_b32_e64 v224, 32, v19
 ds_read_b64 v[188:189], v19 offset:12288
 ds_read_b64 v[190:191], v224 offset:12288
 s_waitcnt lgkmcnt(0)
 s_nop 0
 mf v[64:67],v[160:163],a[0:3],0
 mf v[68:71],v[160:163],a[16:19],0
 mf v[72:75],v[160:163],a[32:35],0
 mf v[76:79],v[160:163],a[48:51],0
 mf v[64:67],v[164:167],a[4:7],v[64:67]
 mf v[68:71],v[164:167],a[20:23],v[68:71]
 mf v[72:75],v[164:167],a[36:39],v[72:75]
 mf v[76:79],v[164:167],a[52:55],v[76:79]
 mf v[64:67],v[168:171],a[8:11],v[64:67]
 mf v[68:71],v[168:171],a[24:27],v[68:71]
 mf v[72:75],v[168:171],a[40:43],v[72:75]
 mf v[76:79],v[168:171],a[56:59],v[76:79]
 mf v[64:67],v[172:175],a[12:15],v[64:67]
 mf v[68:71],v[172:175],a[28:31],v[68:71]
 mf v[72:75],v[172:175],a[44:47],v[72:75]
 mf v[76:79],v[172:175],a[60:63],v[76:79]
 mf v[80:83],v[176:179],a[0:3],0
 mf v[84:87],v[176:179],a[16:19],0
 mf v[88:91],v[176:179],a[32:35],0
 mf v[92:95],v[176:179],a[48:51],0
 mf v[80:83],v[180:183],a[4:7],v[80:83]
 mf v[84:87],v[180:183],a[20:23],v[84:87]
 mf v[88:91],v[180:183],a[36:39],v[88:91]
 mf v[92:95],v[180:183],a[52:55],v[92:95]
 mf v[80:83],v[184:187],a[8:11],v[80:83]
 mf v[84:87],v[184:187],a[24:27],v[84:87]
 mf v[88:91],v[184:187],a[40:43],v[88:91]
 mf v[92:95],v[184:187],a[56:59],v[92:95]
 mf v[80:83],v[188:191],a[12:15],v[80:83]
 mf v[84:87],v[188:191],a[28:31],v[84:87]
 mf v[88:91],v[188:191],a[44:47],v[88:91]
 mf v[92:95],v[188:191],a[60:63],v[92:95]
 s_nop 7
 s_nop 1
 v_max3_f32 v144, v144, v64, v65
 v_max3_f32 v144, v144, v66, v67
 v_max3_f32 v144, v144, v80, v81
 v_max3_f32 v144, v144, v82, v83
 v_max3_f32 v145, v145, v68, v69
 v_max3_f32 v145, v145, v70, v71
 v_max3_f32 v145, v145, v84, v85
 v_max3_f32 v145, v145, v86, v87
 v_max3_f32 v146, v146, v72, v73
 v_max3_f32 v146, v146, v74, v75
 v_max3_f32 v146, v146, v88, v89
 v_max3_f32 v146, v146, v90, v91
 v_max3_f32 v147, v147, v76, v77
 v_max3_f32 v147, v147, v78, v79
 v_max3_f32 v147, v147, v92, v93
 v_max3_f32 v147, v147, v94, v95
 s_barrier
 s_nop 0
 s_add_u32 s30, s30, 16384
 s_cmp_lt_u32 s30, 131072
 s_cbranch_scc1 L_slow_max_100001
 v_mov_b32 v224, v144
 s_nop 1
 v_permlane16_swap_b32 v144, v224
 s_nop 1
 v_max_f32 v144, v144, v224
 v_mov_b32 v224, v144
 s_nop 1
 v_permlane32_swap_b32 v144, v224
 s_nop 1
 v_max_f32 v144, v144, v224
 v_mov_b32 v224, v145
 s_nop 1
 v_permlane16_swap_b32 v145, v224
 s_nop 1
 v_max_f32 v145, v145, v224
 v_mov_b32 v224, v145
 s_nop 1
 v_permlane32_swap_b32 v145, v224
 s_nop 1
 v_max_f32 v145, v145, v224
 v_mov_b32 v224, v146
 s_nop 1
 v_permlane16_swap_b32 v146, v224
 s_nop 1
 v_max_f32 v146, v146, v224
 v_mov_b32 v224, v146
 s_nop 1
 v_permlane32_swap_b32 v146, v224
 s_nop 1
 v_max_f32 v146, v146, v224
 v_mov_b32 v224, v147
 s_nop 1
 v_permlane16_swap_b32 v147, v224
 s_nop 1
 v_max_f32 v147, v147, v224
 v_mov_b32 v224, v147
 s_nop 1
 v_permlane32_swap_b32 v147, v224
 s_nop 1
 v_max_f32 v147, v147, v224
 v_mov_b32 v44, 0
 v_mov_b32 v45, 0
 v_mov_b32 v46, 0
 v_mov_b32 v47, 0
 v_mov_b32 v48, 0
 v_mov_b32 v49, 0
 v_mov_b32 v50, 0
 v_mov_b32 v51, 0
 v_mov_b32 v52, 0
 v_mov_b32 v53, 0
 v_mov_b32 v54, 0
 v_mov_b32 v55, 0
 v_mov_b32 v56, 0
 v_mov_b32 v57, 0
 v_mov_b32 v58, 0
 v_mov_b32_e64 v59, 0
 v_accvgpr_write_b32 a128, 0
 v_accvgpr_write_b32 a129, 0
 v_accvgpr_write_b32 a130, 0
 v_accvgpr_write_b32 a131, 0
 v_accvgpr_write_b32 a132, 0
 v_accvgpr_write_b32 a133, 0
 v_accvgpr_write_b32 a134, 0
 v_accvgpr_write_b32 a135, 0
 v_accvgpr_write_b32 a136, 0
 v_accvgpr_write_b32 a137, 0
 v_accvgpr_write_b32 a138, 0
 v_accvgpr_write_b32 a139, 0
 v_accvgpr_write_b32 a140, 0
 v_accvgpr_write_b32 a141, 0
 v_accvgpr_write_b32 a142, 0
 v_accvgpr_write_b32 a143, 0
 v_accvgpr_write_b32 a144, 0
 v_accvgpr_write_b32 a145, 0
 v_accvgpr_write_b32 a146, 0
 v_accvgpr_write_b32 a147, 0
 v_accvgpr_write_b32 a148, 0
 v_accvgpr_write_b32 a149, 0
 v_accvgpr_write_b32 a150, 0
 v_accvgpr_write_b32 a151, 0
 v_accvgpr_write_b32 a152, 0
 v_accvgpr_write_b32 a153, 0
 v_accvgpr_write_b32 a154, 0
 v_accvgpr_write_b32 a155, 0
 v_accvgpr_write_b32 a156, 0
 v_accvgpr_write_b32 a157, 0
 v_accvgpr_write_b32 a158, 0
 v_accvgpr_write_b32 a159, 0
 v_accvgpr_write_b32 a160, 0
 v_accvgpr_write_b32 a161, 0
 v_accvgpr_write_b32 a162, 0
 v_accvgpr_write_b32 a163, 0
 v_accvgpr_write_b32 a164, 0
 v_accvgpr_write_b32 a165, 0
 v_accvgpr_write_b32 a166, 0
 v_accvgpr_write_b32 a167, 0
 v_accvgpr_write_b32 a168, 0
 v_accvgpr_write_b32 a169, 0
 v_accvgpr_write_b32 a170, 0
 v_accvgpr_write_b32 a171, 0
 v_accvgpr_write_b32 a172, 0
 v_accvgpr_write_b32 a173, 0
 v_accvgpr_write_b32 a174, 0
 v_accvgpr_write_b32 a175, 0
 v_accvgpr_write_b32 a176, 0
 v_accvgpr_write_b32 a177, 0
 v_accvgpr_write_b32 a178, 0
 v_accvgpr_write_b32 a179, 0
 v_accvgpr_write_b32 a180, 0
 v_accvgpr_write_b32 a181, 0
 v_accvgpr_write_b32 a182, 0
 v_accvgpr_write_b32 a183, 0
 v_accvgpr_write_b32 a184, 0
 v_accvgpr_write_b32 a185, 0
 v_accvgpr_write_b32 a186, 0
 v_accvgpr_write_b32 a187, 0
 v_accvgpr_write_b32 a188, 0
 v_accvgpr_write_b32 a189, 0
 v_accvgpr_write_b32 a190, 0
 v_accvgpr_write_b32 a191, 0
 v_accvgpr_write_b32 a192, 0
 v_accvgpr_write_b32 a193, 0
 v_accvgpr_write_b32 a194, 0
 v_accvgpr_write_b32 a195, 0
 v_accvgpr_write_b32 a196, 0
 v_accvgpr_write_b32 a197, 0
 v_accvgpr_write_b32 a198, 0
 v_accvgpr_write_b32 a199, 0
 v_accvgpr_write_b32 a200, 0
 v_accvgpr_write_b32 a201, 0
 v_accvgpr_write_b32 a202, 0
 v_accvgpr_write_b32 a203, 0
 v_accvgpr_write_b32 a204, 0
 v_accvgpr_write_b32 a205, 0
 v_accvgpr_write_b32 a206, 0
 v_accvgpr_write_b32 a207, 0
 v_accvgpr_write_b32 a208, 0
 v_accvgpr_write_b32 a209, 0
 v_accvgpr_write_b32 a210, 0
 v_accvgpr_write_b32 a211, 0
 v_accvgpr_write_b32 a212, 0
 v_accvgpr_write_b32 a213, 0
 v_accvgpr_write_b32 a214, 0
 v_accvgpr_write_b32 a215, 0
 v_accvgpr_write_b32 a216, 0
 v_accvgpr_write_b32 a217, 0
 v_accvgpr_write_b32 a218, 0
 v_accvgpr_write_b32 a219, 0
 v_accvgpr_write_b32 a220, 0
 v_accvgpr_write_b32 a221, 0
 v_accvgpr_write_b32 a222, 0
 v_accvgpr_write_b32 a223, 0
 v_accvgpr_write_b32 a224, 0
 v_accvgpr_write_b32 a225, 0
 v_accvgpr_write_b32 a226, 0
 v_accvgpr_write_b32 a227, 0
 v_accvgpr_write_b32 a228, 0
 v_accvgpr_write_b32 a229, 0
 v_accvgpr_write_b32 a230, 0
 v_accvgpr_write_b32 a231, 0
 v_accvgpr_write_b32 a232, 0
 v_accvgpr_write_b32 a233, 0
 v_accvgpr_write_b32 a234, 0
 v_accvgpr_write_b32 a235, 0
 v_accvgpr_write_b32 a236, 0
 v_accvgpr_write_b32 a237, 0
 v_accvgpr_write_b32 a238, 0
 v_accvgpr_write_b32 a239, 0
 v_accvgpr_write_b32 a240, 0
 v_accvgpr_write_b32 a241, 0
 v_accvgpr_write_b32 a242, 0
 v_accvgpr_write_b32 a243, 0
 v_accvgpr_write_b32 a244, 0
 v_accvgpr_write_b32 a245, 0
 v_accvgpr_write_b32 a246, 0
 v_accvgpr_write_b32 a247, 0
 v_accvgpr_write_b32 a248, 0
 v_accvgpr_write_b32 a249, 0
 v_accvgpr_write_b32 a250, 0
 v_accvgpr_write_b32 a251, 0
 v_accvgpr_write_b32 a252, 0
 v_accvgpr_write_b32 a253, 0
 v_accvgpr_write_b32 a254, 0
 v_accvgpr_write_b32 a255, 0
 s_mov_b32 s30, 0
L_slow_pv_100002:
 s_mov_b32 m0, s29
 s_add_u32 s26, s34, s30
 s_nop 0
 buffer_load_dwordx4 v8, s[4:7], s26 offen offset:0 lds
 buffer_load_dwordx4 v9, s[4:7], s26 offen offset:1024 lds
 buffer_load_dwordx4 v10, s[4:7], s26 offen offset:2048 lds
 buffer_load_dwordx4 v11, s[4:7], s26 offen offset:3072 lds
 s_add_u32 m0, s29, 16384
 s_nop 0
 s_nop 0
 buffer_load_dwordx4 v12, s[8:11], s26 offen offset:0 lds
 buffer_load_dwordx4 v13, s[8:11], s26 offen offset:1024 lds
 buffer_load_dwordx4 v14, s[8:11], s26 offen offset:2048 lds
 buffer_load_dwordx4 v15, s[8:11], s26 offen offset:3072 lds
 s_waitcnt vmcnt(0)
 s_barrier
 v_xor_b32_e64 v224, 32, v16
 ds_read_b64 v[160:161], v16 offset:0
 ds_read_b64 v[162:163], v224 offset:0
 v_xor_b32_e64 v224, 32, v17
 ds_read_b64 v[164:165], v17 offset:0
 ds_read_b64 v[166:167], v224 offset:0
 v_xor_b32_e64 v224, 32, v18
 ds_read_b64 v[168:169], v18 offset:0
 ds_read_b64 v[170:171], v224 offset:0
 v_xor_b32_e64 v224, 32, v19
 ds_read_b64 v[172:173], v19 offset:0
 ds_read_b64 v[174:175], v224 offset:0
 v_xor_b32_e64 v224, 32, v16
 ds_read_b64 v[176:177], v16 offset:4096
 ds_read_b64 v[178:179], v224 offset:4096
 v_xor_b32_e64 v224, 32, v17
 ds_read_b64 v[180:181], v17 offset:4096
 ds_read_b64 v[182:183], v224 offset:4096
 v_xor_b32_e64 v224, 32, v18
 ds_read_b64 v[184:185], v18 offset:4096
 ds_read_b64 v[186:187], v224 offset:4096
 v_xor_b32_e64 v224, 32, v19
 ds_read_b64 v[188:189], v19 offset:4096
 ds_read_b64 v[190:191], v224 offset:4096
 s_waitcnt lgkmcnt(0)
 s_nop 0
 mf v[64:67],v[160:163],a[0:3],0
 mf v[68:71],v[160:163],a[16:19],0
 mf v[72:75],v[160:163],a[32:35],0
 mf v[76:79],v[160:163],a[48:51],0
 mf v[64:67],v[164:167],a[4:7],v[64:67]
 mf v[68:71],v[164:167],a[20:23],v[68:71]
 mf v[72:75],v[164:167],a[36:39],v[72:75]
 mf v[76:79],v[164:167],a[52:55],v[76:79]
 mf v[64:67],v[168:171],a[8:11],v[64:67]
 mf v[68:71],v[168:171],a[24:27],v[68:71]
 mf v[72:75],v[168:171],a[40:43],v[72:75]
 mf v[76:79],v[168:171],a[56:59],v[76:79]
 mf v[64:67],v[172:175],a[12:15],v[64:67]
 mf v[68:71],v[172:175],a[28:31],v[68:71]
 mf v[72:75],v[172:175],a[44:47],v[72:75]
 mf v[76:79],v[172:175],a[60:63],v[76:79]
 mf v[80:83],v[176:179],a[0:3],0
 mf v[84:87],v[176:179],a[16:19],0
 mf v[88:91],v[176:179],a[32:35],0
 mf v[92:95],v[176:179],a[48:51],0
 mf v[80:83],v[180:183],a[4:7],v[80:83]
 mf v[84:87],v[180:183],a[20:23],v[84:87]
 mf v[88:91],v[180:183],a[36:39],v[88:91]
 mf v[92:95],v[180:183],a[52:55],v[92:95]
 mf v[80:83],v[184:187],a[8:11],v[80:83]
 mf v[84:87],v[184:187],a[24:27],v[84:87]
 mf v[88:91],v[184:187],a[40:43],v[88:91]
 mf v[92:95],v[184:187],a[56:59],v[92:95]
 mf v[80:83],v[188:191],a[12:15],v[80:83]
 mf v[84:87],v[188:191],a[28:31],v[84:87]
 mf v[88:91],v[188:191],a[44:47],v[88:91]
 mf v[92:95],v[188:191],a[60:63],v[92:95]
 s_nop 7
 s_nop 1
 tr v[192:193],v24,16384
 tr v[194:195],v24,20480
 tr v[196:197],v25,16384
 tr v[198:199],v25,20480
 tr v[200:201],v26,16384
 tr v[202:203],v26,20480
 tr v[204:205],v27,16384
 tr v[206:207],v27,20480
 tr v[208:209],v28,16384
 tr v[210:211],v28,20480
 tr v[212:213],v29,16384
 tr v[214:215],v29,20480
 tr v[216:217],v30,16384
 tr v[218:219],v30,20480
 tr v[220:221],v31,16384
 tr v[222:223],v31,20480
 v_sub_f32 v64, v64, v144
 v_sub_f32 v65, v65, v144
 v_sub_f32 v66, v66, v144
 v_sub_f32 v67, v67, v144
 v_exp_f32 v64, v64
 v_exp_f32 v65, v65
 v_exp_f32_e64 v66, v66
 v_exp_f32 v67, v67
 s_nop 0
 v_cvt_pk_bf16_f32 v128, v64, v65
 v_cvt_pk_bf16_f32 v129, v66, v67
 v_sub_f32 v68, v68, v145
 v_sub_f32 v69, v69, v145
 v_sub_f32 v70, v70, v145
 v_sub_f32 v71, v71, v145
 v_exp_f32 v68, v68
 v_exp_f32 v69, v69
 v_exp_f32_e64 v70, v70
 v_exp_f32 v71, v71
 s_nop 0
 v_cvt_pk_bf16_f32 v132, v68, v69
 v_cvt_pk_bf16_f32 v133, v70, v71
 v_sub_f32 v72, v72, v146
 v_sub_f32 v73, v73, v146
 v_sub_f32 v74, v74, v146
 v_sub_f32 v75, v75, v146
 v_exp_f32 v72, v72
 v_exp_f32 v73, v73
 v_exp_f32_e64 v74, v74
 v_exp_f32 v75, v75
 s_nop 0
 v_cvt_pk_bf16_f32 v136, v72, v73
 v_cvt_pk_bf16_f32 v137, v74, v75
 v_sub_f32 v76, v76, v147
 v_sub_f32 v77, v77, v147
 v_sub_f32 v78, v78, v147
 v_sub_f32 v79, v79, v147
 v_exp_f32 v76, v76
 v_exp_f32 v77, v77
 v_exp_f32_e64 v78, v78
 v_exp_f32 v79, v79
 s_nop 0
 v_cvt_pk_bf16_f32 v140, v76, v77
 v_cvt_pk_bf16_f32 v141, v78, v79
 v_sub_f32 v80, v80, v144
 v_sub_f32 v81, v81, v144
 v_sub_f32 v82, v82, v144
 v_sub_f32 v83, v83, v144
 v_exp_f32 v80, v80
 v_exp_f32 v81, v81
 v_exp_f32_e64 v82, v82
 v_exp_f32 v83, v83
 s_nop 0
 v_cvt_pk_bf16_f32 v130, v80, v81
 v_cvt_pk_bf16_f32 v131, v82, v83
 v_sub_f32 v84, v84, v145
 v_sub_f32 v85, v85, v145
 v_sub_f32 v86, v86, v145
 v_sub_f32 v87, v87, v145
 v_exp_f32 v84, v84
 v_exp_f32 v85, v85
 v_exp_f32_e64 v86, v86
 v_exp_f32 v87, v87
 s_nop 0
 v_cvt_pk_bf16_f32 v134, v84, v85
 v_cvt_pk_bf16_f32 v135, v86, v87
 v_sub_f32 v88, v88, v146
 v_sub_f32 v89, v89, v146
 v_sub_f32 v90, v90, v146
 v_sub_f32 v91, v91, v146
 v_exp_f32 v88, v88
 v_exp_f32 v89, v89
 v_exp_f32_e64 v90, v90
 v_exp_f32 v91, v91
 s_nop 0
 v_cvt_pk_bf16_f32 v138, v88, v89
 v_cvt_pk_bf16_f32 v139, v90, v91
 v_sub_f32 v92, v92, v147
 v_sub_f32 v93, v93, v147
 v_sub_f32 v94, v94, v147
 v_sub_f32 v95, v95, v147
 v_exp_f32 v92, v92
 v_exp_f32 v93, v93
 v_exp_f32_e64 v94, v94
 v_exp_f32 v95, v95
 s_nop 0
 v_cvt_pk_bf16_f32 v142, v92, v93
 v_cvt_pk_bf16_f32 v143, v94, v95
 s_waitcnt lgkmcnt(0)
 s_nop 1
 mf a[128:131],v[192:195],v[128:131],a[128:131]
 mf a[132:135],v[192:195],v[132:135],a[132:135]
 mf a[136:139],v[192:195],v[136:139],a[136:139]
 mf a[140:143],v[192:195],v[140:143],a[140:143]
 mf a[144:147],v[196:199],v[128:131],a[144:147]
 mf a[148:151],v[196:199],v[132:135],a[148:151]
 mf a[152:155],v[196:199],v[136:139],a[152:155]
 mf a[156:159],v[196:199],v[140:143],a[156:159]
 mf a[160:163],v[200:203],v[128:131],a[160:163]
 mf a[164:167],v[200:203],v[132:135],a[164:167]
 mf a[168:171],v[200:203],v[136:139],a[168:171]
 mf a[172:175],v[200:203],v[140:143],a[172:175]
 mf a[176:179],v[204:207],v[128:131],a[176:179]
 mf a[180:183],v[204:207],v[132:135],a[180:183]
 mf a[184:187],v[204:207],v[136:139],a[184:187]
 mf a[188:191],v[204:207],v[140:143],a[188:191]
 mf a[192:195],v[208:211],v[128:131],a[192:195]
 mf a[196:199],v[208:211],v[132:135],a[196:199]
 mf a[200:203],v[208:211],v[136:139],a[200:203]
 mf a[204:207],v[208:211],v[140:143],a[204:207]
 mf a[208:211],v[212:215],v[128:131],a[208:211]
 mf a[212:215],v[212:215],v[132:135],a[212:215]
 mf a[216:219],v[212:215],v[136:139],a[216:219]
 mf a[220:223],v[212:215],v[140:143],a[220:223]
 mf a[224:227],v[216:219],v[128:131],a[224:227]
 mf a[228:231],v[216:219],v[132:135],a[228:231]
 mf a[232:235],v[216:219],v[136:139],a[232:235]
 mf a[236:239],v[216:219],v[140:143],a[236:239]
 mf a[240:243],v[220:223],v[128:131],a[240:243]
 mf a[244:247],v[220:223],v[132:135],a[244:247]
 mf a[248:251],v[220:223],v[136:139],a[248:251]
 mf a[252:255],v[220:223],v[140:143],a[252:255]
 mf v[44:47],v[40:43],v[128:131],v[44:47]
 mf v[48:51],v[40:43],v[132:135],v[48:51]
 mf v[52:55],v[40:43],v[136:139],v[52:55]
 mf v[56:59],v[40:43],v[140:143],v[56:59]
 v_xor_b32_e64 v224, 32, v16
 ds_read_b64 v[160:161], v16 offset:8192
 ds_read_b64 v[162:163], v224 offset:8192
 v_xor_b32_e64 v224, 32, v17
 ds_read_b64 v[164:165], v17 offset:8192
 ds_read_b64 v[166:167], v224 offset:8192
 v_xor_b32_e64 v224, 32, v18
 ds_read_b64 v[168:169], v18 offset:8192
 ds_read_b64 v[170:171], v224 offset:8192
 v_xor_b32_e64 v224, 32, v19
 ds_read_b64 v[172:173], v19 offset:8192
 ds_read_b64 v[174:175], v224 offset:8192
 v_xor_b32_e64 v224, 32, v16
 ds_read_b64 v[176:177], v16 offset:12288
 ds_read_b64 v[178:179], v224 offset:12288
 v_xor_b32_e64 v224, 32, v17
 ds_read_b64 v[180:181], v17 offset:12288
 ds_read_b64 v[182:183], v224 offset:12288
 v_xor_b32_e64 v224, 32, v18
 ds_read_b64 v[184:185], v18 offset:12288
 ds_read_b64 v[186:187], v224 offset:12288
 v_xor_b32_e64 v224, 32, v19
 ds_read_b64 v[188:189], v19 offset:12288
 ds_read_b64 v[190:191], v224 offset:12288
 s_waitcnt lgkmcnt(0)
 s_nop 0
 mf v[64:67],v[160:163],a[0:3],0
 mf v[68:71],v[160:163],a[16:19],0
 mf v[72:75],v[160:163],a[32:35],0
 mf v[76:79],v[160:163],a[48:51],0
 mf v[64:67],v[164:167],a[4:7],v[64:67]
 mf v[68:71],v[164:167],a[20:23],v[68:71]
 mf v[72:75],v[164:167],a[36:39],v[72:75]
 mf v[76:79],v[164:167],a[52:55],v[76:79]
 mf v[64:67],v[168:171],a[8:11],v[64:67]
 mf v[68:71],v[168:171],a[24:27],v[68:71]
 mf v[72:75],v[168:171],a[40:43],v[72:75]
 mf v[76:79],v[168:171],a[56:59],v[76:79]
 mf v[64:67],v[172:175],a[12:15],v[64:67]
 mf v[68:71],v[172:175],a[28:31],v[68:71]
 mf v[72:75],v[172:175],a[44:47],v[72:75]
 mf v[76:79],v[172:175],a[60:63],v[76:79]
 mf v[80:83],v[176:179],a[0:3],0
 mf v[84:87],v[176:179],a[16:19],0
 mf v[88:91],v[176:179],a[32:35],0
 mf v[92:95],v[176:179],a[48:51],0
 mf v[80:83],v[180:183],a[4:7],v[80:83]
 mf v[84:87],v[180:183],a[20:23],v[84:87]
 mf v[88:91],v[180:183],a[36:39],v[88:91]
 mf v[92:95],v[180:183],a[52:55],v[92:95]
 mf v[80:83],v[184:187],a[8:11],v[80:83]
 mf v[84:87],v[184:187],a[24:27],v[84:87]
 mf v[88:91],v[184:187],a[40:43],v[88:91]
 mf v[92:95],v[184:187],a[56:59],v[92:95]
 mf v[80:83],v[188:191],a[12:15],v[80:83]
 mf v[84:87],v[188:191],a[28:31],v[84:87]
 mf v[88:91],v[188:191],a[44:47],v[88:91]
 mf v[92:95],v[188:191],a[60:63],v[92:95]
 s_nop 7
 s_nop 1
 tr v[192:193],v24,24576
 tr v[194:195],v24,28672
 tr v[196:197],v25,24576
 tr v[198:199],v25,28672
 tr v[200:201],v26,24576
 tr v[202:203],v26,28672
 tr v[204:205],v27,24576
 tr v[206:207],v27,28672
 tr v[208:209],v28,24576
 tr v[210:211],v28,28672
 tr v[212:213],v29,24576
 tr v[214:215],v29,28672
 tr v[216:217],v30,24576
 tr v[218:219],v30,28672
 tr v[220:221],v31,24576
 tr v[222:223],v31,28672
 v_sub_f32 v64, v64, v144
 v_sub_f32 v65, v65, v144
 v_sub_f32 v66, v66, v144
 v_sub_f32 v67, v67, v144
 v_exp_f32 v64, v64
 v_exp_f32 v65, v65
 v_exp_f32_e64 v66, v66
 v_exp_f32 v67, v67
 s_nop 0
 v_cvt_pk_bf16_f32 v128, v64, v65
 v_cvt_pk_bf16_f32 v129, v66, v67
 v_sub_f32 v68, v68, v145
 v_sub_f32 v69, v69, v145
 v_sub_f32 v70, v70, v145
 v_sub_f32 v71, v71, v145
 v_exp_f32 v68, v68
 v_exp_f32 v69, v69
 v_exp_f32_e64 v70, v70
 v_exp_f32 v71, v71
 s_nop 0
 v_cvt_pk_bf16_f32 v132, v68, v69
 v_cvt_pk_bf16_f32 v133, v70, v71
 v_sub_f32 v72, v72, v146
 v_sub_f32 v73, v73, v146
 v_sub_f32 v74, v74, v146
 v_sub_f32 v75, v75, v146
 v_exp_f32 v72, v72
 v_exp_f32 v73, v73
 v_exp_f32_e64 v74, v74
 v_exp_f32 v75, v75
 s_nop 0
 v_cvt_pk_bf16_f32 v136, v72, v73
 v_cvt_pk_bf16_f32 v137, v74, v75
 v_sub_f32 v76, v76, v147
 v_sub_f32 v77, v77, v147
 v_sub_f32 v78, v78, v147
 v_sub_f32 v79, v79, v147
 v_exp_f32 v76, v76
 v_exp_f32 v77, v77
 v_exp_f32_e64 v78, v78
 v_exp_f32 v79, v79
 s_nop 0
 v_cvt_pk_bf16_f32 v140, v76, v77
 v_cvt_pk_bf16_f32 v141, v78, v79
 v_sub_f32 v80, v80, v144
 v_sub_f32 v81, v81, v144
 v_sub_f32 v82, v82, v144
 v_sub_f32 v83, v83, v144
 v_exp_f32 v80, v80
 v_exp_f32 v81, v81
 v_exp_f32_e64 v82, v82
 v_exp_f32 v83, v83
 s_nop 0
 v_cvt_pk_bf16_f32 v130, v80, v81
 v_cvt_pk_bf16_f32 v131, v82, v83
 v_sub_f32 v84, v84, v145
 v_sub_f32 v85, v85, v145
 v_sub_f32 v86, v86, v145
 v_sub_f32 v87, v87, v145
 v_exp_f32 v84, v84
 v_exp_f32 v85, v85
 v_exp_f32_e64 v86, v86
 v_exp_f32 v87, v87
 s_nop 0
 v_cvt_pk_bf16_f32 v134, v84, v85
 v_cvt_pk_bf16_f32 v135, v86, v87
 v_sub_f32 v88, v88, v146
 v_sub_f32 v89, v89, v146
 v_sub_f32 v90, v90, v146
 v_sub_f32 v91, v91, v146
 v_exp_f32 v88, v88
 v_exp_f32 v89, v89
 v_exp_f32_e64 v90, v90
 v_exp_f32 v91, v91
 s_nop 0
 v_cvt_pk_bf16_f32 v138, v88, v89
 v_cvt_pk_bf16_f32 v139, v90, v91
 v_sub_f32 v92, v92, v147
 v_sub_f32 v93, v93, v147
 v_sub_f32 v94, v94, v147
 v_sub_f32 v95, v95, v147
 v_exp_f32 v92, v92
 v_exp_f32 v93, v93
 v_exp_f32_e64 v94, v94
 v_exp_f32 v95, v95
 s_nop 0
 v_cvt_pk_bf16_f32 v142, v92, v93
 v_cvt_pk_bf16_f32 v143, v94, v95
 s_waitcnt lgkmcnt(0)
 s_nop 1
 mf a[128:131],v[192:195],v[128:131],a[128:131]
 mf a[132:135],v[192:195],v[132:135],a[132:135]
 mf a[136:139],v[192:195],v[136:139],a[136:139]
 mf a[140:143],v[192:195],v[140:143],a[140:143]
 mf a[144:147],v[196:199],v[128:131],a[144:147]
 mf a[148:151],v[196:199],v[132:135],a[148:151]
 mf a[152:155],v[196:199],v[136:139],a[152:155]
 mf a[156:159],v[196:199],v[140:143],a[156:159]
 mf a[160:163],v[200:203],v[128:131],a[160:163]
 mf a[164:167],v[200:203],v[132:135],a[164:167]
 mf a[168:171],v[200:203],v[136:139],a[168:171]
 mf a[172:175],v[200:203],v[140:143],a[172:175]
 mf a[176:179],v[204:207],v[128:131],a[176:179]
 mf a[180:183],v[204:207],v[132:135],a[180:183]
 mf a[184:187],v[204:207],v[136:139],a[184:187]
 mf a[188:191],v[204:207],v[140:143],a[188:191]
 mf a[192:195],v[208:211],v[128:131],a[192:195]
 mf a[196:199],v[208:211],v[132:135],a[196:199]
 mf a[200:203],v[208:211],v[136:139],a[200:203]
 mf a[204:207],v[208:211],v[140:143],a[204:207]
 mf a[208:211],v[212:215],v[128:131],a[208:211]
 mf a[212:215],v[212:215],v[132:135],a[212:215]
 mf a[216:219],v[212:215],v[136:139],a[216:219]
 mf a[220:223],v[212:215],v[140:143],a[220:223]
 mf a[224:227],v[216:219],v[128:131],a[224:227]
 mf a[228:231],v[216:219],v[132:135],a[228:231]
 mf a[232:235],v[216:219],v[136:139],a[232:235]
 mf a[236:239],v[216:219],v[140:143],a[236:239]
 mf a[240:243],v[220:223],v[128:131],a[240:243]
 mf a[244:247],v[220:223],v[132:135],a[244:247]
 mf a[248:251],v[220:223],v[136:139],a[248:251]
 mf a[252:255],v[220:223],v[140:143],a[252:255]
 mf v[44:47],v[40:43],v[128:131],v[44:47]
 mf v[48:51],v[40:43],v[132:135],v[48:51]
 mf v[52:55],v[40:43],v[136:139],v[52:55]
 mf v[56:59],v[40:43],v[140:143],v[56:59]
 s_barrier
 s_nop 0
 s_add_u32 s30, s30, 16384
 s_cmp_lt_u32 s30, 131072
 s_cbranch_scc1 L_slow_pv_100002
 s_nop 7
 s_nop 1
 s_nop 0
 s_mov_b32 s31, 0x33800000
 s_mov_b32 s3, 0x53800000
 v_cmp_nle_f32 vcc, s31, v44
 s_or_b64 s[50:51], s[50:51], vcc
 v_cmp_nge_f32 vcc, s3, v44
 s_or_b64 s[50:51], s[50:51], vcc
 v_rcp_f32 v252, v44
 v_cmp_nle_f32 vcc, s31, v48
 s_or_b64 s[50:51], s[50:51], vcc
 v_cmp_nge_f32 vcc, s3, v48
 s_or_b64 s[50:51], s[50:51], vcc
 v_rcp_f32 v253, v48
 v_cmp_nle_f32 vcc, s31, v52
 s_or_b64 s[50:51], s[50:51], vcc
 v_cmp_nge_f32 vcc, s3, v52
 s_or_b64 s[50:51], s[50:51], vcc
 v_rcp_f32_e64 v254, v52
 v_cmp_nle_f32 vcc, s31, v56
 s_or_b64 s[50:51], s[50:51], vcc
 v_cmp_nge_f32 vcc, s3, v56
 s_or_b64 s[50:51], s[50:51], vcc
 v_rcp_f32 v255, v56
 s_add_u32 s31, s35, 0
 ar v224,a128
 ar v228,a144
 ar v225,a129
 ar v229,a145
 ar v226,a130
 ar v230,a146
 ar v227,a131
 ar v231,a147
 v_pk_mul_f32 v[224:225], v[224:225], v[252:253] op_sel:[0,0] op_sel_hi:[1,0]
 v_pk_mul_f32 v[226:227], v[226:227], v[252:253] op_sel:[0,0] op_sel_hi:[1,0]
 v_pk_mul_f32 v[228:229], v[228:229], v[252:253] op_sel:[0,0] op_sel_hi:[1,0]
 v_pk_mul_f32 v[230:231], v[230:231], v[252:253] op_sel:[0,0] op_sel_hi:[1,0]
 v_cvt_pk_bf16_f32 v232, v224, v225
 v_cvt_pk_bf16_f32 v233, v226, v227
 v_cvt_pk_bf16_f32 v234, v228, v229
 v_cvt_pk_bf16_f32 v235, v230, v231
 buffer_store_dwordx4 v[232:235], v60, s[12:15], s31 offen offset:0 sc1
 ar v236,a132
 ar v240,a148
 ar v237,a133
 ar v241,a149
 ar v238,a134
 ar v242,a150
 ar v239,a135
 ar v243,a151
 v_pk_mul_f32 v[236:237], v[236:237], v[252:253] op_sel:[0,1] op_sel_hi:[1,1]
 v_pk_mul_f32 v[238:239], v[238:239], v[252:253] op_sel:[0,1] op_sel_hi:[1,1]
 v_pk_mul_f32 v[240:241], v[240:241], v[252:253] op_sel:[0,1] op_sel_hi:[1,1]
 v_pk_mul_f32 v[242:243], v[242:243], v[252:253] op_sel:[0,1] op_sel_hi:[1,1]
 v_cvt_pk_bf16_f32 v244, v236, v237
 v_cvt_pk_bf16_f32 v245, v238, v239
 v_cvt_pk_bf16_f32 v246, v240, v241
 v_cvt_pk_bf16_f32 v247, v242, v243
 buffer_store_dwordx4 v[244:247], v60, s[12:15], s31 offen offset:1024 sc1
 ar v224,a136
 ar v228,a152
 ar v225,a137
 ar v229,a153
 ar v226,a138
 ar v230,a154
 ar v227,a139
 ar v231,a155
 v_pk_mul_f32 v[224:225], v[224:225], v[254:255] op_sel:[0,0] op_sel_hi:[1,0]
 v_pk_mul_f32 v[226:227], v[226:227], v[254:255] op_sel:[0,0] op_sel_hi:[1,0]
 v_pk_mul_f32 v[228:229], v[228:229], v[254:255] op_sel:[0,0] op_sel_hi:[1,0]
 v_pk_mul_f32 v[230:231], v[230:231], v[254:255] op_sel:[0,0] op_sel_hi:[1,0]
 v_cvt_pk_bf16_f32 v232, v224, v225
 v_cvt_pk_bf16_f32 v233, v226, v227
 v_cvt_pk_bf16_f32 v234, v228, v229
 v_cvt_pk_bf16_f32 v235, v230, v231
 buffer_store_dwordx4 v[232:235], v60, s[12:15], s31 offen offset:2048 sc1
 ar v236,a140
 ar v240,a156
 ar v237,a141
 ar v241,a157
 ar v238,a142
 ar v242,a158
 ar v239,a143
 ar v243,a159
 v_pk_mul_f32 v[236:237], v[236:237], v[254:255] op_sel:[0,1] op_sel_hi:[1,1]
 v_pk_mul_f32 v[238:239], v[238:239], v[254:255] op_sel:[0,1] op_sel_hi:[1,1]
 v_pk_mul_f32 v[240:241], v[240:241], v[254:255] op_sel:[0,1] op_sel_hi:[1,1]
 v_pk_mul_f32 v[242:243], v[242:243], v[254:255] op_sel:[0,1] op_sel_hi:[1,1]
 v_cvt_pk_bf16_f32 v244, v236, v237
 v_cvt_pk_bf16_f32 v245, v238, v239
 v_cvt_pk_bf16_f32 v246, v240, v241
 v_cvt_pk_bf16_f32 v247, v242, v243
 buffer_store_dwordx4 v[244:247], v60, s[12:15], s31 offen offset:3072 sc1
 s_add_u32 s31, s35, 131072
 ar v224,a160
 ar v228,a176
 ar v225,a161
 ar v229,a177
 ar v226,a162
 ar v230,a178
 ar v227,a163
 ar v231,a179
 v_pk_mul_f32 v[224:225], v[224:225], v[252:253] op_sel:[0,0] op_sel_hi:[1,0]
 v_pk_mul_f32 v[226:227], v[226:227], v[252:253] op_sel:[0,0] op_sel_hi:[1,0]
 v_pk_mul_f32 v[228:229], v[228:229], v[252:253] op_sel:[0,0] op_sel_hi:[1,0]
 v_pk_mul_f32 v[230:231], v[230:231], v[252:253] op_sel:[0,0] op_sel_hi:[1,0]
 v_cvt_pk_bf16_f32 v232, v224, v225
 v_cvt_pk_bf16_f32 v233, v226, v227
 v_cvt_pk_bf16_f32 v234, v228, v229
 v_cvt_pk_bf16_f32 v235, v230, v231
 buffer_store_dwordx4 v[232:235], v60, s[12:15], s31 offen offset:0 sc1
 ar v236,a164
 ar v240,a180
 ar v237,a165
 ar v241,a181
 ar v238,a166
 ar v242,a182
 ar v239,a167
 ar v243,a183
 v_pk_mul_f32 v[236:237], v[236:237], v[252:253] op_sel:[0,1] op_sel_hi:[1,1]
 v_pk_mul_f32 v[238:239], v[238:239], v[252:253] op_sel:[0,1] op_sel_hi:[1,1]
 v_pk_mul_f32 v[240:241], v[240:241], v[252:253] op_sel:[0,1] op_sel_hi:[1,1]
 v_pk_mul_f32 v[242:243], v[242:243], v[252:253] op_sel:[0,1] op_sel_hi:[1,1]
 v_cvt_pk_bf16_f32 v244, v236, v237
 v_cvt_pk_bf16_f32 v245, v238, v239
 v_cvt_pk_bf16_f32 v246, v240, v241
 v_cvt_pk_bf16_f32 v247, v242, v243
 buffer_store_dwordx4 v[244:247], v60, s[12:15], s31 offen offset:1024 sc1
 ar v224,a168
 ar v228,a184
 ar v225,a169
 ar v229,a185
 ar v226,a170
 ar v230,a186
 ar v227,a171
 ar v231,a187
 v_pk_mul_f32 v[224:225], v[224:225], v[254:255] op_sel:[0,0] op_sel_hi:[1,0]
 v_pk_mul_f32 v[226:227], v[226:227], v[254:255] op_sel:[0,0] op_sel_hi:[1,0]
 v_pk_mul_f32 v[228:229], v[228:229], v[254:255] op_sel:[0,0] op_sel_hi:[1,0]
 v_pk_mul_f32 v[230:231], v[230:231], v[254:255] op_sel:[0,0] op_sel_hi:[1,0]
 v_cvt_pk_bf16_f32 v232, v224, v225
 v_cvt_pk_bf16_f32 v233, v226, v227
 v_cvt_pk_bf16_f32 v234, v228, v229
 v_cvt_pk_bf16_f32 v235, v230, v231
 buffer_store_dwordx4 v[232:235], v60, s[12:15], s31 offen offset:2048 sc1
 ar v236,a172
 ar v240,a188
 ar v237,a173
 ar v241,a189
 ar v238,a174
 ar v242,a190
 ar v239,a175
 ar v243,a191
 v_pk_mul_f32 v[236:237], v[236:237], v[254:255] op_sel:[0,1] op_sel_hi:[1,1]
 v_pk_mul_f32 v[238:239], v[238:239], v[254:255] op_sel:[0,1] op_sel_hi:[1,1]
 v_pk_mul_f32 v[240:241], v[240:241], v[254:255] op_sel:[0,1] op_sel_hi:[1,1]
 v_pk_mul_f32 v[242:243], v[242:243], v[254:255] op_sel:[0,1] op_sel_hi:[1,1]
 v_cvt_pk_bf16_f32 v244, v236, v237
 v_cvt_pk_bf16_f32 v245, v238, v239
 v_cvt_pk_bf16_f32 v246, v240, v241
 v_cvt_pk_bf16_f32 v247, v242, v243
 buffer_store_dwordx4 v[244:247], v60, s[12:15], s31 offen offset:3072 sc1
 s_add_u32 s31, s35, 262144
 ar v224,a192
 ar v228,a208
 ar v225,a193
 ar v229,a209
 ar v226,a194
 ar v230,a210
 ar v227,a195
 ar v231,a211
 v_pk_mul_f32 v[224:225], v[224:225], v[252:253] op_sel:[0,0] op_sel_hi:[1,0]
 v_pk_mul_f32 v[226:227], v[226:227], v[252:253] op_sel:[0,0] op_sel_hi:[1,0]
 v_pk_mul_f32 v[228:229], v[228:229], v[252:253] op_sel:[0,0] op_sel_hi:[1,0]
 v_pk_mul_f32 v[230:231], v[230:231], v[252:253] op_sel:[0,0] op_sel_hi:[1,0]
 v_cvt_pk_bf16_f32 v232, v224, v225
 v_cvt_pk_bf16_f32 v233, v226, v227
 v_cvt_pk_bf16_f32 v234, v228, v229
 v_cvt_pk_bf16_f32 v235, v230, v231
 buffer_store_dwordx4 v[232:235], v60, s[12:15], s31 offen offset:0 sc1
 ar v236,a196
 ar v240,a212
 ar v237,a197
 ar v241,a213
 ar v238,a198
 ar v242,a214
 ar v239,a199
 ar v243,a215
 v_pk_mul_f32 v[236:237], v[236:237], v[252:253] op_sel:[0,1] op_sel_hi:[1,1]
 v_pk_mul_f32 v[238:239], v[238:239], v[252:253] op_sel:[0,1] op_sel_hi:[1,1]
 v_pk_mul_f32 v[240:241], v[240:241], v[252:253] op_sel:[0,1] op_sel_hi:[1,1]
 v_pk_mul_f32 v[242:243], v[242:243], v[252:253] op_sel:[0,1] op_sel_hi:[1,1]
 v_cvt_pk_bf16_f32 v244, v236, v237
 v_cvt_pk_bf16_f32 v245, v238, v239
 v_cvt_pk_bf16_f32 v246, v240, v241
 v_cvt_pk_bf16_f32 v247, v242, v243
 buffer_store_dwordx4 v[244:247], v60, s[12:15], s31 offen offset:1024 sc1
 ar v224,a200
 ar v228,a216
 ar v225,a201
 ar v229,a217
 ar v226,a202
 ar v230,a218
 ar v227,a203
 ar v231,a219
 v_pk_mul_f32 v[224:225], v[224:225], v[254:255] op_sel:[0,0] op_sel_hi:[1,0]
 v_pk_mul_f32 v[226:227], v[226:227], v[254:255] op_sel:[0,0] op_sel_hi:[1,0]
 v_pk_mul_f32 v[228:229], v[228:229], v[254:255] op_sel:[0,0] op_sel_hi:[1,0]
 v_pk_mul_f32 v[230:231], v[230:231], v[254:255] op_sel:[0,0] op_sel_hi:[1,0]
 v_cvt_pk_bf16_f32 v232, v224, v225
 v_cvt_pk_bf16_f32 v233, v226, v227
 v_cvt_pk_bf16_f32 v234, v228, v229
 v_cvt_pk_bf16_f32 v235, v230, v231
 buffer_store_dwordx4 v[232:235], v60, s[12:15], s31 offen offset:2048 sc1
 ar v236,a204
 ar v240,a220
 ar v237,a205
 ar v241,a221
 ar v238,a206
 ar v242,a222
 ar v239,a207
 ar v243,a223
 v_pk_mul_f32 v[236:237], v[236:237], v[254:255] op_sel:[0,1] op_sel_hi:[1,1]
 v_pk_mul_f32 v[238:239], v[238:239], v[254:255] op_sel:[0,1] op_sel_hi:[1,1]
 v_pk_mul_f32 v[240:241], v[240:241], v[254:255] op_sel:[0,1] op_sel_hi:[1,1]
 v_pk_mul_f32 v[242:243], v[242:243], v[254:255] op_sel:[0,1] op_sel_hi:[1,1]
 v_cvt_pk_bf16_f32 v244, v236, v237
 v_cvt_pk_bf16_f32 v245, v238, v239
 v_cvt_pk_bf16_f32 v246, v240, v241
 v_cvt_pk_bf16_f32 v247, v242, v243
 buffer_store_dwordx4 v[244:247], v60, s[12:15], s31 offen offset:3072 sc1
 s_add_u32 s31, s35, 393216
 ar v224,a224
 ar v228,a240
 ar v225,a225
 ar v229,a241
 ar v226,a226
 ar v230,a242
 ar v227,a227
 ar v231,a243
 v_pk_mul_f32 v[224:225], v[224:225], v[252:253] op_sel:[0,0] op_sel_hi:[1,0]
 v_pk_mul_f32 v[226:227], v[226:227], v[252:253] op_sel:[0,0] op_sel_hi:[1,0]
 v_pk_mul_f32 v[228:229], v[228:229], v[252:253] op_sel:[0,0] op_sel_hi:[1,0]
 v_pk_mul_f32 v[230:231], v[230:231], v[252:253] op_sel:[0,0] op_sel_hi:[1,0]
 v_cvt_pk_bf16_f32 v232, v224, v225
 v_cvt_pk_bf16_f32 v233, v226, v227
 v_cvt_pk_bf16_f32 v234, v228, v229
 v_cvt_pk_bf16_f32 v235, v230, v231
 buffer_store_dwordx4 v[232:235], v60, s[12:15], s31 offen offset:0 sc1
 ar v236,a228
 ar v240,a244
 ar v237,a229
 ar v241,a245
 ar v238,a230
 ar v242,a246
 ar v239,a231
 ar v243,a247
 v_pk_mul_f32 v[236:237], v[236:237], v[252:253] op_sel:[0,1] op_sel_hi:[1,1]
 v_pk_mul_f32 v[238:239], v[238:239], v[252:253] op_sel:[0,1] op_sel_hi:[1,1]
 v_pk_mul_f32 v[240:241], v[240:241], v[252:253] op_sel:[0,1] op_sel_hi:[1,1]
 v_pk_mul_f32 v[242:243], v[242:243], v[252:253] op_sel:[0,1] op_sel_hi:[1,1]
 v_cvt_pk_bf16_f32 v244, v236, v237
 v_cvt_pk_bf16_f32 v245, v238, v239
 v_cvt_pk_bf16_f32 v246, v240, v241
 v_cvt_pk_bf16_f32 v247, v242, v243
 buffer_store_dwordx4 v[244:247], v60, s[12:15], s31 offen offset:1024 sc1
 ar v224,a232
 ar v228,a248
 ar v225,a233
 ar v229,a249
 ar v226,a234
 ar v230,a250
 ar v227,a235
 ar v231,a251
 v_pk_mul_f32 v[224:225], v[224:225], v[254:255] op_sel:[0,0] op_sel_hi:[1,0]
 v_pk_mul_f32 v[226:227], v[226:227], v[254:255] op_sel:[0,0] op_sel_hi:[1,0]
 v_pk_mul_f32 v[228:229], v[228:229], v[254:255] op_sel:[0,0] op_sel_hi:[1,0]
 v_pk_mul_f32 v[230:231], v[230:231], v[254:255] op_sel:[0,0] op_sel_hi:[1,0]
 v_cvt_pk_bf16_f32 v232, v224, v225
 v_cvt_pk_bf16_f32 v233, v226, v227
 v_cvt_pk_bf16_f32 v234, v228, v229
 v_cvt_pk_bf16_f32 v235, v230, v231
 buffer_store_dwordx4 v[232:235], v60, s[12:15], s31 offen offset:2048 sc1
 ar v236,a236
 ar v240,a252
 ar v237,a237
 ar v241,a253
 ar v238,a238
 ar v242,a254
 ar v239,a239
 ar v243,a255
 v_pk_mul_f32 v[236:237], v[236:237], v[254:255] op_sel:[0,1] op_sel_hi:[1,1]
 v_pk_mul_f32 v[238:239], v[238:239], v[254:255] op_sel:[0,1] op_sel_hi:[1,1]
 v_pk_mul_f32 v[240:241], v[240:241], v[254:255] op_sel:[0,1] op_sel_hi:[1,1]
 v_pk_mul_f32 v[242:243], v[242:243], v[254:255] op_sel:[0,1] op_sel_hi:[1,1]
 v_cvt_pk_bf16_f32 v244, v236, v237
 v_cvt_pk_bf16_f32 v245, v238, v239
 v_cvt_pk_bf16_f32 v246, v240, v241
 v_cvt_pk_bf16_f32 v247, v242, v243
 buffer_store_dwordx4 v[244:247], v60, s[12:15], s31 offen offset:3072 sc1
 v_mov_b32 v144, 0xff800000
 v_mov_b32 v145, 0xff800000
 v_mov_b32 v146, 0xff800000
 v_mov_b32 v147, 0xff800000
 s_mov_b32 s30, 0
L_slow_max_100003:
 s_mov_b32 m0, s29
 s_add_u32 s26, s34, s30
 s_nop 0
 buffer_load_dwordx4 v8, s[4:7], s26 offen offset:0 lds
 buffer_load_dwordx4 v9, s[4:7], s26 offen offset:1024 lds
 buffer_load_dwordx4 v10, s[4:7], s26 offen offset:2048 lds
 buffer_load_dwordx4 v11, s[4:7], s26 offen offset:3072 lds
 s_waitcnt vmcnt(0)
 s_barrier
 v_xor_b32_e64 v224, 32, v16
 ds_read_b64 v[160:161], v16 offset:0
 ds_read_b64 v[162:163], v224 offset:0
 v_xor_b32_e64 v224, 32, v17
 ds_read_b64 v[164:165], v17 offset:0
 ds_read_b64 v[166:167], v224 offset:0
 v_xor_b32_e64 v224, 32, v18
 ds_read_b64 v[168:169], v18 offset:0
 ds_read_b64 v[170:171], v224 offset:0
 v_xor_b32_e64 v224, 32, v19
 ds_read_b64 v[172:173], v19 offset:0
 ds_read_b64 v[174:175], v224 offset:0
 v_xor_b32_e64 v224, 32, v16
 ds_read_b64 v[176:177], v16 offset:4096
 ds_read_b64 v[178:179], v224 offset:4096
 v_xor_b32_e64 v224, 32, v17
 ds_read_b64 v[180:181], v17 offset:4096
 ds_read_b64 v[182:183], v224 offset:4096
 v_xor_b32_e64 v224, 32, v18
 ds_read_b64 v[184:185], v18 offset:4096
 ds_read_b64 v[186:187], v224 offset:4096
 v_xor_b32_e64 v224, 32, v19
 ds_read_b64 v[188:189], v19 offset:4096
 ds_read_b64 v[190:191], v224 offset:4096
 s_waitcnt lgkmcnt(0)
 s_nop 0
 mf v[64:67],v[160:163],a[64:67],0
 mf v[68:71],v[160:163],a[80:83],0
 mf v[72:75],v[160:163],a[96:99],0
 mf v[76:79],v[160:163],a[112:115],0
 mf v[64:67],v[164:167],a[68:71],v[64:67]
 mf v[68:71],v[164:167],a[84:87],v[68:71]
 mf v[72:75],v[164:167],a[100:103],v[72:75]
 mf v[76:79],v[164:167],a[116:119],v[76:79]
 mf v[64:67],v[168:171],a[72:75],v[64:67]
 mf v[68:71],v[168:171],a[88:91],v[68:71]
 mf v[72:75],v[168:171],a[104:107],v[72:75]
 mf v[76:79],v[168:171],a[120:123],v[76:79]
 mf v[64:67],v[172:175],a[76:79],v[64:67]
 mf v[68:71],v[172:175],a[92:95],v[68:71]
 mf v[72:75],v[172:175],a[108:111],v[72:75]
 mf v[76:79],v[172:175],a[124:127],v[76:79]
 mf v[80:83],v[176:179],a[64:67],0
 mf v[84:87],v[176:179],a[80:83],0
 mf v[88:91],v[176:179],a[96:99],0
 mf v[92:95],v[176:179],a[112:115],0
 mf v[80:83],v[180:183],a[68:71],v[80:83]
 mf v[84:87],v[180:183],a[84:87],v[84:87]
 mf v[88:91],v[180:183],a[100:103],v[88:91]
 mf v[92:95],v[180:183],a[116:119],v[92:95]
 mf v[80:83],v[184:187],a[72:75],v[80:83]
 mf v[84:87],v[184:187],a[88:91],v[84:87]
 mf v[88:91],v[184:187],a[104:107],v[88:91]
 mf v[92:95],v[184:187],a[120:123],v[92:95]
 mf v[80:83],v[188:191],a[76:79],v[80:83]
 mf v[84:87],v[188:191],a[92:95],v[84:87]
 mf v[88:91],v[188:191],a[108:111],v[88:91]
 mf v[92:95],v[188:191],a[124:127],v[92:95]
 s_nop 7
 s_nop 1
 v_max3_f32 v144, v144, v64, v65
 v_max3_f32 v144, v144, v66, v67
 v_max3_f32 v144, v144, v80, v81
 v_max3_f32 v144, v144, v82, v83
 v_max3_f32 v145, v145, v68, v69
 v_max3_f32 v145, v145, v70, v71
 v_max3_f32 v145, v145, v84, v85
 v_max3_f32 v145, v145, v86, v87
 v_max3_f32 v146, v146, v72, v73
 v_max3_f32 v146, v146, v74, v75
 v_max3_f32 v146, v146, v88, v89
 v_max3_f32 v146, v146, v90, v91
 v_max3_f32 v147, v147, v76, v77
 v_max3_f32 v147, v147, v78, v79
 v_max3_f32 v147, v147, v92, v93
 v_max3_f32 v147, v147, v94, v95
 v_xor_b32_e64 v224, 32, v16
 ds_read_b64 v[160:161], v16 offset:8192
 ds_read_b64 v[162:163], v224 offset:8192
 v_xor_b32_e64 v224, 32, v17
 ds_read_b64 v[164:165], v17 offset:8192
 ds_read_b64 v[166:167], v224 offset:8192
 v_xor_b32_e64 v224, 32, v18
 ds_read_b64 v[168:169], v18 offset:8192
 ds_read_b64 v[170:171], v224 offset:8192
 v_xor_b32_e64 v224, 32, v19
 ds_read_b64 v[172:173], v19 offset:8192
 ds_read_b64 v[174:175], v224 offset:8192
 v_xor_b32_e64 v224, 32, v16
 ds_read_b64 v[176:177], v16 offset:12288
 ds_read_b64 v[178:179], v224 offset:12288
 v_xor_b32_e64 v224, 32, v17
 ds_read_b64 v[180:181], v17 offset:12288
 ds_read_b64 v[182:183], v224 offset:12288
 v_xor_b32_e64 v224, 32, v18
 ds_read_b64 v[184:185], v18 offset:12288
 ds_read_b64 v[186:187], v224 offset:12288
 v_xor_b32_e64 v224, 32, v19
 ds_read_b64 v[188:189], v19 offset:12288
 ds_read_b64 v[190:191], v224 offset:12288
 s_waitcnt lgkmcnt(0)
 s_nop 0
 mf v[64:67],v[160:163],a[64:67],0
 mf v[68:71],v[160:163],a[80:83],0
 mf v[72:75],v[160:163],a[96:99],0
 mf v[76:79],v[160:163],a[112:115],0
 mf v[64:67],v[164:167],a[68:71],v[64:67]
 mf v[68:71],v[164:167],a[84:87],v[68:71]
 mf v[72:75],v[164:167],a[100:103],v[72:75]
 mf v[76:79],v[164:167],a[116:119],v[76:79]
 mf v[64:67],v[168:171],a[72:75],v[64:67]
 mf v[68:71],v[168:171],a[88:91],v[68:71]
 mf v[72:75],v[168:171],a[104:107],v[72:75]
 mf v[76:79],v[168:171],a[120:123],v[76:79]
 mf v[64:67],v[172:175],a[76:79],v[64:67]
 mf v[68:71],v[172:175],a[92:95],v[68:71]
 mf v[72:75],v[172:175],a[108:111],v[72:75]
 mf v[76:79],v[172:175],a[124:127],v[76:79]
 mf v[80:83],v[176:179],a[64:67],0
 mf v[84:87],v[176:179],a[80:83],0
 mf v[88:91],v[176:179],a[96:99],0
 mf v[92:95],v[176:179],a[112:115],0
 mf v[80:83],v[180:183],a[68:71],v[80:83]
 mf v[84:87],v[180:183],a[84:87],v[84:87]
 mf v[88:91],v[180:183],a[100:103],v[88:91]
 mf v[92:95],v[180:183],a[116:119],v[92:95]
 mf v[80:83],v[184:187],a[72:75],v[80:83]
 mf v[84:87],v[184:187],a[88:91],v[84:87]
 mf v[88:91],v[184:187],a[104:107],v[88:91]
 mf v[92:95],v[184:187],a[120:123],v[92:95]
 mf v[80:83],v[188:191],a[76:79],v[80:83]
 mf v[84:87],v[188:191],a[92:95],v[84:87]
 mf v[88:91],v[188:191],a[108:111],v[88:91]
 mf v[92:95],v[188:191],a[124:127],v[92:95]
 s_nop 7
 s_nop 1
 v_max3_f32 v144, v144, v64, v65
 v_max3_f32 v144, v144, v66, v67
 v_max3_f32 v144, v144, v80, v81
 v_max3_f32 v144, v144, v82, v83
 v_max3_f32 v145, v145, v68, v69
 v_max3_f32 v145, v145, v70, v71
 v_max3_f32 v145, v145, v84, v85
 v_max3_f32 v145, v145, v86, v87
 v_max3_f32 v146, v146, v72, v73
 v_max3_f32 v146, v146, v74, v75
 v_max3_f32 v146, v146, v88, v89
 v_max3_f32 v146, v146, v90, v91
 v_max3_f32 v147, v147, v76, v77
 v_max3_f32 v147, v147, v78, v79
 v_max3_f32 v147, v147, v92, v93
 v_max3_f32 v147, v147, v94, v95
 s_barrier
 s_nop 0
 s_add_u32 s30, s30, 16384
 s_cmp_lt_u32 s30, 131072
 s_cbranch_scc1 L_slow_max_100003
 v_mov_b32 v224, v144
 s_nop 1
 v_permlane16_swap_b32 v144, v224
 s_nop 1
 v_max_f32 v144, v144, v224
 v_mov_b32 v224, v144
 s_nop 1
 v_permlane32_swap_b32 v144, v224
 s_nop 1
 v_max_f32 v144, v144, v224
 v_mov_b32 v224, v145
 s_nop 1
 v_permlane16_swap_b32 v145, v224
 s_nop 1
 v_max_f32 v145, v145, v224
 v_mov_b32 v224, v145
 s_nop 1
 v_permlane32_swap_b32 v145, v224
 s_nop 1
 v_max_f32 v145, v145, v224
 v_mov_b32 v224, v146
 s_nop 1
 v_permlane16_swap_b32 v146, v224
 s_nop 1
 v_max_f32 v146, v146, v224
 v_mov_b32 v224, v146
 s_nop 1
 v_permlane32_swap_b32 v146, v224
 s_nop 1
 v_max_f32 v146, v146, v224
 v_mov_b32 v224, v147
 s_nop 1
 v_permlane16_swap_b32 v147, v224
 s_nop 1
 v_max_f32 v147, v147, v224
 v_mov_b32 v224, v147
 s_nop 1
 v_permlane32_swap_b32 v147, v224
 s_nop 1
 v_max_f32 v147, v147, v224
 v_mov_b32 v44, 0
 v_mov_b32 v45, 0
 v_mov_b32 v46, 0
 v_mov_b32 v47, 0
 v_mov_b32 v48, 0
 v_mov_b32 v49, 0
 v_mov_b32 v50, 0
 v_mov_b32 v51, 0
 v_mov_b32 v52, 0
 v_mov_b32 v53, 0
 v_mov_b32 v54, 0
 v_mov_b32 v55, 0
 v_mov_b32 v56, 0
 v_mov_b32 v57, 0
 v_mov_b32 v58, 0
 v_mov_b32_e64 v59, 0
 v_accvgpr_write_b32 a128, 0
 v_accvgpr_write_b32 a129, 0
 v_accvgpr_write_b32 a130, 0
 v_accvgpr_write_b32 a131, 0
 v_accvgpr_write_b32 a132, 0
 v_accvgpr_write_b32 a133, 0
 v_accvgpr_write_b32 a134, 0
 v_accvgpr_write_b32 a135, 0
 v_accvgpr_write_b32 a136, 0
 v_accvgpr_write_b32 a137, 0
 v_accvgpr_write_b32 a138, 0
 v_accvgpr_write_b32 a139, 0
 v_accvgpr_write_b32 a140, 0
 v_accvgpr_write_b32 a141, 0
 v_accvgpr_write_b32 a142, 0
 v_accvgpr_write_b32 a143, 0
 v_accvgpr_write_b32 a144, 0
 v_accvgpr_write_b32 a145, 0
 v_accvgpr_write_b32 a146, 0
 v_accvgpr_write_b32 a147, 0
 v_accvgpr_write_b32 a148, 0
 v_accvgpr_write_b32 a149, 0
 v_accvgpr_write_b32 a150, 0
 v_accvgpr_write_b32 a151, 0
 v_accvgpr_write_b32 a152, 0
 v_accvgpr_write_b32 a153, 0
 v_accvgpr_write_b32 a154, 0
 v_accvgpr_write_b32 a155, 0
 v_accvgpr_write_b32 a156, 0
 v_accvgpr_write_b32 a157, 0
 v_accvgpr_write_b32 a158, 0
 v_accvgpr_write_b32 a159, 0
 v_accvgpr_write_b32 a160, 0
 v_accvgpr_write_b32 a161, 0
 v_accvgpr_write_b32 a162, 0
 v_accvgpr_write_b32 a163, 0
 v_accvgpr_write_b32 a164, 0
 v_accvgpr_write_b32 a165, 0
 v_accvgpr_write_b32 a166, 0
 v_accvgpr_write_b32 a167, 0
 v_accvgpr_write_b32 a168, 0
 v_accvgpr_write_b32 a169, 0
 v_accvgpr_write_b32 a170, 0
 v_accvgpr_write_b32 a171, 0
 v_accvgpr_write_b32 a172, 0
 v_accvgpr_write_b32 a173, 0
 v_accvgpr_write_b32 a174, 0
 v_accvgpr_write_b32 a175, 0
 v_accvgpr_write_b32 a176, 0
 v_accvgpr_write_b32 a177, 0
 v_accvgpr_write_b32 a178, 0
 v_accvgpr_write_b32 a179, 0
 v_accvgpr_write_b32 a180, 0
 v_accvgpr_write_b32 a181, 0
 v_accvgpr_write_b32 a182, 0
 v_accvgpr_write_b32 a183, 0
 v_accvgpr_write_b32 a184, 0
 v_accvgpr_write_b32 a185, 0
 v_accvgpr_write_b32 a186, 0
 v_accvgpr_write_b32 a187, 0
 v_accvgpr_write_b32 a188, 0
 v_accvgpr_write_b32 a189, 0
 v_accvgpr_write_b32 a190, 0
 v_accvgpr_write_b32 a191, 0
 v_accvgpr_write_b32 a192, 0
 v_accvgpr_write_b32 a193, 0
 v_accvgpr_write_b32 a194, 0
 v_accvgpr_write_b32 a195, 0
 v_accvgpr_write_b32 a196, 0
 v_accvgpr_write_b32 a197, 0
 v_accvgpr_write_b32 a198, 0
 v_accvgpr_write_b32 a199, 0
 v_accvgpr_write_b32 a200, 0
 v_accvgpr_write_b32 a201, 0
 v_accvgpr_write_b32 a202, 0
 v_accvgpr_write_b32 a203, 0
 v_accvgpr_write_b32 a204, 0
 v_accvgpr_write_b32 a205, 0
 v_accvgpr_write_b32 a206, 0
 v_accvgpr_write_b32 a207, 0
 v_accvgpr_write_b32 a208, 0
 v_accvgpr_write_b32 a209, 0
 v_accvgpr_write_b32 a210, 0
 v_accvgpr_write_b32 a211, 0
 v_accvgpr_write_b32 a212, 0
 v_accvgpr_write_b32 a213, 0
 v_accvgpr_write_b32 a214, 0
 v_accvgpr_write_b32 a215, 0
 v_accvgpr_write_b32 a216, 0
 v_accvgpr_write_b32 a217, 0
 v_accvgpr_write_b32 a218, 0
 v_accvgpr_write_b32 a219, 0
 v_accvgpr_write_b32 a220, 0
 v_accvgpr_write_b32 a221, 0
 v_accvgpr_write_b32 a222, 0
 v_accvgpr_write_b32 a223, 0
 v_accvgpr_write_b32 a224, 0
 v_accvgpr_write_b32 a225, 0
 v_accvgpr_write_b32 a226, 0
 v_accvgpr_write_b32 a227, 0
 v_accvgpr_write_b32 a228, 0
 v_accvgpr_write_b32 a229, 0
 v_accvgpr_write_b32 a230, 0
 v_accvgpr_write_b32 a231, 0
 v_accvgpr_write_b32 a232, 0
 v_accvgpr_write_b32 a233, 0
 v_accvgpr_write_b32 a234, 0
 v_accvgpr_write_b32 a235, 0
 v_accvgpr_write_b32 a236, 0
 v_accvgpr_write_b32 a237, 0
 v_accvgpr_write_b32 a238, 0
 v_accvgpr_write_b32 a239, 0
 v_accvgpr_write_b32 a240, 0
 v_accvgpr_write_b32 a241, 0
 v_accvgpr_write_b32 a242, 0
 v_accvgpr_write_b32 a243, 0
 v_accvgpr_write_b32 a244, 0
 v_accvgpr_write_b32 a245, 0
 v_accvgpr_write_b32 a246, 0
 v_accvgpr_write_b32 a247, 0
 v_accvgpr_write_b32 a248, 0
 v_accvgpr_write_b32 a249, 0
 v_accvgpr_write_b32 a250, 0
 v_accvgpr_write_b32 a251, 0
 v_accvgpr_write_b32 a252, 0
 v_accvgpr_write_b32 a253, 0
 v_accvgpr_write_b32 a254, 0
 v_accvgpr_write_b32 a255, 0
 s_mov_b32 s30, 0
L_slow_pv_100004:
 s_mov_b32 m0, s29
 s_add_u32 s26, s34, s30
 s_nop 0
 buffer_load_dwordx4 v8, s[4:7], s26 offen offset:0 lds
 buffer_load_dwordx4 v9, s[4:7], s26 offen offset:1024 lds
 buffer_load_dwordx4 v10, s[4:7], s26 offen offset:2048 lds
 buffer_load_dwordx4 v11, s[4:7], s26 offen offset:3072 lds
 s_add_u32 m0, s29, 16384
 s_nop 0
 s_nop 0
 buffer_load_dwordx4 v12, s[8:11], s26 offen offset:0 lds
 buffer_load_dwordx4 v13, s[8:11], s26 offen offset:1024 lds
 buffer_load_dwordx4 v14, s[8:11], s26 offen offset:2048 lds
 buffer_load_dwordx4 v15, s[8:11], s26 offen offset:3072 lds
 s_waitcnt vmcnt(0)
 s_barrier
 v_xor_b32_e64 v224, 32, v16
 ds_read_b64 v[160:161], v16 offset:0
 ds_read_b64 v[162:163], v224 offset:0
 v_xor_b32_e64 v224, 32, v17
 ds_read_b64 v[164:165], v17 offset:0
 ds_read_b64 v[166:167], v224 offset:0
 v_xor_b32_e64 v224, 32, v18
 ds_read_b64 v[168:169], v18 offset:0
 ds_read_b64 v[170:171], v224 offset:0
 v_xor_b32_e64 v224, 32, v19
 ds_read_b64 v[172:173], v19 offset:0
 ds_read_b64 v[174:175], v224 offset:0
 v_xor_b32_e64 v224, 32, v16
 ds_read_b64 v[176:177], v16 offset:4096
 ds_read_b64 v[178:179], v224 offset:4096
 v_xor_b32_e64 v224, 32, v17
 ds_read_b64 v[180:181], v17 offset:4096
 ds_read_b64 v[182:183], v224 offset:4096
 v_xor_b32_e64 v224, 32, v18
 ds_read_b64 v[184:185], v18 offset:4096
 ds_read_b64 v[186:187], v224 offset:4096
 v_xor_b32_e64 v224, 32, v19
 ds_read_b64 v[188:189], v19 offset:4096
 ds_read_b64 v[190:191], v224 offset:4096
 s_waitcnt lgkmcnt(0)
 s_nop 0
 mf v[64:67],v[160:163],a[64:67],0
 mf v[68:71],v[160:163],a[80:83],0
 mf v[72:75],v[160:163],a[96:99],0
 mf v[76:79],v[160:163],a[112:115],0
 mf v[64:67],v[164:167],a[68:71],v[64:67]
 mf v[68:71],v[164:167],a[84:87],v[68:71]
 mf v[72:75],v[164:167],a[100:103],v[72:75]
 mf v[76:79],v[164:167],a[116:119],v[76:79]
 mf v[64:67],v[168:171],a[72:75],v[64:67]
 mf v[68:71],v[168:171],a[88:91],v[68:71]
 mf v[72:75],v[168:171],a[104:107],v[72:75]
 mf v[76:79],v[168:171],a[120:123],v[76:79]
 mf v[64:67],v[172:175],a[76:79],v[64:67]
 mf v[68:71],v[172:175],a[92:95],v[68:71]
 mf v[72:75],v[172:175],a[108:111],v[72:75]
 mf v[76:79],v[172:175],a[124:127],v[76:79]
 mf v[80:83],v[176:179],a[64:67],0
 mf v[84:87],v[176:179],a[80:83],0
 mf v[88:91],v[176:179],a[96:99],0
 mf v[92:95],v[176:179],a[112:115],0
 mf v[80:83],v[180:183],a[68:71],v[80:83]
 mf v[84:87],v[180:183],a[84:87],v[84:87]
 mf v[88:91],v[180:183],a[100:103],v[88:91]
 mf v[92:95],v[180:183],a[116:119],v[92:95]
 mf v[80:83],v[184:187],a[72:75],v[80:83]
 mf v[84:87],v[184:187],a[88:91],v[84:87]
 mf v[88:91],v[184:187],a[104:107],v[88:91]
 mf v[92:95],v[184:187],a[120:123],v[92:95]
 mf v[80:83],v[188:191],a[76:79],v[80:83]
 mf v[84:87],v[188:191],a[92:95],v[84:87]
 mf v[88:91],v[188:191],a[108:111],v[88:91]
 mf v[92:95],v[188:191],a[124:127],v[92:95]
 s_nop 7
 s_nop 1
 tr v[192:193],v24,16384
 tr v[194:195],v24,20480
 tr v[196:197],v25,16384
 tr v[198:199],v25,20480
 tr v[200:201],v26,16384
 tr v[202:203],v26,20480
 tr v[204:205],v27,16384
 tr v[206:207],v27,20480
 tr v[208:209],v28,16384
 tr v[210:211],v28,20480
 tr v[212:213],v29,16384
 tr v[214:215],v29,20480
 tr v[216:217],v30,16384
 tr v[218:219],v30,20480
 tr v[220:221],v31,16384
 tr v[222:223],v31,20480
 v_sub_f32 v64, v64, v144
 v_sub_f32 v65, v65, v144
 v_sub_f32 v66, v66, v144
 v_sub_f32 v67, v67, v144
 v_exp_f32 v64, v64
 v_exp_f32 v65, v65
 v_exp_f32_e64 v66, v66
 v_exp_f32 v67, v67
 s_nop 0
 v_cvt_pk_bf16_f32 v128, v64, v65
 v_cvt_pk_bf16_f32 v129, v66, v67
 v_sub_f32 v68, v68, v145
 v_sub_f32 v69, v69, v145
 v_sub_f32 v70, v70, v145
 v_sub_f32 v71, v71, v145
 v_exp_f32 v68, v68
 v_exp_f32 v69, v69
 v_exp_f32_e64 v70, v70
 v_exp_f32 v71, v71
 s_nop 0
 v_cvt_pk_bf16_f32 v132, v68, v69
 v_cvt_pk_bf16_f32 v133, v70, v71
 v_sub_f32 v72, v72, v146
 v_sub_f32 v73, v73, v146
 v_sub_f32 v74, v74, v146
 v_sub_f32 v75, v75, v146
 v_exp_f32 v72, v72
 v_exp_f32 v73, v73
 v_exp_f32_e64 v74, v74
 v_exp_f32 v75, v75
 s_nop 0
 v_cvt_pk_bf16_f32 v136, v72, v73
 v_cvt_pk_bf16_f32 v137, v74, v75
 v_sub_f32 v76, v76, v147
 v_sub_f32 v77, v77, v147
 v_sub_f32 v78, v78, v147
 v_sub_f32 v79, v79, v147
 v_exp_f32 v76, v76
 v_exp_f32 v77, v77
 v_exp_f32_e64 v78, v78
 v_exp_f32 v79, v79
 s_nop 0
 v_cvt_pk_bf16_f32 v140, v76, v77
 v_cvt_pk_bf16_f32 v141, v78, v79
 v_sub_f32 v80, v80, v144
 v_sub_f32 v81, v81, v144
 v_sub_f32 v82, v82, v144
 v_sub_f32 v83, v83, v144
 v_exp_f32 v80, v80
 v_exp_f32 v81, v81
 v_exp_f32_e64 v82, v82
 v_exp_f32 v83, v83
 s_nop 0
 v_cvt_pk_bf16_f32 v130, v80, v81
 v_cvt_pk_bf16_f32 v131, v82, v83
 v_sub_f32 v84, v84, v145
 v_sub_f32 v85, v85, v145
 v_sub_f32 v86, v86, v145
 v_sub_f32 v87, v87, v145
 v_exp_f32 v84, v84
 v_exp_f32 v85, v85
 v_exp_f32_e64 v86, v86
 v_exp_f32 v87, v87
 s_nop 0
 v_cvt_pk_bf16_f32 v134, v84, v85
 v_cvt_pk_bf16_f32 v135, v86, v87
 v_sub_f32 v88, v88, v146
 v_sub_f32 v89, v89, v146
 v_sub_f32 v90, v90, v146
 v_sub_f32 v91, v91, v146
 v_exp_f32 v88, v88
 v_exp_f32 v89, v89
 v_exp_f32_e64 v90, v90
 v_exp_f32 v91, v91
 s_nop 0
 v_cvt_pk_bf16_f32 v138, v88, v89
 v_cvt_pk_bf16_f32 v139, v90, v91
 v_sub_f32 v92, v92, v147
 v_sub_f32 v93, v93, v147
 v_sub_f32 v94, v94, v147
 v_sub_f32 v95, v95, v147
 v_exp_f32 v92, v92
 v_exp_f32 v93, v93
 v_exp_f32_e64 v94, v94
 v_exp_f32 v95, v95
 s_nop 0
 v_cvt_pk_bf16_f32 v142, v92, v93
 v_cvt_pk_bf16_f32 v143, v94, v95
 s_waitcnt lgkmcnt(0)
 s_nop 1
 mf a[128:131],v[192:195],v[128:131],a[128:131]
 mf a[132:135],v[192:195],v[132:135],a[132:135]
 mf a[136:139],v[192:195],v[136:139],a[136:139]
 mf a[140:143],v[192:195],v[140:143],a[140:143]
 mf a[144:147],v[196:199],v[128:131],a[144:147]
 mf a[148:151],v[196:199],v[132:135],a[148:151]
 mf a[152:155],v[196:199],v[136:139],a[152:155]
 mf a[156:159],v[196:199],v[140:143],a[156:159]
 mf a[160:163],v[200:203],v[128:131],a[160:163]
 mf a[164:167],v[200:203],v[132:135],a[164:167]
 mf a[168:171],v[200:203],v[136:139],a[168:171]
 mf a[172:175],v[200:203],v[140:143],a[172:175]
 mf a[176:179],v[204:207],v[128:131],a[176:179]
 mf a[180:183],v[204:207],v[132:135],a[180:183]
 mf a[184:187],v[204:207],v[136:139],a[184:187]
 mf a[188:191],v[204:207],v[140:143],a[188:191]
 mf a[192:195],v[208:211],v[128:131],a[192:195]
 mf a[196:199],v[208:211],v[132:135],a[196:199]
 mf a[200:203],v[208:211],v[136:139],a[200:203]
 mf a[204:207],v[208:211],v[140:143],a[204:207]
 mf a[208:211],v[212:215],v[128:131],a[208:211]
 mf a[212:215],v[212:215],v[132:135],a[212:215]
 mf a[216:219],v[212:215],v[136:139],a[216:219]
 mf a[220:223],v[212:215],v[140:143],a[220:223]
 mf a[224:227],v[216:219],v[128:131],a[224:227]
 mf a[228:231],v[216:219],v[132:135],a[228:231]
 mf a[232:235],v[216:219],v[136:139],a[232:235]
 mf a[236:239],v[216:219],v[140:143],a[236:239]
 mf a[240:243],v[220:223],v[128:131],a[240:243]
 mf a[244:247],v[220:223],v[132:135],a[244:247]
 mf a[248:251],v[220:223],v[136:139],a[248:251]
 mf a[252:255],v[220:223],v[140:143],a[252:255]
 mf v[44:47],v[40:43],v[128:131],v[44:47]
 mf v[48:51],v[40:43],v[132:135],v[48:51]
 mf v[52:55],v[40:43],v[136:139],v[52:55]
 mf v[56:59],v[40:43],v[140:143],v[56:59]
 v_xor_b32_e64 v224, 32, v16
 ds_read_b64 v[160:161], v16 offset:8192
 ds_read_b64 v[162:163], v224 offset:8192
 v_xor_b32_e64 v224, 32, v17
 ds_read_b64 v[164:165], v17 offset:8192
 ds_read_b64 v[166:167], v224 offset:8192
 v_xor_b32_e64 v224, 32, v18
 ds_read_b64 v[168:169], v18 offset:8192
 ds_read_b64 v[170:171], v224 offset:8192
 v_xor_b32_e64 v224, 32, v19
 ds_read_b64 v[172:173], v19 offset:8192
 ds_read_b64 v[174:175], v224 offset:8192
 v_xor_b32_e64 v224, 32, v16
 ds_read_b64 v[176:177], v16 offset:12288
 ds_read_b64 v[178:179], v224 offset:12288
 v_xor_b32_e64 v224, 32, v17
 ds_read_b64 v[180:181], v17 offset:12288
 ds_read_b64 v[182:183], v224 offset:12288
 v_xor_b32_e64 v224, 32, v18
 ds_read_b64 v[184:185], v18 offset:12288
 ds_read_b64 v[186:187], v224 offset:12288
 v_xor_b32_e64 v224, 32, v19
 ds_read_b64 v[188:189], v19 offset:12288
 ds_read_b64 v[190:191], v224 offset:12288
 s_waitcnt lgkmcnt(0)
 s_nop 0
 mf v[64:67],v[160:163],a[64:67],0
 mf v[68:71],v[160:163],a[80:83],0
 mf v[72:75],v[160:163],a[96:99],0
 mf v[76:79],v[160:163],a[112:115],0
 mf v[64:67],v[164:167],a[68:71],v[64:67]
 mf v[68:71],v[164:167],a[84:87],v[68:71]
 mf v[72:75],v[164:167],a[100:103],v[72:75]
 mf v[76:79],v[164:167],a[116:119],v[76:79]
 mf v[64:67],v[168:171],a[72:75],v[64:67]
 mf v[68:71],v[168:171],a[88:91],v[68:71]
 mf v[72:75],v[168:171],a[104:107],v[72:75]
 mf v[76:79],v[168:171],a[120:123],v[76:79]
 mf v[64:67],v[172:175],a[76:79],v[64:67]
 mf v[68:71],v[172:175],a[92:95],v[68:71]
 mf v[72:75],v[172:175],a[108:111],v[72:75]
 mf v[76:79],v[172:175],a[124:127],v[76:79]
 mf v[80:83],v[176:179],a[64:67],0
 mf v[84:87],v[176:179],a[80:83],0
 mf v[88:91],v[176:179],a[96:99],0
 mf v[92:95],v[176:179],a[112:115],0
 mf v[80:83],v[180:183],a[68:71],v[80:83]
 mf v[84:87],v[180:183],a[84:87],v[84:87]
 mf v[88:91],v[180:183],a[100:103],v[88:91]
 mf v[92:95],v[180:183],a[116:119],v[92:95]
 mf v[80:83],v[184:187],a[72:75],v[80:83]
 mf v[84:87],v[184:187],a[88:91],v[84:87]
 mf v[88:91],v[184:187],a[104:107],v[88:91]
 mf v[92:95],v[184:187],a[120:123],v[92:95]
 mf v[80:83],v[188:191],a[76:79],v[80:83]
 mf v[84:87],v[188:191],a[92:95],v[84:87]
 mf v[88:91],v[188:191],a[108:111],v[88:91]
 mf v[92:95],v[188:191],a[124:127],v[92:95]
 s_nop 7
 s_nop 1
 tr v[192:193],v24,24576
 tr v[194:195],v24,28672
 tr v[196:197],v25,24576
 tr v[198:199],v25,28672
 tr v[200:201],v26,24576
 tr v[202:203],v26,28672
 tr v[204:205],v27,24576
 tr v[206:207],v27,28672
 tr v[208:209],v28,24576
 tr v[210:211],v28,28672
 tr v[212:213],v29,24576
 tr v[214:215],v29,28672
 tr v[216:217],v30,24576
 tr v[218:219],v30,28672
 tr v[220:221],v31,24576
 tr v[222:223],v31,28672
 v_sub_f32 v64, v64, v144
 v_sub_f32 v65, v65, v144
 v_sub_f32 v66, v66, v144
 v_sub_f32 v67, v67, v144
 v_exp_f32 v64, v64
 v_exp_f32 v65, v65
 v_exp_f32_e64 v66, v66
 v_exp_f32 v67, v67
 s_nop 0
 v_cvt_pk_bf16_f32 v128, v64, v65
 v_cvt_pk_bf16_f32 v129, v66, v67
 v_sub_f32 v68, v68, v145
 v_sub_f32 v69, v69, v145
 v_sub_f32 v70, v70, v145
 v_sub_f32 v71, v71, v145
 v_exp_f32 v68, v68
 v_exp_f32 v69, v69
 v_exp_f32_e64 v70, v70
 v_exp_f32 v71, v71
 s_nop 0
 v_cvt_pk_bf16_f32 v132, v68, v69
 v_cvt_pk_bf16_f32 v133, v70, v71
 v_sub_f32 v72, v72, v146
 v_sub_f32 v73, v73, v146
 v_sub_f32 v74, v74, v146
 v_sub_f32 v75, v75, v146
 v_exp_f32 v72, v72
 v_exp_f32 v73, v73
 v_exp_f32_e64 v74, v74
 v_exp_f32 v75, v75
 s_nop 0
 v_cvt_pk_bf16_f32 v136, v72, v73
 v_cvt_pk_bf16_f32 v137, v74, v75
 v_sub_f32 v76, v76, v147
 v_sub_f32 v77, v77, v147
 v_sub_f32 v78, v78, v147
 v_sub_f32 v79, v79, v147
 v_exp_f32 v76, v76
 v_exp_f32 v77, v77
 v_exp_f32_e64 v78, v78
 v_exp_f32 v79, v79
 s_nop 0
 v_cvt_pk_bf16_f32 v140, v76, v77
 v_cvt_pk_bf16_f32 v141, v78, v79
 v_sub_f32 v80, v80, v144
 v_sub_f32 v81, v81, v144
 v_sub_f32 v82, v82, v144
 v_sub_f32 v83, v83, v144
 v_exp_f32 v80, v80
 v_exp_f32 v81, v81
 v_exp_f32_e64 v82, v82
 v_exp_f32 v83, v83
 s_nop 0
 v_cvt_pk_bf16_f32 v130, v80, v81
 v_cvt_pk_bf16_f32 v131, v82, v83
 v_sub_f32 v84, v84, v145
 v_sub_f32 v85, v85, v145
 v_sub_f32 v86, v86, v145
 v_sub_f32 v87, v87, v145
 v_exp_f32 v84, v84
 v_exp_f32 v85, v85
 v_exp_f32_e64 v86, v86
 v_exp_f32 v87, v87
 s_nop 0
 v_cvt_pk_bf16_f32 v134, v84, v85
 v_cvt_pk_bf16_f32 v135, v86, v87
 v_sub_f32 v88, v88, v146
 v_sub_f32 v89, v89, v146
 v_sub_f32 v90, v90, v146
 v_sub_f32 v91, v91, v146
 v_exp_f32 v88, v88
 v_exp_f32 v89, v89
 v_exp_f32_e64 v90, v90
 v_exp_f32 v91, v91
 s_nop 0
 v_cvt_pk_bf16_f32 v138, v88, v89
 v_cvt_pk_bf16_f32 v139, v90, v91
 v_sub_f32 v92, v92, v147
 v_sub_f32 v93, v93, v147
 v_sub_f32 v94, v94, v147
 v_sub_f32 v95, v95, v147
 v_exp_f32 v92, v92
 v_exp_f32 v93, v93
 v_exp_f32_e64 v94, v94
 v_exp_f32 v95, v95
 s_nop 0
 v_cvt_pk_bf16_f32 v142, v92, v93
 v_cvt_pk_bf16_f32 v143, v94, v95
 s_waitcnt lgkmcnt(0)
 s_nop 1
 mf a[128:131],v[192:195],v[128:131],a[128:131]
 mf a[132:135],v[192:195],v[132:135],a[132:135]
 mf a[136:139],v[192:195],v[136:139],a[136:139]
 mf a[140:143],v[192:195],v[140:143],a[140:143]
 mf a[144:147],v[196:199],v[128:131],a[144:147]
 mf a[148:151],v[196:199],v[132:135],a[148:151]
 mf a[152:155],v[196:199],v[136:139],a[152:155]
 mf a[156:159],v[196:199],v[140:143],a[156:159]
 mf a[160:163],v[200:203],v[128:131],a[160:163]
 mf a[164:167],v[200:203],v[132:135],a[164:167]
 mf a[168:171],v[200:203],v[136:139],a[168:171]
 mf a[172:175],v[200:203],v[140:143],a[172:175]
 mf a[176:179],v[204:207],v[128:131],a[176:179]
 mf a[180:183],v[204:207],v[132:135],a[180:183]
 mf a[184:187],v[204:207],v[136:139],a[184:187]
 mf a[188:191],v[204:207],v[140:143],a[188:191]
 mf a[192:195],v[208:211],v[128:131],a[192:195]
 mf a[196:199],v[208:211],v[132:135],a[196:199]
 mf a[200:203],v[208:211],v[136:139],a[200:203]
 mf a[204:207],v[208:211],v[140:143],a[204:207]
 mf a[208:211],v[212:215],v[128:131],a[208:211]
 mf a[212:215],v[212:215],v[132:135],a[212:215]
 mf a[216:219],v[212:215],v[136:139],a[216:219]
 mf a[220:223],v[212:215],v[140:143],a[220:223]
 mf a[224:227],v[216:219],v[128:131],a[224:227]
 mf a[228:231],v[216:219],v[132:135],a[228:231]
 mf a[232:235],v[216:219],v[136:139],a[232:235]
 mf a[236:239],v[216:219],v[140:143],a[236:239]
 mf a[240:243],v[220:223],v[128:131],a[240:243]
 mf a[244:247],v[220:223],v[132:135],a[244:247]
 mf a[248:251],v[220:223],v[136:139],a[248:251]
 mf a[252:255],v[220:223],v[140:143],a[252:255]
 mf v[44:47],v[40:43],v[128:131],v[44:47]
 mf v[48:51],v[40:43],v[132:135],v[48:51]
 mf v[52:55],v[40:43],v[136:139],v[52:55]
 mf v[56:59],v[40:43],v[140:143],v[56:59]
 s_barrier
 s_nop 0
 s_add_u32 s30, s30, 16384
 s_cmp_lt_u32 s30, 131072
 s_cbranch_scc1 L_slow_pv_100004
 s_nop 7
 s_nop 1
 s_nop 0
 s_mov_b32 s31, 0x33800000
 s_mov_b32 s3, 0x53800000
 v_cmp_nle_f32 vcc, s31, v44
 s_or_b64 s[50:51], s[50:51], vcc
 v_cmp_nge_f32 vcc, s3, v44
 s_or_b64 s[50:51], s[50:51], vcc
 v_rcp_f32 v252, v44
 v_cmp_nle_f32 vcc, s31, v48
 s_or_b64 s[50:51], s[50:51], vcc
 v_cmp_nge_f32 vcc, s3, v48
 s_or_b64 s[50:51], s[50:51], vcc
 v_rcp_f32 v253, v48
 v_cmp_nle_f32 vcc, s31, v52
 s_or_b64 s[50:51], s[50:51], vcc
 v_cmp_nge_f32 vcc, s3, v52
 s_or_b64 s[50:51], s[50:51], vcc
 v_rcp_f32 v254, v52
 v_cmp_nle_f32 vcc, s31, v56
 s_or_b64 s[50:51], s[50:51], vcc
 v_cmp_nge_f32 vcc, s3, v56
 s_or_b64 s[50:51], s[50:51], vcc
 v_rcp_f32 v255, v56
 s_add_u32 s31, s35, 4096
 ar v224,a128
 ar v228,a144
 ar v225,a129
 ar v229,a145
 ar v226,a130
 ar v230,a146
 ar v227,a131
 ar v231,a147
 v_pk_mul_f32 v[224:225], v[224:225], v[252:253] op_sel:[0,0] op_sel_hi:[1,0]
 v_pk_mul_f32 v[226:227], v[226:227], v[252:253] op_sel:[0,0] op_sel_hi:[1,0]
 v_pk_mul_f32 v[228:229], v[228:229], v[252:253] op_sel:[0,0] op_sel_hi:[1,0]
 v_pk_mul_f32 v[230:231], v[230:231], v[252:253] op_sel:[0,0] op_sel_hi:[1,0]
 v_cvt_pk_bf16_f32 v232, v224, v225
 v_cvt_pk_bf16_f32 v233, v226, v227
 v_cvt_pk_bf16_f32 v234, v228, v229
 v_cvt_pk_bf16_f32 v235, v230, v231
 buffer_store_dwordx4 v[232:235], v60, s[12:15], s31 offen offset:0 sc1
 ar v236,a132
 ar v240,a148
 ar v237,a133
 ar v241,a149
 ar v238,a134
 ar v242,a150
 ar v239,a135
 ar v243,a151
 v_pk_mul_f32 v[236:237], v[236:237], v[252:253] op_sel:[0,1] op_sel_hi:[1,1]
 v_pk_mul_f32 v[238:239], v[238:239], v[252:253] op_sel:[0,1] op_sel_hi:[1,1]
 v_pk_mul_f32 v[240:241], v[240:241], v[252:253] op_sel:[0,1] op_sel_hi:[1,1]
 v_pk_mul_f32 v[242:243], v[242:243], v[252:253] op_sel:[0,1] op_sel_hi:[1,1]
 v_cvt_pk_bf16_f32 v244, v236, v237
 v_cvt_pk_bf16_f32 v245, v238, v239
 v_cvt_pk_bf16_f32 v246, v240, v241
 v_cvt_pk_bf16_f32 v247, v242, v243
 buffer_store_dwordx4 v[244:247], v60, s[12:15], s31 offen offset:1024 sc1
 ar v224,a136
 ar v228,a152
 ar v225,a137
 ar v229,a153
 ar v226,a138
 ar v230,a154
 ar v227,a139
 ar v231,a155
 v_pk_mul_f32 v[224:225], v[224:225], v[254:255] op_sel:[0,0] op_sel_hi:[1,0]
 v_pk_mul_f32 v[226:227], v[226:227], v[254:255] op_sel:[0,0] op_sel_hi:[1,0]
 v_pk_mul_f32 v[228:229], v[228:229], v[254:255] op_sel:[0,0] op_sel_hi:[1,0]
 v_pk_mul_f32 v[230:231], v[230:231], v[254:255] op_sel:[0,0] op_sel_hi:[1,0]
 v_cvt_pk_bf16_f32 v232, v224, v225
 v_cvt_pk_bf16_f32 v233, v226, v227
 v_cvt_pk_bf16_f32 v234, v228, v229
 v_cvt_pk_bf16_f32 v235, v230, v231
 buffer_store_dwordx4 v[232:235], v60, s[12:15], s31 offen offset:2048 sc1
 ar v236,a140
 ar v240,a156
 ar v237,a141
 ar v241,a157
 ar v238,a142
 ar v242,a158
 ar v239,a143
 ar v243,a159
 v_pk_mul_f32 v[236:237], v[236:237], v[254:255] op_sel:[0,1] op_sel_hi:[1,1]
 v_pk_mul_f32 v[238:239], v[238:239], v[254:255] op_sel:[0,1] op_sel_hi:[1,1]
 v_pk_mul_f32 v[240:241], v[240:241], v[254:255] op_sel:[0,1] op_sel_hi:[1,1]
 v_pk_mul_f32 v[242:243], v[242:243], v[254:255] op_sel:[0,1] op_sel_hi:[1,1]
 v_cvt_pk_bf16_f32 v244, v236, v237
 v_cvt_pk_bf16_f32 v245, v238, v239
 v_cvt_pk_bf16_f32 v246, v240, v241
 v_cvt_pk_bf16_f32 v247, v242, v243
 buffer_store_dwordx4 v[244:247], v60, s[12:15], s31 offen offset:3072 sc1
 s_add_u32 s31, s35, 135168
 ar v224,a160
 ar v228,a176
 ar v225,a161
 ar v229,a177
 ar v226,a162
 ar v230,a178
 ar v227,a163
 ar v231,a179
 v_pk_mul_f32 v[224:225], v[224:225], v[252:253] op_sel:[0,0] op_sel_hi:[1,0]
 v_pk_mul_f32 v[226:227], v[226:227], v[252:253] op_sel:[0,0] op_sel_hi:[1,0]
 v_pk_mul_f32 v[228:229], v[228:229], v[252:253] op_sel:[0,0] op_sel_hi:[1,0]
 v_pk_mul_f32 v[230:231], v[230:231], v[252:253] op_sel:[0,0] op_sel_hi:[1,0]
 v_cvt_pk_bf16_f32 v232, v224, v225
 v_cvt_pk_bf16_f32 v233, v226, v227
 v_cvt_pk_bf16_f32 v234, v228, v229
 v_cvt_pk_bf16_f32 v235, v230, v231
 buffer_store_dwordx4 v[232:235], v60, s[12:15], s31 offen offset:0 sc1
 ar v236,a164
 ar v240,a180
 ar v237,a165
 ar v241,a181
 ar v238,a166
 ar v242,a182
 ar v239,a167
 ar v243,a183
 v_pk_mul_f32 v[236:237], v[236:237], v[252:253] op_sel:[0,1] op_sel_hi:[1,1]
 v_pk_mul_f32 v[238:239], v[238:239], v[252:253] op_sel:[0,1] op_sel_hi:[1,1]
 v_pk_mul_f32 v[240:241], v[240:241], v[252:253] op_sel:[0,1] op_sel_hi:[1,1]
 v_pk_mul_f32 v[242:243], v[242:243], v[252:253] op_sel:[0,1] op_sel_hi:[1,1]
 v_cvt_pk_bf16_f32 v244, v236, v237
 v_cvt_pk_bf16_f32 v245, v238, v239
 v_cvt_pk_bf16_f32 v246, v240, v241
 v_cvt_pk_bf16_f32 v247, v242, v243
 buffer_store_dwordx4 v[244:247], v60, s[12:15], s31 offen offset:1024 sc1
 ar v224,a168
 ar v228,a184
 ar v225,a169
 ar v229,a185
 ar v226,a170
 ar v230,a186
 ar v227,a171
 ar v231,a187
 v_pk_mul_f32 v[224:225], v[224:225], v[254:255] op_sel:[0,0] op_sel_hi:[1,0]
 v_pk_mul_f32 v[226:227], v[226:227], v[254:255] op_sel:[0,0] op_sel_hi:[1,0]
 v_pk_mul_f32 v[228:229], v[228:229], v[254:255] op_sel:[0,0] op_sel_hi:[1,0]
 v_pk_mul_f32 v[230:231], v[230:231], v[254:255] op_sel:[0,0] op_sel_hi:[1,0]
 v_cvt_pk_bf16_f32 v232, v224, v225
 v_cvt_pk_bf16_f32 v233, v226, v227
 v_cvt_pk_bf16_f32 v234, v228, v229
 v_cvt_pk_bf16_f32 v235, v230, v231
 buffer_store_dwordx4 v[232:235], v60, s[12:15], s31 offen offset:2048 sc1
 ar v236,a172
 ar v240,a188
 ar v237,a173
 ar v241,a189
 ar v238,a174
 ar v242,a190
 ar v239,a175
 ar v243,a191
 v_pk_mul_f32 v[236:237], v[236:237], v[254:255] op_sel:[0,1] op_sel_hi:[1,1]
 v_pk_mul_f32 v[238:239], v[238:239], v[254:255] op_sel:[0,1] op_sel_hi:[1,1]
 v_pk_mul_f32 v[240:241], v[240:241], v[254:255] op_sel:[0,1] op_sel_hi:[1,1]
 v_pk_mul_f32 v[242:243], v[242:243], v[254:255] op_sel:[0,1] op_sel_hi:[1,1]
 v_cvt_pk_bf16_f32 v244, v236, v237
 v_cvt_pk_bf16_f32 v245, v238, v239
 v_cvt_pk_bf16_f32 v246, v240, v241
 v_cvt_pk_bf16_f32 v247, v242, v243
 buffer_store_dwordx4 v[244:247], v60, s[12:15], s31 offen offset:3072 sc1
 s_add_u32 s31, s35, 266240
 ar v224,a192
 ar v228,a208
 ar v225,a193
 ar v229,a209
 ar v226,a194
 ar v230,a210
 ar v227,a195
 ar v231,a211
 v_pk_mul_f32 v[224:225], v[224:225], v[252:253] op_sel:[0,0] op_sel_hi:[1,0]
 v_pk_mul_f32 v[226:227], v[226:227], v[252:253] op_sel:[0,0] op_sel_hi:[1,0]
 v_pk_mul_f32 v[228:229], v[228:229], v[252:253] op_sel:[0,0] op_sel_hi:[1,0]
 v_pk_mul_f32 v[230:231], v[230:231], v[252:253] op_sel:[0,0] op_sel_hi:[1,0]
 v_cvt_pk_bf16_f32 v232, v224, v225
 v_cvt_pk_bf16_f32 v233, v226, v227
 v_cvt_pk_bf16_f32 v234, v228, v229
 v_cvt_pk_bf16_f32 v235, v230, v231
 buffer_store_dwordx4 v[232:235], v60, s[12:15], s31 offen offset:0 sc1
 ar v236,a196
 ar v240,a212
 ar v237,a197
 ar v241,a213
 ar v238,a198
 ar v242,a214
 ar v239,a199
 ar v243,a215
 v_pk_mul_f32 v[236:237], v[236:237], v[252:253] op_sel:[0,1] op_sel_hi:[1,1]
 v_pk_mul_f32 v[238:239], v[238:239], v[252:253] op_sel:[0,1] op_sel_hi:[1,1]
 v_pk_mul_f32 v[240:241], v[240:241], v[252:253] op_sel:[0,1] op_sel_hi:[1,1]
 v_pk_mul_f32 v[242:243], v[242:243], v[252:253] op_sel:[0,1] op_sel_hi:[1,1]
 v_cvt_pk_bf16_f32 v244, v236, v237
 v_cvt_pk_bf16_f32 v245, v238, v239
 v_cvt_pk_bf16_f32 v246, v240, v241
 v_cvt_pk_bf16_f32 v247, v242, v243
 buffer_store_dwordx4 v[244:247], v60, s[12:15], s31 offen offset:1024 sc1
 ar v224,a200
 ar v228,a216
 ar v225,a201
 ar v229,a217
 ar v226,a202
 ar v230,a218
 ar v227,a203
 ar v231,a219
 v_pk_mul_f32 v[224:225], v[224:225], v[254:255] op_sel:[0,0] op_sel_hi:[1,0]
 v_pk_mul_f32 v[226:227], v[226:227], v[254:255] op_sel:[0,0] op_sel_hi:[1,0]
 v_pk_mul_f32 v[228:229], v[228:229], v[254:255] op_sel:[0,0] op_sel_hi:[1,0]
 v_pk_mul_f32 v[230:231], v[230:231], v[254:255] op_sel:[0,0] op_sel_hi:[1,0]
 v_cvt_pk_bf16_f32 v232, v224, v225
 v_cvt_pk_bf16_f32 v233, v226, v227
 v_cvt_pk_bf16_f32 v234, v228, v229
 v_cvt_pk_bf16_f32 v235, v230, v231
 buffer_store_dwordx4 v[232:235], v60, s[12:15], s31 offen offset:2048 sc1
 ar v236,a204
 ar v240,a220
 ar v237,a205
 ar v241,a221
 ar v238,a206
 ar v242,a222
 ar v239,a207
 ar v243,a223
 v_pk_mul_f32 v[236:237], v[236:237], v[254:255] op_sel:[0,1] op_sel_hi:[1,1]
 v_pk_mul_f32 v[238:239], v[238:239], v[254:255] op_sel:[0,1] op_sel_hi:[1,1]
 v_pk_mul_f32 v[240:241], v[240:241], v[254:255] op_sel:[0,1] op_sel_hi:[1,1]
 v_pk_mul_f32 v[242:243], v[242:243], v[254:255] op_sel:[0,1] op_sel_hi:[1,1]
 v_cvt_pk_bf16_f32 v244, v236, v237
 v_cvt_pk_bf16_f32 v245, v238, v239
 v_cvt_pk_bf16_f32 v246, v240, v241
 v_cvt_pk_bf16_f32 v247, v242, v243
 buffer_store_dwordx4 v[244:247], v60, s[12:15], s31 offen offset:3072 sc1
 s_add_u32 s31, s35, 397312
 ar v224,a224
 ar v228,a240
 ar v225,a225
 ar v229,a241
 ar v226,a226
 ar v230,a242
 ar v227,a227
 ar v231,a243
 v_pk_mul_f32 v[224:225], v[224:225], v[252:253] op_sel:[0,0] op_sel_hi:[1,0]
 v_pk_mul_f32 v[226:227], v[226:227], v[252:253] op_sel:[0,0] op_sel_hi:[1,0]
 v_pk_mul_f32 v[228:229], v[228:229], v[252:253] op_sel:[0,0] op_sel_hi:[1,0]
 v_pk_mul_f32 v[230:231], v[230:231], v[252:253] op_sel:[0,0] op_sel_hi:[1,0]
 v_cvt_pk_bf16_f32 v232, v224, v225
 v_cvt_pk_bf16_f32 v233, v226, v227
 v_cvt_pk_bf16_f32 v234, v228, v229
 v_cvt_pk_bf16_f32 v235, v230, v231
 buffer_store_dwordx4 v[232:235], v60, s[12:15], s31 offen offset:0 sc1
 ar v236,a228
 ar v240,a244
 ar v237,a229
 ar v241,a245
 ar v238,a230
 ar v242,a246
 ar v239,a231
 ar v243,a247
 v_pk_mul_f32 v[236:237], v[236:237], v[252:253] op_sel:[0,1] op_sel_hi:[1,1]
 v_pk_mul_f32 v[238:239], v[238:239], v[252:253] op_sel:[0,1] op_sel_hi:[1,1]
 v_pk_mul_f32 v[240:241], v[240:241], v[252:253] op_sel:[0,1] op_sel_hi:[1,1]
 v_pk_mul_f32 v[242:243], v[242:243], v[252:253] op_sel:[0,1] op_sel_hi:[1,1]
 v_cvt_pk_bf16_f32 v244, v236, v237
 v_cvt_pk_bf16_f32 v245, v238, v239
 v_cvt_pk_bf16_f32 v246, v240, v241
 v_cvt_pk_bf16_f32 v247, v242, v243
 buffer_store_dwordx4 v[244:247], v60, s[12:15], s31 offen offset:1024 sc1
 ar v224,a232
 ar v228,a248
 ar v225,a233
 ar v229,a249
 ar v226,a234
 ar v230,a250
 ar v227,a235
 ar v231,a251
 v_pk_mul_f32 v[224:225], v[224:225], v[254:255] op_sel:[0,0] op_sel_hi:[1,0]
 v_pk_mul_f32 v[226:227], v[226:227], v[254:255] op_sel:[0,0] op_sel_hi:[1,0]
 v_pk_mul_f32 v[228:229], v[228:229], v[254:255] op_sel:[0,0] op_sel_hi:[1,0]
 v_pk_mul_f32 v[230:231], v[230:231], v[254:255] op_sel:[0,0] op_sel_hi:[1,0]
 v_cvt_pk_bf16_f32 v232, v224, v225
 v_cvt_pk_bf16_f32 v233, v226, v227
 v_cvt_pk_bf16_f32 v234, v228, v229
 v_cvt_pk_bf16_f32 v235, v230, v231
 buffer_store_dwordx4 v[232:235], v60, s[12:15], s31 offen offset:2048 sc1
 ar v236,a236
 ar v240,a252
 ar v237,a237
 ar v241,a253
 ar v238,a238
 ar v242,a254
 ar v239,a239
 ar v243,a255
 v_pk_mul_f32 v[236:237], v[236:237], v[254:255] op_sel:[0,1] op_sel_hi:[1,1]
 v_pk_mul_f32 v[238:239], v[238:239], v[254:255] op_sel:[0,1] op_sel_hi:[1,1]
 v_pk_mul_f32 v[240:241], v[240:241], v[254:255] op_sel:[0,1] op_sel_hi:[1,1]
 v_pk_mul_f32 v[242:243], v[242:243], v[254:255] op_sel:[0,1] op_sel_hi:[1,1]
 v_cvt_pk_bf16_f32 v244, v236, v237
 v_cvt_pk_bf16_f32 v245, v238, v239
 v_cvt_pk_bf16_f32 v246, v240, v241
 v_cvt_pk_bf16_f32 v247, v242, v243
 buffer_store_dwordx4 v[244:247], v60, s[12:15], s31 offen offset:3072 sc1
 s_and_b32 s40, s39, 3
 s_and_b32 s41, s96, 1
 s_lshl_b32 s41, s41, 2
 s_add_u32 s40, s40, s41
 s_bfe_u32 s41, s39, 0x20002
 s_and_b32 s42, s96, 2
 s_lshl_b32 s42, s42, 1
 s_add_u32 s41, s41, s42
 s_nop 0
 s_bfe_u32 s42, s96, 0x10002
 s_mul_i32 s98, s42, 0
 s_mul_i32 s97, s98, 3
 s_sub_u32 s97, 26, s97
 s_nop 0
 s_mul_i32 s81, s42, 3407872
 s_lshl_b32 s31, s41, 8
 s_add_u32 s81, s81, s31
 s_mul_i32 s82, s42, 6815744
 s_lshl_b32 s31, s40, 14
 s_add_u32 s82, s82, s31
 s_lshl_b32 s31, s22, 17
 s_add_u32 s82, s82, s31
 s_lshl_b32 s31, s21, 13
 s_add_u32 s82, s82, s31
 s_lshl_b32 s88, s40, 8
 s_nop 0
 s_add_u32 s88, s88, 8192
 s_lshl_b32 s87, s40, 1
 s_add_u32 s87, s87, s22
 s_lshl_b32 s87, s87, 3
 s_add_u32 s87, s87, s41
 s_lshl_b32 s87, s87, 15
 s_lshl_b32 s31, s42, 22
 s_add_u32 s87, s87, s31
 s_lshl_b32 s31, s21, 13
 s_add_u32 s87, s87, s31
 s_lshl_b32 s86, s40, 3
 s_add_u32 s86, s86, s41
 s_lshl_b32 s86, s86, 6
 s_lshl_b32 s31, s42, 3
 s_add_u32 s86, s86, s31
 s_add_u32 s86, s86, 12288
 s_bfe_u32 s43, s96, 0x20001
 s_lshl_b32 s89, s43, 5
 s_add_u32 s89, s89, s88
 s_xor_b32 s88, s89, 32
 s_mul_i32 s42, s42, 26
 s_lshl_b32 s43, s43, 4
 s_sub_u32 s42, s43, s42
 s_lshl_b32 s31, s42, 17
 s_add_u32 s81, s81, s31
 s_lshl_b32 s31, s42, 18
 s_add_u32 s82, s82, s31
 s_and_b32 s43, s43, 16
 s_lshl_b32 s43, s43, 1
 s_sub_u32 s43, 4, s43
 s_lshl_b32 s85, s43, 17
 s_lshl_b32 s90, s43, 18
 s_lshl_b32 s31, s20, 4
 v_add_u32 v5, s31, v2
 v_lshlrev_b32 v5, 11, v5
 v_and_b32 v6, 15, v1
 v_or_b32 v7, 0, v2
 v_lshlrev_b32 v7, 1, v7
 v_xor_b32 v7, v7, v6
 v_lshl_add_u32 v7, v7, 4, v5
 v_add_u32 v8, 0, v7
 v_or_b32 v7, 4, v2
 v_lshlrev_b32 v7, 1, v7
 v_xor_b32 v7, v7, v6
 v_lshl_add_u32 v7, v7, 4, v5
 v_add_u32 v9, 7168, v7
 v_or_b32 v7, 0, v2
 v_lshlrev_b32 v7, 1, v7
 v_xor_b32_e64 v7, v7, v6
 v_lshl_add_u32 v7, v7, 4, v5
 v_add_u32 v10, 14336, v7
 v_or_b32 v7, 4, v2
 v_lshlrev_b32 v7, 1, v7
 v_xor_b32_e64 v7, v7, v6
 v_lshl_add_u32 v7, v7, 4, v5
 v_add_u32 v11, 21504, v7
 v_lshlrev_b32_e64 v12, 4, v1
 v_lshl_add_u32 v6, v2, 2, v3
 v_lshlrev_b32 v5, 8, v6
 v_and_b32 v7, 1, v4
 v_lshl_add_u32 v5, v7, 3, v5
 v_lshrrev_b32_e64 v7, 1, v4
 v_lshl_add_u32 v5, v7, 4, v5
 v_and_b32 v6, 7, v6
 s_lshl_b32 s31, s21, 2
 s_add_u32 s25, s31, 0
 v_xor_b32 v7, s25, v6
 v_lshl_add_u32 v14, v7, 5, v5
 v_add_u32 v18, 98304, v14
 s_add_u32 s25, s31, 1
 v_xor_b32 v7, s25, v6
 v_lshl_add_u32 v15, v7, 5, v5
 v_add_u32 v19, 98304, v15
 s_add_u32 s25, s31, 2
 v_xor_b32 v7, s25, v6
 v_lshl_add_u32 v16, v7, 5, v5
 v_add_u32 v20, 98304, v16
 s_add_u32 s25, s31, 3
 v_xor_b32 v7, s25, v6
 v_lshl_add_u32 v17, v7, 5, v5
 v_add_u32 v21, 98304, v17
 v_add_u32 v13, 4096, v12
 s_lshl_b32 s28, s20, 13
 s_lshl_b32 s31, s22, 13
 s_add_u32 s31, s31, 16384
 v_add_u32_e64 v22, s31, v12
 v_add_u32 v23, 49152, v22
 v_add_u32 v24, 98304, v22
 s_mov_b32 s4, s64
 s_mov_b32 s5, s65
 s_mov_b32 s6, 8388608
 s_add_u32 s8, s32, 4194304
 s_addc_u32 s9, s33, 0
 s_nop 0
 s_mov_b32 s10, 16777216
 s_mov_b32 s26, s81
 s_mov_b32 s27, s82
 s_add_u32 m0, s29, 0
 s_nop 0
 buffer_load_dwordx4 v8, s[4:7], s26 offen offset:0 lds
 buffer_load_dwordx4 v9, s[4:7], s26 offen offset:1024 lds
 buffer_load_dwordx4 v10, s[4:7], s26 offen offset:2048 lds
 buffer_load_dwordx4 v11, s[4:7], s26 offen offset:3072 lds
 s_add_u32 s26, s26, 131072
 s_add_u32 m0, s29, 49152
 s_nop 0
 s_nop 0
 buffer_load_dwordx4 v8, s[4:7], s26 offen offset:0 lds
 buffer_load_dwordx4 v9, s[4:7], s26 offen offset:1024 lds
 buffer_load_dwordx4 v10, s[4:7], s26 offen offset:2048 lds
 buffer_load_dwordx4 v11, s[4:7], s26 offen offset:3072 lds
 s_add_u32 s26, s26, 131072
 s_add_u32 m0, s29, 98304
 s_nop 0
 s_nop 0
 buffer_load_dwordx4 v8, s[4:7], s26 offen offset:0 lds
 buffer_load_dwordx4 v9, s[4:7], s26 offen offset:1024 lds
 buffer_load_dwordx4 v10, s[4:7], s26 offen offset:2048 lds
 buffer_load_dwordx4 v11, s[4:7], s26 offen offset:3072 lds
 s_add_u32 s26, s26, 131072
 s_lshl_b32 s40, s23, 8
 s_lshl_b32 s41, s24, 3
 s_add_u32 s40, s40, s41
 s_nop 0
 s_add_u32 s40, s40, 8192
 s_waitcnt vmcnt(0)
 s_barrier
 s_getpc_b64 s[42:43]
L_far_100005:
 s_nop 0
 s_add_u32 s42, s42, L_att_done_14 - L_far_100005
 s_addc_u32 s43, s43, (L_att_done_14 - L_far_100005) >> 32
 s_setpc_b64 s[42:43]
L_o2_late:
 v_min_u32 v5, 3, v1
 v_lshlrev_b32_e64 v5, 3, v5
 s_mov_b32 s80, 0x20000
 s_branch L_poll_100007
L_again_100008:
 s_sub_u32 s80, s80, 1
 s_cbranch_scc1 L_wt_100006
 s_sleep 2
L_poll_100007:
 buffer_load_dwordx2 v[6:7], v5, s[16:19], s88 offen sc1
 s_waitcnt vmcnt(0)
 v_cmp_ne_u64 vcc, s[36:37], v[6:7]
 s_cmp_lg_u64 vcc, 0
 s_cbranch_scc1 L_again_100008
L_wt_100006:
 s_getpc_b64 s[42:43]
L_far_100009:
 s_nop 0
 s_add_u32 s42, s42, L_o2_ok - L_far_100009
 s_addc_u32 s43, s43, (L_o2_ok - L_far_100009) >> 32
 s_setpc_b64 s[42:43]
L_z2_late:
 v_min_u32 v5, 7, v1
 v_lshlrev_b32_e64 v5, 3, v5
 s_mov_b32 s80, 0x20000
 s_branch L_poll_100011
L_again_100012:
 s_sub_u32 s80, s80, 1
 s_cbranch_scc1 L_wt_100010
 s_sleep 2
L_poll_100011:
 buffer_load_dwordx2 v[6:7], v5, s[16:19], s40 offen sc1
 s_waitcnt vmcnt(0)
 v_cmp_ne_u64 vcc, s[36:37], v[6:7]
 s_cmp_lg_u64 vcc, 0
 s_cbranch_scc1 L_again_100012
L_wt_100010:
 s_branch L_z2_ok
L_o_late:
 v_mov_b32 v5, v60
 s_mov_b32 s80, 0x20000
 s_branch L_poll_100014
L_again_100015:
 s_sub_u32 s80, s80, 1
 s_cbranch_scc1 L_wt_100013
 s_sleep 2
L_poll_100014:
 buffer_load_dwordx2 v[6:7], v5, s[16:19], 0 offen sc1
 s_waitcnt vmcnt(0)
 v_cmp_ne_u64 vcc, s[36:37], v[6:7]
 s_cmp_lg_u64 vcc, 0
 s_cbranch_scc1 L_again_100015
L_wt_100013:
 s_branch L_o_ok
L_u_late:
 v_min_u32 v5, 13, v1
 v_lshlrev_b32_e64 v5, 3, v5
 s_mov_b32 s80, 0x20000
 s_branch L_poll_100017
L_again_100018:
 s_sub_u32 s80, s80, 1
 s_cbranch_scc1 L_wt_100016
 s_sleep 2
L_poll_100017:
 buffer_load_dwordx2 v[6:7], v5, s[16:19], s89 offen sc1
 s_waitcnt vmcnt(0)
 v_cmp_ne_u64 vcc, s[36:37], v[6:7]
 s_cmp_lg_u64 vcc, 0
 s_cbranch_scc1 L_again_100018
L_wt_100016:
 s_branch L_u_ok
L_u_sig:
 s_mov_b64 exec, 1
 v_mov_b32 v5, 0
 v_mov_b32 v6, s36
 v_mov_b32_e64 v7, s37
 buffer_store_dwordx2 v[6:7], v5, s[16:19], s90 offen sc1
 s_mov_b64 exec, -1
 s_branch L_u_sig_ok
.section .rodata,"a"
.p2align 6
.amdhsa_kernel recurrent_scan__sliding_block_cached__mixer_gmlp__prompt_kernel
  .amdhsa_next_free_vgpr 512
  .amdhsa_next_free_sgpr 102
  .amdhsa_accum_offset 256
  .amdhsa_group_segment_fixed_size 0
  .amdhsa_kernarg_size 104
  .amdhsa_user_sgpr_count 2
  .amdhsa_user_sgpr_kernarg_segment_ptr 1
  .amdhsa_system_sgpr_workgroup_id_x 1
.end_amdhsa_kernel
```
